```python
import torch

def _softmax(x, axis=-1):
    return torch.softmax(x, dim=axis)
def _gelu(x):
    return torch.nn.functional.gelu(x, approximate="tanh")
def _silu(x):
    return torch.nn.functional.silu(x)
def _sigmoid(x):
    return torch.sigmoid(x)
def _layernorm(x, axis=-1, eps=1e-5):
    m = x.mean(dim=axis, keepdim=True)
    v = x.var(dim=axis, keepdim=True, unbiased=False)
    return (x - m) / torch.sqrt(v + eps)
def _scatter_add(tgt, idx, src, axis=0):
    return tgt.clone().index_add_(axis, idx, src)
def _segment_sum(src, seg, n):
    out = torch.zeros((n,) + src.shape[1:], dtype=src.dtype)
    return out.index_add_(0, seg, src)
def _pad(x, pw):
    flat = tuple(v for pair in reversed(pw) for v in pair)
    return torch.nn.functional.pad(x, flat)

kernel_name = 'standalone__window_attn_swin__vision'

def setup_inputs():

    _w = (lambda a: (lambda t: t.to(torch.bfloat16) if t.is_floating_point() else t)(torch.as_tensor(a)))
    H = W = 512
    C = 192
    ws = 8
    nh = 4
    shift = ws // 2
    coords = torch.stack(torch.meshgrid(torch.arange(ws), torch.arange(ws), indexing='ij'), 0).reshape(2, -1)
    rel = coords[:, :, None] - coords[:, None, :]
    rel[0] += ws - 1
    rel[1] += ws - 1
    rel[0] *= 2 * ws - 1
    rp_idx = rel.sum(0).to(torch.int64)
    img_mask = torch.zeros((1, H, W, 1), dtype=float)
    cnt = 0
    for hs in (slice(0, H - ws), slice(H - ws, H - shift), slice(H - shift, H)):
        for vs in (slice(0, W - ws), slice(W - ws, W - shift), slice(W - shift, W)):
            img_mask[:, hs, vs, :] = cnt
            cnt += 1
    mw = img_mask.reshape(1, H // ws, ws, W // ws, ws, 1).permute(0, 1, 3, 2, 4, 5).reshape(-1, ws * ws)
    am = mw[:, :, None] - mw[:, None, :]
    attn_mask = torch.where(am != 0, -100.0, 0.0).to(float)
    return {
        "x": _w((lambda *s: torch.randn(*s, dtype=torch.bfloat16) * 1.6)(1, H, W, C)),
        "wqkv": _w((lambda *s: torch.randn(*s, dtype=torch.bfloat16) * 1.6)(C, 3 * C) * 0.02),
        "wo": _w((lambda *s: torch.randn(*s, dtype=torch.bfloat16) * 0.05)(C, C) * 0.02),
        "rpb": _w((lambda *s: torch.randn(*s, dtype=torch.bfloat16) * 0.2)((2 * ws - 1) * (2 * ws - 1), nh)),
        "rp_idx": _w(rp_idx),
        "attn_mask": _w(attn_mask),
    }

def reference(x, wqkv, wo, rpb, rp_idx, attn_mask):
    B, H, W, C = x.shape
    N = rp_idx.shape[0]
    ws = int(round(N ** 0.5))
    nh = rpb.shape[-1]
    hd = C // nh
    shift = ws // 2
    xs = torch.roll(x, (-shift, -shift), (1, 2))
    nWh = H // ws
    nWw = W // ws
    xw = (lambda x, *d: x.permute(*d))(xs.reshape(B, nWh, ws, nWw, ws, C), 0, 1, 3, 2, 4, 5).reshape(B * nWh * nWw, N, C)
    qkv = (lambda x, *d: x.permute(*d))(torch.einsum('wnc,cd->wnd', xw, wqkv).reshape(-1, N, 3, nh, hd), 2, 0, 3, 1, 4)
    q, k, v = qkv[0], qkv[1], qkv[2]
    attn = torch.einsum('whid,whjd->whij', q, k) * (hd ** -0.5)
    bias = (lambda x, *d: x.permute(*d))(rpb[rp_idx.reshape(-1)].reshape(N, N, nh), 2, 0, 1)
    attn = attn + bias[None, :, :, :]
    attn = (attn.reshape(B, nWh * nWw, nh, N, N) + attn_mask[None, :, None, :, :]).reshape(-1, nh, N, N)
    attn = _softmax(attn, axis=-1)
    out = (lambda x, *d: x.permute(*d))(torch.einsum('whij,whjd->whid', attn, v), 0, 2, 1, 3).reshape(-1, N, C)
    out = torch.einsum('wnc,cd->wnd', out, wo)
    out = (lambda x, *d: x.permute(*d))(out.reshape(B, nWh, nWw, ws, ws, C), 0, 1, 3, 2, 4, 5).reshape(B, H, W, C)
    return torch.roll(out, (shift, shift), (1, 2))
```

```asm
; @launch grid=(256,1,1) block=(256,1,1) lds=163840
.amdgcn_target "amdgcn-amd-amdhsa--gfx950"
.text
.globl standalone__window_attn_swin__vision_kernel
.p2align 12
.type standalone__window_attn_swin__vision_kernel,@function
standalone__window_attn_swin__vision_kernel:
  s_mov_b32 s31, 0
L_again:
  s_load_dwordx2 s[8:9], s[0:1], 0
  s_load_dwordx2 s[12:13], s[0:1], 8
  s_cmpk_ge_u32 s2, 256
  s_cbranch_scc1 L_end
  s_getpc_b64 s[42:43]
  s_lshr_b32 s44, s2, 3
  s_lshl_b32 s45, s44, 10
  v_lshl_add_u32 v2, v0, 2, s45
  v_mov_b32 v3, 0
  v_lshl_add_u64 v[2:3], v[2:3], 0, s[42:43]
  global_load_dword v64, v[2:3], off
  v_readfirstlane_b32 s3, v0
  s_load_dwordx2 s[20:21], s[0:1], 24
  s_mov_b32 s11, 0x20000
  s_mov_b32 s15, s11
  s_mov_b32 s14, 223232
  s_mulk_i32 s44, 6912
  v_lshlrev_b32 v26, 5, v0
  s_and_b32 s28, s2, 63
  s_lshr_b32 s29, s2, 6
  s_lshr_b32 s4, s3, 6
  s_lshl_b32 s36, s28, 3
  v_bfe_u32 v21, v0, 3, 3
  v_add3_u32 v25, s36, 4, v21
  v_and_b32 v25, 0x1ff, v25
  v_mul_u32_u24 v25, 0x180, v25
  v_lshrrev_b32 v23, 4, v0
  v_lshrrev_b32 v24, 1, v0
  v_and_b32 v24, 4, v24
  v_bitop3_b32 v24, v24, v23, v0 bitop3:0x96
  v_and_b32 v24, 7, v24
  v_lshl_add_u32 v6, v24, 4, v25
  s_lshl3_add_u32 s36, s29, s4
  s_add_u32 s48, s36, 484
  s_add_u32 s49, s48, 4
  s_and_b32 s49, s49, 0x1ff
  s_mov_b32 s37, 196608
  s_mul_i32 s48, s48, s37
  s_mul_i32 s49, s49, s37
  s_mov_b32 s10, 100663296
  s_waitcnt lgkmcnt(0)
  s_sub_u32 s12, s12, 2048
  s_subb_u32 s13, s13, 0
  buffer_load_dword v65, v26, s[12:15], s44 offen offset:2048
  v_and_b32 v22, 4, v23
  v_and_b32 v24, 2, v21
  v_bitop3_b32 v24, v24, v22, v0 bitop3:0x96
  v_and_b32 v24, 7, v24
  v_mul_u32_u24 v25, 1152, v21
  v_lshl_add_u32 v25, v24, 4, v25
  v_add_u32 v140, 2048, v25
  v_add_u32 v141, 1152, v25
  v_add_u32 v142, 256, v25
  s_mul_i32 s62, s4, 9216
  s_mul_i32 s58, s4, 3072
  s_add_u32 s63, s58, 40960
  s_mov_b32 s22, 1800
  s_mov_b32 s23, s11
  v_lshlrev_b32 v34, 4, v0
  s_lshl_b32 s37, s4, 10
  s_add_u32 m0, s37, 24576
  v_mul_u32_u24 v35, 9, v0
  buffer_load_dwordx4 v34, s[20:23], 0 offen lds
  v_and_b32 v35, -4, v35
  s_load_dwordx2 s[16:17], s[0:1], 16
  s_load_dwordx2 s[24:25], s[0:1], 48
  v_and_b32 v16, 63, v0
  v_and_b32 v17, 15, v16
  v_lshrrev_b32 v18, 4, v16
  v_lshrrev_b32 v20, 2, v17
  v_and_b32 v27, 1, v18
  v_lshrrev_b32 v28, 3, v17
  s_add_u32 m0, s63, 0
  s_add_u32 s36, s62, 0
  buffer_load_dwordx4 v140, s[12:15], s36 offen offset:0 lds
  v_lshl_add_u32 v21, v27, 1, v28
  v_mul_u32_u24 v22, 3072, v18
  v_lshl_add_u32 v22, v20, 7, v22
  v_lshl_add_u32 v22, v21, 5, v22
  v_and_b32 v29, 3, v17
  v_lshl_add_u32 v22, v29, 3, v22
  s_mul_i32 s37, s4, 3
  s_and_b32 s38, s37, 3
  buffer_load_dwordx4 v141, s[12:15], s36 offen offset:1024 lds
  s_lshl_b32 s38, s38, 5
  s_lshr_b32 s39, s37, 2
  s_lshl_b32 s39, s39, 10
  s_add_u32 s39, s39, 40960
  v_xor_b32 v23, s38, v22
  v_add_u32 v12, s39, v23
  v_add_u32 v15, 73728, v12
  s_add_u32 s37, s37, 1
  buffer_load_dwordx4 v142, s[12:15], s36 offen offset:2048 lds
  s_and_b32 s38, s37, 3
  s_lshl_b32 s38, s38, 5
  s_lshr_b32 s39, s37, 2
  s_lshl_b32 s39, s39, 10
  s_add_u32 s39, s39, 40960
  v_xor_b32 v23, s38, v22
  v_add_u32 v13, s39, v23
  v_add_u32 v9, 73728, v13
  s_add_u32 m0, s63, 12288
  s_add_u32 s36, s62, 36864
  buffer_load_dwordx4 v140, s[12:15], s36 offen offset:0 lds
  s_add_u32 s37, s37, 1
  s_and_b32 s38, s37, 3
  s_lshl_b32 s38, s38, 5
  s_lshr_b32 s39, s37, 2
  s_lshl_b32 s39, s39, 10
  s_add_u32 s39, s39, 40960
  v_xor_b32 v23, s38, v22
  v_add_u32 v14, s39, v23
  buffer_load_dwordx4 v141, s[12:15], s36 offen offset:1024 lds
  v_add_u32 v11, 73728, v14
  s_mov_b32 s46, 0x3e553b95
  s_mov_b32 s47, s46
  s_mov_b32 s44, 0xffff0000
  v_bfe_u32 v19, v17, 1, 3
  v_and_b32 v21, 1, v17
  v_lshlrev_b32 v21, 2, v21
  v_xor_b32 v19, v19, v21
  buffer_load_dwordx4 v142, s[12:15], s36 offen offset:2048 lds
  v_xor_b32 v21, v18, v19
  v_lshlrev_b32 v21, 4, v21
  v_lshl_add_u32 v0, v17, 7, v21
  s_lshl_b32 s32, s4, 10
  v_subrev_u32 v10, s32, v0
  v_xor_b32 v1, 64, v0
  v_lshlrev_b32 v22, 4, v17
  v_lshl_add_u32 v23, v18, 10, v22
  s_add_u32 m0, s63, 24576
  s_add_u32 s36, s62, 73728
  buffer_load_dwordx4 v140, s[12:15], s36 offen offset:0 lds
  s_and_b32 s5, s4, 1
  s_lshl_b32 s37, s5, 9
  s_add_u32 s38, s37, 114688
  v_add_u32 v3, s38, v23
  s_sub_u32 s38, 114688, s37
  v_add_u32 v2, s38, v23
  s_lshl_b32 s37, s4, 12
  s_add_u32 s37, s37, 90112
  v_add_u32 v4, s37, v23
  s_lshl_b32 s37, s4, 11
  s_add_u32 s37, s37, 106496
  v_lshrrev_b32 v23, 1, v18
  v_lshl_add_u32 v24, v23, 10, v22
  v_lshl_add_u32 v24, v27, 3, v24
  v_add_u32 v5, s37, v24
  s_mov_b32 s7, 24576
  v_sub_u32 v24, v28, v23
  v_mul_i32_i24 v24, 15, v24
  v_and_b32 v26, 7, v17
  v_lshlrev_b32 v25, 2, v27
  v_sub_u32 v30, v26, v25
  v_add3_u32 v24, v24, v30, 19
  s_lshl_b32 s37, s4, 1
  s_and_b32 s37, s37, 0
  s_mul_i32 s60, s4, 0x02020000
  s_add_u32 s60, s60, 0x01000c0c
  s_add_u32 s37, s37, 24576
  v_lshl_add_u32 v144, v24, 3, s37
  s_waitcnt lgkmcnt(0)
  s_mov_b32 s18, 73728
  s_mov_b32 s19, s11
  v_add_u32 v145, 960, v144
  s_lshl_b32 s37, s28, 3
  v_add3_u32 v24, s37, 4, v26
  v_and_b32 v24, 0x1ff, v24
  v_mul_u32_u24 v24, 0x180, v24
  v_mul_u32_u24 v26, 196608, v28
  v_add_u32 v24, v24, v26
  v_lshl_add_u32 v24, v18, 4, v24
  s_lshr_b32 s37, s4, 1
  s_lshl_b32 s38, s37, 6
  s_add_u32 s39, s38, 256
  v_add_u32 v8, s39, v24
  s_lshl_b32 s39, s5, 7
  s_add_u32 s38, s38, s39
  v_add_u32 v7, s38, v24
  v_and_b32 v24, 16, v16
  v_lshlrev_b32 v24, 2, v24
  v_lshlrev_b32 v26, 4, v16
  v_xor_b32 v24, v24, v26
  v_accvgpr_write_b32 a228, v24
  v_add_u32 v30, v25, v20
  v_mul_u32_u24 v31, 3072, v23
  v_lshl_add_u32 v31, v29, 4, v31
  v_mad_u32_u24 v32, v30, 3, s5
  v_lshrrev_b32 v33, 1, v32
  v_xor_b32 v33, s37, v33
  v_and_b32 v33, 1, v33
  v_lshl_add_u32 v32, v32, 1, v33
  v_lshl_add_u32 v32, v32, 6, v31
  v_add_u32 v32, 114688, v32
  v_accvgpr_write_b32 a229, v32
  v_mad_u32_u24 v32, v30, 3, 2
  v_lshrrev_b32 v33, 1, v32
  buffer_load_dwordx4 v141, s[12:15], s36 offen offset:1024 lds
  v_xor_b32 v33, s37, v33
  v_and_b32 v33, 1, v33
  v_lshl_add_u32 v32, v32, 1, v33
  v_lshl_add_u32 v32, v32, 6, v31
  v_add_u32 v32, 114688, v32
  v_accvgpr_write_b32 a230, v32
  v_mul_u32_u24 v31, 3072, v18
  v_lshl_add_u32 v31, v29, 4, v31
  v_mad_u32_u24 v32, v20, 3, s5
  v_lshrrev_b32 v33, 1, v32
  v_xor_b32 v33, s37, v33
  v_and_b32 v33, 1, v33
  buffer_load_dwordx4 v142, s[12:15], s36 offen offset:2048 lds
  v_lshl_add_u32 v32, v32, 1, v33
  v_lshl_add_u32 v32, v32, 6, v31
  v_accvgpr_write_b32 a231, v32
  v_mad_u32_u24 v32, v20, 3, 2
  v_lshrrev_b32 v33, 1, v32
  v_xor_b32 v33, s37, v33
  v_and_b32 v33, 1, v33
  v_lshl_add_u32 v32, v32, 1, v33
  v_lshl_add_u32 v32, v32, 6, v31
  v_accvgpr_write_b32 a232, v32
  s_mul_i32 s59, s37, 12288
  s_add_u32 s59, s59, s58
  s_add_u32 m0, s63, 36864
  s_add_u32 s36, s62, 110592
  buffer_load_dwordx4 v140, s[12:15], s36 offen offset:0 lds
  v_cmp_eq_u32 vcc, 0, v29
  v_mov_b32 v31, 0x3f803f80
  s_mov_b32 s26, 100663296
  s_mov_b32 s27, s11
  v_cndmask_b32 v31, 0, v31, vcc
  v_accvgpr_write_b32 a240, v31
  s_mov_b64 exec, 0
  s_cmp_eq_u32 s4, 0
  s_cbranch_scc1 L_hop0
  s_cmp_eq_u32 s4, 1
  s_cbranch_scc1 L_hop1
  s_cmp_eq_u32 s4, 2
  s_cbranch_scc1 L_hop2
  s_branch L_hop3
L_hopped:
  s_mov_b64 exec, -1
  v_accvgpr_write_b32 a241, v31
  v_accvgpr_write_b32 a242, v31
  v_accvgpr_write_b32 a243, v31
  v_lshrrev_b32 v150, 2, v16
  v_xor_b32 v151, v16, v150
  buffer_load_dwordx4 v141, s[12:15], s36 offen offset:1024 lds
  s_cmp_eq_u32 s28, 63
  s_cselect_b32 s37, 4, 0
  v_and_b32 v151, s37, v151
  v_cmp_eq_u32 vcc, 0, v151
  s_cmp_eq_u32 s29, 3
  s_cselect_b32 s37, 0xc31044fe, 0
  v_mov_b32 v150, s37
  v_mov_b32 v149, 0xc31044fe
  v_cndmask_b32 v151, 0, v150, vcc
  v_cndmask_b32 v150, v149, 0, vcc
  s_mov_b32 s45, 0x3fb8aa3b
  s_lshl_b32 s37, s29, 3
  buffer_load_dwordx4 v142, s[12:15], s36 offen offset:2048 lds
  s_lshl_b32 s38, s5, 2
  s_waitcnt vmcnt(12)
  s_barrier
  ds_read_b64 v[152:153], v144 offset:24
  s_xor_b32 s39, s38, 0
  ds_read_b64 v[154:155], v144 offset:16
  s_add_u32 s40, s39, s37
  ds_read_b64 v[156:157], v144 offset:8
  s_add_u32 s40, s40, 484
  ds_read_b64 v[158:159], v144 offset:0
  s_and_b32 s40, s40, 0x1ff
  s_add_u32 m0, s63, 49152
  s_add_u32 s36, s62, 147456
  buffer_load_dwordx4 v140, s[12:15], s36 offen offset:0 lds
  s_mul_i32 s40, s40, 196608
  ds_read_b64 v[160:161], v144 offset:264
  s_sub_u32 s39, s39, s4
  ds_read_b64 v[162:163], v144 offset:256
  s_sub_u32 s39, s39, 96
  ds_read_b64 v[164:165], v144 offset:248
  s_mul_i32 s52, s39, 196608
  s_xor_b32 s39, s38, 2
  ds_read_b64 v[166:167], v144 offset:240
  s_add_u32 s41, s39, s37
  ds_read_b64 v[168:169], v144 offset:504
  s_add_u32 s41, s41, 484
  buffer_load_dwordx4 v141, s[12:15], s36 offen offset:1024 lds
  ds_read_b64 v[170:171], v144 offset:496
  s_and_b32 s41, s41, 0x1ff
  ds_read_b64 v[172:173], v144 offset:488
  s_mul_i32 s41, s41, 196608
  s_sub_u32 s39, s39, s4
  ds_read_b64 v[174:175], v144 offset:480
  s_sub_u32 s39, s39, 96
  ds_read_b64 v[176:177], v144 offset:744
  s_mul_i32 s53, s39, 196608
  ds_read_b64 v[178:179], v144 offset:736
  s_xor_b32 s39, s38, 4
  s_add_u32 s42, s39, s37
  buffer_load_dwordx4 v142, s[12:15], s36 offen offset:2048 lds
  ds_read_b64 v[180:181], v144 offset:728
  s_add_u32 s42, s42, 484
  ds_read_b64 v[182:183], v144 offset:720
  s_and_b32 s42, s42, 0x1ff
  ds_read_b64 v[116:117], v144 offset:984
  s_mul_i32 s42, s42, 196608
  ds_read_b64 v[118:119], v144 offset:976
  s_sub_u32 s39, s39, s4
  s_sub_u32 s39, s39, 96
  ds_read_b64 v[120:121], v144 offset:968
  s_mul_i32 s54, s39, 196608
  ds_read_b64 v[122:123], v144 offset:960
  s_add_u32 m0, s63, 61440
  s_add_u32 s36, s62, 184320
  buffer_load_dwordx4 v140, s[12:15], s36 offen offset:0 lds
  s_xor_b32 s39, s38, 6
  ds_read_b64 v[124:125], v144 offset:1224
  s_add_u32 s43, s39, s37
  s_add_u32 s43, s43, 484
  ds_read_b64 v[126:127], v144 offset:1216
  s_and_b32 s43, s43, 0x1ff
  ds_read_b64 v[128:129], v144 offset:1208
  s_mul_i32 s43, s43, 196608
  ds_read_b64 v[130:131], v144 offset:1200
  s_sub_u32 s39, s39, s4
  ds_read_b64 v[132:133], v144 offset:1464
  s_sub_u32 s39, s39, 96
  buffer_load_dwordx4 v141, s[12:15], s36 offen offset:1024 lds
  s_mul_i32 s55, s39, 196608
  ds_read_b64 v[134:135], v144 offset:1456
  s_mul_i32 s34, s32, 3
  ds_read_b64 v[136:137], v144 offset:1448
  s_add_u32 s34, s34, 106496
  ds_read_b64 v[138:139], v144 offset:1440
  s_mov_b32 s35, 1
  s_mov_b32 s30, 1
  s_waitcnt vmcnt(11)
  s_barrier
  ds_read_b64_tr_b16 v[184:185], v12 offset:0
  ds_read_b64_tr_b16 v[186:187], v12 offset:512
  buffer_load_dwordx4 v142, s[12:15], s36 offen offset:2048 lds
  ds_read_b64_tr_b16 v[188:189], v13 offset:0
  ds_read_b64_tr_b16 v[190:191], v13 offset:512
  ds_read_b64_tr_b16 v[192:193], v14 offset:0
  ds_read_b64_tr_b16 v[194:195], v14 offset:512
  ds_read_b64_tr_b16 v[196:197], v12 offset:12288
  ds_read_b64_tr_b16 v[198:199], v12 offset:12800
  ds_read_b64_tr_b16 v[200:201], v13 offset:12288
  ds_read_b64_tr_b16 v[202:203], v13 offset:12800
  ds_read_b64_tr_b16 v[204:205], v14 offset:12288
  ds_read_b64_tr_b16 v[206:207], v14 offset:12800
  s_waitcnt lgkmcnt(12)
  v_perm_b32 v88, v153, v152, s60
  s_lshl_b32 m0, s3, 4
  s_nop 0
  buffer_load_dwordx4 v6, s[8:11], s48 offen offset:0 nt lds
  v_perm_b32 v89, v155, v154, s60
  v_perm_b32 v90, v157, v156, s60
  v_perm_b32 v91, v159, v158, s60
  v_perm_b32 v92, v161, v160, s60
  v_perm_b32 v93, v163, v162, s60
  v_perm_b32 v94, v165, v164, s60
  v_perm_b32 v95, v167, v166, s60
  v_perm_b32 v96, v169, v168, s60
  v_perm_b32 v97, v171, v170, s60
  v_perm_b32 v98, v173, v172, s60
  v_perm_b32 v99, v175, v174, s60
  v_perm_b32 v100, v177, v176, s60
  s_addk_i32 m0, 8064
  s_nop 0
  buffer_load_dwordx4 v6, s[8:11], s48 offen offset:128 nt lds
  v_perm_b32 v101, v179, v178, s60
  v_perm_b32 v102, v181, v180, s60
  v_perm_b32 v103, v183, v182, s60
  v_perm_b32 v104, v117, v116, s60
  v_perm_b32 v105, v119, v118, s60
  v_perm_b32 v106, v121, v120, s60
  v_perm_b32 v107, v123, v122, s60
  v_perm_b32 v108, v125, v124, s60
  v_perm_b32 v109, v127, v126, s60
  v_perm_b32 v110, v129, v128, s60
  v_perm_b32 v111, v131, v130, s60
  v_perm_b32 v112, v133, v132, s60
  s_addk_i32 m0, 8064
  s_nop 0
  buffer_load_dwordx4 v6, s[8:11], s48 offen offset:256 nt lds
  v_perm_b32 v113, v135, v134, s60
  v_perm_b32 v114, v137, v136, s60
  v_perm_b32 v115, v139, v138, s60
  v_fma_f32 v88, v88, s45, v150
  v_fma_f32 v89, v89, s45, v150
  v_fma_f32 v90, v90, s45, v150
  v_fma_f32 v91, v91, s45, v150
  v_fma_f32 v92, v92, s45, v150
  v_fma_f32 v93, v93, s45, v150
  v_fma_f32 v94, v94, s45, v150
  v_fma_f32 v95, v95, s45, v150
  v_fma_f32 v96, v96, s45, v150
  s_lshl_b32 m0, s3, 4
  s_addk_i32 m0, 4096
  s_nop 0
  buffer_load_dwordx4 v6, s[8:11], s49 offen offset:0 nt lds
  v_fma_f32 v97, v97, s45, v150
  v_fma_f32 v98, v98, s45, v150
  v_fma_f32 v99, v99, s45, v150
  v_fma_f32 v100, v100, s45, v150
  v_fma_f32 v101, v101, s45, v150
  v_fma_f32 v102, v102, s45, v150
  v_fma_f32 v103, v103, s45, v150
  v_fma_f32 v104, v104, s45, v150
  v_fma_f32 v105, v105, s45, v150
  v_fma_f32 v106, v106, s45, v150
  v_fma_f32 v107, v107, s45, v150
  v_fma_f32 v108, v108, s45, v150
  s_addk_i32 m0, 8064
  s_nop 0
  buffer_load_dwordx4 v6, s[8:11], s49 offen offset:128 nt lds
  v_fma_f32 v109, v109, s45, v150
  v_fma_f32 v110, v110, s45, v150
  v_fma_f32 v111, v111, s45, v150
  v_fma_f32 v112, v112, s45, v150
  v_fma_f32 v113, v113, s45, v150
  v_fma_f32 v114, v114, s45, v150
  v_fma_f32 v115, v115, s45, v150
  v_add_f32 v152, v151, v112
  v_add_f32 v153, v151, v113
  v_add_f32 v154, v151, v114
  v_add_f32 v155, v151, v115
  v_add_f32 v160, v151, v108
  s_addk_i32 m0, 8064
  s_nop 0
  buffer_load_dwordx4 v6, s[8:11], s49 offen offset:256 nt lds
  v_add_f32 v161, v151, v109
  v_add_f32 v162, v151, v110
  v_add_f32 v163, v151, v111
  v_add_f32 v180, v151, v104
  v_add_f32 v181, v151, v105
  v_add_f32 v182, v151, v106
  v_add_f32 v183, v151, v107
  v_add_f32 v156, v151, v96
  v_add_f32 v157, v151, v97
  v_add_f32 v158, v151, v98
  v_add_f32 v159, v151, v99
  v_add_f32 v172, v151, v92
  s_lshr_b32 s36, s2, 3
  s_mulk_i32 s36, 2304
  buffer_load_dword v66, v35, s[16:19], s36 offen
  v_add_f32 v173, v151, v93
  v_add_f32 v174, v151, v94
  v_add_f32 v175, v151, v95
  v_add_f32 v176, v151, v88
  v_add_f32 v177, v151, v89
  v_add_f32 v178, v151, v90
  v_add_f32 v179, v151, v91
  s_waitcnt lgkmcnt(10)
  v_lshlrev_b32 v40, 16, v184
  v_and_b32 v41, s44, v184
  v_lshlrev_b32 v42, 16, v185
  v_and_b32 v43, s44, v185
  v_lshlrev_b32 v44, 16, v186
  v_and_b32 v45, s44, v186
  v_lshlrev_b32 v46, 16, v187
  v_and_b32 v47, s44, v187
  v_pk_mul_f32 v[40:41], v[40:41], s[46:47]
  v_pk_mul_f32 v[42:43], v[42:43], s[46:47]
  v_pk_mul_f32 v[44:45], v[44:45], s[46:47]
  v_pk_mul_f32 v[46:47], v[46:47], s[46:47]
  v_cvt_pk_bf16_f32 v184, v40, v41
  v_cvt_pk_bf16_f32 v185, v42, v43
  v_cvt_pk_bf16_f32 v186, v44, v45
  s_waitcnt lgkmcnt(0)
  v_cvt_pk_bf16_f32 v187, v46, v47
  v_lshlrev_b32 v48, 16, v188
  v_and_b32 v49, s44, v188
  v_lshlrev_b32 v50, 16, v189
  v_and_b32 v51, s44, v189
  v_lshlrev_b32 v52, 16, v190
  v_and_b32 v53, s44, v190
  v_lshlrev_b32 v54, 16, v191
  v_and_b32 v55, s44, v191
  v_pk_mul_f32 v[48:49], v[48:49], s[46:47]
  v_pk_mul_f32 v[50:51], v[50:51], s[46:47]
  v_pk_mul_f32 v[52:53], v[52:53], s[46:47]
  v_pk_mul_f32 v[54:55], v[54:55], s[46:47]
  v_cvt_pk_bf16_f32 v188, v48, v49
  v_cvt_pk_bf16_f32 v189, v50, v51
  v_cvt_pk_bf16_f32 v190, v52, v53
  v_cvt_pk_bf16_f32 v191, v54, v55
  v_lshlrev_b32 v56, 16, v192
  v_and_b32 v57, s44, v192
  v_lshlrev_b32 v58, 16, v193
  v_and_b32 v59, s44, v193
  v_lshlrev_b32 v60, 16, v194
  v_and_b32 v61, s44, v194
  v_lshlrev_b32 v62, 16, v195
  v_and_b32 v63, s44, v195
  v_pk_mul_f32 v[56:57], v[56:57], s[46:47]
  v_pk_mul_f32 v[58:59], v[58:59], s[46:47]
  v_pk_mul_f32 v[60:61], v[60:61], s[46:47]
  v_pk_mul_f32 v[62:63], v[62:63], s[46:47]
  v_cvt_pk_bf16_f32 v192, v56, v57
  v_cvt_pk_bf16_f32 v193, v58, v59
  v_cvt_pk_bf16_f32 v194, v60, v61
  v_cvt_pk_bf16_f32 v195, v62, v63
  v_lshlrev_b32 v40, 16, v196
  v_and_b32 v41, s44, v196
  v_lshlrev_b32 v42, 16, v197
  v_and_b32 v43, s44, v197
  v_lshlrev_b32 v44, 16, v198
  v_and_b32 v45, s44, v198
  v_lshlrev_b32 v46, 16, v199
  v_and_b32 v47, s44, v199
  v_pk_mul_f32 v[40:41], v[40:41], s[46:47]
  v_pk_mul_f32 v[42:43], v[42:43], s[46:47]
  v_pk_mul_f32 v[44:45], v[44:45], s[46:47]
  v_pk_mul_f32 v[46:47], v[46:47], s[46:47]
  v_cvt_pk_bf16_f32 v196, v40, v41
  v_cvt_pk_bf16_f32 v197, v42, v43
  v_cvt_pk_bf16_f32 v198, v44, v45
  v_cvt_pk_bf16_f32 v199, v46, v47
  v_lshlrev_b32 v48, 16, v200
  v_and_b32 v49, s44, v200
  v_lshlrev_b32 v50, 16, v201
  v_and_b32 v51, s44, v201
  v_lshlrev_b32 v52, 16, v202
  v_and_b32 v53, s44, v202
  v_lshlrev_b32 v54, 16, v203
  v_and_b32 v55, s44, v203
  v_pk_mul_f32 v[48:49], v[48:49], s[46:47]
  v_pk_mul_f32 v[50:51], v[50:51], s[46:47]
  v_pk_mul_f32 v[52:53], v[52:53], s[46:47]
  v_pk_mul_f32 v[54:55], v[54:55], s[46:47]
  v_cvt_pk_bf16_f32 v200, v48, v49
  v_cvt_pk_bf16_f32 v201, v50, v51
  v_cvt_pk_bf16_f32 v202, v52, v53
  v_cvt_pk_bf16_f32 v203, v54, v55
L_hop0:
  s_cbranch_execz L_hopped
  v_lshlrev_b32 v56, 16, v204
  v_and_b32 v57, s44, v204
  v_lshlrev_b32 v58, 16, v205
  v_and_b32 v59, s44, v205
  v_lshlrev_b32 v60, 16, v206
  v_and_b32 v61, s44, v206
  v_lshlrev_b32 v62, 16, v207
  v_and_b32 v63, s44, v207
  v_pk_mul_f32 v[56:57], v[56:57], s[46:47]
  v_pk_mul_f32 v[58:59], v[58:59], s[46:47]
  v_pk_mul_f32 v[60:61], v[60:61], s[46:47]
  v_pk_mul_f32 v[62:63], v[62:63], s[46:47]
  v_cvt_pk_bf16_f32 v204, v56, v57
  v_cvt_pk_bf16_f32 v205, v58, v59
  v_cvt_pk_bf16_f32 v206, v60, v61
  v_cvt_pk_bf16_f32 v207, v62, v63
  s_waitcnt vmcnt(13)
  s_barrier
  ds_read_b64_tr_b16 v[208:209], v12 offset:24576
  ds_read_b64_tr_b16 v[210:211], v12 offset:25088
  ds_read_b64_tr_b16 v[212:213], v13 offset:24576
  ds_read_b64_tr_b16 v[214:215], v13 offset:25088
  ds_read_b64_tr_b16 v[216:217], v14 offset:24576
  ds_read_b64_tr_b16 v[218:219], v14 offset:25088
  ds_read_b64_tr_b16 v[220:221], v12 offset:36864
  ds_read_b64_tr_b16 v[222:223], v12 offset:37376
  ds_read_b64_tr_b16 v[224:225], v13 offset:36864
  ds_read_b64_tr_b16 v[226:227], v13 offset:37376
  ds_read_b64_tr_b16 v[228:229], v14 offset:36864
  ds_read_b64_tr_b16 v[230:231], v14 offset:37376
  s_waitcnt lgkmcnt(10)
  v_lshlrev_b32 v40, 16, v208
  v_and_b32 v41, s44, v208
  v_lshlrev_b32 v42, 16, v209
  v_and_b32 v43, s44, v209
  v_lshlrev_b32 v44, 16, v210
  v_and_b32 v45, s44, v210
  v_lshlrev_b32 v46, 16, v211
  v_and_b32 v47, s44, v211
  v_pk_mul_f32 v[40:41], v[40:41], s[46:47]
  v_pk_mul_f32 v[42:43], v[42:43], s[46:47]
  v_pk_mul_f32 v[44:45], v[44:45], s[46:47]
  v_pk_mul_f32 v[46:47], v[46:47], s[46:47]
  v_cvt_pk_bf16_f32 v208, v40, v41
  v_cvt_pk_bf16_f32 v209, v42, v43
  v_cvt_pk_bf16_f32 v210, v44, v45
  s_waitcnt lgkmcnt(0)
  v_cvt_pk_bf16_f32 v211, v46, v47
  v_lshlrev_b32 v48, 16, v212
  v_and_b32 v49, s44, v212
  v_lshlrev_b32 v50, 16, v213
  v_and_b32 v51, s44, v213
  v_lshlrev_b32 v52, 16, v214
  v_and_b32 v53, s44, v214
  v_lshlrev_b32 v54, 16, v215
  v_and_b32 v55, s44, v215
  v_pk_mul_f32 v[48:49], v[48:49], s[46:47]
  v_pk_mul_f32 v[50:51], v[50:51], s[46:47]
  v_pk_mul_f32 v[52:53], v[52:53], s[46:47]
  v_pk_mul_f32 v[54:55], v[54:55], s[46:47]
  v_cvt_pk_bf16_f32 v212, v48, v49
  v_cvt_pk_bf16_f32 v213, v50, v51
  v_cvt_pk_bf16_f32 v214, v52, v53
  v_cvt_pk_bf16_f32 v215, v54, v55
  v_lshlrev_b32 v56, 16, v216
  v_and_b32 v57, s44, v216
  v_lshlrev_b32 v58, 16, v217
  v_and_b32 v59, s44, v217
  v_lshlrev_b32 v60, 16, v218
  v_and_b32 v61, s44, v218
  v_lshlrev_b32 v62, 16, v219
  v_and_b32 v63, s44, v219
  v_pk_mul_f32 v[56:57], v[56:57], s[46:47]
  v_pk_mul_f32 v[58:59], v[58:59], s[46:47]
  v_pk_mul_f32 v[60:61], v[60:61], s[46:47]
  v_pk_mul_f32 v[62:63], v[62:63], s[46:47]
  v_cvt_pk_bf16_f32 v216, v56, v57
  v_cvt_pk_bf16_f32 v217, v58, v59
  v_cvt_pk_bf16_f32 v218, v60, v61
  v_cvt_pk_bf16_f32 v219, v62, v63
  v_lshlrev_b32 v40, 16, v220
  v_and_b32 v41, s44, v220
  v_lshlrev_b32 v42, 16, v221
  v_and_b32 v43, s44, v221
  v_lshlrev_b32 v44, 16, v222
  v_and_b32 v45, s44, v222
  v_lshlrev_b32 v46, 16, v223
  v_and_b32 v47, s44, v223
  v_pk_mul_f32 v[40:41], v[40:41], s[46:47]
  v_pk_mul_f32 v[42:43], v[42:43], s[46:47]
  v_pk_mul_f32 v[44:45], v[44:45], s[46:47]
  v_pk_mul_f32 v[46:47], v[46:47], s[46:47]
  v_cvt_pk_bf16_f32 v220, v40, v41
  v_cvt_pk_bf16_f32 v221, v42, v43
  v_cvt_pk_bf16_f32 v222, v44, v45
  v_cvt_pk_bf16_f32 v223, v46, v47
  v_lshlrev_b32 v48, 16, v224
  v_and_b32 v49, s44, v224
  v_lshlrev_b32 v50, 16, v225
  v_and_b32 v51, s44, v225
  v_lshlrev_b32 v52, 16, v226
  v_and_b32 v53, s44, v226
  v_lshlrev_b32 v54, 16, v227
  v_and_b32 v55, s44, v227
  v_pk_mul_f32 v[48:49], v[48:49], s[46:47]
  v_pk_mul_f32 v[50:51], v[50:51], s[46:47]
  v_pk_mul_f32 v[52:53], v[52:53], s[46:47]
  v_pk_mul_f32 v[54:55], v[54:55], s[46:47]
  v_cvt_pk_bf16_f32 v224, v48, v49
  v_cvt_pk_bf16_f32 v225, v50, v51
  v_cvt_pk_bf16_f32 v226, v52, v53
  v_cvt_pk_bf16_f32 v227, v54, v55
  v_lshlrev_b32 v56, 16, v228
  v_and_b32 v57, s44, v228
  v_lshlrev_b32 v58, 16, v229
  v_and_b32 v59, s44, v229
  v_lshlrev_b32 v60, 16, v230
  v_and_b32 v61, s44, v230
  v_lshlrev_b32 v62, 16, v231
  v_and_b32 v63, s44, v231
  s_add_u32 m0, s63, 73728
  s_add_u32 s36, s62, 384
  buffer_load_dwordx4 v140, s[12:15], s36 offen offset:0 lds
  v_pk_mul_f32 v[56:57], v[56:57], s[46:47]
  v_pk_mul_f32 v[58:59], v[58:59], s[46:47]
  v_pk_mul_f32 v[60:61], v[60:61], s[46:47]
  v_pk_mul_f32 v[62:63], v[62:63], s[46:47]
  v_cvt_pk_bf16_f32 v228, v56, v57
  v_cvt_pk_bf16_f32 v229, v58, v59
  v_cvt_pk_bf16_f32 v230, v60, v61
  v_cvt_pk_bf16_f32 v231, v62, v63
  s_waitcnt vmcnt(8)
  s_barrier
  ds_read_b64_tr_b16 v[232:233], v12 offset:49152
  ds_read_b64_tr_b16 v[234:235], v12 offset:49664
  ds_read_b64_tr_b16 v[236:237], v13 offset:49152
  ds_read_b64_tr_b16 v[238:239], v13 offset:49664
  ds_read_b64_tr_b16 v[240:241], v14 offset:49152
  ds_read_b64_tr_b16 v[242:243], v14 offset:49664
  ds_read_b64_tr_b16 v[244:245], v12 offset:61440
  ds_read_b64_tr_b16 v[246:247], v12 offset:61952
  ds_read_b64_tr_b16 v[248:249], v13 offset:61440
  ds_read_b64_tr_b16 v[250:251], v13 offset:61952
  buffer_load_dwordx4 v141, s[12:15], s36 offen offset:1024 lds
  ds_read_b64_tr_b16 v[252:253], v14 offset:61440
  ds_read_b64_tr_b16 v[254:255], v14 offset:61952
  s_waitcnt lgkmcnt(10)
  v_lshlrev_b32 v40, 16, v232
  v_and_b32 v41, s44, v232
  v_lshlrev_b32 v42, 16, v233
  v_and_b32 v43, s44, v233
  v_lshlrev_b32 v44, 16, v234
  v_and_b32 v45, s44, v234
  v_lshlrev_b32 v46, 16, v235
  v_and_b32 v47, s44, v235
  v_pk_mul_f32 v[40:41], v[40:41], s[46:47]
  v_pk_mul_f32 v[42:43], v[42:43], s[46:47]
  v_pk_mul_f32 v[44:45], v[44:45], s[46:47]
  v_pk_mul_f32 v[46:47], v[46:47], s[46:47]
  v_cvt_pk_bf16_f32 v232, v40, v41
  v_cvt_pk_bf16_f32 v233, v42, v43
  v_cvt_pk_bf16_f32 v234, v44, v45
  s_waitcnt lgkmcnt(0)
  v_cvt_pk_bf16_f32 v235, v46, v47
  buffer_load_dwordx4 v142, s[12:15], s36 offen offset:2048 lds
  v_lshlrev_b32 v48, 16, v236
  v_and_b32 v49, s44, v236
  v_lshlrev_b32 v50, 16, v237
  v_and_b32 v51, s44, v237
  v_lshlrev_b32 v52, 16, v238
  v_and_b32 v53, s44, v238
  v_lshlrev_b32 v54, 16, v239
  v_and_b32 v55, s44, v239
  v_pk_mul_f32 v[48:49], v[48:49], s[46:47]
  v_pk_mul_f32 v[50:51], v[50:51], s[46:47]
  v_pk_mul_f32 v[52:53], v[52:53], s[46:47]
  v_pk_mul_f32 v[54:55], v[54:55], s[46:47]
  v_cvt_pk_bf16_f32 v236, v48, v49
  v_cvt_pk_bf16_f32 v237, v50, v51
  v_cvt_pk_bf16_f32 v238, v52, v53
  v_cvt_pk_bf16_f32 v239, v54, v55
  v_lshlrev_b32 v56, 16, v240
  v_and_b32 v57, s44, v240
  v_lshlrev_b32 v58, 16, v241
  v_and_b32 v59, s44, v241
  s_add_u32 m0, s63, 86016
  s_add_u32 s36, s62, 37248
  buffer_load_dwordx4 v140, s[12:15], s36 offen offset:0 lds
  v_lshlrev_b32 v60, 16, v242
  v_and_b32 v61, s44, v242
  v_lshlrev_b32 v62, 16, v243
  v_and_b32 v63, s44, v243
  v_pk_mul_f32 v[56:57], v[56:57], s[46:47]
  v_pk_mul_f32 v[58:59], v[58:59], s[46:47]
  v_pk_mul_f32 v[60:61], v[60:61], s[46:47]
  v_pk_mul_f32 v[62:63], v[62:63], s[46:47]
  v_cvt_pk_bf16_f32 v240, v56, v57
  v_cvt_pk_bf16_f32 v241, v58, v59
  v_cvt_pk_bf16_f32 v242, v60, v61
  v_cvt_pk_bf16_f32 v243, v62, v63
  v_lshlrev_b32 v40, 16, v244
  v_and_b32 v41, s44, v244
  v_lshlrev_b32 v42, 16, v245
  v_and_b32 v43, s44, v245
  v_lshlrev_b32 v44, 16, v246
  v_and_b32 v45, s44, v246
  v_lshlrev_b32 v46, 16, v247
  v_and_b32 v47, s44, v247
  buffer_load_dwordx4 v141, s[12:15], s36 offen offset:1024 lds
  v_pk_mul_f32 v[40:41], v[40:41], s[46:47]
  v_pk_mul_f32 v[42:43], v[42:43], s[46:47]
  v_pk_mul_f32 v[44:45], v[44:45], s[46:47]
  v_pk_mul_f32 v[46:47], v[46:47], s[46:47]
  v_cvt_pk_bf16_f32 v244, v40, v41
  v_cvt_pk_bf16_f32 v245, v42, v43
  v_cvt_pk_bf16_f32 v246, v44, v45
  v_cvt_pk_bf16_f32 v247, v46, v47
  v_lshlrev_b32 v48, 16, v248
  v_and_b32 v49, s44, v248
  v_lshlrev_b32 v50, 16, v249
  v_and_b32 v51, s44, v249
  v_lshlrev_b32 v52, 16, v250
  v_and_b32 v53, s44, v250
  v_lshlrev_b32 v54, 16, v251
  v_and_b32 v55, s44, v251
  v_pk_mul_f32 v[48:49], v[48:49], s[46:47]
  v_pk_mul_f32 v[50:51], v[50:51], s[46:47]
  v_pk_mul_f32 v[52:53], v[52:53], s[46:47]
  v_pk_mul_f32 v[54:55], v[54:55], s[46:47]
  buffer_load_dwordx4 v142, s[12:15], s36 offen offset:2048 lds
  v_cvt_pk_bf16_f32 v248, v48, v49
  v_cvt_pk_bf16_f32 v249, v50, v51
  v_cvt_pk_bf16_f32 v250, v52, v53
  v_cvt_pk_bf16_f32 v251, v54, v55
  v_lshlrev_b32 v56, 16, v252
  v_and_b32 v57, s44, v252
  v_lshlrev_b32 v58, 16, v253
  v_and_b32 v59, s44, v253
  v_lshlrev_b32 v60, 16, v254
  v_and_b32 v61, s44, v254
  v_lshlrev_b32 v62, 16, v255
  v_and_b32 v63, s44, v255
  v_pk_mul_f32 v[56:57], v[56:57], s[46:47]
  v_pk_mul_f32 v[58:59], v[58:59], s[46:47]
  v_pk_mul_f32 v[60:61], v[60:61], s[46:47]
  v_pk_mul_f32 v[62:63], v[62:63], s[46:47]
  v_cvt_pk_bf16_f32 v252, v56, v57
  v_cvt_pk_bf16_f32 v253, v58, v59
  v_cvt_pk_bf16_f32 v254, v60, v61
  v_cvt_pk_bf16_f32 v255, v62, v63
  s_lshl3_add_u32 s37, s29, s4
  s_add_u32 s37, s37, 4
  s_mul_i32 s48, s37, 196608
  s_add_u32 s49, s48, 786432
  s_add_u32 s50, s48, 100663296
  s_mov_b32 s10, 95158272
  s_waitcnt vmcnt(7)
  s_barrier
  ds_read_b128 a[144:147], v0 offset:0
  ds_read_b128 a[148:151], v1 offset:0
  ds_read_b128 a[152:155], v0 offset:8192
  ds_read_b128 a[156:159], v1 offset:8192
  ds_read_b128 a[160:163], v0 offset:16384
  ds_read_b128 a[164:167], v1 offset:16384
  s_waitcnt lgkmcnt(4)
  v_mfma_f32_16x16x32_bf16 v[164:167], v[184:187], a[144:147], 0
  v_mfma_f32_16x16x32_bf16 v[164:167], v[196:199], a[148:151], v[164:167]
  s_waitcnt lgkmcnt(0)
  v_mfma_f32_16x16x32_bf16 v[164:167], v[208:211], a[152:155], v[164:167]
  s_add_u32 m0, s63, 98304
  s_add_u32 s36, s62, 74112
  v_mfma_f32_16x16x32_bf16 v[164:167], v[220:223], a[156:159], v[164:167]
  buffer_load_dwordx4 v140, s[12:15], s36 offen offset:0 lds
  v_mfma_f32_16x16x32_bf16 v[164:167], v[232:235], a[160:163], v[164:167]
  v_mfma_f32_16x16x32_bf16 v[164:167], v[244:247], a[164:167], v[164:167]
  ds_read_b128 a[168:171], v0 offset:2048
  ds_read_b128 a[172:175], v1 offset:2048
  v_mfma_f32_16x16x32_bf16 v[168:171], v[248:251], a[164:167], 0
  ds_read_b128 a[176:179], v0 offset:10240
  ds_read_b128 a[180:183], v1 offset:10240
  v_mfma_f32_16x16x32_bf16 v[168:171], v[236:239], a[160:163], v[168:171]
  ds_read_b128 a[184:187], v0 offset:18432
  ds_read_b128 a[188:191], v1 offset:18432
  v_mfma_f32_16x16x32_bf16 v[168:171], v[224:227], a[156:159], v[168:171]
  v_cvt_pk_bf16_f32 v40, v164, v165
  v_cvt_pk_bf16_f32 v41, v166, v167
  v_mfma_f32_16x16x32_bf16 v[168:171], v[212:215], a[152:155], v[168:171]
  buffer_load_dwordx4 v141, s[12:15], s36 offen offset:1024 lds
  v_mfma_f32_16x16x32_bf16 v[168:171], v[200:203], a[148:151], v[168:171]
  buffer_load_dwordx4 v142, s[12:15], s36 offen offset:2048 lds
  v_mfma_f32_16x16x32_bf16 v[168:171], v[188:191], a[144:147], v[168:171]
  v_mfma_f32_16x16x32_bf16 v[164:167], v[192:195], a[144:147], 0
  v_mfma_f32_16x16x32_bf16 v[164:167], v[204:207], a[148:151], v[164:167]
  s_add_u32 m0, s63, 110592
  s_add_u32 s36, s62, 110976
  v_mfma_f32_16x16x32_bf16 v[164:167], v[216:219], a[152:155], v[164:167]
  v_cvt_pk_bf16_f32 v42, v168, v169
  v_cvt_pk_bf16_f32 v43, v170, v171
  v_mfma_f32_16x16x32_bf16 v[164:167], v[228:231], a[156:159], v[164:167]
  buffer_load_dwordx4 v140, s[12:15], s36 offen offset:0 lds
  v_mfma_f32_16x16x32_bf16 v[164:167], v[240:243], a[160:163], v[164:167]
  v_mfma_f32_16x16x32_bf16 v[164:167], v[252:255], a[164:167], v[164:167]
  s_waitcnt lgkmcnt(0)
  v_mfma_f32_16x16x32_bf16 v[168:171], v[184:187], a[168:171], 0
  buffer_load_dwordx4 v141, s[12:15], s36 offen offset:1024 lds
  v_mfma_f32_16x16x32_bf16 v[168:171], v[196:199], a[172:175], v[168:171]
  v_mfma_f32_16x16x32_bf16 v[168:171], v[208:211], a[176:179], v[168:171]
  v_cvt_pk_bf16_f32 v44, v164, v165
  v_cvt_pk_bf16_f32 v45, v166, v167
  v_mfma_f32_16x16x32_bf16 v[168:171], v[220:223], a[180:183], v[168:171]
  ds_read_b128 a[192:195], v0 offset:4096
  ds_read_b128 a[196:199], v1 offset:4096
  v_mfma_f32_16x16x32_bf16 v[168:171], v[232:235], a[184:187], v[168:171]
  ds_read_b128 a[200:203], v0 offset:12288
  ds_read_b128 a[204:207], v1 offset:12288
  v_mfma_f32_16x16x32_bf16 v[168:171], v[244:247], a[188:191], v[168:171]
  ds_read_b128 a[208:211], v0 offset:20480
  ds_read_b128 a[212:215], v1 offset:20480
  v_mfma_f32_16x16x32_bf16 v[164:167], v[248:251], a[188:191], 0
  buffer_load_dwordx4 v142, s[12:15], s36 offen offset:2048 lds
  v_mfma_f32_16x16x32_bf16 v[164:167], v[236:239], a[184:187], v[164:167]
  s_add_u32 m0, s63, 0
  s_add_u32 s36, s62, 147840
  v_mfma_f32_16x16x32_bf16 v[164:167], v[224:227], a[180:183], v[164:167]
  v_cvt_pk_bf16_f32 v52, v168, v169
  v_cvt_pk_bf16_f32 v53, v170, v171
  v_mfma_f32_16x16x32_bf16 v[164:167], v[212:215], a[176:179], v[164:167]
  buffer_load_dwordx4 v140, s[12:15], s36 offen offset:0 lds
  v_mfma_f32_16x16x32_bf16 v[164:167], v[200:203], a[172:175], v[164:167]
  v_mfma_f32_16x16x32_bf16 v[164:167], v[188:191], a[168:171], v[164:167]
  v_mfma_f32_16x16x32_bf16 v[168:171], v[192:195], a[168:171], 0
  s_waitcnt vmcnt(7)
  s_barrier
  v_mfma_f32_16x16x32_bf16 v[168:171], v[204:207], a[172:175], v[168:171]
  buffer_load_dwordx4 v141, s[12:15], s36 offen offset:1024 lds
  v_mfma_f32_16x16x32_bf16 v[168:171], v[216:219], a[176:179], v[168:171]
  v_cvt_pk_bf16_f32 v54, v164, v165
  v_cvt_pk_bf16_f32 v55, v166, v167
  v_mfma_f32_16x16x32_bf16 v[168:171], v[228:231], a[180:183], v[168:171]
  ds_read_b64_tr_b16 a[0:1], v15 offset:0
  ds_read_b64_tr_b16 a[2:3], v15 offset:512
  v_mfma_f32_16x16x32_bf16 v[168:171], v[240:243], a[184:187], v[168:171]
  ds_read_b64_tr_b16 a[4:5], v9 offset:0
  ds_read_b64_tr_b16 a[6:7], v9 offset:512
  v_mfma_f32_16x16x32_bf16 v[168:171], v[252:255], a[188:191], v[168:171]
  s_waitcnt lgkmcnt(4)
  ds_read_b64_tr_b16 a[8:9], v11 offset:0
  v_mfma_f32_16x16x32_bf16 v[164:167], v[184:187], a[192:195], 0
  buffer_load_dwordx4 v142, s[12:15], s36 offen offset:2048 lds
  v_mfma_f32_16x16x32_bf16 v[164:167], v[196:199], a[196:199], v[164:167]
  ds_read_b64_tr_b16 a[10:11], v11 offset:512
  ds_read_b64_tr_b16 a[12:13], v15 offset:12288
  v_mfma_f32_16x16x32_bf16 v[164:167], v[208:211], a[200:203], v[164:167]
  v_cvt_pk_bf16_f32 v56, v168, v169
  v_cvt_pk_bf16_f32 v57, v170, v171
  v_mfma_f32_16x16x32_bf16 v[164:167], v[220:223], a[204:207], v[164:167]
  ds_read_b128 a[216:219], v0 offset:6144
  ds_read_b128 a[220:223], v1 offset:6144
  v_mfma_f32_16x16x32_bf16 v[164:167], v[232:235], a[208:211], v[164:167]
  ds_read_b128 a[224:227], v0 offset:14336
  ds_read_b128 a[244:247], v1 offset:14336
  v_mfma_f32_16x16x32_bf16 v[164:167], v[244:247], a[212:215], v[164:167]
  ds_read_b128 a[248:251], v0 offset:22528
  ds_read_b128 a[252:255], v1 offset:22528
  v_mfma_f32_16x16x32_bf16 v[168:171], v[248:251], a[212:215], 0
  s_add_u32 m0, s63, 12288
  s_add_u32 s36, s62, 184704
  v_mfma_f32_16x16x32_bf16 v[168:171], v[236:239], a[208:211], v[168:171]
  buffer_load_dwordx4 v140, s[12:15], s36 offen offset:0 lds
  v_mfma_f32_16x16x32_bf16 v[168:171], v[224:227], a[204:207], v[168:171]
  v_cvt_pk_bf16_f32 v64, v164, v165
  v_cvt_pk_bf16_f32 v65, v166, v167
  v_mfma_f32_16x16x32_bf16 v[168:171], v[212:215], a[200:203], v[168:171]
  buffer_load_dwordx4 v141, s[12:15], s36 offen offset:1024 lds
  v_mfma_f32_16x16x32_bf16 v[168:171], v[200:203], a[196:199], v[168:171]
  ds_read_b64_tr_b16 a[14:15], v15 offset:12800
  ds_read_b64_tr_b16 a[16:17], v9 offset:12288
  v_mfma_f32_16x16x32_bf16 v[168:171], v[188:191], a[192:195], v[168:171]
  ds_read_b64_tr_b16 a[18:19], v9 offset:12800
  ds_read_b64_tr_b16 a[20:21], v11 offset:12288
  v_mfma_f32_16x16x32_bf16 v[164:167], v[192:195], a[192:195], 0
  ds_read_b64_tr_b16 a[22:23], v11 offset:12800
  v_mfma_f32_16x16x32_bf16 v[164:167], v[204:207], a[196:199], v[164:167]
  buffer_load_dwordx4 v142, s[12:15], s36 offen offset:2048 lds
  v_mfma_f32_16x16x32_bf16 v[164:167], v[216:219], a[200:203], v[164:167]
  v_cvt_pk_bf16_f32 v66, v168, v169
  v_cvt_pk_bf16_f32 v67, v170, v171
  v_mfma_f32_16x16x32_bf16 v[164:167], v[228:231], a[204:207], v[164:167]
  v_mfma_f32_16x16x32_bf16 v[164:167], v[240:243], a[208:211], v[164:167]
  s_add_u32 m0, s63, 24576
  s_add_u32 s36, s62, 768
  v_mfma_f32_16x16x32_bf16 v[164:167], v[252:255], a[212:215], v[164:167]
  s_waitcnt lgkmcnt(5)
  v_mfma_f32_16x16x32_bf16 v[168:171], v[184:187], a[216:219], 0
  buffer_load_dwordx4 v140, s[12:15], s36 offen offset:0 lds
  v_mfma_f32_16x16x32_bf16 v[168:171], v[196:199], a[220:223], v[168:171]
  v_mfma_f32_16x16x32_bf16 v[168:171], v[208:211], a[224:227], v[168:171]
  v_cvt_pk_bf16_f32 v68, v164, v165
  v_cvt_pk_bf16_f32 v69, v166, v167
  v_mfma_f32_16x16x32_bf16 v[168:171], v[220:223], a[244:247], v[168:171]
  s_waitcnt lgkmcnt(0)
  s_waitcnt vmcnt(7)
  s_barrier
  v_mfma_f32_16x16x32_bf16 v[168:171], v[232:235], a[248:251], v[168:171]
  buffer_load_dwordx4 v141, s[12:15], s36 offen offset:1024 lds
  v_mfma_f32_16x16x32_bf16 v[168:171], v[244:247], a[252:255], v[168:171]
  ds_read_b64_tr_b16 a[24:25], v15 offset:24576
  ds_read_b64_tr_b16 a[26:27], v15 offset:25088
  v_mfma_f32_16x16x32_bf16 v[164:167], v[248:251], a[252:255], 0
  ds_read_b64_tr_b16 a[28:29], v9 offset:24576
  ds_read_b64_tr_b16 a[30:31], v9 offset:25088
  v_mfma_f32_16x16x32_bf16 v[164:167], v[236:239], a[248:251], v[164:167]
  ds_read_b64_tr_b16 a[32:33], v11 offset:24576
  ds_read_b64_tr_b16 a[34:35], v11 offset:25088
  v_mfma_f32_16x16x32_bf16 v[164:167], v[224:227], a[244:247], v[164:167]
  v_cvt_pk_bf16_f32 v70, v168, v169
  v_cvt_pk_bf16_f32 v71, v170, v171
  v_mfma_f32_16x16x32_bf16 v[164:167], v[212:215], a[224:227], v[164:167]
  buffer_load_dwordx4 v142, s[12:15], s36 offen offset:2048 lds
  v_mfma_f32_16x16x32_bf16 v[164:167], v[200:203], a[220:223], v[164:167]
  ds_read_b64_tr_b16 a[36:37], v15 offset:36864
  ds_read_b64_tr_b16 a[38:39], v15 offset:37376
  v_mfma_f32_16x16x32_bf16 v[164:167], v[188:191], a[216:219], v[164:167]
  ds_read_b64_tr_b16 a[40:41], v9 offset:36864
  ds_read_b64_tr_b16 a[42:43], v9 offset:37376
  v_mfma_f32_16x16x32_bf16 v[168:171], v[192:195], a[216:219], 0
  s_add_u32 m0, s63, 36864
  s_add_u32 s36, s62, 37632
  v_mfma_f32_16x16x32_bf16 v[168:171], v[204:207], a[220:223], v[168:171]
  buffer_load_dwordx4 v140, s[12:15], s36 offen offset:0 lds
  v_mfma_f32_16x16x32_bf16 v[168:171], v[216:219], a[224:227], v[168:171]
  v_cvt_pk_bf16_f32 v72, v164, v165
  v_cvt_pk_bf16_f32 v73, v166, v167
  v_mfma_f32_16x16x32_bf16 v[168:171], v[228:231], a[244:247], v[168:171]
  ds_read_b64_tr_b16 a[44:45], v11 offset:36864
  ds_read_b64_tr_b16 a[46:47], v11 offset:37376
  v_mfma_f32_16x16x32_bf16 v[168:171], v[240:243], a[248:251], v[168:171]
  v_mfma_f32_16x16x32_bf16 v[168:171], v[252:255], a[252:255], v[168:171]
  buffer_load_dwordx4 v141, s[12:15], s36 offen offset:1024 lds
  v_mfma_f32_16x16x32_bf16 v[116:119], a[0:3], a[144:147], 0
  v_mfma_f32_16x16x32_bf16 v[116:119], a[12:15], a[148:151], v[116:119]
  s_waitcnt lgkmcnt(0)
  v_mfma_f32_16x16x32_bf16 v[116:119], a[24:27], a[152:155], v[116:119]
  v_cvt_pk_bf16_f32 v74, v168, v169
  v_cvt_pk_bf16_f32 v75, v170, v171
  v_mfma_f32_16x16x32_bf16 v[116:119], a[36:39], a[156:159], v[116:119]
  buffer_load_dwordx4 v142, s[12:15], s36 offen offset:2048 lds
  v_mfma_f32_16x16x32_bf16 v[120:123], a[40:43], a[156:159], 0
  v_mfma_f32_16x16x32_bf16 v[120:123], a[28:31], a[152:155], v[120:123]
  v_mfma_f32_16x16x32_bf16 v[120:123], a[16:19], a[148:151], v[120:123]
  v_mfma_f32_16x16x32_bf16 v[120:123], a[4:7], a[144:147], v[120:123]
  s_add_u32 m0, s63, 49152
  s_add_u32 s36, s62, 74496
  v_mfma_f32_16x16x32_bf16 v[124:127], a[8:11], a[144:147], 0
  buffer_load_dwordx4 v140, s[12:15], s36 offen offset:0 lds
  v_mfma_f32_16x16x32_bf16 v[124:127], a[20:23], a[148:151], v[124:127]
  v_mfma_f32_16x16x32_bf16 v[124:127], a[32:35], a[152:155], v[124:127]
  v_mfma_f32_16x16x32_bf16 v[124:127], a[44:47], a[156:159], v[124:127]
  v_mfma_f32_16x16x32_bf16 v[128:131], a[0:3], a[168:171], 0
  s_waitcnt vmcnt(7)
  s_barrier
  v_mfma_f32_16x16x32_bf16 v[128:131], a[12:15], a[172:175], v[128:131]
  buffer_load_dwordx4 v141, s[12:15], s36 offen offset:1024 lds
  v_mfma_f32_16x16x32_bf16 v[128:131], a[24:27], a[176:179], v[128:131]
  ds_read_b64_tr_b16 a[48:49], v12 offset:0
  ds_read_b64_tr_b16 a[50:51], v12 offset:512
  v_mfma_f32_16x16x32_bf16 v[128:131], a[36:39], a[180:183], v[128:131]
  ds_read_b64_tr_b16 a[52:53], v13 offset:0
  ds_read_b64_tr_b16 a[54:55], v13 offset:512
  v_mfma_f32_16x16x32_bf16 v[132:135], a[40:43], a[180:183], 0
  ds_read_b64_tr_b16 a[56:57], v14 offset:0
  ds_read_b64_tr_b16 a[58:59], v14 offset:512
  v_mfma_f32_16x16x32_bf16 v[132:135], a[28:31], a[176:179], v[132:135]
  buffer_load_dwordx4 v142, s[12:15], s36 offen offset:2048 lds
  v_mfma_f32_16x16x32_bf16 v[132:135], a[16:19], a[172:175], v[132:135]
  ds_read_b64_tr_b16 a[60:61], v12 offset:12288
  ds_read_b64_tr_b16 a[62:63], v12 offset:12800
  v_mfma_f32_16x16x32_bf16 v[132:135], a[4:7], a[168:171], v[132:135]
  ds_read_b64_tr_b16 a[64:65], v13 offset:12288
  ds_read_b64_tr_b16 a[66:67], v13 offset:12800
  v_mfma_f32_16x16x32_bf16 v[136:139], a[8:11], a[168:171], 0
  s_add_u32 m0, s63, 61440
  s_add_u32 s36, s62, 111360
  v_mfma_f32_16x16x32_bf16 v[136:139], a[20:23], a[172:175], v[136:139]
  buffer_load_dwordx4 v140, s[12:15], s36 offen offset:0 lds
  v_mfma_f32_16x16x32_bf16 v[136:139], a[32:35], a[176:179], v[136:139]
  ds_read_b64_tr_b16 a[68:69], v14 offset:12288
  ds_read_b64_tr_b16 a[70:71], v14 offset:12800
  v_mfma_f32_16x16x32_bf16 v[136:139], a[44:47], a[180:183], v[136:139]
  v_mfma_f32_16x16x32_bf16 v[16:19], a[0:3], a[192:195], 0
  v_mfma_f32_16x16x32_bf16 v[16:19], a[12:15], a[196:199], v[16:19]
  buffer_load_dwordx4 v141, s[12:15], s36 offen offset:1024 lds
  v_mfma_f32_16x16x32_bf16 v[16:19], a[24:27], a[200:203], v[16:19]
  v_mfma_f32_16x16x32_bf16 v[16:19], a[36:39], a[204:207], v[16:19]
  v_mfma_f32_16x16x32_bf16 v[20:23], a[40:43], a[204:207], 0
  v_mfma_f32_16x16x32_bf16 v[20:23], a[28:31], a[200:203], v[20:23]
  v_mfma_f32_16x16x32_bf16 v[20:23], a[16:19], a[196:199], v[20:23]
  buffer_load_dwordx4 v142, s[12:15], s36 offen offset:2048 lds
  v_mfma_f32_16x16x32_bf16 v[20:23], a[4:7], a[192:195], v[20:23]
  v_mfma_f32_16x16x32_bf16 v[24:27], a[8:11], a[192:195], 0
  v_mfma_f32_16x16x32_bf16 v[24:27], a[20:23], a[196:199], v[24:27]
  s_add_u32 m0, s63, 73728
  s_add_u32 s36, s62, 148224
  v_mfma_f32_16x16x32_bf16 v[24:27], a[32:35], a[200:203], v[24:27]
  buffer_load_dwordx4 v140, s[12:15], s36 offen offset:0 lds
  v_mfma_f32_16x16x32_bf16 v[24:27], a[44:47], a[204:207], v[24:27]
  v_mfma_f32_16x16x32_bf16 v[28:31], a[0:3], a[216:219], 0
  v_mfma_f32_16x16x32_bf16 v[28:31], a[12:15], a[220:223], v[28:31]
  v_mfma_f32_16x16x32_bf16 v[28:31], a[24:27], a[224:227], v[28:31]
  s_waitcnt lgkmcnt(0)
  s_waitcnt vmcnt(7)
  s_barrier
  v_mfma_f32_16x16x32_bf16 v[28:31], a[36:39], a[244:247], v[28:31]
  buffer_load_dwordx4 v141, s[12:15], s36 offen offset:1024 lds
  v_mfma_f32_16x16x32_bf16 v[32:35], a[40:43], a[244:247], 0
  ds_read_b64_tr_b16 a[72:73], v12 offset:24576
  ds_read_b64_tr_b16 a[74:75], v12 offset:25088
  v_mfma_f32_16x16x32_bf16 v[32:35], a[28:31], a[224:227], v[32:35]
  ds_read_b64_tr_b16 a[76:77], v13 offset:24576
  ds_read_b64_tr_b16 a[78:79], v13 offset:25088
  v_mfma_f32_16x16x32_bf16 v[32:35], a[16:19], a[220:223], v[32:35]
  ds_read_b64_tr_b16 a[80:81], v14 offset:24576
  ds_read_b64_tr_b16 a[82:83], v14 offset:25088
  v_mfma_f32_16x16x32_bf16 v[32:35], a[4:7], a[216:219], v[32:35]
  buffer_load_dwordx4 v142, s[12:15], s36 offen offset:2048 lds
  v_mfma_f32_16x16x32_bf16 v[36:39], a[8:11], a[216:219], 0
  ds_read_b64_tr_b16 a[84:85], v12 offset:36864
  ds_read_b64_tr_b16 a[86:87], v12 offset:37376
  v_mfma_f32_16x16x32_bf16 v[36:39], a[20:23], a[220:223], v[36:39]
  ds_read_b64_tr_b16 a[88:89], v13 offset:36864
  ds_read_b64_tr_b16 a[90:91], v13 offset:37376
  v_mfma_f32_16x16x32_bf16 v[36:39], a[32:35], a[224:227], v[36:39]
  s_add_u32 m0, s63, 86016
  s_add_u32 s36, s62, 185088
  v_mfma_f32_16x16x32_bf16 v[36:39], a[44:47], a[244:247], v[36:39]
  buffer_load_dwordx4 v140, s[12:15], s36 offen offset:0 lds
  v_mfma_f32_16x16x32_bf16 v[116:119], a[48:51], a[160:163], v[116:119]
  ds_read_b64_tr_b16 a[92:93], v14 offset:36864
  ds_read_b64_tr_b16 a[94:95], v14 offset:37376
  v_mfma_f32_16x16x32_bf16 v[116:119], a[60:63], a[164:167], v[116:119]
  v_mfma_f32_16x16x32_bf16 v[120:123], a[64:67], a[164:167], v[120:123]
  v_mfma_f32_16x16x32_bf16 v[120:123], a[52:55], a[160:163], v[120:123]
  v_mfma_f32_16x16x32_bf16 v[124:127], a[56:59], a[160:163], v[124:127]
  v_cvt_pk_bf16_f32 v46, v116, v117
  v_cvt_pk_bf16_f32 v47, v118, v119
  v_mfma_f32_16x16x32_bf16 v[124:127], a[68:71], a[164:167], v[124:127]
  buffer_load_dwordx4 v141, s[12:15], s36 offen offset:1024 lds
  v_mfma_f32_16x16x32_bf16 v[128:131], a[48:51], a[184:187], v[128:131]
  v_cvt_pk_bf16_f32 v48, v120, v121
  v_cvt_pk_bf16_f32 v49, v122, v123
  v_mfma_f32_16x16x32_bf16 v[128:131], a[60:63], a[188:191], v[128:131]
  v_mfma_f32_16x16x32_bf16 v[132:135], a[64:67], a[188:191], v[132:135]
  v_cvt_pk_bf16_f32 v50, v124, v125
  v_cvt_pk_bf16_f32 v51, v126, v127
  v_mfma_f32_16x16x32_bf16 v[132:135], a[52:55], a[184:187], v[132:135]
  buffer_load_dwordx4 v142, s[12:15], s36 offen offset:2048 lds
  v_mfma_f32_16x16x32_bf16 v[136:139], a[56:59], a[184:187], v[136:139]
  v_cvt_pk_bf16_f32 v58, v128, v129
  v_cvt_pk_bf16_f32 v59, v130, v131
  v_mfma_f32_16x16x32_bf16 v[136:139], a[68:71], a[188:191], v[136:139]
  s_add_u32 m0, s32, 40960
  v_mfma_f32_16x16x32_bf16 v[16:19], a[48:51], a[208:211], v[16:19]
  v_cvt_pk_bf16_f32 v60, v132, v133
  v_cvt_pk_bf16_f32 v61, v134, v135
  v_mfma_f32_16x16x32_bf16 v[16:19], a[60:63], a[212:215], v[16:19]
  buffer_load_dwordx4 v6, s[8:11], s48 offen offset:0 nt lds
  v_mfma_f32_16x16x32_bf16 v[20:23], a[64:67], a[212:215], v[20:23]
  v_cvt_pk_bf16_f32 v62, v136, v137
  v_cvt_pk_bf16_f32 v63, v138, v139
  v_mfma_f32_16x16x32_bf16 v[20:23], a[52:55], a[208:211], v[20:23]
  s_add_u32 m0, s32, 49024
  v_mfma_f32_16x16x32_bf16 v[24:27], a[56:59], a[208:211], v[24:27]
  v_cvt_pk_bf16_f32 v76, v16, v17
  v_cvt_pk_bf16_f32 v77, v18, v19
  v_mfma_f32_16x16x32_bf16 v[24:27], a[68:71], a[212:215], v[24:27]
  buffer_load_dwordx4 v6, s[8:11], s48 offen offset:128 nt lds
  v_mfma_f32_16x16x32_bf16 v[28:31], a[48:51], a[248:251], v[28:31]
  v_cvt_pk_bf16_f32 v78, v20, v21
L_hop1:
  s_cbranch_execz L_hopped
  v_cvt_pk_bf16_f32 v79, v22, v23
  v_mfma_f32_16x16x32_bf16 v[28:31], a[60:63], a[252:255], v[28:31]
  s_waitcnt lgkmcnt(0)
  s_waitcnt vmcnt(8)
  s_barrier
  v_mfma_f32_16x16x32_bf16 v[32:35], a[64:67], a[252:255], v[32:35]
  v_cvt_pk_bf16_f32 v80, v24, v25
  v_cvt_pk_bf16_f32 v81, v26, v27
  v_mfma_f32_16x16x32_bf16 v[32:35], a[52:55], a[248:251], v[32:35]
  s_add_u32 m0, s32, 57088
  ds_read_b64_tr_b16 a[96:97], v12 offset:49152
  v_mfma_f32_16x16x32_bf16 v[36:39], a[56:59], a[248:251], v[36:39]
  v_cvt_pk_bf16_f32 v82, v28, v29
  v_cvt_pk_bf16_f32 v83, v30, v31
  v_mfma_f32_16x16x32_bf16 v[36:39], a[68:71], a[252:255], v[36:39]
  buffer_load_dwordx4 v6, s[8:11], s48 offen offset:256 nt lds
  v_mfma_f32_16x16x32_bf16 v[116:119], v[46:49], v[70:73], v[152:155]
  v_cvt_pk_bf16_f32 v84, v32, v33
  v_cvt_pk_bf16_f32 v85, v34, v35
  v_mfma_f32_16x16x32_bf16 v[120:123], v[58:61], v[70:73], v[160:163]
  s_add_u32 m0, s32, 45056
  ds_read_b64_tr_b16 a[98:99], v12 offset:49664
  v_mfma_f32_16x16x32_bf16 v[124:127], v[76:79], v[70:73], v[104:107]
  v_cvt_pk_bf16_f32 v86, v36, v37
  v_cvt_pk_bf16_f32 v87, v38, v39
  v_mfma_f32_16x16x32_bf16 v[128:131], v[82:85], v[70:73], v[100:103]
  buffer_load_dwordx4 v6, s[8:11], s49 offen offset:0 nt lds
  v_mfma_f32_16x16x16_bf16 v[116:119], v[50:51], v[74:75], v[116:119]
  s_cmp_lg_u32 s31, 0
  s_cbranch_scc1 L_special0
  v_mfma_f32_16x16x16_bf16 v[120:123], v[62:63], v[74:75], v[120:123]
  s_add_u32 m0, s32, 53120
  ds_read_b64_tr_b16 a[100:101], v13 offset:49152
  v_mfma_f32_16x16x16_bf16 v[124:127], v[80:81], v[74:75], v[124:127]
  buffer_load_dwordx4 v6, s[8:11], s49 offen offset:128 nt lds
  v_mfma_f32_16x16x16_bf16 v[128:131], v[86:87], v[74:75], v[128:131]
  ds_read_b64_tr_b16 a[102:103], v13 offset:49664
  ds_read_b64_tr_b16 a[104:105], v14 offset:49152
  v_mfma_f32_16x16x32_bf16 v[132:135], v[46:49], v[64:67], v[160:163]
  ds_read_b64_tr_b16 a[106:107], v14 offset:49664
  ds_read_b64_tr_b16 a[108:109], v12 offset:61440
  v_mfma_f32_16x16x32_bf16 v[136:139], v[58:61], v[64:67], v[180:183]
  ds_read_b64_tr_b16 a[110:111], v12 offset:61952
  ds_read_b64_tr_b16 a[112:113], v13 offset:61440
  v_mfma_f32_16x16x32_bf16 v[140:143], v[76:79], v[64:67], v[100:103]
  s_add_u32 m0, s32, 61184
  ds_read_b64_tr_b16 a[114:115], v13 offset:61952
  v_mfma_f32_16x16x32_bf16 v[144:147], v[82:85], v[64:67], v[96:99]
  buffer_load_dwordx4 v6, s[8:11], s49 offen offset:256 nt lds
  v_mfma_f32_16x16x16_bf16 v[132:135], v[50:51], v[68:69], v[132:135]
  s_add_u32 s48, s48, 6291456
  s_add_u32 s49, s48, 786432
  v_mfma_f32_16x16x16_bf16 v[136:139], v[62:63], v[68:69], v[136:139]
  ds_read_b64_tr_b16 a[116:117], v14 offset:61440
  ds_read_b64_tr_b16 a[118:119], v14 offset:61952
  v_mfma_f32_16x16x16_bf16 v[140:143], v[80:81], v[68:69], v[140:143]
  s_add_u32 m0, s32, 65536
  v_mfma_f32_16x16x16_bf16 v[144:147], v[86:87], v[68:69], v[144:147]
  buffer_load_dwordx4 v6, s[8:11], s48 offen offset:0 nt lds
  v_mfma_f32_16x16x32_bf16 v[148:151], v[46:49], v[52:55], v[104:107]
  v_exp_f32 v116, v116
  v_mfma_f32_16x16x32_bf16 v[152:155], v[58:61], v[52:55], v[100:103]
  v_exp_f32 v117, v117
  v_mfma_f32_16x16x32_bf16 v[156:159], v[76:79], v[52:55], v[156:159]
  s_add_u32 m0, s32, 73600
  v_mfma_f32_16x16x32_bf16 v[160:163], v[82:85], v[52:55], v[172:175]
  buffer_load_dwordx4 v6, s[8:11], s48 offen offset:128 nt lds
  v_mfma_f32_16x16x16_bf16 v[148:151], v[50:51], v[56:57], v[148:151]
  s_waitcnt lgkmcnt(0)
  s_waitcnt vmcnt(8)
  s_barrier
  v_mfma_f32_16x16x16_bf16 v[152:155], v[62:63], v[56:57], v[152:155]
  ds_read_b64_tr_b16 a[120:121], v15 offset:0
  ds_read_b64_tr_b16 a[122:123], v15 offset:512
  v_mfma_f32_16x16x16_bf16 v[156:159], v[80:81], v[56:57], v[156:159]
  ds_read_b64_tr_b16 a[124:125], v9 offset:0
  ds_read_b64_tr_b16 a[126:127], v9 offset:512
  v_mfma_f32_16x16x16_bf16 v[160:163], v[86:87], v[56:57], v[160:163]
  s_add_u32 m0, s32, 81664
  ds_read_b64_tr_b16 a[128:129], v11 offset:0
  v_mfma_f32_16x16x32_bf16 v[164:167], v[46:49], v[40:43], v[100:103]
  buffer_load_dwordx4 v6, s[8:11], s48 offen offset:256 nt lds
  v_mfma_f32_16x16x32_bf16 v[168:171], v[58:61], v[40:43], v[96:99]
  ds_read_b64_tr_b16 a[130:131], v11 offset:512
  ds_read_b64_tr_b16 a[132:133], v15 offset:12288
  v_mfma_f32_16x16x32_bf16 v[172:175], v[76:79], v[40:43], v[172:175]
  ds_read_b64_tr_b16 a[134:135], v15 offset:12800
  ds_read_b64_tr_b16 a[136:137], v9 offset:12288
  v_mfma_f32_16x16x32_bf16 v[176:179], v[82:85], v[40:43], v[176:179]
  ds_read_b64_tr_b16 a[138:139], v9 offset:12800
  ds_read_b64_tr_b16 a[140:141], v11 offset:12288
  v_mfma_f32_16x16x16_bf16 v[164:167], v[50:51], v[44:45], v[164:167]
  ds_read_b64_tr_b16 a[142:143], v11 offset:12800
  v_mfma_f32_16x16x16_bf16 v[168:171], v[62:63], v[44:45], v[168:171]
  v_exp_f32 v118, v118
  v_mfma_f32_16x16x16_bf16 v[172:175], v[80:81], v[44:45], v[172:175]
  v_exp_f32 v119, v119
  v_mfma_f32_16x16x16_bf16 v[176:179], v[86:87], v[44:45], v[176:179]
  v_exp_f32 v120, v120
L_enter:
  v_mfma_f32_16x16x32_bf16 v[40:43], a[144:147], a[72:75], 0
  v_exp_f32 v121, v121
  v_mfma_f32_16x16x32_bf16 v[40:43], a[148:151], a[84:87], v[40:43]
  v_exp_f32 v122, v122
  v_mfma_f32_16x16x32_bf16 v[40:43], a[152:155], a[96:99], v[40:43]
  v_exp_f32 v123, v123
  v_mfma_f32_16x16x32_bf16 v[40:43], a[156:159], a[108:111], v[40:43]
  s_waitcnt lgkmcnt(0)
  v_mfma_f32_16x16x32_bf16 v[40:43], a[160:163], a[120:123], v[40:43]
  v_exp_f32 v124, v124
  v_mfma_f32_16x16x32_bf16 v[40:43], a[164:167], a[132:135], v[40:43]
  v_cvt_pk_bf16_f32 v116, v116, v117
  v_cvt_pk_bf16_f32 v117, v118, v119
  v_mfma_f32_16x16x32_bf16 v[44:47], a[164:167], a[136:139], 0
  v_cvt_pk_bf16_f32 v118, v120, v121
  v_cvt_pk_bf16_f32 v119, v122, v123
  v_mfma_f32_16x16x32_bf16 v[44:47], a[160:163], a[124:127], v[44:47]
  v_exp_f32 v125, v125
  v_mfma_f32_16x16x32_bf16 v[44:47], a[156:159], a[112:115], v[44:47]
  v_cvt_pk_bf16_f32 v16, v40, v41
  v_cvt_pk_bf16_f32 v17, v42, v43
  v_mfma_f32_16x16x32_bf16 v[44:47], a[152:155], a[100:103], v[44:47]
  v_exp_f32 v126, v126
  v_mfma_f32_16x16x32_bf16 v[44:47], a[148:151], a[88:91], v[44:47]
  v_exp_f32 v127, v127
  v_mfma_f32_16x16x32_bf16 v[44:47], a[144:147], a[76:79], v[44:47]
  v_exp_f32 v128, v128
  v_mfma_f32_16x16x32_bf16 v[40:43], a[144:147], a[80:83], 0
  v_exp_f32 v129, v129
  v_mfma_f32_16x16x32_bf16 v[40:43], a[148:151], a[92:95], v[40:43]
  v_exp_f32 v130, v130
  v_mfma_f32_16x16x32_bf16 v[40:43], a[152:155], a[104:107], v[40:43]
  v_cvt_pk_bf16_f32 v24, v44, v45
  v_cvt_pk_bf16_f32 v25, v46, v47
  v_mfma_f32_16x16x32_bf16 v[40:43], a[156:159], a[116:119], v[40:43]
  v_exp_f32 v131, v131
  v_mfma_f32_16x16x32_bf16 v[40:43], a[160:163], a[128:131], v[40:43]
  v_exp_f32 v132, v132
  v_mfma_f32_16x16x32_bf16 v[40:43], a[164:167], a[140:143], v[40:43]
  v_cvt_pk_bf16_f32 v124, v124, v125
  v_cvt_pk_bf16_f32 v125, v126, v127
  v_mfma_f32_16x16x32_bf16 v[44:47], a[168:171], a[72:75], 0
  v_cvt_pk_bf16_f32 v126, v128, v129
  v_cvt_pk_bf16_f32 v127, v130, v131
  v_mfma_f32_16x16x32_bf16 v[44:47], a[172:175], a[84:87], v[44:47]
  v_exp_f32 v133, v133
  v_mfma_f32_16x16x32_bf16 v[44:47], a[176:179], a[96:99], v[44:47]
  v_cvt_pk_bf16_f32 v32, v40, v41
  v_cvt_pk_bf16_f32 v33, v42, v43
  v_mfma_f32_16x16x32_bf16 v[44:47], a[180:183], a[108:111], v[44:47]
  v_exp_f32 v134, v134
  v_mfma_f32_16x16x32_bf16 v[44:47], a[184:187], a[120:123], v[44:47]
  v_exp_f32 v135, v135
  v_mfma_f32_16x16x32_bf16 v[44:47], a[188:191], a[132:135], v[44:47]
  v_exp_f32 v136, v136
  v_mfma_f32_16x16x32_bf16 v[40:43], a[188:191], a[136:139], 0
  v_exp_f32 v137, v137
  v_mfma_f32_16x16x32_bf16 v[40:43], a[184:187], a[124:127], v[40:43]
  v_exp_f32 v138, v138
  v_mfma_f32_16x16x32_bf16 v[40:43], a[180:183], a[112:115], v[40:43]
  v_cvt_pk_bf16_f32 v18, v44, v45
  v_cvt_pk_bf16_f32 v19, v46, v47
  v_mfma_f32_16x16x32_bf16 v[40:43], a[176:179], a[100:103], v[40:43]
  v_exp_f32 v139, v139
  v_mfma_f32_16x16x32_bf16 v[40:43], a[172:175], a[88:91], v[40:43]
  v_exp_f32 v140, v140
  v_mfma_f32_16x16x32_bf16 v[40:43], a[168:171], a[76:79], v[40:43]
  v_cvt_pk_bf16_f32 v132, v132, v133
  v_cvt_pk_bf16_f32 v133, v134, v135
  v_mfma_f32_16x16x32_bf16 v[44:47], a[168:171], a[80:83], 0
  v_cvt_pk_bf16_f32 v134, v136, v137
  v_cvt_pk_bf16_f32 v135, v138, v139
  v_mfma_f32_16x16x32_bf16 v[44:47], a[172:175], a[92:95], v[44:47]
  v_exp_f32 v141, v141
  v_mfma_f32_16x16x32_bf16 v[44:47], a[176:179], a[104:107], v[44:47]
  v_cvt_pk_bf16_f32 v26, v40, v41
  v_cvt_pk_bf16_f32 v27, v42, v43
  v_mfma_f32_16x16x32_bf16 v[44:47], a[180:183], a[116:119], v[44:47]
  v_exp_f32 v142, v142
  v_mfma_f32_16x16x32_bf16 v[44:47], a[184:187], a[128:131], v[44:47]
  v_exp_f32 v143, v143
  v_mfma_f32_16x16x32_bf16 v[44:47], a[188:191], a[140:143], v[44:47]
  v_exp_f32 v144, v144
  v_mfma_f32_16x16x32_bf16 v[40:43], a[192:195], a[72:75], 0
  v_exp_f32 v145, v145
  v_mfma_f32_16x16x32_bf16 v[40:43], a[196:199], a[84:87], v[40:43]
  v_exp_f32 v146, v146
  v_mfma_f32_16x16x32_bf16 v[40:43], a[200:203], a[96:99], v[40:43]
  v_cvt_pk_bf16_f32 v34, v44, v45
  v_cvt_pk_bf16_f32 v35, v46, v47
  v_mfma_f32_16x16x32_bf16 v[40:43], a[204:207], a[108:111], v[40:43]
  v_exp_f32 v147, v147
  v_mfma_f32_16x16x32_bf16 v[40:43], a[208:211], a[120:123], v[40:43]
  v_exp_f32 v148, v148
  v_mfma_f32_16x16x32_bf16 v[40:43], a[212:215], a[132:135], v[40:43]
  v_cvt_pk_bf16_f32 v140, v140, v141
  v_cvt_pk_bf16_f32 v141, v142, v143
  v_mfma_f32_16x16x32_bf16 v[44:47], a[212:215], a[136:139], 0
  v_cvt_pk_bf16_f32 v142, v144, v145
  v_cvt_pk_bf16_f32 v143, v146, v147
  v_mfma_f32_16x16x32_bf16 v[44:47], a[208:211], a[124:127], v[44:47]
  v_exp_f32 v149, v149
  v_mfma_f32_16x16x32_bf16 v[44:47], a[204:207], a[112:115], v[44:47]
  v_cvt_pk_bf16_f32 v20, v40, v41
  v_cvt_pk_bf16_f32 v21, v42, v43
  v_mfma_f32_16x16x32_bf16 v[44:47], a[200:203], a[100:103], v[44:47]
  v_exp_f32 v150, v150
  v_mfma_f32_16x16x32_bf16 v[44:47], a[196:199], a[88:91], v[44:47]
  v_exp_f32 v151, v151
  v_mfma_f32_16x16x32_bf16 v[44:47], a[192:195], a[76:79], v[44:47]
  v_exp_f32 v152, v152
  v_mfma_f32_16x16x32_bf16 v[40:43], a[192:195], a[80:83], 0
  v_exp_f32 v153, v153
  v_mfma_f32_16x16x32_bf16 v[40:43], a[196:199], a[92:95], v[40:43]
  v_exp_f32 v154, v154
  v_mfma_f32_16x16x32_bf16 v[40:43], a[200:203], a[104:107], v[40:43]
  v_cvt_pk_bf16_f32 v28, v44, v45
  v_cvt_pk_bf16_f32 v29, v46, v47
  v_mfma_f32_16x16x32_bf16 v[40:43], a[204:207], a[116:119], v[40:43]
  v_exp_f32 v155, v155
  v_mfma_f32_16x16x32_bf16 v[40:43], a[208:211], a[128:131], v[40:43]
  v_exp_f32 v156, v156
  v_mfma_f32_16x16x32_bf16 v[40:43], a[212:215], a[140:143], v[40:43]
  v_cvt_pk_bf16_f32 v148, v148, v149
  v_cvt_pk_bf16_f32 v149, v150, v151
  v_mfma_f32_16x16x32_bf16 v[44:47], a[216:219], a[72:75], 0
  v_cvt_pk_bf16_f32 v150, v152, v153
  v_cvt_pk_bf16_f32 v151, v154, v155
  v_mfma_f32_16x16x32_bf16 v[44:47], a[220:223], a[84:87], v[44:47]
  v_exp_f32 v157, v157
  v_mfma_f32_16x16x32_bf16 v[44:47], a[224:227], a[96:99], v[44:47]
  v_cvt_pk_bf16_f32 v36, v40, v41
  v_cvt_pk_bf16_f32 v37, v42, v43
  v_mfma_f32_16x16x32_bf16 v[44:47], a[244:247], a[108:111], v[44:47]
  v_exp_f32 v158, v158
  v_mfma_f32_16x16x32_bf16 v[44:47], a[248:251], a[120:123], v[44:47]
  v_exp_f32 v159, v159
  v_mfma_f32_16x16x32_bf16 v[44:47], a[252:255], a[132:135], v[44:47]
  v_exp_f32 v160, v160
  v_mfma_f32_16x16x32_bf16 v[40:43], a[252:255], a[136:139], 0
  v_exp_f32 v161, v161
  v_mfma_f32_16x16x32_bf16 v[40:43], a[248:251], a[124:127], v[40:43]
  v_exp_f32 v162, v162
  v_mfma_f32_16x16x32_bf16 v[40:43], a[244:247], a[112:115], v[40:43]
  v_cvt_pk_bf16_f32 v22, v44, v45
  v_cvt_pk_bf16_f32 v23, v46, v47
  v_mfma_f32_16x16x32_bf16 v[40:43], a[224:227], a[100:103], v[40:43]
  v_exp_f32 v163, v163
  v_mfma_f32_16x16x32_bf16 v[40:43], a[220:223], a[88:91], v[40:43]
  v_exp_f32 v164, v164
  v_mfma_f32_16x16x32_bf16 v[40:43], a[216:219], a[76:79], v[40:43]
  v_cvt_pk_bf16_f32 v156, v156, v157
  v_cvt_pk_bf16_f32 v157, v158, v159
  v_mfma_f32_16x16x32_bf16 v[44:47], a[216:219], a[80:83], 0
  v_cvt_pk_bf16_f32 v158, v160, v161
  v_cvt_pk_bf16_f32 v159, v162, v163
  v_mfma_f32_16x16x32_bf16 v[44:47], a[220:223], a[92:95], v[44:47]
  v_exp_f32 v165, v165
  v_mfma_f32_16x16x32_bf16 v[44:47], a[224:227], a[104:107], v[44:47]
  v_cvt_pk_bf16_f32 v30, v40, v41
  v_cvt_pk_bf16_f32 v31, v42, v43
  v_mfma_f32_16x16x32_bf16 v[44:47], a[244:247], a[116:119], v[44:47]
  v_exp_f32 v166, v166
  v_mfma_f32_16x16x32_bf16 v[44:47], a[248:251], a[128:131], v[44:47]
  v_exp_f32 v167, v167
  v_mfma_f32_16x16x32_bf16 v[44:47], a[252:255], a[140:143], v[44:47]
  v_exp_f32 v168, v168
  s_add_u32 s32, s32, 40960
  v_add_u32 v0, s32, v10
  v_xor_b32 v1, 64, v0
  v_exp_f32 v169, v169
  v_mfma_f32_16x16x32_bf16 v[144:147], a[240:243], v[116:119], 0
  v_exp_f32 v170, v170
  v_mfma_f32_16x16x32_bf16 v[144:147], a[240:243], v[124:127], v[144:147]
  v_exp_f32 v171, v171
  v_mfma_f32_16x16x32_bf16 v[120:123], v[20:23], v[124:127], 0
  v_cvt_pk_bf16_f32 v38, v44, v45
  v_cvt_pk_bf16_f32 v39, v46, v47
  v_mfma_f32_16x16x32_bf16 v[120:123], v[16:19], v[116:119], v[120:123]
  v_exp_f32 v172, v172
  v_mfma_f32_16x16x32_bf16 v[128:131], v[24:27], v[116:119], 0
  v_rcp_f32 v15, v144
  v_mfma_f32_16x16x32_bf16 v[128:131], v[28:31], v[124:127], v[128:131]
  v_cvt_pk_bf16_f32 v164, v164, v165
  v_cvt_pk_bf16_f32 v165, v166, v167
  v_mfma_f32_16x16x32_bf16 v[136:139], v[36:39], v[124:127], 0
  v_cvt_pk_bf16_f32 v166, v168, v169
  v_cvt_pk_bf16_f32 v167, v170, v171
  v_mfma_f32_16x16x32_bf16 v[136:139], v[32:35], v[116:119], v[136:139]
  v_exp_f32 v173, v173
  v_mfma_f32_16x16x32_bf16 v[144:147], a[240:243], v[132:135], 0
  v_exp_f32 v174, v174
  v_mfma_f32_16x16x32_bf16 v[144:147], a[240:243], v[140:143], v[144:147]
  v_exp_f32 v175, v175
  v_mfma_f32_16x16x32_bf16 v[116:119], v[20:23], v[140:143], 0
  v_exp_f32 v176, v176
  v_mfma_f32_16x16x32_bf16 v[116:119], v[16:19], v[132:135], v[116:119]
  v_exp_f32 v177, v177
  v_mfma_f32_16x16x32_bf16 v[124:127], v[24:27], v[132:135], 0
  v_rcp_f32 v14, v144
  v_mfma_f32_16x16x32_bf16 v[124:127], v[28:31], v[140:143], v[124:127]
  v_exp_f32 v178, v178
  v_mfma_f32_16x16x32_bf16 v[152:155], v[36:39], v[140:143], 0
  v_exp_f32 v179, v179
  v_mfma_f32_16x16x32_bf16 v[152:155], v[32:35], v[132:135], v[152:155]
  v_cvt_pk_bf16_f32 v172, v172, v173
  v_cvt_pk_bf16_f32 v173, v174, v175
  v_mfma_f32_16x16x32_bf16 v[144:147], a[240:243], v[148:151], 0
  v_cvt_pk_bf16_f32 v174, v176, v177
  v_cvt_pk_bf16_f32 v175, v178, v179
  v_mfma_f32_16x16x32_bf16 v[144:147], a[240:243], v[156:159], v[144:147]
  s_waitcnt vmcnt(3)
  s_barrier
  v_mfma_f32_16x16x32_bf16 v[132:135], v[20:23], v[156:159], 0
  s_add_u32 m0, s32, 28672
  v_mul_f32 v120, v15, v120
  v_mfma_f32_16x16x32_bf16 v[132:135], v[16:19], v[148:151], v[132:135]
  ds_read_b128 a[244:247], v0 offset:0
  ds_read_b128 a[248:251], v1 offset:0
  v_mfma_f32_16x16x32_bf16 v[140:143], v[24:27], v[148:151], 0
  v_rcp_f32 v13, v144
  v_mfma_f32_16x16x32_bf16 v[140:143], v[28:31], v[156:159], v[140:143]
  ds_read_b128 a[252:255], v0 offset:8192
  ds_read_b128 v[180:183], v1 offset:8192
  v_mfma_f32_16x16x32_bf16 v[160:163], v[36:39], v[156:159], 0
  buffer_load_dwordx4 v6, s[8:11], s49 offen offset:0 nt lds
  v_mfma_f32_16x16x32_bf16 v[160:163], v[32:35], v[148:151], v[160:163]
  ds_read_b128 v[64:67], v0 offset:16384
  ds_read_b128 v[68:71], v1 offset:16384
  v_mfma_f32_16x16x32_bf16 v[144:147], a[240:243], v[164:167], 0
  s_add_u32 m0, s32, 36736
  v_mul_f32 v121, v15, v121
  v_mfma_f32_16x16x32_bf16 v[144:147], a[240:243], v[172:175], v[144:147]
  buffer_load_dwordx4 v6, s[8:11], s49 offen offset:128 nt lds
  v_mfma_f32_16x16x32_bf16 v[148:151], v[20:23], v[172:175], 0
  s_add_u32 m0, s32, 44800
  v_mul_f32 v122, v15, v122
  v_mfma_f32_16x16x32_bf16 v[148:151], v[16:19], v[164:167], v[148:151]
  buffer_load_dwordx4 v6, s[8:11], s49 offen offset:256 nt lds
  v_mfma_f32_16x16x32_bf16 v[156:159], v[24:27], v[164:167], 0
  v_rcp_f32 v12, v144
  v_mfma_f32_16x16x32_bf16 v[156:159], v[28:31], v[172:175], v[156:159]
  v_mul_f32 v123, v15, v123
  v_cvt_pk_bf16_f32 v120, v120, v121
  v_mfma_f32_16x16x32_bf16 v[168:171], v[36:39], v[172:175], 0
  v_cvt_pk_bf16_f32 v121, v122, v123
  v_mul_f32 v128, v15, v128
  v_mfma_f32_16x16x32_bf16 v[168:171], v[32:35], v[164:167], v[168:171]
  s_waitcnt lgkmcnt(4)
  v_mul_f32 v129, v15, v129
  v_mfma_f32_16x16x32_bf16 v[76:79], v[184:187], a[244:247], 0
  v_mul_f32 v130, v15, v130
  v_mul_f32 v131, v15, v131
  v_mfma_f32_16x16x32_bf16 v[76:79], v[196:199], a[248:251], v[76:79]
  s_waitcnt lgkmcnt(2)
  v_cvt_pk_bf16_f32 v122, v128, v129
  v_mfma_f32_16x16x32_bf16 v[76:79], v[208:211], a[252:255], v[76:79]
  v_cvt_pk_bf16_f32 v123, v130, v131
  v_mfma_f32_16x16x32_bf16 v[76:79], v[220:223], v[180:183], v[76:79]
  s_waitcnt lgkmcnt(0)
  v_mfma_f32_16x16x32_bf16 v[76:79], v[232:235], v[64:67], v[76:79]
  ds_write_b128 v4, v[120:123] offset:768
  v_mfma_f32_16x16x32_bf16 v[76:79], v[244:247], v[68:71], v[76:79]
  v_mul_f32 v136, v15, v136
  v_mul_f32 v137, v15, v137
  v_mfma_f32_16x16x32_bf16 v[80:83], v[248:251], v[68:71], 0
  v_mul_f32 v138, v15, v138
  v_mul_f32 v139, v15, v139
  v_mfma_f32_16x16x32_bf16 v[80:83], v[236:239], v[64:67], v[80:83]
  v_cvt_pk_bf16_f32 v136, v136, v137
  v_cvt_pk_bf16_f32 v137, v138, v139
  v_mfma_f32_16x16x32_bf16 v[80:83], v[224:227], v[180:183], v[80:83]
  v_cvt_pk_bf16_f32 v40, v76, v77
  v_cvt_pk_bf16_f32 v41, v78, v79
  v_mfma_f32_16x16x32_bf16 v[80:83], v[212:215], a[252:255], v[80:83]
  ds_write_b64 v5, v[136:137] offset:768
  v_mfma_f32_16x16x32_bf16 v[80:83], v[200:203], a[248:251], v[80:83]
  v_mul_f32 v116, v14, v116
  v_mul_f32 v117, v14, v117
  v_mfma_f32_16x16x32_bf16 v[80:83], v[188:191], a[244:247], v[80:83]
  v_mul_f32 v118, v14, v118
  v_mul_f32 v119, v14, v119
  v_mfma_f32_16x16x32_bf16 v[76:79], v[192:195], a[244:247], 0
  v_cvt_pk_bf16_f32 v116, v116, v117
  v_cvt_pk_bf16_f32 v117, v118, v119
  v_mfma_f32_16x16x32_bf16 v[76:79], v[204:207], a[248:251], v[76:79]
  v_mul_f32 v124, v14, v124
  v_mul_f32 v125, v14, v125
  v_mfma_f32_16x16x32_bf16 v[76:79], v[216:219], a[252:255], v[76:79]
  v_cvt_pk_bf16_f32 v42, v80, v81
  v_cvt_pk_bf16_f32 v43, v82, v83
  v_mfma_f32_16x16x32_bf16 v[76:79], v[228:231], v[180:183], v[76:79]
  v_mul_f32 v126, v14, v126
  v_mul_f32 v127, v14, v127
  v_mfma_f32_16x16x32_bf16 v[76:79], v[240:243], v[64:67], v[76:79]
  v_cvt_pk_bf16_f32 v118, v124, v125
  v_cvt_pk_bf16_f32 v119, v126, v127
  v_mfma_f32_16x16x32_bf16 v[76:79], v[252:255], v[68:71], v[76:79]
  ds_write_b128 v4, v[116:119] offset:512
  v_mfma_f32_16x16x32_bf16 v[80:83], a[60:63], v[68:71], 0
  v_mul_f32 v152, v14, v152
  v_mul_f32 v153, v14, v153
  v_mfma_f32_16x16x32_bf16 v[80:83], a[48:51], v[64:67], v[80:83]
  v_mul_f32 v154, v14, v154
  v_mul_f32 v155, v14, v155
  v_mfma_f32_16x16x32_bf16 v[80:83], a[36:39], v[180:183], v[80:83]
  v_cvt_pk_bf16_f32 v44, v76, v77
  v_cvt_pk_bf16_f32 v45, v78, v79
  v_mfma_f32_16x16x32_bf16 v[80:83], a[24:27], a[252:255], v[80:83]
  v_cvt_pk_bf16_f32 v152, v152, v153
  v_cvt_pk_bf16_f32 v153, v154, v155
  v_mfma_f32_16x16x32_bf16 v[80:83], a[12:15], a[248:251], v[80:83]
  ds_write_b64 v5, v[152:153] offset:512
  v_mfma_f32_16x16x32_bf16 v[80:83], a[0:3], a[244:247], v[80:83]
  v_mul_f32 v132, v13, v132
  v_mul_f32 v133, v13, v133
  v_mfma_f32_16x16x32_bf16 v[76:79], a[4:7], a[244:247], 0
  v_mul_f32 v134, v13, v134
  v_mul_f32 v135, v13, v135
  v_mfma_f32_16x16x32_bf16 v[76:79], a[16:19], a[248:251], v[76:79]
  v_cvt_pk_bf16_f32 v132, v132, v133
  v_cvt_pk_bf16_f32 v133, v134, v135
  v_mfma_f32_16x16x32_bf16 v[76:79], a[28:31], a[252:255], v[76:79]
  v_cvt_pk_bf16_f32 v46, v80, v81
  v_cvt_pk_bf16_f32 v47, v82, v83
  v_mfma_f32_16x16x32_bf16 v[76:79], a[40:43], v[180:183], v[76:79]
  v_mul_f32 v140, v13, v140
  v_mul_f32 v141, v13, v141
  v_mfma_f32_16x16x32_bf16 v[76:79], a[52:55], v[64:67], v[76:79]
  v_mul_f32 v142, v13, v142
  v_mul_f32 v143, v13, v143
  v_mfma_f32_16x16x32_bf16 v[76:79], a[64:67], v[68:71], v[76:79]
  v_cvt_pk_bf16_f32 v134, v140, v141
  v_cvt_pk_bf16_f32 v135, v142, v143
  v_mfma_f32_16x16x32_bf16 v[80:83], a[68:71], v[68:71], 0
  ds_write_b128 v4, v[132:135] offset:256
  v_mfma_f32_16x16x32_bf16 v[80:83], a[56:59], v[64:67], v[80:83]
  v_mul_f32 v160, v13, v160
  v_mul_f32 v161, v13, v161
  v_mfma_f32_16x16x32_bf16 v[80:83], a[44:47], v[180:183], v[80:83]
  v_cvt_pk_bf16_f32 v48, v76, v77
  v_cvt_pk_bf16_f32 v49, v78, v79
  v_mfma_f32_16x16x32_bf16 v[80:83], a[32:35], a[252:255], v[80:83]
  v_mul_f32 v162, v13, v162
  v_mul_f32 v163, v13, v163
  v_mfma_f32_16x16x32_bf16 v[80:83], a[20:23], a[248:251], v[80:83]
  v_cvt_pk_bf16_f32 v160, v160, v161
  v_cvt_pk_bf16_f32 v161, v162, v163
  v_mfma_f32_16x16x32_bf16 v[80:83], a[8:11], a[244:247], v[80:83]
  ds_write_b64 v5, v[160:161] offset:256
  v_mfma_f32_16x16x32_bf16 v[76:79], a[244:247], a[72:75], 0
  v_mul_f32 v148, v12, v148
  v_mul_f32 v149, v12, v149
  v_mfma_f32_16x16x32_bf16 v[76:79], a[248:251], a[84:87], v[76:79]
  v_mul_f32 v150, v12, v150
  v_mul_f32 v151, v12, v151
  v_mfma_f32_16x16x32_bf16 v[76:79], a[252:255], a[96:99], v[76:79]
  v_cvt_pk_bf16_f32 v50, v80, v81
  v_cvt_pk_bf16_f32 v51, v82, v83
  v_mfma_f32_16x16x32_bf16 v[76:79], v[180:183], a[108:111], v[76:79]
  ds_read_b128 v[72:75], v0 offset:2048
  v_cvt_pk_bf16_f32 v148, v148, v149
  v_mfma_f32_16x16x32_bf16 v[76:79], v[64:67], a[120:123], v[76:79]
  ds_read_b128 v[84:87], v1 offset:2048
  v_cvt_pk_bf16_f32 v149, v150, v151
  v_mfma_f32_16x16x32_bf16 v[76:79], v[68:71], a[132:135], v[76:79]
  ds_read_b128 v[164:167], v0 offset:10240
  v_mul_f32 v156, v12, v156
  v_mfma_f32_16x16x32_bf16 v[80:83], v[68:71], a[136:139], 0
  ds_read_b128 v[172:175], v1 offset:10240
  v_mul_f32 v157, v12, v157
  v_mfma_f32_16x16x32_bf16 v[80:83], v[64:67], a[124:127], v[80:83]
  ds_read_b128 v[176:179], v0 offset:18432
  v_mul_f32 v158, v12, v158
  v_mfma_f32_16x16x32_bf16 v[80:83], v[180:183], a[112:115], v[80:83]
  v_cvt_pk_bf16_f32 v16, v76, v77
  v_cvt_pk_bf16_f32 v17, v78, v79
  v_mfma_f32_16x16x32_bf16 v[80:83], a[252:255], a[100:103], v[80:83]
  ds_read_b128 v[144:147], v1 offset:18432
  v_mul_f32 v159, v12, v159
  v_mfma_f32_16x16x32_bf16 v[80:83], a[248:251], a[88:91], v[80:83]
  v_cvt_pk_bf16_f32 v150, v156, v157
  v_cvt_pk_bf16_f32 v151, v158, v159
  v_mfma_f32_16x16x32_bf16 v[80:83], a[244:247], a[76:79], v[80:83]
  ds_write_b128 v4, v[148:151] offset:0
  v_mfma_f32_16x16x32_bf16 v[76:79], a[244:247], a[80:83], 0
  v_mul_f32 v168, v12, v168
  v_mul_f32 v169, v12, v169
  v_mfma_f32_16x16x32_bf16 v[76:79], a[248:251], a[92:95], v[76:79]
  v_mul_f32 v170, v12, v170
  v_mul_f32 v171, v12, v171
  v_mfma_f32_16x16x32_bf16 v[76:79], a[252:255], a[104:107], v[76:79]
  v_cvt_pk_bf16_f32 v24, v80, v81
  v_cvt_pk_bf16_f32 v25, v82, v83
  v_mfma_f32_16x16x32_bf16 v[76:79], v[180:183], a[116:119], v[76:79]
  v_cvt_pk_bf16_f32 v168, v168, v169
  v_cvt_pk_bf16_f32 v169, v170, v171
  v_mfma_f32_16x16x32_bf16 v[76:79], v[64:67], a[128:131], v[76:79]
  ds_write_b64 v5, v[168:169] offset:0
  v_mfma_f32_16x16x32_bf16 v[76:79], v[68:71], a[140:143], v[76:79]
  s_waitcnt lgkmcnt(2)
  v_subrev_u32 v3, s7, v3
  v_mfma_f32_16x16x32_bf16 v[80:83], v[184:187], v[72:75], 0
  v_subrev_u32 v2, s7, v2
  v_add_u32 v4, s7, v4
  v_mfma_f32_16x16x32_bf16 v[80:83], v[196:199], v[84:87], v[80:83]
  v_add_u32 v5, s7, v5
  s_sub_u32 s7, 0, s7
  v_mfma_f32_16x16x32_bf16 v[80:83], v[208:211], v[164:167], v[80:83]
  v_cvt_pk_bf16_f32 v32, v76, v77
  v_cvt_pk_bf16_f32 v33, v78, v79
  v_mfma_f32_16x16x32_bf16 v[80:83], v[220:223], v[172:175], v[80:83]
  v_max_f32 v9, v12, v13
  v_max3_f32 v9, v14, v15, v9
  v_mfma_f32_16x16x32_bf16 v[80:83], v[232:235], v[176:179], v[80:83]
  v_min_f32 v11, v12, v13
  v_min3_f32 v11, v14, v15, v11
  v_mfma_f32_16x16x32_bf16 v[80:83], v[244:247], v[144:147], v[80:83]
  v_accvgpr_read_b32 v180, a228
  v_mfma_f32_16x16x32_bf16 v[76:79], v[248:251], v[144:147], 0
  s_add_u32 m0, s58, 114688
  s_add_u32 s36, s58, 0
  v_mfma_f32_16x16x32_bf16 v[76:79], v[236:239], v[176:179], v[76:79]
  buffer_load_dwordx4 v180, s[16:19], s36 offen offset:0 lds
  v_mfma_f32_16x16x32_bf16 v[76:79], v[224:227], v[172:175], v[76:79]
  v_cvt_pk_bf16_f32 v52, v80, v81
  v_cvt_pk_bf16_f32 v53, v82, v83
  v_mfma_f32_16x16x32_bf16 v[76:79], v[212:215], v[164:167], v[76:79]
  buffer_load_dwordx4 v180, s[16:19], s36 offen offset:1024 lds
  v_mfma_f32_16x16x32_bf16 v[76:79], v[200:203], v[84:87], v[76:79]
  v_mfma_f32_16x16x32_bf16 v[76:79], v[188:191], v[72:75], v[76:79]
  v_mfma_f32_16x16x32_bf16 v[80:83], v[192:195], v[72:75], 0
  v_mfma_f32_16x16x32_bf16 v[80:83], v[204:207], v[84:87], v[80:83]
  buffer_load_dwordx4 v180, s[16:19], s36 offen offset:2048 lds
  v_mfma_f32_16x16x32_bf16 v[80:83], v[216:219], v[164:167], v[80:83]
  v_cvt_pk_bf16_f32 v54, v76, v77
  v_cvt_pk_bf16_f32 v55, v78, v79
  v_mfma_f32_16x16x32_bf16 v[80:83], v[228:231], v[172:175], v[80:83]
  v_mfma_f32_16x16x32_bf16 v[80:83], v[240:243], v[176:179], v[80:83]
  s_add_u32 m0, s58, 126976
  s_add_u32 s36, s58, 18432
  v_mfma_f32_16x16x32_bf16 v[80:83], v[252:255], v[144:147], v[80:83]
  buffer_load_dwordx4 v180, s[16:19], s36 offen offset:0 lds
  v_mfma_f32_16x16x32_bf16 v[76:79], a[60:63], v[144:147], 0
  v_mfma_f32_16x16x32_bf16 v[76:79], a[48:51], v[176:179], v[76:79]
  v_mfma_f32_16x16x32_bf16 v[76:79], a[36:39], v[172:175], v[76:79]
  v_cvt_pk_bf16_f32 v56, v80, v81
  v_cvt_pk_bf16_f32 v57, v82, v83
  v_mfma_f32_16x16x32_bf16 v[76:79], a[24:27], v[164:167], v[76:79]
  buffer_load_dwordx4 v180, s[16:19], s36 offen offset:1024 lds
  v_mfma_f32_16x16x32_bf16 v[76:79], a[12:15], v[84:87], v[76:79]
  v_mfma_f32_16x16x32_bf16 v[76:79], a[0:3], v[72:75], v[76:79]
  v_mfma_f32_16x16x32_bf16 v[80:83], a[4:7], v[72:75], 0
  buffer_load_dwordx4 v180, s[16:19], s36 offen offset:2048 lds
  v_mfma_f32_16x16x32_bf16 v[80:83], a[16:19], v[84:87], v[80:83]
  v_mfma_f32_16x16x32_bf16 v[80:83], a[28:31], v[164:167], v[80:83]
  v_cvt_pk_bf16_f32 v58, v76, v77
  v_cvt_pk_bf16_f32 v59, v78, v79
  v_mfma_f32_16x16x32_bf16 v[80:83], a[40:43], v[172:175], v[80:83]
  s_add_u32 m0, s58, 139264
  s_add_u32 s36, s58, 36864
  v_mfma_f32_16x16x32_bf16 v[80:83], a[52:55], v[176:179], v[80:83]
  buffer_load_dwordx4 v180, s[16:19], s36 offen offset:0 lds
  v_mfma_f32_16x16x32_bf16 v[80:83], a[64:67], v[144:147], v[80:83]
  v_mfma_f32_16x16x32_bf16 v[76:79], a[68:71], v[144:147], 0
  v_mfma_f32_16x16x32_bf16 v[76:79], a[56:59], v[176:179], v[76:79]
  buffer_load_dwordx4 v180, s[16:19], s36 offen offset:1024 lds
  v_mfma_f32_16x16x32_bf16 v[76:79], a[44:47], v[172:175], v[76:79]
  v_cvt_pk_bf16_f32 v60, v80, v81
  v_cvt_pk_bf16_f32 v61, v82, v83
  v_mfma_f32_16x16x32_bf16 v[76:79], a[32:35], v[164:167], v[76:79]
  v_mfma_f32_16x16x32_bf16 v[76:79], a[20:23], v[84:87], v[76:79]
  v_mfma_f32_16x16x32_bf16 v[76:79], a[8:11], v[72:75], v[76:79]
  buffer_load_dwordx4 v180, s[16:19], s36 offen offset:2048 lds
  v_mfma_f32_16x16x32_bf16 v[80:83], v[72:75], a[72:75], 0
  v_mfma_f32_16x16x32_bf16 v[80:83], v[84:87], a[84:87], v[80:83]
  v_mfma_f32_16x16x32_bf16 v[80:83], v[164:167], a[96:99], v[80:83]
  v_cvt_pk_bf16_f32 v62, v76, v77
  v_cvt_pk_bf16_f32 v63, v78, v79
  v_mfma_f32_16x16x32_bf16 v[80:83], v[172:175], a[108:111], v[80:83]
  ds_read_b128 v[116:119], v0 offset:4096
  v_mfma_f32_16x16x32_bf16 v[80:83], v[176:179], a[120:123], v[80:83]
  ds_read_b128 v[120:123], v1 offset:4096
L_hop2:
  s_cbranch_execz L_hopped
  v_mfma_f32_16x16x32_bf16 v[80:83], v[144:147], a[132:135], v[80:83]
  ds_read_b128 v[124:127], v0 offset:12288
  v_mfma_f32_16x16x32_bf16 v[76:79], v[144:147], a[136:139], 0
  ds_read_b128 v[128:131], v1 offset:12288
  v_mfma_f32_16x16x32_bf16 v[76:79], v[176:179], a[124:127], v[76:79]
  ds_read_b128 v[132:135], v0 offset:20480
  v_mfma_f32_16x16x32_bf16 v[76:79], v[172:175], a[112:115], v[76:79]
  v_cvt_pk_bf16_f32 v18, v80, v81
  v_cvt_pk_bf16_f32 v19, v82, v83
  v_mfma_f32_16x16x32_bf16 v[76:79], v[164:167], a[100:103], v[76:79]
  ds_read_b128 v[136:139], v1 offset:20480
  v_mfma_f32_16x16x32_bf16 v[76:79], v[84:87], a[88:91], v[76:79]
  s_add_u32 m0, s58, 151552
  s_add_u32 s36, s58, 55296
  v_mfma_f32_16x16x32_bf16 v[76:79], v[72:75], a[76:79], v[76:79]
  buffer_load_dwordx4 v180, s[16:19], s36 offen offset:0 lds
  v_mfma_f32_16x16x32_bf16 v[80:83], v[72:75], a[80:83], 0
  buffer_load_dwordx4 v180, s[16:19], s36 offen offset:1024 lds
  v_mfma_f32_16x16x32_bf16 v[80:83], v[84:87], a[92:95], v[80:83]
  buffer_load_dwordx4 v180, s[16:19], s36 offen offset:2048 lds
  v_mfma_f32_16x16x32_bf16 v[80:83], v[164:167], a[104:107], v[80:83]
  v_cvt_pk_bf16_f32 v26, v76, v77
  v_cvt_pk_bf16_f32 v27, v78, v79
  v_mfma_f32_16x16x32_bf16 v[80:83], v[172:175], a[116:119], v[80:83]
  s_add_u32 m0, s58, 0
  s_add_u32 s36, s59, 12288
  v_mfma_f32_16x16x32_bf16 v[80:83], v[176:179], a[128:131], v[80:83]
  buffer_load_dwordx4 v180, s[16:19], s36 offen offset:0 lds
  v_mfma_f32_16x16x32_bf16 v[80:83], v[144:147], a[140:143], v[80:83]
  s_waitcnt lgkmcnt(0)
  v_mfma_f32_16x16x32_bf16 v[148:151], v[184:187], v[116:119], 0
  buffer_load_dwordx4 v180, s[16:19], s36 offen offset:1024 lds
  v_mfma_f32_16x16x32_bf16 v[148:151], v[196:199], v[120:123], v[148:151]
  v_mfma_f32_16x16x32_bf16 v[148:151], v[208:211], v[124:127], v[148:151]
  v_cvt_pk_bf16_f32 v34, v80, v81
  v_cvt_pk_bf16_f32 v35, v82, v83
  v_mfma_f32_16x16x32_bf16 v[148:151], v[220:223], v[128:131], v[148:151]
  buffer_load_dwordx4 v180, s[16:19], s36 offen offset:2048 lds
  v_mfma_f32_16x16x32_bf16 v[148:151], v[232:235], v[132:135], v[148:151]
  v_mfma_f32_16x16x32_bf16 v[148:151], v[244:247], v[136:139], v[148:151]
  v_mfma_f32_16x16x32_bf16 v[152:155], v[248:251], v[136:139], 0
  ds_read_b128 v[140:143], v0 offset:6144
  v_mfma_f32_16x16x32_bf16 v[152:155], v[236:239], v[132:135], v[152:155]
  ds_read_b128 v[144:147], v1 offset:6144
  v_mfma_f32_16x16x32_bf16 v[152:155], v[224:227], v[128:131], v[152:155]
  v_cvt_pk_bf16_f32 v64, v148, v149
  v_cvt_pk_bf16_f32 v65, v150, v151
  v_mfma_f32_16x16x32_bf16 v[152:155], v[212:215], v[124:127], v[152:155]
  ds_read_b128 v[156:159], v0 offset:14336
  v_mfma_f32_16x16x32_bf16 v[152:155], v[200:203], v[120:123], v[152:155]
  ds_read_b128 v[160:163], v1 offset:14336
  v_mfma_f32_16x16x32_bf16 v[152:155], v[188:191], v[116:119], v[152:155]
  ds_read_b128 v[164:167], v0 offset:22528
  v_mfma_f32_16x16x32_bf16 v[148:151], v[192:195], v[116:119], 0
  ds_read_b128 v[168:171], v1 offset:22528
  v_mfma_f32_16x16x32_bf16 v[148:151], v[204:207], v[120:123], v[148:151]
  s_add_u32 m0, s58, 12288
  s_add_u32 s36, s59, 49152
  v_mfma_f32_16x16x32_bf16 v[148:151], v[216:219], v[124:127], v[148:151]
  v_cvt_pk_bf16_f32 v66, v152, v153
  v_cvt_pk_bf16_f32 v67, v154, v155
  v_mfma_f32_16x16x32_bf16 v[148:151], v[228:231], v[128:131], v[148:151]
  buffer_load_dwordx4 v180, s[16:19], s36 offen offset:0 lds
  v_mfma_f32_16x16x32_bf16 v[148:151], v[240:243], v[132:135], v[148:151]
  buffer_load_dwordx4 v180, s[16:19], s36 offen offset:1024 lds
  v_mfma_f32_16x16x32_bf16 v[148:151], v[252:255], v[136:139], v[148:151]
  buffer_load_dwordx4 v180, s[16:19], s36 offen offset:2048 lds
  v_mfma_f32_16x16x32_bf16 v[152:155], a[60:63], v[136:139], 0
  v_accvgpr_read_b32 v180, a229
  v_accvgpr_read_b32 v181, a230
  v_mfma_f32_16x16x32_bf16 v[152:155], a[48:51], v[132:135], v[152:155]
  v_accvgpr_read_b32 v182, a231
  v_accvgpr_read_b32 v183, a232
  v_mfma_f32_16x16x32_bf16 v[152:155], a[36:39], v[128:131], v[152:155]
  v_cvt_pk_bf16_f32 v68, v148, v149
  v_cvt_pk_bf16_f32 v69, v150, v151
  v_mfma_f32_16x16x32_bf16 v[152:155], a[24:27], v[124:127], v[152:155]
  s_add_u32 s48, s48, 6291456
  s_add_u32 s49, s48, 786432
  v_mfma_f32_16x16x32_bf16 v[152:155], a[12:15], v[120:123], v[152:155]
  s_sub_u32 s33, s32, 40960
  s_add_u32 s32, s33, 65536
  v_mfma_f32_16x16x32_bf16 v[152:155], a[0:3], v[116:119], v[152:155]
  s_mov_b32 s35, 0
  s_mov_b64 vcc, 0
  v_mfma_f32_16x16x32_bf16 v[148:151], a[4:7], v[116:119], 0
  v_add_u32 v0, s32, v10
  v_xor_b32 v1, 64, v0
  v_mfma_f32_16x16x32_bf16 v[148:151], a[16:19], v[120:123], v[148:151]
  v_mfma_f32_16x16x32_bf16 v[148:151], a[28:31], v[124:127], v[148:151]
  v_cvt_pk_bf16_f32 v76, v152, v153
  v_cvt_pk_bf16_f32 v77, v154, v155
  v_mfma_f32_16x16x32_bf16 v[148:151], a[40:43], v[128:131], v[148:151]
  v_mfma_f32_16x16x32_bf16 v[148:151], a[52:55], v[132:135], v[148:151]
  v_mfma_f32_16x16x32_bf16 v[148:151], a[64:67], v[136:139], v[148:151]
  v_mfma_f32_16x16x32_bf16 v[152:155], a[68:71], v[136:139], 0
  v_mfma_f32_16x16x32_bf16 v[152:155], a[56:59], v[132:135], v[152:155]
  v_mfma_f32_16x16x32_bf16 v[152:155], a[44:47], v[128:131], v[152:155]
  v_cvt_pk_bf16_f32 v78, v148, v149
  v_cvt_pk_bf16_f32 v79, v150, v151
  v_mfma_f32_16x16x32_bf16 v[152:155], a[32:35], v[124:127], v[152:155]
  v_mfma_f32_16x16x32_bf16 v[152:155], a[20:23], v[120:123], v[152:155]
  s_waitcnt lgkmcnt(0)
  s_waitcnt vmcnt(0)
  s_barrier
  v_mfma_f32_16x16x32_bf16 v[152:155], a[8:11], v[116:119], v[152:155]
  ds_read_b64_tr_b16 a[144:145], v180 offset:0
  ds_read_b64_tr_b16 a[146:147], v180 offset:6144
  v_mfma_f32_16x16x32_bf16 v[148:151], v[116:119], a[72:75], 0
  ds_read_b64_tr_b16 a[148:149], v180 offset:8
  v_mfma_f32_16x16x32_bf16 v[148:151], v[120:123], a[84:87], v[148:151]
  s_add_u32 m0, s33, 40960
  ds_read_b64_tr_b16 a[150:151], v180 offset:6152
  v_mfma_f32_16x16x32_bf16 v[148:151], v[124:127], a[96:99], v[148:151]
  v_cvt_pk_bf16_f32 v80, v152, v153
  v_cvt_pk_bf16_f32 v81, v154, v155
  v_mfma_f32_16x16x32_bf16 v[148:151], v[128:131], a[108:111], v[148:151]
  buffer_load_dwordx4 v6, s[8:11], s48 offen offset:0 nt lds
  v_mfma_f32_16x16x32_bf16 v[148:151], v[132:135], a[120:123], v[148:151]
  ds_read_b64_tr_b16 a[152:153], v181 offset:0
  v_mfma_f32_16x16x32_bf16 v[148:151], v[136:139], a[132:135], v[148:151]
  ds_read_b64_tr_b16 a[154:155], v181 offset:6144
  ds_read_b64_tr_b16 a[156:157], v181 offset:8
  v_mfma_f32_16x16x32_bf16 v[152:155], v[136:139], a[136:139], 0
  ds_read_b64_tr_b16 a[158:159], v181 offset:6152
  v_mfma_f32_16x16x32_bf16 v[152:155], v[132:135], a[124:127], v[152:155]
  ds_read_b64_tr_b16 a[160:161], v180 offset:12288
  v_mfma_f32_16x16x32_bf16 v[152:155], v[128:131], a[112:115], v[152:155]
  v_cvt_pk_bf16_f32 v20, v148, v149
  v_cvt_pk_bf16_f32 v21, v150, v151
  v_mfma_f32_16x16x32_bf16 v[152:155], v[124:127], a[100:103], v[152:155]
  ds_read_b64_tr_b16 a[162:163], v180 offset:18432
  ds_read_b64_tr_b16 a[164:165], v180 offset:12296
  v_mfma_f32_16x16x32_bf16 v[152:155], v[120:123], a[88:91], v[152:155]
  ds_read_b64_tr_b16 a[166:167], v180 offset:18440
  v_mfma_f32_16x16x32_bf16 v[152:155], v[116:119], a[76:79], v[152:155]
  ds_read_b64_tr_b16 a[168:169], v181 offset:12288
  v_mfma_f32_16x16x32_bf16 v[148:151], v[116:119], a[80:83], 0
  s_add_u32 m0, s33, 49024
  ds_read_b64_tr_b16 a[170:171], v181 offset:18432
  v_mfma_f32_16x16x32_bf16 v[148:151], v[120:123], a[92:95], v[148:151]
  buffer_load_dwordx4 v6, s[8:11], s48 offen offset:128 nt lds
  v_mfma_f32_16x16x32_bf16 v[148:151], v[124:127], a[104:107], v[148:151]
  v_cvt_pk_bf16_f32 v28, v152, v153
  v_cvt_pk_bf16_f32 v29, v154, v155
  v_mfma_f32_16x16x32_bf16 v[148:151], v[128:131], a[116:119], v[148:151]
  ds_read_b64_tr_b16 a[172:173], v181 offset:12296
  ds_read_b64_tr_b16 a[174:175], v181 offset:18440
  v_mfma_f32_16x16x32_bf16 v[148:151], v[132:135], a[128:131], v[148:151]
  ds_read_b64_tr_b16 a[176:177], v180 offset:24576
  v_mfma_f32_16x16x32_bf16 v[148:151], v[136:139], a[140:143], v[148:151]
  ds_read_b64_tr_b16 a[178:179], v180 offset:30720
  v_mfma_f32_16x16x32_bf16 v[172:175], v[184:187], v[140:143], 0
  ds_read_b64_tr_b16 a[180:181], v180 offset:24584
  v_mfma_f32_16x16x32_bf16 v[172:175], v[196:199], v[144:147], v[172:175]
  ds_read_b64_tr_b16 a[182:183], v180 offset:30728
  ds_read_b64_tr_b16 a[184:185], v181 offset:24576
  v_mfma_f32_16x16x32_bf16 v[172:175], v[208:211], v[156:159], v[172:175]
  v_cvt_pk_bf16_f32 v36, v148, v149
  v_cvt_pk_bf16_f32 v37, v150, v151
  v_mfma_f32_16x16x32_bf16 v[172:175], v[220:223], v[160:163], v[172:175]
  ds_read_b64_tr_b16 a[186:187], v181 offset:30720
  v_mfma_f32_16x16x32_bf16 v[172:175], v[232:235], v[164:167], v[172:175]
  ds_read_b64_tr_b16 a[188:189], v181 offset:24584
  v_mfma_f32_16x16x32_bf16 v[172:175], v[244:247], v[168:171], v[172:175]
  s_add_u32 m0, s33, 57088
  ds_read_b64_tr_b16 a[190:191], v181 offset:30728
  v_mfma_f32_16x16x32_bf16 v[176:179], v[248:251], v[168:171], 0
  buffer_load_dwordx4 v6, s[8:11], s48 offen offset:256 nt lds
  v_mfma_f32_16x16x32_bf16 v[176:179], v[236:239], v[164:167], v[176:179]
  ds_read_b64_tr_b16 a[192:193], v180 offset:36864
  v_mfma_f32_16x16x32_bf16 v[176:179], v[224:227], v[160:163], v[176:179]
  v_cvt_pk_bf16_f32 v70, v172, v173
  v_cvt_pk_bf16_f32 v71, v174, v175
  v_mfma_f32_16x16x32_bf16 v[176:179], v[212:215], v[156:159], v[176:179]
  ds_read_b64_tr_b16 a[194:195], v180 offset:43008
  v_mfma_f32_16x16x32_bf16 v[176:179], v[200:203], v[144:147], v[176:179]
  ds_read_b64_tr_b16 a[196:197], v180 offset:36872
  v_mfma_f32_16x16x32_bf16 v[176:179], v[188:191], v[140:143], v[176:179]
  ds_read_b64_tr_b16 a[198:199], v180 offset:43016
  v_mfma_f32_16x16x32_bf16 v[172:175], v[192:195], v[140:143], 0
  ds_read_b64_tr_b16 a[200:201], v181 offset:36864
  v_mfma_f32_16x16x32_bf16 v[172:175], v[204:207], v[144:147], v[172:175]
  ds_read_b64_tr_b16 a[202:203], v181 offset:43008
  v_mfma_f32_16x16x32_bf16 v[172:175], v[216:219], v[156:159], v[172:175]
  v_cvt_pk_bf16_f32 v72, v176, v177
  v_cvt_pk_bf16_f32 v73, v178, v179
  v_mfma_f32_16x16x32_bf16 v[172:175], v[228:231], v[160:163], v[172:175]
  ds_read_b64_tr_b16 a[204:205], v181 offset:36872
  v_mfma_f32_16x16x32_bf16 v[172:175], v[240:243], v[164:167], v[172:175]
  s_add_u32 m0, s33, 45056
  ds_read_b64_tr_b16 a[206:207], v181 offset:43016
  v_mfma_f32_16x16x32_bf16 v[172:175], v[252:255], v[168:171], v[172:175]
  buffer_load_dwordx4 v6, s[8:11], s49 offen offset:0 nt lds
  v_mfma_f32_16x16x32_bf16 v[176:179], a[60:63], v[168:171], 0
  ds_read_b64_tr_b16 a[208:209], v182 offset:0
  v_mfma_f32_16x16x32_bf16 v[176:179], a[48:51], v[164:167], v[176:179]
  ds_read_b64_tr_b16 a[210:211], v182 offset:1536
  v_mfma_f32_16x16x32_bf16 v[176:179], a[36:39], v[160:163], v[176:179]
  v_cvt_pk_bf16_f32 v74, v172, v173
  v_cvt_pk_bf16_f32 v75, v174, v175
  v_mfma_f32_16x16x32_bf16 v[176:179], a[24:27], v[156:159], v[176:179]
  ds_read_b64_tr_b16 a[212:213], v182 offset:8
  v_mfma_f32_16x16x32_bf16 v[176:179], a[12:15], v[144:147], v[176:179]
  ds_read_b64_tr_b16 a[214:215], v182 offset:1544
  v_mfma_f32_16x16x32_bf16 v[176:179], a[0:3], v[140:143], v[176:179]
  ds_read_b64_tr_b16 a[216:217], v183 offset:0
  v_mfma_f32_16x16x32_bf16 v[172:175], a[4:7], v[140:143], 0
  ds_read_b64_tr_b16 a[218:219], v183 offset:1536
  v_mfma_f32_16x16x32_bf16 v[172:175], a[16:19], v[144:147], v[172:175]
  ds_read_b64_tr_b16 a[220:221], v183 offset:8
  v_mfma_f32_16x16x32_bf16 v[172:175], a[28:31], v[156:159], v[172:175]
  v_cvt_pk_bf16_f32 v82, v176, v177
  v_cvt_pk_bf16_f32 v83, v178, v179
  v_mfma_f32_16x16x32_bf16 v[172:175], a[40:43], v[160:163], v[172:175]
  s_add_u32 m0, s33, 53120
  ds_read_b64_tr_b16 a[222:223], v183 offset:1544
  v_mfma_f32_16x16x32_bf16 v[172:175], a[52:55], v[164:167], v[172:175]
  buffer_load_dwordx4 v6, s[8:11], s49 offen offset:128 nt lds
  v_mfma_f32_16x16x32_bf16 v[172:175], a[64:67], v[168:171], v[172:175]
  ds_read_b64_tr_b16 a[224:225], v182 offset:12288
  v_mfma_f32_16x16x32_bf16 v[176:179], a[68:71], v[168:171], 0
  ds_read_b64_tr_b16 a[226:227], v182 offset:13824
  v_mfma_f32_16x16x32_bf16 v[176:179], a[56:59], v[164:167], v[176:179]
  ds_read_b64_tr_b16 a[228:229], v182 offset:12296
  v_mfma_f32_16x16x32_bf16 v[176:179], a[44:47], v[160:163], v[176:179]
  v_cvt_pk_bf16_f32 v84, v172, v173
  v_cvt_pk_bf16_f32 v85, v174, v175
  v_mfma_f32_16x16x32_bf16 v[176:179], a[32:35], v[156:159], v[176:179]
  ds_read_b64_tr_b16 a[230:231], v182 offset:13832
  v_mfma_f32_16x16x32_bf16 v[176:179], a[20:23], v[144:147], v[176:179]
  ds_read_b64_tr_b16 a[232:233], v183 offset:12288
  v_mfma_f32_16x16x32_bf16 v[176:179], a[8:11], v[140:143], v[176:179]
  ds_read_b64_tr_b16 a[234:235], v183 offset:13824
  v_mfma_f32_16x16x32_bf16 v[172:175], v[140:143], a[72:75], 0
  ds_read_b64_tr_b16 a[236:237], v183 offset:12296
  v_mfma_f32_16x16x32_bf16 v[172:175], v[144:147], a[84:87], v[172:175]
  s_add_u32 m0, s33, 61184
  ds_read_b64_tr_b16 a[238:239], v183 offset:13832
  v_mfma_f32_16x16x32_bf16 v[172:175], v[156:159], a[96:99], v[172:175]
  v_cvt_pk_bf16_f32 v86, v176, v177
  v_cvt_pk_bf16_f32 v87, v178, v179
  v_mfma_f32_16x16x32_bf16 v[172:175], v[160:163], a[108:111], v[172:175]
  buffer_load_dwordx4 v6, s[8:11], s49 offen offset:256 nt lds
  v_mfma_f32_16x16x32_bf16 v[172:175], v[164:167], a[120:123], v[172:175]
  s_add_u32 s48, s48, 6291456
  s_add_u32 s49, s48, 786432
  v_mfma_f32_16x16x32_bf16 v[172:175], v[168:171], a[132:135], v[172:175]
  v_mfma_f32_16x16x32_bf16 v[176:179], v[168:171], a[136:139], 0
  s_waitcnt lgkmcnt(0)
  s_waitcnt vmcnt(24)
  s_barrier
  v_mfma_f32_16x16x32_bf16 v[176:179], v[164:167], a[124:127], v[176:179]
  v_mfma_f32_16x16x32_bf16 v[176:179], v[160:163], a[112:115], v[176:179]
  v_cvt_pk_bf16_f32 v22, v172, v173
  v_cvt_pk_bf16_f32 v23, v174, v175
  v_mfma_f32_16x16x32_bf16 v[176:179], v[156:159], a[100:103], v[176:179]
  ds_read_b128 a[244:247], v3 offset:0
  v_mfma_f32_16x16x32_bf16 v[176:179], v[144:147], a[88:91], v[176:179]
  ds_read_b128 a[248:251], v3 offset:4096
  v_mfma_f32_16x16x32_bf16 v[176:179], v[140:143], a[76:79], v[176:179]
  ds_read_b128 a[252:255], v3 offset:8192
  v_mfma_f32_16x16x32_bf16 v[172:175], v[140:143], a[80:83], 0
  ds_read_b128 v[180:183], v3 offset:12288
  v_mfma_f32_16x16x32_bf16 v[172:175], v[144:147], a[92:95], v[172:175]
  v_mfma_f32_16x16x32_bf16 v[172:175], v[156:159], a[104:107], v[172:175]
  v_cvt_pk_bf16_f32 v30, v176, v177
  v_cvt_pk_bf16_f32 v31, v178, v179
  v_mfma_f32_16x16x32_bf16 v[172:175], v[160:163], a[116:119], v[172:175]
  v_mfma_f32_16x16x32_bf16 v[172:175], v[164:167], a[128:131], v[172:175]
  v_mfma_f32_16x16x32_bf16 v[172:175], v[168:171], a[140:143], v[172:175]
  s_branch L_s
.p2align 6
L_s:
  v_mfma_f32_16x16x32_bf16 v[116:119], v[46:49], v[70:73], v[112:115]
  v_mfma_f32_16x16x32_bf16 v[120:123], v[58:61], v[70:73], v[108:111]
  s_cmp_lg_u32 s31, 0
  v_mfma_f32_16x16x32_bf16 v[124:127], v[76:79], v[70:73], v[104:107]
  v_cvt_pk_bf16_f32 v38, v172, v173
  v_cvt_pk_bf16_f32 v39, v174, v175
  v_mfma_f32_16x16x32_bf16 v[128:131], v[82:85], v[70:73], v[100:103]
  v_mfma_f32_16x16x16_bf16 v[116:119], v[50:51], v[74:75], v[116:119]
  s_cbranch_scc1 L_special
  v_mfma_f32_16x16x16_bf16 v[120:123], v[62:63], v[74:75], v[120:123]
  v_mfma_f32_16x16x16_bf16 v[124:127], v[80:81], v[74:75], v[124:127]
  v_mfma_f32_16x16x16_bf16 v[128:131], v[86:87], v[74:75], v[128:131]
  v_exp_f32 v116, v116
  v_mfma_f32_16x16x32_bf16 v[132:135], v[46:49], v[64:67], v[108:111]
  v_exp_f32 v117, v117
  v_mfma_f32_16x16x32_bf16 v[136:139], v[58:61], v[64:67], v[104:107]
  v_exp_f32 v118, v118
  v_mfma_f32_16x16x32_bf16 v[140:143], v[76:79], v[64:67], v[100:103]
  v_exp_f32 v119, v119
  v_mfma_f32_16x16x32_bf16 v[144:147], v[82:85], v[64:67], v[96:99]
  v_exp_f32 v120, v120
  v_mfma_f32_16x16x16_bf16 v[132:135], v[50:51], v[68:69], v[132:135]
  v_exp_f32 v121, v121
  v_mfma_f32_16x16x16_bf16 v[136:139], v[62:63], v[68:69], v[136:139]
  v_exp_f32 v122, v122
  v_mfma_f32_16x16x16_bf16 v[140:143], v[80:81], v[68:69], v[140:143]
  v_exp_f32 v123, v123
  v_mfma_f32_16x16x16_bf16 v[144:147], v[86:87], v[68:69], v[144:147]
  ds_read_b128 v[64:67], v3 offset:16384
  ds_read_b128 v[68:71], v3 offset:20480
  v_mfma_f32_16x16x32_bf16 v[148:151], v[46:49], v[52:55], v[104:107]
  v_exp_f32 v124, v124
  v_mfma_f32_16x16x32_bf16 v[152:155], v[58:61], v[52:55], v[100:103]
  v_cvt_pk_bf16_f32 v116, v116, v117
  v_cvt_pk_bf16_f32 v117, v118, v119
  v_mfma_f32_16x16x32_bf16 v[156:159], v[76:79], v[52:55], v[96:99]
  v_cvt_pk_bf16_f32 v118, v120, v121
  v_cvt_pk_bf16_f32 v119, v122, v123
  v_mfma_f32_16x16x32_bf16 v[160:163], v[82:85], v[52:55], v[92:95]
  v_exp_f32 v125, v125
  v_mfma_f32_16x16x16_bf16 v[148:151], v[50:51], v[56:57], v[148:151]
  v_exp_f32 v126, v126
  v_mfma_f32_16x16x16_bf16 v[152:155], v[62:63], v[56:57], v[152:155]
  v_exp_f32 v127, v127
  v_mfma_f32_16x16x16_bf16 v[156:159], v[80:81], v[56:57], v[156:159]
  v_exp_f32 v128, v128
  v_mfma_f32_16x16x16_bf16 v[160:163], v[86:87], v[56:57], v[160:163]
  v_exp_f32 v129, v129
  v_mfma_f32_16x16x32_bf16 v[164:167], v[46:49], v[40:43], v[100:103]
  v_exp_f32 v130, v130
  v_mfma_f32_16x16x32_bf16 v[168:171], v[58:61], v[40:43], v[96:99]
  v_exp_f32 v131, v131
  v_mfma_f32_16x16x32_bf16 v[172:175], v[76:79], v[40:43], v[92:95]
  v_exp_f32 v132, v132
  v_mfma_f32_16x16x32_bf16 v[176:179], v[82:85], v[40:43], v[88:91]
  v_cvt_pk_bf16_f32 v124, v124, v125
  v_cvt_pk_bf16_f32 v125, v126, v127
  v_mfma_f32_16x16x16_bf16 v[164:167], v[50:51], v[44:45], v[164:167]
  v_cvt_pk_bf16_f32 v126, v128, v129
  v_cvt_pk_bf16_f32 v127, v130, v131
  v_mfma_f32_16x16x16_bf16 v[168:171], v[62:63], v[44:45], v[168:171]
  v_exp_f32 v133, v133
  v_mfma_f32_16x16x16_bf16 v[172:175], v[80:81], v[44:45], v[172:175]
  v_exp_f32 v134, v134
  v_mfma_f32_16x16x16_bf16 v[176:179], v[86:87], v[44:45], v[176:179]
  s_waitcnt lgkmcnt(0)
L_pj:
  v_mfma_f32_16x16x32_bf16 v[40:43], a[144:147], a[244:247], 0
  ds_read_b128 v[72:75], v3 offset:256
  ds_read_b128 v[56:59], v3 offset:4352
  v_mfma_f32_16x16x32_bf16 v[40:43], a[160:163], a[248:251], v[40:43]
  v_exp_f32 v135, v135
  v_mfma_f32_16x16x32_bf16 v[40:43], a[176:179], a[252:255], v[40:43]
  ds_read_b128 v[60:63], v3 offset:8448
  ds_read_b128 v[76:79], v3 offset:12544
  v_mfma_f32_16x16x32_bf16 v[40:43], a[192:195], v[180:183], v[40:43]
  v_exp_f32 v136, v136
  v_mfma_f32_16x16x32_bf16 v[40:43], a[208:211], v[64:67], v[40:43]
  ds_read_b128 v[80:83], v3 offset:16640
  ds_read_b128 v[84:87], v3 offset:20736
  v_mfma_f32_16x16x32_bf16 v[40:43], a[224:227], v[68:71], v[40:43]
  v_exp_f32 v137, v137
  v_mfma_f32_16x16x32_bf16 v[44:47], a[228:231], v[68:71], 0
  v_exp_f32 v138, v138
  v_mfma_f32_16x16x32_bf16 v[44:47], a[212:215], v[64:67], v[44:47]
  v_exp_f32 v139, v139
  v_mfma_f32_16x16x32_bf16 v[44:47], a[196:199], v[180:183], v[44:47]
  v_cvt_pk_bf16_f32 v40, v40, v41
  v_cvt_pk_bf16_f32 v41, v42, v43
  v_mfma_f32_16x16x32_bf16 v[44:47], a[180:183], a[252:255], v[44:47]
  ds_read_b128 v[120:123], v2 offset:512
  ds_read_b128 v[128:131], v2 offset:4608
  v_mfma_f32_16x16x32_bf16 v[44:47], a[164:167], a[248:251], v[44:47]
  v_exp_f32 v140, v140
  v_mfma_f32_16x16x32_bf16 v[44:47], a[148:151], a[244:247], v[44:47]
  s_waitcnt lgkmcnt(2)
  v_cvt_pk_bf16_f32 v132, v132, v133
  v_mfma_f32_16x16x32_bf16 v[48:51], a[144:147], v[72:75], 0
  ds_read_b128 a[244:247], v2 offset:8704
  ds_read_b128 a[248:251], v2 offset:12800
  v_mfma_f32_16x16x32_bf16 v[48:51], a[160:163], v[56:59], v[48:51]
  v_cvt_pk_bf16_f32 v133, v134, v135
  v_cvt_pk_bf16_f32 v134, v136, v137
  v_mfma_f32_16x16x32_bf16 v[48:51], a[176:179], v[60:63], v[48:51]
  v_cvt_pk_bf16_f32 v42, v44, v45
  v_cvt_pk_bf16_f32 v43, v46, v47
  v_mfma_f32_16x16x32_bf16 v[48:51], a[192:195], v[76:79], v[48:51]
  buffer_store_dwordx4 v[40:43], v7, s[24:27], s40 offen nt
  v_mfma_f32_16x16x32_bf16 v[48:51], a[208:211], v[80:83], v[48:51]
  ds_read_b128 a[252:255], v2 offset:16896
  ds_read_b128 v[180:183], v2 offset:20992
  v_mfma_f32_16x16x32_bf16 v[48:51], a[224:227], v[84:87], v[48:51]
  v_cvt_pk_bf16_f32 v135, v138, v139
  v_mfma_f32_16x16x32_bf16 v[52:55], a[228:231], v[84:87], 0
  v_exp_f32 v141, v141
  v_mfma_f32_16x16x32_bf16 v[52:55], a[212:215], v[80:83], v[52:55]
  v_exp_f32 v142, v142
  v_mfma_f32_16x16x32_bf16 v[52:55], a[196:199], v[76:79], v[52:55]
  v_cvt_pk_bf16_f32 v48, v48, v49
  v_cvt_pk_bf16_f32 v49, v50, v51
  v_mfma_f32_16x16x32_bf16 v[52:55], a[180:183], v[60:63], v[52:55]
  v_exp_f32 v143, v143
  v_mfma_f32_16x16x32_bf16 v[52:55], a[164:167], v[56:59], v[52:55]
  v_exp_f32 v144, v144
  v_mfma_f32_16x16x32_bf16 v[52:55], a[148:151], v[72:75], v[52:55]
  s_waitcnt lgkmcnt(0)
  v_mfma_f32_16x16x32_bf16 v[40:43], a[144:147], v[120:123], 0
  v_exp_f32 v145, v145
  v_mfma_f32_16x16x32_bf16 v[40:43], a[160:163], v[128:131], v[40:43]
  v_exp_f32 v146, v146
  v_mfma_f32_16x16x32_bf16 v[40:43], a[176:179], a[244:247], v[40:43]
  v_cvt_pk_bf16_f32 v50, v52, v53
  v_cvt_pk_bf16_f32 v51, v54, v55
  v_mfma_f32_16x16x32_bf16 v[40:43], a[192:195], a[248:251], v[40:43]
  buffer_store_dwordx4 v[48:51], v7, s[24:27], s41 offen nt
  v_mfma_f32_16x16x32_bf16 v[40:43], a[208:211], a[252:255], v[40:43]
  ds_read_b128 v[72:75], v2 offset:768
  ds_read_b128 v[56:59], v2 offset:4864
  v_mfma_f32_16x16x32_bf16 v[40:43], a[224:227], v[180:183], v[40:43]
  v_exp_f32 v147, v147
  v_mfma_f32_16x16x32_bf16 v[44:47], a[228:231], v[180:183], 0
  ds_read_b128 v[60:63], v2 offset:8960
  ds_read_b128 v[76:79], v2 offset:13056
  v_mfma_f32_16x16x32_bf16 v[44:47], a[212:215], a[252:255], v[44:47]
  v_exp_f32 v148, v148
  v_mfma_f32_16x16x32_bf16 v[44:47], a[196:199], a[248:251], v[44:47]
  v_cvt_pk_bf16_f32 v40, v40, v41
  v_cvt_pk_bf16_f32 v41, v42, v43
  v_mfma_f32_16x16x32_bf16 v[44:47], a[180:183], a[244:247], v[44:47]
  ds_read_b128 v[80:83], v2 offset:17152
  ds_read_b128 v[84:87], v2 offset:21248
  v_mfma_f32_16x16x32_bf16 v[44:47], a[164:167], v[128:131], v[44:47]
  v_cvt_pk_bf16_f32 v140, v140, v141
  v_cvt_pk_bf16_f32 v141, v142, v143
  v_mfma_f32_16x16x32_bf16 v[44:47], a[148:151], v[120:123], v[44:47]
  v_cvt_pk_bf16_f32 v142, v144, v145
  v_cvt_pk_bf16_f32 v143, v146, v147
  v_mfma_f32_16x16x32_bf16 v[48:51], a[152:155], v[120:123], 0
  v_exp_f32 v149, v149
  v_mfma_f32_16x16x32_bf16 v[48:51], a[168:171], v[128:131], v[48:51]
  v_exp_f32 v150, v150
  v_mfma_f32_16x16x32_bf16 v[48:51], a[184:187], a[244:247], v[48:51]
  v_cvt_pk_bf16_f32 v42, v44, v45
  v_cvt_pk_bf16_f32 v43, v46, v47
  v_mfma_f32_16x16x32_bf16 v[48:51], a[200:203], a[248:251], v[48:51]
  buffer_store_dwordx4 v[40:43], v7, s[24:27], s42 offen nt
  v_mfma_f32_16x16x32_bf16 v[48:51], a[216:219], a[252:255], v[48:51]
  v_exp_f32 v151, v151
  v_mfma_f32_16x16x32_bf16 v[48:51], a[232:235], v[180:183], v[48:51]
  v_exp_f32 v152, v152
  v_mfma_f32_16x16x32_bf16 v[52:55], a[236:239], v[180:183], 0
  v_exp_f32 v153, v153
  v_mfma_f32_16x16x32_bf16 v[52:55], a[220:223], a[252:255], v[52:55]
  v_exp_f32 v154, v154
  v_mfma_f32_16x16x32_bf16 v[52:55], a[204:207], a[248:251], v[52:55]
  v_cvt_pk_bf16_f32 v48, v48, v49
  v_cvt_pk_bf16_f32 v49, v50, v51
  v_mfma_f32_16x16x32_bf16 v[52:55], a[188:191], a[244:247], v[52:55]
  v_exp_f32 v155, v155
  v_mfma_f32_16x16x32_bf16 v[52:55], a[172:175], v[128:131], v[52:55]
  v_exp_f32 v156, v156
  v_mfma_f32_16x16x32_bf16 v[52:55], a[156:159], v[120:123], v[52:55]
  s_waitcnt lgkmcnt(0)
  v_cvt_pk_bf16_f32 v148, v148, v149
  v_mfma_f32_16x16x32_bf16 v[40:43], a[144:147], v[72:75], 0
  v_cvt_pk_bf16_f32 v149, v150, v151
  v_cvt_pk_bf16_f32 v150, v152, v153
  v_mfma_f32_16x16x32_bf16 v[40:43], a[160:163], v[56:59], v[40:43]
  v_cvt_pk_bf16_f32 v151, v154, v155
  v_mfma_f32_16x16x32_bf16 v[40:43], a[176:179], v[60:63], v[40:43]
  v_cvt_pk_bf16_f32 v50, v52, v53
  v_cvt_pk_bf16_f32 v51, v54, v55
  v_mfma_f32_16x16x32_bf16 v[40:43], a[192:195], v[76:79], v[40:43]
  buffer_store_dwordx4 v[48:51], v8, s[24:27], s42 offen nt
  v_mfma_f32_16x16x32_bf16 v[40:43], a[208:211], v[80:83], v[40:43]
  v_exp_f32 v157, v157
  v_mfma_f32_16x16x32_bf16 v[40:43], a[224:227], v[84:87], v[40:43]
  v_exp_f32 v158, v158
  v_mfma_f32_16x16x32_bf16 v[44:47], a[228:231], v[84:87], 0
  v_exp_f32 v159, v159
  v_mfma_f32_16x16x32_bf16 v[44:47], a[212:215], v[80:83], v[44:47]
  v_exp_f32 v160, v160
  v_mfma_f32_16x16x32_bf16 v[44:47], a[196:199], v[76:79], v[44:47]
  v_cvt_pk_bf16_f32 v40, v40, v41
  v_cvt_pk_bf16_f32 v41, v42, v43
  v_mfma_f32_16x16x32_bf16 v[44:47], a[180:183], v[60:63], v[44:47]
  v_exp_f32 v161, v161
  v_mfma_f32_16x16x32_bf16 v[44:47], a[164:167], v[56:59], v[44:47]
  v_exp_f32 v162, v162
  v_mfma_f32_16x16x32_bf16 v[44:47], a[148:151], v[72:75], v[44:47]
  v_exp_f32 v163, v163
  v_mfma_f32_16x16x32_bf16 v[48:51], a[152:155], v[72:75], 0
  v_exp_f32 v164, v164
  v_mfma_f32_16x16x32_bf16 v[48:51], a[168:171], v[56:59], v[48:51]
  v_cvt_pk_bf16_f32 v156, v156, v157
  v_cvt_pk_bf16_f32 v157, v158, v159
  v_mfma_f32_16x16x32_bf16 v[48:51], a[184:187], v[60:63], v[48:51]
  v_cvt_pk_bf16_f32 v42, v44, v45
  v_cvt_pk_bf16_f32 v43, v46, v47
  v_mfma_f32_16x16x32_bf16 v[48:51], a[200:203], v[76:79], v[48:51]
  buffer_store_dwordx4 v[40:43], v7, s[24:27], s43 offen nt
  v_mfma_f32_16x16x32_bf16 v[48:51], a[216:219], v[80:83], v[48:51]
  v_cvt_pk_bf16_f32 v158, v160, v161
  v_cvt_pk_bf16_f32 v159, v162, v163
  v_mfma_f32_16x16x32_bf16 v[48:51], a[232:235], v[84:87], v[48:51]
  v_exp_f32 v165, v165
  v_mfma_f32_16x16x32_bf16 v[52:55], a[236:239], v[84:87], 0
  v_exp_f32 v166, v166
  v_mfma_f32_16x16x32_bf16 v[52:55], a[220:223], v[80:83], v[52:55]
  v_exp_f32 v167, v167
  v_mfma_f32_16x16x32_bf16 v[52:55], a[204:207], v[76:79], v[52:55]
  v_cvt_pk_bf16_f32 v48, v48, v49
  v_cvt_pk_bf16_f32 v49, v50, v51
  v_mfma_f32_16x16x32_bf16 v[52:55], a[188:191], v[60:63], v[52:55]
  v_exp_f32 v168, v168
  v_mfma_f32_16x16x32_bf16 v[52:55], a[172:175], v[56:59], v[52:55]
  v_exp_f32 v169, v169
  v_mfma_f32_16x16x32_bf16 v[52:55], a[156:159], v[72:75], v[52:55]
  s_cbranch_scc1 L_fin
  v_mfma_f32_16x16x32_bf16 v[144:147], a[240:243], v[116:119], 0
  v_exp_f32 v170, v170
  v_mfma_f32_16x16x32_bf16 v[144:147], a[240:243], v[124:127], v[144:147]
  v_exp_f32 v171, v171
  v_mfma_f32_16x16x32_bf16 v[120:123], v[20:23], v[124:127], 0
  v_cvt_pk_bf16_f32 v50, v52, v53
  v_cvt_pk_bf16_f32 v51, v54, v55
  v_mfma_f32_16x16x32_bf16 v[120:123], v[16:19], v[116:119], v[120:123]
  buffer_store_dwordx4 v[48:51], v8, s[24:27], s43 offen nt
  v_mfma_f32_16x16x32_bf16 v[128:131], v[24:27], v[116:119], 0
  v_rcp_f32 v15, v144
  v_mfma_f32_16x16x32_bf16 v[128:131], v[28:31], v[124:127], v[128:131]
  v_exp_f32 v172, v172
  v_mfma_f32_16x16x32_bf16 v[136:139], v[36:39], v[124:127], 0
  v_cvt_pk_bf16_f32 v164, v164, v165
  v_cvt_pk_bf16_f32 v165, v166, v167
  v_mfma_f32_16x16x32_bf16 v[136:139], v[32:35], v[116:119], v[136:139]
  v_cvt_pk_bf16_f32 v166, v168, v169
  v_cvt_pk_bf16_f32 v167, v170, v171
  v_mfma_f32_16x16x32_bf16 v[144:147], a[240:243], v[132:135], 0
  v_exp_f32 v173, v173
  v_mfma_f32_16x16x32_bf16 v[144:147], a[240:243], v[140:143], v[144:147]
  v_exp_f32 v174, v174
  v_mfma_f32_16x16x32_bf16 v[116:119], v[20:23], v[140:143], 0
  v_exp_f32 v175, v175
  v_mfma_f32_16x16x32_bf16 v[116:119], v[16:19], v[132:135], v[116:119]
  v_exp_f32 v176, v176
  v_mfma_f32_16x16x32_bf16 v[124:127], v[24:27], v[132:135], 0
  v_rcp_f32 v14, v144
  v_mfma_f32_16x16x32_bf16 v[124:127], v[28:31], v[140:143], v[124:127]
  v_exp_f32 v177, v177
  v_mfma_f32_16x16x32_bf16 v[152:155], v[36:39], v[140:143], 0
  v_exp_f32 v178, v178
  v_mfma_f32_16x16x32_bf16 v[152:155], v[32:35], v[132:135], v[152:155]
  v_exp_f32 v179, v179
  v_mfma_f32_16x16x32_bf16 v[144:147], a[240:243], v[148:151], 0
  v_cvt_pk_bf16_f32 v172, v172, v173
  v_cvt_pk_bf16_f32 v173, v174, v175
  v_mfma_f32_16x16x32_bf16 v[144:147], a[240:243], v[156:159], v[144:147]
L_hop3:
  s_cbranch_execz L_hopped
  v_cvt_pk_bf16_f32 v174, v176, v177
  v_cvt_pk_bf16_f32 v175, v178, v179
  v_mfma_f32_16x16x32_bf16 v[132:135], v[20:23], v[156:159], 0
  v_mul_f32 v120, v15, v120
  v_mul_f32 v121, v15, v121
  v_mfma_f32_16x16x32_bf16 v[132:135], v[16:19], v[148:151], v[132:135]
  ds_read_b128 a[244:247], v0 offset:0
  ds_read_b128 a[248:251], v1 offset:0
  v_mfma_f32_16x16x32_bf16 v[140:143], v[24:27], v[148:151], 0
  v_rcp_f32 v13, v144
  v_mfma_f32_16x16x32_bf16 v[140:143], v[28:31], v[156:159], v[140:143]
  ds_read_b128 a[252:255], v0 offset:8192
  ds_read_b128 v[180:183], v1 offset:8192
  v_mfma_f32_16x16x32_bf16 v[160:163], v[36:39], v[156:159], 0
  v_mul_f32 v122, v15, v122
  v_mul_f32 v123, v15, v123
  v_mfma_f32_16x16x32_bf16 v[160:163], v[32:35], v[148:151], v[160:163]
  ds_read_b128 v[64:67], v0 offset:16384
  ds_read_b128 v[68:71], v1 offset:16384
  v_mfma_f32_16x16x32_bf16 v[144:147], a[240:243], v[164:167], 0
  v_cvt_pk_bf16_f32 v120, v120, v121
  v_cvt_pk_bf16_f32 v121, v122, v123
  v_mfma_f32_16x16x32_bf16 v[144:147], a[240:243], v[172:175], v[144:147]
  v_mul_f32 v128, v15, v128
  v_mul_f32 v129, v15, v129
  v_mfma_f32_16x16x32_bf16 v[148:151], v[20:23], v[172:175], 0
  v_mul_f32 v130, v15, v130
  v_mul_f32 v131, v15, v131
  v_mfma_f32_16x16x32_bf16 v[148:151], v[16:19], v[164:167], v[148:151]
  v_cvt_pk_bf16_f32 v122, v128, v129
  v_cvt_pk_bf16_f32 v123, v130, v131
  v_mfma_f32_16x16x32_bf16 v[156:159], v[24:27], v[164:167], 0
  v_rcp_f32 v12, v144
  v_mfma_f32_16x16x32_bf16 v[156:159], v[28:31], v[172:175], v[156:159]
  ds_write_b128 v4, v[120:123] offset:768
  v_mfma_f32_16x16x32_bf16 v[168:171], v[36:39], v[172:175], 0
  v_mul_f32 v136, v15, v136
  v_mul_f32 v137, v15, v137
  v_mfma_f32_16x16x32_bf16 v[168:171], v[32:35], v[164:167], v[168:171]
  s_waitcnt lgkmcnt(5)
  s_cbranch_vccnz L_epi
  v_mfma_f32_16x16x32_bf16 v[76:79], v[184:187], a[244:247], 0
  v_mul_f32 v138, v15, v138
  v_mul_f32 v139, v15, v139
  v_mfma_f32_16x16x32_bf16 v[76:79], v[196:199], a[248:251], v[76:79]
  s_waitcnt lgkmcnt(3)
  v_cvt_pk_bf16_f32 v136, v136, v137
  v_mfma_f32_16x16x32_bf16 v[76:79], v[208:211], a[252:255], v[76:79]
  v_cvt_pk_bf16_f32 v137, v138, v139
  v_mfma_f32_16x16x32_bf16 v[76:79], v[220:223], v[180:183], v[76:79]
  s_waitcnt lgkmcnt(1)
  s_add_u32 m0, s33, 0
  v_mfma_f32_16x16x32_bf16 v[76:79], v[232:235], v[64:67], v[76:79]
  buffer_load_dwordx4 v6, s[8:11], s48 offen offset:0 nt lds
  v_mfma_f32_16x16x32_bf16 v[76:79], v[244:247], v[68:71], v[76:79]
  ds_write_b64 v5, v[136:137] offset:768
  v_mfma_f32_16x16x32_bf16 v[80:83], v[248:251], v[68:71], 0
  v_mul_f32 v116, v14, v116
  v_mul_f32 v117, v14, v117
  v_mfma_f32_16x16x32_bf16 v[80:83], v[236:239], v[64:67], v[80:83]
  v_mul_f32 v118, v14, v118
  v_mul_f32 v119, v14, v119
  v_mfma_f32_16x16x32_bf16 v[80:83], v[224:227], v[180:183], v[80:83]
  v_cvt_pk_bf16_f32 v40, v76, v77
  v_cvt_pk_bf16_f32 v41, v78, v79
  v_mfma_f32_16x16x32_bf16 v[80:83], v[212:215], a[252:255], v[80:83]
  v_cvt_pk_bf16_f32 v116, v116, v117
  v_cvt_pk_bf16_f32 v117, v118, v119
  v_mfma_f32_16x16x32_bf16 v[80:83], v[200:203], a[248:251], v[80:83]
  v_mul_f32 v124, v14, v124
  v_mul_f32 v125, v14, v125
  v_mfma_f32_16x16x32_bf16 v[80:83], v[188:191], a[244:247], v[80:83]
  v_mul_f32 v126, v14, v126
  v_mul_f32 v127, v14, v127
  v_mfma_f32_16x16x32_bf16 v[76:79], v[192:195], a[244:247], 0
  v_cvt_pk_bf16_f32 v118, v124, v125
  v_cvt_pk_bf16_f32 v119, v126, v127
  v_mfma_f32_16x16x32_bf16 v[76:79], v[204:207], a[248:251], v[76:79]
  ds_write_b128 v4, v[116:119] offset:512
  v_mfma_f32_16x16x32_bf16 v[76:79], v[216:219], a[252:255], v[76:79]
  v_cvt_pk_bf16_f32 v42, v80, v81
  v_cvt_pk_bf16_f32 v43, v82, v83
  v_mfma_f32_16x16x32_bf16 v[76:79], v[228:231], v[180:183], v[76:79]
  v_mul_f32 v152, v14, v152
  v_mul_f32 v153, v14, v153
  v_mfma_f32_16x16x32_bf16 v[76:79], v[240:243], v[64:67], v[76:79]
  v_mul_f32 v154, v14, v154
  v_mul_f32 v155, v14, v155
  v_mfma_f32_16x16x32_bf16 v[76:79], v[252:255], v[68:71], v[76:79]
  v_cvt_pk_bf16_f32 v152, v152, v153
  v_cvt_pk_bf16_f32 v153, v154, v155
  v_mfma_f32_16x16x32_bf16 v[80:83], a[60:63], v[68:71], 0
  ds_write_b64 v5, v[152:153] offset:512
  v_mfma_f32_16x16x32_bf16 v[80:83], a[48:51], v[64:67], v[80:83]
  s_add_u32 m0, s33, 8064
  v_mul_f32 v132, v13, v132
  v_mfma_f32_16x16x32_bf16 v[80:83], a[36:39], v[180:183], v[80:83]
  v_cvt_pk_bf16_f32 v44, v76, v77
  v_cvt_pk_bf16_f32 v45, v78, v79
  v_mfma_f32_16x16x32_bf16 v[80:83], a[24:27], a[252:255], v[80:83]
  buffer_load_dwordx4 v6, s[8:11], s48 offen offset:128 nt lds
  v_mfma_f32_16x16x32_bf16 v[80:83], a[12:15], a[248:251], v[80:83]
  v_mul_f32 v133, v13, v133
  v_mul_f32 v134, v13, v134
  v_mfma_f32_16x16x32_bf16 v[80:83], a[0:3], a[244:247], v[80:83]
  v_mul_f32 v135, v13, v135
  v_cvt_pk_bf16_f32 v132, v132, v133
  v_mfma_f32_16x16x32_bf16 v[76:79], a[4:7], a[244:247], 0
  v_cvt_pk_bf16_f32 v133, v134, v135
  v_mul_f32 v140, v13, v140
  v_mfma_f32_16x16x32_bf16 v[76:79], a[16:19], a[248:251], v[76:79]
  v_mul_f32 v141, v13, v141
  v_mul_f32 v142, v13, v142
  v_mfma_f32_16x16x32_bf16 v[76:79], a[28:31], a[252:255], v[76:79]
  v_cvt_pk_bf16_f32 v46, v80, v81
  v_cvt_pk_bf16_f32 v47, v82, v83
  v_mfma_f32_16x16x32_bf16 v[76:79], a[40:43], v[180:183], v[76:79]
  v_mul_f32 v143, v13, v143
  v_cvt_pk_bf16_f32 v134, v140, v141
  v_mfma_f32_16x16x32_bf16 v[76:79], a[52:55], v[64:67], v[76:79]
  v_cvt_pk_bf16_f32 v135, v142, v143
  v_mfma_f32_16x16x32_bf16 v[76:79], a[64:67], v[68:71], v[76:79]
  ds_write_b128 v4, v[132:135] offset:256
  v_mfma_f32_16x16x32_bf16 v[80:83], a[68:71], v[68:71], 0
  v_mul_f32 v160, v13, v160
  v_mul_f32 v161, v13, v161
  v_mfma_f32_16x16x32_bf16 v[80:83], a[56:59], v[64:67], v[80:83]
  v_mul_f32 v162, v13, v162
  v_mul_f32 v163, v13, v163
  v_mfma_f32_16x16x32_bf16 v[80:83], a[44:47], v[180:183], v[80:83]
  v_cvt_pk_bf16_f32 v48, v76, v77
  v_cvt_pk_bf16_f32 v49, v78, v79
  v_mfma_f32_16x16x32_bf16 v[80:83], a[32:35], a[252:255], v[80:83]
  v_cvt_pk_bf16_f32 v160, v160, v161
  v_cvt_pk_bf16_f32 v161, v162, v163
  v_mfma_f32_16x16x32_bf16 v[80:83], a[20:23], a[248:251], v[80:83]
  ds_write_b64 v5, v[160:161] offset:256
  v_mfma_f32_16x16x32_bf16 v[80:83], a[8:11], a[244:247], v[80:83]
  s_add_u32 m0, s33, 16128
  v_mul_f32 v148, v12, v148
  v_mfma_f32_16x16x32_bf16 v[76:79], a[244:247], a[72:75], 0
  buffer_load_dwordx4 v6, s[8:11], s48 offen offset:256 nt lds
  v_mfma_f32_16x16x32_bf16 v[76:79], a[248:251], a[84:87], v[76:79]
  v_mul_f32 v149, v12, v149
  v_mul_f32 v150, v12, v150
  v_mfma_f32_16x16x32_bf16 v[76:79], a[252:255], a[96:99], v[76:79]
  v_cvt_pk_bf16_f32 v50, v80, v81
  v_cvt_pk_bf16_f32 v51, v82, v83
  v_mfma_f32_16x16x32_bf16 v[76:79], v[180:183], a[108:111], v[76:79]
  ds_read_b128 v[72:75], v0 offset:2048
  v_mul_f32 v151, v12, v151
  v_mfma_f32_16x16x32_bf16 v[76:79], v[64:67], a[120:123], v[76:79]
  ds_read_b128 v[84:87], v1 offset:2048
  v_cvt_pk_bf16_f32 v148, v148, v149
  v_mfma_f32_16x16x32_bf16 v[76:79], v[68:71], a[132:135], v[76:79]
  ds_read_b128 v[164:167], v0 offset:10240
  v_cvt_pk_bf16_f32 v149, v150, v151
  v_mfma_f32_16x16x32_bf16 v[80:83], v[68:71], a[136:139], 0
  ds_read_b128 v[172:175], v1 offset:10240
  v_mul_f32 v156, v12, v156
  v_mfma_f32_16x16x32_bf16 v[80:83], v[64:67], a[124:127], v[80:83]
  ds_read_b128 v[176:179], v0 offset:18432
  v_mul_f32 v157, v12, v157
  v_mfma_f32_16x16x32_bf16 v[80:83], v[180:183], a[112:115], v[80:83]
  v_cvt_pk_bf16_f32 v16, v76, v77
  v_cvt_pk_bf16_f32 v17, v78, v79
  v_mfma_f32_16x16x32_bf16 v[80:83], a[252:255], a[100:103], v[80:83]
  ds_read_b128 v[144:147], v1 offset:18432
  v_mul_f32 v158, v12, v158
  v_mfma_f32_16x16x32_bf16 v[80:83], a[248:251], a[88:91], v[80:83]
  v_mul_f32 v159, v12, v159
  v_cvt_pk_bf16_f32 v150, v156, v157
  v_mfma_f32_16x16x32_bf16 v[80:83], a[244:247], a[76:79], v[80:83]
  v_cvt_pk_bf16_f32 v151, v158, v159
  v_mfma_f32_16x16x32_bf16 v[76:79], a[244:247], a[80:83], 0
  ds_write_b128 v4, v[148:151] offset:0
  v_mfma_f32_16x16x32_bf16 v[76:79], a[248:251], a[92:95], v[76:79]
  v_mul_f32 v168, v12, v168
  v_mul_f32 v169, v12, v169
  v_mfma_f32_16x16x32_bf16 v[76:79], a[252:255], a[104:107], v[76:79]
  v_cvt_pk_bf16_f32 v24, v80, v81
  v_cvt_pk_bf16_f32 v25, v82, v83
  v_mfma_f32_16x16x32_bf16 v[76:79], v[180:183], a[116:119], v[76:79]
  s_add_u32 m0, s33, 4096
  v_mul_f32 v170, v12, v170
  v_mfma_f32_16x16x32_bf16 v[76:79], v[64:67], a[128:131], v[76:79]
  buffer_load_dwordx4 v6, s[8:11], s49 offen offset:0 nt lds
  v_mfma_f32_16x16x32_bf16 v[76:79], v[68:71], a[140:143], v[76:79]
  s_waitcnt lgkmcnt(1)
  v_mul_f32 v171, v12, v171
  v_mfma_f32_16x16x32_bf16 v[80:83], v[184:187], v[72:75], 0
  v_cvt_pk_bf16_f32 v168, v168, v169
  v_cvt_pk_bf16_f32 v169, v170, v171
  v_mfma_f32_16x16x32_bf16 v[80:83], v[196:199], v[84:87], v[80:83]
  ds_write_b64 v5, v[168:169] offset:0
  v_mfma_f32_16x16x32_bf16 v[80:83], v[208:211], v[164:167], v[80:83]
  v_cvt_pk_bf16_f32 v32, v76, v77
  v_cvt_pk_bf16_f32 v33, v78, v79
  v_mfma_f32_16x16x32_bf16 v[80:83], v[220:223], v[172:175], v[80:83]
  v_subrev_u32 v3, s7, v3
  v_subrev_u32 v2, s7, v2
  v_mfma_f32_16x16x32_bf16 v[80:83], v[232:235], v[176:179], v[80:83]
  v_add_u32 v4, s7, v4
  v_add_u32 v5, s7, v5
  v_mfma_f32_16x16x32_bf16 v[80:83], v[244:247], v[144:147], v[80:83]
  s_sub_u32 s7, 0, s7
  v_max3_f32 v9, v12, v13, v9
  v_mfma_f32_16x16x32_bf16 v[76:79], v[248:251], v[144:147], 0
  v_max3_f32 v9, v14, v15, v9
  v_min3_f32 v11, v12, v13, v11
  v_mfma_f32_16x16x32_bf16 v[76:79], v[236:239], v[176:179], v[76:79]
  v_min3_f32 v11, v14, v15, v11
  v_mfma_f32_16x16x32_bf16 v[76:79], v[224:227], v[172:175], v[76:79]
  v_cvt_pk_bf16_f32 v52, v80, v81
  v_cvt_pk_bf16_f32 v53, v82, v83
  v_mfma_f32_16x16x32_bf16 v[76:79], v[212:215], v[164:167], v[76:79]
  v_mfma_f32_16x16x32_bf16 v[76:79], v[200:203], v[84:87], v[76:79]
  v_mfma_f32_16x16x32_bf16 v[76:79], v[188:191], v[72:75], v[76:79]
  v_mfma_f32_16x16x32_bf16 v[80:83], v[192:195], v[72:75], 0
  v_mfma_f32_16x16x32_bf16 v[80:83], v[204:207], v[84:87], v[80:83]
  s_add_u32 m0, s33, 12160
  v_mfma_f32_16x16x32_bf16 v[80:83], v[216:219], v[164:167], v[80:83]
  v_cvt_pk_bf16_f32 v54, v76, v77
  v_cvt_pk_bf16_f32 v55, v78, v79
  v_mfma_f32_16x16x32_bf16 v[80:83], v[228:231], v[172:175], v[80:83]
  buffer_load_dwordx4 v6, s[8:11], s49 offen offset:128 nt lds
  v_mfma_f32_16x16x32_bf16 v[80:83], v[240:243], v[176:179], v[80:83]
  v_mfma_f32_16x16x32_bf16 v[80:83], v[252:255], v[144:147], v[80:83]
  v_mfma_f32_16x16x32_bf16 v[76:79], a[60:63], v[144:147], 0
  v_mfma_f32_16x16x32_bf16 v[76:79], a[48:51], v[176:179], v[76:79]
  v_mfma_f32_16x16x32_bf16 v[76:79], a[36:39], v[172:175], v[76:79]
  v_cvt_pk_bf16_f32 v56, v80, v81
  v_cvt_pk_bf16_f32 v57, v82, v83
  v_mfma_f32_16x16x32_bf16 v[76:79], a[24:27], v[164:167], v[76:79]
  v_mfma_f32_16x16x32_bf16 v[76:79], a[12:15], v[84:87], v[76:79]
  v_mfma_f32_16x16x32_bf16 v[76:79], a[0:3], v[72:75], v[76:79]
  v_mfma_f32_16x16x32_bf16 v[80:83], a[4:7], v[72:75], 0
  v_mfma_f32_16x16x32_bf16 v[80:83], a[16:19], v[84:87], v[80:83]
  v_mfma_f32_16x16x32_bf16 v[80:83], a[28:31], v[164:167], v[80:83]
  v_cvt_pk_bf16_f32 v58, v76, v77
  v_cvt_pk_bf16_f32 v59, v78, v79
  v_mfma_f32_16x16x32_bf16 v[80:83], a[40:43], v[172:175], v[80:83]
  v_mfma_f32_16x16x32_bf16 v[80:83], a[52:55], v[176:179], v[80:83]
  v_mfma_f32_16x16x32_bf16 v[80:83], a[64:67], v[144:147], v[80:83]
  s_add_u32 m0, s33, 20224
  v_mfma_f32_16x16x32_bf16 v[76:79], a[68:71], v[144:147], 0
  buffer_load_dwordx4 v6, s[8:11], s49 offen offset:256 nt lds
  v_mfma_f32_16x16x32_bf16 v[76:79], a[56:59], v[176:179], v[76:79]
  v_mfma_f32_16x16x32_bf16 v[76:79], a[44:47], v[172:175], v[76:79]
  v_cvt_pk_bf16_f32 v60, v80, v81
  v_cvt_pk_bf16_f32 v61, v82, v83
  v_mfma_f32_16x16x32_bf16 v[76:79], a[32:35], v[164:167], v[76:79]
  v_mfma_f32_16x16x32_bf16 v[76:79], a[20:23], v[84:87], v[76:79]
  v_mfma_f32_16x16x32_bf16 v[76:79], a[8:11], v[72:75], v[76:79]
  v_mfma_f32_16x16x32_bf16 v[80:83], v[72:75], a[72:75], 0
  v_mfma_f32_16x16x32_bf16 v[80:83], v[84:87], a[84:87], v[80:83]
  v_mfma_f32_16x16x32_bf16 v[80:83], v[164:167], a[96:99], v[80:83]
  v_cvt_pk_bf16_f32 v62, v76, v77
  v_cvt_pk_bf16_f32 v63, v78, v79
  v_mfma_f32_16x16x32_bf16 v[80:83], v[172:175], a[108:111], v[80:83]
  ds_read_b128 v[116:119], v0 offset:4096
  v_mfma_f32_16x16x32_bf16 v[80:83], v[176:179], a[120:123], v[80:83]
  ds_read_b128 v[120:123], v1 offset:4096
  v_mfma_f32_16x16x32_bf16 v[80:83], v[144:147], a[132:135], v[80:83]
  ds_read_b128 v[124:127], v0 offset:12288
  v_mfma_f32_16x16x32_bf16 v[76:79], v[144:147], a[136:139], 0
  ds_read_b128 v[128:131], v1 offset:12288
  v_mfma_f32_16x16x32_bf16 v[76:79], v[176:179], a[124:127], v[76:79]
  ds_read_b128 v[132:135], v0 offset:20480
  v_mfma_f32_16x16x32_bf16 v[76:79], v[172:175], a[112:115], v[76:79]
  v_cvt_pk_bf16_f32 v18, v80, v81
  v_cvt_pk_bf16_f32 v19, v82, v83
  v_mfma_f32_16x16x32_bf16 v[76:79], v[164:167], a[100:103], v[76:79]
  ds_read_b128 v[136:139], v1 offset:20480
  v_mfma_f32_16x16x32_bf16 v[76:79], v[84:87], a[88:91], v[76:79]
  v_mfma_f32_16x16x32_bf16 v[76:79], v[72:75], a[76:79], v[76:79]
  v_mfma_f32_16x16x32_bf16 v[80:83], v[72:75], a[80:83], 0
  v_mfma_f32_16x16x32_bf16 v[80:83], v[84:87], a[92:95], v[80:83]
  v_mfma_f32_16x16x32_bf16 v[80:83], v[164:167], a[104:107], v[80:83]
  v_cvt_pk_bf16_f32 v26, v76, v77
  v_cvt_pk_bf16_f32 v27, v78, v79
  v_mfma_f32_16x16x32_bf16 v[80:83], v[172:175], a[116:119], v[80:83]
  v_mfma_f32_16x16x32_bf16 v[80:83], v[176:179], a[128:131], v[80:83]
  v_mfma_f32_16x16x32_bf16 v[80:83], v[144:147], a[140:143], v[80:83]
  s_waitcnt lgkmcnt(0)
  v_mfma_f32_16x16x32_bf16 v[148:151], v[184:187], v[116:119], 0
  s_add_u32 s40, s48, s52
  s_add_u32 s41, s48, s53
  v_mfma_f32_16x16x32_bf16 v[148:151], v[196:199], v[120:123], v[148:151]
  s_add_u32 s42, s48, s54
  s_add_u32 s43, s48, s55
  v_mfma_f32_16x16x32_bf16 v[148:151], v[208:211], v[124:127], v[148:151]
  v_cvt_pk_bf16_f32 v34, v80, v81
  v_cvt_pk_bf16_f32 v35, v82, v83
  v_mfma_f32_16x16x32_bf16 v[148:151], v[220:223], v[128:131], v[148:151]
  s_cmp_eq_u32 s48, s50
  s_cselect_b64 vcc, -1, 0
  v_mfma_f32_16x16x32_bf16 v[148:151], v[232:235], v[132:135], v[148:151]
  s_add_u32 s48, s48, 6291456
  s_add_u32 s49, s48, 786432
  v_mfma_f32_16x16x32_bf16 v[148:151], v[244:247], v[136:139], v[148:151]
  s_add_u32 s36, s32, s33
  s_mov_b32 s33, s32
  v_mfma_f32_16x16x32_bf16 v[152:155], v[248:251], v[136:139], 0
  s_sub_u32 s32, s34, s36
  v_mfma_f32_16x16x32_bf16 v[152:155], v[236:239], v[132:135], v[152:155]
  v_mfma_f32_16x16x32_bf16 v[152:155], v[224:227], v[128:131], v[152:155]
  v_cvt_pk_bf16_f32 v64, v148, v149
  v_cvt_pk_bf16_f32 v65, v150, v151
  v_mfma_f32_16x16x32_bf16 v[152:155], v[212:215], v[124:127], v[152:155]
  v_mfma_f32_16x16x32_bf16 v[152:155], v[200:203], v[120:123], v[152:155]
  v_mfma_f32_16x16x32_bf16 v[152:155], v[188:191], v[116:119], v[152:155]
  v_mfma_f32_16x16x32_bf16 v[148:151], v[192:195], v[116:119], 0
  v_mfma_f32_16x16x32_bf16 v[148:151], v[204:207], v[120:123], v[148:151]
  v_mfma_f32_16x16x32_bf16 v[148:151], v[216:219], v[124:127], v[148:151]
  v_cvt_pk_bf16_f32 v66, v152, v153
  v_cvt_pk_bf16_f32 v67, v154, v155
  v_mfma_f32_16x16x32_bf16 v[148:151], v[228:231], v[128:131], v[148:151]
  v_mfma_f32_16x16x32_bf16 v[148:151], v[240:243], v[132:135], v[148:151]
  v_mfma_f32_16x16x32_bf16 v[148:151], v[252:255], v[136:139], v[148:151]
  v_mfma_f32_16x16x32_bf16 v[152:155], a[60:63], v[136:139], 0
  v_mfma_f32_16x16x32_bf16 v[152:155], a[48:51], v[132:135], v[152:155]
  v_mfma_f32_16x16x32_bf16 v[152:155], a[36:39], v[128:131], v[152:155]
  v_cvt_pk_bf16_f32 v68, v148, v149
  v_cvt_pk_bf16_f32 v69, v150, v151
  v_mfma_f32_16x16x32_bf16 v[152:155], a[24:27], v[124:127], v[152:155]
  v_mfma_f32_16x16x32_bf16 v[152:155], a[12:15], v[120:123], v[152:155]
  v_mfma_f32_16x16x32_bf16 v[152:155], a[0:3], v[116:119], v[152:155]
  v_mfma_f32_16x16x32_bf16 v[148:151], a[4:7], v[116:119], 0
  v_mfma_f32_16x16x32_bf16 v[148:151], a[16:19], v[120:123], v[148:151]
  v_mfma_f32_16x16x32_bf16 v[148:151], a[28:31], v[124:127], v[148:151]
  v_cvt_pk_bf16_f32 v76, v152, v153
  v_cvt_pk_bf16_f32 v77, v154, v155
  v_mfma_f32_16x16x32_bf16 v[148:151], a[40:43], v[128:131], v[148:151]
  v_mfma_f32_16x16x32_bf16 v[148:151], a[52:55], v[132:135], v[148:151]
  v_mfma_f32_16x16x32_bf16 v[148:151], a[64:67], v[136:139], v[148:151]
  v_mfma_f32_16x16x32_bf16 v[152:155], a[68:71], v[136:139], 0
  v_mfma_f32_16x16x32_bf16 v[152:155], a[56:59], v[132:135], v[152:155]
  v_mfma_f32_16x16x32_bf16 v[152:155], a[44:47], v[128:131], v[152:155]
  v_cvt_pk_bf16_f32 v78, v148, v149
  v_cvt_pk_bf16_f32 v79, v150, v151
  v_mfma_f32_16x16x32_bf16 v[152:155], a[32:35], v[124:127], v[152:155]
  v_mfma_f32_16x16x32_bf16 v[152:155], a[20:23], v[120:123], v[152:155]
  v_mfma_f32_16x16x32_bf16 v[152:155], a[8:11], v[116:119], v[152:155]
  v_mfma_f32_16x16x32_bf16 v[148:151], v[116:119], a[72:75], 0
  v_mfma_f32_16x16x32_bf16 v[148:151], v[120:123], a[84:87], v[148:151]
  v_mfma_f32_16x16x32_bf16 v[148:151], v[124:127], a[96:99], v[148:151]
  v_cvt_pk_bf16_f32 v80, v152, v153
  v_cvt_pk_bf16_f32 v81, v154, v155
  v_mfma_f32_16x16x32_bf16 v[148:151], v[128:131], a[108:111], v[148:151]
  ds_read_b128 v[140:143], v0 offset:6144
  v_mfma_f32_16x16x32_bf16 v[148:151], v[132:135], a[120:123], v[148:151]
  ds_read_b128 v[144:147], v1 offset:6144
  v_mfma_f32_16x16x32_bf16 v[148:151], v[136:139], a[132:135], v[148:151]
  ds_read_b128 v[156:159], v0 offset:14336
  v_mfma_f32_16x16x32_bf16 v[152:155], v[136:139], a[136:139], 0
  ds_read_b128 v[160:163], v1 offset:14336
  v_mfma_f32_16x16x32_bf16 v[152:155], v[132:135], a[124:127], v[152:155]
  ds_read_b128 v[164:167], v0 offset:22528
  v_mfma_f32_16x16x32_bf16 v[152:155], v[128:131], a[112:115], v[152:155]
  v_cvt_pk_bf16_f32 v20, v148, v149
  v_cvt_pk_bf16_f32 v21, v150, v151
  v_mfma_f32_16x16x32_bf16 v[152:155], v[124:127], a[100:103], v[152:155]
  ds_read_b128 v[168:171], v1 offset:22528
  v_mfma_f32_16x16x32_bf16 v[152:155], v[120:123], a[88:91], v[152:155]
  v_mfma_f32_16x16x32_bf16 v[152:155], v[116:119], a[76:79], v[152:155]
  v_mfma_f32_16x16x32_bf16 v[148:151], v[116:119], a[80:83], 0
  v_mfma_f32_16x16x32_bf16 v[148:151], v[120:123], a[92:95], v[148:151]
  v_mfma_f32_16x16x32_bf16 v[148:151], v[124:127], a[104:107], v[148:151]
  v_cvt_pk_bf16_f32 v28, v152, v153
  v_cvt_pk_bf16_f32 v29, v154, v155
  v_mfma_f32_16x16x32_bf16 v[148:151], v[128:131], a[116:119], v[148:151]
  v_mfma_f32_16x16x32_bf16 v[148:151], v[132:135], a[128:131], v[148:151]
  v_mfma_f32_16x16x32_bf16 v[148:151], v[136:139], a[140:143], v[148:151]
  s_waitcnt lgkmcnt(0)
  v_mfma_f32_16x16x32_bf16 v[172:175], v[184:187], v[140:143], 0
  v_mfma_f32_16x16x32_bf16 v[172:175], v[196:199], v[144:147], v[172:175]
  v_mfma_f32_16x16x32_bf16 v[172:175], v[208:211], v[156:159], v[172:175]
  v_cvt_pk_bf16_f32 v36, v148, v149
  v_cvt_pk_bf16_f32 v37, v150, v151
  v_mfma_f32_16x16x32_bf16 v[172:175], v[220:223], v[160:163], v[172:175]
  v_mfma_f32_16x16x32_bf16 v[172:175], v[232:235], v[164:167], v[172:175]
  v_mfma_f32_16x16x32_bf16 v[172:175], v[244:247], v[168:171], v[172:175]
  v_mfma_f32_16x16x32_bf16 v[176:179], v[248:251], v[168:171], 0
  s_waitcnt vmcnt(12)
  s_barrier
  v_mfma_f32_16x16x32_bf16 v[176:179], v[236:239], v[164:167], v[176:179]
  v_add_u32 v0, s32, v10
  v_xor_b32 v1, 64, v0
  v_mfma_f32_16x16x32_bf16 v[176:179], v[224:227], v[160:163], v[176:179]
  v_cvt_pk_bf16_f32 v70, v172, v173
  v_cvt_pk_bf16_f32 v71, v174, v175
  v_mfma_f32_16x16x32_bf16 v[176:179], v[212:215], v[156:159], v[176:179]
  v_mfma_f32_16x16x32_bf16 v[176:179], v[200:203], v[144:147], v[176:179]
  v_mfma_f32_16x16x32_bf16 v[176:179], v[188:191], v[140:143], v[176:179]
  v_mfma_f32_16x16x32_bf16 v[172:175], v[192:195], v[140:143], 0
  v_mfma_f32_16x16x32_bf16 v[172:175], v[204:207], v[144:147], v[172:175]
  v_mfma_f32_16x16x32_bf16 v[172:175], v[216:219], v[156:159], v[172:175]
  v_cvt_pk_bf16_f32 v72, v176, v177
  v_cvt_pk_bf16_f32 v73, v178, v179
  v_mfma_f32_16x16x32_bf16 v[172:175], v[228:231], v[160:163], v[172:175]
  v_mfma_f32_16x16x32_bf16 v[172:175], v[240:243], v[164:167], v[172:175]
  v_mfma_f32_16x16x32_bf16 v[172:175], v[252:255], v[168:171], v[172:175]
  v_mfma_f32_16x16x32_bf16 v[176:179], a[60:63], v[168:171], 0
  v_mfma_f32_16x16x32_bf16 v[176:179], a[48:51], v[164:167], v[176:179]
  v_mfma_f32_16x16x32_bf16 v[176:179], a[36:39], v[160:163], v[176:179]
  v_cvt_pk_bf16_f32 v74, v172, v173
  v_cvt_pk_bf16_f32 v75, v174, v175
  v_mfma_f32_16x16x32_bf16 v[176:179], a[24:27], v[156:159], v[176:179]
  v_mfma_f32_16x16x32_bf16 v[176:179], a[12:15], v[144:147], v[176:179]
  v_mfma_f32_16x16x32_bf16 v[176:179], a[0:3], v[140:143], v[176:179]
  v_mfma_f32_16x16x32_bf16 v[172:175], a[4:7], v[140:143], 0
  v_mfma_f32_16x16x32_bf16 v[172:175], a[16:19], v[144:147], v[172:175]
  v_mfma_f32_16x16x32_bf16 v[172:175], a[28:31], v[156:159], v[172:175]
  v_cvt_pk_bf16_f32 v82, v176, v177
  v_cvt_pk_bf16_f32 v83, v178, v179
  v_mfma_f32_16x16x32_bf16 v[172:175], a[40:43], v[160:163], v[172:175]
  v_mfma_f32_16x16x32_bf16 v[172:175], a[52:55], v[164:167], v[172:175]
  v_mfma_f32_16x16x32_bf16 v[172:175], a[64:67], v[168:171], v[172:175]
  v_mfma_f32_16x16x32_bf16 v[176:179], a[68:71], v[168:171], 0
  v_mfma_f32_16x16x32_bf16 v[176:179], a[56:59], v[164:167], v[176:179]
  v_mfma_f32_16x16x32_bf16 v[176:179], a[44:47], v[160:163], v[176:179]
  v_cvt_pk_bf16_f32 v84, v172, v173
  v_cvt_pk_bf16_f32 v85, v174, v175
  v_mfma_f32_16x16x32_bf16 v[176:179], a[32:35], v[156:159], v[176:179]
  v_mfma_f32_16x16x32_bf16 v[176:179], a[20:23], v[144:147], v[176:179]
  v_mfma_f32_16x16x32_bf16 v[176:179], a[8:11], v[140:143], v[176:179]
  v_mfma_f32_16x16x32_bf16 v[172:175], v[140:143], a[72:75], 0
  v_mfma_f32_16x16x32_bf16 v[172:175], v[144:147], a[84:87], v[172:175]
  v_mfma_f32_16x16x32_bf16 v[172:175], v[156:159], a[96:99], v[172:175]
  v_cvt_pk_bf16_f32 v86, v176, v177
  v_cvt_pk_bf16_f32 v87, v178, v179
  v_mfma_f32_16x16x32_bf16 v[172:175], v[160:163], a[108:111], v[172:175]
  v_mfma_f32_16x16x32_bf16 v[172:175], v[164:167], a[120:123], v[172:175]
  v_mfma_f32_16x16x32_bf16 v[172:175], v[168:171], a[132:135], v[172:175]
  v_mfma_f32_16x16x32_bf16 v[176:179], v[168:171], a[136:139], 0
  v_mfma_f32_16x16x32_bf16 v[176:179], v[164:167], a[124:127], v[176:179]
  v_mfma_f32_16x16x32_bf16 v[176:179], v[160:163], a[112:115], v[176:179]
  v_cvt_pk_bf16_f32 v22, v172, v173
  v_cvt_pk_bf16_f32 v23, v174, v175
  v_mfma_f32_16x16x32_bf16 v[176:179], v[156:159], a[100:103], v[176:179]
  ds_read_b128 a[244:247], v3 offset:0
  v_mfma_f32_16x16x32_bf16 v[176:179], v[144:147], a[88:91], v[176:179]
  ds_read_b128 a[248:251], v3 offset:4096
  v_mfma_f32_16x16x32_bf16 v[176:179], v[140:143], a[76:79], v[176:179]
  ds_read_b128 a[252:255], v3 offset:8192
  v_mfma_f32_16x16x32_bf16 v[172:175], v[140:143], a[80:83], 0
  ds_read_b128 v[180:183], v3 offset:12288
  v_mfma_f32_16x16x32_bf16 v[172:175], v[144:147], a[92:95], v[172:175]
  v_mfma_f32_16x16x32_bf16 v[172:175], v[156:159], a[104:107], v[172:175]
  v_cvt_pk_bf16_f32 v30, v176, v177
  v_cvt_pk_bf16_f32 v31, v178, v179
  v_mfma_f32_16x16x32_bf16 v[172:175], v[160:163], a[116:119], v[172:175]
  v_mfma_f32_16x16x32_bf16 v[172:175], v[164:167], a[128:131], v[172:175]
  v_mfma_f32_16x16x32_bf16 v[172:175], v[168:171], a[140:143], v[172:175]
  s_branch L_s
L_fin:
  s_nop 6
  v_cvt_pk_bf16_f32 v50, v52, v53
  v_cvt_pk_bf16_f32 v51, v54, v55
  buffer_store_dwordx4 v[48:51], v8, s[24:27], s43 offen nt
  s_endpgm
L_epi:
  v_mul_f32 v138, v15, v138
  v_mul_f32 v139, v15, v139
  v_cvt_pk_bf16_f32 v136, v136, v137
  v_cvt_pk_bf16_f32 v137, v138, v139
  ds_write_b64 v5, v[136:137] offset:768
  v_mul_f32 v116, v14, v116
  v_mul_f32 v117, v14, v117
  v_mul_f32 v118, v14, v118
  v_max3_f32 v9, v12, v13, v9
  v_max3_f32 v9, v14, v15, v9
  v_min3_f32 v11, v12, v13, v11
  v_min3_f32 v11, v14, v15, v11
  v_subrev_u32 v3, s7, v3
  v_subrev_u32 v2, s7, v2
  v_cmp_nle_f32 vcc, 0x2b800000, v11
  s_lshl_b32 s39, s4, 2
  s_add_u32 s39, s39, 139264
  v_mov_b32 v0, s39
  s_nop 0
  s_mov_b64 s[36:37], vcc
  v_cmp_nge_f32 vcc, 0x53800000, v9
  s_add_u32 s40, s48, s52
  s_add_u32 s41, s48, s53
  s_add_u32 s42, s48, s54
  s_add_u32 s43, s48, s55
  s_or_b64 vcc, vcc, s[36:37]
  s_cselect_b32 s38, 1, 0
  v_mov_b32 v1, s38
  ds_write_b32 v0, v1
  v_mov_b32 v1, 139264
  v_mul_f32 v119, v14, v119
  v_cvt_pk_bf16_f32 v116, v116, v117
  v_cvt_pk_bf16_f32 v117, v118, v119
  v_mul_f32 v124, v14, v124
  v_mul_f32 v125, v14, v125
  v_mul_f32 v126, v14, v126
  v_mul_f32 v127, v14, v127
  v_cvt_pk_bf16_f32 v118, v124, v125
  v_cvt_pk_bf16_f32 v119, v126, v127
  ds_write_b128 v4, v[116:119] offset:512
  v_mul_f32 v152, v14, v152
  v_mul_f32 v153, v14, v153
  v_mul_f32 v154, v14, v154
  v_mul_f32 v155, v14, v155
  v_cvt_pk_bf16_f32 v152, v152, v153
  v_cvt_pk_bf16_f32 v153, v154, v155
  ds_write_b64 v5, v[152:153] offset:512
  v_mul_f32 v132, v13, v132
  v_mul_f32 v133, v13, v133
  v_mul_f32 v134, v13, v134
  v_mul_f32 v135, v13, v135
  v_cvt_pk_bf16_f32 v132, v132, v133
  v_cvt_pk_bf16_f32 v133, v134, v135
  v_mul_f32 v140, v13, v140
  v_mul_f32 v141, v13, v141
  v_mul_f32 v142, v13, v142
  v_mul_f32 v143, v13, v143
  v_cvt_pk_bf16_f32 v134, v140, v141
  v_cvt_pk_bf16_f32 v135, v142, v143
  ds_write_b128 v4, v[132:135] offset:256
  v_mul_f32 v160, v13, v160
  v_mul_f32 v161, v13, v161
  v_mul_f32 v162, v13, v162
  v_mul_f32 v163, v13, v163
  v_cvt_pk_bf16_f32 v160, v160, v161
  v_cvt_pk_bf16_f32 v161, v162, v163
  ds_write_b64 v5, v[160:161] offset:256
  v_mul_f32 v148, v12, v148
  v_mul_f32 v149, v12, v149
  v_mul_f32 v150, v12, v150
  v_mul_f32 v151, v12, v151
  v_cvt_pk_bf16_f32 v148, v148, v149
  v_cvt_pk_bf16_f32 v149, v150, v151
  v_mul_f32 v156, v12, v156
  v_mul_f32 v157, v12, v157
  v_mul_f32 v158, v12, v158
  v_mul_f32 v159, v12, v159
  v_cvt_pk_bf16_f32 v150, v156, v157
  v_cvt_pk_bf16_f32 v151, v158, v159
  ds_write_b128 v4, v[148:151] offset:0
  v_mul_f32 v168, v12, v168
  v_mul_f32 v169, v12, v169
  v_mul_f32 v170, v12, v170
  v_mul_f32 v171, v12, v171
  v_cvt_pk_bf16_f32 v168, v168, v169
  v_cvt_pk_bf16_f32 v169, v170, v171
  ds_write_b64 v5, v[168:169] offset:0
  s_waitcnt lgkmcnt(0)
  s_barrier
  ds_read_b128 v[116:119], v1
  ds_read_b128 a[244:247], v3 offset:0
  ds_read_b128 a[248:251], v3 offset:4096
  ds_read_b128 a[252:255], v3 offset:8192
  ds_read_b128 v[180:183], v3 offset:12288
  ds_read_b128 v[64:67], v3 offset:16384
  ds_read_b128 v[68:71], v3 offset:20480
  s_waitcnt lgkmcnt(6)
  v_or3_b32 v116, v116, v117, v118
  v_or_b32 v116, v116, v119
  s_nop 0
  v_readfirstlane_b32 s36, v116
  s_nop 3
  s_andn2_b32 s36, s36, s31
  s_cmp_eq_u32 s36, 0
  s_waitcnt lgkmcnt(0)
  s_cbranch_scc1 L_pj
  s_mov_b32 s31, 1
  s_waitcnt vmcnt(0) lgkmcnt(0)
  v_mbcnt_lo_u32_b32 v0, -1, 0
  v_mbcnt_hi_u32_b32 v0, -1, v0
  v_add_u32 v0, s3, v0
  s_barrier
  s_branch L_again
L_special0:
  s_add_u32 m0, s32, 53120
  ds_read_b64_tr_b16 a[100:101], v13 offset:49152
  buffer_load_dwordx4 v6, s[8:11], s49 offen offset:128 nt lds
  ds_read_b64_tr_b16 a[102:103], v13 offset:49664
  ds_read_b64_tr_b16 a[104:105], v14 offset:49152
  ds_read_b64_tr_b16 a[106:107], v14 offset:49664
  ds_read_b64_tr_b16 a[108:109], v12 offset:61440
  ds_read_b64_tr_b16 a[110:111], v12 offset:61952
  ds_read_b64_tr_b16 a[112:113], v13 offset:61440
  s_add_u32 m0, s32, 61184
  ds_read_b64_tr_b16 a[114:115], v13 offset:61952
  buffer_load_dwordx4 v6, s[8:11], s49 offen offset:256 nt lds
  s_add_u32 s48, s48, 6291456
  s_add_u32 s49, s48, 786432
  ds_read_b64_tr_b16 a[116:117], v14 offset:61440
  ds_read_b64_tr_b16 a[118:119], v14 offset:61952
  s_add_u32 m0, s32, 65536
  s_nop 0
  buffer_load_dwordx4 v6, s[8:11], s48 offen offset:0 nt lds
  s_add_u32 m0, s32, 73600
  s_nop 0
  buffer_load_dwordx4 v6, s[8:11], s48 offen offset:128 nt lds
  s_waitcnt lgkmcnt(0)
  s_waitcnt vmcnt(8)
  s_barrier
  ds_read_b64_tr_b16 a[120:121], v15 offset:0
  ds_read_b64_tr_b16 a[122:123], v15 offset:512
  ds_read_b64_tr_b16 a[124:125], v9 offset:0
  ds_read_b64_tr_b16 a[126:127], v9 offset:512
  s_add_u32 m0, s32, 81664
  ds_read_b64_tr_b16 a[128:129], v11 offset:0
  buffer_load_dwordx4 v6, s[8:11], s48 offen offset:256 nt lds
  ds_read_b64_tr_b16 a[130:131], v11 offset:512
  ds_read_b64_tr_b16 a[132:133], v15 offset:12288
  ds_read_b64_tr_b16 a[134:135], v15 offset:12800
  ds_read_b64_tr_b16 a[136:137], v9 offset:12288
  ds_read_b64_tr_b16 a[138:139], v9 offset:12800
  ds_read_b64_tr_b16 a[140:141], v11 offset:12288
  ds_read_b64_tr_b16 a[142:143], v11 offset:12800
  v_mfma_f32_16x16x16_bf16 v[120:123], v[62:63], v[74:75], v[120:123]
  v_mfma_f32_16x16x16_bf16 v[124:127], v[80:81], v[74:75], v[124:127]
  v_mfma_f32_16x16x16_bf16 v[128:131], v[86:87], v[74:75], v[128:131]
  v_mfma_f32_16x16x32_bf16 v[132:135], v[46:49], v[64:67], v[160:163]
  v_mfma_f32_16x16x32_bf16 v[136:139], v[58:61], v[64:67], v[180:183]
  v_mfma_f32_16x16x32_bf16 v[140:143], v[76:79], v[64:67], v[100:103]
  v_mfma_f32_16x16x32_bf16 v[144:147], v[82:85], v[64:67], v[96:99]
  v_mfma_f32_16x16x16_bf16 v[132:135], v[50:51], v[68:69], v[132:135]
  v_mfma_f32_16x16x16_bf16 v[136:139], v[62:63], v[68:69], v[136:139]
  v_mfma_f32_16x16x16_bf16 v[140:143], v[80:81], v[68:69], v[140:143]
  v_mfma_f32_16x16x16_bf16 v[144:147], v[86:87], v[68:69], v[144:147]
  v_mfma_f32_16x16x32_bf16 v[148:151], v[46:49], v[52:55], v[104:107]
  v_mfma_f32_16x16x32_bf16 v[152:155], v[58:61], v[52:55], v[100:103]
  v_mfma_f32_16x16x32_bf16 v[156:159], v[76:79], v[52:55], v[156:159]
  v_mfma_f32_16x16x32_bf16 v[160:163], v[82:85], v[52:55], v[172:175]
  v_mfma_f32_16x16x16_bf16 v[148:151], v[50:51], v[56:57], v[148:151]
  v_mfma_f32_16x16x16_bf16 v[152:155], v[62:63], v[56:57], v[152:155]
  v_mfma_f32_16x16x16_bf16 v[156:159], v[80:81], v[56:57], v[156:159]
  v_mfma_f32_16x16x16_bf16 v[160:163], v[86:87], v[56:57], v[160:163]
  v_mfma_f32_16x16x32_bf16 v[164:167], v[46:49], v[40:43], v[100:103]
  v_mfma_f32_16x16x32_bf16 v[168:171], v[58:61], v[40:43], v[96:99]
  v_mfma_f32_16x16x32_bf16 v[172:175], v[76:79], v[40:43], v[172:175]
  v_mfma_f32_16x16x32_bf16 v[176:179], v[82:85], v[40:43], v[176:179]
  v_mfma_f32_16x16x16_bf16 v[164:167], v[50:51], v[44:45], v[164:167]
  v_mfma_f32_16x16x16_bf16 v[168:171], v[62:63], v[44:45], v[168:171]
  v_mfma_f32_16x16x16_bf16 v[172:175], v[80:81], v[44:45], v[172:175]
  v_mfma_f32_16x16x16_bf16 v[176:179], v[86:87], v[44:45], v[176:179]
  s_branch L_sp2
L_special:
  v_mfma_f32_16x16x16_bf16 v[120:123], v[62:63], v[74:75], v[120:123]
  v_mfma_f32_16x16x16_bf16 v[124:127], v[80:81], v[74:75], v[124:127]
  v_mfma_f32_16x16x16_bf16 v[128:131], v[86:87], v[74:75], v[128:131]
  v_mfma_f32_16x16x32_bf16 v[132:135], v[46:49], v[64:67], v[108:111]
  v_mfma_f32_16x16x32_bf16 v[136:139], v[58:61], v[64:67], v[104:107]
  v_mfma_f32_16x16x32_bf16 v[140:143], v[76:79], v[64:67], v[100:103]
  v_mfma_f32_16x16x32_bf16 v[144:147], v[82:85], v[64:67], v[96:99]
  v_mfma_f32_16x16x16_bf16 v[132:135], v[50:51], v[68:69], v[132:135]
  v_mfma_f32_16x16x16_bf16 v[136:139], v[62:63], v[68:69], v[136:139]
  v_mfma_f32_16x16x16_bf16 v[140:143], v[80:81], v[68:69], v[140:143]
  v_mfma_f32_16x16x16_bf16 v[144:147], v[86:87], v[68:69], v[144:147]
  v_mfma_f32_16x16x32_bf16 v[148:151], v[46:49], v[52:55], v[104:107]
  v_mfma_f32_16x16x32_bf16 v[152:155], v[58:61], v[52:55], v[100:103]
  v_mfma_f32_16x16x32_bf16 v[156:159], v[76:79], v[52:55], v[96:99]
  v_mfma_f32_16x16x32_bf16 v[160:163], v[82:85], v[52:55], v[92:95]
  v_mfma_f32_16x16x16_bf16 v[148:151], v[50:51], v[56:57], v[148:151]
  v_mfma_f32_16x16x16_bf16 v[152:155], v[62:63], v[56:57], v[152:155]
  v_mfma_f32_16x16x16_bf16 v[156:159], v[80:81], v[56:57], v[156:159]
  v_mfma_f32_16x16x16_bf16 v[160:163], v[86:87], v[56:57], v[160:163]
  v_mfma_f32_16x16x32_bf16 v[164:167], v[46:49], v[40:43], v[100:103]
  v_mfma_f32_16x16x32_bf16 v[168:171], v[58:61], v[40:43], v[96:99]
  v_mfma_f32_16x16x32_bf16 v[172:175], v[76:79], v[40:43], v[92:95]
  v_mfma_f32_16x16x32_bf16 v[176:179], v[82:85], v[40:43], v[88:91]
  v_mfma_f32_16x16x16_bf16 v[164:167], v[50:51], v[44:45], v[164:167]
  v_mfma_f32_16x16x16_bf16 v[168:171], v[62:63], v[44:45], v[168:171]
  v_mfma_f32_16x16x16_bf16 v[172:175], v[80:81], v[44:45], v[172:175]
  v_mfma_f32_16x16x16_bf16 v[176:179], v[86:87], v[44:45], v[176:179]
  ds_read_b128 v[64:67], v3 offset:16384
  ds_read_b128 v[68:71], v3 offset:20480
L_sp2:
  s_nop 15
  v_max_f32 v40, v164, v165
  v_max3_f32 v40, v166, v167, v40
  v_max3_f32 v40, v168, v169, v40
  v_max3_f32 v40, v170, v171, v40
  v_max3_f32 v40, v172, v173, v40
  v_max3_f32 v40, v174, v175, v40
  v_max3_f32 v40, v176, v177, v40
  v_max3_f32 v40, v178, v179, v40
  v_mov_b32 v41, v40
  s_nop 1
  v_permlane32_swap_b32 v40, v41
  v_max_f32 v40, v40, v41
  v_mov_b32 v41, v40
  s_nop 1
  v_permlane16_swap_b32 v40, v41
  v_max_f32 v40, v40, v41
  v_sub_f32 v164, v164, v40
  v_sub_f32 v165, v165, v40
  v_sub_f32 v166, v166, v40
  v_sub_f32 v167, v167, v40
  v_sub_f32 v168, v168, v40
  v_sub_f32 v169, v169, v40
  v_sub_f32 v170, v170, v40
  v_sub_f32 v171, v171, v40
  v_sub_f32 v172, v172, v40
  v_sub_f32 v173, v173, v40
  v_sub_f32 v174, v174, v40
  v_sub_f32 v175, v175, v40
  v_sub_f32 v176, v176, v40
  v_sub_f32 v177, v177, v40
  v_sub_f32 v178, v178, v40
  v_sub_f32 v179, v179, v40
  v_max_f32 v40, v148, v149
  v_max3_f32 v40, v150, v151, v40
  v_max3_f32 v40, v152, v153, v40
  v_max3_f32 v40, v154, v155, v40
  v_max3_f32 v40, v156, v157, v40
  v_max3_f32 v40, v158, v159, v40
  v_max3_f32 v40, v160, v161, v40
  v_max3_f32 v40, v162, v163, v40
  v_mov_b32 v41, v40
  s_nop 1
  v_permlane32_swap_b32 v40, v41
  v_max_f32 v40, v40, v41
  v_mov_b32 v41, v40
  s_nop 1
  v_permlane16_swap_b32 v40, v41
  v_max_f32 v40, v40, v41
  v_sub_f32 v148, v148, v40
  v_sub_f32 v149, v149, v40
  v_sub_f32 v150, v150, v40
  v_sub_f32 v151, v151, v40
  v_sub_f32 v152, v152, v40
  v_sub_f32 v153, v153, v40
  v_sub_f32 v154, v154, v40
  v_sub_f32 v155, v155, v40
  v_sub_f32 v156, v156, v40
  v_sub_f32 v157, v157, v40
  v_sub_f32 v158, v158, v40
  v_sub_f32 v159, v159, v40
  v_sub_f32 v160, v160, v40
  v_sub_f32 v161, v161, v40
  v_sub_f32 v162, v162, v40
  v_sub_f32 v163, v163, v40
  v_max_f32 v40, v132, v133
  v_max3_f32 v40, v134, v135, v40
  v_max3_f32 v40, v136, v137, v40
  v_max3_f32 v40, v138, v139, v40
  v_max3_f32 v40, v140, v141, v40
  v_max3_f32 v40, v142, v143, v40
  v_max3_f32 v40, v144, v145, v40
  v_max3_f32 v40, v146, v147, v40
  v_mov_b32 v41, v40
  s_nop 1
  v_permlane32_swap_b32 v40, v41
  v_max_f32 v40, v40, v41
  v_mov_b32 v41, v40
  s_nop 1
  v_permlane16_swap_b32 v40, v41
  v_max_f32 v40, v40, v41
  v_sub_f32 v132, v132, v40
  v_sub_f32 v133, v133, v40
  v_sub_f32 v134, v134, v40
  v_sub_f32 v135, v135, v40
  v_sub_f32 v136, v136, v40
  v_sub_f32 v137, v137, v40
  v_sub_f32 v138, v138, v40
  v_sub_f32 v139, v139, v40
  v_sub_f32 v140, v140, v40
  v_sub_f32 v141, v141, v40
  v_sub_f32 v142, v142, v40
  v_sub_f32 v143, v143, v40
  v_sub_f32 v144, v144, v40
  v_sub_f32 v145, v145, v40
  v_sub_f32 v146, v146, v40
  v_sub_f32 v147, v147, v40
  v_max_f32 v40, v116, v117
  v_max3_f32 v40, v118, v119, v40
  v_max3_f32 v40, v120, v121, v40
  v_max3_f32 v40, v122, v123, v40
  v_max3_f32 v40, v124, v125, v40
  v_max3_f32 v40, v126, v127, v40
  v_max3_f32 v40, v128, v129, v40
  v_max3_f32 v40, v130, v131, v40
  v_mov_b32 v41, v40
  s_nop 1
  v_permlane32_swap_b32 v40, v41
  v_max_f32 v40, v40, v41
  v_mov_b32 v41, v40
  s_nop 1
  v_permlane16_swap_b32 v40, v41
  v_max_f32 v40, v40, v41
  v_sub_f32 v116, v116, v40
  v_sub_f32 v117, v117, v40
  v_sub_f32 v118, v118, v40
  v_sub_f32 v119, v119, v40
  v_sub_f32 v120, v120, v40
  v_sub_f32 v121, v121, v40
  v_sub_f32 v122, v122, v40
  v_sub_f32 v123, v123, v40
  v_sub_f32 v124, v124, v40
  v_sub_f32 v125, v125, v40
  v_sub_f32 v126, v126, v40
  v_sub_f32 v127, v127, v40
  v_sub_f32 v128, v128, v40
  v_sub_f32 v129, v129, v40
  v_sub_f32 v130, v130, v40
  v_sub_f32 v131, v131, v40
  v_exp_f32 v116, v116
  v_exp_f32 v117, v117
  v_exp_f32 v118, v118
  v_exp_f32 v119, v119
  v_exp_f32 v120, v120
  s_waitcnt lgkmcnt(0)
  s_nop 7
  s_cmp_eq_u32 s35, 1
  s_cbranch_scc1 L_enter
  v_exp_f32 v121, v121
  v_exp_f32 v122, v122
  v_exp_f32 v123, v123
  v_exp_f32 v124, v124
  v_cvt_pk_bf16_f32 v116, v116, v117
  v_cvt_pk_bf16_f32 v117, v118, v119
  v_cvt_pk_bf16_f32 v118, v120, v121
  v_cvt_pk_bf16_f32 v119, v122, v123
  v_exp_f32 v125, v125
  v_exp_f32 v126, v126
  v_exp_f32 v127, v127
  v_exp_f32 v128, v128
  v_exp_f32 v129, v129
  v_exp_f32 v130, v130
  v_exp_f32 v131, v131
  v_exp_f32 v132, v132
  v_cvt_pk_bf16_f32 v124, v124, v125
  v_cvt_pk_bf16_f32 v125, v126, v127
  v_cvt_pk_bf16_f32 v126, v128, v129
  v_cvt_pk_bf16_f32 v127, v130, v131
  v_exp_f32 v133, v133
  v_exp_f32 v134, v134
  s_nop 7
  s_branch L_pj
L_end:
  s_endpgm
.fill (standalone__window_attn_swin__vision_kernel + 33280 - .) / 4, 4, 0xbf810000
.section .rodata,"a"
.p2align 6
.amdhsa_kernel standalone__window_attn_swin__vision_kernel
  .amdhsa_next_free_vgpr 512
  .amdhsa_next_free_sgpr 100
  .amdhsa_accum_offset 256
  .amdhsa_group_segment_fixed_size 0
  .amdhsa_kernarg_size 72
  .amdhsa_user_sgpr_count 2
  .amdhsa_user_sgpr_kernarg_segment_ptr 1
  .amdhsa_system_sgpr_workgroup_id_x 1
.end_amdhsa_kernel
```

```asm
; @launch grid=(256,1,1) block=(256,1,1) lds=163840
.amdgcn_target "amdgcn-amd-amdhsa--gfx950"
.text
.globl standalone__window_attn_swin__vision_kernel
.p2align 12
.type standalone__window_attn_swin__vision_kernel,@function
standalone__window_attn_swin__vision_kernel:
  s_mov_b32 s31, 0
L_again:
  s_load_dwordx2 s[8:9], s[0:1], 0
  s_load_dwordx2 s[12:13], s[0:1], 8
  s_cmpk_ge_u32 s2, 256
  s_cbranch_scc1 L_end
  s_getpc_b64 s[42:43]
  s_lshr_b32 s44, s2, 3
  s_lshl_b32 s45, s44, 10
  v_lshl_add_u32 v2, v0, 2, s45
  v_mov_b32 v3, 0
  v_lshl_add_u64 v[2:3], v[2:3], 0, s[42:43]
  global_load_dword v64, v[2:3], off
  v_readfirstlane_b32 s3, v0
  s_load_dwordx2 s[20:21], s[0:1], 24
  s_mov_b32 s11, 0x20000
  s_mov_b32 s15, s11
  s_mov_b32 s14, 223232
  s_mulk_i32 s44, 6912
  v_lshlrev_b32 v26, 5, v0
  s_and_b32 s28, s2, 63
  s_lshr_b32 s29, s2, 6
  s_lshr_b32 s4, s3, 6
  s_lshl_b32 s36, s28, 3
  v_bfe_u32 v21, v0, 3, 3
  v_add3_u32 v25, s36, 4, v21
  v_and_b32 v25, 0x1ff, v25
  v_mul_u32_u24 v25, 0x180, v25
  v_lshrrev_b32 v23, 4, v0
  v_lshrrev_b32 v24, 1, v0
  v_and_b32 v24, 4, v24
  v_bitop3_b32 v24, v24, v23, v0 bitop3:0x96
  v_and_b32 v24, 7, v24
  v_lshl_add_u32 v6, v24, 4, v25
  s_lshl3_add_u32 s36, s29, s4
  s_add_u32 s48, s36, 484
  s_add_u32 s49, s48, 4
  s_and_b32 s49, s49, 0x1ff
  s_mov_b32 s37, 196608
  s_mul_i32 s48, s48, s37
  s_mul_i32 s49, s49, s37
  s_mov_b32 s10, 100663296
  s_waitcnt lgkmcnt(0)
  s_sub_u32 s12, s12, 2048
  s_subb_u32 s13, s13, 0
  buffer_load_dword v65, v26, s[12:15], s44 offen offset:2048
  v_and_b32 v22, 4, v23
  v_and_b32 v24, 2, v21
  v_bitop3_b32 v24, v24, v22, v0 bitop3:0x96
  v_and_b32 v24, 7, v24
  v_mul_u32_u24 v25, 1152, v21
  v_lshl_add_u32 v25, v24, 4, v25
  v_add_u32 v136, 2048, v25
  v_add_u32 v137, 1152, v25
  v_add_u32 v138, 256, v25
  s_mul_i32 s62, s4, 9216
  s_mul_i32 s58, s4, 3072
  s_add_u32 s63, s58, 40960
  s_mov_b32 s22, 1800
  s_mov_b32 s23, s11
  v_lshlrev_b32 v34, 4, v0
  s_lshl_b32 s37, s4, 10
  s_add_u32 m0, s37, 24576
  v_mul_u32_u24 v35, 9, v0
  buffer_load_dwordx4 v34, s[20:23], 0 offen lds
  v_and_b32 v35, -4, v35
  s_load_dwordx2 s[16:17], s[0:1], 16
  s_load_dwordx2 s[24:25], s[0:1], 48
  v_and_b32 v16, 63, v0
  v_and_b32 v17, 15, v16
  v_lshrrev_b32 v18, 4, v16
  v_lshrrev_b32 v20, 2, v17
  v_and_b32 v27, 1, v18
  v_lshrrev_b32 v28, 3, v17
  s_add_u32 m0, s63, 0
  s_add_u32 s36, s62, 0
  buffer_load_dwordx4 v136, s[12:15], s36 offen offset:0 lds
  v_lshl_add_u32 v21, v27, 1, v28
  v_mul_u32_u24 v22, 3072, v18
  v_lshl_add_u32 v22, v20, 7, v22
  v_lshl_add_u32 v22, v21, 5, v22
  v_and_b32 v29, 3, v17
  v_lshl_add_u32 v22, v29, 3, v22
  s_mul_i32 s37, s4, 3
  s_and_b32 s38, s37, 3
  buffer_load_dwordx4 v137, s[12:15], s36 offen offset:1024 lds
  s_lshl_b32 s38, s38, 5
  s_lshr_b32 s39, s37, 2
  s_lshl_b32 s39, s39, 10
  s_add_u32 s39, s39, 40960
  v_xor_b32 v23, s38, v22
  v_add_u32 v12, s39, v23
  v_add_u32 v15, 73728, v12
  s_add_u32 s37, s37, 1
  buffer_load_dwordx4 v138, s[12:15], s36 offen offset:2048 lds
  s_and_b32 s38, s37, 3
  s_lshl_b32 s38, s38, 5
  s_lshr_b32 s39, s37, 2
  s_lshl_b32 s39, s39, 10
  s_add_u32 s39, s39, 40960
  v_xor_b32 v23, s38, v22
  s_mov_b64 exec, 0
  s_cmp_eq_u32 s4, 0
  s_cbranch_scc1 L_hop0
  s_cmp_eq_u32 s4, 1
  s_cbranch_scc1 L_hop1
  s_cmp_eq_u32 s4, 2
  s_cbranch_scc1 L_hop2
  s_branch L_hop3
L_hopped:
  s_mov_b64 exec, -1
  v_add_u32 v13, s39, v23
  s_add_u32 m0, s63, 12288
  s_add_u32 s36, s62, 36864
  buffer_load_dwordx4 v136, s[12:15], s36 offen offset:0 lds
  v_add_u32 v9, 73728, v13
  s_add_u32 s37, s37, 1
  s_and_b32 s38, s37, 3
  s_lshl_b32 s38, s38, 5
  s_lshr_b32 s39, s37, 2
  s_lshl_b32 s39, s39, 10
  s_add_u32 s39, s39, 40960
  v_xor_b32 v23, s38, v22
  buffer_load_dwordx4 v137, s[12:15], s36 offen offset:1024 lds
  v_add_u32 v14, s39, v23
  v_add_u32 v11, 73728, v14
  s_mov_b32 s46, 0x3e553b95
  s_mov_b32 s47, s46
  s_mov_b32 s44, 0xffff0000
  v_bfe_u32 v19, v17, 1, 3
  v_and_b32 v21, 1, v17
  v_lshlrev_b32 v21, 2, v21
  buffer_load_dwordx4 v138, s[12:15], s36 offen offset:2048 lds
  v_xor_b32 v19, v19, v21
  v_xor_b32 v21, v18, v19
  v_lshlrev_b32 v21, 4, v21
  v_lshl_add_u32 v0, v17, 7, v21
  s_lshl_b32 s32, s4, 10
  v_subrev_u32 v10, s32, v0
  v_and_b32 v21, 1, v17
  v_mul_u32_u24 v21, 0xaaaa, v21
  s_add_u32 m0, s63, 24576
  s_add_u32 s36, s62, 73728
  buffer_load_dwordx4 v136, s[12:15], s36 offen offset:0 lds
  v_add_u32 v21, 0x4444, v21
  v_lshl_add_u32 v10, v10, 16, v21
  v_xor_b32 v1, 64, v0
  v_lshlrev_b32 v22, 4, v17
  v_lshl_add_u32 v23, v18, 10, v22
  s_and_b32 s5, s4, 1
  s_lshl_b32 s37, s5, 9
  s_add_u32 s38, s37, 114688
  v_add_u32 v3, s38, v23
  s_sub_u32 s38, 114688, s37
  v_add_u32 v2, s38, v23
  s_lshl_b32 s37, s4, 12
  s_add_u32 s37, s37, 90112
  v_add_u32 v4, s37, v23
  s_lshl_b32 s37, s4, 11
  s_add_u32 s37, s37, 106496
  v_lshrrev_b32 v23, 1, v18
  v_lshl_add_u32 v24, v23, 10, v22
  v_lshl_add_u32 v24, v27, 3, v24
  v_add_u32 v5, s37, v24
  s_mov_b32 s7, 24576
  v_sub_u32 v24, v28, v23
  v_mul_i32_i24 v24, 15, v24
  v_and_b32 v26, 7, v17
  v_lshlrev_b32 v25, 2, v27
  v_sub_u32 v30, v26, v25
  v_add3_u32 v24, v24, v30, 19
  s_lshl_b32 s37, s4, 1
  s_and_b32 s37, s37, 0
  s_waitcnt lgkmcnt(0)
  s_mov_b32 s18, 73728
  s_mov_b32 s19, s11
  s_mul_i32 s60, s4, 0x02020000
  s_add_u32 s60, s60, 0x01000c0c
  s_add_u32 s37, s37, 24576
  v_lshl_add_u32 v144, v24, 3, s37
  v_add_u32 v145, 960, v144
  s_lshl_b32 s37, s28, 3
  v_add3_u32 v24, s37, 4, v26
  v_and_b32 v24, 0x1ff, v24
  v_mul_u32_u24 v24, 0x180, v24
  v_mul_u32_u24 v26, 196608, v28
  v_add_u32 v24, v24, v26
  v_lshl_add_u32 v24, v18, 4, v24
  s_lshr_b32 s37, s4, 1
  s_lshl_b32 s38, s37, 6
  s_add_u32 s39, s38, 256
  v_add_u32 v8, s39, v24
  s_lshl_b32 s39, s5, 7
  s_add_u32 s38, s38, s39
  v_add_u32 v7, s38, v24
  v_and_b32 v24, 16, v16
  v_lshlrev_b32 v24, 2, v24
  v_lshlrev_b32 v26, 4, v16
  v_xor_b32 v24, v24, v26
  v_accvgpr_write_b32 a228, v24
  v_add_u32 v30, v25, v20
  v_mul_u32_u24 v31, 3072, v23
  v_lshl_add_u32 v31, v29, 4, v31
  v_mad_u32_u24 v32, v30, 3, s5
  v_lshrrev_b32 v33, 1, v32
  v_xor_b32 v33, s37, v33
  v_and_b32 v33, 1, v33
  v_lshl_add_u32 v32, v32, 1, v33
  v_lshl_add_u32 v32, v32, 6, v31
  v_add_u32 v32, 114688, v32
  v_accvgpr_write_b32 a229, v32
  v_mad_u32_u24 v32, v30, 3, 2
  buffer_load_dwordx4 v137, s[12:15], s36 offen offset:1024 lds
  v_lshrrev_b32 v33, 1, v32
  v_xor_b32 v33, s37, v33
  v_and_b32 v33, 1, v33
  v_lshl_add_u32 v32, v32, 1, v33
  v_lshl_add_u32 v32, v32, 6, v31
  v_add_u32 v32, 114688, v32
  v_accvgpr_write_b32 a230, v32
  v_mul_u32_u24 v31, 3072, v18
  v_lshl_add_u32 v31, v29, 4, v31
  v_mad_u32_u24 v32, v20, 3, s5
  v_lshrrev_b32 v33, 1, v32
  v_xor_b32 v33, s37, v33
  buffer_load_dwordx4 v138, s[12:15], s36 offen offset:2048 lds
  v_and_b32 v33, 1, v33
  v_lshl_add_u32 v32, v32, 1, v33
  v_lshl_add_u32 v32, v32, 6, v31
  v_accvgpr_write_b32 a231, v32
  v_mad_u32_u24 v32, v20, 3, 2
  v_lshrrev_b32 v33, 1, v32
  v_xor_b32 v33, s37, v33
  v_and_b32 v33, 1, v33
  v_lshl_add_u32 v32, v32, 1, v33
  v_lshl_add_u32 v32, v32, 6, v31
  v_accvgpr_write_b32 a232, v32
  s_mul_i32 s59, s37, 12288
  s_add_u32 m0, s63, 36864
  s_add_u32 s36, s62, 110592
  buffer_load_dwordx4 v136, s[12:15], s36 offen offset:0 lds
  s_add_u32 s59, s59, s58
  v_cmp_gt_u32 vcc, 2, v29
  v_mov_b32 v31, 0x3f803f80
  s_mov_b32 s26, 100663296
  s_mov_b32 s27, s11
  v_cndmask_b32 v31, 0, v31, vcc
  v_accvgpr_write_b32 a240, v31
  v_accvgpr_write_b32 a241, v31
  v_accvgpr_write_b32 a242, v31
  v_accvgpr_write_b32 a243, v31
  v_lshrrev_b32 v150, 2, v16
  v_xor_b32 v151, v16, v150
  buffer_load_dwordx4 v137, s[12:15], s36 offen offset:1024 lds
  s_cmp_eq_u32 s28, 63
  s_cselect_b32 s37, 4, 0
  v_and_b32 v151, s37, v151
  v_cmp_eq_u32 vcc, 0, v151
  s_cmp_eq_u32 s29, 3
  s_cselect_b32 s37, 0xc31044fe, 0
  v_mov_b32 v150, s37
  v_mov_b32 v149, 0xc31044fe
  v_cndmask_b32 v151, 0, v150, vcc
  v_cndmask_b32 v150, v149, 0, vcc
  s_mov_b32 s45, 0x3fb8aa3b
  s_lshl_b32 s37, s29, 3
  buffer_load_dwordx4 v138, s[12:15], s36 offen offset:2048 lds
  s_lshl_b32 s38, s5, 2
  s_waitcnt vmcnt(12)
  s_barrier
  ds_read_b64 v[156:157], v144 offset:24
  s_xor_b32 s39, s38, 0
  ds_read_b64 v[158:159], v144 offset:16
  s_add_u32 s40, s39, s37
  ds_read_b64 v[152:153], v144 offset:8
  s_add_u32 s40, s40, 484
  ds_read_b64 v[154:155], v144 offset:0
  s_and_b32 s40, s40, 0x1ff
  s_add_u32 m0, s63, 49152
  s_add_u32 s36, s62, 147456
  buffer_load_dwordx4 v136, s[12:15], s36 offen offset:0 lds
  s_mul_i32 s40, s40, 196608
  ds_read_b64 v[160:161], v144 offset:264
  s_sub_u32 s39, s39, s4
  ds_read_b64 v[162:163], v144 offset:256
  s_sub_u32 s39, s39, 96
  ds_read_b64 v[164:165], v144 offset:248
  s_mul_i32 s52, s39, 196608
  s_xor_b32 s39, s38, 2
  ds_read_b64 v[166:167], v144 offset:240
  s_add_u32 s41, s39, s37
  ds_read_b64 v[172:173], v144 offset:504
  s_add_u32 s41, s41, 484
  buffer_load_dwordx4 v137, s[12:15], s36 offen offset:1024 lds
  ds_read_b64 v[174:175], v144 offset:496
  s_and_b32 s41, s41, 0x1ff
  ds_read_b64 v[168:169], v144 offset:488
  s_mul_i32 s41, s41, 196608
  s_sub_u32 s39, s39, s4
  ds_read_b64 v[170:171], v144 offset:480
  s_sub_u32 s39, s39, 96
  ds_read_b64 v[176:177], v144 offset:744
  s_mul_i32 s53, s39, 196608
  ds_read_b64 v[178:179], v144 offset:736
  s_xor_b32 s39, s38, 4
  s_add_u32 s42, s39, s37
  buffer_load_dwordx4 v138, s[12:15], s36 offen offset:2048 lds
  ds_read_b64 v[180:181], v144 offset:728
  s_add_u32 s42, s42, 484
  ds_read_b64 v[182:183], v144 offset:720
  s_and_b32 s42, s42, 0x1ff
  ds_read_b64 v[116:117], v144 offset:984
  s_mul_i32 s42, s42, 196608
  ds_read_b64 v[118:119], v144 offset:976
  s_sub_u32 s39, s39, s4
  s_sub_u32 s39, s39, 96
  ds_read_b64 v[124:125], v144 offset:968
  s_mul_i32 s54, s39, 196608
  ds_read_b64 v[126:127], v144 offset:960
  s_add_u32 m0, s63, 61440
  s_add_u32 s36, s62, 184320
  buffer_load_dwordx4 v136, s[12:15], s36 offen offset:0 lds
  s_xor_b32 s39, s38, 6
  ds_read_b64 v[120:121], v144 offset:1224
  s_add_u32 s43, s39, s37
  s_add_u32 s43, s43, 484
  ds_read_b64 v[122:123], v144 offset:1216
  s_and_b32 s43, s43, 0x1ff
  ds_read_b64 v[128:129], v144 offset:1208
  s_mul_i32 s43, s43, 196608
  ds_read_b64 v[130:131], v144 offset:1200
  s_sub_u32 s39, s39, s4
  ds_read_b64 v[132:133], v144 offset:1464
  s_sub_u32 s39, s39, 96
  buffer_load_dwordx4 v137, s[12:15], s36 offen offset:1024 lds
  s_mul_i32 s55, s39, 196608
  ds_read_b64 v[134:135], v144 offset:1456
  s_mul_i32 s34, s32, 3
  ds_read_b64 v[140:141], v144 offset:1448
  s_add_u32 s34, s34, 106496
  ds_read_b64 v[142:143], v144 offset:1440
  s_mov_b32 s35, 1
  s_mov_b32 s30, 1
  s_waitcnt vmcnt(11)
  s_barrier
  ds_read_b64_tr_b16 v[184:185], v12 offset:0
  ds_read_b64_tr_b16 v[186:187], v12 offset:512
  buffer_load_dwordx4 v138, s[12:15], s36 offen offset:2048 lds
  ds_read_b64_tr_b16 v[188:189], v13 offset:0
  ds_read_b64_tr_b16 v[190:191], v13 offset:512
  ds_read_b64_tr_b16 v[192:193], v14 offset:0
  ds_read_b64_tr_b16 v[194:195], v14 offset:512
  ds_read_b64_tr_b16 v[196:197], v12 offset:12288
  ds_read_b64_tr_b16 v[198:199], v12 offset:12800
  ds_read_b64_tr_b16 v[200:201], v13 offset:12288
  ds_read_b64_tr_b16 v[202:203], v13 offset:12800
  ds_read_b64_tr_b16 v[204:205], v14 offset:12288
  ds_read_b64_tr_b16 v[206:207], v14 offset:12800
  s_waitcnt lgkmcnt(12)
  v_perm_b32 v88, v157, v156, s60
  s_lshl_b32 m0, s3, 4
  s_nop 0
  buffer_load_dwordx4 v6, s[8:11], s48 offen offset:0 nt lds
  v_perm_b32 v89, v159, v158, s60
  v_perm_b32 v90, v153, v152, s60
  v_perm_b32 v91, v155, v154, s60
  v_perm_b32 v92, v161, v160, s60
  v_perm_b32 v93, v163, v162, s60
  v_perm_b32 v94, v165, v164, s60
  v_perm_b32 v95, v167, v166, s60
  v_perm_b32 v96, v173, v172, s60
  v_perm_b32 v97, v175, v174, s60
  v_perm_b32 v98, v169, v168, s60
  v_perm_b32 v99, v171, v170, s60
  v_perm_b32 v100, v177, v176, s60
  s_addk_i32 m0, 8064
  s_nop 0
  buffer_load_dwordx4 v6, s[8:11], s48 offen offset:128 nt lds
  v_perm_b32 v101, v179, v178, s60
  v_perm_b32 v102, v181, v180, s60
  v_perm_b32 v103, v183, v182, s60
  v_perm_b32 v104, v117, v116, s60
  v_perm_b32 v105, v119, v118, s60
  v_perm_b32 v106, v125, v124, s60
  v_perm_b32 v107, v127, v126, s60
  v_perm_b32 v108, v121, v120, s60
  v_perm_b32 v109, v123, v122, s60
  v_perm_b32 v110, v129, v128, s60
  v_perm_b32 v111, v131, v130, s60
  v_perm_b32 v112, v133, v132, s60
  s_addk_i32 m0, 8064
  s_nop 0
  buffer_load_dwordx4 v6, s[8:11], s48 offen offset:256 nt lds
  v_perm_b32 v113, v135, v134, s60
  v_perm_b32 v114, v141, v140, s60
  v_perm_b32 v115, v143, v142, s60
  s_waitcnt lgkmcnt(10)
  v_lshlrev_b32 v40, 16, v184
  v_and_b32 v41, s44, v184
  v_lshlrev_b32 v42, 16, v185
  v_and_b32 v43, s44, v185
  v_lshlrev_b32 v44, 16, v186
  v_and_b32 v45, s44, v186
  v_lshlrev_b32 v46, 16, v187
  v_and_b32 v47, s44, v187
  s_lshl_b32 m0, s3, 4
  s_addk_i32 m0, 4096
  s_nop 0
  buffer_load_dwordx4 v6, s[8:11], s49 offen offset:0 nt lds
  v_pk_mul_f32 v[40:41], v[40:41], s[46:47]
  v_pk_mul_f32 v[42:43], v[42:43], s[46:47]
  v_pk_mul_f32 v[44:45], v[44:45], s[46:47]
  v_pk_mul_f32 v[46:47], v[46:47], s[46:47]
  v_cvt_pk_bf16_f32 v184, v40, v41
  v_cvt_pk_bf16_f32 v185, v42, v43
  v_cvt_pk_bf16_f32 v186, v44, v45
  s_waitcnt lgkmcnt(0)
  v_cvt_pk_bf16_f32 v187, v46, v47
  v_lshlrev_b32 v48, 16, v188
  v_and_b32 v49, s44, v188
  v_lshlrev_b32 v50, 16, v189
  s_addk_i32 m0, 8064
  s_nop 0
  buffer_load_dwordx4 v6, s[8:11], s49 offen offset:128 nt lds
  v_and_b32 v51, s44, v189
  v_lshlrev_b32 v52, 16, v190
  v_and_b32 v53, s44, v190
  v_lshlrev_b32 v54, 16, v191
  v_and_b32 v55, s44, v191
  v_pk_mul_f32 v[48:49], v[48:49], s[46:47]
  v_pk_mul_f32 v[50:51], v[50:51], s[46:47]
  v_pk_mul_f32 v[52:53], v[52:53], s[46:47]
  v_pk_mul_f32 v[54:55], v[54:55], s[46:47]
  v_cvt_pk_bf16_f32 v188, v48, v49
  v_cvt_pk_bf16_f32 v189, v50, v51
  v_cvt_pk_bf16_f32 v190, v52, v53
  s_addk_i32 m0, 8064
  s_nop 0
  buffer_load_dwordx4 v6, s[8:11], s49 offen offset:256 nt lds
  v_cvt_pk_bf16_f32 v191, v54, v55
  v_lshlrev_b32 v56, 16, v192
  v_and_b32 v57, s44, v192
  v_lshlrev_b32 v58, 16, v193
  v_and_b32 v59, s44, v193
  v_lshlrev_b32 v60, 16, v194
  v_and_b32 v61, s44, v194
  v_lshlrev_b32 v62, 16, v195
  v_and_b32 v63, s44, v195
  v_pk_mul_f32 v[56:57], v[56:57], s[46:47]
  v_pk_mul_f32 v[58:59], v[58:59], s[46:47]
  v_pk_mul_f32 v[60:61], v[60:61], s[46:47]
  s_lshr_b32 s36, s2, 3
  s_mulk_i32 s36, 2304
  buffer_load_dword v66, v35, s[16:19], s36 offen
  v_pk_mul_f32 v[62:63], v[62:63], s[46:47]
  v_cvt_pk_bf16_f32 v192, v56, v57
  v_cvt_pk_bf16_f32 v193, v58, v59
  v_cvt_pk_bf16_f32 v194, v60, v61
  v_cvt_pk_bf16_f32 v195, v62, v63
  v_lshlrev_b32 v40, 16, v196
  v_and_b32 v41, s44, v196
  v_lshlrev_b32 v42, 16, v197
  v_and_b32 v43, s44, v197
  v_lshlrev_b32 v44, 16, v198
  v_and_b32 v45, s44, v198
  v_lshlrev_b32 v46, 16, v199
  v_and_b32 v47, s44, v199
  v_pk_mul_f32 v[40:41], v[40:41], s[46:47]
  v_pk_mul_f32 v[42:43], v[42:43], s[46:47]
  v_pk_mul_f32 v[44:45], v[44:45], s[46:47]
  v_pk_mul_f32 v[46:47], v[46:47], s[46:47]
  v_cvt_pk_bf16_f32 v196, v40, v41
  v_cvt_pk_bf16_f32 v197, v42, v43
  v_cvt_pk_bf16_f32 v198, v44, v45
  v_cvt_pk_bf16_f32 v199, v46, v47
  v_lshlrev_b32 v48, 16, v200
  v_and_b32 v49, s44, v200
  v_lshlrev_b32 v50, 16, v201
  v_and_b32 v51, s44, v201
  v_lshlrev_b32 v52, 16, v202
  v_and_b32 v53, s44, v202
  v_lshlrev_b32 v54, 16, v203
  v_and_b32 v55, s44, v203
  v_pk_mul_f32 v[48:49], v[48:49], s[46:47]
  v_pk_mul_f32 v[50:51], v[50:51], s[46:47]
  v_pk_mul_f32 v[52:53], v[52:53], s[46:47]
  v_pk_mul_f32 v[54:55], v[54:55], s[46:47]
  v_cvt_pk_bf16_f32 v200, v48, v49
  v_cvt_pk_bf16_f32 v201, v50, v51
  v_cvt_pk_bf16_f32 v202, v52, v53
  v_cvt_pk_bf16_f32 v203, v54, v55
  v_lshlrev_b32 v56, 16, v204
  v_and_b32 v57, s44, v204
  v_lshlrev_b32 v58, 16, v205
  v_and_b32 v59, s44, v205
  v_lshlrev_b32 v60, 16, v206
  v_and_b32 v61, s44, v206
  v_lshlrev_b32 v62, 16, v207
  v_and_b32 v63, s44, v207
  v_pk_mul_f32 v[56:57], v[56:57], s[46:47]
  v_pk_mul_f32 v[58:59], v[58:59], s[46:47]
  v_pk_mul_f32 v[60:61], v[60:61], s[46:47]
  v_pk_mul_f32 v[62:63], v[62:63], s[46:47]
  v_cvt_pk_bf16_f32 v204, v56, v57
  v_cvt_pk_bf16_f32 v205, v58, v59
  v_cvt_pk_bf16_f32 v206, v60, v61
  v_cvt_pk_bf16_f32 v207, v62, v63
  s_waitcnt vmcnt(13)
  s_barrier
  ds_read_b64_tr_b16 v[208:209], v12 offset:24576
  ds_read_b64_tr_b16 v[210:211], v12 offset:25088
  ds_read_b64_tr_b16 v[212:213], v13 offset:24576
  ds_read_b64_tr_b16 v[214:215], v13 offset:25088
  ds_read_b64_tr_b16 v[216:217], v14 offset:24576
  ds_read_b64_tr_b16 v[218:219], v14 offset:25088
  ds_read_b64_tr_b16 v[220:221], v12 offset:36864
  ds_read_b64_tr_b16 v[222:223], v12 offset:37376
  ds_read_b64_tr_b16 v[224:225], v13 offset:36864
  ds_read_b64_tr_b16 v[226:227], v13 offset:37376
  ds_read_b64_tr_b16 v[228:229], v14 offset:36864
  ds_read_b64_tr_b16 v[230:231], v14 offset:37376
  s_waitcnt lgkmcnt(10)
  v_lshlrev_b32 v40, 16, v208
  v_and_b32 v41, s44, v208
  v_lshlrev_b32 v42, 16, v209
  v_and_b32 v43, s44, v209
  v_lshlrev_b32 v44, 16, v210
  v_and_b32 v45, s44, v210
  v_lshlrev_b32 v46, 16, v211
  v_and_b32 v47, s44, v211
  v_pk_mul_f32 v[40:41], v[40:41], s[46:47]
  v_pk_mul_f32 v[42:43], v[42:43], s[46:47]
  v_pk_mul_f32 v[44:45], v[44:45], s[46:47]
  v_pk_mul_f32 v[46:47], v[46:47], s[46:47]
  v_cvt_pk_bf16_f32 v208, v40, v41
  v_cvt_pk_bf16_f32 v209, v42, v43
  v_cvt_pk_bf16_f32 v210, v44, v45
L_hop0:
  s_cbranch_execz L_hopped
  s_waitcnt lgkmcnt(0)
  v_cvt_pk_bf16_f32 v211, v46, v47
  v_lshlrev_b32 v48, 16, v212
  v_and_b32 v49, s44, v212
  v_lshlrev_b32 v50, 16, v213
  v_and_b32 v51, s44, v213
  v_lshlrev_b32 v52, 16, v214
  v_and_b32 v53, s44, v214
  v_lshlrev_b32 v54, 16, v215
  v_and_b32 v55, s44, v215
  v_pk_mul_f32 v[48:49], v[48:49], s[46:47]
  v_pk_mul_f32 v[50:51], v[50:51], s[46:47]
  v_pk_mul_f32 v[52:53], v[52:53], s[46:47]
  v_pk_mul_f32 v[54:55], v[54:55], s[46:47]
  v_cvt_pk_bf16_f32 v212, v48, v49
  v_cvt_pk_bf16_f32 v213, v50, v51
  v_cvt_pk_bf16_f32 v214, v52, v53
  v_cvt_pk_bf16_f32 v215, v54, v55
  v_lshlrev_b32 v56, 16, v216
  v_and_b32 v57, s44, v216
  v_lshlrev_b32 v58, 16, v217
  v_and_b32 v59, s44, v217
  v_lshlrev_b32 v60, 16, v218
  v_and_b32 v61, s44, v218
  v_lshlrev_b32 v62, 16, v219
  v_and_b32 v63, s44, v219
  v_pk_mul_f32 v[56:57], v[56:57], s[46:47]
  v_pk_mul_f32 v[58:59], v[58:59], s[46:47]
  v_pk_mul_f32 v[60:61], v[60:61], s[46:47]
  v_pk_mul_f32 v[62:63], v[62:63], s[46:47]
  v_cvt_pk_bf16_f32 v216, v56, v57
  v_cvt_pk_bf16_f32 v217, v58, v59
  v_cvt_pk_bf16_f32 v218, v60, v61
  v_cvt_pk_bf16_f32 v219, v62, v63
  v_lshlrev_b32 v40, 16, v220
  v_and_b32 v41, s44, v220
  v_lshlrev_b32 v42, 16, v221
  v_and_b32 v43, s44, v221
  v_lshlrev_b32 v44, 16, v222
  v_and_b32 v45, s44, v222
  v_lshlrev_b32 v46, 16, v223
  v_and_b32 v47, s44, v223
  v_pk_mul_f32 v[40:41], v[40:41], s[46:47]
  v_pk_mul_f32 v[42:43], v[42:43], s[46:47]
  v_pk_mul_f32 v[44:45], v[44:45], s[46:47]
  v_pk_mul_f32 v[46:47], v[46:47], s[46:47]
  v_cvt_pk_bf16_f32 v220, v40, v41
  v_cvt_pk_bf16_f32 v221, v42, v43
  v_cvt_pk_bf16_f32 v222, v44, v45
  v_cvt_pk_bf16_f32 v223, v46, v47
  v_lshlrev_b32 v48, 16, v224
  v_and_b32 v49, s44, v224
  v_lshlrev_b32 v50, 16, v225
  v_and_b32 v51, s44, v225
  v_lshlrev_b32 v52, 16, v226
  v_and_b32 v53, s44, v226
  v_lshlrev_b32 v54, 16, v227
  v_and_b32 v55, s44, v227
  v_pk_mul_f32 v[48:49], v[48:49], s[46:47]
  v_pk_mul_f32 v[50:51], v[50:51], s[46:47]
  v_pk_mul_f32 v[52:53], v[52:53], s[46:47]
  v_pk_mul_f32 v[54:55], v[54:55], s[46:47]
  v_cvt_pk_bf16_f32 v224, v48, v49
  v_cvt_pk_bf16_f32 v225, v50, v51
  v_cvt_pk_bf16_f32 v226, v52, v53
  v_cvt_pk_bf16_f32 v227, v54, v55
  v_lshlrev_b32 v56, 16, v228
  v_and_b32 v57, s44, v228
  v_lshlrev_b32 v58, 16, v229
  v_and_b32 v59, s44, v229
  v_lshlrev_b32 v60, 16, v230
  v_and_b32 v61, s44, v230
  v_lshlrev_b32 v62, 16, v231
  v_and_b32 v63, s44, v231
  s_add_u32 m0, s63, 73728
  s_add_u32 s36, s62, 384
  buffer_load_dwordx4 v136, s[12:15], s36 offen offset:0 lds
  v_pk_mul_f32 v[56:57], v[56:57], s[46:47]
  v_pk_mul_f32 v[58:59], v[58:59], s[46:47]
  v_pk_mul_f32 v[60:61], v[60:61], s[46:47]
  v_pk_mul_f32 v[62:63], v[62:63], s[46:47]
  v_cvt_pk_bf16_f32 v228, v56, v57
  v_cvt_pk_bf16_f32 v229, v58, v59
  v_cvt_pk_bf16_f32 v230, v60, v61
  v_cvt_pk_bf16_f32 v231, v62, v63
  s_waitcnt vmcnt(8)
  s_barrier
  ds_read_b64_tr_b16 v[232:233], v12 offset:49152
  ds_read_b64_tr_b16 v[234:235], v12 offset:49664
  ds_read_b64_tr_b16 v[236:237], v13 offset:49152
  ds_read_b64_tr_b16 v[238:239], v13 offset:49664
  ds_read_b64_tr_b16 v[240:241], v14 offset:49152
  ds_read_b64_tr_b16 v[242:243], v14 offset:49664
  ds_read_b64_tr_b16 v[244:245], v12 offset:61440
  ds_read_b64_tr_b16 v[246:247], v12 offset:61952
  ds_read_b64_tr_b16 v[248:249], v13 offset:61440
  ds_read_b64_tr_b16 v[250:251], v13 offset:61952
  buffer_load_dwordx4 v137, s[12:15], s36 offen offset:1024 lds
  ds_read_b64_tr_b16 v[252:253], v14 offset:61440
  ds_read_b64_tr_b16 v[254:255], v14 offset:61952
  s_waitcnt lgkmcnt(10)
  v_lshlrev_b32 v40, 16, v232
  v_and_b32 v41, s44, v232
  v_lshlrev_b32 v42, 16, v233
  v_and_b32 v43, s44, v233
  v_lshlrev_b32 v44, 16, v234
  v_and_b32 v45, s44, v234
  v_lshlrev_b32 v46, 16, v235
  v_and_b32 v47, s44, v235
  v_pk_mul_f32 v[40:41], v[40:41], s[46:47]
  v_pk_mul_f32 v[42:43], v[42:43], s[46:47]
  v_pk_mul_f32 v[44:45], v[44:45], s[46:47]
  v_pk_mul_f32 v[46:47], v[46:47], s[46:47]
  v_cvt_pk_bf16_f32 v232, v40, v41
  v_cvt_pk_bf16_f32 v233, v42, v43
  v_cvt_pk_bf16_f32 v234, v44, v45
  s_waitcnt lgkmcnt(0)
  v_cvt_pk_bf16_f32 v235, v46, v47
  buffer_load_dwordx4 v138, s[12:15], s36 offen offset:2048 lds
  v_lshlrev_b32 v48, 16, v236
  v_and_b32 v49, s44, v236
  v_lshlrev_b32 v50, 16, v237
  v_and_b32 v51, s44, v237
  v_lshlrev_b32 v52, 16, v238
  v_and_b32 v53, s44, v238
  v_lshlrev_b32 v54, 16, v239
  v_and_b32 v55, s44, v239
  v_pk_mul_f32 v[48:49], v[48:49], s[46:47]
  v_pk_mul_f32 v[50:51], v[50:51], s[46:47]
  v_pk_mul_f32 v[52:53], v[52:53], s[46:47]
  v_pk_mul_f32 v[54:55], v[54:55], s[46:47]
  v_cvt_pk_bf16_f32 v236, v48, v49
  v_cvt_pk_bf16_f32 v237, v50, v51
  v_cvt_pk_bf16_f32 v238, v52, v53
  v_cvt_pk_bf16_f32 v239, v54, v55
  v_lshlrev_b32 v56, 16, v240
  v_and_b32 v57, s44, v240
  v_lshlrev_b32 v58, 16, v241
  v_and_b32 v59, s44, v241
  s_add_u32 m0, s63, 86016
  s_add_u32 s36, s62, 37248
  buffer_load_dwordx4 v136, s[12:15], s36 offen offset:0 lds
  v_lshlrev_b32 v60, 16, v242
  v_and_b32 v61, s44, v242
  v_lshlrev_b32 v62, 16, v243
  v_and_b32 v63, s44, v243
  v_pk_mul_f32 v[56:57], v[56:57], s[46:47]
  v_pk_mul_f32 v[58:59], v[58:59], s[46:47]
  v_pk_mul_f32 v[60:61], v[60:61], s[46:47]
  v_pk_mul_f32 v[62:63], v[62:63], s[46:47]
  v_cvt_pk_bf16_f32 v240, v56, v57
  v_cvt_pk_bf16_f32 v241, v58, v59
  v_cvt_pk_bf16_f32 v242, v60, v61
  v_cvt_pk_bf16_f32 v243, v62, v63
  v_lshlrev_b32 v40, 16, v244
  v_and_b32 v41, s44, v244
  v_lshlrev_b32 v42, 16, v245
  v_and_b32 v43, s44, v245
  v_lshlrev_b32 v44, 16, v246
  v_and_b32 v45, s44, v246
  v_lshlrev_b32 v46, 16, v247
  v_and_b32 v47, s44, v247
  buffer_load_dwordx4 v137, s[12:15], s36 offen offset:1024 lds
  v_pk_mul_f32 v[40:41], v[40:41], s[46:47]
  v_pk_mul_f32 v[42:43], v[42:43], s[46:47]
  v_pk_mul_f32 v[44:45], v[44:45], s[46:47]
  v_pk_mul_f32 v[46:47], v[46:47], s[46:47]
  v_cvt_pk_bf16_f32 v244, v40, v41
  v_cvt_pk_bf16_f32 v245, v42, v43
  v_cvt_pk_bf16_f32 v246, v44, v45
  v_cvt_pk_bf16_f32 v247, v46, v47
  v_lshlrev_b32 v48, 16, v248
  v_and_b32 v49, s44, v248
  v_lshlrev_b32 v50, 16, v249
  v_and_b32 v51, s44, v249
  v_lshlrev_b32 v52, 16, v250
  v_and_b32 v53, s44, v250
  v_lshlrev_b32 v54, 16, v251
  v_and_b32 v55, s44, v251
  v_pk_mul_f32 v[48:49], v[48:49], s[46:47]
  v_pk_mul_f32 v[50:51], v[50:51], s[46:47]
  v_pk_mul_f32 v[52:53], v[52:53], s[46:47]
  v_pk_mul_f32 v[54:55], v[54:55], s[46:47]
  buffer_load_dwordx4 v138, s[12:15], s36 offen offset:2048 lds
  v_cvt_pk_bf16_f32 v248, v48, v49
  v_cvt_pk_bf16_f32 v249, v50, v51
  v_cvt_pk_bf16_f32 v250, v52, v53
  v_cvt_pk_bf16_f32 v251, v54, v55
  v_lshlrev_b32 v56, 16, v252
  v_and_b32 v57, s44, v252
  v_lshlrev_b32 v58, 16, v253
  v_and_b32 v59, s44, v253
  v_lshlrev_b32 v60, 16, v254
  v_and_b32 v61, s44, v254
  v_lshlrev_b32 v62, 16, v255
  v_and_b32 v63, s44, v255
  v_pk_mul_f32 v[56:57], v[56:57], s[46:47]
  v_pk_mul_f32 v[58:59], v[58:59], s[46:47]
  v_pk_mul_f32 v[60:61], v[60:61], s[46:47]
  v_pk_mul_f32 v[62:63], v[62:63], s[46:47]
  v_cvt_pk_bf16_f32 v252, v56, v57
  v_cvt_pk_bf16_f32 v253, v58, v59
  v_cvt_pk_bf16_f32 v254, v60, v61
  v_cvt_pk_bf16_f32 v255, v62, v63
  s_lshl3_add_u32 s48, s29, s4
  s_add_u32 s48, s48, 4
  s_mul_i32 s48, s48, 196608
  s_add_u32 s49, s48, 786432
  s_add_u32 s50, s48, 100663296
  s_mov_b32 s10, 95158272
  s_waitcnt vmcnt(10)
  s_barrier
  ds_read_b128 a[144:147], v0 offset:0
  ds_read_b128 a[148:151], v1 offset:0
  ds_read_b128 a[152:155], v0 offset:8192
  ds_read_b128 a[156:159], v1 offset:8192
  ds_read_b128 a[160:163], v0 offset:16384
  ds_read_b128 a[164:167], v1 offset:16384
  s_waitcnt lgkmcnt(4)
  v_mfma_f32_16x16x32_bf16 v[164:167], v[184:187], a[144:147], 0
  v_mfma_f32_16x16x32_bf16 v[164:167], v[196:199], a[148:151], v[164:167]
  s_waitcnt lgkmcnt(0)
  v_mfma_f32_16x16x32_bf16 v[164:167], v[208:211], a[152:155], v[164:167]
  s_add_u32 m0, s63, 98304
  s_add_u32 s36, s62, 74112
  v_mfma_f32_16x16x32_bf16 v[164:167], v[220:223], a[156:159], v[164:167]
  buffer_load_dwordx4 v136, s[12:15], s36 offen offset:0 lds
  v_mfma_f32_16x16x32_bf16 v[164:167], v[232:235], a[160:163], v[164:167]
  v_fma_f32 v88, v88, s45, v150
  v_fma_f32 v89, v89, s45, v150
  v_mfma_f32_16x16x32_bf16 v[164:167], v[244:247], a[164:167], v[164:167]
  ds_read_b128 a[168:171], v0 offset:2048
  ds_read_b128 a[172:175], v1 offset:2048
  v_mfma_f32_16x16x32_bf16 v[172:175], v[248:251], a[164:167], 0
  ds_read_b128 a[176:179], v0 offset:10240
  ds_read_b128 a[180:183], v1 offset:10240
  v_mfma_f32_16x16x32_bf16 v[172:175], v[236:239], a[160:163], v[172:175]
  ds_read_b128 a[184:187], v0 offset:18432
  ds_read_b128 a[188:191], v1 offset:18432
  v_mfma_f32_16x16x32_bf16 v[172:175], v[224:227], a[156:159], v[172:175]
  v_cvt_pk_bf16_f32 v40, v164, v165
  v_cvt_pk_bf16_f32 v41, v166, v167
  v_mfma_f32_16x16x32_bf16 v[172:175], v[212:215], a[152:155], v[172:175]
  buffer_load_dwordx4 v137, s[12:15], s36 offen offset:1024 lds
  v_mfma_f32_16x16x32_bf16 v[172:175], v[200:203], a[148:151], v[172:175]
  buffer_load_dwordx4 v138, s[12:15], s36 offen offset:2048 lds
  v_mfma_f32_16x16x32_bf16 v[172:175], v[188:191], a[144:147], v[172:175]
  v_fma_f32 v90, v90, s45, v150
  v_fma_f32 v91, v91, s45, v150
  v_mfma_f32_16x16x32_bf16 v[164:167], v[192:195], a[144:147], 0
  s_add_u32 m0, s63, 110592
  s_add_u32 s36, s62, 110976
  v_mfma_f32_16x16x32_bf16 v[164:167], v[204:207], a[148:151], v[164:167]
  buffer_load_dwordx4 v136, s[12:15], s36 offen offset:0 lds
  v_mfma_f32_16x16x32_bf16 v[164:167], v[216:219], a[152:155], v[164:167]
  v_cvt_pk_bf16_f32 v42, v172, v173
  v_cvt_pk_bf16_f32 v43, v174, v175
  v_mfma_f32_16x16x32_bf16 v[164:167], v[228:231], a[156:159], v[164:167]
  v_fma_f32 v92, v92, s45, v150
  v_fma_f32 v93, v93, s45, v150
  v_mfma_f32_16x16x32_bf16 v[164:167], v[240:243], a[160:163], v[164:167]
  v_fma_f32 v94, v94, s45, v150
  v_fma_f32 v95, v95, s45, v150
  v_mfma_f32_16x16x32_bf16 v[164:167], v[252:255], a[164:167], v[164:167]
  s_waitcnt lgkmcnt(0)
  v_fma_f32 v96, v96, s45, v150
  v_mfma_f32_16x16x32_bf16 v[172:175], v[184:187], a[168:171], 0
  buffer_load_dwordx4 v137, s[12:15], s36 offen offset:1024 lds
  v_mfma_f32_16x16x32_bf16 v[172:175], v[196:199], a[172:175], v[172:175]
  s_waitcnt vmcnt(12)
  s_barrier
  v_mfma_f32_16x16x32_bf16 v[172:175], v[208:211], a[176:179], v[172:175]
  v_cvt_pk_bf16_f32 v44, v164, v165
  v_cvt_pk_bf16_f32 v45, v166, v167
  v_mfma_f32_16x16x32_bf16 v[172:175], v[220:223], a[180:183], v[172:175]
  ds_read_b128 a[192:195], v0 offset:4096
  ds_read_b128 a[196:199], v1 offset:4096
  v_mfma_f32_16x16x32_bf16 v[172:175], v[232:235], a[184:187], v[172:175]
  ds_read_b128 a[200:203], v0 offset:12288
  ds_read_b128 a[204:207], v1 offset:12288
  v_mfma_f32_16x16x32_bf16 v[172:175], v[244:247], a[188:191], v[172:175]
  ds_read_b128 a[208:211], v0 offset:20480
  ds_read_b128 a[212:215], v1 offset:20480
  v_mfma_f32_16x16x32_bf16 v[164:167], v[248:251], a[188:191], 0
  buffer_load_dwordx4 v138, s[12:15], s36 offen offset:2048 lds
  v_mfma_f32_16x16x32_bf16 v[164:167], v[236:239], a[184:187], v[164:167]
  s_add_u32 m0, s63, 0
  s_add_u32 s36, s62, 147840
  v_mfma_f32_16x16x32_bf16 v[164:167], v[224:227], a[180:183], v[164:167]
  v_cvt_pk_bf16_f32 v52, v172, v173
  v_cvt_pk_bf16_f32 v53, v174, v175
  v_mfma_f32_16x16x32_bf16 v[164:167], v[212:215], a[176:179], v[164:167]
  buffer_load_dwordx4 v136, s[12:15], s36 offen offset:0 lds
  v_mfma_f32_16x16x32_bf16 v[164:167], v[200:203], a[172:175], v[164:167]
  v_fma_f32 v97, v97, s45, v150
  v_fma_f32 v98, v98, s45, v150
  v_mfma_f32_16x16x32_bf16 v[164:167], v[188:191], a[168:171], v[164:167]
  v_fma_f32 v99, v99, s45, v150
  v_fma_f32 v100, v100, s45, v150
  v_mfma_f32_16x16x32_bf16 v[172:175], v[192:195], a[168:171], 0
  buffer_load_dwordx4 v137, s[12:15], s36 offen offset:1024 lds
  v_mfma_f32_16x16x32_bf16 v[172:175], v[204:207], a[172:175], v[172:175]
  v_fma_f32 v101, v101, s45, v150
  v_fma_f32 v102, v102, s45, v150
  v_mfma_f32_16x16x32_bf16 v[172:175], v[216:219], a[176:179], v[172:175]
  v_cvt_pk_bf16_f32 v54, v164, v165
  v_cvt_pk_bf16_f32 v55, v166, v167
  v_mfma_f32_16x16x32_bf16 v[172:175], v[228:231], a[180:183], v[172:175]
  v_fma_f32 v103, v103, s45, v150
  v_fma_f32 v104, v104, s45, v150
  v_mfma_f32_16x16x32_bf16 v[172:175], v[240:243], a[184:187], v[172:175]
  buffer_load_dwordx4 v138, s[12:15], s36 offen offset:2048 lds
  v_mfma_f32_16x16x32_bf16 v[172:175], v[252:255], a[188:191], v[172:175]
  s_waitcnt lgkmcnt(0)
  v_fma_f32 v105, v105, s45, v150
  v_mfma_f32_16x16x32_bf16 v[164:167], v[184:187], a[192:195], 0
  v_fma_f32 v106, v106, s45, v150
  v_fma_f32 v107, v107, s45, v150
  v_mfma_f32_16x16x32_bf16 v[164:167], v[196:199], a[196:199], v[164:167]
  v_fma_f32 v108, v108, s45, v150
  v_fma_f32 v109, v109, s45, v150
  v_mfma_f32_16x16x32_bf16 v[164:167], v[208:211], a[200:203], v[164:167]
  v_cvt_pk_bf16_f32 v56, v172, v173
  v_cvt_pk_bf16_f32 v57, v174, v175
  v_mfma_f32_16x16x32_bf16 v[164:167], v[220:223], a[204:207], v[164:167]
  ds_read_b128 a[216:219], v0 offset:6144
  ds_read_b128 a[220:223], v1 offset:6144
  v_mfma_f32_16x16x32_bf16 v[164:167], v[232:235], a[208:211], v[164:167]
  ds_read_b128 a[224:227], v0 offset:14336
  ds_read_b128 a[244:247], v1 offset:14336
  v_mfma_f32_16x16x32_bf16 v[164:167], v[244:247], a[212:215], v[164:167]
  ds_read_b128 a[248:251], v0 offset:22528
  ds_read_b128 a[252:255], v1 offset:22528
  v_mfma_f32_16x16x32_bf16 v[172:175], v[248:251], a[212:215], 0
  s_add_u32 m0, s63, 12288
  s_add_u32 s36, s62, 184704
  v_mfma_f32_16x16x32_bf16 v[172:175], v[236:239], a[208:211], v[172:175]
  buffer_load_dwordx4 v136, s[12:15], s36 offen offset:0 lds
  v_mfma_f32_16x16x32_bf16 v[172:175], v[224:227], a[204:207], v[172:175]
  v_cvt_pk_bf16_f32 v64, v164, v165
  v_cvt_pk_bf16_f32 v65, v166, v167
  v_mfma_f32_16x16x32_bf16 v[172:175], v[212:215], a[200:203], v[172:175]
  s_waitcnt vmcnt(10)
  s_barrier
  v_mfma_f32_16x16x32_bf16 v[172:175], v[200:203], a[196:199], v[172:175]
  buffer_load_dwordx4 v137, s[12:15], s36 offen offset:1024 lds
  v_mfma_f32_16x16x32_bf16 v[172:175], v[188:191], a[192:195], v[172:175]
  buffer_load_dwordx4 v138, s[12:15], s36 offen offset:2048 lds
  v_mfma_f32_16x16x32_bf16 v[164:167], v[192:195], a[192:195], 0
  ds_read_b64_tr_b16 a[0:1], v15 offset:0
  ds_read_b64_tr_b16 a[2:3], v15 offset:512
  v_mfma_f32_16x16x32_bf16 v[164:167], v[204:207], a[196:199], v[164:167]
  s_add_u32 m0, s63, 24576
  s_add_u32 s36, s62, 768
  v_mfma_f32_16x16x32_bf16 v[164:167], v[216:219], a[200:203], v[164:167]
  v_cvt_pk_bf16_f32 v66, v172, v173
  v_cvt_pk_bf16_f32 v67, v174, v175
  v_mfma_f32_16x16x32_bf16 v[164:167], v[228:231], a[204:207], v[164:167]
  buffer_load_dwordx4 v136, s[12:15], s36 offen offset:0 lds
  v_mfma_f32_16x16x32_bf16 v[164:167], v[240:243], a[208:211], v[164:167]
  ds_read_b64_tr_b16 a[4:5], v9 offset:0
  ds_read_b64_tr_b16 a[6:7], v9 offset:512
  v_mfma_f32_16x16x32_bf16 v[164:167], v[252:255], a[212:215], v[164:167]
  s_waitcnt lgkmcnt(4)
  ds_read_b64_tr_b16 a[8:9], v11 offset:0
  v_mfma_f32_16x16x32_bf16 v[172:175], v[184:187], a[216:219], 0
  ds_read_b64_tr_b16 a[10:11], v11 offset:512
  ds_read_b64_tr_b16 a[12:13], v15 offset:12288
  v_mfma_f32_16x16x32_bf16 v[172:175], v[196:199], a[220:223], v[172:175]
  buffer_load_dwordx4 v137, s[12:15], s36 offen offset:1024 lds
  v_mfma_f32_16x16x32_bf16 v[172:175], v[208:211], a[224:227], v[172:175]
  v_cvt_pk_bf16_f32 v68, v164, v165
  v_cvt_pk_bf16_f32 v69, v166, v167
  v_mfma_f32_16x16x32_bf16 v[172:175], v[220:223], a[244:247], v[172:175]
  ds_read_b64_tr_b16 a[14:15], v15 offset:12800
  ds_read_b64_tr_b16 a[16:17], v9 offset:12288
  v_mfma_f32_16x16x32_bf16 v[172:175], v[232:235], a[248:251], v[172:175]
  ds_read_b64_tr_b16 a[18:19], v9 offset:12800
  ds_read_b64_tr_b16 a[20:21], v11 offset:12288
  v_mfma_f32_16x16x32_bf16 v[172:175], v[244:247], a[252:255], v[172:175]
  buffer_load_dwordx4 v138, s[12:15], s36 offen offset:2048 lds
  v_mfma_f32_16x16x32_bf16 v[164:167], v[248:251], a[252:255], 0
  ds_read_b64_tr_b16 a[22:23], v11 offset:12800
  v_fma_f32 v110, v110, s45, v150
  v_mfma_f32_16x16x32_bf16 v[164:167], v[236:239], a[248:251], v[164:167]
  v_fma_f32 v111, v111, s45, v150
  v_fma_f32 v112, v112, s45, v150
  v_mfma_f32_16x16x32_bf16 v[164:167], v[224:227], a[244:247], v[164:167]
  v_cvt_pk_bf16_f32 v70, v172, v173
  v_cvt_pk_bf16_f32 v71, v174, v175
  v_mfma_f32_16x16x32_bf16 v[164:167], v[212:215], a[224:227], v[164:167]
  s_add_u32 m0, s63, 36864
  s_add_u32 s36, s62, 37632
  v_mfma_f32_16x16x32_bf16 v[164:167], v[200:203], a[220:223], v[164:167]
  buffer_load_dwordx4 v136, s[12:15], s36 offen offset:0 lds
  v_mfma_f32_16x16x32_bf16 v[164:167], v[188:191], a[216:219], v[164:167]
  v_fma_f32 v113, v113, s45, v150
  v_fma_f32 v114, v114, s45, v150
  v_mfma_f32_16x16x32_bf16 v[172:175], v[192:195], a[216:219], 0
  v_fma_f32 v115, v115, s45, v150
  v_add_f32 v156, v151, v112
  v_mfma_f32_16x16x32_bf16 v[172:175], v[204:207], a[220:223], v[172:175]
  v_add_f32 v157, v151, v113
  v_add_f32 v158, v151, v114
  v_mfma_f32_16x16x32_bf16 v[172:175], v[216:219], a[224:227], v[172:175]
  v_cvt_pk_bf16_f32 v72, v164, v165
  v_cvt_pk_bf16_f32 v73, v166, v167
  v_mfma_f32_16x16x32_bf16 v[172:175], v[228:231], a[244:247], v[172:175]
  buffer_load_dwordx4 v137, s[12:15], s36 offen offset:1024 lds
  v_mfma_f32_16x16x32_bf16 v[172:175], v[240:243], a[248:251], v[172:175]
  s_waitcnt lgkmcnt(0)
  s_waitcnt vmcnt(11)
  s_barrier
  v_mfma_f32_16x16x32_bf16 v[172:175], v[252:255], a[252:255], v[172:175]
  ds_read_b64_tr_b16 a[24:25], v15 offset:24576
  v_mfma_f32_16x16x32_bf16 v[116:119], a[0:3], a[144:147], 0
  buffer_load_dwordx4 v138, s[12:15], s36 offen offset:2048 lds
  v_mfma_f32_16x16x32_bf16 v[116:119], a[12:15], a[148:151], v[116:119]
  ds_read_b64_tr_b16 a[26:27], v15 offset:25088
  ds_read_b64_tr_b16 a[28:29], v9 offset:24576
  v_mfma_f32_16x16x32_bf16 v[124:127], a[16:19], a[148:151], 0
  v_cvt_pk_bf16_f32 v74, v172, v173
  v_cvt_pk_bf16_f32 v75, v174, v175
  v_mfma_f32_16x16x32_bf16 v[124:127], a[4:7], a[144:147], v[124:127]
  s_add_u32 m0, s63, 49152
  s_add_u32 s36, s62, 74496
  v_mfma_f32_16x16x32_bf16 v[120:123], a[8:11], a[144:147], 0
  buffer_load_dwordx4 v136, s[12:15], s36 offen offset:0 lds
  v_mfma_f32_16x16x32_bf16 v[120:123], a[20:23], a[148:151], v[120:123]
  ds_read_b64_tr_b16 a[30:31], v9 offset:25088
  ds_read_b64_tr_b16 a[32:33], v11 offset:24576
  v_mfma_f32_16x16x32_bf16 v[128:131], a[0:3], a[168:171], 0
  ds_read_b64_tr_b16 a[34:35], v11 offset:25088
  ds_read_b64_tr_b16 a[36:37], v15 offset:36864
  v_mfma_f32_16x16x32_bf16 v[128:131], a[12:15], a[172:175], v[128:131]
  ds_read_b64_tr_b16 a[38:39], v15 offset:37376
  ds_read_b64_tr_b16 a[40:41], v9 offset:36864
  v_mfma_f32_16x16x32_bf16 v[132:135], a[16:19], a[172:175], 0
  buffer_load_dwordx4 v137, s[12:15], s36 offen offset:1024 lds
  v_mfma_f32_16x16x32_bf16 v[132:135], a[4:7], a[168:171], v[132:135]
  ds_read_b64_tr_b16 a[42:43], v9 offset:37376
  ds_read_b64_tr_b16 a[44:45], v11 offset:36864
  v_mfma_f32_16x16x32_bf16 v[140:143], a[8:11], a[168:171], 0
  ds_read_b64_tr_b16 a[46:47], v11 offset:37376
  v_add_f32 v159, v151, v115
  v_mfma_f32_16x16x32_bf16 v[140:143], a[20:23], a[172:175], v[140:143]
  v_add_f32 v160, v151, v108
  v_add_f32 v161, v151, v109
  v_mfma_f32_16x16x32_bf16 v[16:19], a[0:3], a[192:195], 0
  v_add_f32 v162, v151, v110
  v_add_f32 v163, v151, v111
  v_mfma_f32_16x16x32_bf16 v[16:19], a[12:15], a[196:199], v[16:19]
  buffer_load_dwordx4 v138, s[12:15], s36 offen offset:2048 lds
  v_mfma_f32_16x16x32_bf16 v[20:23], a[16:19], a[196:199], 0
  v_add_f32 v180, v151, v104
  v_add_f32 v181, v151, v105
  v_mfma_f32_16x16x32_bf16 v[20:23], a[4:7], a[192:195], v[20:23]
  v_add_f32 v182, v151, v106
  v_add_f32 v183, v151, v107
  v_mfma_f32_16x16x32_bf16 v[24:27], a[8:11], a[192:195], 0
  s_add_u32 m0, s63, 61440
  s_add_u32 s36, s62, 111360
  v_mfma_f32_16x16x32_bf16 v[24:27], a[20:23], a[196:199], v[24:27]
  buffer_load_dwordx4 v136, s[12:15], s36 offen offset:0 lds
  v_mfma_f32_16x16x32_bf16 v[28:31], a[0:3], a[216:219], 0
  v_add_f32 v152, v151, v96
  v_add_f32 v153, v151, v97
  v_mfma_f32_16x16x32_bf16 v[28:31], a[12:15], a[220:223], v[28:31]
  v_add_f32 v154, v151, v98
  v_add_f32 v155, v151, v99
  v_mfma_f32_16x16x32_bf16 v[32:35], a[16:19], a[220:223], 0
  v_add_f32 v168, v151, v92
  v_add_f32 v169, v151, v93
  v_mfma_f32_16x16x32_bf16 v[32:35], a[4:7], a[216:219], v[32:35]
  buffer_load_dwordx4 v137, s[12:15], s36 offen offset:1024 lds
  v_mfma_f32_16x16x32_bf16 v[36:39], a[8:11], a[216:219], 0
  v_add_f32 v170, v151, v94
  v_add_f32 v171, v151, v95
  v_mfma_f32_16x16x32_bf16 v[36:39], a[20:23], a[220:223], v[36:39]
  s_waitcnt lgkmcnt(0)
  v_add_f32 v176, v151, v88
  v_mfma_f32_16x16x32_bf16 v[116:119], a[24:27], a[152:155], v[116:119]
  s_waitcnt vmcnt(11)
  s_barrier
  v_mfma_f32_16x16x32_bf16 v[116:119], a[36:39], a[156:159], v[116:119]
  buffer_load_dwordx4 v138, s[12:15], s36 offen offset:2048 lds
  v_mfma_f32_16x16x32_bf16 v[124:127], a[40:43], a[156:159], v[124:127]
  ds_read_b64_tr_b16 a[48:49], v12 offset:0
  ds_read_b64_tr_b16 a[50:51], v12 offset:512
  v_mfma_f32_16x16x32_bf16 v[124:127], a[28:31], a[152:155], v[124:127]
  ds_read_b64_tr_b16 a[52:53], v13 offset:0
  ds_read_b64_tr_b16 a[54:55], v13 offset:512
  v_mfma_f32_16x16x32_bf16 v[120:123], a[32:35], a[152:155], v[120:123]
  s_add_u32 m0, s63, 73728
  s_add_u32 s36, s62, 148224
  v_mfma_f32_16x16x32_bf16 v[120:123], a[44:47], a[156:159], v[120:123]
  buffer_load_dwordx4 v136, s[12:15], s36 offen offset:0 lds
  v_mfma_f32_16x16x32_bf16 v[128:131], a[24:27], a[176:179], v[128:131]
  ds_read_b64_tr_b16 a[56:57], v14 offset:0
  ds_read_b64_tr_b16 a[58:59], v14 offset:512
  v_mfma_f32_16x16x32_bf16 v[128:131], a[36:39], a[180:183], v[128:131]
  ds_read_b64_tr_b16 a[60:61], v12 offset:12288
  ds_read_b64_tr_b16 a[62:63], v12 offset:12800
  v_mfma_f32_16x16x32_bf16 v[132:135], a[40:43], a[180:183], v[132:135]
  ds_read_b64_tr_b16 a[64:65], v13 offset:12288
  ds_read_b64_tr_b16 a[66:67], v13 offset:12800
  v_mfma_f32_16x16x32_bf16 v[132:135], a[28:31], a[176:179], v[132:135]
  ds_read_b64_tr_b16 a[68:69], v14 offset:12288
  ds_read_b64_tr_b16 a[70:71], v14 offset:12800
  v_mfma_f32_16x16x32_bf16 v[140:143], a[32:35], a[176:179], v[140:143]
  buffer_load_dwordx4 v137, s[12:15], s36 offen offset:1024 lds
  v_mfma_f32_16x16x32_bf16 v[140:143], a[44:47], a[180:183], v[140:143]
  v_add_f32 v177, v151, v89
  v_add_f32 v178, v151, v90
  v_mfma_f32_16x16x32_bf16 v[16:19], a[24:27], a[200:203], v[16:19]
  v_add_f32 v179, v151, v91
  v_mfma_f32_16x16x32_bf16 v[16:19], a[36:39], a[204:207], v[16:19]
  v_mfma_f32_16x16x32_bf16 v[20:23], a[40:43], a[204:207], v[20:23]
  buffer_load_dwordx4 v138, s[12:15], s36 offen offset:2048 lds
  v_mfma_f32_16x16x32_bf16 v[20:23], a[28:31], a[200:203], v[20:23]
  v_mfma_f32_16x16x32_bf16 v[24:27], a[32:35], a[200:203], v[24:27]
  v_mfma_f32_16x16x32_bf16 v[24:27], a[44:47], a[204:207], v[24:27]
  s_add_u32 m0, s63, 86016
  s_add_u32 s36, s62, 185088
  v_mfma_f32_16x16x32_bf16 v[28:31], a[24:27], a[224:227], v[28:31]
  buffer_load_dwordx4 v136, s[12:15], s36 offen offset:0 lds
  v_mfma_f32_16x16x32_bf16 v[28:31], a[36:39], a[244:247], v[28:31]
  v_mfma_f32_16x16x32_bf16 v[32:35], a[40:43], a[244:247], v[32:35]
  s_waitcnt lgkmcnt(0)
  s_waitcnt vmcnt(10)
  s_barrier
  v_mfma_f32_16x16x32_bf16 v[32:35], a[28:31], a[224:227], v[32:35]
  ds_read_b64_tr_b16 a[72:73], v12 offset:24576
  ds_read_b64_tr_b16 a[74:75], v12 offset:25088
  v_mfma_f32_16x16x32_bf16 v[36:39], a[32:35], a[224:227], v[36:39]
  buffer_load_dwordx4 v137, s[12:15], s36 offen offset:1024 lds
  v_mfma_f32_16x16x32_bf16 v[36:39], a[44:47], a[244:247], v[36:39]
  ds_read_b64_tr_b16 a[76:77], v13 offset:24576
  v_mfma_f32_16x16x32_bf16 v[116:119], a[48:51], a[160:163], v[116:119]
  ds_read_b64_tr_b16 a[78:79], v13 offset:25088
  ds_read_b64_tr_b16 a[80:81], v14 offset:24576
  v_mfma_f32_16x16x32_bf16 v[116:119], a[60:63], a[164:167], v[116:119]
  ds_read_b64_tr_b16 a[82:83], v14 offset:25088
  ds_read_b64_tr_b16 a[84:85], v12 offset:36864
  v_mfma_f32_16x16x32_bf16 v[124:127], a[64:67], a[164:167], v[124:127]
  buffer_load_dwordx4 v138, s[12:15], s36 offen offset:2048 lds
  v_mfma_f32_16x16x32_bf16 v[124:127], a[52:55], a[160:163], v[124:127]
  ds_read_b64_tr_b16 a[86:87], v12 offset:37376
  ds_read_b64_tr_b16 a[88:89], v13 offset:36864
  v_mfma_f32_16x16x32_bf16 v[120:123], a[56:59], a[160:163], v[120:123]
  v_cvt_pk_bf16_f32 v46, v116, v117
  v_cvt_pk_bf16_f32 v47, v118, v119
  v_mfma_f32_16x16x32_bf16 v[120:123], a[68:71], a[164:167], v[120:123]
  s_add_u32 m0, s32, 40960
  ds_read_b64_tr_b16 a[90:91], v13 offset:37376
  v_mfma_f32_16x16x32_bf16 v[128:131], a[48:51], a[184:187], v[128:131]
  v_cvt_pk_bf16_f32 v48, v124, v125
  v_cvt_pk_bf16_f32 v49, v126, v127
  v_mfma_f32_16x16x32_bf16 v[128:131], a[60:63], a[188:191], v[128:131]
  buffer_load_dwordx4 v6, s[8:11], s48 offen offset:0 nt lds
  v_mfma_f32_16x16x32_bf16 v[132:135], a[64:67], a[188:191], v[132:135]
  v_cvt_pk_bf16_f32 v50, v120, v121
  v_cvt_pk_bf16_f32 v51, v122, v123
  v_mfma_f32_16x16x32_bf16 v[132:135], a[52:55], a[184:187], v[132:135]
  s_add_u32 m0, s32, 49024
  ds_read_b64_tr_b16 a[92:93], v14 offset:36864
  v_mfma_f32_16x16x32_bf16 v[140:143], a[56:59], a[184:187], v[140:143]
  v_cvt_pk_bf16_f32 v58, v128, v129
  v_cvt_pk_bf16_f32 v59, v130, v131
  v_mfma_f32_16x16x32_bf16 v[140:143], a[68:71], a[188:191], v[140:143]
  buffer_load_dwordx4 v6, s[8:11], s48 offen offset:128 nt lds
  v_mfma_f32_16x16x32_bf16 v[16:19], a[48:51], a[208:211], v[16:19]
  v_cvt_pk_bf16_f32 v60, v132, v133
  v_cvt_pk_bf16_f32 v61, v134, v135
  v_mfma_f32_16x16x32_bf16 v[16:19], a[60:63], a[212:215], v[16:19]
  s_add_u32 m0, s32, 57088
  ds_read_b64_tr_b16 a[94:95], v14 offset:37376
  v_mfma_f32_16x16x32_bf16 v[20:23], a[64:67], a[212:215], v[20:23]
  v_cvt_pk_bf16_f32 v62, v140, v141
  v_cvt_pk_bf16_f32 v63, v142, v143
  v_mfma_f32_16x16x32_bf16 v[20:23], a[52:55], a[208:211], v[20:23]
L_hop1:
  s_cbranch_execz L_hopped
  buffer_load_dwordx4 v6, s[8:11], s48 offen offset:256 nt lds
  v_mfma_f32_16x16x32_bf16 v[24:27], a[56:59], a[208:211], v[24:27]
  v_cvt_pk_bf16_f32 v76, v16, v17
  v_cvt_pk_bf16_f32 v77, v18, v19
  v_mfma_f32_16x16x32_bf16 v[24:27], a[68:71], a[212:215], v[24:27]
  s_add_u32 m0, s32, 45056
  v_mfma_f32_16x16x32_bf16 v[28:31], a[48:51], a[248:251], v[28:31]
  v_cvt_pk_bf16_f32 v78, v20, v21
  v_cvt_pk_bf16_f32 v79, v22, v23
  v_mfma_f32_16x16x32_bf16 v[28:31], a[60:63], a[252:255], v[28:31]
  s_waitcnt lgkmcnt(0)
  s_waitcnt vmcnt(9)
  s_barrier
  v_mfma_f32_16x16x32_bf16 v[32:35], a[64:67], a[252:255], v[32:35]
  v_cvt_pk_bf16_f32 v80, v24, v25
  v_cvt_pk_bf16_f32 v81, v26, v27
  v_mfma_f32_16x16x32_bf16 v[32:35], a[52:55], a[248:251], v[32:35]
  buffer_load_dwordx4 v6, s[8:11], s49 offen offset:0 nt lds
  v_mfma_f32_16x16x32_bf16 v[36:39], a[56:59], a[248:251], v[36:39]
  v_cvt_pk_bf16_f32 v82, v28, v29
  v_cvt_pk_bf16_f32 v83, v30, v31
  v_mfma_f32_16x16x32_bf16 v[36:39], a[68:71], a[252:255], v[36:39]
  s_add_u32 m0, s32, 53120
  ds_read_b64_tr_b16 a[96:97], v12 offset:49152
  v_mfma_f32_16x16x32_bf16 v[116:119], v[46:49], v[70:73], v[156:159]
  v_cvt_pk_bf16_f32 v84, v32, v33
  v_cvt_pk_bf16_f32 v85, v34, v35
  v_mfma_f32_16x16x32_bf16 v[124:127], v[58:61], v[70:73], v[160:163]
  buffer_load_dwordx4 v6, s[8:11], s49 offen offset:128 nt lds
  v_mfma_f32_16x16x32_bf16 v[120:123], v[76:79], v[70:73], v[104:107]
  v_cvt_pk_bf16_f32 v86, v36, v37
  v_cvt_pk_bf16_f32 v87, v38, v39
  v_mfma_f32_16x16x32_bf16 v[128:131], v[82:85], v[70:73], v[100:103]
  s_add_u32 m0, s32, 61184
  ds_read_b64_tr_b16 a[98:99], v12 offset:49664
  v_mfma_f32_16x16x16_bf16 v[116:119], v[50:51], v[74:75], v[116:119]
  s_cmp_lg_u32 s31, 0
  s_cbranch_scc1 L_special0
  v_mfma_f32_16x16x16_bf16 v[124:127], v[62:63], v[74:75], v[124:127]
  buffer_load_dwordx4 v6, s[8:11], s49 offen offset:256 nt lds
  v_mfma_f32_16x16x16_bf16 v[120:123], v[80:81], v[74:75], v[120:123]
  s_add_u32 s48, s48, 6291456
  s_add_u32 s49, s48, 786432
  v_mfma_f32_16x16x16_bf16 v[128:131], v[86:87], v[74:75], v[128:131]
  s_add_u32 m0, s32, 65536
  ds_read_b64_tr_b16 a[100:101], v13 offset:49152
  v_mfma_f32_16x16x32_bf16 v[132:135], v[46:49], v[64:67], v[160:163]
  buffer_load_dwordx4 v6, s[8:11], s48 offen offset:0 nt lds
  v_mfma_f32_16x16x32_bf16 v[140:143], v[58:61], v[64:67], v[180:183]
  ds_read_b64_tr_b16 a[102:103], v13 offset:49664
  ds_read_b64_tr_b16 a[104:105], v14 offset:49152
  v_mfma_f32_16x16x32_bf16 v[136:139], v[76:79], v[64:67], v[100:103]
  ds_read_b64_tr_b16 a[106:107], v14 offset:49664
  ds_read_b64_tr_b16 a[108:109], v12 offset:61440
  v_mfma_f32_16x16x32_bf16 v[144:147], v[82:85], v[64:67], v[96:99]
  s_add_u32 m0, s32, 73600
  ds_read_b64_tr_b16 a[110:111], v12 offset:61952
  v_mfma_f32_16x16x16_bf16 v[132:135], v[50:51], v[68:69], v[132:135]
  buffer_load_dwordx4 v6, s[8:11], s48 offen offset:128 nt lds
  v_mfma_f32_16x16x16_bf16 v[140:143], v[62:63], v[68:69], v[140:143]
  ds_read_b64_tr_b16 a[112:113], v13 offset:61440
  ds_read_b64_tr_b16 a[114:115], v13 offset:61952
  v_mfma_f32_16x16x16_bf16 v[136:139], v[80:81], v[68:69], v[136:139]
  ds_read_b64_tr_b16 a[116:117], v14 offset:61440
  ds_read_b64_tr_b16 a[118:119], v14 offset:61952
  v_mfma_f32_16x16x16_bf16 v[144:147], v[86:87], v[68:69], v[144:147]
  s_add_u32 m0, s32, 81664
  v_mfma_f32_16x16x32_bf16 v[148:151], v[46:49], v[52:55], v[104:107]
  buffer_load_dwordx4 v6, s[8:11], s48 offen offset:256 nt lds
  v_mfma_f32_16x16x32_bf16 v[156:159], v[58:61], v[52:55], v[100:103]
  v_exp_f32 v116, v116
  v_mfma_f32_16x16x32_bf16 v[152:155], v[76:79], v[52:55], v[152:155]
  v_exp_f32 v117, v117
  v_mfma_f32_16x16x32_bf16 v[160:163], v[82:85], v[52:55], v[168:171]
  v_exp_f32 v118, v118
  v_mfma_f32_16x16x16_bf16 v[148:151], v[50:51], v[56:57], v[148:151]
  s_waitcnt lgkmcnt(0)
  s_waitcnt vmcnt(9)
  s_barrier
  v_mfma_f32_16x16x16_bf16 v[156:159], v[62:63], v[56:57], v[156:159]
  ds_read_b64_tr_b16 a[120:121], v15 offset:0
  ds_read_b64_tr_b16 a[122:123], v15 offset:512
  v_mfma_f32_16x16x16_bf16 v[152:155], v[80:81], v[56:57], v[152:155]
  ds_read_b64_tr_b16 a[124:125], v9 offset:0
  ds_read_b64_tr_b16 a[126:127], v9 offset:512
  v_mfma_f32_16x16x16_bf16 v[160:163], v[86:87], v[56:57], v[160:163]
  ds_read_b64_tr_b16 a[128:129], v11 offset:0
  ds_read_b64_tr_b16 a[130:131], v11 offset:512
  v_mfma_f32_16x16x32_bf16 v[164:167], v[46:49], v[40:43], v[100:103]
  ds_read_b64_tr_b16 a[132:133], v15 offset:12288
  ds_read_b64_tr_b16 a[134:135], v15 offset:12800
  v_mfma_f32_16x16x32_bf16 v[172:175], v[58:61], v[40:43], v[96:99]
  ds_read_b64_tr_b16 a[136:137], v9 offset:12288
  ds_read_b64_tr_b16 a[138:139], v9 offset:12800
  v_mfma_f32_16x16x32_bf16 v[168:171], v[76:79], v[40:43], v[168:171]
  ds_read_b64_tr_b16 a[140:141], v11 offset:12288
  ds_read_b64_tr_b16 a[142:143], v11 offset:12800
  v_mfma_f32_16x16x32_bf16 v[176:179], v[82:85], v[40:43], v[176:179]
  v_exp_f32 v119, v119
  v_mfma_f32_16x16x16_bf16 v[164:167], v[50:51], v[44:45], v[164:167]
  v_cvt_pk_bf16_f32 v116, v116, v117
  v_cvt_pk_bf16_f32 v117, v118, v119
  v_mfma_f32_16x16x16_bf16 v[172:175], v[62:63], v[44:45], v[172:175]
  v_exp_f32 v124, v124
  v_mfma_f32_16x16x16_bf16 v[168:171], v[80:81], v[44:45], v[168:171]
  v_exp_f32 v125, v125
  v_mfma_f32_16x16x16_bf16 v[176:179], v[86:87], v[44:45], v[176:179]
  v_exp_f32 v126, v126
L_enter:
  v_mfma_f32_16x16x32_bf16 v[40:43], a[144:147], a[72:75], 0
  v_exp_f32 v127, v127
  v_mfma_f32_16x16x32_bf16 v[40:43], a[148:151], a[84:87], v[40:43]
  v_cvt_pk_bf16_f32 v118, v124, v125
  v_cvt_pk_bf16_f32 v119, v126, v127
  v_mfma_f32_16x16x32_bf16 v[40:43], a[152:155], a[96:99], v[40:43]
  v_exp_f32 v120, v120
  v_mfma_f32_16x16x32_bf16 v[40:43], a[156:159], a[108:111], v[40:43]
  s_waitcnt lgkmcnt(0)
  v_mfma_f32_16x16x32_bf16 v[40:43], a[160:163], a[120:123], v[40:43]
  v_exp_f32 v121, v121
  v_mfma_f32_16x16x32_bf16 v[40:43], a[164:167], a[132:135], v[40:43]
  v_exp_f32 v122, v122
  v_mfma_f32_16x16x32_bf16 v[44:47], a[164:167], a[136:139], 0
  v_exp_f32 v123, v123
  v_mfma_f32_16x16x32_bf16 v[44:47], a[160:163], a[124:127], v[44:47]
  v_cvt_pk_bf16_f32 v120, v120, v121
  v_cvt_pk_bf16_f32 v121, v122, v123
  v_mfma_f32_16x16x32_bf16 v[44:47], a[156:159], a[112:115], v[44:47]
  v_cvt_pk_bf16_f32 v16, v40, v41
  v_cvt_pk_bf16_f32 v17, v42, v43
  v_mfma_f32_16x16x32_bf16 v[44:47], a[152:155], a[100:103], v[44:47]
  v_exp_f32 v128, v128
  v_mfma_f32_16x16x32_bf16 v[44:47], a[148:151], a[88:91], v[44:47]
  v_exp_f32 v129, v129
  v_mfma_f32_16x16x32_bf16 v[44:47], a[144:147], a[76:79], v[44:47]
  v_exp_f32 v130, v130
  v_mfma_f32_16x16x32_bf16 v[40:43], a[144:147], a[80:83], 0
  v_exp_f32 v131, v131
  v_mfma_f32_16x16x32_bf16 v[40:43], a[148:151], a[92:95], v[40:43]
  v_exp_f32 v132, v132
  v_mfma_f32_16x16x32_bf16 v[40:43], a[152:155], a[104:107], v[40:43]
  v_cvt_pk_bf16_f32 v24, v44, v45
  v_cvt_pk_bf16_f32 v25, v46, v47
  v_mfma_f32_16x16x32_bf16 v[40:43], a[156:159], a[116:119], v[40:43]
  v_exp_f32 v133, v133
  v_mfma_f32_16x16x32_bf16 v[40:43], a[160:163], a[128:131], v[40:43]
  v_cvt_pk_bf16_f32 v122, v128, v129
  v_cvt_pk_bf16_f32 v123, v130, v131
  v_mfma_f32_16x16x32_bf16 v[40:43], a[164:167], a[140:143], v[40:43]
  v_exp_f32 v134, v134
  v_mfma_f32_16x16x32_bf16 v[44:47], a[168:171], a[72:75], 0
  v_cvt_pk_bf16_f32 v132, v132, v133
  v_mfma_f32_16x16x32_bf16 v[44:47], a[172:175], a[84:87], v[44:47]
  v_exp_f32 v135, v135
  v_mfma_f32_16x16x32_bf16 v[44:47], a[176:179], a[96:99], v[44:47]
  v_cvt_pk_bf16_f32 v32, v40, v41
  v_cvt_pk_bf16_f32 v33, v42, v43
  v_mfma_f32_16x16x32_bf16 v[44:47], a[180:183], a[108:111], v[44:47]
  v_exp_f32 v140, v140
  v_mfma_f32_16x16x32_bf16 v[44:47], a[184:187], a[120:123], v[44:47]
  v_exp_f32 v141, v141
  v_mfma_f32_16x16x32_bf16 v[44:47], a[188:191], a[132:135], v[44:47]
  v_exp_f32 v142, v142
  v_mfma_f32_16x16x32_bf16 v[40:43], a[188:191], a[136:139], 0
  v_exp_f32 v143, v143
  v_mfma_f32_16x16x32_bf16 v[40:43], a[184:187], a[124:127], v[40:43]
  v_cvt_pk_bf16_f32 v133, v134, v135
  v_cvt_pk_bf16_f32 v134, v140, v141
  v_mfma_f32_16x16x32_bf16 v[40:43], a[180:183], a[112:115], v[40:43]
  v_cvt_pk_bf16_f32 v18, v44, v45
  v_cvt_pk_bf16_f32 v19, v46, v47
  v_mfma_f32_16x16x32_bf16 v[40:43], a[176:179], a[100:103], v[40:43]
  v_cvt_pk_bf16_f32 v135, v142, v143
  v_mfma_f32_16x16x32_bf16 v[40:43], a[172:175], a[88:91], v[40:43]
  v_exp_f32 v136, v136
  v_mfma_f32_16x16x32_bf16 v[40:43], a[168:171], a[76:79], v[40:43]
  v_exp_f32 v137, v137
  v_mfma_f32_16x16x32_bf16 v[44:47], a[168:171], a[80:83], 0
  v_exp_f32 v138, v138
  v_mfma_f32_16x16x32_bf16 v[44:47], a[172:175], a[92:95], v[44:47]
  v_exp_f32 v139, v139
  v_mfma_f32_16x16x32_bf16 v[44:47], a[176:179], a[104:107], v[44:47]
  v_cvt_pk_bf16_f32 v26, v40, v41
  v_cvt_pk_bf16_f32 v27, v42, v43
  v_mfma_f32_16x16x32_bf16 v[44:47], a[180:183], a[116:119], v[44:47]
  v_exp_f32 v144, v144
  v_mfma_f32_16x16x32_bf16 v[44:47], a[184:187], a[128:131], v[44:47]
  v_exp_f32 v145, v145
  v_mfma_f32_16x16x32_bf16 v[44:47], a[188:191], a[140:143], v[44:47]
  v_cvt_pk_bf16_f32 v136, v136, v137
  v_cvt_pk_bf16_f32 v137, v138, v139
  v_mfma_f32_16x16x32_bf16 v[40:43], a[192:195], a[72:75], 0
  v_cvt_pk_bf16_f32 v138, v144, v145
  v_mfma_f32_16x16x32_bf16 v[40:43], a[196:199], a[84:87], v[40:43]
  v_exp_f32 v146, v146
  v_mfma_f32_16x16x32_bf16 v[40:43], a[200:203], a[96:99], v[40:43]
  v_cvt_pk_bf16_f32 v34, v44, v45
  v_cvt_pk_bf16_f32 v35, v46, v47
  v_mfma_f32_16x16x32_bf16 v[40:43], a[204:207], a[108:111], v[40:43]
  v_exp_f32 v147, v147
  v_mfma_f32_16x16x32_bf16 v[40:43], a[208:211], a[120:123], v[40:43]
  v_cvt_pk_bf16_f32 v139, v146, v147
  v_mov_b64 v[144:145], 0
  v_mfma_f32_16x16x32_bf16 v[40:43], a[212:215], a[132:135], v[40:43]
  v_exp_f32 v148, v148
  v_mfma_f32_16x16x32_bf16 v[44:47], a[212:215], a[136:139], 0
  v_exp_f32 v149, v149
  v_mfma_f32_16x16x32_bf16 v[44:47], a[208:211], a[124:127], v[44:47]
  v_exp_f32 v150, v150
  v_mfma_f32_16x16x32_bf16 v[44:47], a[204:207], a[112:115], v[44:47]
  v_cvt_pk_bf16_f32 v20, v40, v41
  v_cvt_pk_bf16_f32 v21, v42, v43
  v_mfma_f32_16x16x32_bf16 v[44:47], a[200:203], a[100:103], v[44:47]
  v_exp_f32 v151, v151
  v_mfma_f32_16x16x32_bf16 v[44:47], a[196:199], a[88:91], v[44:47]
  v_exp_f32 v156, v156
  v_mfma_f32_16x16x32_bf16 v[44:47], a[192:195], a[76:79], v[44:47]
  v_exp_f32 v157, v157
  v_mfma_f32_16x16x32_bf16 v[40:43], a[192:195], a[80:83], 0
  v_cvt_pk_bf16_f32 v148, v148, v149
  v_cvt_pk_bf16_f32 v149, v150, v151
  v_mfma_f32_16x16x32_bf16 v[40:43], a[196:199], a[92:95], v[40:43]
  v_exp_f32 v158, v158
  v_mfma_f32_16x16x32_bf16 v[40:43], a[200:203], a[104:107], v[40:43]
  v_cvt_pk_bf16_f32 v28, v44, v45
  v_cvt_pk_bf16_f32 v29, v46, v47
  v_mfma_f32_16x16x32_bf16 v[40:43], a[204:207], a[116:119], v[40:43]
  v_exp_f32 v159, v159
  v_mfma_f32_16x16x32_bf16 v[40:43], a[208:211], a[128:131], v[40:43]
  v_exp_f32 v152, v152
  v_mfma_f32_16x16x32_bf16 v[40:43], a[212:215], a[140:143], v[40:43]
  v_cvt_pk_bf16_f32 v150, v156, v157
  v_mfma_f32_16x16x32_bf16 v[44:47], a[216:219], a[72:75], 0
  v_exp_f32 v153, v153
  v_mfma_f32_16x16x32_bf16 v[44:47], a[220:223], a[84:87], v[44:47]
  v_cvt_pk_bf16_f32 v151, v158, v159
  v_cvt_pk_bf16_f32 v152, v152, v153
  v_mfma_f32_16x16x32_bf16 v[44:47], a[224:227], a[96:99], v[44:47]
  v_cvt_pk_bf16_f32 v36, v40, v41
  v_cvt_pk_bf16_f32 v37, v42, v43
  v_mfma_f32_16x16x32_bf16 v[44:47], a[244:247], a[108:111], v[44:47]
  v_exp_f32 v154, v154
  v_mfma_f32_16x16x32_bf16 v[44:47], a[248:251], a[120:123], v[44:47]
  v_exp_f32 v155, v155
  v_mfma_f32_16x16x32_bf16 v[44:47], a[252:255], a[132:135], v[44:47]
  v_exp_f32 v160, v160
  v_mfma_f32_16x16x32_bf16 v[40:43], a[252:255], a[136:139], 0
  v_exp_f32 v161, v161
  v_mfma_f32_16x16x32_bf16 v[40:43], a[248:251], a[124:127], v[40:43]
  v_cvt_pk_bf16_f32 v153, v154, v155
  v_cvt_pk_bf16_f32 v154, v160, v161
  v_mfma_f32_16x16x32_bf16 v[40:43], a[244:247], a[112:115], v[40:43]
  v_cvt_pk_bf16_f32 v22, v44, v45
  v_cvt_pk_bf16_f32 v23, v46, v47
  v_mfma_f32_16x16x32_bf16 v[40:43], a[224:227], a[100:103], v[40:43]
  v_exp_f32 v162, v162
  v_mfma_f32_16x16x32_bf16 v[40:43], a[220:223], a[88:91], v[40:43]
  v_exp_f32 v163, v163
  v_mfma_f32_16x16x32_bf16 v[40:43], a[216:219], a[76:79], v[40:43]
  v_exp_f32 v164, v164
  v_mfma_f32_16x16x32_bf16 v[44:47], a[216:219], a[80:83], 0
  v_exp_f32 v165, v165
  v_mfma_f32_16x16x32_bf16 v[44:47], a[220:223], a[92:95], v[44:47]
  v_exp_f32 v166, v166
  v_mfma_f32_16x16x32_bf16 v[44:47], a[224:227], a[104:107], v[44:47]
  v_cvt_pk_bf16_f32 v30, v40, v41
  v_cvt_pk_bf16_f32 v31, v42, v43
  v_mfma_f32_16x16x32_bf16 v[44:47], a[244:247], a[116:119], v[44:47]
  v_exp_f32 v167, v167
  v_mfma_f32_16x16x32_bf16 v[44:47], a[248:251], a[128:131], v[44:47]
  v_cvt_pk_bf16_f32 v155, v162, v163
  v_cvt_pk_bf16_f32 v164, v164, v165
  v_mfma_f32_16x16x32_bf16 v[44:47], a[252:255], a[140:143], v[44:47]
  v_exp_f32 v172, v172
  s_add_u32 s32, s32, 40960
  v_mad_i32_i16 v0, v10, 1, s32 op_sel:[1,0,0,0]
  v_xor_b32 v1, 64, v0
  v_exp_f32 v173, v173
  v_exp_f32 v174, v174
  v_cvt_pk_bf16_f32 v165, v166, v167
  v_smfmac_f32_16x16x64_bf16 v[144:147], a[240:243], v[116:123], v10
  v_exp_f32 v175, v175
  v_mfma_f32_16x16x32_bf16 v[124:127], v[20:23], v[120:123], 0
  v_cvt_pk_bf16_f32 v166, v172, v173
  v_cvt_pk_bf16_f32 v167, v174, v175
  v_mfma_f32_16x16x32_bf16 v[124:127], v[16:19], v[116:119], v[124:127]
  v_cvt_pk_bf16_f32 v38, v44, v45
  v_cvt_pk_bf16_f32 v39, v46, v47
  v_mfma_f32_16x16x32_bf16 v[128:131], v[24:27], v[116:119], 0
  v_add_f32 v15, v144, v145
  v_mov_b64 v[144:145], 0
  v_mfma_f32_16x16x32_bf16 v[128:131], v[28:31], v[120:123], v[128:131]
  v_exp_f32 v168, v168
  v_mfma_f32_16x16x32_bf16 v[140:143], v[36:39], v[120:123], 0
  v_exp_f32 v169, v169
  v_mfma_f32_16x16x32_bf16 v[140:143], v[32:35], v[116:119], v[140:143]
  v_exp_f32 v170, v170
  v_smfmac_f32_16x16x64_bf16 v[144:147], a[240:243], v[132:139], v10
  v_exp_f32 v171, v171
  v_mfma_f32_16x16x32_bf16 v[116:119], v[20:23], v[136:139], 0
  v_cvt_pk_bf16_f32 v168, v168, v169
  v_cvt_pk_bf16_f32 v169, v170, v171
  v_mfma_f32_16x16x32_bf16 v[116:119], v[16:19], v[132:135], v[116:119]
  v_exp_f32 v176, v176
  v_mfma_f32_16x16x32_bf16 v[120:123], v[24:27], v[132:135], 0
  v_add_f32 v14, v144, v145
  v_mov_b64 v[144:145], 0
  v_mfma_f32_16x16x32_bf16 v[120:123], v[28:31], v[136:139], v[120:123]
  v_exp_f32 v177, v177
  v_mfma_f32_16x16x32_bf16 v[156:159], v[36:39], v[136:139], 0
  v_exp_f32 v178, v178
  v_mfma_f32_16x16x32_bf16 v[156:159], v[32:35], v[132:135], v[156:159]
  v_exp_f32 v179, v179
  v_smfmac_f32_16x16x64_bf16 v[144:147], a[240:243], v[148:155], v10
  v_cvt_pk_bf16_f32 v170, v176, v177
  v_cvt_pk_bf16_f32 v171, v178, v179
  v_mfma_f32_16x16x32_bf16 v[132:135], v[20:23], v[152:155], 0
  s_add_u32 m0, s32, 28672
  v_mfma_f32_16x16x32_bf16 v[132:135], v[16:19], v[148:151], v[132:135]
  s_waitcnt vmcnt(6)
  s_barrier
  v_mfma_f32_16x16x32_bf16 v[136:139], v[24:27], v[148:151], 0
  v_add_f32 v13, v144, v145
  v_mov_b64 v[144:145], 0
  v_mfma_f32_16x16x32_bf16 v[136:139], v[28:31], v[152:155], v[136:139]
  ds_read_b128 a[244:247], v0 offset:0
  ds_read_b128 a[248:251], v1 offset:0
  v_mfma_f32_16x16x32_bf16 v[160:163], v[36:39], v[152:155], 0
  buffer_load_dwordx4 v6, s[8:11], s49 offen offset:0 nt lds
  v_mfma_f32_16x16x32_bf16 v[160:163], v[32:35], v[148:151], v[160:163]
  ds_read_b128 a[252:255], v0 offset:8192
  ds_read_b128 v[180:183], v1 offset:8192
  v_smfmac_f32_16x16x64_bf16 v[144:147], a[240:243], v[164:171], v10
  s_add_u32 m0, s32, 36736
  v_mfma_f32_16x16x32_bf16 v[148:151], v[20:23], v[168:171], 0
  ds_read_b128 v[64:67], v0 offset:16384
  ds_read_b128 v[68:71], v1 offset:16384
  v_mfma_f32_16x16x32_bf16 v[148:151], v[16:19], v[164:167], v[148:151]
  buffer_load_dwordx4 v6, s[8:11], s49 offen offset:128 nt lds
  v_mfma_f32_16x16x32_bf16 v[152:155], v[24:27], v[164:167], 0
  v_add_f32 v12, v144, v145
  s_add_u32 m0, s32, 44800
  v_mfma_f32_16x16x32_bf16 v[152:155], v[28:31], v[168:171], v[152:155]
  buffer_load_dwordx4 v6, s[8:11], s49 offen offset:256 nt lds
  v_mfma_f32_16x16x32_bf16 v[172:175], v[36:39], v[168:171], 0
  v_rcp_f32 v15, v15
  v_mfma_f32_16x16x32_bf16 v[172:175], v[32:35], v[164:167], v[172:175]
  s_waitcnt lgkmcnt(4)
  v_mfma_f32_16x16x32_bf16 v[76:79], v[184:187], a[244:247], 0
  v_rcp_f32 v14, v14
  v_mfma_f32_16x16x32_bf16 v[76:79], v[196:199], a[248:251], v[76:79]
  s_waitcnt lgkmcnt(2)
  v_mul_f32 v124, v15, v124
  v_mfma_f32_16x16x32_bf16 v[76:79], v[208:211], a[252:255], v[76:79]
  v_mul_f32 v125, v15, v125
  v_mul_f32 v126, v15, v126
  v_mfma_f32_16x16x32_bf16 v[76:79], v[220:223], v[180:183], v[76:79]
  s_waitcnt lgkmcnt(0)
  v_mul_f32 v127, v15, v127
  v_mfma_f32_16x16x32_bf16 v[76:79], v[232:235], v[64:67], v[76:79]
  v_cvt_pk_bf16_f32 v124, v124, v125
  v_cvt_pk_bf16_f32 v125, v126, v127
  v_mfma_f32_16x16x32_bf16 v[76:79], v[244:247], v[68:71], v[76:79]
  v_mul_f32 v128, v15, v128
  v_mul_f32 v129, v15, v129
  v_mfma_f32_16x16x32_bf16 v[80:83], v[248:251], v[68:71], 0
  v_mul_f32 v130, v15, v130
  v_mul_f32 v131, v15, v131
  v_mfma_f32_16x16x32_bf16 v[80:83], v[236:239], v[64:67], v[80:83]
  v_cvt_pk_bf16_f32 v126, v128, v129
  v_cvt_pk_bf16_f32 v127, v130, v131
  v_mfma_f32_16x16x32_bf16 v[80:83], v[224:227], v[180:183], v[80:83]
  v_cvt_pk_bf16_f32 v40, v76, v77
  v_cvt_pk_bf16_f32 v41, v78, v79
  v_mfma_f32_16x16x32_bf16 v[80:83], v[212:215], a[252:255], v[80:83]
  ds_write_b128 v4, v[124:127] offset:768
  v_mfma_f32_16x16x32_bf16 v[80:83], v[200:203], a[248:251], v[80:83]
  v_mul_f32 v140, v15, v140
  v_mul_f32 v141, v15, v141
  v_mfma_f32_16x16x32_bf16 v[80:83], v[188:191], a[244:247], v[80:83]
  v_mul_f32 v142, v15, v142
  v_mul_f32 v143, v15, v143
  v_mfma_f32_16x16x32_bf16 v[76:79], v[192:195], a[244:247], 0
  v_cvt_pk_bf16_f32 v140, v140, v141
  v_cvt_pk_bf16_f32 v141, v142, v143
  v_mfma_f32_16x16x32_bf16 v[76:79], v[204:207], a[248:251], v[76:79]
  ds_write_b64 v5, v[140:141] offset:768
  v_mfma_f32_16x16x32_bf16 v[76:79], v[216:219], a[252:255], v[76:79]
  v_cvt_pk_bf16_f32 v42, v80, v81
  v_cvt_pk_bf16_f32 v43, v82, v83
  v_mfma_f32_16x16x32_bf16 v[76:79], v[228:231], v[180:183], v[76:79]
  v_rcp_f32 v13, v13
  v_mfma_f32_16x16x32_bf16 v[76:79], v[240:243], v[64:67], v[76:79]
  v_mul_f32 v116, v14, v116
  v_mul_f32 v117, v14, v117
  v_mfma_f32_16x16x32_bf16 v[76:79], v[252:255], v[68:71], v[76:79]
  v_mul_f32 v118, v14, v118
  v_mul_f32 v119, v14, v119
  v_mfma_f32_16x16x32_bf16 v[80:83], a[60:63], v[68:71], 0
  v_cvt_pk_bf16_f32 v116, v116, v117
  v_cvt_pk_bf16_f32 v117, v118, v119
  v_mfma_f32_16x16x32_bf16 v[80:83], a[48:51], v[64:67], v[80:83]
  v_mul_f32 v120, v14, v120
  v_mul_f32 v121, v14, v121
  v_mfma_f32_16x16x32_bf16 v[80:83], a[36:39], v[180:183], v[80:83]
  v_cvt_pk_bf16_f32 v44, v76, v77
  v_cvt_pk_bf16_f32 v45, v78, v79
  v_mfma_f32_16x16x32_bf16 v[80:83], a[24:27], a[252:255], v[80:83]
  v_mul_f32 v122, v14, v122
  v_mul_f32 v123, v14, v123
  v_mfma_f32_16x16x32_bf16 v[80:83], a[12:15], a[248:251], v[80:83]
  v_cvt_pk_bf16_f32 v118, v120, v121
  v_cvt_pk_bf16_f32 v119, v122, v123
  v_mfma_f32_16x16x32_bf16 v[80:83], a[0:3], a[244:247], v[80:83]
  ds_write_b128 v4, v[116:119] offset:512
  v_mfma_f32_16x16x32_bf16 v[76:79], a[4:7], a[244:247], 0
  v_mul_f32 v156, v14, v156
  v_mul_f32 v157, v14, v157
  v_mfma_f32_16x16x32_bf16 v[76:79], a[16:19], a[248:251], v[76:79]
  v_mul_f32 v158, v14, v158
  v_mul_f32 v159, v14, v159
  v_mfma_f32_16x16x32_bf16 v[76:79], a[28:31], a[252:255], v[76:79]
  v_cvt_pk_bf16_f32 v46, v80, v81
  v_cvt_pk_bf16_f32 v47, v82, v83
  v_mfma_f32_16x16x32_bf16 v[76:79], a[40:43], v[180:183], v[76:79]
  v_cvt_pk_bf16_f32 v156, v156, v157
  v_cvt_pk_bf16_f32 v157, v158, v159
  v_mfma_f32_16x16x32_bf16 v[76:79], a[52:55], v[64:67], v[76:79]
  ds_write_b64 v5, v[156:157] offset:512
  v_mfma_f32_16x16x32_bf16 v[76:79], a[64:67], v[68:71], v[76:79]
  v_rcp_f32 v12, v12
  v_mfma_f32_16x16x32_bf16 v[80:83], a[68:71], v[68:71], 0
  v_mul_f32 v132, v13, v132
  v_mul_f32 v133, v13, v133
  v_mfma_f32_16x16x32_bf16 v[80:83], a[56:59], v[64:67], v[80:83]
  v_mul_f32 v134, v13, v134
  v_mul_f32 v135, v13, v135
  v_mfma_f32_16x16x32_bf16 v[80:83], a[44:47], v[180:183], v[80:83]
  v_cvt_pk_bf16_f32 v48, v76, v77
  v_cvt_pk_bf16_f32 v49, v78, v79
  v_mfma_f32_16x16x32_bf16 v[80:83], a[32:35], a[252:255], v[80:83]
  v_cvt_pk_bf16_f32 v132, v132, v133
  v_cvt_pk_bf16_f32 v133, v134, v135
  v_mfma_f32_16x16x32_bf16 v[80:83], a[20:23], a[248:251], v[80:83]
  v_mul_f32 v136, v13, v136
  v_mul_f32 v137, v13, v137
  v_mfma_f32_16x16x32_bf16 v[80:83], a[8:11], a[244:247], v[80:83]
  v_mul_f32 v138, v13, v138
  v_mul_f32 v139, v13, v139
  v_mfma_f32_16x16x32_bf16 v[76:79], a[244:247], a[72:75], 0
  v_cvt_pk_bf16_f32 v134, v136, v137
  v_cvt_pk_bf16_f32 v135, v138, v139
  v_mfma_f32_16x16x32_bf16 v[76:79], a[248:251], a[84:87], v[76:79]
  ds_write_b128 v4, v[132:135] offset:256
  v_mfma_f32_16x16x32_bf16 v[76:79], a[252:255], a[96:99], v[76:79]
  v_cvt_pk_bf16_f32 v50, v80, v81
  v_cvt_pk_bf16_f32 v51, v82, v83
  v_mfma_f32_16x16x32_bf16 v[76:79], v[180:183], a[108:111], v[76:79]
  ds_read_b128 v[72:75], v0 offset:2048
  v_mul_f32 v160, v13, v160
  v_mfma_f32_16x16x32_bf16 v[76:79], v[64:67], a[120:123], v[76:79]
  ds_read_b128 v[84:87], v1 offset:2048
  v_mul_f32 v161, v13, v161
  v_mfma_f32_16x16x32_bf16 v[76:79], v[68:71], a[132:135], v[76:79]
  ds_read_b128 v[164:167], v0 offset:10240
  v_mul_f32 v162, v13, v162
  v_mfma_f32_16x16x32_bf16 v[80:83], v[68:71], a[136:139], 0
  ds_read_b128 v[168:171], v1 offset:10240
  v_mul_f32 v163, v13, v163
  v_mfma_f32_16x16x32_bf16 v[80:83], v[64:67], a[124:127], v[80:83]
  ds_read_b128 v[176:179], v0 offset:18432
  v_cvt_pk_bf16_f32 v160, v160, v161
  v_mfma_f32_16x16x32_bf16 v[80:83], v[180:183], a[112:115], v[80:83]
  v_cvt_pk_bf16_f32 v16, v76, v77
  v_cvt_pk_bf16_f32 v17, v78, v79
  v_mfma_f32_16x16x32_bf16 v[80:83], a[252:255], a[100:103], v[80:83]
  ds_read_b128 v[144:147], v1 offset:18432
  v_cvt_pk_bf16_f32 v161, v162, v163
  v_mfma_f32_16x16x32_bf16 v[80:83], a[248:251], a[88:91], v[80:83]
  ds_write_b64 v5, v[160:161] offset:256
  v_mfma_f32_16x16x32_bf16 v[80:83], a[244:247], a[76:79], v[80:83]
  v_mul_f32 v148, v12, v148
  v_mul_f32 v149, v12, v149
  v_mfma_f32_16x16x32_bf16 v[76:79], a[244:247], a[80:83], 0
  v_mul_f32 v150, v12, v150
  v_mul_f32 v151, v12, v151
  v_mfma_f32_16x16x32_bf16 v[76:79], a[248:251], a[92:95], v[76:79]
  v_cvt_pk_bf16_f32 v148, v148, v149
  v_cvt_pk_bf16_f32 v149, v150, v151
  v_mfma_f32_16x16x32_bf16 v[76:79], a[252:255], a[104:107], v[76:79]
  v_cvt_pk_bf16_f32 v24, v80, v81
  v_cvt_pk_bf16_f32 v25, v82, v83
  v_mfma_f32_16x16x32_bf16 v[76:79], v[180:183], a[116:119], v[76:79]
  v_mul_f32 v152, v12, v152
  v_mul_f32 v153, v12, v153
  v_mfma_f32_16x16x32_bf16 v[76:79], v[64:67], a[128:131], v[76:79]
  v_mul_f32 v154, v12, v154
  v_mul_f32 v155, v12, v155
  v_mfma_f32_16x16x32_bf16 v[76:79], v[68:71], a[140:143], v[76:79]
  s_waitcnt lgkmcnt(1)
  v_cvt_pk_bf16_f32 v150, v152, v153
  v_mfma_f32_16x16x32_bf16 v[80:83], v[184:187], v[72:75], 0
  v_cvt_pk_bf16_f32 v151, v154, v155
  v_mfma_f32_16x16x32_bf16 v[80:83], v[196:199], v[84:87], v[80:83]
  ds_write_b128 v4, v[148:151] offset:0
  v_mfma_f32_16x16x32_bf16 v[80:83], v[208:211], v[164:167], v[80:83]
  v_cvt_pk_bf16_f32 v32, v76, v77
  v_cvt_pk_bf16_f32 v33, v78, v79
  v_mfma_f32_16x16x32_bf16 v[80:83], v[220:223], v[168:171], v[80:83]
  v_mul_f32 v172, v12, v172
  v_mul_f32 v173, v12, v173
  v_mfma_f32_16x16x32_bf16 v[80:83], v[232:235], v[176:179], v[80:83]
  v_mul_f32 v174, v12, v174
  v_mul_f32 v175, v12, v175
  v_mfma_f32_16x16x32_bf16 v[80:83], v[244:247], v[144:147], v[80:83]
  v_cvt_pk_bf16_f32 v172, v172, v173
  v_cvt_pk_bf16_f32 v173, v174, v175
  v_mfma_f32_16x16x32_bf16 v[76:79], v[248:251], v[144:147], 0
  ds_write_b64 v5, v[172:173] offset:0
  v_mfma_f32_16x16x32_bf16 v[76:79], v[236:239], v[176:179], v[76:79]
  v_subrev_u32 v3, s7, v3
  v_subrev_u32 v2, s7, v2
  v_mfma_f32_16x16x32_bf16 v[76:79], v[224:227], v[168:171], v[76:79]
  v_cvt_pk_bf16_f32 v52, v80, v81
  v_cvt_pk_bf16_f32 v53, v82, v83
  v_mfma_f32_16x16x32_bf16 v[76:79], v[212:215], v[164:167], v[76:79]
  v_add_u32 v4, s7, v4
  v_add_u32 v5, s7, v5
  v_mfma_f32_16x16x32_bf16 v[76:79], v[200:203], v[84:87], v[76:79]
  s_sub_u32 s7, 0, s7
  v_max_f32 v9, v12, v13
  v_mfma_f32_16x16x32_bf16 v[76:79], v[188:191], v[72:75], v[76:79]
  v_max3_f32 v9, v14, v15, v9
  v_min_f32 v11, v12, v13
  v_mfma_f32_16x16x32_bf16 v[80:83], v[192:195], v[72:75], 0
  v_min3_f32 v11, v14, v15, v11
  v_accvgpr_read_b32 v180, a228
  v_mfma_f32_16x16x32_bf16 v[80:83], v[204:207], v[84:87], v[80:83]
  s_add_u32 m0, s58, 114688
  s_add_u32 s36, s58, 0
  v_mfma_f32_16x16x32_bf16 v[80:83], v[216:219], v[164:167], v[80:83]
  v_cvt_pk_bf16_f32 v54, v76, v77
  v_cvt_pk_bf16_f32 v55, v78, v79
  v_mfma_f32_16x16x32_bf16 v[80:83], v[228:231], v[168:171], v[80:83]
  buffer_load_dwordx4 v180, s[16:19], s36 offen offset:0 lds
  v_mfma_f32_16x16x32_bf16 v[80:83], v[240:243], v[176:179], v[80:83]
  buffer_load_dwordx4 v180, s[16:19], s36 offen offset:1024 lds
  v_mfma_f32_16x16x32_bf16 v[80:83], v[252:255], v[144:147], v[80:83]
  buffer_load_dwordx4 v180, s[16:19], s36 offen offset:2048 lds
  v_mfma_f32_16x16x32_bf16 v[76:79], a[60:63], v[144:147], 0
  s_add_u32 m0, s58, 126976
  s_add_u32 s36, s58, 18432
  v_mfma_f32_16x16x32_bf16 v[76:79], a[48:51], v[176:179], v[76:79]
  buffer_load_dwordx4 v180, s[16:19], s36 offen offset:0 lds
  v_mfma_f32_16x16x32_bf16 v[76:79], a[36:39], v[168:171], v[76:79]
  v_cvt_pk_bf16_f32 v56, v80, v81
  v_cvt_pk_bf16_f32 v57, v82, v83
  v_mfma_f32_16x16x32_bf16 v[76:79], a[24:27], v[164:167], v[76:79]
  buffer_load_dwordx4 v180, s[16:19], s36 offen offset:1024 lds
  v_mfma_f32_16x16x32_bf16 v[76:79], a[12:15], v[84:87], v[76:79]
  v_mfma_f32_16x16x32_bf16 v[76:79], a[0:3], v[72:75], v[76:79]
  v_mfma_f32_16x16x32_bf16 v[80:83], a[4:7], v[72:75], 0
  buffer_load_dwordx4 v180, s[16:19], s36 offen offset:2048 lds
  v_mfma_f32_16x16x32_bf16 v[80:83], a[16:19], v[84:87], v[80:83]
  v_mfma_f32_16x16x32_bf16 v[80:83], a[28:31], v[164:167], v[80:83]
  v_cvt_pk_bf16_f32 v58, v76, v77
  v_cvt_pk_bf16_f32 v59, v78, v79
  v_mfma_f32_16x16x32_bf16 v[80:83], a[40:43], v[168:171], v[80:83]
  s_add_u32 m0, s58, 139264
  s_add_u32 s36, s58, 36864
  v_mfma_f32_16x16x32_bf16 v[80:83], a[52:55], v[176:179], v[80:83]
  buffer_load_dwordx4 v180, s[16:19], s36 offen offset:0 lds
  v_mfma_f32_16x16x32_bf16 v[80:83], a[64:67], v[144:147], v[80:83]
  v_mfma_f32_16x16x32_bf16 v[76:79], a[68:71], v[144:147], 0
  v_mfma_f32_16x16x32_bf16 v[76:79], a[56:59], v[176:179], v[76:79]
  buffer_load_dwordx4 v180, s[16:19], s36 offen offset:1024 lds
  v_mfma_f32_16x16x32_bf16 v[76:79], a[44:47], v[168:171], v[76:79]
  v_cvt_pk_bf16_f32 v60, v80, v81
  v_cvt_pk_bf16_f32 v61, v82, v83
  v_mfma_f32_16x16x32_bf16 v[76:79], a[32:35], v[164:167], v[76:79]
  v_mfma_f32_16x16x32_bf16 v[76:79], a[20:23], v[84:87], v[76:79]
  v_mfma_f32_16x16x32_bf16 v[76:79], a[8:11], v[72:75], v[76:79]
  buffer_load_dwordx4 v180, s[16:19], s36 offen offset:2048 lds
  v_mfma_f32_16x16x32_bf16 v[80:83], v[72:75], a[72:75], 0
  s_waitcnt vmcnt(15)
  s_barrier
  v_mfma_f32_16x16x32_bf16 v[80:83], v[84:87], a[84:87], v[80:83]
  v_mfma_f32_16x16x32_bf16 v[80:83], v[164:167], a[96:99], v[80:83]
L_hop2:
  s_cbranch_execz L_hopped
  v_cvt_pk_bf16_f32 v62, v76, v77
  v_cvt_pk_bf16_f32 v63, v78, v79
  v_mfma_f32_16x16x32_bf16 v[80:83], v[168:171], a[108:111], v[80:83]
  ds_read_b128 v[116:119], v0 offset:4096
  v_mfma_f32_16x16x32_bf16 v[80:83], v[176:179], a[120:123], v[80:83]
  ds_read_b128 v[124:127], v1 offset:4096
  v_mfma_f32_16x16x32_bf16 v[80:83], v[144:147], a[132:135], v[80:83]
  ds_read_b128 v[120:123], v0 offset:12288
  v_mfma_f32_16x16x32_bf16 v[76:79], v[144:147], a[136:139], 0
  ds_read_b128 v[128:131], v1 offset:12288
  v_mfma_f32_16x16x32_bf16 v[76:79], v[176:179], a[124:127], v[76:79]
  ds_read_b128 v[132:135], v0 offset:20480
  v_mfma_f32_16x16x32_bf16 v[76:79], v[168:171], a[112:115], v[76:79]
  v_cvt_pk_bf16_f32 v18, v80, v81
  v_cvt_pk_bf16_f32 v19, v82, v83
  v_mfma_f32_16x16x32_bf16 v[76:79], v[164:167], a[100:103], v[76:79]
  ds_read_b128 v[140:143], v1 offset:20480
  v_mfma_f32_16x16x32_bf16 v[76:79], v[84:87], a[88:91], v[76:79]
  s_add_u32 m0, s58, 151552
  s_add_u32 s36, s58, 55296
  v_mfma_f32_16x16x32_bf16 v[76:79], v[72:75], a[76:79], v[76:79]
  buffer_load_dwordx4 v180, s[16:19], s36 offen offset:0 lds
  v_mfma_f32_16x16x32_bf16 v[80:83], v[72:75], a[80:83], 0
  buffer_load_dwordx4 v180, s[16:19], s36 offen offset:1024 lds
  v_mfma_f32_16x16x32_bf16 v[80:83], v[84:87], a[92:95], v[80:83]
  buffer_load_dwordx4 v180, s[16:19], s36 offen offset:2048 lds
  v_mfma_f32_16x16x32_bf16 v[80:83], v[164:167], a[104:107], v[80:83]
  v_cvt_pk_bf16_f32 v26, v76, v77
  v_cvt_pk_bf16_f32 v27, v78, v79
  v_mfma_f32_16x16x32_bf16 v[80:83], v[168:171], a[116:119], v[80:83]
  s_add_u32 m0, s58, 0
  s_add_u32 s36, s59, 12288
  v_mfma_f32_16x16x32_bf16 v[80:83], v[176:179], a[128:131], v[80:83]
  buffer_load_dwordx4 v180, s[16:19], s36 offen offset:0 lds
  v_mfma_f32_16x16x32_bf16 v[80:83], v[144:147], a[140:143], v[80:83]
  s_waitcnt lgkmcnt(0)
  v_mfma_f32_16x16x32_bf16 v[148:151], v[184:187], v[116:119], 0
  buffer_load_dwordx4 v180, s[16:19], s36 offen offset:1024 lds
  v_mfma_f32_16x16x32_bf16 v[148:151], v[196:199], v[124:127], v[148:151]
  v_mfma_f32_16x16x32_bf16 v[148:151], v[208:211], v[120:123], v[148:151]
  v_cvt_pk_bf16_f32 v34, v80, v81
  v_cvt_pk_bf16_f32 v35, v82, v83
  v_mfma_f32_16x16x32_bf16 v[148:151], v[220:223], v[128:131], v[148:151]
  buffer_load_dwordx4 v180, s[16:19], s36 offen offset:2048 lds
  v_mfma_f32_16x16x32_bf16 v[148:151], v[232:235], v[132:135], v[148:151]
  v_mfma_f32_16x16x32_bf16 v[148:151], v[244:247], v[140:143], v[148:151]
  v_mfma_f32_16x16x32_bf16 v[156:159], v[248:251], v[140:143], 0
  ds_read_b128 v[136:139], v0 offset:6144
  v_mfma_f32_16x16x32_bf16 v[156:159], v[236:239], v[132:135], v[156:159]
  ds_read_b128 v[144:147], v1 offset:6144
  v_mfma_f32_16x16x32_bf16 v[156:159], v[224:227], v[128:131], v[156:159]
  v_cvt_pk_bf16_f32 v64, v148, v149
  v_cvt_pk_bf16_f32 v65, v150, v151
  v_mfma_f32_16x16x32_bf16 v[156:159], v[212:215], v[120:123], v[156:159]
  ds_read_b128 v[152:155], v0 offset:14336
  v_mfma_f32_16x16x32_bf16 v[156:159], v[200:203], v[124:127], v[156:159]
  ds_read_b128 v[160:163], v1 offset:14336
  v_mfma_f32_16x16x32_bf16 v[156:159], v[188:191], v[116:119], v[156:159]
  ds_read_b128 v[164:167], v0 offset:22528
  v_mfma_f32_16x16x32_bf16 v[148:151], v[192:195], v[116:119], 0
  ds_read_b128 v[172:175], v1 offset:22528
  v_mfma_f32_16x16x32_bf16 v[148:151], v[204:207], v[124:127], v[148:151]
  s_add_u32 m0, s58, 12288
  s_add_u32 s36, s59, 49152
  v_mfma_f32_16x16x32_bf16 v[148:151], v[216:219], v[120:123], v[148:151]
  v_cvt_pk_bf16_f32 v66, v156, v157
  v_cvt_pk_bf16_f32 v67, v158, v159
  v_mfma_f32_16x16x32_bf16 v[148:151], v[228:231], v[128:131], v[148:151]
  buffer_load_dwordx4 v180, s[16:19], s36 offen offset:0 lds
  v_mfma_f32_16x16x32_bf16 v[148:151], v[240:243], v[132:135], v[148:151]
  buffer_load_dwordx4 v180, s[16:19], s36 offen offset:1024 lds
  v_mfma_f32_16x16x32_bf16 v[148:151], v[252:255], v[140:143], v[148:151]
  buffer_load_dwordx4 v180, s[16:19], s36 offen offset:2048 lds
  v_mfma_f32_16x16x32_bf16 v[156:159], a[60:63], v[140:143], 0
  v_accvgpr_read_b32 v180, a229
  v_accvgpr_read_b32 v181, a230
  v_mfma_f32_16x16x32_bf16 v[156:159], a[48:51], v[132:135], v[156:159]
  v_accvgpr_read_b32 v182, a231
  v_accvgpr_read_b32 v183, a232
  v_mfma_f32_16x16x32_bf16 v[156:159], a[36:39], v[128:131], v[156:159]
  v_cvt_pk_bf16_f32 v68, v148, v149
  v_cvt_pk_bf16_f32 v69, v150, v151
  v_mfma_f32_16x16x32_bf16 v[156:159], a[24:27], v[120:123], v[156:159]
  s_add_u32 s48, s48, 6291456
  s_add_u32 s49, s48, 786432
  v_mfma_f32_16x16x32_bf16 v[156:159], a[12:15], v[124:127], v[156:159]
  s_sub_u32 s33, s32, 40960
  s_add_u32 s32, s33, 65536
  v_mfma_f32_16x16x32_bf16 v[156:159], a[0:3], v[116:119], v[156:159]
  s_mov_b32 s35, 0
  s_mov_b64 vcc, 0
  v_mfma_f32_16x16x32_bf16 v[148:151], a[4:7], v[116:119], 0
  v_mad_i32_i16 v0, v10, 1, s32 op_sel:[1,0,0,0]
  v_xor_b32 v1, 64, v0
  v_mfma_f32_16x16x32_bf16 v[148:151], a[16:19], v[124:127], v[148:151]
  v_mfma_f32_16x16x32_bf16 v[148:151], a[28:31], v[120:123], v[148:151]
  v_cvt_pk_bf16_f32 v76, v156, v157
  v_cvt_pk_bf16_f32 v77, v158, v159
  v_mfma_f32_16x16x32_bf16 v[148:151], a[40:43], v[128:131], v[148:151]
  v_mfma_f32_16x16x32_bf16 v[148:151], a[52:55], v[132:135], v[148:151]
  v_mfma_f32_16x16x32_bf16 v[148:151], a[64:67], v[140:143], v[148:151]
  v_mfma_f32_16x16x32_bf16 v[156:159], a[68:71], v[140:143], 0
  v_mfma_f32_16x16x32_bf16 v[156:159], a[56:59], v[132:135], v[156:159]
  v_mfma_f32_16x16x32_bf16 v[156:159], a[44:47], v[128:131], v[156:159]
  v_cvt_pk_bf16_f32 v78, v148, v149
  v_cvt_pk_bf16_f32 v79, v150, v151
  v_mfma_f32_16x16x32_bf16 v[156:159], a[32:35], v[120:123], v[156:159]
  v_mfma_f32_16x16x32_bf16 v[156:159], a[20:23], v[124:127], v[156:159]
  v_mfma_f32_16x16x32_bf16 v[156:159], a[8:11], v[116:119], v[156:159]
  v_mfma_f32_16x16x32_bf16 v[148:151], v[116:119], a[72:75], 0
  v_mfma_f32_16x16x32_bf16 v[148:151], v[124:127], a[84:87], v[148:151]
  v_mfma_f32_16x16x32_bf16 v[148:151], v[120:123], a[96:99], v[148:151]
  v_cvt_pk_bf16_f32 v80, v156, v157
  v_cvt_pk_bf16_f32 v81, v158, v159
  v_mfma_f32_16x16x32_bf16 v[148:151], v[128:131], a[108:111], v[148:151]
  v_mfma_f32_16x16x32_bf16 v[148:151], v[132:135], a[120:123], v[148:151]
  v_mfma_f32_16x16x32_bf16 v[148:151], v[140:143], a[132:135], v[148:151]
  v_mfma_f32_16x16x32_bf16 v[156:159], v[140:143], a[136:139], 0
  v_mfma_f32_16x16x32_bf16 v[156:159], v[132:135], a[124:127], v[156:159]
  v_mfma_f32_16x16x32_bf16 v[156:159], v[128:131], a[112:115], v[156:159]
  v_cvt_pk_bf16_f32 v20, v148, v149
  v_cvt_pk_bf16_f32 v21, v150, v151
  v_mfma_f32_16x16x32_bf16 v[156:159], v[120:123], a[100:103], v[156:159]
  v_mfma_f32_16x16x32_bf16 v[156:159], v[124:127], a[88:91], v[156:159]
  s_waitcnt lgkmcnt(0)
  s_waitcnt vmcnt(0)
  s_barrier
  v_mfma_f32_16x16x32_bf16 v[156:159], v[116:119], a[76:79], v[156:159]
  ds_read_b64_tr_b16 a[144:145], v180 offset:0
  ds_read_b64_tr_b16 a[146:147], v180 offset:6144
  v_mfma_f32_16x16x32_bf16 v[148:151], v[116:119], a[80:83], 0
  ds_read_b64_tr_b16 a[148:149], v180 offset:8
  v_mfma_f32_16x16x32_bf16 v[148:151], v[124:127], a[92:95], v[148:151]
  s_add_u32 m0, s33, 40960
  ds_read_b64_tr_b16 a[150:151], v180 offset:6152
  v_mfma_f32_16x16x32_bf16 v[148:151], v[120:123], a[104:107], v[148:151]
  v_cvt_pk_bf16_f32 v28, v156, v157
  v_cvt_pk_bf16_f32 v29, v158, v159
  v_mfma_f32_16x16x32_bf16 v[148:151], v[128:131], a[116:119], v[148:151]
  buffer_load_dwordx4 v6, s[8:11], s48 offen offset:0 nt lds
  v_mfma_f32_16x16x32_bf16 v[148:151], v[132:135], a[128:131], v[148:151]
  ds_read_b64_tr_b16 a[152:153], v181 offset:0
  ds_read_b64_tr_b16 a[154:155], v181 offset:6144
  v_mfma_f32_16x16x32_bf16 v[148:151], v[140:143], a[140:143], v[148:151]
  ds_read_b64_tr_b16 a[156:157], v181 offset:8
  v_mfma_f32_16x16x32_bf16 v[168:171], v[184:187], v[136:139], 0
  ds_read_b64_tr_b16 a[158:159], v181 offset:6152
  v_mfma_f32_16x16x32_bf16 v[168:171], v[196:199], v[144:147], v[168:171]
  ds_read_b64_tr_b16 a[160:161], v180 offset:12288
  ds_read_b64_tr_b16 a[162:163], v180 offset:18432
  v_mfma_f32_16x16x32_bf16 v[168:171], v[208:211], v[152:155], v[168:171]
  v_cvt_pk_bf16_f32 v36, v148, v149
  v_cvt_pk_bf16_f32 v37, v150, v151
  v_mfma_f32_16x16x32_bf16 v[168:171], v[220:223], v[160:163], v[168:171]
  ds_read_b64_tr_b16 a[164:165], v180 offset:12296
  v_mfma_f32_16x16x32_bf16 v[168:171], v[232:235], v[164:167], v[168:171]
  ds_read_b64_tr_b16 a[166:167], v180 offset:18440
  ds_read_b64_tr_b16 a[168:169], v181 offset:12288
  v_mfma_f32_16x16x32_bf16 v[168:171], v[244:247], v[172:175], v[168:171]
  ds_read_b64_tr_b16 a[170:171], v181 offset:18432
  v_mfma_f32_16x16x32_bf16 v[176:179], v[248:251], v[172:175], 0
  s_add_u32 m0, s33, 49024
  ds_read_b64_tr_b16 a[172:173], v181 offset:12296
  v_mfma_f32_16x16x32_bf16 v[176:179], v[236:239], v[164:167], v[176:179]
  buffer_load_dwordx4 v6, s[8:11], s48 offen offset:128 nt lds
  v_mfma_f32_16x16x32_bf16 v[176:179], v[224:227], v[160:163], v[176:179]
  v_cvt_pk_bf16_f32 v70, v168, v169
  v_cvt_pk_bf16_f32 v71, v170, v171
  v_mfma_f32_16x16x32_bf16 v[176:179], v[212:215], v[152:155], v[176:179]
  ds_read_b64_tr_b16 a[174:175], v181 offset:18440
  ds_read_b64_tr_b16 a[176:177], v180 offset:24576
  v_mfma_f32_16x16x32_bf16 v[176:179], v[200:203], v[144:147], v[176:179]
  ds_read_b64_tr_b16 a[178:179], v180 offset:30720
  v_mfma_f32_16x16x32_bf16 v[176:179], v[188:191], v[136:139], v[176:179]
  ds_read_b64_tr_b16 a[180:181], v180 offset:24584
  ds_read_b64_tr_b16 a[182:183], v180 offset:30728
  v_mfma_f32_16x16x32_bf16 v[168:171], v[192:195], v[136:139], 0
  ds_read_b64_tr_b16 a[184:185], v181 offset:24576
  v_mfma_f32_16x16x32_bf16 v[168:171], v[204:207], v[144:147], v[168:171]
  ds_read_b64_tr_b16 a[186:187], v181 offset:30720
  ds_read_b64_tr_b16 a[188:189], v181 offset:24584
  v_mfma_f32_16x16x32_bf16 v[168:171], v[216:219], v[152:155], v[168:171]
  v_cvt_pk_bf16_f32 v72, v176, v177
  v_cvt_pk_bf16_f32 v73, v178, v179
  v_mfma_f32_16x16x32_bf16 v[168:171], v[228:231], v[160:163], v[168:171]
  ds_read_b64_tr_b16 a[190:191], v181 offset:30728
  v_mfma_f32_16x16x32_bf16 v[168:171], v[240:243], v[164:167], v[168:171]
  ds_read_b64_tr_b16 a[192:193], v180 offset:36864
  ds_read_b64_tr_b16 a[194:195], v180 offset:43008
  v_mfma_f32_16x16x32_bf16 v[168:171], v[252:255], v[172:175], v[168:171]
  s_add_u32 m0, s33, 57088
  ds_read_b64_tr_b16 a[196:197], v180 offset:36872
  v_mfma_f32_16x16x32_bf16 v[176:179], a[60:63], v[172:175], 0
  buffer_load_dwordx4 v6, s[8:11], s48 offen offset:256 nt lds
  v_mfma_f32_16x16x32_bf16 v[176:179], a[48:51], v[164:167], v[176:179]
  ds_read_b64_tr_b16 a[198:199], v180 offset:43016
  v_mfma_f32_16x16x32_bf16 v[176:179], a[36:39], v[160:163], v[176:179]
  v_cvt_pk_bf16_f32 v74, v168, v169
  v_cvt_pk_bf16_f32 v75, v170, v171
  v_mfma_f32_16x16x32_bf16 v[176:179], a[24:27], v[152:155], v[176:179]
  ds_read_b64_tr_b16 a[200:201], v181 offset:36864
  ds_read_b64_tr_b16 a[202:203], v181 offset:43008
  v_mfma_f32_16x16x32_bf16 v[176:179], a[12:15], v[144:147], v[176:179]
  ds_read_b64_tr_b16 a[204:205], v181 offset:36872
  v_mfma_f32_16x16x32_bf16 v[176:179], a[0:3], v[136:139], v[176:179]
  ds_read_b64_tr_b16 a[206:207], v181 offset:43016
  ds_read_b64_tr_b16 a[208:209], v182 offset:0
  v_mfma_f32_16x16x32_bf16 v[168:171], a[4:7], v[136:139], 0
  ds_read_b64_tr_b16 a[210:211], v182 offset:1536
  v_mfma_f32_16x16x32_bf16 v[168:171], a[16:19], v[144:147], v[168:171]
  ds_read_b64_tr_b16 a[212:213], v182 offset:8
  ds_read_b64_tr_b16 a[214:215], v182 offset:1544
  v_mfma_f32_16x16x32_bf16 v[168:171], a[28:31], v[152:155], v[168:171]
  v_cvt_pk_bf16_f32 v82, v176, v177
  v_cvt_pk_bf16_f32 v83, v178, v179
  v_mfma_f32_16x16x32_bf16 v[168:171], a[40:43], v[160:163], v[168:171]
  ds_read_b64_tr_b16 a[216:217], v183 offset:0
  v_mfma_f32_16x16x32_bf16 v[168:171], a[52:55], v[164:167], v[168:171]
  s_add_u32 m0, s33, 45056
  ds_read_b64_tr_b16 a[218:219], v183 offset:1536
  v_mfma_f32_16x16x32_bf16 v[168:171], a[64:67], v[172:175], v[168:171]
  buffer_load_dwordx4 v6, s[8:11], s49 offen offset:0 nt lds
  v_mfma_f32_16x16x32_bf16 v[176:179], a[68:71], v[172:175], 0
  ds_read_b64_tr_b16 a[220:221], v183 offset:8
  ds_read_b64_tr_b16 a[222:223], v183 offset:1544
  v_mfma_f32_16x16x32_bf16 v[176:179], a[56:59], v[164:167], v[176:179]
  ds_read_b64_tr_b16 a[224:225], v182 offset:12288
  v_mfma_f32_16x16x32_bf16 v[176:179], a[44:47], v[160:163], v[176:179]
  v_cvt_pk_bf16_f32 v84, v168, v169
  v_cvt_pk_bf16_f32 v85, v170, v171
  v_mfma_f32_16x16x32_bf16 v[176:179], a[32:35], v[152:155], v[176:179]
  ds_read_b64_tr_b16 a[226:227], v182 offset:13824
  ds_read_b64_tr_b16 a[228:229], v182 offset:12296
  v_mfma_f32_16x16x32_bf16 v[176:179], a[20:23], v[144:147], v[176:179]
  ds_read_b64_tr_b16 a[230:231], v182 offset:13832
  v_mfma_f32_16x16x32_bf16 v[176:179], a[8:11], v[136:139], v[176:179]
  ds_read_b64_tr_b16 a[232:233], v183 offset:12288
  ds_read_b64_tr_b16 a[234:235], v183 offset:13824
  v_mfma_f32_16x16x32_bf16 v[168:171], v[136:139], a[72:75], 0
  ds_read_b64_tr_b16 a[236:237], v183 offset:12296
  v_mfma_f32_16x16x32_bf16 v[168:171], v[144:147], a[84:87], v[168:171]
  ds_read_b64_tr_b16 a[238:239], v183 offset:13832
  v_mfma_f32_16x16x32_bf16 v[168:171], v[152:155], a[96:99], v[168:171]
  v_cvt_pk_bf16_f32 v86, v176, v177
  v_cvt_pk_bf16_f32 v87, v178, v179
  v_mfma_f32_16x16x32_bf16 v[168:171], v[160:163], a[108:111], v[168:171]
  s_add_u32 m0, s33, 53120
  v_mfma_f32_16x16x32_bf16 v[168:171], v[164:167], a[120:123], v[168:171]
  buffer_load_dwordx4 v6, s[8:11], s49 offen offset:128 nt lds
  v_mfma_f32_16x16x32_bf16 v[168:171], v[172:175], a[132:135], v[168:171]
  v_mfma_f32_16x16x32_bf16 v[176:179], v[172:175], a[136:139], 0
  s_waitcnt lgkmcnt(0)
  s_waitcnt vmcnt(23)
  s_barrier
  v_mfma_f32_16x16x32_bf16 v[176:179], v[164:167], a[124:127], v[176:179]
  v_mfma_f32_16x16x32_bf16 v[176:179], v[160:163], a[112:115], v[176:179]
  v_cvt_pk_bf16_f32 v22, v168, v169
  v_cvt_pk_bf16_f32 v23, v170, v171
  v_mfma_f32_16x16x32_bf16 v[176:179], v[152:155], a[100:103], v[176:179]
  ds_read_b128 a[244:247], v3 offset:0
  v_mfma_f32_16x16x32_bf16 v[176:179], v[144:147], a[88:91], v[176:179]
  ds_read_b128 a[248:251], v3 offset:4096
  v_mfma_f32_16x16x32_bf16 v[176:179], v[136:139], a[76:79], v[176:179]
  ds_read_b128 a[252:255], v3 offset:8192
  v_mfma_f32_16x16x32_bf16 v[168:171], v[136:139], a[80:83], 0
  ds_read_b128 v[180:183], v3 offset:12288
  v_mfma_f32_16x16x32_bf16 v[168:171], v[144:147], a[92:95], v[168:171]
  s_add_u32 m0, s33, 61184
  v_mfma_f32_16x16x32_bf16 v[168:171], v[152:155], a[104:107], v[168:171]
  v_cvt_pk_bf16_f32 v30, v176, v177
  v_cvt_pk_bf16_f32 v31, v178, v179
  v_mfma_f32_16x16x32_bf16 v[168:171], v[160:163], a[116:119], v[168:171]
  buffer_load_dwordx4 v6, s[8:11], s49 offen offset:256 nt lds
  v_mfma_f32_16x16x32_bf16 v[168:171], v[164:167], a[128:131], v[168:171]
  s_add_u32 s48, s48, 6291456
  s_add_u32 s49, s48, 786432
  v_mfma_f32_16x16x32_bf16 v[168:171], v[172:175], a[140:143], v[168:171]
  s_branch L_s
.p2align 6
L_s:
  v_mfma_f32_16x16x32_bf16 v[116:119], v[46:49], v[70:73], v[112:115]
  v_mfma_f32_16x16x32_bf16 v[124:127], v[58:61], v[70:73], v[108:111]
  s_cmp_lg_u32 s31, 0
  v_mfma_f32_16x16x32_bf16 v[120:123], v[76:79], v[70:73], v[104:107]
  v_cvt_pk_bf16_f32 v38, v168, v169
  v_cvt_pk_bf16_f32 v39, v170, v171
  v_mfma_f32_16x16x32_bf16 v[128:131], v[82:85], v[70:73], v[100:103]
  v_mfma_f32_16x16x16_bf16 v[116:119], v[50:51], v[74:75], v[116:119]
  s_cbranch_scc1 L_special
  v_mfma_f32_16x16x16_bf16 v[124:127], v[62:63], v[74:75], v[124:127]
  v_mfma_f32_16x16x16_bf16 v[120:123], v[80:81], v[74:75], v[120:123]
  v_mfma_f32_16x16x16_bf16 v[128:131], v[86:87], v[74:75], v[128:131]
  v_exp_f32 v116, v116
  v_mfma_f32_16x16x32_bf16 v[132:135], v[46:49], v[64:67], v[108:111]
  v_exp_f32 v117, v117
  v_mfma_f32_16x16x32_bf16 v[140:143], v[58:61], v[64:67], v[104:107]
  v_exp_f32 v118, v118
  v_mfma_f32_16x16x32_bf16 v[136:139], v[76:79], v[64:67], v[100:103]
  v_exp_f32 v119, v119
  v_mfma_f32_16x16x32_bf16 v[144:147], v[82:85], v[64:67], v[96:99]
  v_cvt_pk_bf16_f32 v116, v116, v117
  v_cvt_pk_bf16_f32 v117, v118, v119
  v_mfma_f32_16x16x16_bf16 v[132:135], v[50:51], v[68:69], v[132:135]
  v_exp_f32 v124, v124
  v_mfma_f32_16x16x16_bf16 v[140:143], v[62:63], v[68:69], v[140:143]
  v_exp_f32 v125, v125
  v_mfma_f32_16x16x16_bf16 v[136:139], v[80:81], v[68:69], v[136:139]
  v_exp_f32 v126, v126
  v_mfma_f32_16x16x16_bf16 v[144:147], v[86:87], v[68:69], v[144:147]
  ds_read_b128 v[64:67], v3 offset:16384
  ds_read_b128 v[68:71], v3 offset:20480
  v_mfma_f32_16x16x32_bf16 v[148:151], v[46:49], v[52:55], v[104:107]
  v_exp_f32 v127, v127
  v_mfma_f32_16x16x32_bf16 v[156:159], v[58:61], v[52:55], v[100:103]
  v_cvt_pk_bf16_f32 v118, v124, v125
  v_cvt_pk_bf16_f32 v119, v126, v127
  v_mfma_f32_16x16x32_bf16 v[152:155], v[76:79], v[52:55], v[96:99]
  v_exp_f32 v120, v120
  v_mfma_f32_16x16x32_bf16 v[160:163], v[82:85], v[52:55], v[92:95]
  v_exp_f32 v121, v121
  v_mfma_f32_16x16x16_bf16 v[148:151], v[50:51], v[56:57], v[148:151]
  v_exp_f32 v122, v122
  v_mfma_f32_16x16x16_bf16 v[156:159], v[62:63], v[56:57], v[156:159]
  v_exp_f32 v123, v123
  v_mfma_f32_16x16x16_bf16 v[152:155], v[80:81], v[56:57], v[152:155]
  v_cvt_pk_bf16_f32 v120, v120, v121
  v_cvt_pk_bf16_f32 v121, v122, v123
  v_mfma_f32_16x16x16_bf16 v[160:163], v[86:87], v[56:57], v[160:163]
  v_exp_f32 v128, v128
  v_mfma_f32_16x16x32_bf16 v[164:167], v[46:49], v[40:43], v[100:103]
  v_exp_f32 v129, v129
  v_mfma_f32_16x16x32_bf16 v[172:175], v[58:61], v[40:43], v[96:99]
  v_exp_f32 v130, v130
  v_mfma_f32_16x16x32_bf16 v[168:171], v[76:79], v[40:43], v[92:95]
  v_exp_f32 v131, v131
  v_mfma_f32_16x16x32_bf16 v[176:179], v[82:85], v[40:43], v[88:91]
  v_exp_f32 v132, v132
  v_mfma_f32_16x16x16_bf16 v[164:167], v[50:51], v[44:45], v[164:167]
  v_exp_f32 v133, v133
  v_mfma_f32_16x16x16_bf16 v[172:175], v[62:63], v[44:45], v[172:175]
  v_cvt_pk_bf16_f32 v122, v128, v129
  v_cvt_pk_bf16_f32 v123, v130, v131
  v_mfma_f32_16x16x16_bf16 v[168:171], v[80:81], v[44:45], v[168:171]
  v_exp_f32 v134, v134
  v_mfma_f32_16x16x16_bf16 v[176:179], v[86:87], v[44:45], v[176:179]
  s_waitcnt lgkmcnt(0)
  v_cvt_pk_bf16_f32 v132, v132, v133
L_pj:
  v_mfma_f32_16x16x32_bf16 v[40:43], a[144:147], a[244:247], 0
  ds_read_b128 v[72:75], v3 offset:256
  ds_read_b128 v[56:59], v3 offset:4352
  v_mfma_f32_16x16x32_bf16 v[40:43], a[160:163], a[248:251], v[40:43]
  v_exp_f32 v135, v135
  v_mfma_f32_16x16x32_bf16 v[40:43], a[176:179], a[252:255], v[40:43]
  ds_read_b128 v[60:63], v3 offset:8448
  ds_read_b128 v[76:79], v3 offset:12544
  v_mfma_f32_16x16x32_bf16 v[40:43], a[192:195], v[180:183], v[40:43]
  v_exp_f32 v140, v140
  v_mfma_f32_16x16x32_bf16 v[40:43], a[208:211], v[64:67], v[40:43]
  ds_read_b128 v[80:83], v3 offset:16640
  ds_read_b128 v[84:87], v3 offset:20736
  v_mfma_f32_16x16x32_bf16 v[40:43], a[224:227], v[68:71], v[40:43]
  v_exp_f32 v141, v141
  v_mfma_f32_16x16x32_bf16 v[44:47], a[228:231], v[68:71], 0
  v_exp_f32 v142, v142
  v_mfma_f32_16x16x32_bf16 v[44:47], a[212:215], v[64:67], v[44:47]
  v_exp_f32 v143, v143
  v_mfma_f32_16x16x32_bf16 v[44:47], a[196:199], v[180:183], v[44:47]
  v_cvt_pk_bf16_f32 v40, v40, v41
  v_cvt_pk_bf16_f32 v41, v42, v43
  v_mfma_f32_16x16x32_bf16 v[44:47], a[180:183], a[252:255], v[44:47]
  ds_read_b128 v[124:127], v2 offset:512
  ds_read_b128 v[128:131], v2 offset:4608
  v_mfma_f32_16x16x32_bf16 v[44:47], a[164:167], a[248:251], v[44:47]
  v_cvt_pk_bf16_f32 v133, v134, v135
  v_cvt_pk_bf16_f32 v134, v140, v141
  v_mfma_f32_16x16x32_bf16 v[44:47], a[148:151], a[244:247], v[44:47]
  s_waitcnt lgkmcnt(2)
  v_cvt_pk_bf16_f32 v135, v142, v143
  v_mfma_f32_16x16x32_bf16 v[48:51], a[144:147], v[72:75], 0
  ds_read_b128 a[244:247], v2 offset:8704
  ds_read_b128 a[248:251], v2 offset:12800
  v_mfma_f32_16x16x32_bf16 v[48:51], a[160:163], v[56:59], v[48:51]
  v_exp_f32 v136, v136
  v_mfma_f32_16x16x32_bf16 v[48:51], a[176:179], v[60:63], v[48:51]
  v_cvt_pk_bf16_f32 v42, v44, v45
  v_cvt_pk_bf16_f32 v43, v46, v47
  v_mfma_f32_16x16x32_bf16 v[48:51], a[192:195], v[76:79], v[48:51]
  buffer_store_dwordx4 v[40:43], v7, s[24:27], s40 offen nt
  v_mfma_f32_16x16x32_bf16 v[48:51], a[208:211], v[80:83], v[48:51]
  ds_read_b128 a[252:255], v2 offset:16896
  ds_read_b128 v[180:183], v2 offset:20992
  v_mfma_f32_16x16x32_bf16 v[48:51], a[224:227], v[84:87], v[48:51]
  v_exp_f32 v137, v137
  v_mfma_f32_16x16x32_bf16 v[52:55], a[228:231], v[84:87], 0
  v_exp_f32 v138, v138
  v_mfma_f32_16x16x32_bf16 v[52:55], a[212:215], v[80:83], v[52:55]
  v_exp_f32 v139, v139
  v_mfma_f32_16x16x32_bf16 v[52:55], a[196:199], v[76:79], v[52:55]
  v_cvt_pk_bf16_f32 v48, v48, v49
  v_cvt_pk_bf16_f32 v49, v50, v51
  v_mfma_f32_16x16x32_bf16 v[52:55], a[180:183], v[60:63], v[52:55]
  v_exp_f32 v144, v144
  v_mfma_f32_16x16x32_bf16 v[52:55], a[164:167], v[56:59], v[52:55]
  v_exp_f32 v145, v145
  v_mfma_f32_16x16x32_bf16 v[52:55], a[148:151], v[72:75], v[52:55]
  s_waitcnt lgkmcnt(0)
  v_cvt_pk_bf16_f32 v136, v136, v137
  v_mfma_f32_16x16x32_bf16 v[40:43], a[144:147], v[124:127], 0
  v_cvt_pk_bf16_f32 v137, v138, v139
  v_cvt_pk_bf16_f32 v138, v144, v145
  v_mfma_f32_16x16x32_bf16 v[40:43], a[160:163], v[128:131], v[40:43]
  v_exp_f32 v146, v146
  v_mfma_f32_16x16x32_bf16 v[40:43], a[176:179], a[244:247], v[40:43]
  v_cvt_pk_bf16_f32 v50, v52, v53
  v_cvt_pk_bf16_f32 v51, v54, v55
  v_mfma_f32_16x16x32_bf16 v[40:43], a[192:195], a[248:251], v[40:43]
  buffer_store_dwordx4 v[48:51], v7, s[24:27], s41 offen nt
  v_mfma_f32_16x16x32_bf16 v[40:43], a[208:211], a[252:255], v[40:43]
  ds_read_b128 v[72:75], v2 offset:768
  ds_read_b128 v[56:59], v2 offset:4864
  v_mfma_f32_16x16x32_bf16 v[40:43], a[224:227], v[180:183], v[40:43]
  v_exp_f32 v147, v147
  v_mfma_f32_16x16x32_bf16 v[44:47], a[228:231], v[180:183], 0
  ds_read_b128 v[60:63], v2 offset:8960
  ds_read_b128 v[76:79], v2 offset:13056
  v_mfma_f32_16x16x32_bf16 v[44:47], a[212:215], a[252:255], v[44:47]
  v_cvt_pk_bf16_f32 v139, v146, v147
  v_mov_b64 v[144:145], 0
  v_mfma_f32_16x16x32_bf16 v[44:47], a[196:199], a[248:251], v[44:47]
  v_cvt_pk_bf16_f32 v40, v40, v41
  v_cvt_pk_bf16_f32 v41, v42, v43
  v_mfma_f32_16x16x32_bf16 v[44:47], a[180:183], a[244:247], v[44:47]
  ds_read_b128 v[80:83], v2 offset:17152
  ds_read_b128 v[84:87], v2 offset:21248
  v_mfma_f32_16x16x32_bf16 v[44:47], a[164:167], v[128:131], v[44:47]
  v_exp_f32 v148, v148
  v_mfma_f32_16x16x32_bf16 v[44:47], a[148:151], v[124:127], v[44:47]
  v_exp_f32 v149, v149
  v_mfma_f32_16x16x32_bf16 v[48:51], a[152:155], v[124:127], 0
  v_exp_f32 v150, v150
  v_mfma_f32_16x16x32_bf16 v[48:51], a[168:171], v[128:131], v[48:51]
  v_exp_f32 v151, v151
  v_mfma_f32_16x16x32_bf16 v[48:51], a[184:187], a[244:247], v[48:51]
  v_cvt_pk_bf16_f32 v42, v44, v45
  v_cvt_pk_bf16_f32 v43, v46, v47
  v_mfma_f32_16x16x32_bf16 v[48:51], a[200:203], a[248:251], v[48:51]
  buffer_store_dwordx4 v[40:43], v7, s[24:27], s42 offen nt
  v_mfma_f32_16x16x32_bf16 v[48:51], a[216:219], a[252:255], v[48:51]
  v_exp_f32 v156, v156
  v_mfma_f32_16x16x32_bf16 v[48:51], a[232:235], v[180:183], v[48:51]
  v_exp_f32 v157, v157
  v_mfma_f32_16x16x32_bf16 v[52:55], a[236:239], v[180:183], 0
  v_cvt_pk_bf16_f32 v148, v148, v149
  v_cvt_pk_bf16_f32 v149, v150, v151
  v_mfma_f32_16x16x32_bf16 v[52:55], a[220:223], a[252:255], v[52:55]
  v_exp_f32 v158, v158
  v_mfma_f32_16x16x32_bf16 v[52:55], a[204:207], a[248:251], v[52:55]
  v_cvt_pk_bf16_f32 v48, v48, v49
  v_cvt_pk_bf16_f32 v49, v50, v51
  v_mfma_f32_16x16x32_bf16 v[52:55], a[188:191], a[244:247], v[52:55]
  v_exp_f32 v159, v159
  v_mfma_f32_16x16x32_bf16 v[52:55], a[172:175], v[128:131], v[52:55]
  v_exp_f32 v152, v152
  v_mfma_f32_16x16x32_bf16 v[52:55], a[156:159], v[124:127], v[52:55]
  s_waitcnt lgkmcnt(0)
  v_cvt_pk_bf16_f32 v150, v156, v157
  v_mfma_f32_16x16x32_bf16 v[40:43], a[144:147], v[72:75], 0
  v_exp_f32 v153, v153
  v_mfma_f32_16x16x32_bf16 v[40:43], a[160:163], v[56:59], v[40:43]
  v_cvt_pk_bf16_f32 v151, v158, v159
  v_cvt_pk_bf16_f32 v152, v152, v153
  v_mfma_f32_16x16x32_bf16 v[40:43], a[176:179], v[60:63], v[40:43]
  v_cvt_pk_bf16_f32 v50, v52, v53
  v_cvt_pk_bf16_f32 v51, v54, v55
  v_mfma_f32_16x16x32_bf16 v[40:43], a[192:195], v[76:79], v[40:43]
  buffer_store_dwordx4 v[48:51], v8, s[24:27], s42 offen nt
  v_mfma_f32_16x16x32_bf16 v[40:43], a[208:211], v[80:83], v[40:43]
  v_exp_f32 v154, v154
  v_mfma_f32_16x16x32_bf16 v[40:43], a[224:227], v[84:87], v[40:43]
  v_exp_f32 v155, v155
  v_mfma_f32_16x16x32_bf16 v[44:47], a[228:231], v[84:87], 0
  v_exp_f32 v160, v160
  v_mfma_f32_16x16x32_bf16 v[44:47], a[212:215], v[80:83], v[44:47]
  v_exp_f32 v161, v161
  v_mfma_f32_16x16x32_bf16 v[44:47], a[196:199], v[76:79], v[44:47]
  v_cvt_pk_bf16_f32 v40, v40, v41
  v_cvt_pk_bf16_f32 v41, v42, v43
  v_mfma_f32_16x16x32_bf16 v[44:47], a[180:183], v[60:63], v[44:47]
  v_cvt_pk_bf16_f32 v153, v154, v155
  v_cvt_pk_bf16_f32 v154, v160, v161
  v_mfma_f32_16x16x32_bf16 v[44:47], a[164:167], v[56:59], v[44:47]
  v_exp_f32 v162, v162
  v_mfma_f32_16x16x32_bf16 v[44:47], a[148:151], v[72:75], v[44:47]
  v_exp_f32 v163, v163
  v_mfma_f32_16x16x32_bf16 v[48:51], a[152:155], v[72:75], 0
  v_exp_f32 v164, v164
  v_mfma_f32_16x16x32_bf16 v[48:51], a[168:171], v[56:59], v[48:51]
  v_exp_f32 v165, v165
  v_mfma_f32_16x16x32_bf16 v[48:51], a[184:187], v[60:63], v[48:51]
  v_cvt_pk_bf16_f32 v42, v44, v45
  v_cvt_pk_bf16_f32 v43, v46, v47
  v_mfma_f32_16x16x32_bf16 v[48:51], a[200:203], v[76:79], v[48:51]
  buffer_store_dwordx4 v[40:43], v7, s[24:27], s43 offen nt
  v_mfma_f32_16x16x32_bf16 v[48:51], a[216:219], v[80:83], v[48:51]
  v_exp_f32 v166, v166
  v_mfma_f32_16x16x32_bf16 v[48:51], a[232:235], v[84:87], v[48:51]
  v_exp_f32 v167, v167
  v_mfma_f32_16x16x32_bf16 v[52:55], a[236:239], v[84:87], 0
  v_cvt_pk_bf16_f32 v155, v162, v163
  v_cvt_pk_bf16_f32 v164, v164, v165
  v_mfma_f32_16x16x32_bf16 v[52:55], a[220:223], v[80:83], v[52:55]
  v_exp_f32 v172, v172
  v_mfma_f32_16x16x32_bf16 v[52:55], a[204:207], v[76:79], v[52:55]
  v_cvt_pk_bf16_f32 v48, v48, v49
  v_cvt_pk_bf16_f32 v49, v50, v51
  v_mfma_f32_16x16x32_bf16 v[52:55], a[188:191], v[60:63], v[52:55]
  v_exp_f32 v173, v173
  v_mfma_f32_16x16x32_bf16 v[52:55], a[172:175], v[56:59], v[52:55]
  v_exp_f32 v174, v174
  v_mfma_f32_16x16x32_bf16 v[52:55], a[156:159], v[72:75], v[52:55]
  v_cvt_pk_bf16_f32 v165, v166, v167
  s_cbranch_scc1 L_fin
  v_smfmac_f32_16x16x64_bf16 v[144:147], a[240:243], v[116:123], v10
  v_exp_f32 v175, v175
  v_mfma_f32_16x16x32_bf16 v[124:127], v[20:23], v[120:123], 0
  v_cvt_pk_bf16_f32 v166, v172, v173
  v_cvt_pk_bf16_f32 v167, v174, v175
  v_mfma_f32_16x16x32_bf16 v[124:127], v[16:19], v[116:119], v[124:127]
  v_cvt_pk_bf16_f32 v50, v52, v53
  v_cvt_pk_bf16_f32 v51, v54, v55
  v_mfma_f32_16x16x32_bf16 v[128:131], v[24:27], v[116:119], 0
  v_add_f32 v15, v144, v145
  v_mov_b64 v[144:145], 0
  v_mfma_f32_16x16x32_bf16 v[128:131], v[28:31], v[120:123], v[128:131]
  buffer_store_dwordx4 v[48:51], v8, s[24:27], s43 offen nt
  v_mfma_f32_16x16x32_bf16 v[140:143], v[36:39], v[120:123], 0
  v_exp_f32 v168, v168
  v_mfma_f32_16x16x32_bf16 v[140:143], v[32:35], v[116:119], v[140:143]
  v_exp_f32 v169, v169
  v_smfmac_f32_16x16x64_bf16 v[144:147], a[240:243], v[132:139], v10
  v_exp_f32 v170, v170
  v_mfma_f32_16x16x32_bf16 v[116:119], v[20:23], v[136:139], 0
  v_exp_f32 v171, v171
  v_mfma_f32_16x16x32_bf16 v[116:119], v[16:19], v[132:135], v[116:119]
  v_cvt_pk_bf16_f32 v168, v168, v169
  v_cvt_pk_bf16_f32 v169, v170, v171
  v_mfma_f32_16x16x32_bf16 v[120:123], v[24:27], v[132:135], 0
L_hop3:
  s_cbranch_execz L_hopped
  v_add_f32 v14, v144, v145
  v_mov_b64 v[144:145], 0
  v_mfma_f32_16x16x32_bf16 v[120:123], v[28:31], v[136:139], v[120:123]
  v_exp_f32 v176, v176
  v_mfma_f32_16x16x32_bf16 v[156:159], v[36:39], v[136:139], 0
  v_exp_f32 v177, v177
  v_mfma_f32_16x16x32_bf16 v[156:159], v[32:35], v[132:135], v[156:159]
  v_exp_f32 v178, v178
  v_smfmac_f32_16x16x64_bf16 v[144:147], a[240:243], v[148:155], v10
  v_exp_f32 v179, v179
  v_mfma_f32_16x16x32_bf16 v[132:135], v[20:23], v[152:155], 0
  v_cvt_pk_bf16_f32 v170, v176, v177
  v_cvt_pk_bf16_f32 v171, v178, v179
  v_mfma_f32_16x16x32_bf16 v[132:135], v[16:19], v[148:151], v[132:135]
  v_rcp_f32 v15, v15
  v_mfma_f32_16x16x32_bf16 v[136:139], v[24:27], v[148:151], 0
  v_add_f32 v13, v144, v145
  v_mov_b64 v[144:145], 0
  v_mfma_f32_16x16x32_bf16 v[136:139], v[28:31], v[152:155], v[136:139]
  ds_read_b128 a[244:247], v0 offset:0
  ds_read_b128 a[248:251], v1 offset:0
  v_mfma_f32_16x16x32_bf16 v[160:163], v[36:39], v[152:155], 0
  v_rcp_f32 v14, v14
  v_mfma_f32_16x16x32_bf16 v[160:163], v[32:35], v[148:151], v[160:163]
  ds_read_b128 a[252:255], v0 offset:8192
  ds_read_b128 v[180:183], v1 offset:8192
  v_smfmac_f32_16x16x64_bf16 v[144:147], a[240:243], v[164:171], v10
  v_mul_f32 v124, v15, v124
  v_mul_f32 v125, v15, v125
  v_mfma_f32_16x16x32_bf16 v[148:151], v[20:23], v[168:171], 0
  ds_read_b128 v[64:67], v0 offset:16384
  ds_read_b128 v[68:71], v1 offset:16384
  v_mfma_f32_16x16x32_bf16 v[148:151], v[16:19], v[164:167], v[148:151]
  v_mul_f32 v126, v15, v126
  v_mul_f32 v127, v15, v127
  v_mfma_f32_16x16x32_bf16 v[152:155], v[24:27], v[164:167], 0
  v_add_f32 v12, v144, v145
  v_cvt_pk_bf16_f32 v124, v124, v125
  v_mfma_f32_16x16x32_bf16 v[152:155], v[28:31], v[168:171], v[152:155]
  v_cvt_pk_bf16_f32 v125, v126, v127
  v_mul_f32 v128, v15, v128
  v_mfma_f32_16x16x32_bf16 v[172:175], v[36:39], v[168:171], 0
  v_mul_f32 v129, v15, v129
  v_mul_f32 v130, v15, v130
  v_mfma_f32_16x16x32_bf16 v[172:175], v[32:35], v[164:167], v[172:175]
  s_waitcnt lgkmcnt(4)
  s_cbranch_vccnz L_epi
  v_mfma_f32_16x16x32_bf16 v[76:79], v[184:187], a[244:247], 0
  v_mul_f32 v131, v15, v131
  v_cvt_pk_bf16_f32 v126, v128, v129
  v_mfma_f32_16x16x32_bf16 v[76:79], v[196:199], a[248:251], v[76:79]
  s_waitcnt lgkmcnt(2)
  v_cvt_pk_bf16_f32 v127, v130, v131
  v_mfma_f32_16x16x32_bf16 v[76:79], v[208:211], a[252:255], v[76:79]
  ds_write_b128 v4, v[124:127] offset:768
  v_mfma_f32_16x16x32_bf16 v[76:79], v[220:223], v[180:183], v[76:79]
  s_waitcnt lgkmcnt(1)
  s_add_u32 m0, s33, 0
  v_mfma_f32_16x16x32_bf16 v[76:79], v[232:235], v[64:67], v[76:79]
  buffer_load_dwordx4 v6, s[8:11], s48 offen offset:0 nt lds
  v_mfma_f32_16x16x32_bf16 v[76:79], v[244:247], v[68:71], v[76:79]
  v_mul_f32 v140, v15, v140
  v_mul_f32 v141, v15, v141
  v_mfma_f32_16x16x32_bf16 v[80:83], v[248:251], v[68:71], 0
  v_mul_f32 v142, v15, v142
  v_mul_f32 v143, v15, v143
  v_mfma_f32_16x16x32_bf16 v[80:83], v[236:239], v[64:67], v[80:83]
  v_cvt_pk_bf16_f32 v140, v140, v141
  v_cvt_pk_bf16_f32 v141, v142, v143
  v_mfma_f32_16x16x32_bf16 v[80:83], v[224:227], v[180:183], v[80:83]
  v_cvt_pk_bf16_f32 v40, v76, v77
  v_cvt_pk_bf16_f32 v41, v78, v79
  v_mfma_f32_16x16x32_bf16 v[80:83], v[212:215], a[252:255], v[80:83]
  ds_write_b64 v5, v[140:141] offset:768
  v_mfma_f32_16x16x32_bf16 v[80:83], v[200:203], a[248:251], v[80:83]
  v_rcp_f32 v13, v13
  v_mfma_f32_16x16x32_bf16 v[80:83], v[188:191], a[244:247], v[80:83]
  v_mul_f32 v116, v14, v116
  v_mul_f32 v117, v14, v117
  v_mfma_f32_16x16x32_bf16 v[76:79], v[192:195], a[244:247], 0
  v_mul_f32 v118, v14, v118
  v_mul_f32 v119, v14, v119
  v_mfma_f32_16x16x32_bf16 v[76:79], v[204:207], a[248:251], v[76:79]
  v_cvt_pk_bf16_f32 v116, v116, v117
  v_cvt_pk_bf16_f32 v117, v118, v119
  v_mfma_f32_16x16x32_bf16 v[76:79], v[216:219], a[252:255], v[76:79]
  v_cvt_pk_bf16_f32 v42, v80, v81
  v_cvt_pk_bf16_f32 v43, v82, v83
  v_mfma_f32_16x16x32_bf16 v[76:79], v[228:231], v[180:183], v[76:79]
  v_mul_f32 v120, v14, v120
  v_mul_f32 v121, v14, v121
  v_mfma_f32_16x16x32_bf16 v[76:79], v[240:243], v[64:67], v[76:79]
  v_mul_f32 v122, v14, v122
  v_mul_f32 v123, v14, v123
  v_mfma_f32_16x16x32_bf16 v[76:79], v[252:255], v[68:71], v[76:79]
  v_cvt_pk_bf16_f32 v118, v120, v121
  v_cvt_pk_bf16_f32 v119, v122, v123
  v_mfma_f32_16x16x32_bf16 v[80:83], a[60:63], v[68:71], 0
  ds_write_b128 v4, v[116:119] offset:512
  v_mfma_f32_16x16x32_bf16 v[80:83], a[48:51], v[64:67], v[80:83]
  s_add_u32 m0, s33, 8064
  v_mul_f32 v156, v14, v156
  v_mfma_f32_16x16x32_bf16 v[80:83], a[36:39], v[180:183], v[80:83]
  v_cvt_pk_bf16_f32 v44, v76, v77
  v_cvt_pk_bf16_f32 v45, v78, v79
  v_mfma_f32_16x16x32_bf16 v[80:83], a[24:27], a[252:255], v[80:83]
  buffer_load_dwordx4 v6, s[8:11], s48 offen offset:128 nt lds
  v_mfma_f32_16x16x32_bf16 v[80:83], a[12:15], a[248:251], v[80:83]
  v_mul_f32 v157, v14, v157
  v_mul_f32 v158, v14, v158
  v_mfma_f32_16x16x32_bf16 v[80:83], a[0:3], a[244:247], v[80:83]
  v_mul_f32 v159, v14, v159
  v_cvt_pk_bf16_f32 v156, v156, v157
  v_mfma_f32_16x16x32_bf16 v[76:79], a[4:7], a[244:247], 0
  v_cvt_pk_bf16_f32 v157, v158, v159
  v_mfma_f32_16x16x32_bf16 v[76:79], a[16:19], a[248:251], v[76:79]
  ds_write_b64 v5, v[156:157] offset:512
  v_mfma_f32_16x16x32_bf16 v[76:79], a[28:31], a[252:255], v[76:79]
  v_cvt_pk_bf16_f32 v46, v80, v81
  v_cvt_pk_bf16_f32 v47, v82, v83
  v_mfma_f32_16x16x32_bf16 v[76:79], a[40:43], v[180:183], v[76:79]
  v_rcp_f32 v12, v12
  v_mfma_f32_16x16x32_bf16 v[76:79], a[52:55], v[64:67], v[76:79]
  v_mul_f32 v132, v13, v132
  v_mul_f32 v133, v13, v133
  v_mfma_f32_16x16x32_bf16 v[76:79], a[64:67], v[68:71], v[76:79]
  v_mul_f32 v134, v13, v134
  v_mul_f32 v135, v13, v135
  v_mfma_f32_16x16x32_bf16 v[80:83], a[68:71], v[68:71], 0
  v_cvt_pk_bf16_f32 v132, v132, v133
  v_cvt_pk_bf16_f32 v133, v134, v135
  v_mfma_f32_16x16x32_bf16 v[80:83], a[56:59], v[64:67], v[80:83]
  v_mul_f32 v136, v13, v136
  v_mul_f32 v137, v13, v137
  v_mfma_f32_16x16x32_bf16 v[80:83], a[44:47], v[180:183], v[80:83]
  v_cvt_pk_bf16_f32 v48, v76, v77
  v_cvt_pk_bf16_f32 v49, v78, v79
  v_mfma_f32_16x16x32_bf16 v[80:83], a[32:35], a[252:255], v[80:83]
  v_mul_f32 v138, v13, v138
  v_mul_f32 v139, v13, v139
  v_mfma_f32_16x16x32_bf16 v[80:83], a[20:23], a[248:251], v[80:83]
  v_cvt_pk_bf16_f32 v134, v136, v137
  v_cvt_pk_bf16_f32 v135, v138, v139
  v_mfma_f32_16x16x32_bf16 v[80:83], a[8:11], a[244:247], v[80:83]
  s_add_u32 m0, s33, 16128
  v_mfma_f32_16x16x32_bf16 v[76:79], a[244:247], a[72:75], 0
  buffer_load_dwordx4 v6, s[8:11], s48 offen offset:256 nt lds
  v_mfma_f32_16x16x32_bf16 v[76:79], a[248:251], a[84:87], v[76:79]
  ds_write_b128 v4, v[132:135] offset:256
  v_mfma_f32_16x16x32_bf16 v[76:79], a[252:255], a[96:99], v[76:79]
  v_cvt_pk_bf16_f32 v50, v80, v81
  v_cvt_pk_bf16_f32 v51, v82, v83
  v_mfma_f32_16x16x32_bf16 v[76:79], v[180:183], a[108:111], v[76:79]
  ds_read_b128 v[72:75], v0 offset:2048
  v_mul_f32 v160, v13, v160
  v_mfma_f32_16x16x32_bf16 v[76:79], v[64:67], a[120:123], v[76:79]
  ds_read_b128 v[84:87], v1 offset:2048
  v_mul_f32 v161, v13, v161
  v_mfma_f32_16x16x32_bf16 v[76:79], v[68:71], a[132:135], v[76:79]
  ds_read_b128 v[164:167], v0 offset:10240
  v_mul_f32 v162, v13, v162
  v_mfma_f32_16x16x32_bf16 v[80:83], v[68:71], a[136:139], 0
  ds_read_b128 v[168:171], v1 offset:10240
  v_mul_f32 v163, v13, v163
  v_mfma_f32_16x16x32_bf16 v[80:83], v[64:67], a[124:127], v[80:83]
  ds_read_b128 v[176:179], v0 offset:18432
  v_cvt_pk_bf16_f32 v160, v160, v161
  v_mfma_f32_16x16x32_bf16 v[80:83], v[180:183], a[112:115], v[80:83]
  v_cvt_pk_bf16_f32 v16, v76, v77
  v_cvt_pk_bf16_f32 v17, v78, v79
  v_mfma_f32_16x16x32_bf16 v[80:83], a[252:255], a[100:103], v[80:83]
  ds_read_b128 v[144:147], v1 offset:18432
  v_cvt_pk_bf16_f32 v161, v162, v163
  v_mfma_f32_16x16x32_bf16 v[80:83], a[248:251], a[88:91], v[80:83]
  ds_write_b64 v5, v[160:161] offset:256
  v_mfma_f32_16x16x32_bf16 v[80:83], a[244:247], a[76:79], v[80:83]
  v_mul_f32 v148, v12, v148
  v_mul_f32 v149, v12, v149
  v_mfma_f32_16x16x32_bf16 v[76:79], a[244:247], a[80:83], 0
  v_mul_f32 v150, v12, v150
  v_mul_f32 v151, v12, v151
  v_mfma_f32_16x16x32_bf16 v[76:79], a[248:251], a[92:95], v[76:79]
  v_cvt_pk_bf16_f32 v148, v148, v149
  v_cvt_pk_bf16_f32 v149, v150, v151
  v_mfma_f32_16x16x32_bf16 v[76:79], a[252:255], a[104:107], v[76:79]
  v_cvt_pk_bf16_f32 v24, v80, v81
  v_cvt_pk_bf16_f32 v25, v82, v83
  v_mfma_f32_16x16x32_bf16 v[76:79], v[180:183], a[116:119], v[76:79]
  s_add_u32 m0, s33, 4096
  v_mul_f32 v152, v12, v152
  v_mfma_f32_16x16x32_bf16 v[76:79], v[64:67], a[128:131], v[76:79]
  buffer_load_dwordx4 v6, s[8:11], s49 offen offset:0 nt lds
  v_mfma_f32_16x16x32_bf16 v[76:79], v[68:71], a[140:143], v[76:79]
  s_waitcnt lgkmcnt(1)
  v_mul_f32 v153, v12, v153
  v_mfma_f32_16x16x32_bf16 v[80:83], v[184:187], v[72:75], 0
  v_mul_f32 v154, v12, v154
  v_mul_f32 v155, v12, v155
  v_mfma_f32_16x16x32_bf16 v[80:83], v[196:199], v[84:87], v[80:83]
  v_cvt_pk_bf16_f32 v150, v152, v153
  v_cvt_pk_bf16_f32 v151, v154, v155
  v_mfma_f32_16x16x32_bf16 v[80:83], v[208:211], v[164:167], v[80:83]
  v_cvt_pk_bf16_f32 v32, v76, v77
  v_cvt_pk_bf16_f32 v33, v78, v79
  v_mfma_f32_16x16x32_bf16 v[80:83], v[220:223], v[168:171], v[80:83]
  ds_write_b128 v4, v[148:151] offset:0
  v_mfma_f32_16x16x32_bf16 v[80:83], v[232:235], v[176:179], v[80:83]
  v_mul_f32 v172, v12, v172
  v_mul_f32 v173, v12, v173
  v_mfma_f32_16x16x32_bf16 v[80:83], v[244:247], v[144:147], v[80:83]
  v_mul_f32 v174, v12, v174
  v_mul_f32 v175, v12, v175
  v_mfma_f32_16x16x32_bf16 v[76:79], v[248:251], v[144:147], 0
  v_cvt_pk_bf16_f32 v172, v172, v173
  v_cvt_pk_bf16_f32 v173, v174, v175
  v_mfma_f32_16x16x32_bf16 v[76:79], v[236:239], v[176:179], v[76:79]
  ds_write_b64 v5, v[172:173] offset:0
  v_mfma_f32_16x16x32_bf16 v[76:79], v[224:227], v[168:171], v[76:79]
  v_cvt_pk_bf16_f32 v52, v80, v81
  v_cvt_pk_bf16_f32 v53, v82, v83
  v_mfma_f32_16x16x32_bf16 v[76:79], v[212:215], v[164:167], v[76:79]
  v_subrev_u32 v3, s7, v3
  v_subrev_u32 v2, s7, v2
  v_mfma_f32_16x16x32_bf16 v[76:79], v[200:203], v[84:87], v[76:79]
  v_add_u32 v4, s7, v4
  v_add_u32 v5, s7, v5
  v_mfma_f32_16x16x32_bf16 v[76:79], v[188:191], v[72:75], v[76:79]
  s_sub_u32 s7, 0, s7
  v_max3_f32 v9, v12, v13, v9
  v_mfma_f32_16x16x32_bf16 v[80:83], v[192:195], v[72:75], 0
  v_max3_f32 v9, v14, v15, v9
  v_min3_f32 v11, v12, v13, v11
  v_mfma_f32_16x16x32_bf16 v[80:83], v[204:207], v[84:87], v[80:83]
  s_add_u32 m0, s33, 12160
  v_min3_f32 v11, v14, v15, v11
  v_mfma_f32_16x16x32_bf16 v[80:83], v[216:219], v[164:167], v[80:83]
  v_cvt_pk_bf16_f32 v54, v76, v77
  v_cvt_pk_bf16_f32 v55, v78, v79
  v_mfma_f32_16x16x32_bf16 v[80:83], v[228:231], v[168:171], v[80:83]
  buffer_load_dwordx4 v6, s[8:11], s49 offen offset:128 nt lds
  v_mfma_f32_16x16x32_bf16 v[80:83], v[240:243], v[176:179], v[80:83]
  v_mfma_f32_16x16x32_bf16 v[80:83], v[252:255], v[144:147], v[80:83]
  v_mfma_f32_16x16x32_bf16 v[76:79], a[60:63], v[144:147], 0
  v_mfma_f32_16x16x32_bf16 v[76:79], a[48:51], v[176:179], v[76:79]
  v_mfma_f32_16x16x32_bf16 v[76:79], a[36:39], v[168:171], v[76:79]
  v_cvt_pk_bf16_f32 v56, v80, v81
  v_cvt_pk_bf16_f32 v57, v82, v83
  v_mfma_f32_16x16x32_bf16 v[76:79], a[24:27], v[164:167], v[76:79]
  v_mfma_f32_16x16x32_bf16 v[76:79], a[12:15], v[84:87], v[76:79]
  v_mfma_f32_16x16x32_bf16 v[76:79], a[0:3], v[72:75], v[76:79]
  v_mfma_f32_16x16x32_bf16 v[80:83], a[4:7], v[72:75], 0
  v_mfma_f32_16x16x32_bf16 v[80:83], a[16:19], v[84:87], v[80:83]
  v_mfma_f32_16x16x32_bf16 v[80:83], a[28:31], v[164:167], v[80:83]
  v_cvt_pk_bf16_f32 v58, v76, v77
  v_cvt_pk_bf16_f32 v59, v78, v79
  v_mfma_f32_16x16x32_bf16 v[80:83], a[40:43], v[168:171], v[80:83]
  v_mfma_f32_16x16x32_bf16 v[80:83], a[52:55], v[176:179], v[80:83]
  v_mfma_f32_16x16x32_bf16 v[80:83], a[64:67], v[144:147], v[80:83]
  s_add_u32 m0, s33, 20224
  v_mfma_f32_16x16x32_bf16 v[76:79], a[68:71], v[144:147], 0
  buffer_load_dwordx4 v6, s[8:11], s49 offen offset:256 nt lds
  v_mfma_f32_16x16x32_bf16 v[76:79], a[56:59], v[176:179], v[76:79]
  v_mfma_f32_16x16x32_bf16 v[76:79], a[44:47], v[168:171], v[76:79]
  v_cvt_pk_bf16_f32 v60, v80, v81
  v_cvt_pk_bf16_f32 v61, v82, v83
  v_mfma_f32_16x16x32_bf16 v[76:79], a[32:35], v[164:167], v[76:79]
  v_mfma_f32_16x16x32_bf16 v[76:79], a[20:23], v[84:87], v[76:79]
  v_mfma_f32_16x16x32_bf16 v[76:79], a[8:11], v[72:75], v[76:79]
  v_mfma_f32_16x16x32_bf16 v[80:83], v[72:75], a[72:75], 0
  v_mfma_f32_16x16x32_bf16 v[80:83], v[84:87], a[84:87], v[80:83]
  v_mfma_f32_16x16x32_bf16 v[80:83], v[164:167], a[96:99], v[80:83]
  v_cvt_pk_bf16_f32 v62, v76, v77
  v_cvt_pk_bf16_f32 v63, v78, v79
  v_mfma_f32_16x16x32_bf16 v[80:83], v[168:171], a[108:111], v[80:83]
  ds_read_b128 v[116:119], v0 offset:4096
  v_mfma_f32_16x16x32_bf16 v[80:83], v[176:179], a[120:123], v[80:83]
  ds_read_b128 v[124:127], v1 offset:4096
  v_mfma_f32_16x16x32_bf16 v[80:83], v[144:147], a[132:135], v[80:83]
  ds_read_b128 v[120:123], v0 offset:12288
  v_mfma_f32_16x16x32_bf16 v[76:79], v[144:147], a[136:139], 0
  ds_read_b128 v[128:131], v1 offset:12288
  v_mfma_f32_16x16x32_bf16 v[76:79], v[176:179], a[124:127], v[76:79]
  ds_read_b128 v[132:135], v0 offset:20480
  v_mfma_f32_16x16x32_bf16 v[76:79], v[168:171], a[112:115], v[76:79]
  v_cvt_pk_bf16_f32 v18, v80, v81
  v_cvt_pk_bf16_f32 v19, v82, v83
  v_mfma_f32_16x16x32_bf16 v[76:79], v[164:167], a[100:103], v[76:79]
  ds_read_b128 v[140:143], v1 offset:20480
  v_mfma_f32_16x16x32_bf16 v[76:79], v[84:87], a[88:91], v[76:79]
  v_mfma_f32_16x16x32_bf16 v[76:79], v[72:75], a[76:79], v[76:79]
  v_mfma_f32_16x16x32_bf16 v[80:83], v[72:75], a[80:83], 0
  v_mfma_f32_16x16x32_bf16 v[80:83], v[84:87], a[92:95], v[80:83]
  v_mfma_f32_16x16x32_bf16 v[80:83], v[164:167], a[104:107], v[80:83]
  v_cvt_pk_bf16_f32 v26, v76, v77
  v_cvt_pk_bf16_f32 v27, v78, v79
  v_mfma_f32_16x16x32_bf16 v[80:83], v[168:171], a[116:119], v[80:83]
  v_mfma_f32_16x16x32_bf16 v[80:83], v[176:179], a[128:131], v[80:83]
  v_mfma_f32_16x16x32_bf16 v[80:83], v[144:147], a[140:143], v[80:83]
  s_waitcnt lgkmcnt(0)
  v_mfma_f32_16x16x32_bf16 v[148:151], v[184:187], v[116:119], 0
  s_add_u32 s40, s48, s52
  s_add_u32 s41, s48, s53
  v_mfma_f32_16x16x32_bf16 v[148:151], v[196:199], v[124:127], v[148:151]
  s_add_u32 s42, s48, s54
  s_add_u32 s43, s48, s55
  v_mfma_f32_16x16x32_bf16 v[148:151], v[208:211], v[120:123], v[148:151]
  v_cvt_pk_bf16_f32 v34, v80, v81
  v_cvt_pk_bf16_f32 v35, v82, v83
  v_mfma_f32_16x16x32_bf16 v[148:151], v[220:223], v[128:131], v[148:151]
  s_cmp_eq_u32 s48, s50
  s_cselect_b64 vcc, -1, 0
  v_mfma_f32_16x16x32_bf16 v[148:151], v[232:235], v[132:135], v[148:151]
  s_add_u32 s48, s48, 6291456
  s_add_u32 s49, s48, 786432
  v_mfma_f32_16x16x32_bf16 v[148:151], v[244:247], v[140:143], v[148:151]
  s_add_u32 s36, s32, s33
  s_mov_b32 s33, s32
  v_mfma_f32_16x16x32_bf16 v[156:159], v[248:251], v[140:143], 0
  s_sub_u32 s32, s34, s36
  v_mfma_f32_16x16x32_bf16 v[156:159], v[236:239], v[132:135], v[156:159]
  v_mfma_f32_16x16x32_bf16 v[156:159], v[224:227], v[128:131], v[156:159]
  v_cvt_pk_bf16_f32 v64, v148, v149
  v_cvt_pk_bf16_f32 v65, v150, v151
  v_mfma_f32_16x16x32_bf16 v[156:159], v[212:215], v[120:123], v[156:159]
  v_mfma_f32_16x16x32_bf16 v[156:159], v[200:203], v[124:127], v[156:159]
  v_mfma_f32_16x16x32_bf16 v[156:159], v[188:191], v[116:119], v[156:159]
  v_mfma_f32_16x16x32_bf16 v[148:151], v[192:195], v[116:119], 0
  v_mfma_f32_16x16x32_bf16 v[148:151], v[204:207], v[124:127], v[148:151]
  v_mfma_f32_16x16x32_bf16 v[148:151], v[216:219], v[120:123], v[148:151]
  v_cvt_pk_bf16_f32 v66, v156, v157
  v_cvt_pk_bf16_f32 v67, v158, v159
  v_mfma_f32_16x16x32_bf16 v[148:151], v[228:231], v[128:131], v[148:151]
  v_mfma_f32_16x16x32_bf16 v[148:151], v[240:243], v[132:135], v[148:151]
  v_mfma_f32_16x16x32_bf16 v[148:151], v[252:255], v[140:143], v[148:151]
  v_mfma_f32_16x16x32_bf16 v[156:159], a[60:63], v[140:143], 0
  v_mfma_f32_16x16x32_bf16 v[156:159], a[48:51], v[132:135], v[156:159]
  v_mfma_f32_16x16x32_bf16 v[156:159], a[36:39], v[128:131], v[156:159]
  v_cvt_pk_bf16_f32 v68, v148, v149
  v_cvt_pk_bf16_f32 v69, v150, v151
  v_mfma_f32_16x16x32_bf16 v[156:159], a[24:27], v[120:123], v[156:159]
  v_mfma_f32_16x16x32_bf16 v[156:159], a[12:15], v[124:127], v[156:159]
  v_mfma_f32_16x16x32_bf16 v[156:159], a[0:3], v[116:119], v[156:159]
  v_mfma_f32_16x16x32_bf16 v[148:151], a[4:7], v[116:119], 0
  v_mfma_f32_16x16x32_bf16 v[148:151], a[16:19], v[124:127], v[148:151]
  v_mfma_f32_16x16x32_bf16 v[148:151], a[28:31], v[120:123], v[148:151]
  v_cvt_pk_bf16_f32 v76, v156, v157
  v_cvt_pk_bf16_f32 v77, v158, v159
  v_mfma_f32_16x16x32_bf16 v[148:151], a[40:43], v[128:131], v[148:151]
  v_mfma_f32_16x16x32_bf16 v[148:151], a[52:55], v[132:135], v[148:151]
  v_mfma_f32_16x16x32_bf16 v[148:151], a[64:67], v[140:143], v[148:151]
  v_mfma_f32_16x16x32_bf16 v[156:159], a[68:71], v[140:143], 0
  v_mfma_f32_16x16x32_bf16 v[156:159], a[56:59], v[132:135], v[156:159]
  v_mfma_f32_16x16x32_bf16 v[156:159], a[44:47], v[128:131], v[156:159]
  v_cvt_pk_bf16_f32 v78, v148, v149
  v_cvt_pk_bf16_f32 v79, v150, v151
  v_mfma_f32_16x16x32_bf16 v[156:159], a[32:35], v[120:123], v[156:159]
  v_mfma_f32_16x16x32_bf16 v[156:159], a[20:23], v[124:127], v[156:159]
  v_mfma_f32_16x16x32_bf16 v[156:159], a[8:11], v[116:119], v[156:159]
  v_mfma_f32_16x16x32_bf16 v[148:151], v[116:119], a[72:75], 0
  v_mfma_f32_16x16x32_bf16 v[148:151], v[124:127], a[84:87], v[148:151]
  v_mfma_f32_16x16x32_bf16 v[148:151], v[120:123], a[96:99], v[148:151]
  v_cvt_pk_bf16_f32 v80, v156, v157
  v_cvt_pk_bf16_f32 v81, v158, v159
  v_mfma_f32_16x16x32_bf16 v[148:151], v[128:131], a[108:111], v[148:151]
  ds_read_b128 v[136:139], v0 offset:6144
  v_mfma_f32_16x16x32_bf16 v[148:151], v[132:135], a[120:123], v[148:151]
  ds_read_b128 v[144:147], v1 offset:6144
  v_mfma_f32_16x16x32_bf16 v[148:151], v[140:143], a[132:135], v[148:151]
  ds_read_b128 v[152:155], v0 offset:14336
  v_mfma_f32_16x16x32_bf16 v[156:159], v[140:143], a[136:139], 0
  ds_read_b128 v[160:163], v1 offset:14336
  v_mfma_f32_16x16x32_bf16 v[156:159], v[132:135], a[124:127], v[156:159]
  ds_read_b128 v[164:167], v0 offset:22528
  v_mfma_f32_16x16x32_bf16 v[156:159], v[128:131], a[112:115], v[156:159]
  v_cvt_pk_bf16_f32 v20, v148, v149
  v_cvt_pk_bf16_f32 v21, v150, v151
  v_mfma_f32_16x16x32_bf16 v[156:159], v[120:123], a[100:103], v[156:159]
  ds_read_b128 v[172:175], v1 offset:22528
  v_mfma_f32_16x16x32_bf16 v[156:159], v[124:127], a[88:91], v[156:159]
  v_mfma_f32_16x16x32_bf16 v[156:159], v[116:119], a[76:79], v[156:159]
  v_mfma_f32_16x16x32_bf16 v[148:151], v[116:119], a[80:83], 0
  v_mfma_f32_16x16x32_bf16 v[148:151], v[124:127], a[92:95], v[148:151]
  v_mfma_f32_16x16x32_bf16 v[148:151], v[120:123], a[104:107], v[148:151]
  v_cvt_pk_bf16_f32 v28, v156, v157
  v_cvt_pk_bf16_f32 v29, v158, v159
  v_mfma_f32_16x16x32_bf16 v[148:151], v[128:131], a[116:119], v[148:151]
  v_mfma_f32_16x16x32_bf16 v[148:151], v[132:135], a[128:131], v[148:151]
  v_mfma_f32_16x16x32_bf16 v[148:151], v[140:143], a[140:143], v[148:151]
  s_waitcnt lgkmcnt(0)
  v_mfma_f32_16x16x32_bf16 v[168:171], v[184:187], v[136:139], 0
  v_mfma_f32_16x16x32_bf16 v[168:171], v[196:199], v[144:147], v[168:171]
  v_mfma_f32_16x16x32_bf16 v[168:171], v[208:211], v[152:155], v[168:171]
  v_cvt_pk_bf16_f32 v36, v148, v149
  v_cvt_pk_bf16_f32 v37, v150, v151
  v_mfma_f32_16x16x32_bf16 v[168:171], v[220:223], v[160:163], v[168:171]
  v_mfma_f32_16x16x32_bf16 v[168:171], v[232:235], v[164:167], v[168:171]
  v_mfma_f32_16x16x32_bf16 v[168:171], v[244:247], v[172:175], v[168:171]
  v_mfma_f32_16x16x32_bf16 v[176:179], v[248:251], v[172:175], 0
  s_waitcnt vmcnt(12)
  s_barrier
  v_mfma_f32_16x16x32_bf16 v[176:179], v[236:239], v[164:167], v[176:179]
  v_mad_i32_i16 v0, v10, 1, s32 op_sel:[1,0,0,0]
  v_xor_b32 v1, 64, v0
  v_mfma_f32_16x16x32_bf16 v[176:179], v[224:227], v[160:163], v[176:179]
  v_cvt_pk_bf16_f32 v70, v168, v169
  v_cvt_pk_bf16_f32 v71, v170, v171
  v_mfma_f32_16x16x32_bf16 v[176:179], v[212:215], v[152:155], v[176:179]
  v_mfma_f32_16x16x32_bf16 v[176:179], v[200:203], v[144:147], v[176:179]
  v_mfma_f32_16x16x32_bf16 v[176:179], v[188:191], v[136:139], v[176:179]
  v_mfma_f32_16x16x32_bf16 v[168:171], v[192:195], v[136:139], 0
  v_mfma_f32_16x16x32_bf16 v[168:171], v[204:207], v[144:147], v[168:171]
  v_mfma_f32_16x16x32_bf16 v[168:171], v[216:219], v[152:155], v[168:171]
  v_cvt_pk_bf16_f32 v72, v176, v177
  v_cvt_pk_bf16_f32 v73, v178, v179
  v_mfma_f32_16x16x32_bf16 v[168:171], v[228:231], v[160:163], v[168:171]
  v_mfma_f32_16x16x32_bf16 v[168:171], v[240:243], v[164:167], v[168:171]
  v_mfma_f32_16x16x32_bf16 v[168:171], v[252:255], v[172:175], v[168:171]
  v_mfma_f32_16x16x32_bf16 v[176:179], a[60:63], v[172:175], 0
  v_mfma_f32_16x16x32_bf16 v[176:179], a[48:51], v[164:167], v[176:179]
  v_mfma_f32_16x16x32_bf16 v[176:179], a[36:39], v[160:163], v[176:179]
  v_cvt_pk_bf16_f32 v74, v168, v169
  v_cvt_pk_bf16_f32 v75, v170, v171
  v_mfma_f32_16x16x32_bf16 v[176:179], a[24:27], v[152:155], v[176:179]
  v_mfma_f32_16x16x32_bf16 v[176:179], a[12:15], v[144:147], v[176:179]
  v_mfma_f32_16x16x32_bf16 v[176:179], a[0:3], v[136:139], v[176:179]
  v_mfma_f32_16x16x32_bf16 v[168:171], a[4:7], v[136:139], 0
  v_mfma_f32_16x16x32_bf16 v[168:171], a[16:19], v[144:147], v[168:171]
  v_mfma_f32_16x16x32_bf16 v[168:171], a[28:31], v[152:155], v[168:171]
  v_cvt_pk_bf16_f32 v82, v176, v177
  v_cvt_pk_bf16_f32 v83, v178, v179
  v_mfma_f32_16x16x32_bf16 v[168:171], a[40:43], v[160:163], v[168:171]
  v_mfma_f32_16x16x32_bf16 v[168:171], a[52:55], v[164:167], v[168:171]
  v_mfma_f32_16x16x32_bf16 v[168:171], a[64:67], v[172:175], v[168:171]
  v_mfma_f32_16x16x32_bf16 v[176:179], a[68:71], v[172:175], 0
  v_mfma_f32_16x16x32_bf16 v[176:179], a[56:59], v[164:167], v[176:179]
  v_mfma_f32_16x16x32_bf16 v[176:179], a[44:47], v[160:163], v[176:179]
  v_cvt_pk_bf16_f32 v84, v168, v169
  v_cvt_pk_bf16_f32 v85, v170, v171
  v_mfma_f32_16x16x32_bf16 v[176:179], a[32:35], v[152:155], v[176:179]
  v_mfma_f32_16x16x32_bf16 v[176:179], a[20:23], v[144:147], v[176:179]
  v_mfma_f32_16x16x32_bf16 v[176:179], a[8:11], v[136:139], v[176:179]
  v_mfma_f32_16x16x32_bf16 v[168:171], v[136:139], a[72:75], 0
  v_mfma_f32_16x16x32_bf16 v[168:171], v[144:147], a[84:87], v[168:171]
  v_mfma_f32_16x16x32_bf16 v[168:171], v[152:155], a[96:99], v[168:171]
  v_cvt_pk_bf16_f32 v86, v176, v177
  v_cvt_pk_bf16_f32 v87, v178, v179
  v_mfma_f32_16x16x32_bf16 v[168:171], v[160:163], a[108:111], v[168:171]
  v_mfma_f32_16x16x32_bf16 v[168:171], v[164:167], a[120:123], v[168:171]
  v_mfma_f32_16x16x32_bf16 v[168:171], v[172:175], a[132:135], v[168:171]
  v_mfma_f32_16x16x32_bf16 v[176:179], v[172:175], a[136:139], 0
  v_mfma_f32_16x16x32_bf16 v[176:179], v[164:167], a[124:127], v[176:179]
  v_mfma_f32_16x16x32_bf16 v[176:179], v[160:163], a[112:115], v[176:179]
  v_cvt_pk_bf16_f32 v22, v168, v169
  v_cvt_pk_bf16_f32 v23, v170, v171
  v_mfma_f32_16x16x32_bf16 v[176:179], v[152:155], a[100:103], v[176:179]
  ds_read_b128 a[244:247], v3 offset:0
  v_mfma_f32_16x16x32_bf16 v[176:179], v[144:147], a[88:91], v[176:179]
  ds_read_b128 a[248:251], v3 offset:4096
  v_mfma_f32_16x16x32_bf16 v[176:179], v[136:139], a[76:79], v[176:179]
  ds_read_b128 a[252:255], v3 offset:8192
  v_mfma_f32_16x16x32_bf16 v[168:171], v[136:139], a[80:83], 0
  ds_read_b128 v[180:183], v3 offset:12288
  v_mfma_f32_16x16x32_bf16 v[168:171], v[144:147], a[92:95], v[168:171]
  v_mfma_f32_16x16x32_bf16 v[168:171], v[152:155], a[104:107], v[168:171]
  v_cvt_pk_bf16_f32 v30, v176, v177
  v_cvt_pk_bf16_f32 v31, v178, v179
  v_mfma_f32_16x16x32_bf16 v[168:171], v[160:163], a[116:119], v[168:171]
  v_mfma_f32_16x16x32_bf16 v[168:171], v[164:167], a[128:131], v[168:171]
  v_mfma_f32_16x16x32_bf16 v[168:171], v[172:175], a[140:143], v[168:171]
  s_branch L_s
L_fin:
  s_nop 5
  v_cvt_pk_bf16_f32 v50, v52, v53
  v_cvt_pk_bf16_f32 v51, v54, v55
  buffer_store_dwordx4 v[48:51], v8, s[24:27], s43 offen nt
  s_waitcnt lgkmcnt(0)
  s_barrier
  ds_read_b128 v[116:119], v1
  s_waitcnt lgkmcnt(0)
  v_or3_b32 v116, v116, v117, v118
  v_or_b32 v116, v116, v119
  s_nop 0
  v_readfirstlane_b32 s36, v116
  s_nop 3
  s_andn2_b32 s36, s36, s31
  s_cbranch_scc1 L_redo
  s_endpgm
L_epi:
  v_mul_f32 v131, v15, v131
  v_cvt_pk_bf16_f32 v126, v128, v129
  v_cvt_pk_bf16_f32 v127, v130, v131
  ds_write_b128 v4, v[124:127] offset:768
  v_pk_mul_f32 v[140:141], v[140:141], v[14:15] op_sel:[0,1] op_sel_hi:[1,1]
  v_pk_mul_f32 v[142:143], v[142:143], v[14:15] op_sel:[0,1] op_sel_hi:[1,1]
  v_cvt_pk_bf16_f32 v140, v140, v141
  v_cvt_pk_bf16_f32 v141, v142, v143
  ds_write_b64 v5, v[140:141] offset:768
  v_rcp_f32 v13, v13
  v_pk_mul_f32 v[116:117], v[116:117], v[14:15] op_sel:[0,0] op_sel_hi:[1,0]
  v_pk_mul_f32 v[118:119], v[118:119], v[14:15] op_sel:[0,0] op_sel_hi:[1,0]
  v_cvt_pk_bf16_f32 v116, v116, v117
  v_cvt_pk_bf16_f32 v117, v118, v119
  v_pk_mul_f32 v[120:121], v[120:121], v[14:15] op_sel:[0,0] op_sel_hi:[1,0]
  v_pk_mul_f32 v[122:123], v[122:123], v[14:15] op_sel:[0,0] op_sel_hi:[1,0]
  v_cvt_pk_bf16_f32 v118, v120, v121
  v_cvt_pk_bf16_f32 v119, v122, v123
  ds_write_b128 v4, v[116:119] offset:512
  v_pk_mul_f32 v[156:157], v[156:157], v[14:15] op_sel:[0,0] op_sel_hi:[1,0]
  v_pk_mul_f32 v[158:159], v[158:159], v[14:15] op_sel:[0,0] op_sel_hi:[1,0]
  v_cvt_pk_bf16_f32 v156, v156, v157
  v_cvt_pk_bf16_f32 v157, v158, v159
  ds_write_b64 v5, v[156:157] offset:512
  v_rcp_f32 v12, v12
  s_nop 0
  v_pk_mul_f32 v[132:133], v[132:133], v[12:13] op_sel:[0,1] op_sel_hi:[1,1]
  v_pk_mul_f32 v[134:135], v[134:135], v[12:13] op_sel:[0,1] op_sel_hi:[1,1]
  v_cvt_pk_bf16_f32 v132, v132, v133
  v_cvt_pk_bf16_f32 v133, v134, v135
  v_pk_mul_f32 v[136:137], v[136:137], v[12:13] op_sel:[0,1] op_sel_hi:[1,1]
  v_pk_mul_f32 v[138:139], v[138:139], v[12:13] op_sel:[0,1] op_sel_hi:[1,1]
  v_cvt_pk_bf16_f32 v134, v136, v137
  v_cvt_pk_bf16_f32 v135, v138, v139
  ds_write_b128 v4, v[132:135] offset:256
  v_pk_mul_f32 v[160:161], v[160:161], v[12:13] op_sel:[0,1] op_sel_hi:[1,1]
  v_pk_mul_f32 v[162:163], v[162:163], v[12:13] op_sel:[0,1] op_sel_hi:[1,1]
  v_cvt_pk_bf16_f32 v160, v160, v161
  v_cvt_pk_bf16_f32 v161, v162, v163
  ds_write_b64 v5, v[160:161] offset:256
  v_pk_mul_f32 v[148:149], v[148:149], v[12:13] op_sel:[0,0] op_sel_hi:[1,0]
  v_pk_mul_f32 v[150:151], v[150:151], v[12:13] op_sel:[0,0] op_sel_hi:[1,0]
  v_cvt_pk_bf16_f32 v148, v148, v149
  v_cvt_pk_bf16_f32 v149, v150, v151
  v_pk_mul_f32 v[152:153], v[152:153], v[12:13] op_sel:[0,0] op_sel_hi:[1,0]
  v_pk_mul_f32 v[154:155], v[154:155], v[12:13] op_sel:[0,0] op_sel_hi:[1,0]
  v_cvt_pk_bf16_f32 v150, v152, v153
  v_cvt_pk_bf16_f32 v151, v154, v155
  ds_write_b128 v4, v[148:151] offset:0
  v_pk_mul_f32 v[172:173], v[172:173], v[12:13] op_sel:[0,0] op_sel_hi:[1,0]
  v_pk_mul_f32 v[174:175], v[174:175], v[12:13] op_sel:[0,0] op_sel_hi:[1,0]
  v_cvt_pk_bf16_f32 v172, v172, v173
  v_cvt_pk_bf16_f32 v173, v174, v175
  ds_write_b64 v5, v[172:173] offset:0
  v_max3_f32 v9, v12, v13, v9
  v_max3_f32 v9, v14, v15, v9
  v_min3_f32 v11, v12, v13, v11
  v_min3_f32 v11, v14, v15, v11
  v_subrev_u32 v3, s7, v3
  v_subrev_u32 v2, s7, v2
  v_cmp_nle_f32 vcc, 0x2b800000, v11
  s_lshl_b32 s39, s4, 2
  s_add_u32 s39, s39, 139264
  v_mov_b32 v0, s39
  s_nop 0
  s_mov_b64 s[36:37], vcc
  v_cmp_nge_f32 vcc, 0x53800000, v9
  s_waitcnt lgkmcnt(0)
  s_barrier
  ds_read_b128 a[244:247], v3 offset:0
  ds_read_b128 a[248:251], v3 offset:4096
  ds_read_b128 a[252:255], v3 offset:8192
  ds_read_b128 v[180:183], v3 offset:12288
  ds_read_b128 v[64:67], v3 offset:16384
  ds_read_b128 v[68:71], v3 offset:20480
  s_add_u32 s40, s48, s52
  s_add_u32 s41, s48, s53
  s_add_u32 s42, s48, s54
  s_add_u32 s43, s48, s55
  s_or_b64 vcc, vcc, s[36:37]
  s_cselect_b32 s38, 1, 0
  v_mov_b32 v1, s38
  ds_write_b32 v0, v1
  v_mov_b32 v1, 139264
  s_cmp_eq_u32 0, 0
  s_waitcnt lgkmcnt(1)
  s_branch L_pj
L_redo:
  s_mov_b32 s31, 1
  s_waitcnt vmcnt(0) lgkmcnt(0)
  v_mbcnt_lo_u32_b32 v0, -1, 0
  v_mbcnt_hi_u32_b32 v0, -1, v0
  v_add_u32 v0, s3, v0
  s_barrier
  s_branch L_again
L_special0:
  buffer_load_dwordx4 v6, s[8:11], s49 offen offset:256 nt lds
  s_add_u32 s48, s48, 6291456
  s_add_u32 s49, s48, 786432
  s_add_u32 m0, s32, 65536
  ds_read_b64_tr_b16 a[100:101], v13 offset:49152
  buffer_load_dwordx4 v6, s[8:11], s48 offen offset:0 nt lds
  ds_read_b64_tr_b16 a[102:103], v13 offset:49664
  ds_read_b64_tr_b16 a[104:105], v14 offset:49152
  ds_read_b64_tr_b16 a[106:107], v14 offset:49664
  ds_read_b64_tr_b16 a[108:109], v12 offset:61440
  s_add_u32 m0, s32, 73600
  ds_read_b64_tr_b16 a[110:111], v12 offset:61952
  buffer_load_dwordx4 v6, s[8:11], s48 offen offset:128 nt lds
  ds_read_b64_tr_b16 a[112:113], v13 offset:61440
  ds_read_b64_tr_b16 a[114:115], v13 offset:61952
  ds_read_b64_tr_b16 a[116:117], v14 offset:61440
  ds_read_b64_tr_b16 a[118:119], v14 offset:61952
  s_add_u32 m0, s32, 81664
  s_nop 0
  buffer_load_dwordx4 v6, s[8:11], s48 offen offset:256 nt lds
  s_waitcnt lgkmcnt(0)
  s_waitcnt vmcnt(9)
  s_barrier
  ds_read_b64_tr_b16 a[120:121], v15 offset:0
  ds_read_b64_tr_b16 a[122:123], v15 offset:512
  ds_read_b64_tr_b16 a[124:125], v9 offset:0
  ds_read_b64_tr_b16 a[126:127], v9 offset:512
  ds_read_b64_tr_b16 a[128:129], v11 offset:0
  ds_read_b64_tr_b16 a[130:131], v11 offset:512
  ds_read_b64_tr_b16 a[132:133], v15 offset:12288
  ds_read_b64_tr_b16 a[134:135], v15 offset:12800
  ds_read_b64_tr_b16 a[136:137], v9 offset:12288
  ds_read_b64_tr_b16 a[138:139], v9 offset:12800
  ds_read_b64_tr_b16 a[140:141], v11 offset:12288
  ds_read_b64_tr_b16 a[142:143], v11 offset:12800
  v_mfma_f32_16x16x16_bf16 v[124:127], v[62:63], v[74:75], v[124:127]
  v_mfma_f32_16x16x16_bf16 v[120:123], v[80:81], v[74:75], v[120:123]
  v_mfma_f32_16x16x16_bf16 v[128:131], v[86:87], v[74:75], v[128:131]
  v_mfma_f32_16x16x32_bf16 v[132:135], v[46:49], v[64:67], v[160:163]
  v_mfma_f32_16x16x32_bf16 v[140:143], v[58:61], v[64:67], v[180:183]
  v_mfma_f32_16x16x32_bf16 v[136:139], v[76:79], v[64:67], v[100:103]
  v_mfma_f32_16x16x32_bf16 v[144:147], v[82:85], v[64:67], v[96:99]
  v_mfma_f32_16x16x16_bf16 v[132:135], v[50:51], v[68:69], v[132:135]
  v_mfma_f32_16x16x16_bf16 v[140:143], v[62:63], v[68:69], v[140:143]
  v_mfma_f32_16x16x16_bf16 v[136:139], v[80:81], v[68:69], v[136:139]
  v_mfma_f32_16x16x16_bf16 v[144:147], v[86:87], v[68:69], v[144:147]
  v_mfma_f32_16x16x32_bf16 v[148:151], v[46:49], v[52:55], v[104:107]
  v_mfma_f32_16x16x32_bf16 v[156:159], v[58:61], v[52:55], v[100:103]
  v_mfma_f32_16x16x32_bf16 v[152:155], v[76:79], v[52:55], v[152:155]
  v_mfma_f32_16x16x32_bf16 v[160:163], v[82:85], v[52:55], v[168:171]
  v_mfma_f32_16x16x16_bf16 v[148:151], v[50:51], v[56:57], v[148:151]
  v_mfma_f32_16x16x16_bf16 v[156:159], v[62:63], v[56:57], v[156:159]
  v_mfma_f32_16x16x16_bf16 v[152:155], v[80:81], v[56:57], v[152:155]
  v_mfma_f32_16x16x16_bf16 v[160:163], v[86:87], v[56:57], v[160:163]
  v_mfma_f32_16x16x32_bf16 v[164:167], v[46:49], v[40:43], v[100:103]
  v_mfma_f32_16x16x32_bf16 v[172:175], v[58:61], v[40:43], v[96:99]
  v_mfma_f32_16x16x32_bf16 v[168:171], v[76:79], v[40:43], v[168:171]
  v_mfma_f32_16x16x32_bf16 v[176:179], v[82:85], v[40:43], v[176:179]
  v_mfma_f32_16x16x16_bf16 v[164:167], v[50:51], v[44:45], v[164:167]
  v_mfma_f32_16x16x16_bf16 v[172:175], v[62:63], v[44:45], v[172:175]
  v_mfma_f32_16x16x16_bf16 v[168:171], v[80:81], v[44:45], v[168:171]
  v_mfma_f32_16x16x16_bf16 v[176:179], v[86:87], v[44:45], v[176:179]
  s_branch L_sp2
L_special:
  v_mfma_f32_16x16x16_bf16 v[124:127], v[62:63], v[74:75], v[124:127]
  v_mfma_f32_16x16x16_bf16 v[120:123], v[80:81], v[74:75], v[120:123]
  v_mfma_f32_16x16x16_bf16 v[128:131], v[86:87], v[74:75], v[128:131]
  v_mfma_f32_16x16x32_bf16 v[132:135], v[46:49], v[64:67], v[108:111]
  v_mfma_f32_16x16x32_bf16 v[140:143], v[58:61], v[64:67], v[104:107]
  v_mfma_f32_16x16x32_bf16 v[136:139], v[76:79], v[64:67], v[100:103]
  v_mfma_f32_16x16x32_bf16 v[144:147], v[82:85], v[64:67], v[96:99]
  v_mfma_f32_16x16x16_bf16 v[132:135], v[50:51], v[68:69], v[132:135]
  v_mfma_f32_16x16x16_bf16 v[140:143], v[62:63], v[68:69], v[140:143]
  v_mfma_f32_16x16x16_bf16 v[136:139], v[80:81], v[68:69], v[136:139]
  v_mfma_f32_16x16x16_bf16 v[144:147], v[86:87], v[68:69], v[144:147]
  v_mfma_f32_16x16x32_bf16 v[148:151], v[46:49], v[52:55], v[104:107]
  v_mfma_f32_16x16x32_bf16 v[156:159], v[58:61], v[52:55], v[100:103]
  v_mfma_f32_16x16x32_bf16 v[152:155], v[76:79], v[52:55], v[96:99]
  v_mfma_f32_16x16x32_bf16 v[160:163], v[82:85], v[52:55], v[92:95]
  v_mfma_f32_16x16x16_bf16 v[148:151], v[50:51], v[56:57], v[148:151]
  v_mfma_f32_16x16x16_bf16 v[156:159], v[62:63], v[56:57], v[156:159]
  v_mfma_f32_16x16x16_bf16 v[152:155], v[80:81], v[56:57], v[152:155]
  v_mfma_f32_16x16x16_bf16 v[160:163], v[86:87], v[56:57], v[160:163]
  v_mfma_f32_16x16x32_bf16 v[164:167], v[46:49], v[40:43], v[100:103]
  v_mfma_f32_16x16x32_bf16 v[172:175], v[58:61], v[40:43], v[96:99]
  v_mfma_f32_16x16x32_bf16 v[168:171], v[76:79], v[40:43], v[92:95]
  v_mfma_f32_16x16x32_bf16 v[176:179], v[82:85], v[40:43], v[88:91]
  v_mfma_f32_16x16x16_bf16 v[164:167], v[50:51], v[44:45], v[164:167]
  v_mfma_f32_16x16x16_bf16 v[172:175], v[62:63], v[44:45], v[172:175]
  v_mfma_f32_16x16x16_bf16 v[168:171], v[80:81], v[44:45], v[168:171]
  v_mfma_f32_16x16x16_bf16 v[176:179], v[86:87], v[44:45], v[176:179]
  ds_read_b128 v[64:67], v3 offset:16384
  ds_read_b128 v[68:71], v3 offset:20480
L_sp2:
  s_nop 15
  v_max_f32 v40, v164, v165
  v_max3_f32 v40, v166, v167, v40
  v_max3_f32 v40, v172, v173, v40
  v_max3_f32 v40, v174, v175, v40
  v_max3_f32 v40, v168, v169, v40
  v_max3_f32 v40, v170, v171, v40
  v_max3_f32 v40, v176, v177, v40
  v_max3_f32 v40, v178, v179, v40
  v_mov_b32 v41, v40
  s_nop 1
  v_permlane32_swap_b32 v40, v41
  v_max_f32 v40, v40, v41
  v_mov_b32 v41, v40
  s_nop 1
  v_permlane16_swap_b32 v40, v41
  v_max_f32 v40, v40, v41
  v_sub_f32 v164, v164, v40
  v_sub_f32 v165, v165, v40
  v_sub_f32 v166, v166, v40
  v_sub_f32 v167, v167, v40
  v_sub_f32 v172, v172, v40
  v_sub_f32 v173, v173, v40
  v_sub_f32 v174, v174, v40
  v_sub_f32 v175, v175, v40
  v_sub_f32 v168, v168, v40
  v_sub_f32 v169, v169, v40
  v_sub_f32 v170, v170, v40
  v_sub_f32 v171, v171, v40
  v_sub_f32 v176, v176, v40
  v_sub_f32 v177, v177, v40
  v_sub_f32 v178, v178, v40
  v_sub_f32 v179, v179, v40
  v_max_f32 v40, v148, v149
  v_max3_f32 v40, v150, v151, v40
  v_max3_f32 v40, v156, v157, v40
  v_max3_f32 v40, v158, v159, v40
  v_max3_f32 v40, v152, v153, v40
  v_max3_f32 v40, v154, v155, v40
  v_max3_f32 v40, v160, v161, v40
  v_max3_f32 v40, v162, v163, v40
  v_mov_b32 v41, v40
  s_nop 1
  v_permlane32_swap_b32 v40, v41
  v_max_f32 v40, v40, v41
  v_mov_b32 v41, v40
  s_nop 1
  v_permlane16_swap_b32 v40, v41
  v_max_f32 v40, v40, v41
  v_sub_f32 v148, v148, v40
  v_sub_f32 v149, v149, v40
  v_sub_f32 v150, v150, v40
  v_sub_f32 v151, v151, v40
  v_sub_f32 v156, v156, v40
  v_sub_f32 v157, v157, v40
  v_sub_f32 v158, v158, v40
  v_sub_f32 v159, v159, v40
  v_sub_f32 v152, v152, v40
  v_sub_f32 v153, v153, v40
  v_sub_f32 v154, v154, v40
  v_sub_f32 v155, v155, v40
  v_sub_f32 v160, v160, v40
  v_sub_f32 v161, v161, v40
  v_sub_f32 v162, v162, v40
  v_sub_f32 v163, v163, v40
  v_max_f32 v40, v132, v133
  v_max3_f32 v40, v134, v135, v40
  v_max3_f32 v40, v140, v141, v40
  v_max3_f32 v40, v142, v143, v40
  v_max3_f32 v40, v136, v137, v40
  v_max3_f32 v40, v138, v139, v40
  v_max3_f32 v40, v144, v145, v40
  v_max3_f32 v40, v146, v147, v40
  v_mov_b32 v41, v40
  s_nop 1
  v_permlane32_swap_b32 v40, v41
  v_max_f32 v40, v40, v41
  v_mov_b32 v41, v40
  s_nop 1
  v_permlane16_swap_b32 v40, v41
  v_max_f32 v40, v40, v41
  v_sub_f32 v132, v132, v40
  v_sub_f32 v133, v133, v40
  v_sub_f32 v134, v134, v40
  v_sub_f32 v135, v135, v40
  v_sub_f32 v140, v140, v40
  v_sub_f32 v141, v141, v40
  v_sub_f32 v142, v142, v40
  v_sub_f32 v143, v143, v40
  v_sub_f32 v136, v136, v40
  v_sub_f32 v137, v137, v40
  v_sub_f32 v138, v138, v40
  v_sub_f32 v139, v139, v40
  v_sub_f32 v144, v144, v40
  v_sub_f32 v145, v145, v40
  v_sub_f32 v146, v146, v40
  v_sub_f32 v147, v147, v40
  v_max_f32 v40, v116, v117
  v_max3_f32 v40, v118, v119, v40
  v_max3_f32 v40, v124, v125, v40
  v_max3_f32 v40, v126, v127, v40
  v_max3_f32 v40, v120, v121, v40
  v_max3_f32 v40, v122, v123, v40
  v_max3_f32 v40, v128, v129, v40
  v_max3_f32 v40, v130, v131, v40
  v_mov_b32 v41, v40
  s_nop 1
  v_permlane32_swap_b32 v40, v41
  v_max_f32 v40, v40, v41
  v_mov_b32 v41, v40
  s_nop 1
  v_permlane16_swap_b32 v40, v41
  v_max_f32 v40, v40, v41
  v_sub_f32 v116, v116, v40
  v_sub_f32 v117, v117, v40
  v_sub_f32 v118, v118, v40
  v_sub_f32 v119, v119, v40
  v_sub_f32 v124, v124, v40
  v_sub_f32 v125, v125, v40
  v_sub_f32 v126, v126, v40
  v_sub_f32 v127, v127, v40
  v_sub_f32 v120, v120, v40
  v_sub_f32 v121, v121, v40
  v_sub_f32 v122, v122, v40
  v_sub_f32 v123, v123, v40
  v_sub_f32 v128, v128, v40
  v_sub_f32 v129, v129, v40
  v_sub_f32 v130, v130, v40
  v_sub_f32 v131, v131, v40
  v_exp_f32 v116, v116
  v_exp_f32 v117, v117
  v_exp_f32 v118, v118
  v_exp_f32 v119, v119
  v_cvt_pk_bf16_f32 v116, v116, v117
  v_cvt_pk_bf16_f32 v117, v118, v119
  v_exp_f32 v124, v124
  v_exp_f32 v125, v125
  v_exp_f32 v126, v126
  s_waitcnt lgkmcnt(0)
  s_nop 7
  s_cmp_eq_u32 s35, 1
  s_cbranch_scc1 L_enter
  v_exp_f32 v127, v127
  v_cvt_pk_bf16_f32 v118, v124, v125
  v_cvt_pk_bf16_f32 v119, v126, v127
  v_exp_f32 v120, v120
  v_exp_f32 v121, v121
  v_exp_f32 v122, v122
  v_exp_f32 v123, v123
  v_cvt_pk_bf16_f32 v120, v120, v121
  v_cvt_pk_bf16_f32 v121, v122, v123
  v_exp_f32 v128, v128
  v_exp_f32 v129, v129
  v_exp_f32 v130, v130
  v_exp_f32 v131, v131
  v_exp_f32 v132, v132
  v_exp_f32 v133, v133
  v_cvt_pk_bf16_f32 v122, v128, v129
  v_cvt_pk_bf16_f32 v123, v130, v131
  v_exp_f32 v134, v134
  v_cvt_pk_bf16_f32 v132, v132, v133
  s_nop 7
  s_branch L_pj
L_end:
  s_endpgm
.fill (standalone__window_attn_swin__vision_kernel + 33280 - .) / 4, 4, 0xbf810000
.section .rodata,"a"
.p2align 6
.amdhsa_kernel standalone__window_attn_swin__vision_kernel
  .amdhsa_next_free_vgpr 512
  .amdhsa_next_free_sgpr 100
  .amdhsa_accum_offset 256
  .amdhsa_group_segment_fixed_size 0
  .amdhsa_kernarg_size 72
  .amdhsa_user_sgpr_count 2
  .amdhsa_user_sgpr_kernarg_segment_ptr 1
  .amdhsa_system_sgpr_workgroup_id_x 1
.end_amdhsa_kernel
```

```asm
; @launch grid=(256,1,1) block=(256,1,1) lds=163840
.amdgcn_target "amdgcn-amd-amdhsa--gfx950"
.text
.globl standalone__window_attn_swin__vision_kernel
.p2align 12
.type standalone__window_attn_swin__vision_kernel,@function
standalone__window_attn_swin__vision_kernel:
  s_mov_b32 s31, 0
L_again:
  s_load_dwordx2 s[8:9], s[0:1], 0
  s_load_dwordx2 s[12:13], s[0:1], 8
  s_cmpk_ge_u32 s2, 256
  s_cbranch_scc1 L_end
  s_getpc_b64 s[42:43]
  s_lshr_b32 s44, s2, 3
  s_lshl_b32 s45, s44, 10
  v_lshl_add_u32 v2, v0, 2, s45
  v_mov_b32 v3, 0
  v_lshl_add_u64 v[2:3], v[2:3], 0, s[42:43]
  global_load_dword v64, v[2:3], off
  v_readfirstlane_b32 s3, v0
  s_load_dwordx2 s[20:21], s[0:1], 24
  s_mov_b32 s11, 0x20000
  s_mov_b32 s15, s11
  s_mov_b32 s14, 223232
  s_mulk_i32 s44, 6912
  v_lshlrev_b32 v26, 5, v0
  s_and_b32 s28, s2, 63
  s_lshr_b32 s29, s2, 6
  s_lshr_b32 s4, s3, 6
  s_lshl_b32 s36, s28, 3
  v_bfe_u32 v21, v0, 3, 3
  v_add3_u32 v25, s36, 4, v21
  v_and_b32 v25, 0x1ff, v25
  v_mul_u32_u24 v25, 0x180, v25
  v_lshrrev_b32 v23, 4, v0
  v_lshrrev_b32 v24, 1, v0
  v_and_b32 v24, 4, v24
  v_bitop3_b32 v24, v24, v23, v0 bitop3:0x96
  v_and_b32 v24, 7, v24
  v_lshl_add_u32 v6, v24, 4, v25
  s_lshl3_add_u32 s36, s29, s4
  s_add_u32 s48, s36, 484
  s_add_u32 s49, s48, 4
  s_and_b32 s49, s49, 0x1ff
  s_mov_b32 s37, 196608
  s_mul_i32 s48, s48, s37
  s_mul_i32 s49, s49, s37
  s_mov_b32 s10, 100663296
  s_waitcnt lgkmcnt(0)
  s_sub_u32 s12, s12, 2048
  s_subb_u32 s13, s13, 0
  buffer_load_dword v65, v26, s[12:15], s44 offen offset:2048
  v_and_b32 v22, 4, v23
  v_and_b32 v24, 2, v21
  v_bitop3_b32 v24, v24, v22, v0 bitop3:0x96
  v_and_b32 v24, 7, v24
  v_mul_u32_u24 v25, 1152, v21
  v_lshl_add_u32 v25, v24, 4, v25
  v_add_u32 v136, 2048, v25
  v_add_u32 v137, 1152, v25
  v_add_u32 v138, 256, v25
  s_mul_i32 s62, s4, 9216
  s_mul_i32 s58, s4, 3072
  s_add_u32 s63, s58, 40960
  s_mov_b32 s22, 1800
  s_mov_b32 s23, s11
  v_lshlrev_b32 v34, 4, v0
  s_lshl_b32 s37, s4, 10
  s_add_u32 m0, s37, 24576
  v_mul_u32_u24 v35, 9, v0
  buffer_load_dwordx4 v34, s[20:23], 0 offen lds
  v_and_b32 v35, -4, v35
  s_load_dwordx2 s[16:17], s[0:1], 16
  s_load_dwordx2 s[24:25], s[0:1], 48
  v_and_b32 v16, 63, v0
  v_and_b32 v17, 15, v16
  v_lshrrev_b32 v18, 4, v16
  v_lshrrev_b32 v20, 2, v17
  v_and_b32 v27, 1, v18
  v_lshrrev_b32 v28, 3, v17
  s_add_u32 m0, s63, 0
  s_add_u32 s36, s62, 0
  buffer_load_dwordx4 v136, s[12:15], s36 offen offset:0 lds
  v_lshl_add_u32 v21, v27, 1, v28
  v_mul_u32_u24 v22, 3072, v18
  v_lshl_add_u32 v22, v20, 7, v22
  v_lshl_add_u32 v22, v21, 5, v22
  v_and_b32 v29, 3, v17
  v_lshl_add_u32 v22, v29, 3, v22
  s_mul_i32 s37, s4, 3
  s_and_b32 s38, s37, 3
  buffer_load_dwordx4 v137, s[12:15], s36 offen offset:1024 lds
  s_lshl_b32 s38, s38, 5
  s_lshr_b32 s39, s37, 2
  s_lshl_b32 s39, s39, 10
  s_add_u32 s39, s39, 40960
  v_xor_b32 v23, s38, v22
  v_add_u32 v12, s39, v23
  v_add_u32 v15, 73728, v12
  s_add_u32 s37, s37, 1
  buffer_load_dwordx4 v138, s[12:15], s36 offen offset:2048 lds
  s_and_b32 s38, s37, 3
  s_lshl_b32 s38, s38, 5
  s_lshr_b32 s39, s37, 2
  s_lshl_b32 s39, s39, 10
  s_add_u32 s39, s39, 40960
  v_xor_b32 v23, s38, v22
  s_mov_b64 exec, 0
  s_cmp_eq_u32 s4, 0
  s_cbranch_scc1 L_hop0
  s_cmp_eq_u32 s4, 1
  s_cbranch_scc1 L_hop1
  s_cmp_eq_u32 s4, 2
  s_cbranch_scc1 L_hop2
  s_branch L_hop3
L_hopped:
  s_mov_b64 exec, -1
  v_add_u32 v13, s39, v23
  s_add_u32 m0, s63, 12288
  s_add_u32 s36, s62, 36864
  buffer_load_dwordx4 v136, s[12:15], s36 offen offset:0 lds
  v_add_u32 v9, 73728, v13
  s_add_u32 s37, s37, 1
  s_and_b32 s38, s37, 3
  s_lshl_b32 s38, s38, 5
  s_lshr_b32 s39, s37, 2
  s_lshl_b32 s39, s39, 10
  s_add_u32 s39, s39, 40960
  v_xor_b32 v23, s38, v22
  buffer_load_dwordx4 v137, s[12:15], s36 offen offset:1024 lds
  v_add_u32 v14, s39, v23
  v_add_u32 v11, 73728, v14
  s_mov_b32 s46, 0x3e553b95
  s_mov_b32 s47, s46
  s_mov_b32 s44, 0xffff0000
  v_bfe_u32 v19, v17, 1, 3
  v_and_b32 v21, 1, v17
  v_lshlrev_b32 v21, 2, v21
  buffer_load_dwordx4 v138, s[12:15], s36 offen offset:2048 lds
  v_xor_b32 v19, v19, v21
  v_xor_b32 v21, v18, v19
  v_lshlrev_b32 v21, 4, v21
  v_lshl_add_u32 v0, v17, 7, v21
  s_lshl_b32 s32, s4, 10
  v_subrev_u32 v10, s32, v0
  v_and_b32 v21, 1, v17
  v_mul_u32_u24 v21, 0xaaaa, v21
  s_add_u32 m0, s63, 24576
  s_add_u32 s36, s62, 73728
  buffer_load_dwordx4 v136, s[12:15], s36 offen offset:0 lds
  v_add_u32 v21, 0x4444, v21
  v_lshl_add_u32 v10, v10, 16, v21
  v_xor_b32 v1, 64, v0
  v_lshlrev_b32 v22, 4, v17
  v_lshl_add_u32 v23, v18, 10, v22
  s_and_b32 s5, s4, 1
  s_lshl_b32 s37, s5, 9
  s_add_u32 s38, s37, 114688
  v_add_u32 v3, s38, v23
  s_sub_u32 s38, 114688, s37
  v_add_u32 v2, s38, v23
  s_lshl_b32 s37, s4, 12
  s_add_u32 s37, s37, 90112
  v_add_u32 v4, s37, v23
  s_lshl_b32 s37, s4, 11
  s_add_u32 s37, s37, 106496
  v_lshrrev_b32 v23, 1, v18
  v_lshl_add_u32 v24, v23, 10, v22
  v_lshl_add_u32 v24, v27, 3, v24
  v_add_u32 v5, s37, v24
  s_mov_b32 s7, 24576
  v_sub_u32 v24, v28, v23
  v_mul_i32_i24 v24, 15, v24
  v_and_b32 v26, 7, v17
  v_lshlrev_b32 v25, 2, v27
  v_sub_u32 v30, v26, v25
  v_add3_u32 v24, v24, v30, 19
  s_lshl_b32 s37, s4, 1
  s_and_b32 s37, s37, 0
  s_waitcnt lgkmcnt(0)
  s_mov_b32 s18, 73728
  s_mov_b32 s19, s11
  s_mul_i32 s60, s4, 0x02020000
  s_add_u32 s60, s60, 0x01000c0c
  s_add_u32 s37, s37, 24576
  v_lshl_add_u32 v144, v24, 3, s37
  v_add_u32 v145, 960, v144
  s_lshl_b32 s37, s28, 3
  v_add3_u32 v24, s37, 4, v26
  v_and_b32 v24, 0x1ff, v24
  v_mul_u32_u24 v24, 0x180, v24
  v_mul_u32_u24 v26, 196608, v28
  v_add_u32 v24, v24, v26
  v_lshl_add_u32 v24, v18, 4, v24
  s_lshr_b32 s37, s4, 1
  s_lshl_b32 s38, s37, 6
  s_add_u32 s39, s38, 256
  v_add_u32 v8, s39, v24
  s_lshl_b32 s39, s5, 7
  s_add_u32 s38, s38, s39
  v_add_u32 v7, s38, v24
  v_and_b32 v24, 16, v16
  v_lshlrev_b32 v24, 2, v24
  v_lshlrev_b32 v26, 4, v16
  v_xor_b32 v24, v24, v26
  v_accvgpr_write_b32 a228, v24
  v_add_u32 v30, v25, v20
  v_mul_u32_u24 v31, 3072, v23
  v_lshl_add_u32 v31, v29, 4, v31
  v_mad_u32_u24 v32, v30, 3, s5
  v_lshrrev_b32 v33, 1, v32
  v_xor_b32 v33, s37, v33
  v_and_b32 v33, 1, v33
  v_lshl_add_u32 v32, v32, 1, v33
  v_lshl_add_u32 v32, v32, 6, v31
  v_add_u32 v32, 114688, v32
  v_accvgpr_write_b32 a229, v32
  v_mad_u32_u24 v32, v30, 3, 2
  v_lshrrev_b32 v33, 1, v32
  buffer_load_dwordx4 v137, s[12:15], s36 offen offset:1024 lds
  v_xor_b32 v33, s37, v33
  v_and_b32 v33, 1, v33
  v_lshl_add_u32 v32, v32, 1, v33
  v_lshl_add_u32 v32, v32, 6, v31
  v_add_u32 v32, 114688, v32
  v_accvgpr_write_b32 a230, v32
  v_mul_u32_u24 v31, 3072, v18
  v_lshl_add_u32 v31, v29, 4, v31
  v_mad_u32_u24 v32, v20, 3, s5
  v_lshrrev_b32 v33, 1, v32
  v_xor_b32 v33, s37, v33
  v_and_b32 v33, 1, v33
  buffer_load_dwordx4 v138, s[12:15], s36 offen offset:2048 lds
  v_lshl_add_u32 v32, v32, 1, v33
  v_lshl_add_u32 v32, v32, 6, v31
  v_accvgpr_write_b32 a231, v32
  v_mad_u32_u24 v32, v20, 3, 2
  v_lshrrev_b32 v33, 1, v32
  v_xor_b32 v33, s37, v33
  v_and_b32 v33, 1, v33
  v_lshl_add_u32 v32, v32, 1, v33
  v_lshl_add_u32 v32, v32, 6, v31
  v_accvgpr_write_b32 a232, v32
  s_mul_i32 s59, s37, 12288
  s_add_u32 s59, s59, s58
  s_add_u32 m0, s63, 36864
  s_add_u32 s36, s62, 110592
  buffer_load_dwordx4 v136, s[12:15], s36 offen offset:0 lds
  v_cmp_gt_u32 vcc, 2, v29
  v_mov_b32 v31, 0x3f803f80
  s_mov_b32 s26, 100663296
  s_mov_b32 s27, s11
  v_cndmask_b32 v31, 0, v31, vcc
  v_accvgpr_write_b32 a240, v31
  v_accvgpr_write_b32 a241, v31
  v_accvgpr_write_b32 a242, v31
  v_accvgpr_write_b32 a243, v31
  v_lshrrev_b32 v150, 2, v16
  v_xor_b32 v151, v16, v150
  s_cmp_eq_u32 s28, 63
  s_cselect_b32 s37, 4, 0
  buffer_load_dwordx4 v137, s[12:15], s36 offen offset:1024 lds
  v_and_b32 v151, s37, v151
  v_cmp_eq_u32 vcc, 0, v151
  s_cmp_eq_u32 s29, 3
  s_cselect_b32 s37, 0xc31044fe, 0
  v_mov_b32 v150, s37
  v_mov_b32 v149, 0xc31044fe
  v_cndmask_b32 v151, 0, v150, vcc
  v_cndmask_b32 v150, v149, 0, vcc
  s_mov_b32 s45, 0x3fb8aa3b
  s_mov_b32 s61, 0x07060302
  s_lshl_b32 s37, s29, 3
  buffer_load_dwordx4 v138, s[12:15], s36 offen offset:2048 lds
  s_lshl_b32 s38, s5, 2
  s_waitcnt vmcnt(12)
  s_barrier
  ds_read_b64 v[156:157], v144 offset:24
  s_xor_b32 s39, s38, 0
  ds_read_b64 v[158:159], v144 offset:16
  s_add_u32 s40, s39, s37
  ds_read_b64 v[152:153], v144 offset:8
  s_add_u32 s40, s40, 484
  ds_read_b64 v[154:155], v144 offset:0
  s_and_b32 s40, s40, 0x1ff
  s_add_u32 m0, s63, 49152
  s_add_u32 s36, s62, 147456
  buffer_load_dwordx4 v136, s[12:15], s36 offen offset:0 lds
  s_mul_i32 s40, s40, 196608
  ds_read_b64 v[160:161], v144 offset:264
  s_sub_u32 s39, s39, s4
  ds_read_b64 v[162:163], v144 offset:256
  s_sub_u32 s39, s39, 96
  ds_read_b64 v[164:165], v144 offset:248
  s_mul_i32 s52, s39, 196608
  s_xor_b32 s39, s38, 2
  ds_read_b64 v[166:167], v144 offset:240
  s_add_u32 s41, s39, s37
  ds_read_b64 v[172:173], v144 offset:504
  s_add_u32 s41, s41, 484
  buffer_load_dwordx4 v137, s[12:15], s36 offen offset:1024 lds
  ds_read_b64 v[174:175], v144 offset:496
  s_and_b32 s41, s41, 0x1ff
  ds_read_b64 v[168:169], v144 offset:488
  s_mul_i32 s41, s41, 196608
  s_sub_u32 s39, s39, s4
  ds_read_b64 v[170:171], v144 offset:480
  s_sub_u32 s39, s39, 96
  ds_read_b64 v[176:177], v144 offset:744
  s_mul_i32 s53, s39, 196608
  ds_read_b64 v[178:179], v144 offset:736
  s_xor_b32 s39, s38, 4
  s_add_u32 s42, s39, s37
  buffer_load_dwordx4 v138, s[12:15], s36 offen offset:2048 lds
  ds_read_b64 v[180:181], v144 offset:728
  s_add_u32 s42, s42, 484
  ds_read_b64 v[182:183], v144 offset:720
  s_and_b32 s42, s42, 0x1ff
  ds_read_b64 v[116:117], v144 offset:984
  s_mul_i32 s42, s42, 196608
  ds_read_b64 v[118:119], v144 offset:976
  s_sub_u32 s39, s39, s4
  s_sub_u32 s39, s39, 96
  ds_read_b64 v[124:125], v144 offset:968
  s_mul_i32 s54, s39, 196608
  ds_read_b64 v[126:127], v144 offset:960
  s_add_u32 m0, s63, 61440
  s_add_u32 s36, s62, 184320
  buffer_load_dwordx4 v136, s[12:15], s36 offen offset:0 lds
  s_xor_b32 s39, s38, 6
  ds_read_b64 v[120:121], v144 offset:1224
  s_add_u32 s43, s39, s37
  s_add_u32 s43, s43, 484
  ds_read_b64 v[122:123], v144 offset:1216
  s_and_b32 s43, s43, 0x1ff
  ds_read_b64 v[128:129], v144 offset:1208
  s_mul_i32 s43, s43, 196608
  ds_read_b64 v[130:131], v144 offset:1200
  s_sub_u32 s39, s39, s4
  ds_read_b64 v[132:133], v144 offset:1464
  s_sub_u32 s39, s39, 96
  buffer_load_dwordx4 v137, s[12:15], s36 offen offset:1024 lds
  s_mul_i32 s55, s39, 196608
  ds_read_b64 v[134:135], v144 offset:1456
  s_mul_i32 s34, s32, 3
  ds_read_b64 v[140:141], v144 offset:1448
  s_add_u32 s34, s34, 106496
  ds_read_b64 v[142:143], v144 offset:1440
  s_mov_b32 s35, 1
  s_mov_b32 s30, 1
  s_waitcnt vmcnt(11)
  s_barrier
  ds_read_b64_tr_b16 v[184:185], v12 offset:0
  ds_read_b64_tr_b16 v[186:187], v12 offset:512
  buffer_load_dwordx4 v138, s[12:15], s36 offen offset:2048 lds
  ds_read_b64_tr_b16 v[188:189], v13 offset:0
  ds_read_b64_tr_b16 v[190:191], v13 offset:512
  ds_read_b64_tr_b16 v[192:193], v14 offset:0
  ds_read_b64_tr_b16 v[194:195], v14 offset:512
  ds_read_b64_tr_b16 v[196:197], v12 offset:12288
  ds_read_b64_tr_b16 v[198:199], v12 offset:12800
  ds_read_b64_tr_b16 v[200:201], v13 offset:12288
  ds_read_b64_tr_b16 v[202:203], v13 offset:12800
  ds_read_b64_tr_b16 v[204:205], v14 offset:12288
  ds_read_b64_tr_b16 v[206:207], v14 offset:12800
  s_waitcnt lgkmcnt(12)
  v_perm_b32 v88, v157, v156, s60
  s_lshl_b32 m0, s3, 4
  s_nop 0
  buffer_load_dwordx4 v6, s[8:11], s48 offen offset:0 nt lds
  v_perm_b32 v89, v159, v158, s60
  v_perm_b32 v90, v153, v152, s60
  v_perm_b32 v91, v155, v154, s60
  v_perm_b32 v92, v161, v160, s60
  v_perm_b32 v93, v163, v162, s60
  v_perm_b32 v94, v165, v164, s60
  v_perm_b32 v95, v167, v166, s60
  v_perm_b32 v96, v173, v172, s60
  v_perm_b32 v97, v175, v174, s60
  v_perm_b32 v98, v169, v168, s60
  v_perm_b32 v99, v171, v170, s60
  v_perm_b32 v100, v177, v176, s60
  s_addk_i32 m0, 8064
  s_nop 0
  buffer_load_dwordx4 v6, s[8:11], s48 offen offset:128 nt lds
  v_perm_b32 v101, v179, v178, s60
  v_perm_b32 v102, v181, v180, s60
  v_perm_b32 v103, v183, v182, s60
  v_perm_b32 v104, v117, v116, s60
  v_perm_b32 v105, v119, v118, s60
  v_perm_b32 v106, v125, v124, s60
  v_perm_b32 v107, v127, v126, s60
  v_perm_b32 v108, v121, v120, s60
  v_perm_b32 v109, v123, v122, s60
  v_perm_b32 v110, v129, v128, s60
  v_perm_b32 v111, v131, v130, s60
  v_perm_b32 v112, v133, v132, s60
  s_addk_i32 m0, 8064
  s_nop 0
  buffer_load_dwordx4 v6, s[8:11], s48 offen offset:256 nt lds
  v_perm_b32 v113, v135, v134, s60
  v_perm_b32 v114, v141, v140, s60
  v_perm_b32 v115, v143, v142, s60
  s_waitcnt lgkmcnt(10)
  v_lshlrev_b32 v40, 16, v184
  v_and_b32 v41, s44, v184
  v_lshlrev_b32 v42, 16, v185
  v_and_b32 v43, s44, v185
  v_lshlrev_b32 v44, 16, v186
  v_and_b32 v45, s44, v186
  v_lshlrev_b32 v46, 16, v187
  v_and_b32 v47, s44, v187
  s_lshl_b32 m0, s3, 4
  s_addk_i32 m0, 4096
  s_nop 0
  buffer_load_dwordx4 v6, s[8:11], s49 offen offset:0 nt lds
  v_pk_mul_f32 v[40:41], v[40:41], s[46:47]
  v_pk_mul_f32 v[42:43], v[42:43], s[46:47]
  v_pk_mul_f32 v[44:45], v[44:45], s[46:47]
  v_pk_mul_f32 v[46:47], v[46:47], s[46:47]
  v_cvt_pk_bf16_f32 v184, v40, v41
  v_cvt_pk_bf16_f32 v185, v42, v43
  v_cvt_pk_bf16_f32 v186, v44, v45
  s_waitcnt lgkmcnt(0)
  v_cvt_pk_bf16_f32 v187, v46, v47
  v_lshlrev_b32 v48, 16, v188
  v_and_b32 v49, s44, v188
  v_lshlrev_b32 v50, 16, v189
  s_addk_i32 m0, 8064
  s_nop 0
  buffer_load_dwordx4 v6, s[8:11], s49 offen offset:128 nt lds
  v_and_b32 v51, s44, v189
  v_lshlrev_b32 v52, 16, v190
  v_and_b32 v53, s44, v190
  v_lshlrev_b32 v54, 16, v191
  v_and_b32 v55, s44, v191
  v_pk_mul_f32 v[48:49], v[48:49], s[46:47]
  v_pk_mul_f32 v[50:51], v[50:51], s[46:47]
  v_pk_mul_f32 v[52:53], v[52:53], s[46:47]
  v_pk_mul_f32 v[54:55], v[54:55], s[46:47]
  v_cvt_pk_bf16_f32 v188, v48, v49
  v_cvt_pk_bf16_f32 v189, v50, v51
  v_cvt_pk_bf16_f32 v190, v52, v53
  s_addk_i32 m0, 8064
  s_nop 0
  buffer_load_dwordx4 v6, s[8:11], s49 offen offset:256 nt lds
  v_cvt_pk_bf16_f32 v191, v54, v55
  v_lshlrev_b32 v56, 16, v192
  v_and_b32 v57, s44, v192
  v_lshlrev_b32 v58, 16, v193
  v_and_b32 v59, s44, v193
  v_lshlrev_b32 v60, 16, v194
  v_and_b32 v61, s44, v194
  v_lshlrev_b32 v62, 16, v195
  v_and_b32 v63, s44, v195
  v_pk_mul_f32 v[56:57], v[56:57], s[46:47]
  v_pk_mul_f32 v[58:59], v[58:59], s[46:47]
  v_pk_mul_f32 v[60:61], v[60:61], s[46:47]
  s_lshr_b32 s36, s2, 3
  s_mulk_i32 s36, 2304
  buffer_load_dword v66, v35, s[16:19], s36 offen
  v_pk_mul_f32 v[62:63], v[62:63], s[46:47]
  v_cvt_pk_bf16_f32 v192, v56, v57
  v_cvt_pk_bf16_f32 v193, v58, v59
  v_cvt_pk_bf16_f32 v194, v60, v61
  v_cvt_pk_bf16_f32 v195, v62, v63
  v_lshlrev_b32 v40, 16, v196
  v_and_b32 v41, s44, v196
  v_lshlrev_b32 v42, 16, v197
  v_and_b32 v43, s44, v197
  v_lshlrev_b32 v44, 16, v198
  v_and_b32 v45, s44, v198
  v_lshlrev_b32 v46, 16, v199
  v_and_b32 v47, s44, v199
  v_pk_mul_f32 v[40:41], v[40:41], s[46:47]
  v_pk_mul_f32 v[42:43], v[42:43], s[46:47]
  v_pk_mul_f32 v[44:45], v[44:45], s[46:47]
  v_pk_mul_f32 v[46:47], v[46:47], s[46:47]
  v_cvt_pk_bf16_f32 v196, v40, v41
  v_cvt_pk_bf16_f32 v197, v42, v43
  v_cvt_pk_bf16_f32 v198, v44, v45
  v_cvt_pk_bf16_f32 v199, v46, v47
  v_lshlrev_b32 v48, 16, v200
  v_and_b32 v49, s44, v200
  v_lshlrev_b32 v50, 16, v201
  v_and_b32 v51, s44, v201
  v_lshlrev_b32 v52, 16, v202
  v_and_b32 v53, s44, v202
  v_lshlrev_b32 v54, 16, v203
  v_and_b32 v55, s44, v203
  v_pk_mul_f32 v[48:49], v[48:49], s[46:47]
  v_pk_mul_f32 v[50:51], v[50:51], s[46:47]
  v_pk_mul_f32 v[52:53], v[52:53], s[46:47]
  v_pk_mul_f32 v[54:55], v[54:55], s[46:47]
  v_cvt_pk_bf16_f32 v200, v48, v49
  v_cvt_pk_bf16_f32 v201, v50, v51
  v_cvt_pk_bf16_f32 v202, v52, v53
  v_cvt_pk_bf16_f32 v203, v54, v55
  v_lshlrev_b32 v56, 16, v204
  v_and_b32 v57, s44, v204
  v_lshlrev_b32 v58, 16, v205
  v_and_b32 v59, s44, v205
  v_lshlrev_b32 v60, 16, v206
  v_and_b32 v61, s44, v206
  v_lshlrev_b32 v62, 16, v207
  v_and_b32 v63, s44, v207
  v_pk_mul_f32 v[56:57], v[56:57], s[46:47]
  v_pk_mul_f32 v[58:59], v[58:59], s[46:47]
  v_pk_mul_f32 v[60:61], v[60:61], s[46:47]
  v_pk_mul_f32 v[62:63], v[62:63], s[46:47]
  v_cvt_pk_bf16_f32 v204, v56, v57
  v_cvt_pk_bf16_f32 v205, v58, v59
  v_cvt_pk_bf16_f32 v206, v60, v61
  v_cvt_pk_bf16_f32 v207, v62, v63
  s_waitcnt vmcnt(13)
  s_barrier
  ds_read_b64_tr_b16 v[208:209], v12 offset:24576
  ds_read_b64_tr_b16 v[210:211], v12 offset:25088
  ds_read_b64_tr_b16 v[212:213], v13 offset:24576
  ds_read_b64_tr_b16 v[214:215], v13 offset:25088
  ds_read_b64_tr_b16 v[216:217], v14 offset:24576
  ds_read_b64_tr_b16 v[218:219], v14 offset:25088
  ds_read_b64_tr_b16 v[220:221], v12 offset:36864
  ds_read_b64_tr_b16 v[222:223], v12 offset:37376
  ds_read_b64_tr_b16 v[224:225], v13 offset:36864
  ds_read_b64_tr_b16 v[226:227], v13 offset:37376
  ds_read_b64_tr_b16 v[228:229], v14 offset:36864
  ds_read_b64_tr_b16 v[230:231], v14 offset:37376
  s_waitcnt lgkmcnt(10)
  v_lshlrev_b32 v40, 16, v208
  v_and_b32 v41, s44, v208
  v_lshlrev_b32 v42, 16, v209
  v_and_b32 v43, s44, v209
  v_lshlrev_b32 v44, 16, v210
  v_and_b32 v45, s44, v210
  v_lshlrev_b32 v46, 16, v211
  v_and_b32 v47, s44, v211
  v_pk_mul_f32 v[40:41], v[40:41], s[46:47]
  v_pk_mul_f32 v[42:43], v[42:43], s[46:47]
  v_pk_mul_f32 v[44:45], v[44:45], s[46:47]
  v_pk_mul_f32 v[46:47], v[46:47], s[46:47]
  v_cvt_pk_bf16_f32 v208, v40, v41
  v_cvt_pk_bf16_f32 v209, v42, v43
L_hop0:
  s_cbranch_execz L_hopped
  v_cvt_pk_bf16_f32 v210, v44, v45
  s_waitcnt lgkmcnt(0)
  v_cvt_pk_bf16_f32 v211, v46, v47
  v_lshlrev_b32 v48, 16, v212
  v_and_b32 v49, s44, v212
  v_lshlrev_b32 v50, 16, v213
  v_and_b32 v51, s44, v213
  v_lshlrev_b32 v52, 16, v214
  v_and_b32 v53, s44, v214
  v_lshlrev_b32 v54, 16, v215
  v_and_b32 v55, s44, v215
  v_pk_mul_f32 v[48:49], v[48:49], s[46:47]
  v_pk_mul_f32 v[50:51], v[50:51], s[46:47]
  v_pk_mul_f32 v[52:53], v[52:53], s[46:47]
  v_pk_mul_f32 v[54:55], v[54:55], s[46:47]
  v_cvt_pk_bf16_f32 v212, v48, v49
  v_cvt_pk_bf16_f32 v213, v50, v51
  v_cvt_pk_bf16_f32 v214, v52, v53
  v_cvt_pk_bf16_f32 v215, v54, v55
  v_lshlrev_b32 v56, 16, v216
  v_and_b32 v57, s44, v216
  v_lshlrev_b32 v58, 16, v217
  v_and_b32 v59, s44, v217
  v_lshlrev_b32 v60, 16, v218
  v_and_b32 v61, s44, v218
  v_lshlrev_b32 v62, 16, v219
  v_and_b32 v63, s44, v219
  v_pk_mul_f32 v[56:57], v[56:57], s[46:47]
  v_pk_mul_f32 v[58:59], v[58:59], s[46:47]
  v_pk_mul_f32 v[60:61], v[60:61], s[46:47]
  v_pk_mul_f32 v[62:63], v[62:63], s[46:47]
  v_cvt_pk_bf16_f32 v216, v56, v57
  v_cvt_pk_bf16_f32 v217, v58, v59
  v_cvt_pk_bf16_f32 v218, v60, v61
  v_cvt_pk_bf16_f32 v219, v62, v63
  v_lshlrev_b32 v40, 16, v220
  v_and_b32 v41, s44, v220
  v_lshlrev_b32 v42, 16, v221
  v_and_b32 v43, s44, v221
  v_lshlrev_b32 v44, 16, v222
  v_and_b32 v45, s44, v222
  v_lshlrev_b32 v46, 16, v223
  v_and_b32 v47, s44, v223
  v_pk_mul_f32 v[40:41], v[40:41], s[46:47]
  v_pk_mul_f32 v[42:43], v[42:43], s[46:47]
  v_pk_mul_f32 v[44:45], v[44:45], s[46:47]
  v_pk_mul_f32 v[46:47], v[46:47], s[46:47]
  v_cvt_pk_bf16_f32 v220, v40, v41
  v_cvt_pk_bf16_f32 v221, v42, v43
  v_cvt_pk_bf16_f32 v222, v44, v45
  v_cvt_pk_bf16_f32 v223, v46, v47
  v_lshlrev_b32 v48, 16, v224
  v_and_b32 v49, s44, v224
  v_lshlrev_b32 v50, 16, v225
  v_and_b32 v51, s44, v225
  v_lshlrev_b32 v52, 16, v226
  v_and_b32 v53, s44, v226
  v_lshlrev_b32 v54, 16, v227
  v_and_b32 v55, s44, v227
  v_pk_mul_f32 v[48:49], v[48:49], s[46:47]
  v_pk_mul_f32 v[50:51], v[50:51], s[46:47]
  v_pk_mul_f32 v[52:53], v[52:53], s[46:47]
  v_pk_mul_f32 v[54:55], v[54:55], s[46:47]
  v_cvt_pk_bf16_f32 v224, v48, v49
  v_cvt_pk_bf16_f32 v225, v50, v51
  v_cvt_pk_bf16_f32 v226, v52, v53
  v_cvt_pk_bf16_f32 v227, v54, v55
  v_lshlrev_b32 v56, 16, v228
  v_and_b32 v57, s44, v228
  v_lshlrev_b32 v58, 16, v229
  v_and_b32 v59, s44, v229
  v_lshlrev_b32 v60, 16, v230
  v_and_b32 v61, s44, v230
  v_lshlrev_b32 v62, 16, v231
  v_and_b32 v63, s44, v231
  s_add_u32 m0, s63, 73728
  s_add_u32 s36, s62, 384
  buffer_load_dwordx4 v136, s[12:15], s36 offen offset:0 lds
  v_pk_mul_f32 v[56:57], v[56:57], s[46:47]
  v_pk_mul_f32 v[58:59], v[58:59], s[46:47]
  v_pk_mul_f32 v[60:61], v[60:61], s[46:47]
  v_pk_mul_f32 v[62:63], v[62:63], s[46:47]
  v_cvt_pk_bf16_f32 v228, v56, v57
  v_cvt_pk_bf16_f32 v229, v58, v59
  v_cvt_pk_bf16_f32 v230, v60, v61
  v_cvt_pk_bf16_f32 v231, v62, v63
  s_waitcnt vmcnt(8)
  s_barrier
  ds_read_b64_tr_b16 v[232:233], v12 offset:49152
  ds_read_b64_tr_b16 v[234:235], v12 offset:49664
  ds_read_b64_tr_b16 v[236:237], v13 offset:49152
  ds_read_b64_tr_b16 v[238:239], v13 offset:49664
  ds_read_b64_tr_b16 v[240:241], v14 offset:49152
  ds_read_b64_tr_b16 v[242:243], v14 offset:49664
  ds_read_b64_tr_b16 v[244:245], v12 offset:61440
  ds_read_b64_tr_b16 v[246:247], v12 offset:61952
  ds_read_b64_tr_b16 v[248:249], v13 offset:61440
  ds_read_b64_tr_b16 v[250:251], v13 offset:61952
  buffer_load_dwordx4 v137, s[12:15], s36 offen offset:1024 lds
  ds_read_b64_tr_b16 v[252:253], v14 offset:61440
  ds_read_b64_tr_b16 v[254:255], v14 offset:61952
  s_waitcnt lgkmcnt(10)
  v_lshlrev_b32 v40, 16, v232
  v_and_b32 v41, s44, v232
  v_lshlrev_b32 v42, 16, v233
  v_and_b32 v43, s44, v233
  v_lshlrev_b32 v44, 16, v234
  v_and_b32 v45, s44, v234
  v_lshlrev_b32 v46, 16, v235
  v_and_b32 v47, s44, v235
  v_pk_mul_f32 v[40:41], v[40:41], s[46:47]
  v_pk_mul_f32 v[42:43], v[42:43], s[46:47]
  v_pk_mul_f32 v[44:45], v[44:45], s[46:47]
  v_pk_mul_f32 v[46:47], v[46:47], s[46:47]
  v_cvt_pk_bf16_f32 v232, v40, v41
  v_cvt_pk_bf16_f32 v233, v42, v43
  v_cvt_pk_bf16_f32 v234, v44, v45
  s_waitcnt lgkmcnt(0)
  v_cvt_pk_bf16_f32 v235, v46, v47
  buffer_load_dwordx4 v138, s[12:15], s36 offen offset:2048 lds
  v_lshlrev_b32 v48, 16, v236
  v_and_b32 v49, s44, v236
  v_lshlrev_b32 v50, 16, v237
  v_and_b32 v51, s44, v237
  v_lshlrev_b32 v52, 16, v238
  v_and_b32 v53, s44, v238
  v_lshlrev_b32 v54, 16, v239
  v_and_b32 v55, s44, v239
  v_pk_mul_f32 v[48:49], v[48:49], s[46:47]
  v_pk_mul_f32 v[50:51], v[50:51], s[46:47]
  v_pk_mul_f32 v[52:53], v[52:53], s[46:47]
  v_pk_mul_f32 v[54:55], v[54:55], s[46:47]
  v_cvt_pk_bf16_f32 v236, v48, v49
  v_cvt_pk_bf16_f32 v237, v50, v51
  v_cvt_pk_bf16_f32 v238, v52, v53
  v_cvt_pk_bf16_f32 v239, v54, v55
  v_lshlrev_b32 v56, 16, v240
  v_and_b32 v57, s44, v240
  v_lshlrev_b32 v58, 16, v241
  v_and_b32 v59, s44, v241
  s_add_u32 m0, s63, 86016
  s_add_u32 s36, s62, 37248
  buffer_load_dwordx4 v136, s[12:15], s36 offen offset:0 lds
  v_lshlrev_b32 v60, 16, v242
  v_and_b32 v61, s44, v242
  v_lshlrev_b32 v62, 16, v243
  v_and_b32 v63, s44, v243
  v_pk_mul_f32 v[56:57], v[56:57], s[46:47]
  v_pk_mul_f32 v[58:59], v[58:59], s[46:47]
  v_pk_mul_f32 v[60:61], v[60:61], s[46:47]
  v_pk_mul_f32 v[62:63], v[62:63], s[46:47]
  v_cvt_pk_bf16_f32 v240, v56, v57
  v_cvt_pk_bf16_f32 v241, v58, v59
  v_cvt_pk_bf16_f32 v242, v60, v61
  v_cvt_pk_bf16_f32 v243, v62, v63
  v_lshlrev_b32 v40, 16, v244
  v_and_b32 v41, s44, v244
  v_lshlrev_b32 v42, 16, v245
  v_and_b32 v43, s44, v245
  v_lshlrev_b32 v44, 16, v246
  v_and_b32 v45, s44, v246
  v_lshlrev_b32 v46, 16, v247
  v_and_b32 v47, s44, v247
  buffer_load_dwordx4 v137, s[12:15], s36 offen offset:1024 lds
  v_pk_mul_f32 v[40:41], v[40:41], s[46:47]
  v_pk_mul_f32 v[42:43], v[42:43], s[46:47]
  v_pk_mul_f32 v[44:45], v[44:45], s[46:47]
  v_pk_mul_f32 v[46:47], v[46:47], s[46:47]
  v_cvt_pk_bf16_f32 v244, v40, v41
  v_cvt_pk_bf16_f32 v245, v42, v43
  v_cvt_pk_bf16_f32 v246, v44, v45
  v_cvt_pk_bf16_f32 v247, v46, v47
  v_lshlrev_b32 v48, 16, v248
  v_and_b32 v49, s44, v248
  v_lshlrev_b32 v50, 16, v249
  v_and_b32 v51, s44, v249
  v_lshlrev_b32 v52, 16, v250
  v_and_b32 v53, s44, v250
  v_lshlrev_b32 v54, 16, v251
  v_and_b32 v55, s44, v251
  v_pk_mul_f32 v[48:49], v[48:49], s[46:47]
  v_pk_mul_f32 v[50:51], v[50:51], s[46:47]
  v_pk_mul_f32 v[52:53], v[52:53], s[46:47]
  v_pk_mul_f32 v[54:55], v[54:55], s[46:47]
  buffer_load_dwordx4 v138, s[12:15], s36 offen offset:2048 lds
  v_cvt_pk_bf16_f32 v248, v48, v49
  v_cvt_pk_bf16_f32 v249, v50, v51
  v_cvt_pk_bf16_f32 v250, v52, v53
  v_cvt_pk_bf16_f32 v251, v54, v55
  v_lshlrev_b32 v56, 16, v252
  v_and_b32 v57, s44, v252
  v_lshlrev_b32 v58, 16, v253
  v_and_b32 v59, s44, v253
  v_lshlrev_b32 v60, 16, v254
  v_and_b32 v61, s44, v254
  v_lshlrev_b32 v62, 16, v255
  v_and_b32 v63, s44, v255
  v_pk_mul_f32 v[56:57], v[56:57], s[46:47]
  v_pk_mul_f32 v[58:59], v[58:59], s[46:47]
  v_pk_mul_f32 v[60:61], v[60:61], s[46:47]
  v_pk_mul_f32 v[62:63], v[62:63], s[46:47]
  v_cvt_pk_bf16_f32 v252, v56, v57
  v_cvt_pk_bf16_f32 v253, v58, v59
  v_cvt_pk_bf16_f32 v254, v60, v61
  v_cvt_pk_bf16_f32 v255, v62, v63
  s_lshl3_add_u32 s48, s29, s4
  s_add_u32 s48, s48, 4
  s_mul_i32 s48, s48, 196608
  s_add_u32 s49, s48, 786432
  s_add_u32 s50, s48, 100663296
  s_mov_b32 s10, 95158272
  s_waitcnt vmcnt(10)
  s_barrier
  ds_read_b128 a[144:147], v0 offset:0
  ds_read_b128 a[148:151], v1 offset:0
  ds_read_b128 a[152:155], v0 offset:8192
  ds_read_b128 a[156:159], v1 offset:8192
  ds_read_b128 a[160:163], v0 offset:16384
  ds_read_b128 a[164:167], v1 offset:16384
  s_waitcnt lgkmcnt(4)
  v_mfma_f32_16x16x32_bf16 v[164:167], v[184:187], a[144:147], 0
  v_mfma_f32_16x16x32_bf16 v[164:167], v[196:199], a[148:151], v[164:167]
  s_waitcnt lgkmcnt(0)
  v_mfma_f32_16x16x32_bf16 v[164:167], v[208:211], a[152:155], v[164:167]
  s_add_u32 m0, s63, 98304
  s_add_u32 s36, s62, 74112
  v_mfma_f32_16x16x32_bf16 v[164:167], v[220:223], a[156:159], v[164:167]
  buffer_load_dwordx4 v136, s[12:15], s36 offen offset:0 lds
  v_mfma_f32_16x16x32_bf16 v[164:167], v[232:235], a[160:163], v[164:167]
  v_fma_f32 v88, v88, s45, v150
  v_fma_f32 v89, v89, s45, v150
  v_mfma_f32_16x16x32_bf16 v[164:167], v[244:247], a[164:167], v[164:167]
  ds_read_b128 a[168:171], v0 offset:2048
  ds_read_b128 a[172:175], v1 offset:2048
  v_mfma_f32_16x16x32_bf16 v[172:175], v[248:251], a[164:167], 0
  ds_read_b128 a[176:179], v0 offset:10240
  ds_read_b128 a[180:183], v1 offset:10240
  v_mfma_f32_16x16x32_bf16 v[172:175], v[236:239], a[160:163], v[172:175]
  ds_read_b128 a[184:187], v0 offset:18432
  ds_read_b128 a[188:191], v1 offset:18432
  v_mfma_f32_16x16x32_bf16 v[172:175], v[224:227], a[156:159], v[172:175]
  v_cvt_pk_bf16_f32 v40, v164, v165
  v_cvt_pk_bf16_f32 v41, v166, v167
  v_mfma_f32_16x16x32_bf16 v[172:175], v[212:215], a[152:155], v[172:175]
  buffer_load_dwordx4 v137, s[12:15], s36 offen offset:1024 lds
  v_mfma_f32_16x16x32_bf16 v[172:175], v[200:203], a[148:151], v[172:175]
  buffer_load_dwordx4 v138, s[12:15], s36 offen offset:2048 lds
  v_mfma_f32_16x16x32_bf16 v[172:175], v[188:191], a[144:147], v[172:175]
  v_fma_f32 v90, v90, s45, v150
  v_fma_f32 v91, v91, s45, v150
  v_mfma_f32_16x16x32_bf16 v[164:167], v[192:195], a[144:147], 0
  s_add_u32 m0, s63, 110592
  s_add_u32 s36, s62, 110976
  v_mfma_f32_16x16x32_bf16 v[164:167], v[204:207], a[148:151], v[164:167]
  buffer_load_dwordx4 v136, s[12:15], s36 offen offset:0 lds
  v_mfma_f32_16x16x32_bf16 v[164:167], v[216:219], a[152:155], v[164:167]
  v_cvt_pk_bf16_f32 v42, v172, v173
  v_cvt_pk_bf16_f32 v43, v174, v175
  v_mfma_f32_16x16x32_bf16 v[164:167], v[228:231], a[156:159], v[164:167]
  v_fma_f32 v92, v92, s45, v150
  v_fma_f32 v93, v93, s45, v150
  v_mfma_f32_16x16x32_bf16 v[164:167], v[240:243], a[160:163], v[164:167]
  v_fma_f32 v94, v94, s45, v150
  v_fma_f32 v95, v95, s45, v150
  v_mfma_f32_16x16x32_bf16 v[164:167], v[252:255], a[164:167], v[164:167]
  s_waitcnt lgkmcnt(0)
  v_fma_f32 v96, v96, s45, v150
  v_mfma_f32_16x16x32_bf16 v[172:175], v[184:187], a[168:171], 0
  buffer_load_dwordx4 v137, s[12:15], s36 offen offset:1024 lds
  v_mfma_f32_16x16x32_bf16 v[172:175], v[196:199], a[172:175], v[172:175]
  s_waitcnt vmcnt(12)
  s_barrier
  v_mfma_f32_16x16x32_bf16 v[172:175], v[208:211], a[176:179], v[172:175]
  v_cvt_pk_bf16_f32 v44, v164, v165
  v_cvt_pk_bf16_f32 v45, v166, v167
  v_mfma_f32_16x16x32_bf16 v[172:175], v[220:223], a[180:183], v[172:175]
  ds_read_b128 a[192:195], v0 offset:4096
  ds_read_b128 a[196:199], v1 offset:4096
  v_mfma_f32_16x16x32_bf16 v[172:175], v[232:235], a[184:187], v[172:175]
  ds_read_b128 a[200:203], v0 offset:12288
  ds_read_b128 a[204:207], v1 offset:12288
  v_mfma_f32_16x16x32_bf16 v[172:175], v[244:247], a[188:191], v[172:175]
  ds_read_b128 a[208:211], v0 offset:20480
  ds_read_b128 a[212:215], v1 offset:20480
  v_mfma_f32_16x16x32_bf16 v[164:167], v[248:251], a[188:191], 0
  buffer_load_dwordx4 v138, s[12:15], s36 offen offset:2048 lds
  v_mfma_f32_16x16x32_bf16 v[164:167], v[236:239], a[184:187], v[164:167]
  s_add_u32 m0, s63, 0
  s_add_u32 s36, s62, 147840
  v_mfma_f32_16x16x32_bf16 v[164:167], v[224:227], a[180:183], v[164:167]
  v_cvt_pk_bf16_f32 v52, v172, v173
  v_cvt_pk_bf16_f32 v53, v174, v175
  v_mfma_f32_16x16x32_bf16 v[164:167], v[212:215], a[176:179], v[164:167]
  buffer_load_dwordx4 v136, s[12:15], s36 offen offset:0 lds
  v_mfma_f32_16x16x32_bf16 v[164:167], v[200:203], a[172:175], v[164:167]
  v_fma_f32 v97, v97, s45, v150
  v_fma_f32 v98, v98, s45, v150
  v_mfma_f32_16x16x32_bf16 v[164:167], v[188:191], a[168:171], v[164:167]
  v_fma_f32 v99, v99, s45, v150
  v_fma_f32 v100, v100, s45, v150
  v_mfma_f32_16x16x32_bf16 v[172:175], v[192:195], a[168:171], 0
  buffer_load_dwordx4 v137, s[12:15], s36 offen offset:1024 lds
  v_mfma_f32_16x16x32_bf16 v[172:175], v[204:207], a[172:175], v[172:175]
  v_fma_f32 v101, v101, s45, v150
  v_fma_f32 v102, v102, s45, v150
  v_mfma_f32_16x16x32_bf16 v[172:175], v[216:219], a[176:179], v[172:175]
  v_cvt_pk_bf16_f32 v54, v164, v165
  v_cvt_pk_bf16_f32 v55, v166, v167
  v_mfma_f32_16x16x32_bf16 v[172:175], v[228:231], a[180:183], v[172:175]
  v_fma_f32 v103, v103, s45, v150
  v_fma_f32 v104, v104, s45, v150
  v_mfma_f32_16x16x32_bf16 v[172:175], v[240:243], a[184:187], v[172:175]
  buffer_load_dwordx4 v138, s[12:15], s36 offen offset:2048 lds
  v_mfma_f32_16x16x32_bf16 v[172:175], v[252:255], a[188:191], v[172:175]
  s_waitcnt lgkmcnt(0)
  v_fma_f32 v105, v105, s45, v150
  v_mfma_f32_16x16x32_bf16 v[164:167], v[184:187], a[192:195], 0
  v_fma_f32 v106, v106, s45, v150
  v_fma_f32 v107, v107, s45, v150
  v_mfma_f32_16x16x32_bf16 v[164:167], v[196:199], a[196:199], v[164:167]
  v_fma_f32 v108, v108, s45, v150
  v_fma_f32 v109, v109, s45, v150
  v_mfma_f32_16x16x32_bf16 v[164:167], v[208:211], a[200:203], v[164:167]
  v_cvt_pk_bf16_f32 v56, v172, v173
  v_cvt_pk_bf16_f32 v57, v174, v175
  v_mfma_f32_16x16x32_bf16 v[164:167], v[220:223], a[204:207], v[164:167]
  ds_read_b128 a[216:219], v0 offset:6144
  ds_read_b128 a[220:223], v1 offset:6144
  v_mfma_f32_16x16x32_bf16 v[164:167], v[232:235], a[208:211], v[164:167]
  ds_read_b128 a[224:227], v0 offset:14336
  ds_read_b128 a[244:247], v1 offset:14336
  v_mfma_f32_16x16x32_bf16 v[164:167], v[244:247], a[212:215], v[164:167]
  ds_read_b128 a[248:251], v0 offset:22528
  ds_read_b128 a[252:255], v1 offset:22528
  v_mfma_f32_16x16x32_bf16 v[172:175], v[248:251], a[212:215], 0
  s_add_u32 m0, s63, 12288
  s_add_u32 s36, s62, 184704
  v_mfma_f32_16x16x32_bf16 v[172:175], v[236:239], a[208:211], v[172:175]
  buffer_load_dwordx4 v136, s[12:15], s36 offen offset:0 lds
  v_mfma_f32_16x16x32_bf16 v[172:175], v[224:227], a[204:207], v[172:175]
  v_cvt_pk_bf16_f32 v64, v164, v165
  v_cvt_pk_bf16_f32 v65, v166, v167
  v_mfma_f32_16x16x32_bf16 v[172:175], v[212:215], a[200:203], v[172:175]
  s_waitcnt vmcnt(10)
  s_barrier
  v_mfma_f32_16x16x32_bf16 v[172:175], v[200:203], a[196:199], v[172:175]
  buffer_load_dwordx4 v137, s[12:15], s36 offen offset:1024 lds
  v_mfma_f32_16x16x32_bf16 v[172:175], v[188:191], a[192:195], v[172:175]
  buffer_load_dwordx4 v138, s[12:15], s36 offen offset:2048 lds
  v_mfma_f32_16x16x32_bf16 v[164:167], v[192:195], a[192:195], 0
  ds_read_b64_tr_b16 a[0:1], v15 offset:0
  ds_read_b64_tr_b16 a[2:3], v15 offset:512
  v_mfma_f32_16x16x32_bf16 v[164:167], v[204:207], a[196:199], v[164:167]
  s_add_u32 m0, s63, 24576
  s_add_u32 s36, s62, 768
  v_mfma_f32_16x16x32_bf16 v[164:167], v[216:219], a[200:203], v[164:167]
  v_cvt_pk_bf16_f32 v66, v172, v173
  v_cvt_pk_bf16_f32 v67, v174, v175
  v_mfma_f32_16x16x32_bf16 v[164:167], v[228:231], a[204:207], v[164:167]
  buffer_load_dwordx4 v136, s[12:15], s36 offen offset:0 lds
  v_mfma_f32_16x16x32_bf16 v[164:167], v[240:243], a[208:211], v[164:167]
  ds_read_b64_tr_b16 a[4:5], v9 offset:0
  ds_read_b64_tr_b16 a[6:7], v9 offset:512
  v_mfma_f32_16x16x32_bf16 v[164:167], v[252:255], a[212:215], v[164:167]
  s_waitcnt lgkmcnt(4)
  ds_read_b64_tr_b16 a[8:9], v11 offset:0
  v_mfma_f32_16x16x32_bf16 v[172:175], v[184:187], a[216:219], 0
  ds_read_b64_tr_b16 a[10:11], v11 offset:512
  ds_read_b64_tr_b16 a[12:13], v15 offset:12288
  v_mfma_f32_16x16x32_bf16 v[172:175], v[196:199], a[220:223], v[172:175]
  buffer_load_dwordx4 v137, s[12:15], s36 offen offset:1024 lds
  v_mfma_f32_16x16x32_bf16 v[172:175], v[208:211], a[224:227], v[172:175]
  v_cvt_pk_bf16_f32 v68, v164, v165
  v_cvt_pk_bf16_f32 v69, v166, v167
  v_mfma_f32_16x16x32_bf16 v[172:175], v[220:223], a[244:247], v[172:175]
  ds_read_b64_tr_b16 a[14:15], v15 offset:12800
  ds_read_b64_tr_b16 a[16:17], v9 offset:12288
  v_mfma_f32_16x16x32_bf16 v[172:175], v[232:235], a[248:251], v[172:175]
  ds_read_b64_tr_b16 a[18:19], v9 offset:12800
  ds_read_b64_tr_b16 a[20:21], v11 offset:12288
  v_mfma_f32_16x16x32_bf16 v[172:175], v[244:247], a[252:255], v[172:175]
  buffer_load_dwordx4 v138, s[12:15], s36 offen offset:2048 lds
  v_mfma_f32_16x16x32_bf16 v[164:167], v[248:251], a[252:255], 0
  ds_read_b64_tr_b16 a[22:23], v11 offset:12800
  v_fma_f32 v110, v110, s45, v150
  v_mfma_f32_16x16x32_bf16 v[164:167], v[236:239], a[248:251], v[164:167]
  v_fma_f32 v111, v111, s45, v150
  v_fma_f32 v112, v112, s45, v150
  v_mfma_f32_16x16x32_bf16 v[164:167], v[224:227], a[244:247], v[164:167]
  v_cvt_pk_bf16_f32 v70, v172, v173
  v_cvt_pk_bf16_f32 v71, v174, v175
  v_mfma_f32_16x16x32_bf16 v[164:167], v[212:215], a[224:227], v[164:167]
  s_add_u32 m0, s63, 36864
  s_add_u32 s36, s62, 37632
  v_mfma_f32_16x16x32_bf16 v[164:167], v[200:203], a[220:223], v[164:167]
  buffer_load_dwordx4 v136, s[12:15], s36 offen offset:0 lds
  v_mfma_f32_16x16x32_bf16 v[164:167], v[188:191], a[216:219], v[164:167]
  v_fma_f32 v113, v113, s45, v150
  v_fma_f32 v114, v114, s45, v150
  v_mfma_f32_16x16x32_bf16 v[172:175], v[192:195], a[216:219], 0
  v_fma_f32 v115, v115, s45, v150
  v_add_f32 v156, v151, v112
  v_mfma_f32_16x16x32_bf16 v[172:175], v[204:207], a[220:223], v[172:175]
  v_add_f32 v157, v151, v113
  v_add_f32 v158, v151, v114
  v_mfma_f32_16x16x32_bf16 v[172:175], v[216:219], a[224:227], v[172:175]
  v_cvt_pk_bf16_f32 v72, v164, v165
  v_cvt_pk_bf16_f32 v73, v166, v167
  v_mfma_f32_16x16x32_bf16 v[172:175], v[228:231], a[244:247], v[172:175]
  buffer_load_dwordx4 v137, s[12:15], s36 offen offset:1024 lds
  v_mfma_f32_16x16x32_bf16 v[172:175], v[240:243], a[248:251], v[172:175]
  s_waitcnt lgkmcnt(0)
  s_waitcnt vmcnt(11)
  s_barrier
  v_mfma_f32_16x16x32_bf16 v[172:175], v[252:255], a[252:255], v[172:175]
  ds_read_b64_tr_b16 a[24:25], v15 offset:24576
  v_mfma_f32_16x16x32_bf16 v[116:119], a[0:3], a[144:147], 0
  buffer_load_dwordx4 v138, s[12:15], s36 offen offset:2048 lds
  v_mfma_f32_16x16x32_bf16 v[116:119], a[12:15], a[148:151], v[116:119]
  ds_read_b64_tr_b16 a[26:27], v15 offset:25088
  ds_read_b64_tr_b16 a[28:29], v9 offset:24576
  v_mfma_f32_16x16x32_bf16 v[124:127], a[16:19], a[148:151], 0
  v_cvt_pk_bf16_f32 v74, v172, v173
  v_cvt_pk_bf16_f32 v75, v174, v175
  v_mfma_f32_16x16x32_bf16 v[124:127], a[4:7], a[144:147], v[124:127]
  s_add_u32 m0, s63, 49152
  s_add_u32 s36, s62, 74496
  v_mfma_f32_16x16x32_bf16 v[120:123], a[8:11], a[144:147], 0
  buffer_load_dwordx4 v136, s[12:15], s36 offen offset:0 lds
  v_mfma_f32_16x16x32_bf16 v[120:123], a[20:23], a[148:151], v[120:123]
  ds_read_b64_tr_b16 a[30:31], v9 offset:25088
  ds_read_b64_tr_b16 a[32:33], v11 offset:24576
  v_mfma_f32_16x16x32_bf16 v[128:131], a[0:3], a[168:171], 0
  ds_read_b64_tr_b16 a[34:35], v11 offset:25088
  ds_read_b64_tr_b16 a[36:37], v15 offset:36864
  v_mfma_f32_16x16x32_bf16 v[128:131], a[12:15], a[172:175], v[128:131]
  ds_read_b64_tr_b16 a[38:39], v15 offset:37376
  ds_read_b64_tr_b16 a[40:41], v9 offset:36864
  v_mfma_f32_16x16x32_bf16 v[132:135], a[16:19], a[172:175], 0
  buffer_load_dwordx4 v137, s[12:15], s36 offen offset:1024 lds
  v_mfma_f32_16x16x32_bf16 v[132:135], a[4:7], a[168:171], v[132:135]
  ds_read_b64_tr_b16 a[42:43], v9 offset:37376
  ds_read_b64_tr_b16 a[44:45], v11 offset:36864
  v_mfma_f32_16x16x32_bf16 v[140:143], a[8:11], a[168:171], 0
  ds_read_b64_tr_b16 a[46:47], v11 offset:37376
  v_add_f32 v159, v151, v115
  v_mfma_f32_16x16x32_bf16 v[140:143], a[20:23], a[172:175], v[140:143]
  v_add_f32 v160, v151, v108
  v_add_f32 v161, v151, v109
  v_mfma_f32_16x16x32_bf16 v[16:19], a[0:3], a[192:195], 0
  v_add_f32 v162, v151, v110
  v_add_f32 v163, v151, v111
  v_mfma_f32_16x16x32_bf16 v[16:19], a[12:15], a[196:199], v[16:19]
  buffer_load_dwordx4 v138, s[12:15], s36 offen offset:2048 lds
  v_mfma_f32_16x16x32_bf16 v[20:23], a[16:19], a[196:199], 0
  v_add_f32 v180, v151, v104
  v_add_f32 v181, v151, v105
  v_mfma_f32_16x16x32_bf16 v[20:23], a[4:7], a[192:195], v[20:23]
  v_add_f32 v182, v151, v106
  v_add_f32 v183, v151, v107
  v_mfma_f32_16x16x32_bf16 v[24:27], a[8:11], a[192:195], 0
  s_add_u32 m0, s63, 61440
  s_add_u32 s36, s62, 111360
  v_mfma_f32_16x16x32_bf16 v[24:27], a[20:23], a[196:199], v[24:27]
  buffer_load_dwordx4 v136, s[12:15], s36 offen offset:0 lds
  v_mfma_f32_16x16x32_bf16 v[28:31], a[0:3], a[216:219], 0
  v_add_f32 v152, v151, v96
  v_add_f32 v153, v151, v97
  v_mfma_f32_16x16x32_bf16 v[28:31], a[12:15], a[220:223], v[28:31]
  v_add_f32 v154, v151, v98
  v_add_f32 v155, v151, v99
  v_mfma_f32_16x16x32_bf16 v[32:35], a[16:19], a[220:223], 0
  v_add_f32 v168, v151, v92
  v_add_f32 v169, v151, v93
  v_mfma_f32_16x16x32_bf16 v[32:35], a[4:7], a[216:219], v[32:35]
  buffer_load_dwordx4 v137, s[12:15], s36 offen offset:1024 lds
  v_mfma_f32_16x16x32_bf16 v[36:39], a[8:11], a[216:219], 0
  v_add_f32 v170, v151, v94
  v_add_f32 v171, v151, v95
  v_mfma_f32_16x16x32_bf16 v[36:39], a[20:23], a[220:223], v[36:39]
  s_waitcnt lgkmcnt(0)
  v_add_f32 v176, v151, v88
  v_mfma_f32_16x16x32_bf16 v[116:119], a[24:27], a[152:155], v[116:119]
  s_waitcnt vmcnt(11)
  s_barrier
  v_mfma_f32_16x16x32_bf16 v[116:119], a[36:39], a[156:159], v[116:119]
  buffer_load_dwordx4 v138, s[12:15], s36 offen offset:2048 lds
  v_mfma_f32_16x16x32_bf16 v[124:127], a[40:43], a[156:159], v[124:127]
  ds_read_b64_tr_b16 a[48:49], v12 offset:0
  ds_read_b64_tr_b16 a[50:51], v12 offset:512
  v_mfma_f32_16x16x32_bf16 v[124:127], a[28:31], a[152:155], v[124:127]
  ds_read_b64_tr_b16 a[52:53], v13 offset:0
  ds_read_b64_tr_b16 a[54:55], v13 offset:512
  v_mfma_f32_16x16x32_bf16 v[120:123], a[32:35], a[152:155], v[120:123]
  s_add_u32 m0, s63, 73728
  s_add_u32 s36, s62, 148224
  v_mfma_f32_16x16x32_bf16 v[120:123], a[44:47], a[156:159], v[120:123]
  buffer_load_dwordx4 v136, s[12:15], s36 offen offset:0 lds
  v_mfma_f32_16x16x32_bf16 v[128:131], a[24:27], a[176:179], v[128:131]
  ds_read_b64_tr_b16 a[56:57], v14 offset:0
  ds_read_b64_tr_b16 a[58:59], v14 offset:512
  v_mfma_f32_16x16x32_bf16 v[128:131], a[36:39], a[180:183], v[128:131]
  ds_read_b64_tr_b16 a[60:61], v12 offset:12288
  ds_read_b64_tr_b16 a[62:63], v12 offset:12800
  v_mfma_f32_16x16x32_bf16 v[132:135], a[40:43], a[180:183], v[132:135]
  ds_read_b64_tr_b16 a[64:65], v13 offset:12288
  ds_read_b64_tr_b16 a[66:67], v13 offset:12800
  v_mfma_f32_16x16x32_bf16 v[132:135], a[28:31], a[176:179], v[132:135]
  ds_read_b64_tr_b16 a[68:69], v14 offset:12288
  ds_read_b64_tr_b16 a[70:71], v14 offset:12800
  v_mfma_f32_16x16x32_bf16 v[140:143], a[32:35], a[176:179], v[140:143]
  buffer_load_dwordx4 v137, s[12:15], s36 offen offset:1024 lds
  v_mfma_f32_16x16x32_bf16 v[140:143], a[44:47], a[180:183], v[140:143]
  v_add_f32 v177, v151, v89
  v_add_f32 v178, v151, v90
  v_mfma_f32_16x16x32_bf16 v[16:19], a[24:27], a[200:203], v[16:19]
  v_add_f32 v179, v151, v91
  v_mfma_f32_16x16x32_bf16 v[16:19], a[36:39], a[204:207], v[16:19]
  v_mfma_f32_16x16x32_bf16 v[20:23], a[40:43], a[204:207], v[20:23]
  buffer_load_dwordx4 v138, s[12:15], s36 offen offset:2048 lds
  v_mfma_f32_16x16x32_bf16 v[20:23], a[28:31], a[200:203], v[20:23]
  v_mfma_f32_16x16x32_bf16 v[24:27], a[32:35], a[200:203], v[24:27]
  v_mfma_f32_16x16x32_bf16 v[24:27], a[44:47], a[204:207], v[24:27]
  s_add_u32 m0, s63, 86016
  s_add_u32 s36, s62, 185088
  v_mfma_f32_16x16x32_bf16 v[28:31], a[24:27], a[224:227], v[28:31]
  buffer_load_dwordx4 v136, s[12:15], s36 offen offset:0 lds
  v_mfma_f32_16x16x32_bf16 v[28:31], a[36:39], a[244:247], v[28:31]
  v_mfma_f32_16x16x32_bf16 v[32:35], a[40:43], a[244:247], v[32:35]
  s_waitcnt lgkmcnt(0)
  s_waitcnt vmcnt(10)
  s_barrier
  v_mfma_f32_16x16x32_bf16 v[32:35], a[28:31], a[224:227], v[32:35]
  ds_read_b64_tr_b16 a[72:73], v12 offset:24576
  ds_read_b64_tr_b16 a[74:75], v12 offset:25088
  v_mfma_f32_16x16x32_bf16 v[36:39], a[32:35], a[224:227], v[36:39]
  buffer_load_dwordx4 v137, s[12:15], s36 offen offset:1024 lds
  v_mfma_f32_16x16x32_bf16 v[36:39], a[44:47], a[244:247], v[36:39]
  ds_read_b64_tr_b16 a[76:77], v13 offset:24576
  v_mfma_f32_16x16x32_bf16 v[116:119], a[48:51], a[160:163], v[116:119]
  ds_read_b64_tr_b16 a[78:79], v13 offset:25088
  ds_read_b64_tr_b16 a[80:81], v14 offset:24576
  v_mfma_f32_16x16x32_bf16 v[116:119], a[60:63], a[164:167], v[116:119]
  ds_read_b64_tr_b16 a[82:83], v14 offset:25088
  ds_read_b64_tr_b16 a[84:85], v12 offset:36864
  v_mfma_f32_16x16x32_bf16 v[124:127], a[64:67], a[164:167], v[124:127]
  buffer_load_dwordx4 v138, s[12:15], s36 offen offset:2048 lds
  v_mfma_f32_16x16x32_bf16 v[124:127], a[52:55], a[160:163], v[124:127]
  ds_read_b64_tr_b16 a[86:87], v12 offset:37376
  ds_read_b64_tr_b16 a[88:89], v13 offset:36864
  v_mfma_f32_16x16x32_bf16 v[120:123], a[56:59], a[160:163], v[120:123]
  v_cvt_pk_bf16_f32 v46, v116, v117
  v_cvt_pk_bf16_f32 v47, v118, v119
  v_mfma_f32_16x16x32_bf16 v[120:123], a[68:71], a[164:167], v[120:123]
  s_add_u32 m0, s32, 40960
  ds_read_b64_tr_b16 a[90:91], v13 offset:37376
  v_mfma_f32_16x16x32_bf16 v[128:131], a[48:51], a[184:187], v[128:131]
  v_cvt_pk_bf16_f32 v48, v124, v125
  v_cvt_pk_bf16_f32 v49, v126, v127
  v_mfma_f32_16x16x32_bf16 v[128:131], a[60:63], a[188:191], v[128:131]
  buffer_load_dwordx4 v6, s[8:11], s48 offen offset:0 nt lds
  v_mfma_f32_16x16x32_bf16 v[132:135], a[64:67], a[188:191], v[132:135]
  v_cvt_pk_bf16_f32 v50, v120, v121
  v_cvt_pk_bf16_f32 v51, v122, v123
  v_mfma_f32_16x16x32_bf16 v[132:135], a[52:55], a[184:187], v[132:135]
  s_add_u32 m0, s32, 49024
  ds_read_b64_tr_b16 a[92:93], v14 offset:36864
  v_mfma_f32_16x16x32_bf16 v[140:143], a[56:59], a[184:187], v[140:143]
  v_cvt_pk_bf16_f32 v58, v128, v129
  v_cvt_pk_bf16_f32 v59, v130, v131
  v_mfma_f32_16x16x32_bf16 v[140:143], a[68:71], a[188:191], v[140:143]
  buffer_load_dwordx4 v6, s[8:11], s48 offen offset:128 nt lds
  v_mfma_f32_16x16x32_bf16 v[16:19], a[48:51], a[208:211], v[16:19]
  v_cvt_pk_bf16_f32 v60, v132, v133
  v_cvt_pk_bf16_f32 v61, v134, v135
  v_mfma_f32_16x16x32_bf16 v[16:19], a[60:63], a[212:215], v[16:19]
  s_add_u32 m0, s32, 57088
  ds_read_b64_tr_b16 a[94:95], v14 offset:37376
  v_mfma_f32_16x16x32_bf16 v[20:23], a[64:67], a[212:215], v[20:23]
  v_cvt_pk_bf16_f32 v62, v140, v141
  v_cvt_pk_bf16_f32 v63, v142, v143
L_hop1:
  s_cbranch_execz L_hopped
  v_mfma_f32_16x16x32_bf16 v[20:23], a[52:55], a[208:211], v[20:23]
  buffer_load_dwordx4 v6, s[8:11], s48 offen offset:256 nt lds
  v_mfma_f32_16x16x32_bf16 v[24:27], a[56:59], a[208:211], v[24:27]
  v_cvt_pk_bf16_f32 v76, v16, v17
  v_cvt_pk_bf16_f32 v77, v18, v19
  v_mfma_f32_16x16x32_bf16 v[24:27], a[68:71], a[212:215], v[24:27]
  s_add_u32 m0, s32, 45056
  v_mfma_f32_16x16x32_bf16 v[28:31], a[48:51], a[248:251], v[28:31]
  v_cvt_pk_bf16_f32 v78, v20, v21
  v_cvt_pk_bf16_f32 v79, v22, v23
  v_mfma_f32_16x16x32_bf16 v[28:31], a[60:63], a[252:255], v[28:31]
  s_waitcnt lgkmcnt(0)
  s_waitcnt vmcnt(9)
  s_barrier
  v_mfma_f32_16x16x32_bf16 v[32:35], a[64:67], a[252:255], v[32:35]
  v_cvt_pk_bf16_f32 v80, v24, v25
  v_cvt_pk_bf16_f32 v81, v26, v27
  v_mfma_f32_16x16x32_bf16 v[32:35], a[52:55], a[248:251], v[32:35]
  buffer_load_dwordx4 v6, s[8:11], s49 offen offset:0 nt lds
  v_mfma_f32_16x16x32_bf16 v[36:39], a[56:59], a[248:251], v[36:39]
  v_cvt_pk_bf16_f32 v82, v28, v29
  v_cvt_pk_bf16_f32 v83, v30, v31
  v_mfma_f32_16x16x32_bf16 v[36:39], a[68:71], a[252:255], v[36:39]
  s_add_u32 m0, s32, 53120
  ds_read_b64_tr_b16 a[96:97], v12 offset:49152
  v_mfma_f32_16x16x32_bf16 v[116:119], v[46:49], v[70:73], v[156:159]
  v_cvt_pk_bf16_f32 v84, v32, v33
  v_cvt_pk_bf16_f32 v85, v34, v35
  v_mfma_f32_16x16x32_bf16 v[124:127], v[58:61], v[70:73], v[160:163]
  buffer_load_dwordx4 v6, s[8:11], s49 offen offset:128 nt lds
  v_mfma_f32_16x16x32_bf16 v[120:123], v[76:79], v[70:73], v[104:107]
  v_cvt_pk_bf16_f32 v86, v36, v37
  v_cvt_pk_bf16_f32 v87, v38, v39
  v_mfma_f32_16x16x32_bf16 v[128:131], v[82:85], v[70:73], v[100:103]
  s_add_u32 m0, s32, 61184
  ds_read_b64_tr_b16 a[98:99], v12 offset:49664
  v_mfma_f32_16x16x16_bf16 v[116:119], v[50:51], v[74:75], v[116:119]
  s_cmp_lg_u32 s31, 0
  s_cbranch_scc1 L_special0
  v_mfma_f32_16x16x16_bf16 v[124:127], v[62:63], v[74:75], v[124:127]
  buffer_load_dwordx4 v6, s[8:11], s49 offen offset:256 nt lds
  v_mfma_f32_16x16x16_bf16 v[120:123], v[80:81], v[74:75], v[120:123]
  s_add_u32 s48, s48, 6291456
  s_add_u32 s49, s48, 786432
  v_mfma_f32_16x16x16_bf16 v[128:131], v[86:87], v[74:75], v[128:131]
  s_add_u32 m0, s32, 65536
  ds_read_b64_tr_b16 a[100:101], v13 offset:49152
  v_mfma_f32_16x16x32_bf16 v[132:135], v[46:49], v[64:67], v[160:163]
  buffer_load_dwordx4 v6, s[8:11], s48 offen offset:0 nt lds
  v_mfma_f32_16x16x32_bf16 v[140:143], v[58:61], v[64:67], v[180:183]
  ds_read_b64_tr_b16 a[102:103], v13 offset:49664
  ds_read_b64_tr_b16 a[104:105], v14 offset:49152
  v_mfma_f32_16x16x32_bf16 v[136:139], v[76:79], v[64:67], v[100:103]
  ds_read_b64_tr_b16 a[106:107], v14 offset:49664
  ds_read_b64_tr_b16 a[108:109], v12 offset:61440
  v_mfma_f32_16x16x32_bf16 v[144:147], v[82:85], v[64:67], v[96:99]
  s_add_u32 m0, s32, 73600
  ds_read_b64_tr_b16 a[110:111], v12 offset:61952
  v_mfma_f32_16x16x16_bf16 v[132:135], v[50:51], v[68:69], v[132:135]
  buffer_load_dwordx4 v6, s[8:11], s48 offen offset:128 nt lds
  v_mfma_f32_16x16x16_bf16 v[140:143], v[62:63], v[68:69], v[140:143]
  ds_read_b64_tr_b16 a[112:113], v13 offset:61440
  ds_read_b64_tr_b16 a[114:115], v13 offset:61952
  v_mfma_f32_16x16x16_bf16 v[136:139], v[80:81], v[68:69], v[136:139]
  ds_read_b64_tr_b16 a[116:117], v14 offset:61440
  ds_read_b64_tr_b16 a[118:119], v14 offset:61952
  v_mfma_f32_16x16x16_bf16 v[144:147], v[86:87], v[68:69], v[144:147]
  s_add_u32 m0, s32, 81664
  v_mfma_f32_16x16x32_bf16 v[148:151], v[46:49], v[52:55], v[104:107]
  buffer_load_dwordx4 v6, s[8:11], s48 offen offset:256 nt lds
  v_mfma_f32_16x16x32_bf16 v[156:159], v[58:61], v[52:55], v[100:103]
  v_exp_f32 v116, v116
  v_mfma_f32_16x16x32_bf16 v[152:155], v[76:79], v[52:55], v[152:155]
  v_exp_f32 v117, v117
  v_mfma_f32_16x16x32_bf16 v[160:163], v[82:85], v[52:55], v[168:171]
  v_exp_f32 v118, v118
  v_mfma_f32_16x16x16_bf16 v[148:151], v[50:51], v[56:57], v[148:151]
  s_waitcnt lgkmcnt(0)
  s_waitcnt vmcnt(9)
  s_barrier
  v_mfma_f32_16x16x16_bf16 v[156:159], v[62:63], v[56:57], v[156:159]
  ds_read_b64_tr_b16 a[120:121], v15 offset:0
  ds_read_b64_tr_b16 a[122:123], v15 offset:512
  v_mfma_f32_16x16x16_bf16 v[152:155], v[80:81], v[56:57], v[152:155]
  ds_read_b64_tr_b16 a[124:125], v9 offset:0
  ds_read_b64_tr_b16 a[126:127], v9 offset:512
  v_mfma_f32_16x16x16_bf16 v[160:163], v[86:87], v[56:57], v[160:163]
  ds_read_b64_tr_b16 a[128:129], v11 offset:0
  ds_read_b64_tr_b16 a[130:131], v11 offset:512
  v_mfma_f32_16x16x32_bf16 v[164:167], v[46:49], v[40:43], v[100:103]
  ds_read_b64_tr_b16 a[132:133], v15 offset:12288
  ds_read_b64_tr_b16 a[134:135], v15 offset:12800
  v_mfma_f32_16x16x32_bf16 v[172:175], v[58:61], v[40:43], v[96:99]
  ds_read_b64_tr_b16 a[136:137], v9 offset:12288
  ds_read_b64_tr_b16 a[138:139], v9 offset:12800
  v_mfma_f32_16x16x32_bf16 v[168:171], v[76:79], v[40:43], v[168:171]
  ds_read_b64_tr_b16 a[140:141], v11 offset:12288
  ds_read_b64_tr_b16 a[142:143], v11 offset:12800
  v_mfma_f32_16x16x32_bf16 v[176:179], v[82:85], v[40:43], v[176:179]
  v_exp_f32 v119, v119
  v_mfma_f32_16x16x16_bf16 v[164:167], v[50:51], v[44:45], v[164:167]
  v_perm_b32 v116, v117, v116, s61
  v_perm_b32 v117, v119, v118, s61
  v_mfma_f32_16x16x16_bf16 v[172:175], v[62:63], v[44:45], v[172:175]
  v_exp_f32 v124, v124
  v_mfma_f32_16x16x16_bf16 v[168:171], v[80:81], v[44:45], v[168:171]
  v_exp_f32 v125, v125
  v_mfma_f32_16x16x16_bf16 v[176:179], v[86:87], v[44:45], v[176:179]
  v_exp_f32 v126, v126
L_enter:
  v_mfma_f32_16x16x32_bf16 v[40:43], a[144:147], a[72:75], 0
  v_exp_f32 v127, v127
  v_mfma_f32_16x16x32_bf16 v[40:43], a[148:151], a[84:87], v[40:43]
  v_perm_b32 v118, v125, v124, s61
  v_perm_b32 v119, v127, v126, s61
  v_mfma_f32_16x16x32_bf16 v[40:43], a[152:155], a[96:99], v[40:43]
  v_exp_f32 v120, v120
  v_mfma_f32_16x16x32_bf16 v[40:43], a[156:159], a[108:111], v[40:43]
  s_waitcnt lgkmcnt(0)
  v_mfma_f32_16x16x32_bf16 v[40:43], a[160:163], a[120:123], v[40:43]
  v_exp_f32 v121, v121
  v_mfma_f32_16x16x32_bf16 v[40:43], a[164:167], a[132:135], v[40:43]
  v_exp_f32 v122, v122
  v_mfma_f32_16x16x32_bf16 v[44:47], a[164:167], a[136:139], 0
  v_exp_f32 v123, v123
  v_mfma_f32_16x16x32_bf16 v[44:47], a[160:163], a[124:127], v[44:47]
  v_perm_b32 v120, v121, v120, s61
  v_perm_b32 v121, v123, v122, s61
  v_mfma_f32_16x16x32_bf16 v[44:47], a[156:159], a[112:115], v[44:47]
  v_cvt_pk_bf16_f32 v16, v40, v41
  v_cvt_pk_bf16_f32 v17, v42, v43
  v_mfma_f32_16x16x32_bf16 v[44:47], a[152:155], a[100:103], v[44:47]
  v_exp_f32 v128, v128
  v_mfma_f32_16x16x32_bf16 v[44:47], a[148:151], a[88:91], v[44:47]
  v_exp_f32 v129, v129
  v_mfma_f32_16x16x32_bf16 v[44:47], a[144:147], a[76:79], v[44:47]
  v_exp_f32 v130, v130
  v_mfma_f32_16x16x32_bf16 v[40:43], a[144:147], a[80:83], 0
  v_exp_f32 v131, v131
  v_mfma_f32_16x16x32_bf16 v[40:43], a[148:151], a[92:95], v[40:43]
  v_perm_b32 v122, v129, v128, s61
  v_perm_b32 v123, v131, v130, s61
  v_mfma_f32_16x16x32_bf16 v[40:43], a[152:155], a[104:107], v[40:43]
  v_cvt_pk_bf16_f32 v24, v44, v45
  v_cvt_pk_bf16_f32 v25, v46, v47
  v_mfma_f32_16x16x32_bf16 v[40:43], a[156:159], a[116:119], v[40:43]
  v_exp_f32 v132, v132
  v_mfma_f32_16x16x32_bf16 v[40:43], a[160:163], a[128:131], v[40:43]
  v_exp_f32 v133, v133
  v_mfma_f32_16x16x32_bf16 v[40:43], a[164:167], a[140:143], v[40:43]
  v_exp_f32 v134, v134
  v_mfma_f32_16x16x32_bf16 v[44:47], a[168:171], a[72:75], 0
  v_perm_b32 v132, v133, v132, s61
  v_mfma_f32_16x16x32_bf16 v[44:47], a[172:175], a[84:87], v[44:47]
  v_exp_f32 v135, v135
  v_mfma_f32_16x16x32_bf16 v[44:47], a[176:179], a[96:99], v[44:47]
  v_cvt_pk_bf16_f32 v32, v40, v41
  v_cvt_pk_bf16_f32 v33, v42, v43
  v_mfma_f32_16x16x32_bf16 v[44:47], a[180:183], a[108:111], v[44:47]
  v_exp_f32 v140, v140
  v_mfma_f32_16x16x32_bf16 v[44:47], a[184:187], a[120:123], v[44:47]
  v_exp_f32 v141, v141
  v_mfma_f32_16x16x32_bf16 v[44:47], a[188:191], a[132:135], v[44:47]
  v_perm_b32 v133, v135, v134, s61
  v_perm_b32 v134, v141, v140, s61
  v_mfma_f32_16x16x32_bf16 v[40:43], a[188:191], a[136:139], 0
  v_exp_f32 v142, v142
  v_mfma_f32_16x16x32_bf16 v[40:43], a[184:187], a[124:127], v[40:43]
  v_exp_f32 v143, v143
  v_mfma_f32_16x16x32_bf16 v[40:43], a[180:183], a[112:115], v[40:43]
  v_cvt_pk_bf16_f32 v18, v44, v45
  v_cvt_pk_bf16_f32 v19, v46, v47
  v_mfma_f32_16x16x32_bf16 v[40:43], a[176:179], a[100:103], v[40:43]
  v_perm_b32 v135, v143, v142, s61
  v_mfma_f32_16x16x32_bf16 v[40:43], a[172:175], a[88:91], v[40:43]
  v_exp_f32 v136, v136
  v_mfma_f32_16x16x32_bf16 v[40:43], a[168:171], a[76:79], v[40:43]
  v_exp_f32 v137, v137
  v_mfma_f32_16x16x32_bf16 v[44:47], a[168:171], a[80:83], 0
  v_exp_f32 v138, v138
  v_mfma_f32_16x16x32_bf16 v[44:47], a[172:175], a[92:95], v[44:47]
  v_exp_f32 v139, v139
  v_mfma_f32_16x16x32_bf16 v[44:47], a[176:179], a[104:107], v[44:47]
  v_cvt_pk_bf16_f32 v26, v40, v41
  v_cvt_pk_bf16_f32 v27, v42, v43
  v_mfma_f32_16x16x32_bf16 v[44:47], a[180:183], a[116:119], v[44:47]
  v_perm_b32 v136, v137, v136, s61
  v_perm_b32 v137, v139, v138, s61
  v_mfma_f32_16x16x32_bf16 v[44:47], a[184:187], a[128:131], v[44:47]
  v_exp_f32 v144, v144
  v_mfma_f32_16x16x32_bf16 v[44:47], a[188:191], a[140:143], v[44:47]
  v_exp_f32 v145, v145
  v_mfma_f32_16x16x32_bf16 v[40:43], a[192:195], a[72:75], 0
  v_exp_f32 v146, v146
  v_mfma_f32_16x16x32_bf16 v[40:43], a[196:199], a[84:87], v[40:43]
  v_exp_f32 v147, v147
  v_mfma_f32_16x16x32_bf16 v[40:43], a[200:203], a[96:99], v[40:43]
  v_cvt_pk_bf16_f32 v34, v44, v45
  v_cvt_pk_bf16_f32 v35, v46, v47
  v_mfma_f32_16x16x32_bf16 v[40:43], a[204:207], a[108:111], v[40:43]
  v_perm_b32 v138, v145, v144, s61
  v_perm_b32 v139, v147, v146, s61
  v_mfma_f32_16x16x32_bf16 v[40:43], a[208:211], a[120:123], v[40:43]
  v_exp_f32 v148, v148
  v_mfma_f32_16x16x32_bf16 v[40:43], a[212:215], a[132:135], v[40:43]
  v_exp_f32 v149, v149
  v_mfma_f32_16x16x32_bf16 v[44:47], a[212:215], a[136:139], 0
  v_mov_b64 v[144:145], 0
  v_perm_b32 v148, v149, v148, s61
  v_mfma_f32_16x16x32_bf16 v[44:47], a[208:211], a[124:127], v[44:47]
  v_exp_f32 v150, v150
  v_mfma_f32_16x16x32_bf16 v[44:47], a[204:207], a[112:115], v[44:47]
  v_cvt_pk_bf16_f32 v20, v40, v41
  v_cvt_pk_bf16_f32 v21, v42, v43
  v_mfma_f32_16x16x32_bf16 v[44:47], a[200:203], a[100:103], v[44:47]
  v_exp_f32 v151, v151
  v_mfma_f32_16x16x32_bf16 v[44:47], a[196:199], a[88:91], v[44:47]
  v_exp_f32 v156, v156
  v_mfma_f32_16x16x32_bf16 v[44:47], a[192:195], a[76:79], v[44:47]
  v_exp_f32 v157, v157
  v_mfma_f32_16x16x32_bf16 v[40:43], a[192:195], a[80:83], 0
  v_perm_b32 v149, v151, v150, s61
  v_perm_b32 v150, v157, v156, s61
  v_mfma_f32_16x16x32_bf16 v[40:43], a[196:199], a[92:95], v[40:43]
  v_exp_f32 v158, v158
  v_mfma_f32_16x16x32_bf16 v[40:43], a[200:203], a[104:107], v[40:43]
  v_cvt_pk_bf16_f32 v28, v44, v45
  v_cvt_pk_bf16_f32 v29, v46, v47
  v_mfma_f32_16x16x32_bf16 v[40:43], a[204:207], a[116:119], v[40:43]
  v_exp_f32 v159, v159
  v_mfma_f32_16x16x32_bf16 v[40:43], a[208:211], a[128:131], v[40:43]
  v_perm_b32 v151, v159, v158, s61
  v_mfma_f32_16x16x32_bf16 v[40:43], a[212:215], a[140:143], v[40:43]
  v_exp_f32 v152, v152
  v_mfma_f32_16x16x32_bf16 v[44:47], a[216:219], a[72:75], 0
  v_exp_f32 v153, v153
  v_mfma_f32_16x16x32_bf16 v[44:47], a[220:223], a[84:87], v[44:47]
  v_exp_f32 v154, v154
  v_mfma_f32_16x16x32_bf16 v[44:47], a[224:227], a[96:99], v[44:47]
  v_cvt_pk_bf16_f32 v36, v40, v41
  v_cvt_pk_bf16_f32 v37, v42, v43
  v_mfma_f32_16x16x32_bf16 v[44:47], a[244:247], a[108:111], v[44:47]
  v_exp_f32 v155, v155
  v_mfma_f32_16x16x32_bf16 v[44:47], a[248:251], a[120:123], v[44:47]
  v_perm_b32 v152, v153, v152, s61
  v_perm_b32 v153, v155, v154, s61
  v_mfma_f32_16x16x32_bf16 v[44:47], a[252:255], a[132:135], v[44:47]
  v_exp_f32 v160, v160
  v_mfma_f32_16x16x32_bf16 v[40:43], a[252:255], a[136:139], 0
  v_exp_f32 v161, v161
  v_mfma_f32_16x16x32_bf16 v[40:43], a[248:251], a[124:127], v[40:43]
  v_exp_f32 v162, v162
  v_mfma_f32_16x16x32_bf16 v[40:43], a[244:247], a[112:115], v[40:43]
  v_cvt_pk_bf16_f32 v22, v44, v45
  v_cvt_pk_bf16_f32 v23, v46, v47
  v_mfma_f32_16x16x32_bf16 v[40:43], a[224:227], a[100:103], v[40:43]
  v_exp_f32 v163, v163
  v_mfma_f32_16x16x32_bf16 v[40:43], a[220:223], a[88:91], v[40:43]
  v_perm_b32 v154, v161, v160, s61
  v_perm_b32 v155, v163, v162, s61
  v_mfma_f32_16x16x32_bf16 v[40:43], a[216:219], a[76:79], v[40:43]
  v_exp_f32 v164, v164
  v_mfma_f32_16x16x32_bf16 v[44:47], a[216:219], a[80:83], 0
  v_exp_f32 v165, v165
  v_mfma_f32_16x16x32_bf16 v[44:47], a[220:223], a[92:95], v[44:47]
  v_exp_f32 v166, v166
  v_mfma_f32_16x16x32_bf16 v[44:47], a[224:227], a[104:107], v[44:47]
  v_cvt_pk_bf16_f32 v30, v40, v41
  v_cvt_pk_bf16_f32 v31, v42, v43
  v_mfma_f32_16x16x32_bf16 v[44:47], a[244:247], a[116:119], v[44:47]
  v_exp_f32 v167, v167
  v_mfma_f32_16x16x32_bf16 v[44:47], a[248:251], a[128:131], v[44:47]
  v_perm_b32 v164, v165, v164, s61
  v_perm_b32 v165, v167, v166, s61
  v_mfma_f32_16x16x32_bf16 v[44:47], a[252:255], a[140:143], v[44:47]
  v_exp_f32 v172, v172
  s_add_u32 s32, s32, 40960
  v_mad_i32_i16 v0, v10, 1, s32 op_sel:[1,0,0,0]
  v_xor_b32 v1, 64, v0
  v_exp_f32 v173, v173
  s_nop 0
  v_perm_b32 v166, v173, v172, s61
  v_smfmac_f32_16x16x64_bf16 v[144:147], a[240:243], v[116:123], v10
  v_exp_f32 v174, v174
  v_mfma_f32_16x16x32_bf16 v[124:127], v[20:23], v[120:123], 0
  v_exp_f32 v175, v175
  v_mfma_f32_16x16x32_bf16 v[124:127], v[16:19], v[116:119], v[124:127]
  v_cvt_pk_bf16_f32 v38, v44, v45
  v_cvt_pk_bf16_f32 v39, v46, v47
  v_mfma_f32_16x16x32_bf16 v[128:131], v[24:27], v[116:119], 0
  v_add_f32 v15, v144, v145
  v_mov_b64 v[144:145], 0
  v_mfma_f32_16x16x32_bf16 v[128:131], v[28:31], v[120:123], v[128:131]
  v_exp_f32 v168, v168
  v_mfma_f32_16x16x32_bf16 v[140:143], v[36:39], v[120:123], 0
  v_exp_f32 v169, v169
  v_mfma_f32_16x16x32_bf16 v[140:143], v[32:35], v[116:119], v[140:143]
  v_perm_b32 v167, v175, v174, s61
  v_perm_b32 v168, v169, v168, s61
  v_smfmac_f32_16x16x64_bf16 v[144:147], a[240:243], v[132:139], v10
  v_exp_f32 v170, v170
  v_mfma_f32_16x16x32_bf16 v[116:119], v[20:23], v[136:139], 0
  v_exp_f32 v171, v171
  v_mfma_f32_16x16x32_bf16 v[116:119], v[16:19], v[132:135], v[116:119]
  v_exp_f32 v176, v176
  v_mfma_f32_16x16x32_bf16 v[120:123], v[24:27], v[132:135], 0
  v_add_f32 v14, v144, v145
  v_mov_b64 v[144:145], 0
  v_mfma_f32_16x16x32_bf16 v[120:123], v[28:31], v[136:139], v[120:123]
  v_exp_f32 v177, v177
  v_mfma_f32_16x16x32_bf16 v[156:159], v[36:39], v[136:139], 0
  v_perm_b32 v169, v171, v170, s61
  v_perm_b32 v170, v177, v176, s61
  v_mfma_f32_16x16x32_bf16 v[156:159], v[32:35], v[132:135], v[156:159]
  v_exp_f32 v178, v178
  v_smfmac_f32_16x16x64_bf16 v[144:147], a[240:243], v[148:155], v10
  v_exp_f32 v179, v179
  v_mfma_f32_16x16x32_bf16 v[132:135], v[20:23], v[152:155], 0
  v_perm_b32 v171, v179, v178, s61
  s_add_u32 m0, s32, 28672
  v_mfma_f32_16x16x32_bf16 v[132:135], v[16:19], v[148:151], v[132:135]
  s_waitcnt vmcnt(6)
  s_barrier
  v_mfma_f32_16x16x32_bf16 v[136:139], v[24:27], v[148:151], 0
  v_add_f32 v13, v144, v145
  v_mov_b64 v[144:145], 0
  v_mfma_f32_16x16x32_bf16 v[136:139], v[28:31], v[152:155], v[136:139]
  ds_read_b128 a[244:247], v0 offset:0
  ds_read_b128 a[248:251], v1 offset:0
  v_mfma_f32_16x16x32_bf16 v[160:163], v[36:39], v[152:155], 0
  buffer_load_dwordx4 v6, s[8:11], s49 offen offset:0 nt lds
  v_mfma_f32_16x16x32_bf16 v[160:163], v[32:35], v[148:151], v[160:163]
  ds_read_b128 a[252:255], v0 offset:8192
  ds_read_b128 v[180:183], v1 offset:8192
  v_smfmac_f32_16x16x64_bf16 v[144:147], a[240:243], v[164:171], v10
  s_add_u32 m0, s32, 36736
  v_mfma_f32_16x16x32_bf16 v[148:151], v[20:23], v[168:171], 0
  ds_read_b128 v[64:67], v0 offset:16384
  ds_read_b128 v[68:71], v1 offset:16384
  v_mfma_f32_16x16x32_bf16 v[148:151], v[16:19], v[164:167], v[148:151]
  buffer_load_dwordx4 v6, s[8:11], s49 offen offset:128 nt lds
  v_mfma_f32_16x16x32_bf16 v[152:155], v[24:27], v[164:167], 0
  v_add_f32 v12, v144, v145
  s_add_u32 m0, s32, 44800
  v_mfma_f32_16x16x32_bf16 v[152:155], v[28:31], v[168:171], v[152:155]
  buffer_load_dwordx4 v6, s[8:11], s49 offen offset:256 nt lds
  v_mfma_f32_16x16x32_bf16 v[172:175], v[36:39], v[168:171], 0
  v_rcp_f32 v15, v15
  v_mfma_f32_16x16x32_bf16 v[172:175], v[32:35], v[164:167], v[172:175]
  s_waitcnt lgkmcnt(4)
  v_mfma_f32_16x16x32_bf16 v[76:79], v[184:187], a[244:247], 0
  v_rcp_f32 v14, v14
  v_mfma_f32_16x16x32_bf16 v[76:79], v[196:199], a[248:251], v[76:79]
  s_waitcnt lgkmcnt(2)
  v_mul_f32 v124, v15, v124
  v_mfma_f32_16x16x32_bf16 v[76:79], v[208:211], a[252:255], v[76:79]
  v_mul_f32 v125, v15, v125
  v_mul_f32 v126, v15, v126
  v_mfma_f32_16x16x32_bf16 v[76:79], v[220:223], v[180:183], v[76:79]
  s_waitcnt lgkmcnt(0)
  v_mul_f32 v127, v15, v127
  v_mfma_f32_16x16x32_bf16 v[76:79], v[232:235], v[64:67], v[76:79]
  v_cvt_pk_bf16_f32 v124, v124, v125
  v_cvt_pk_bf16_f32 v125, v126, v127
  v_mfma_f32_16x16x32_bf16 v[76:79], v[244:247], v[68:71], v[76:79]
  v_mul_f32 v128, v15, v128
  v_mul_f32 v129, v15, v129
  v_mfma_f32_16x16x32_bf16 v[80:83], v[248:251], v[68:71], 0
  v_mul_f32 v130, v15, v130
  v_mul_f32 v131, v15, v131
  v_mfma_f32_16x16x32_bf16 v[80:83], v[236:239], v[64:67], v[80:83]
  v_cvt_pk_bf16_f32 v126, v128, v129
  v_cvt_pk_bf16_f32 v127, v130, v131
  v_mfma_f32_16x16x32_bf16 v[80:83], v[224:227], v[180:183], v[80:83]
  v_cvt_pk_bf16_f32 v40, v76, v77
  v_cvt_pk_bf16_f32 v41, v78, v79
  v_mfma_f32_16x16x32_bf16 v[80:83], v[212:215], a[252:255], v[80:83]
  ds_write_b128 v4, v[124:127] offset:768
  v_mfma_f32_16x16x32_bf16 v[80:83], v[200:203], a[248:251], v[80:83]
  v_mul_f32 v140, v15, v140
  v_mul_f32 v141, v15, v141
  v_mfma_f32_16x16x32_bf16 v[80:83], v[188:191], a[244:247], v[80:83]
  v_mul_f32 v142, v15, v142
  v_mul_f32 v143, v15, v143
  v_mfma_f32_16x16x32_bf16 v[76:79], v[192:195], a[244:247], 0
  v_cvt_pk_bf16_f32 v140, v140, v141
  v_cvt_pk_bf16_f32 v141, v142, v143
  v_mfma_f32_16x16x32_bf16 v[76:79], v[204:207], a[248:251], v[76:79]
  ds_write_b64 v5, v[140:141] offset:768
  v_mfma_f32_16x16x32_bf16 v[76:79], v[216:219], a[252:255], v[76:79]
  v_cvt_pk_bf16_f32 v42, v80, v81
  v_cvt_pk_bf16_f32 v43, v82, v83
  v_mfma_f32_16x16x32_bf16 v[76:79], v[228:231], v[180:183], v[76:79]
  v_rcp_f32 v13, v13
  v_mfma_f32_16x16x32_bf16 v[76:79], v[240:243], v[64:67], v[76:79]
  v_mul_f32 v116, v14, v116
  v_mul_f32 v117, v14, v117
  v_mfma_f32_16x16x32_bf16 v[76:79], v[252:255], v[68:71], v[76:79]
  v_mul_f32 v118, v14, v118
  v_mul_f32 v119, v14, v119
  v_mfma_f32_16x16x32_bf16 v[80:83], a[60:63], v[68:71], 0
  v_cvt_pk_bf16_f32 v116, v116, v117
  v_cvt_pk_bf16_f32 v117, v118, v119
  v_mfma_f32_16x16x32_bf16 v[80:83], a[48:51], v[64:67], v[80:83]
  v_mul_f32 v120, v14, v120
  v_mul_f32 v121, v14, v121
  v_mfma_f32_16x16x32_bf16 v[80:83], a[36:39], v[180:183], v[80:83]
  v_cvt_pk_bf16_f32 v44, v76, v77
  v_cvt_pk_bf16_f32 v45, v78, v79
  v_mfma_f32_16x16x32_bf16 v[80:83], a[24:27], a[252:255], v[80:83]
  v_mul_f32 v122, v14, v122
  v_mul_f32 v123, v14, v123
  v_mfma_f32_16x16x32_bf16 v[80:83], a[12:15], a[248:251], v[80:83]
  v_cvt_pk_bf16_f32 v118, v120, v121
  v_cvt_pk_bf16_f32 v119, v122, v123
  v_mfma_f32_16x16x32_bf16 v[80:83], a[0:3], a[244:247], v[80:83]
  ds_write_b128 v4, v[116:119] offset:512
  v_mfma_f32_16x16x32_bf16 v[76:79], a[4:7], a[244:247], 0
  v_mul_f32 v156, v14, v156
  v_mul_f32 v157, v14, v157
  v_mfma_f32_16x16x32_bf16 v[76:79], a[16:19], a[248:251], v[76:79]
  v_mul_f32 v158, v14, v158
  v_mul_f32 v159, v14, v159
  v_mfma_f32_16x16x32_bf16 v[76:79], a[28:31], a[252:255], v[76:79]
  v_cvt_pk_bf16_f32 v46, v80, v81
  v_cvt_pk_bf16_f32 v47, v82, v83
  v_mfma_f32_16x16x32_bf16 v[76:79], a[40:43], v[180:183], v[76:79]
  v_cvt_pk_bf16_f32 v156, v156, v157
  v_cvt_pk_bf16_f32 v157, v158, v159
  v_mfma_f32_16x16x32_bf16 v[76:79], a[52:55], v[64:67], v[76:79]
  ds_write_b64 v5, v[156:157] offset:512
  v_mfma_f32_16x16x32_bf16 v[76:79], a[64:67], v[68:71], v[76:79]
  v_rcp_f32 v12, v12
  v_mfma_f32_16x16x32_bf16 v[80:83], a[68:71], v[68:71], 0
  v_mul_f32 v132, v13, v132
  v_mul_f32 v133, v13, v133
  v_mfma_f32_16x16x32_bf16 v[80:83], a[56:59], v[64:67], v[80:83]
  v_mul_f32 v134, v13, v134
  v_mul_f32 v135, v13, v135
  v_mfma_f32_16x16x32_bf16 v[80:83], a[44:47], v[180:183], v[80:83]
  v_cvt_pk_bf16_f32 v48, v76, v77
  v_cvt_pk_bf16_f32 v49, v78, v79
  v_mfma_f32_16x16x32_bf16 v[80:83], a[32:35], a[252:255], v[80:83]
  v_cvt_pk_bf16_f32 v132, v132, v133
  v_cvt_pk_bf16_f32 v133, v134, v135
  v_mfma_f32_16x16x32_bf16 v[80:83], a[20:23], a[248:251], v[80:83]
  v_mul_f32 v136, v13, v136
  v_mul_f32 v137, v13, v137
  v_mfma_f32_16x16x32_bf16 v[80:83], a[8:11], a[244:247], v[80:83]
  v_mul_f32 v138, v13, v138
  v_mul_f32 v139, v13, v139
  v_mfma_f32_16x16x32_bf16 v[76:79], a[244:247], a[72:75], 0
  v_cvt_pk_bf16_f32 v134, v136, v137
  v_cvt_pk_bf16_f32 v135, v138, v139
  v_mfma_f32_16x16x32_bf16 v[76:79], a[248:251], a[84:87], v[76:79]
  ds_write_b128 v4, v[132:135] offset:256
  v_mfma_f32_16x16x32_bf16 v[76:79], a[252:255], a[96:99], v[76:79]
  v_cvt_pk_bf16_f32 v50, v80, v81
  v_cvt_pk_bf16_f32 v51, v82, v83
  v_mfma_f32_16x16x32_bf16 v[76:79], v[180:183], a[108:111], v[76:79]
  ds_read_b128 v[72:75], v0 offset:2048
  v_mul_f32 v160, v13, v160
  v_mfma_f32_16x16x32_bf16 v[76:79], v[64:67], a[120:123], v[76:79]
  ds_read_b128 v[84:87], v1 offset:2048
  v_mul_f32 v161, v13, v161
  v_mfma_f32_16x16x32_bf16 v[76:79], v[68:71], a[132:135], v[76:79]
  ds_read_b128 v[164:167], v0 offset:10240
  v_mul_f32 v162, v13, v162
  v_mfma_f32_16x16x32_bf16 v[80:83], v[68:71], a[136:139], 0
  ds_read_b128 v[168:171], v1 offset:10240
  v_mul_f32 v163, v13, v163
  v_mfma_f32_16x16x32_bf16 v[80:83], v[64:67], a[124:127], v[80:83]
  ds_read_b128 v[176:179], v0 offset:18432
  v_cvt_pk_bf16_f32 v160, v160, v161
  v_mfma_f32_16x16x32_bf16 v[80:83], v[180:183], a[112:115], v[80:83]
  v_cvt_pk_bf16_f32 v16, v76, v77
  v_cvt_pk_bf16_f32 v17, v78, v79
  v_mfma_f32_16x16x32_bf16 v[80:83], a[252:255], a[100:103], v[80:83]
  ds_read_b128 v[144:147], v1 offset:18432
  v_cvt_pk_bf16_f32 v161, v162, v163
  v_mfma_f32_16x16x32_bf16 v[80:83], a[248:251], a[88:91], v[80:83]
  ds_write_b64 v5, v[160:161] offset:256
  v_mfma_f32_16x16x32_bf16 v[80:83], a[244:247], a[76:79], v[80:83]
  v_mul_f32 v148, v12, v148
  v_mul_f32 v149, v12, v149
  v_mfma_f32_16x16x32_bf16 v[76:79], a[244:247], a[80:83], 0
  v_mul_f32 v150, v12, v150
  v_mul_f32 v151, v12, v151
  v_mfma_f32_16x16x32_bf16 v[76:79], a[248:251], a[92:95], v[76:79]
  v_cvt_pk_bf16_f32 v148, v148, v149
  v_cvt_pk_bf16_f32 v149, v150, v151
  v_mfma_f32_16x16x32_bf16 v[76:79], a[252:255], a[104:107], v[76:79]
  v_cvt_pk_bf16_f32 v24, v80, v81
  v_cvt_pk_bf16_f32 v25, v82, v83
  v_mfma_f32_16x16x32_bf16 v[76:79], v[180:183], a[116:119], v[76:79]
  v_mul_f32 v152, v12, v152
  v_mul_f32 v153, v12, v153
  v_mfma_f32_16x16x32_bf16 v[76:79], v[64:67], a[128:131], v[76:79]
  v_mul_f32 v154, v12, v154
  v_mul_f32 v155, v12, v155
  v_mfma_f32_16x16x32_bf16 v[76:79], v[68:71], a[140:143], v[76:79]
  s_waitcnt lgkmcnt(1)
  v_cvt_pk_bf16_f32 v150, v152, v153
  v_mfma_f32_16x16x32_bf16 v[80:83], v[184:187], v[72:75], 0
  v_cvt_pk_bf16_f32 v151, v154, v155
  v_mfma_f32_16x16x32_bf16 v[80:83], v[196:199], v[84:87], v[80:83]
  ds_write_b128 v4, v[148:151] offset:0
  v_mfma_f32_16x16x32_bf16 v[80:83], v[208:211], v[164:167], v[80:83]
  v_cvt_pk_bf16_f32 v32, v76, v77
  v_cvt_pk_bf16_f32 v33, v78, v79
  v_mfma_f32_16x16x32_bf16 v[80:83], v[220:223], v[168:171], v[80:83]
  v_mul_f32 v172, v12, v172
  v_mul_f32 v173, v12, v173
  v_mfma_f32_16x16x32_bf16 v[80:83], v[232:235], v[176:179], v[80:83]
  v_mul_f32 v174, v12, v174
  v_mul_f32 v175, v12, v175
  v_mfma_f32_16x16x32_bf16 v[80:83], v[244:247], v[144:147], v[80:83]
  v_cvt_pk_bf16_f32 v172, v172, v173
  v_cvt_pk_bf16_f32 v173, v174, v175
  v_mfma_f32_16x16x32_bf16 v[76:79], v[248:251], v[144:147], 0
  ds_write_b64 v5, v[172:173] offset:0
  v_mfma_f32_16x16x32_bf16 v[76:79], v[236:239], v[176:179], v[76:79]
  v_subrev_u32 v3, s7, v3
  v_subrev_u32 v2, s7, v2
  v_mfma_f32_16x16x32_bf16 v[76:79], v[224:227], v[168:171], v[76:79]
  v_cvt_pk_bf16_f32 v52, v80, v81
  v_cvt_pk_bf16_f32 v53, v82, v83
  v_mfma_f32_16x16x32_bf16 v[76:79], v[212:215], v[164:167], v[76:79]
  v_add_u32 v4, s7, v4
  v_add_u32 v5, s7, v5
  v_mfma_f32_16x16x32_bf16 v[76:79], v[200:203], v[84:87], v[76:79]
  s_sub_u32 s7, 0, s7
  v_max_f32 v9, v12, v13
  v_mfma_f32_16x16x32_bf16 v[76:79], v[188:191], v[72:75], v[76:79]
  v_max3_f32 v9, v14, v15, v9
  v_min_f32 v11, v12, v13
  v_mfma_f32_16x16x32_bf16 v[80:83], v[192:195], v[72:75], 0
  v_min3_f32 v11, v14, v15, v11
  v_accvgpr_read_b32 v180, a228
  v_mfma_f32_16x16x32_bf16 v[80:83], v[204:207], v[84:87], v[80:83]
  s_add_u32 m0, s58, 114688
  s_add_u32 s36, s58, 0
  v_mfma_f32_16x16x32_bf16 v[80:83], v[216:219], v[164:167], v[80:83]
  v_cvt_pk_bf16_f32 v54, v76, v77
  v_cvt_pk_bf16_f32 v55, v78, v79
  v_mfma_f32_16x16x32_bf16 v[80:83], v[228:231], v[168:171], v[80:83]
  buffer_load_dwordx4 v180, s[16:19], s36 offen offset:0 lds
  v_mfma_f32_16x16x32_bf16 v[80:83], v[240:243], v[176:179], v[80:83]
  buffer_load_dwordx4 v180, s[16:19], s36 offen offset:1024 lds
  v_mfma_f32_16x16x32_bf16 v[80:83], v[252:255], v[144:147], v[80:83]
  buffer_load_dwordx4 v180, s[16:19], s36 offen offset:2048 lds
  v_mfma_f32_16x16x32_bf16 v[76:79], a[60:63], v[144:147], 0
  s_add_u32 m0, s58, 126976
  s_add_u32 s36, s58, 18432
  v_mfma_f32_16x16x32_bf16 v[76:79], a[48:51], v[176:179], v[76:79]
  buffer_load_dwordx4 v180, s[16:19], s36 offen offset:0 lds
  v_mfma_f32_16x16x32_bf16 v[76:79], a[36:39], v[168:171], v[76:79]
  v_cvt_pk_bf16_f32 v56, v80, v81
  v_cvt_pk_bf16_f32 v57, v82, v83
  v_mfma_f32_16x16x32_bf16 v[76:79], a[24:27], v[164:167], v[76:79]
  buffer_load_dwordx4 v180, s[16:19], s36 offen offset:1024 lds
  v_mfma_f32_16x16x32_bf16 v[76:79], a[12:15], v[84:87], v[76:79]
  v_mfma_f32_16x16x32_bf16 v[76:79], a[0:3], v[72:75], v[76:79]
  v_mfma_f32_16x16x32_bf16 v[80:83], a[4:7], v[72:75], 0
  buffer_load_dwordx4 v180, s[16:19], s36 offen offset:2048 lds
  v_mfma_f32_16x16x32_bf16 v[80:83], a[16:19], v[84:87], v[80:83]
  v_mfma_f32_16x16x32_bf16 v[80:83], a[28:31], v[164:167], v[80:83]
  v_cvt_pk_bf16_f32 v58, v76, v77
  v_cvt_pk_bf16_f32 v59, v78, v79
  v_mfma_f32_16x16x32_bf16 v[80:83], a[40:43], v[168:171], v[80:83]
  s_add_u32 m0, s58, 139264
  s_add_u32 s36, s58, 36864
  v_mfma_f32_16x16x32_bf16 v[80:83], a[52:55], v[176:179], v[80:83]
  buffer_load_dwordx4 v180, s[16:19], s36 offen offset:0 lds
  v_mfma_f32_16x16x32_bf16 v[80:83], a[64:67], v[144:147], v[80:83]
  v_mfma_f32_16x16x32_bf16 v[76:79], a[68:71], v[144:147], 0
  v_mfma_f32_16x16x32_bf16 v[76:79], a[56:59], v[176:179], v[76:79]
  buffer_load_dwordx4 v180, s[16:19], s36 offen offset:1024 lds
  v_mfma_f32_16x16x32_bf16 v[76:79], a[44:47], v[168:171], v[76:79]
  v_cvt_pk_bf16_f32 v60, v80, v81
  v_cvt_pk_bf16_f32 v61, v82, v83
  v_mfma_f32_16x16x32_bf16 v[76:79], a[32:35], v[164:167], v[76:79]
  v_mfma_f32_16x16x32_bf16 v[76:79], a[20:23], v[84:87], v[76:79]
  v_mfma_f32_16x16x32_bf16 v[76:79], a[8:11], v[72:75], v[76:79]
  buffer_load_dwordx4 v180, s[16:19], s36 offen offset:2048 lds
  v_mfma_f32_16x16x32_bf16 v[80:83], v[72:75], a[72:75], 0
  s_waitcnt vmcnt(15)
  s_barrier
  v_mfma_f32_16x16x32_bf16 v[80:83], v[84:87], a[84:87], v[80:83]
L_hop2:
  s_cbranch_execz L_hopped
  v_mfma_f32_16x16x32_bf16 v[80:83], v[164:167], a[96:99], v[80:83]
  v_cvt_pk_bf16_f32 v62, v76, v77
  v_cvt_pk_bf16_f32 v63, v78, v79
  v_mfma_f32_16x16x32_bf16 v[80:83], v[168:171], a[108:111], v[80:83]
  ds_read_b128 v[116:119], v0 offset:4096
  v_mfma_f32_16x16x32_bf16 v[80:83], v[176:179], a[120:123], v[80:83]
  ds_read_b128 v[124:127], v1 offset:4096
  v_mfma_f32_16x16x32_bf16 v[80:83], v[144:147], a[132:135], v[80:83]
  ds_read_b128 v[120:123], v0 offset:12288
  v_mfma_f32_16x16x32_bf16 v[76:79], v[144:147], a[136:139], 0
  ds_read_b128 v[128:131], v1 offset:12288
  v_mfma_f32_16x16x32_bf16 v[76:79], v[176:179], a[124:127], v[76:79]
  ds_read_b128 v[132:135], v0 offset:20480
  v_mfma_f32_16x16x32_bf16 v[76:79], v[168:171], a[112:115], v[76:79]
  v_cvt_pk_bf16_f32 v18, v80, v81
  v_cvt_pk_bf16_f32 v19, v82, v83
  v_mfma_f32_16x16x32_bf16 v[76:79], v[164:167], a[100:103], v[76:79]
  ds_read_b128 v[140:143], v1 offset:20480
  v_mfma_f32_16x16x32_bf16 v[76:79], v[84:87], a[88:91], v[76:79]
  s_add_u32 m0, s58, 151552
  s_add_u32 s36, s58, 55296
  v_mfma_f32_16x16x32_bf16 v[76:79], v[72:75], a[76:79], v[76:79]
  buffer_load_dwordx4 v180, s[16:19], s36 offen offset:0 lds
  v_mfma_f32_16x16x32_bf16 v[80:83], v[72:75], a[80:83], 0
  buffer_load_dwordx4 v180, s[16:19], s36 offen offset:1024 lds
  v_mfma_f32_16x16x32_bf16 v[80:83], v[84:87], a[92:95], v[80:83]
  buffer_load_dwordx4 v180, s[16:19], s36 offen offset:2048 lds
  v_mfma_f32_16x16x32_bf16 v[80:83], v[164:167], a[104:107], v[80:83]
  v_cvt_pk_bf16_f32 v26, v76, v77
  v_cvt_pk_bf16_f32 v27, v78, v79
  v_mfma_f32_16x16x32_bf16 v[80:83], v[168:171], a[116:119], v[80:83]
  s_add_u32 m0, s58, 0
  s_add_u32 s36, s59, 12288
  v_mfma_f32_16x16x32_bf16 v[80:83], v[176:179], a[128:131], v[80:83]
  buffer_load_dwordx4 v180, s[16:19], s36 offen offset:0 lds
  v_mfma_f32_16x16x32_bf16 v[80:83], v[144:147], a[140:143], v[80:83]
  s_waitcnt lgkmcnt(0)
  v_mfma_f32_16x16x32_bf16 v[148:151], v[184:187], v[116:119], 0
  buffer_load_dwordx4 v180, s[16:19], s36 offen offset:1024 lds
  v_mfma_f32_16x16x32_bf16 v[148:151], v[196:199], v[124:127], v[148:151]
  v_mfma_f32_16x16x32_bf16 v[148:151], v[208:211], v[120:123], v[148:151]
  v_cvt_pk_bf16_f32 v34, v80, v81
  v_cvt_pk_bf16_f32 v35, v82, v83
  v_mfma_f32_16x16x32_bf16 v[148:151], v[220:223], v[128:131], v[148:151]
  buffer_load_dwordx4 v180, s[16:19], s36 offen offset:2048 lds
  v_mfma_f32_16x16x32_bf16 v[148:151], v[232:235], v[132:135], v[148:151]
  v_mfma_f32_16x16x32_bf16 v[148:151], v[244:247], v[140:143], v[148:151]
  v_mfma_f32_16x16x32_bf16 v[156:159], v[248:251], v[140:143], 0
  ds_read_b128 v[136:139], v0 offset:6144
  v_mfma_f32_16x16x32_bf16 v[156:159], v[236:239], v[132:135], v[156:159]
  ds_read_b128 v[144:147], v1 offset:6144
  v_mfma_f32_16x16x32_bf16 v[156:159], v[224:227], v[128:131], v[156:159]
  v_cvt_pk_bf16_f32 v64, v148, v149
  v_cvt_pk_bf16_f32 v65, v150, v151
  v_mfma_f32_16x16x32_bf16 v[156:159], v[212:215], v[120:123], v[156:159]
  ds_read_b128 v[152:155], v0 offset:14336
  v_mfma_f32_16x16x32_bf16 v[156:159], v[200:203], v[124:127], v[156:159]
  ds_read_b128 v[160:163], v1 offset:14336
  v_mfma_f32_16x16x32_bf16 v[156:159], v[188:191], v[116:119], v[156:159]
  ds_read_b128 v[164:167], v0 offset:22528
  v_mfma_f32_16x16x32_bf16 v[148:151], v[192:195], v[116:119], 0
  ds_read_b128 v[172:175], v1 offset:22528
  v_mfma_f32_16x16x32_bf16 v[148:151], v[204:207], v[124:127], v[148:151]
  s_add_u32 m0, s58, 12288
  s_add_u32 s36, s59, 49152
  v_mfma_f32_16x16x32_bf16 v[148:151], v[216:219], v[120:123], v[148:151]
  v_cvt_pk_bf16_f32 v66, v156, v157
  v_cvt_pk_bf16_f32 v67, v158, v159
  v_mfma_f32_16x16x32_bf16 v[148:151], v[228:231], v[128:131], v[148:151]
  buffer_load_dwordx4 v180, s[16:19], s36 offen offset:0 lds
  v_mfma_f32_16x16x32_bf16 v[148:151], v[240:243], v[132:135], v[148:151]
  buffer_load_dwordx4 v180, s[16:19], s36 offen offset:1024 lds
  v_mfma_f32_16x16x32_bf16 v[148:151], v[252:255], v[140:143], v[148:151]
  buffer_load_dwordx4 v180, s[16:19], s36 offen offset:2048 lds
  v_mfma_f32_16x16x32_bf16 v[156:159], a[60:63], v[140:143], 0
  v_accvgpr_read_b32 v180, a229
  v_accvgpr_read_b32 v181, a230
  v_mfma_f32_16x16x32_bf16 v[156:159], a[48:51], v[132:135], v[156:159]
  v_accvgpr_read_b32 v182, a231
  v_accvgpr_read_b32 v183, a232
  v_mfma_f32_16x16x32_bf16 v[156:159], a[36:39], v[128:131], v[156:159]
  v_cvt_pk_bf16_f32 v68, v148, v149
  v_cvt_pk_bf16_f32 v69, v150, v151
  v_mfma_f32_16x16x32_bf16 v[156:159], a[24:27], v[120:123], v[156:159]
  s_add_u32 s48, s48, 6291456
  s_add_u32 s49, s48, 786432
  v_mfma_f32_16x16x32_bf16 v[156:159], a[12:15], v[124:127], v[156:159]
  s_sub_u32 s33, s32, 40960
  s_add_u32 s32, s33, 65536
  v_mfma_f32_16x16x32_bf16 v[156:159], a[0:3], v[116:119], v[156:159]
  s_mov_b32 s35, 2
  s_mov_b64 vcc, 0
  v_mfma_f32_16x16x32_bf16 v[148:151], a[4:7], v[116:119], 0
  v_mad_i32_i16 v0, v10, 1, s32 op_sel:[1,0,0,0]
  v_xor_b32 v1, 64, v0
  v_mfma_f32_16x16x32_bf16 v[148:151], a[16:19], v[124:127], v[148:151]
  v_mfma_f32_16x16x32_bf16 v[148:151], a[28:31], v[120:123], v[148:151]
  v_cvt_pk_bf16_f32 v76, v156, v157
  v_cvt_pk_bf16_f32 v77, v158, v159
  v_mfma_f32_16x16x32_bf16 v[148:151], a[40:43], v[128:131], v[148:151]
  v_mfma_f32_16x16x32_bf16 v[148:151], a[52:55], v[132:135], v[148:151]
  v_mfma_f32_16x16x32_bf16 v[148:151], a[64:67], v[140:143], v[148:151]
  v_mfma_f32_16x16x32_bf16 v[156:159], a[68:71], v[140:143], 0
  v_mfma_f32_16x16x32_bf16 v[156:159], a[56:59], v[132:135], v[156:159]
  v_mfma_f32_16x16x32_bf16 v[156:159], a[44:47], v[128:131], v[156:159]
  v_cvt_pk_bf16_f32 v78, v148, v149
  v_cvt_pk_bf16_f32 v79, v150, v151
  v_mfma_f32_16x16x32_bf16 v[156:159], a[32:35], v[120:123], v[156:159]
  v_mfma_f32_16x16x32_bf16 v[156:159], a[20:23], v[124:127], v[156:159]
  v_mfma_f32_16x16x32_bf16 v[156:159], a[8:11], v[116:119], v[156:159]
  v_mfma_f32_16x16x32_bf16 v[148:151], v[116:119], a[72:75], 0
  v_mfma_f32_16x16x32_bf16 v[148:151], v[124:127], a[84:87], v[148:151]
  v_mfma_f32_16x16x32_bf16 v[148:151], v[120:123], a[96:99], v[148:151]
  v_cvt_pk_bf16_f32 v80, v156, v157
  v_cvt_pk_bf16_f32 v81, v158, v159
  v_mfma_f32_16x16x32_bf16 v[148:151], v[128:131], a[108:111], v[148:151]
  v_mfma_f32_16x16x32_bf16 v[148:151], v[132:135], a[120:123], v[148:151]
  v_mfma_f32_16x16x32_bf16 v[148:151], v[140:143], a[132:135], v[148:151]
  v_mfma_f32_16x16x32_bf16 v[156:159], v[140:143], a[136:139], 0
  v_mfma_f32_16x16x32_bf16 v[156:159], v[132:135], a[124:127], v[156:159]
  v_mfma_f32_16x16x32_bf16 v[156:159], v[128:131], a[112:115], v[156:159]
  v_cvt_pk_bf16_f32 v20, v148, v149
  v_cvt_pk_bf16_f32 v21, v150, v151
  v_mfma_f32_16x16x32_bf16 v[156:159], v[120:123], a[100:103], v[156:159]
  v_mfma_f32_16x16x32_bf16 v[156:159], v[124:127], a[88:91], v[156:159]
  s_waitcnt lgkmcnt(0)
  s_waitcnt vmcnt(0)
  s_barrier
  v_mfma_f32_16x16x32_bf16 v[156:159], v[116:119], a[76:79], v[156:159]
  ds_read_b64_tr_b16 a[144:145], v180 offset:0
  ds_read_b64_tr_b16 a[146:147], v180 offset:6144
  v_mfma_f32_16x16x32_bf16 v[148:151], v[116:119], a[80:83], 0
  s_add_u32 m0, s33, 40960
  ds_read_b64_tr_b16 a[148:149], v180 offset:8
  v_mfma_f32_16x16x32_bf16 v[148:151], v[124:127], a[92:95], v[148:151]
  buffer_load_dwordx4 v6, s[8:11], s48 offen offset:0 nt lds
  v_mfma_f32_16x16x32_bf16 v[148:151], v[120:123], a[104:107], v[148:151]
  v_cvt_pk_bf16_f32 v28, v156, v157
  v_cvt_pk_bf16_f32 v29, v158, v159
  v_mfma_f32_16x16x32_bf16 v[148:151], v[128:131], a[116:119], v[148:151]
  ds_read_b64_tr_b16 a[150:151], v180 offset:6152
  v_mfma_f32_16x16x32_bf16 v[148:151], v[132:135], a[128:131], v[148:151]
  ds_read_b64_tr_b16 a[152:153], v181 offset:0
  ds_read_b64_tr_b16 a[154:155], v181 offset:6144
  v_mfma_f32_16x16x32_bf16 v[148:151], v[140:143], a[140:143], v[148:151]
  ds_read_b64_tr_b16 a[156:157], v181 offset:8
  v_mfma_f32_16x16x32_bf16 v[168:171], v[184:187], v[136:139], 0
  ds_read_b64_tr_b16 a[158:159], v181 offset:6152
  v_mfma_f32_16x16x32_bf16 v[168:171], v[196:199], v[144:147], v[168:171]
  ds_read_b64_tr_b16 a[160:161], v180 offset:12288
  ds_read_b64_tr_b16 a[162:163], v180 offset:18432
  v_mfma_f32_16x16x32_bf16 v[168:171], v[208:211], v[152:155], v[168:171]
  v_cvt_pk_bf16_f32 v36, v148, v149
  v_cvt_pk_bf16_f32 v37, v150, v151
  v_mfma_f32_16x16x32_bf16 v[168:171], v[220:223], v[160:163], v[168:171]
  ds_read_b64_tr_b16 a[164:165], v180 offset:12296
  v_mfma_f32_16x16x32_bf16 v[168:171], v[232:235], v[164:167], v[168:171]
  ds_read_b64_tr_b16 a[166:167], v180 offset:18440
  ds_read_b64_tr_b16 a[168:169], v181 offset:12288
  v_mfma_f32_16x16x32_bf16 v[168:171], v[244:247], v[172:175], v[168:171]
  s_add_u32 m0, s33, 49024
  ds_read_b64_tr_b16 a[170:171], v181 offset:18432
  v_mfma_f32_16x16x32_bf16 v[176:179], v[248:251], v[172:175], 0
  buffer_load_dwordx4 v6, s[8:11], s48 offen offset:128 nt lds
  v_mfma_f32_16x16x32_bf16 v[176:179], v[236:239], v[164:167], v[176:179]
  ds_read_b64_tr_b16 a[172:173], v181 offset:12296
  v_mfma_f32_16x16x32_bf16 v[176:179], v[224:227], v[160:163], v[176:179]
  v_cvt_pk_bf16_f32 v70, v168, v169
  v_cvt_pk_bf16_f32 v71, v170, v171
  v_mfma_f32_16x16x32_bf16 v[176:179], v[212:215], v[152:155], v[176:179]
  ds_read_b64_tr_b16 a[174:175], v181 offset:18440
  ds_read_b64_tr_b16 a[176:177], v180 offset:24576
  v_mfma_f32_16x16x32_bf16 v[176:179], v[200:203], v[144:147], v[176:179]
  ds_read_b64_tr_b16 a[178:179], v180 offset:30720
  v_mfma_f32_16x16x32_bf16 v[176:179], v[188:191], v[136:139], v[176:179]
  ds_read_b64_tr_b16 a[180:181], v180 offset:24584
  ds_read_b64_tr_b16 a[182:183], v180 offset:30728
  v_mfma_f32_16x16x32_bf16 v[168:171], v[192:195], v[136:139], 0
  ds_read_b64_tr_b16 a[184:185], v181 offset:24576
  v_mfma_f32_16x16x32_bf16 v[168:171], v[204:207], v[144:147], v[168:171]
  ds_read_b64_tr_b16 a[186:187], v181 offset:30720
  ds_read_b64_tr_b16 a[188:189], v181 offset:24584
  v_mfma_f32_16x16x32_bf16 v[168:171], v[216:219], v[152:155], v[168:171]
  v_cvt_pk_bf16_f32 v72, v176, v177
  v_cvt_pk_bf16_f32 v73, v178, v179
  v_mfma_f32_16x16x32_bf16 v[168:171], v[228:231], v[160:163], v[168:171]
  ds_read_b64_tr_b16 a[190:191], v181 offset:30728
  v_mfma_f32_16x16x32_bf16 v[168:171], v[240:243], v[164:167], v[168:171]
  s_add_u32 m0, s33, 57088
  ds_read_b64_tr_b16 a[192:193], v180 offset:36864
  v_mfma_f32_16x16x32_bf16 v[168:171], v[252:255], v[172:175], v[168:171]
  buffer_load_dwordx4 v6, s[8:11], s48 offen offset:256 nt lds
  v_mfma_f32_16x16x32_bf16 v[176:179], a[60:63], v[172:175], 0
  ds_read_b64_tr_b16 a[194:195], v180 offset:43008
  ds_read_b64_tr_b16 a[196:197], v180 offset:36872
  v_mfma_f32_16x16x32_bf16 v[176:179], a[48:51], v[164:167], v[176:179]
  ds_read_b64_tr_b16 a[198:199], v180 offset:43016
  v_mfma_f32_16x16x32_bf16 v[176:179], a[36:39], v[160:163], v[176:179]
  v_cvt_pk_bf16_f32 v74, v168, v169
  v_cvt_pk_bf16_f32 v75, v170, v171
  v_mfma_f32_16x16x32_bf16 v[176:179], a[24:27], v[152:155], v[176:179]
  ds_read_b64_tr_b16 a[200:201], v181 offset:36864
  ds_read_b64_tr_b16 a[202:203], v181 offset:43008
  v_mfma_f32_16x16x32_bf16 v[176:179], a[12:15], v[144:147], v[176:179]
  ds_read_b64_tr_b16 a[204:205], v181 offset:36872
  v_mfma_f32_16x16x32_bf16 v[176:179], a[0:3], v[136:139], v[176:179]
  ds_read_b64_tr_b16 a[206:207], v181 offset:43016
  ds_read_b64_tr_b16 a[208:209], v182 offset:0
  v_mfma_f32_16x16x32_bf16 v[168:171], a[4:7], v[136:139], 0
  ds_read_b64_tr_b16 a[210:211], v182 offset:1536
  v_mfma_f32_16x16x32_bf16 v[168:171], a[16:19], v[144:147], v[168:171]
  ds_read_b64_tr_b16 a[212:213], v182 offset:8
  ds_read_b64_tr_b16 a[214:215], v182 offset:1544
  v_mfma_f32_16x16x32_bf16 v[168:171], a[28:31], v[152:155], v[168:171]
  v_cvt_pk_bf16_f32 v82, v176, v177
  v_cvt_pk_bf16_f32 v83, v178, v179
  v_mfma_f32_16x16x32_bf16 v[168:171], a[40:43], v[160:163], v[168:171]
  s_add_u32 m0, s33, 45056
  ds_read_b64_tr_b16 a[216:217], v183 offset:0
  v_mfma_f32_16x16x32_bf16 v[168:171], a[52:55], v[164:167], v[168:171]
  buffer_load_dwordx4 v6, s[8:11], s49 offen offset:0 nt lds
  v_mfma_f32_16x16x32_bf16 v[168:171], a[64:67], v[172:175], v[168:171]
  ds_read_b64_tr_b16 a[218:219], v183 offset:1536
  v_mfma_f32_16x16x32_bf16 v[176:179], a[68:71], v[172:175], 0
  ds_read_b64_tr_b16 a[220:221], v183 offset:8
  ds_read_b64_tr_b16 a[222:223], v183 offset:1544
  v_mfma_f32_16x16x32_bf16 v[176:179], a[56:59], v[164:167], v[176:179]
  ds_read_b64_tr_b16 a[224:225], v182 offset:12288
  v_mfma_f32_16x16x32_bf16 v[176:179], a[44:47], v[160:163], v[176:179]
  v_cvt_pk_bf16_f32 v84, v168, v169
  v_cvt_pk_bf16_f32 v85, v170, v171
  v_mfma_f32_16x16x32_bf16 v[176:179], a[32:35], v[152:155], v[176:179]
  ds_read_b64_tr_b16 a[226:227], v182 offset:13824
  ds_read_b64_tr_b16 a[228:229], v182 offset:12296
  v_mfma_f32_16x16x32_bf16 v[176:179], a[20:23], v[144:147], v[176:179]
  ds_read_b64_tr_b16 a[230:231], v182 offset:13832
  v_mfma_f32_16x16x32_bf16 v[176:179], a[8:11], v[136:139], v[176:179]
  ds_read_b64_tr_b16 a[232:233], v183 offset:12288
  ds_read_b64_tr_b16 a[234:235], v183 offset:13824
  v_mfma_f32_16x16x32_bf16 v[168:171], v[136:139], a[72:75], 0
  ds_read_b64_tr_b16 a[236:237], v183 offset:12296
  v_mfma_f32_16x16x32_bf16 v[168:171], v[144:147], a[84:87], v[168:171]
  s_add_u32 m0, s33, 53120
  ds_read_b64_tr_b16 a[238:239], v183 offset:13832
  v_mfma_f32_16x16x32_bf16 v[168:171], v[152:155], a[96:99], v[168:171]
  v_cvt_pk_bf16_f32 v86, v176, v177
  v_cvt_pk_bf16_f32 v87, v178, v179
  v_mfma_f32_16x16x32_bf16 v[168:171], v[160:163], a[108:111], v[168:171]
  buffer_load_dwordx4 v6, s[8:11], s49 offen offset:128 nt lds
  v_mfma_f32_16x16x32_bf16 v[168:171], v[164:167], a[120:123], v[168:171]
  v_mfma_f32_16x16x32_bf16 v[168:171], v[172:175], a[132:135], v[168:171]
  v_mfma_f32_16x16x32_bf16 v[176:179], v[172:175], a[136:139], 0
  s_waitcnt lgkmcnt(0)
  s_waitcnt vmcnt(23)
  s_barrier
  v_mfma_f32_16x16x32_bf16 v[176:179], v[164:167], a[124:127], v[176:179]
  v_mfma_f32_16x16x32_bf16 v[176:179], v[160:163], a[112:115], v[176:179]
  v_cvt_pk_bf16_f32 v22, v168, v169
  v_cvt_pk_bf16_f32 v23, v170, v171
  v_mfma_f32_16x16x32_bf16 v[176:179], v[152:155], a[100:103], v[176:179]
  ds_read_b128 a[244:247], v3 offset:0
  v_mfma_f32_16x16x32_bf16 v[176:179], v[144:147], a[88:91], v[176:179]
  ds_read_b128 a[248:251], v3 offset:4096
  v_mfma_f32_16x16x32_bf16 v[176:179], v[136:139], a[76:79], v[176:179]
  ds_read_b128 a[252:255], v3 offset:8192
  v_mfma_f32_16x16x32_bf16 v[168:171], v[136:139], a[80:83], 0
  ds_read_b128 v[180:183], v3 offset:12288
  v_mfma_f32_16x16x32_bf16 v[168:171], v[144:147], a[92:95], v[168:171]
  s_add_u32 m0, s33, 61184
  v_mfma_f32_16x16x32_bf16 v[168:171], v[152:155], a[104:107], v[168:171]
  v_cvt_pk_bf16_f32 v30, v176, v177
  v_cvt_pk_bf16_f32 v31, v178, v179
  v_mfma_f32_16x16x32_bf16 v[168:171], v[160:163], a[116:119], v[168:171]
  buffer_load_dwordx4 v6, s[8:11], s49 offen offset:256 nt lds
  v_mfma_f32_16x16x32_bf16 v[168:171], v[164:167], a[128:131], v[168:171]
  s_add_u32 s48, s48, 6291456
  s_add_u32 s49, s48, 786432
  v_mfma_f32_16x16x32_bf16 v[168:171], v[172:175], a[140:143], v[168:171]
  s_branch L_s
.p2align 6
L_s:
  v_mfma_f32_16x16x32_bf16 v[116:119], v[46:49], v[70:73], v[112:115]
  v_mfma_f32_16x16x32_bf16 v[124:127], v[58:61], v[70:73], v[108:111]
  s_cmp_lg_u32 s31, 0
  v_mfma_f32_16x16x32_bf16 v[120:123], v[76:79], v[70:73], v[104:107]
  v_cvt_pk_bf16_f32 v38, v168, v169
  v_cvt_pk_bf16_f32 v39, v170, v171
  v_mfma_f32_16x16x32_bf16 v[128:131], v[82:85], v[70:73], v[100:103]
  v_mfma_f32_16x16x16_bf16 v[116:119], v[50:51], v[74:75], v[116:119]
  s_cbranch_scc1 L_special
  v_mfma_f32_16x16x16_bf16 v[124:127], v[62:63], v[74:75], v[124:127]
  v_mfma_f32_16x16x16_bf16 v[120:123], v[80:81], v[74:75], v[120:123]
  v_mfma_f32_16x16x16_bf16 v[128:131], v[86:87], v[74:75], v[128:131]
  v_exp_f32 v116, v116
  v_mfma_f32_16x16x32_bf16 v[132:135], v[46:49], v[64:67], v[108:111]
  v_exp_f32 v117, v117
  v_mfma_f32_16x16x32_bf16 v[140:143], v[58:61], v[64:67], v[104:107]
  v_exp_f32 v118, v118
  v_mfma_f32_16x16x32_bf16 v[136:139], v[76:79], v[64:67], v[100:103]
  v_exp_f32 v119, v119
  v_mfma_f32_16x16x32_bf16 v[144:147], v[82:85], v[64:67], v[96:99]
  v_perm_b32 v116, v117, v116, s61
  v_perm_b32 v117, v119, v118, s61
  v_mfma_f32_16x16x16_bf16 v[132:135], v[50:51], v[68:69], v[132:135]
  v_exp_f32 v124, v124
  v_mfma_f32_16x16x16_bf16 v[140:143], v[62:63], v[68:69], v[140:143]
  v_exp_f32 v125, v125
  v_mfma_f32_16x16x16_bf16 v[136:139], v[80:81], v[68:69], v[136:139]
  v_exp_f32 v126, v126
  v_mfma_f32_16x16x16_bf16 v[144:147], v[86:87], v[68:69], v[144:147]
  ds_read_b128 v[64:67], v3 offset:16384
  ds_read_b128 v[68:71], v3 offset:20480
  v_mfma_f32_16x16x32_bf16 v[148:151], v[46:49], v[52:55], v[104:107]
  v_exp_f32 v127, v127
  v_mfma_f32_16x16x32_bf16 v[156:159], v[58:61], v[52:55], v[100:103]
  v_perm_b32 v118, v125, v124, s61
  v_perm_b32 v119, v127, v126, s61
  v_mfma_f32_16x16x32_bf16 v[152:155], v[76:79], v[52:55], v[96:99]
  v_exp_f32 v120, v120
  v_mfma_f32_16x16x32_bf16 v[160:163], v[82:85], v[52:55], v[92:95]
  v_exp_f32 v121, v121
  v_mfma_f32_16x16x16_bf16 v[148:151], v[50:51], v[56:57], v[148:151]
  v_exp_f32 v122, v122
  v_mfma_f32_16x16x16_bf16 v[156:159], v[62:63], v[56:57], v[156:159]
  v_exp_f32 v123, v123
  v_mfma_f32_16x16x16_bf16 v[152:155], v[80:81], v[56:57], v[152:155]
  v_perm_b32 v120, v121, v120, s61
  v_perm_b32 v121, v123, v122, s61
  v_mfma_f32_16x16x16_bf16 v[160:163], v[86:87], v[56:57], v[160:163]
  v_exp_f32 v128, v128
  v_mfma_f32_16x16x32_bf16 v[164:167], v[46:49], v[40:43], v[100:103]
  v_exp_f32 v129, v129
  v_mfma_f32_16x16x32_bf16 v[172:175], v[58:61], v[40:43], v[96:99]
  v_exp_f32 v130, v130
  v_mfma_f32_16x16x32_bf16 v[168:171], v[76:79], v[40:43], v[92:95]
  v_exp_f32 v131, v131
  v_mfma_f32_16x16x32_bf16 v[176:179], v[82:85], v[40:43], v[88:91]
  v_perm_b32 v122, v129, v128, s61
  v_perm_b32 v123, v131, v130, s61
  v_mfma_f32_16x16x16_bf16 v[164:167], v[50:51], v[44:45], v[164:167]
  v_exp_f32 v132, v132
  v_mfma_f32_16x16x16_bf16 v[172:175], v[62:63], v[44:45], v[172:175]
  v_exp_f32 v133, v133
  v_mfma_f32_16x16x16_bf16 v[168:171], v[80:81], v[44:45], v[168:171]
  v_exp_f32 v134, v134
  v_mfma_f32_16x16x16_bf16 v[176:179], v[86:87], v[44:45], v[176:179]
  s_waitcnt lgkmcnt(0)
  v_perm_b32 v132, v133, v132, s61
L_pj:
  v_mfma_f32_16x16x32_bf16 v[40:43], a[144:147], a[244:247], 0
  ds_read_b128 v[72:75], v3 offset:256
  ds_read_b128 v[56:59], v3 offset:4352
  v_mfma_f32_16x16x32_bf16 v[40:43], a[160:163], a[248:251], v[40:43]
  v_exp_f32 v135, v135
  v_mfma_f32_16x16x32_bf16 v[40:43], a[176:179], a[252:255], v[40:43]
  ds_read_b128 v[60:63], v3 offset:8448
  ds_read_b128 v[76:79], v3 offset:12544
  v_mfma_f32_16x16x32_bf16 v[40:43], a[192:195], v[180:183], v[40:43]
  v_exp_f32 v140, v140
  v_mfma_f32_16x16x32_bf16 v[40:43], a[208:211], v[64:67], v[40:43]
  ds_read_b128 v[80:83], v3 offset:16640
  ds_read_b128 v[84:87], v3 offset:20736
  v_mfma_f32_16x16x32_bf16 v[40:43], a[224:227], v[68:71], v[40:43]
  v_exp_f32 v141, v141
  v_mfma_f32_16x16x32_bf16 v[44:47], a[228:231], v[68:71], 0
  v_perm_b32 v133, v135, v134, s61
  v_perm_b32 v134, v141, v140, s61
  v_mfma_f32_16x16x32_bf16 v[44:47], a[212:215], v[64:67], v[44:47]
  v_exp_f32 v142, v142
  v_mfma_f32_16x16x32_bf16 v[44:47], a[196:199], v[180:183], v[44:47]
  v_cvt_pk_bf16_f32 v40, v40, v41
  v_cvt_pk_bf16_f32 v41, v42, v43
  v_mfma_f32_16x16x32_bf16 v[44:47], a[180:183], a[252:255], v[44:47]
  ds_read_b128 v[124:127], v2 offset:512
  ds_read_b128 v[128:131], v2 offset:4608
  v_mfma_f32_16x16x32_bf16 v[44:47], a[164:167], a[248:251], v[44:47]
  v_exp_f32 v143, v143
  v_mfma_f32_16x16x32_bf16 v[44:47], a[148:151], a[244:247], v[44:47]
  s_waitcnt lgkmcnt(2)
  v_perm_b32 v135, v143, v142, s61
  v_mfma_f32_16x16x32_bf16 v[48:51], a[144:147], v[72:75], 0
  ds_read_b128 a[244:247], v2 offset:8704
  ds_read_b128 a[248:251], v2 offset:12800
  v_mfma_f32_16x16x32_bf16 v[48:51], a[160:163], v[56:59], v[48:51]
  v_exp_f32 v136, v136
  v_mfma_f32_16x16x32_bf16 v[48:51], a[176:179], v[60:63], v[48:51]
  v_cvt_pk_bf16_f32 v42, v44, v45
  v_cvt_pk_bf16_f32 v43, v46, v47
  v_mfma_f32_16x16x32_bf16 v[48:51], a[192:195], v[76:79], v[48:51]
  buffer_store_dwordx4 v[40:43], v7, s[24:27], s40 offen nt
  v_mfma_f32_16x16x32_bf16 v[48:51], a[208:211], v[80:83], v[48:51]
  ds_read_b128 a[252:255], v2 offset:16896
  ds_read_b128 v[180:183], v2 offset:20992
  v_mfma_f32_16x16x32_bf16 v[48:51], a[224:227], v[84:87], v[48:51]
  v_exp_f32 v137, v137
  v_mfma_f32_16x16x32_bf16 v[52:55], a[228:231], v[84:87], 0
  v_exp_f32 v138, v138
  v_mfma_f32_16x16x32_bf16 v[52:55], a[212:215], v[80:83], v[52:55]
  v_exp_f32 v139, v139
  v_mfma_f32_16x16x32_bf16 v[52:55], a[196:199], v[76:79], v[52:55]
  v_cvt_pk_bf16_f32 v48, v48, v49
  v_cvt_pk_bf16_f32 v49, v50, v51
  v_mfma_f32_16x16x32_bf16 v[52:55], a[180:183], v[60:63], v[52:55]
  v_perm_b32 v136, v137, v136, s61
  v_perm_b32 v137, v139, v138, s61
  v_mfma_f32_16x16x32_bf16 v[52:55], a[164:167], v[56:59], v[52:55]
  v_exp_f32 v144, v144
  v_mfma_f32_16x16x32_bf16 v[52:55], a[148:151], v[72:75], v[52:55]
  s_waitcnt lgkmcnt(0)
  v_mfma_f32_16x16x32_bf16 v[40:43], a[144:147], v[124:127], 0
  v_exp_f32 v145, v145
  v_mfma_f32_16x16x32_bf16 v[40:43], a[160:163], v[128:131], v[40:43]
  v_exp_f32 v146, v146
  v_mfma_f32_16x16x32_bf16 v[40:43], a[176:179], a[244:247], v[40:43]
  v_cvt_pk_bf16_f32 v50, v52, v53
  v_cvt_pk_bf16_f32 v51, v54, v55
  v_mfma_f32_16x16x32_bf16 v[40:43], a[192:195], a[248:251], v[40:43]
  buffer_store_dwordx4 v[48:51], v7, s[24:27], s41 offen nt
  v_mfma_f32_16x16x32_bf16 v[40:43], a[208:211], a[252:255], v[40:43]
  ds_read_b128 v[72:75], v2 offset:768
  ds_read_b128 v[56:59], v2 offset:4864
  v_mfma_f32_16x16x32_bf16 v[40:43], a[224:227], v[180:183], v[40:43]
  v_exp_f32 v147, v147
  v_mfma_f32_16x16x32_bf16 v[44:47], a[228:231], v[180:183], 0
  ds_read_b128 v[60:63], v2 offset:8960
  ds_read_b128 v[76:79], v2 offset:13056
  v_mfma_f32_16x16x32_bf16 v[44:47], a[212:215], a[252:255], v[44:47]
  v_perm_b32 v138, v145, v144, s61
  v_perm_b32 v139, v147, v146, s61
  v_mfma_f32_16x16x32_bf16 v[44:47], a[196:199], a[248:251], v[44:47]
  v_cvt_pk_bf16_f32 v40, v40, v41
  v_cvt_pk_bf16_f32 v41, v42, v43
  v_mfma_f32_16x16x32_bf16 v[44:47], a[180:183], a[244:247], v[44:47]
  ds_read_b128 v[80:83], v2 offset:17152
  ds_read_b128 v[84:87], v2 offset:21248
  v_mfma_f32_16x16x32_bf16 v[44:47], a[164:167], v[128:131], v[44:47]
  v_exp_f32 v148, v148
  v_mfma_f32_16x16x32_bf16 v[44:47], a[148:151], v[124:127], v[44:47]
  v_exp_f32 v149, v149
  v_mfma_f32_16x16x32_bf16 v[48:51], a[152:155], v[124:127], 0
  v_mov_b64 v[144:145], 0
  v_perm_b32 v148, v149, v148, s61
  v_mfma_f32_16x16x32_bf16 v[48:51], a[168:171], v[128:131], v[48:51]
  v_exp_f32 v150, v150
  v_mfma_f32_16x16x32_bf16 v[48:51], a[184:187], a[244:247], v[48:51]
  v_cvt_pk_bf16_f32 v42, v44, v45
  v_cvt_pk_bf16_f32 v43, v46, v47
  v_mfma_f32_16x16x32_bf16 v[48:51], a[200:203], a[248:251], v[48:51]
  buffer_store_dwordx4 v[40:43], v7, s[24:27], s42 offen nt
  v_mfma_f32_16x16x32_bf16 v[48:51], a[216:219], a[252:255], v[48:51]
  v_exp_f32 v151, v151
  v_mfma_f32_16x16x32_bf16 v[48:51], a[232:235], v[180:183], v[48:51]
  v_exp_f32 v156, v156
  v_mfma_f32_16x16x32_bf16 v[52:55], a[236:239], v[180:183], 0
  v_exp_f32 v157, v157
  v_mfma_f32_16x16x32_bf16 v[52:55], a[220:223], a[252:255], v[52:55]
  v_perm_b32 v149, v151, v150, s61
  v_perm_b32 v150, v157, v156, s61
  v_mfma_f32_16x16x32_bf16 v[52:55], a[204:207], a[248:251], v[52:55]
  v_cvt_pk_bf16_f32 v48, v48, v49
  v_cvt_pk_bf16_f32 v49, v50, v51
  v_mfma_f32_16x16x32_bf16 v[52:55], a[188:191], a[244:247], v[52:55]
  v_exp_f32 v158, v158
  v_mfma_f32_16x16x32_bf16 v[52:55], a[172:175], v[128:131], v[52:55]
  v_exp_f32 v159, v159
  v_mfma_f32_16x16x32_bf16 v[52:55], a[156:159], v[124:127], v[52:55]
  s_waitcnt lgkmcnt(0)
  v_perm_b32 v151, v159, v158, s61
  v_mfma_f32_16x16x32_bf16 v[40:43], a[144:147], v[72:75], 0
  v_exp_f32 v152, v152
  v_mfma_f32_16x16x32_bf16 v[40:43], a[160:163], v[56:59], v[40:43]
  v_exp_f32 v153, v153
  v_mfma_f32_16x16x32_bf16 v[40:43], a[176:179], v[60:63], v[40:43]
  v_cvt_pk_bf16_f32 v50, v52, v53
  v_cvt_pk_bf16_f32 v51, v54, v55
  v_mfma_f32_16x16x32_bf16 v[40:43], a[192:195], v[76:79], v[40:43]
  buffer_store_dwordx4 v[48:51], v8, s[24:27], s42 offen nt
  v_mfma_f32_16x16x32_bf16 v[40:43], a[208:211], v[80:83], v[40:43]
  v_exp_f32 v154, v154
  v_mfma_f32_16x16x32_bf16 v[40:43], a[224:227], v[84:87], v[40:43]
  v_exp_f32 v155, v155
  v_mfma_f32_16x16x32_bf16 v[44:47], a[228:231], v[84:87], 0
  v_perm_b32 v152, v153, v152, s61
  v_perm_b32 v153, v155, v154, s61
  v_mfma_f32_16x16x32_bf16 v[44:47], a[212:215], v[80:83], v[44:47]
  v_exp_f32 v160, v160
  v_mfma_f32_16x16x32_bf16 v[44:47], a[196:199], v[76:79], v[44:47]
  v_cvt_pk_bf16_f32 v40, v40, v41
  v_cvt_pk_bf16_f32 v41, v42, v43
  v_mfma_f32_16x16x32_bf16 v[44:47], a[180:183], v[60:63], v[44:47]
  v_exp_f32 v161, v161
  v_mfma_f32_16x16x32_bf16 v[44:47], a[164:167], v[56:59], v[44:47]
  v_exp_f32 v162, v162
  v_mfma_f32_16x16x32_bf16 v[44:47], a[148:151], v[72:75], v[44:47]
  v_exp_f32 v163, v163
  v_mfma_f32_16x16x32_bf16 v[48:51], a[152:155], v[72:75], 0
  v_perm_b32 v154, v161, v160, s61
  v_perm_b32 v155, v163, v162, s61
  v_mfma_f32_16x16x32_bf16 v[48:51], a[168:171], v[56:59], v[48:51]
  v_exp_f32 v164, v164
  v_mfma_f32_16x16x32_bf16 v[48:51], a[184:187], v[60:63], v[48:51]
  v_cvt_pk_bf16_f32 v42, v44, v45
  v_cvt_pk_bf16_f32 v43, v46, v47
  v_mfma_f32_16x16x32_bf16 v[48:51], a[200:203], v[76:79], v[48:51]
  buffer_store_dwordx4 v[40:43], v7, s[24:27], s43 offen nt
  v_mfma_f32_16x16x32_bf16 v[48:51], a[216:219], v[80:83], v[48:51]
  v_exp_f32 v165, v165
  v_mfma_f32_16x16x32_bf16 v[48:51], a[232:235], v[84:87], v[48:51]
  v_exp_f32 v166, v166
  v_mfma_f32_16x16x32_bf16 v[52:55], a[236:239], v[84:87], 0
  v_exp_f32 v167, v167
  v_mfma_f32_16x16x32_bf16 v[52:55], a[220:223], v[80:83], v[52:55]
  v_perm_b32 v164, v165, v164, s61
  v_perm_b32 v165, v167, v166, s61
  v_mfma_f32_16x16x32_bf16 v[52:55], a[204:207], v[76:79], v[52:55]
  v_cvt_pk_bf16_f32 v48, v48, v49
  v_cvt_pk_bf16_f32 v49, v50, v51
  v_mfma_f32_16x16x32_bf16 v[52:55], a[188:191], v[60:63], v[52:55]
  v_exp_f32 v172, v172
  v_mfma_f32_16x16x32_bf16 v[52:55], a[172:175], v[56:59], v[52:55]
  v_exp_f32 v173, v173
  v_mfma_f32_16x16x32_bf16 v[52:55], a[156:159], v[72:75], v[52:55]
  v_perm_b32 v166, v173, v172, s61
  s_cbranch_scc1 L_fin
  v_smfmac_f32_16x16x64_bf16 v[144:147], a[240:243], v[116:123], v10
  v_exp_f32 v174, v174
  v_mfma_f32_16x16x32_bf16 v[124:127], v[20:23], v[120:123], 0
  v_exp_f32 v175, v175
  v_mfma_f32_16x16x32_bf16 v[124:127], v[16:19], v[116:119], v[124:127]
  v_cvt_pk_bf16_f32 v50, v52, v53
  v_cvt_pk_bf16_f32 v51, v54, v55
  v_mfma_f32_16x16x32_bf16 v[128:131], v[24:27], v[116:119], 0
  v_add_f32 v15, v144, v145
  v_mov_b64 v[144:145], 0
  v_mfma_f32_16x16x32_bf16 v[128:131], v[28:31], v[120:123], v[128:131]
  buffer_store_dwordx4 v[48:51], v8, s[24:27], s43 offen nt
  v_mfma_f32_16x16x32_bf16 v[140:143], v[36:39], v[120:123], 0
  v_exp_f32 v168, v168
  v_mfma_f32_16x16x32_bf16 v[140:143], v[32:35], v[116:119], v[140:143]
  v_exp_f32 v169, v169
  v_smfmac_f32_16x16x64_bf16 v[144:147], a[240:243], v[132:139], v10
  v_perm_b32 v167, v175, v174, s61
  v_perm_b32 v168, v169, v168, s61
  v_mfma_f32_16x16x32_bf16 v[116:119], v[20:23], v[136:139], 0
  v_exp_f32 v170, v170
  v_mfma_f32_16x16x32_bf16 v[116:119], v[16:19], v[132:135], v[116:119]
  v_exp_f32 v171, v171
  v_mfma_f32_16x16x32_bf16 v[120:123], v[24:27], v[132:135], 0
  v_add_f32 v14, v144, v145
  v_mov_b64 v[144:145], 0
L_hop3:
  s_cbranch_execz L_hopped
  v_mfma_f32_16x16x32_bf16 v[120:123], v[28:31], v[136:139], v[120:123]
  v_exp_f32 v176, v176
  v_mfma_f32_16x16x32_bf16 v[156:159], v[36:39], v[136:139], 0
  v_exp_f32 v177, v177
  v_mfma_f32_16x16x32_bf16 v[156:159], v[32:35], v[132:135], v[156:159]
  v_perm_b32 v169, v171, v170, s61
  v_perm_b32 v170, v177, v176, s61
  v_smfmac_f32_16x16x64_bf16 v[144:147], a[240:243], v[148:155], v10
  v_exp_f32 v178, v178
  v_mfma_f32_16x16x32_bf16 v[132:135], v[20:23], v[152:155], 0
  v_exp_f32 v179, v179
  v_mfma_f32_16x16x32_bf16 v[132:135], v[16:19], v[148:151], v[132:135]
  v_perm_b32 v171, v179, v178, s61
  v_mfma_f32_16x16x32_bf16 v[136:139], v[24:27], v[148:151], 0
  v_add_f32 v13, v144, v145
  v_mov_b64 v[144:145], 0
  v_mfma_f32_16x16x32_bf16 v[136:139], v[28:31], v[152:155], v[136:139]
  ds_read_b128 a[244:247], v0 offset:0
  ds_read_b128 a[248:251], v1 offset:0
  v_mfma_f32_16x16x32_bf16 v[160:163], v[36:39], v[152:155], 0
  v_rcp_f32 v15, v15
  v_mfma_f32_16x16x32_bf16 v[160:163], v[32:35], v[148:151], v[160:163]
  ds_read_b128 a[252:255], v0 offset:8192
  ds_read_b128 v[180:183], v1 offset:8192
  v_smfmac_f32_16x16x64_bf16 v[144:147], a[240:243], v[164:171], v10
  v_rcp_f32 v14, v14
  v_mfma_f32_16x16x32_bf16 v[148:151], v[20:23], v[168:171], 0
  ds_read_b128 v[64:67], v0 offset:16384
  ds_read_b128 v[68:71], v1 offset:16384
  v_mfma_f32_16x16x32_bf16 v[148:151], v[16:19], v[164:167], v[148:151]
  v_mul_f32 v124, v15, v124
  v_mul_f32 v125, v15, v125
  v_mfma_f32_16x16x32_bf16 v[152:155], v[24:27], v[164:167], 0
  v_add_f32 v12, v144, v145
  v_mul_f32 v126, v15, v126
  v_mfma_f32_16x16x32_bf16 v[152:155], v[28:31], v[168:171], v[152:155]
  v_mul_f32 v127, v15, v127
  v_cvt_pk_bf16_f32 v124, v124, v125
  v_mfma_f32_16x16x32_bf16 v[172:175], v[36:39], v[168:171], 0
  v_cvt_pk_bf16_f32 v125, v126, v127
  v_mul_f32 v128, v15, v128
  v_mfma_f32_16x16x32_bf16 v[172:175], v[32:35], v[164:167], v[172:175]
  s_waitcnt lgkmcnt(4)
  s_cbranch_vccnz L_epi
  v_mfma_f32_16x16x32_bf16 v[76:79], v[184:187], a[244:247], 0
  v_mul_f32 v129, v15, v129
  v_mul_f32 v130, v15, v130
  v_mfma_f32_16x16x32_bf16 v[76:79], v[196:199], a[248:251], v[76:79]
  s_waitcnt lgkmcnt(2)
  v_mul_f32 v131, v15, v131
  v_mfma_f32_16x16x32_bf16 v[76:79], v[208:211], a[252:255], v[76:79]
  v_cvt_pk_bf16_f32 v126, v128, v129
  v_cvt_pk_bf16_f32 v127, v130, v131
  v_mfma_f32_16x16x32_bf16 v[76:79], v[220:223], v[180:183], v[76:79]
  s_waitcnt lgkmcnt(0)
  v_mfma_f32_16x16x32_bf16 v[76:79], v[232:235], v[64:67], v[76:79]
  ds_write_b128 v4, v[124:127] offset:768
  v_mfma_f32_16x16x32_bf16 v[76:79], v[244:247], v[68:71], v[76:79]
  v_mul_f32 v140, v15, v140
  v_mul_f32 v141, v15, v141
  v_mfma_f32_16x16x32_bf16 v[80:83], v[248:251], v[68:71], 0
  v_mul_f32 v142, v15, v142
  v_mul_f32 v143, v15, v143
  v_mfma_f32_16x16x32_bf16 v[80:83], v[236:239], v[64:67], v[80:83]
  v_cvt_pk_bf16_f32 v140, v140, v141
  v_cvt_pk_bf16_f32 v141, v142, v143
  v_mfma_f32_16x16x32_bf16 v[80:83], v[224:227], v[180:183], v[80:83]
  v_cvt_pk_bf16_f32 v40, v76, v77
  v_cvt_pk_bf16_f32 v41, v78, v79
  v_mfma_f32_16x16x32_bf16 v[80:83], v[212:215], a[252:255], v[80:83]
  ds_write_b64 v5, v[140:141] offset:768
  v_mfma_f32_16x16x32_bf16 v[80:83], v[200:203], a[248:251], v[80:83]
  v_rcp_f32 v13, v13
  v_mfma_f32_16x16x32_bf16 v[80:83], v[188:191], a[244:247], v[80:83]
  s_add_u32 m0, s33, 0
  v_mul_f32 v116, v14, v116
  v_mfma_f32_16x16x32_bf16 v[76:79], v[192:195], a[244:247], 0
  buffer_load_dwordx4 v6, s[8:11], s48 offen offset:0 nt lds
  v_mfma_f32_16x16x32_bf16 v[76:79], v[204:207], a[248:251], v[76:79]
  v_mul_f32 v117, v14, v117
  v_mul_f32 v118, v14, v118
  v_mfma_f32_16x16x32_bf16 v[76:79], v[216:219], a[252:255], v[76:79]
  v_cvt_pk_bf16_f32 v42, v80, v81
  v_cvt_pk_bf16_f32 v43, v82, v83
  v_mfma_f32_16x16x32_bf16 v[76:79], v[228:231], v[180:183], v[76:79]
  v_mul_f32 v119, v14, v119
  v_cvt_pk_bf16_f32 v116, v116, v117
  v_mfma_f32_16x16x32_bf16 v[76:79], v[240:243], v[64:67], v[76:79]
  v_cvt_pk_bf16_f32 v117, v118, v119
  v_mul_f32 v120, v14, v120
  v_mfma_f32_16x16x32_bf16 v[76:79], v[252:255], v[68:71], v[76:79]
  v_mul_f32 v121, v14, v121
  v_mul_f32 v122, v14, v122
  v_mfma_f32_16x16x32_bf16 v[80:83], a[60:63], v[68:71], 0
  v_mul_f32 v123, v14, v123
  v_cvt_pk_bf16_f32 v118, v120, v121
  v_mfma_f32_16x16x32_bf16 v[80:83], a[48:51], v[64:67], v[80:83]
  s_add_u32 m0, s33, 8064
  v_cvt_pk_bf16_f32 v119, v122, v123
  v_mfma_f32_16x16x32_bf16 v[80:83], a[36:39], v[180:183], v[80:83]
  v_cvt_pk_bf16_f32 v44, v76, v77
  v_cvt_pk_bf16_f32 v45, v78, v79
  v_mfma_f32_16x16x32_bf16 v[80:83], a[24:27], a[252:255], v[80:83]
  buffer_load_dwordx4 v6, s[8:11], s48 offen offset:128 nt lds
  v_mfma_f32_16x16x32_bf16 v[80:83], a[12:15], a[248:251], v[80:83]
  ds_write_b128 v4, v[116:119] offset:512
  v_mfma_f32_16x16x32_bf16 v[80:83], a[0:3], a[244:247], v[80:83]
  v_mul_f32 v156, v14, v156
  v_mul_f32 v157, v14, v157
  v_mfma_f32_16x16x32_bf16 v[76:79], a[4:7], a[244:247], 0
  v_mul_f32 v158, v14, v158
  v_mul_f32 v159, v14, v159
  v_mfma_f32_16x16x32_bf16 v[76:79], a[16:19], a[248:251], v[76:79]
  v_cvt_pk_bf16_f32 v156, v156, v157
  v_cvt_pk_bf16_f32 v157, v158, v159
  v_mfma_f32_16x16x32_bf16 v[76:79], a[28:31], a[252:255], v[76:79]
  v_cvt_pk_bf16_f32 v46, v80, v81
  v_cvt_pk_bf16_f32 v47, v82, v83
  v_mfma_f32_16x16x32_bf16 v[76:79], a[40:43], v[180:183], v[76:79]
  s_add_u32 m0, s33, 16128
  v_mfma_f32_16x16x32_bf16 v[76:79], a[52:55], v[64:67], v[76:79]
  buffer_load_dwordx4 v6, s[8:11], s48 offen offset:256 nt lds
  v_mfma_f32_16x16x32_bf16 v[76:79], a[64:67], v[68:71], v[76:79]
  ds_write_b64 v5, v[156:157] offset:512
  v_mfma_f32_16x16x32_bf16 v[80:83], a[68:71], v[68:71], 0
  v_rcp_f32 v12, v12
  v_mfma_f32_16x16x32_bf16 v[80:83], a[56:59], v[64:67], v[80:83]
  v_mul_f32 v132, v13, v132
  v_mul_f32 v133, v13, v133
  v_mfma_f32_16x16x32_bf16 v[80:83], a[44:47], v[180:183], v[80:83]
  v_cvt_pk_bf16_f32 v48, v76, v77
  v_cvt_pk_bf16_f32 v49, v78, v79
  v_mfma_f32_16x16x32_bf16 v[80:83], a[32:35], a[252:255], v[80:83]
  v_mul_f32 v134, v13, v134
  v_mul_f32 v135, v13, v135
  v_mfma_f32_16x16x32_bf16 v[80:83], a[20:23], a[248:251], v[80:83]
  v_cvt_pk_bf16_f32 v132, v132, v133
  v_cvt_pk_bf16_f32 v133, v134, v135
  v_mfma_f32_16x16x32_bf16 v[80:83], a[8:11], a[244:247], v[80:83]
  s_add_u32 m0, s33, 4096
  v_mul_f32 v136, v13, v136
  v_mfma_f32_16x16x32_bf16 v[76:79], a[244:247], a[72:75], 0
  buffer_load_dwordx4 v6, s[8:11], s49 offen offset:0 nt lds
  v_mfma_f32_16x16x32_bf16 v[76:79], a[248:251], a[84:87], v[76:79]
  v_mul_f32 v137, v13, v137
  v_mul_f32 v138, v13, v138
  v_mfma_f32_16x16x32_bf16 v[76:79], a[252:255], a[96:99], v[76:79]
  v_cvt_pk_bf16_f32 v50, v80, v81
  v_cvt_pk_bf16_f32 v51, v82, v83
  v_mfma_f32_16x16x32_bf16 v[76:79], v[180:183], a[108:111], v[76:79]
  ds_read_b128 v[72:75], v0 offset:2048
  v_mul_f32 v139, v13, v139
  v_mfma_f32_16x16x32_bf16 v[76:79], v[64:67], a[120:123], v[76:79]
  ds_read_b128 v[84:87], v1 offset:2048
  v_cvt_pk_bf16_f32 v134, v136, v137
  v_mfma_f32_16x16x32_bf16 v[76:79], v[68:71], a[132:135], v[76:79]
  ds_read_b128 v[164:167], v0 offset:10240
  v_cvt_pk_bf16_f32 v135, v138, v139
  v_mfma_f32_16x16x32_bf16 v[80:83], v[68:71], a[136:139], 0
  ds_read_b128 v[168:171], v1 offset:10240
  v_mfma_f32_16x16x32_bf16 v[80:83], v[64:67], a[124:127], v[80:83]
  ds_read_b128 v[176:179], v0 offset:18432
  v_mfma_f32_16x16x32_bf16 v[80:83], v[180:183], a[112:115], v[80:83]
  v_cvt_pk_bf16_f32 v16, v76, v77
  v_cvt_pk_bf16_f32 v17, v78, v79
  v_mfma_f32_16x16x32_bf16 v[80:83], a[252:255], a[100:103], v[80:83]
  ds_read_b128 v[144:147], v1 offset:18432
  s_add_u32 m0, s33, 12160
  v_mfma_f32_16x16x32_bf16 v[80:83], a[248:251], a[88:91], v[80:83]
  buffer_load_dwordx4 v6, s[8:11], s49 offen offset:128 nt lds
  v_mfma_f32_16x16x32_bf16 v[80:83], a[244:247], a[76:79], v[80:83]
  ds_write_b128 v4, v[132:135] offset:256
  v_mfma_f32_16x16x32_bf16 v[76:79], a[244:247], a[80:83], 0
  v_mul_f32 v160, v13, v160
  v_mul_f32 v161, v13, v161
  v_mfma_f32_16x16x32_bf16 v[76:79], a[248:251], a[92:95], v[76:79]
  v_mul_f32 v162, v13, v162
  v_mul_f32 v163, v13, v163
  v_mfma_f32_16x16x32_bf16 v[76:79], a[252:255], a[104:107], v[76:79]
  v_cvt_pk_bf16_f32 v24, v80, v81
  v_cvt_pk_bf16_f32 v25, v82, v83
  v_mfma_f32_16x16x32_bf16 v[76:79], v[180:183], a[116:119], v[76:79]
  s_add_u32 m0, s33, 20224
  v_cvt_pk_bf16_f32 v160, v160, v161
  v_mfma_f32_16x16x32_bf16 v[76:79], v[64:67], a[128:131], v[76:79]
  buffer_load_dwordx4 v6, s[8:11], s49 offen offset:256 nt lds
  v_mfma_f32_16x16x32_bf16 v[76:79], v[68:71], a[140:143], v[76:79]
  s_waitcnt lgkmcnt(1)
  v_cvt_pk_bf16_f32 v161, v162, v163
  v_mfma_f32_16x16x32_bf16 v[80:83], v[184:187], v[72:75], 0
  ds_write_b64 v5, v[160:161] offset:256
  v_mfma_f32_16x16x32_bf16 v[80:83], v[196:199], v[84:87], v[80:83]
  v_mul_f32 v148, v12, v148
  v_mul_f32 v149, v12, v149
  v_mfma_f32_16x16x32_bf16 v[80:83], v[208:211], v[164:167], v[80:83]
  v_cvt_pk_bf16_f32 v32, v76, v77
  v_cvt_pk_bf16_f32 v33, v78, v79
  v_mfma_f32_16x16x32_bf16 v[80:83], v[220:223], v[168:171], v[80:83]
  v_mul_f32 v150, v12, v150
  v_mul_f32 v151, v12, v151
  v_mfma_f32_16x16x32_bf16 v[80:83], v[232:235], v[176:179], v[80:83]
  v_cvt_pk_bf16_f32 v148, v148, v149
  v_cvt_pk_bf16_f32 v149, v150, v151
  v_mfma_f32_16x16x32_bf16 v[80:83], v[244:247], v[144:147], v[80:83]
  v_mul_f32 v152, v12, v152
  v_mul_f32 v153, v12, v153
  v_mfma_f32_16x16x32_bf16 v[76:79], v[248:251], v[144:147], 0
  v_mul_f32 v154, v12, v154
  v_mul_f32 v155, v12, v155
  v_mfma_f32_16x16x32_bf16 v[76:79], v[236:239], v[176:179], v[76:79]
  v_cvt_pk_bf16_f32 v150, v152, v153
  v_cvt_pk_bf16_f32 v151, v154, v155
  v_mfma_f32_16x16x32_bf16 v[76:79], v[224:227], v[168:171], v[76:79]
  v_cvt_pk_bf16_f32 v52, v80, v81
  v_cvt_pk_bf16_f32 v53, v82, v83
  v_mfma_f32_16x16x32_bf16 v[76:79], v[212:215], v[164:167], v[76:79]
  ds_write_b128 v4, v[148:151] offset:0
  v_mfma_f32_16x16x32_bf16 v[76:79], v[200:203], v[84:87], v[76:79]
  v_mul_f32 v172, v12, v172
  v_mul_f32 v173, v12, v173
  v_mfma_f32_16x16x32_bf16 v[76:79], v[188:191], v[72:75], v[76:79]
  v_mul_f32 v174, v12, v174
  v_mul_f32 v175, v12, v175
  v_mfma_f32_16x16x32_bf16 v[80:83], v[192:195], v[72:75], 0
  v_cvt_pk_bf16_f32 v172, v172, v173
  v_cvt_pk_bf16_f32 v173, v174, v175
  v_mfma_f32_16x16x32_bf16 v[80:83], v[204:207], v[84:87], v[80:83]
  ds_write_b64 v5, v[172:173] offset:0
  v_mfma_f32_16x16x32_bf16 v[80:83], v[216:219], v[164:167], v[80:83]
  v_cvt_pk_bf16_f32 v54, v76, v77
  v_cvt_pk_bf16_f32 v55, v78, v79
  v_mfma_f32_16x16x32_bf16 v[80:83], v[228:231], v[168:171], v[80:83]
  v_subrev_u32 v3, s7, v3
  v_subrev_u32 v2, s7, v2
  v_mfma_f32_16x16x32_bf16 v[80:83], v[240:243], v[176:179], v[80:83]
  v_add_u32 v4, s7, v4
  v_add_u32 v5, s7, v5
  v_mfma_f32_16x16x32_bf16 v[80:83], v[252:255], v[144:147], v[80:83]
  s_sub_u32 s7, 0, s7
  v_max3_f32 v9, v12, v13, v9
  v_mfma_f32_16x16x32_bf16 v[76:79], a[60:63], v[144:147], 0
  v_max3_f32 v9, v14, v15, v9
  v_min3_f32 v11, v12, v13, v11
  v_mfma_f32_16x16x32_bf16 v[76:79], a[48:51], v[176:179], v[76:79]
  v_min3_f32 v11, v14, v15, v11
  v_mfma_f32_16x16x32_bf16 v[76:79], a[36:39], v[168:171], v[76:79]
  v_cvt_pk_bf16_f32 v56, v80, v81
  v_cvt_pk_bf16_f32 v57, v82, v83
  v_mfma_f32_16x16x32_bf16 v[76:79], a[24:27], v[164:167], v[76:79]
  v_mfma_f32_16x16x32_bf16 v[76:79], a[12:15], v[84:87], v[76:79]
  v_mfma_f32_16x16x32_bf16 v[76:79], a[0:3], v[72:75], v[76:79]
  v_mfma_f32_16x16x32_bf16 v[80:83], a[4:7], v[72:75], 0
  v_mfma_f32_16x16x32_bf16 v[80:83], a[16:19], v[84:87], v[80:83]
  v_mfma_f32_16x16x32_bf16 v[80:83], a[28:31], v[164:167], v[80:83]
  v_cvt_pk_bf16_f32 v58, v76, v77
  v_cvt_pk_bf16_f32 v59, v78, v79
  v_mfma_f32_16x16x32_bf16 v[80:83], a[40:43], v[168:171], v[80:83]
  v_mfma_f32_16x16x32_bf16 v[80:83], a[52:55], v[176:179], v[80:83]
  v_mfma_f32_16x16x32_bf16 v[80:83], a[64:67], v[144:147], v[80:83]
  v_mfma_f32_16x16x32_bf16 v[76:79], a[68:71], v[144:147], 0
  v_mfma_f32_16x16x32_bf16 v[76:79], a[56:59], v[176:179], v[76:79]
  v_mfma_f32_16x16x32_bf16 v[76:79], a[44:47], v[168:171], v[76:79]
  v_cvt_pk_bf16_f32 v60, v80, v81
  v_cvt_pk_bf16_f32 v61, v82, v83
  v_mfma_f32_16x16x32_bf16 v[76:79], a[32:35], v[164:167], v[76:79]
  v_mfma_f32_16x16x32_bf16 v[76:79], a[20:23], v[84:87], v[76:79]
  v_mfma_f32_16x16x32_bf16 v[76:79], a[8:11], v[72:75], v[76:79]
  v_mfma_f32_16x16x32_bf16 v[80:83], v[72:75], a[72:75], 0
  v_mfma_f32_16x16x32_bf16 v[80:83], v[84:87], a[84:87], v[80:83]
  v_mfma_f32_16x16x32_bf16 v[80:83], v[164:167], a[96:99], v[80:83]
  v_cvt_pk_bf16_f32 v62, v76, v77
  v_cvt_pk_bf16_f32 v63, v78, v79
  v_mfma_f32_16x16x32_bf16 v[80:83], v[168:171], a[108:111], v[80:83]
  ds_read_b128 v[116:119], v0 offset:4096
  v_mfma_f32_16x16x32_bf16 v[80:83], v[176:179], a[120:123], v[80:83]
  ds_read_b128 v[124:127], v1 offset:4096
  v_mfma_f32_16x16x32_bf16 v[80:83], v[144:147], a[132:135], v[80:83]
  ds_read_b128 v[120:123], v0 offset:12288
  v_mfma_f32_16x16x32_bf16 v[76:79], v[144:147], a[136:139], 0
  ds_read_b128 v[128:131], v1 offset:12288
  v_mfma_f32_16x16x32_bf16 v[76:79], v[176:179], a[124:127], v[76:79]
  ds_read_b128 v[132:135], v0 offset:20480
  v_mfma_f32_16x16x32_bf16 v[76:79], v[168:171], a[112:115], v[76:79]
  v_cvt_pk_bf16_f32 v18, v80, v81
  v_cvt_pk_bf16_f32 v19, v82, v83
  v_mfma_f32_16x16x32_bf16 v[76:79], v[164:167], a[100:103], v[76:79]
  ds_read_b128 v[140:143], v1 offset:20480
  v_mfma_f32_16x16x32_bf16 v[76:79], v[84:87], a[88:91], v[76:79]
  v_mfma_f32_16x16x32_bf16 v[76:79], v[72:75], a[76:79], v[76:79]
  v_mfma_f32_16x16x32_bf16 v[80:83], v[72:75], a[80:83], 0
  v_mfma_f32_16x16x32_bf16 v[80:83], v[84:87], a[92:95], v[80:83]
  v_mfma_f32_16x16x32_bf16 v[80:83], v[164:167], a[104:107], v[80:83]
  v_cvt_pk_bf16_f32 v26, v76, v77
  v_cvt_pk_bf16_f32 v27, v78, v79
  v_mfma_f32_16x16x32_bf16 v[80:83], v[168:171], a[116:119], v[80:83]
  v_mfma_f32_16x16x32_bf16 v[80:83], v[176:179], a[128:131], v[80:83]
  v_mfma_f32_16x16x32_bf16 v[80:83], v[144:147], a[140:143], v[80:83]
  s_waitcnt lgkmcnt(0)
  v_mfma_f32_16x16x32_bf16 v[148:151], v[184:187], v[116:119], 0
  s_add_u32 s40, s48, s52
  s_add_u32 s41, s48, s53
  v_mfma_f32_16x16x32_bf16 v[148:151], v[196:199], v[124:127], v[148:151]
  s_add_u32 s42, s48, s54
  s_add_u32 s43, s48, s55
  v_mfma_f32_16x16x32_bf16 v[148:151], v[208:211], v[120:123], v[148:151]
  v_cvt_pk_bf16_f32 v34, v80, v81
  v_cvt_pk_bf16_f32 v35, v82, v83
  v_mfma_f32_16x16x32_bf16 v[148:151], v[220:223], v[128:131], v[148:151]
  s_cmp_eq_u32 s48, s50
  s_cselect_b64 vcc, -1, 0
  v_mfma_f32_16x16x32_bf16 v[148:151], v[232:235], v[132:135], v[148:151]
  s_add_u32 s48, s48, 6291456
  s_add_u32 s49, s48, 786432
  v_mfma_f32_16x16x32_bf16 v[148:151], v[244:247], v[140:143], v[148:151]
  s_add_u32 s36, s32, s33
  s_mov_b32 s33, s32
  v_mfma_f32_16x16x32_bf16 v[156:159], v[248:251], v[140:143], 0
  s_sub_u32 s32, s34, s36
  v_mfma_f32_16x16x32_bf16 v[156:159], v[236:239], v[132:135], v[156:159]
  v_mfma_f32_16x16x32_bf16 v[156:159], v[224:227], v[128:131], v[156:159]
  v_cvt_pk_bf16_f32 v64, v148, v149
  v_cvt_pk_bf16_f32 v65, v150, v151
  v_mfma_f32_16x16x32_bf16 v[156:159], v[212:215], v[120:123], v[156:159]
  v_mfma_f32_16x16x32_bf16 v[156:159], v[200:203], v[124:127], v[156:159]
  v_mfma_f32_16x16x32_bf16 v[156:159], v[188:191], v[116:119], v[156:159]
  v_mfma_f32_16x16x32_bf16 v[148:151], v[192:195], v[116:119], 0
  v_mfma_f32_16x16x32_bf16 v[148:151], v[204:207], v[124:127], v[148:151]
  v_mfma_f32_16x16x32_bf16 v[148:151], v[216:219], v[120:123], v[148:151]
  v_cvt_pk_bf16_f32 v66, v156, v157
  v_cvt_pk_bf16_f32 v67, v158, v159
  v_mfma_f32_16x16x32_bf16 v[148:151], v[228:231], v[128:131], v[148:151]
  v_mfma_f32_16x16x32_bf16 v[148:151], v[240:243], v[132:135], v[148:151]
  v_mfma_f32_16x16x32_bf16 v[148:151], v[252:255], v[140:143], v[148:151]
  v_mfma_f32_16x16x32_bf16 v[156:159], a[60:63], v[140:143], 0
  v_mfma_f32_16x16x32_bf16 v[156:159], a[48:51], v[132:135], v[156:159]
  v_mfma_f32_16x16x32_bf16 v[156:159], a[36:39], v[128:131], v[156:159]
  v_cvt_pk_bf16_f32 v68, v148, v149
  v_cvt_pk_bf16_f32 v69, v150, v151
  v_mfma_f32_16x16x32_bf16 v[156:159], a[24:27], v[120:123], v[156:159]
  v_mfma_f32_16x16x32_bf16 v[156:159], a[12:15], v[124:127], v[156:159]
  v_mfma_f32_16x16x32_bf16 v[156:159], a[0:3], v[116:119], v[156:159]
  v_mfma_f32_16x16x32_bf16 v[148:151], a[4:7], v[116:119], 0
  v_mfma_f32_16x16x32_bf16 v[148:151], a[16:19], v[124:127], v[148:151]
  v_mfma_f32_16x16x32_bf16 v[148:151], a[28:31], v[120:123], v[148:151]
  v_cvt_pk_bf16_f32 v76, v156, v157
  v_cvt_pk_bf16_f32 v77, v158, v159
  v_mfma_f32_16x16x32_bf16 v[148:151], a[40:43], v[128:131], v[148:151]
  v_mfma_f32_16x16x32_bf16 v[148:151], a[52:55], v[132:135], v[148:151]
  v_mfma_f32_16x16x32_bf16 v[148:151], a[64:67], v[140:143], v[148:151]
  v_mfma_f32_16x16x32_bf16 v[156:159], a[68:71], v[140:143], 0
  v_mfma_f32_16x16x32_bf16 v[156:159], a[56:59], v[132:135], v[156:159]
  v_mfma_f32_16x16x32_bf16 v[156:159], a[44:47], v[128:131], v[156:159]
  v_cvt_pk_bf16_f32 v78, v148, v149
  v_cvt_pk_bf16_f32 v79, v150, v151
  v_mfma_f32_16x16x32_bf16 v[156:159], a[32:35], v[120:123], v[156:159]
  v_mfma_f32_16x16x32_bf16 v[156:159], a[20:23], v[124:127], v[156:159]
  v_mfma_f32_16x16x32_bf16 v[156:159], a[8:11], v[116:119], v[156:159]
  v_mfma_f32_16x16x32_bf16 v[148:151], v[116:119], a[72:75], 0
  v_mfma_f32_16x16x32_bf16 v[148:151], v[124:127], a[84:87], v[148:151]
  v_mfma_f32_16x16x32_bf16 v[148:151], v[120:123], a[96:99], v[148:151]
  v_cvt_pk_bf16_f32 v80, v156, v157
  v_cvt_pk_bf16_f32 v81, v158, v159
  v_mfma_f32_16x16x32_bf16 v[148:151], v[128:131], a[108:111], v[148:151]
  ds_read_b128 v[136:139], v0 offset:6144
  v_mfma_f32_16x16x32_bf16 v[148:151], v[132:135], a[120:123], v[148:151]
  ds_read_b128 v[144:147], v1 offset:6144
  v_mfma_f32_16x16x32_bf16 v[148:151], v[140:143], a[132:135], v[148:151]
  ds_read_b128 v[152:155], v0 offset:14336
  v_mfma_f32_16x16x32_bf16 v[156:159], v[140:143], a[136:139], 0
  ds_read_b128 v[160:163], v1 offset:14336
  v_mfma_f32_16x16x32_bf16 v[156:159], v[132:135], a[124:127], v[156:159]
  ds_read_b128 v[164:167], v0 offset:22528
  v_mfma_f32_16x16x32_bf16 v[156:159], v[128:131], a[112:115], v[156:159]
  v_cvt_pk_bf16_f32 v20, v148, v149
  v_cvt_pk_bf16_f32 v21, v150, v151
  v_mfma_f32_16x16x32_bf16 v[156:159], v[120:123], a[100:103], v[156:159]
  ds_read_b128 v[172:175], v1 offset:22528
  v_mfma_f32_16x16x32_bf16 v[156:159], v[124:127], a[88:91], v[156:159]
  v_mfma_f32_16x16x32_bf16 v[156:159], v[116:119], a[76:79], v[156:159]
  v_mfma_f32_16x16x32_bf16 v[148:151], v[116:119], a[80:83], 0
  v_mfma_f32_16x16x32_bf16 v[148:151], v[124:127], a[92:95], v[148:151]
  v_mfma_f32_16x16x32_bf16 v[148:151], v[120:123], a[104:107], v[148:151]
  v_cvt_pk_bf16_f32 v28, v156, v157
  v_cvt_pk_bf16_f32 v29, v158, v159
  v_mfma_f32_16x16x32_bf16 v[148:151], v[128:131], a[116:119], v[148:151]
  v_mfma_f32_16x16x32_bf16 v[148:151], v[132:135], a[128:131], v[148:151]
  v_mfma_f32_16x16x32_bf16 v[148:151], v[140:143], a[140:143], v[148:151]
  s_waitcnt lgkmcnt(0)
  v_mfma_f32_16x16x32_bf16 v[168:171], v[184:187], v[136:139], 0
  v_mfma_f32_16x16x32_bf16 v[168:171], v[196:199], v[144:147], v[168:171]
  v_mfma_f32_16x16x32_bf16 v[168:171], v[208:211], v[152:155], v[168:171]
  v_cvt_pk_bf16_f32 v36, v148, v149
  v_cvt_pk_bf16_f32 v37, v150, v151
  v_mfma_f32_16x16x32_bf16 v[168:171], v[220:223], v[160:163], v[168:171]
  v_mfma_f32_16x16x32_bf16 v[168:171], v[232:235], v[164:167], v[168:171]
  v_mfma_f32_16x16x32_bf16 v[168:171], v[244:247], v[172:175], v[168:171]
  v_mfma_f32_16x16x32_bf16 v[176:179], v[248:251], v[172:175], 0
  s_waitcnt vmcnt(12)
  s_barrier
  v_mfma_f32_16x16x32_bf16 v[176:179], v[236:239], v[164:167], v[176:179]
  v_mad_i32_i16 v0, v10, 1, s32 op_sel:[1,0,0,0]
  v_xor_b32 v1, 64, v0
  v_mfma_f32_16x16x32_bf16 v[176:179], v[224:227], v[160:163], v[176:179]
  v_cvt_pk_bf16_f32 v70, v168, v169
  v_cvt_pk_bf16_f32 v71, v170, v171
  v_mfma_f32_16x16x32_bf16 v[176:179], v[212:215], v[152:155], v[176:179]
  v_mfma_f32_16x16x32_bf16 v[176:179], v[200:203], v[144:147], v[176:179]
  v_mfma_f32_16x16x32_bf16 v[176:179], v[188:191], v[136:139], v[176:179]
  v_mfma_f32_16x16x32_bf16 v[168:171], v[192:195], v[136:139], 0
  v_mfma_f32_16x16x32_bf16 v[168:171], v[204:207], v[144:147], v[168:171]
  v_mfma_f32_16x16x32_bf16 v[168:171], v[216:219], v[152:155], v[168:171]
  v_cvt_pk_bf16_f32 v72, v176, v177
  v_cvt_pk_bf16_f32 v73, v178, v179
  v_mfma_f32_16x16x32_bf16 v[168:171], v[228:231], v[160:163], v[168:171]
  v_mfma_f32_16x16x32_bf16 v[168:171], v[240:243], v[164:167], v[168:171]
  v_mfma_f32_16x16x32_bf16 v[168:171], v[252:255], v[172:175], v[168:171]
  v_mfma_f32_16x16x32_bf16 v[176:179], a[60:63], v[172:175], 0
  v_mfma_f32_16x16x32_bf16 v[176:179], a[48:51], v[164:167], v[176:179]
  v_mfma_f32_16x16x32_bf16 v[176:179], a[36:39], v[160:163], v[176:179]
  v_cvt_pk_bf16_f32 v74, v168, v169
  v_cvt_pk_bf16_f32 v75, v170, v171
  v_mfma_f32_16x16x32_bf16 v[176:179], a[24:27], v[152:155], v[176:179]
  v_mfma_f32_16x16x32_bf16 v[176:179], a[12:15], v[144:147], v[176:179]
  v_mfma_f32_16x16x32_bf16 v[176:179], a[0:3], v[136:139], v[176:179]
  v_mfma_f32_16x16x32_bf16 v[168:171], a[4:7], v[136:139], 0
  v_mfma_f32_16x16x32_bf16 v[168:171], a[16:19], v[144:147], v[168:171]
  v_mfma_f32_16x16x32_bf16 v[168:171], a[28:31], v[152:155], v[168:171]
  v_cvt_pk_bf16_f32 v82, v176, v177
  v_cvt_pk_bf16_f32 v83, v178, v179
  v_mfma_f32_16x16x32_bf16 v[168:171], a[40:43], v[160:163], v[168:171]
  v_mfma_f32_16x16x32_bf16 v[168:171], a[52:55], v[164:167], v[168:171]
  v_mfma_f32_16x16x32_bf16 v[168:171], a[64:67], v[172:175], v[168:171]
  v_mfma_f32_16x16x32_bf16 v[176:179], a[68:71], v[172:175], 0
  v_mfma_f32_16x16x32_bf16 v[176:179], a[56:59], v[164:167], v[176:179]
  v_mfma_f32_16x16x32_bf16 v[176:179], a[44:47], v[160:163], v[176:179]
  v_cvt_pk_bf16_f32 v84, v168, v169
  v_cvt_pk_bf16_f32 v85, v170, v171
  v_mfma_f32_16x16x32_bf16 v[176:179], a[32:35], v[152:155], v[176:179]
  v_mfma_f32_16x16x32_bf16 v[176:179], a[20:23], v[144:147], v[176:179]
  v_mfma_f32_16x16x32_bf16 v[176:179], a[8:11], v[136:139], v[176:179]
  v_mfma_f32_16x16x32_bf16 v[168:171], v[136:139], a[72:75], 0
  v_mfma_f32_16x16x32_bf16 v[168:171], v[144:147], a[84:87], v[168:171]
  v_mfma_f32_16x16x32_bf16 v[168:171], v[152:155], a[96:99], v[168:171]
  v_cvt_pk_bf16_f32 v86, v176, v177
  v_cvt_pk_bf16_f32 v87, v178, v179
  v_mfma_f32_16x16x32_bf16 v[168:171], v[160:163], a[108:111], v[168:171]
  v_mfma_f32_16x16x32_bf16 v[168:171], v[164:167], a[120:123], v[168:171]
  v_mfma_f32_16x16x32_bf16 v[168:171], v[172:175], a[132:135], v[168:171]
  v_mfma_f32_16x16x32_bf16 v[176:179], v[172:175], a[136:139], 0
  v_mfma_f32_16x16x32_bf16 v[176:179], v[164:167], a[124:127], v[176:179]
  v_mfma_f32_16x16x32_bf16 v[176:179], v[160:163], a[112:115], v[176:179]
  v_cvt_pk_bf16_f32 v22, v168, v169
  v_cvt_pk_bf16_f32 v23, v170, v171
  v_mfma_f32_16x16x32_bf16 v[176:179], v[152:155], a[100:103], v[176:179]
  ds_read_b128 a[244:247], v3 offset:0
  v_mfma_f32_16x16x32_bf16 v[176:179], v[144:147], a[88:91], v[176:179]
  ds_read_b128 a[248:251], v3 offset:4096
  v_mfma_f32_16x16x32_bf16 v[176:179], v[136:139], a[76:79], v[176:179]
  ds_read_b128 a[252:255], v3 offset:8192
  v_mfma_f32_16x16x32_bf16 v[168:171], v[136:139], a[80:83], 0
  ds_read_b128 v[180:183], v3 offset:12288
  v_mfma_f32_16x16x32_bf16 v[168:171], v[144:147], a[92:95], v[168:171]
  v_mfma_f32_16x16x32_bf16 v[168:171], v[152:155], a[104:107], v[168:171]
  v_cvt_pk_bf16_f32 v30, v176, v177
  v_cvt_pk_bf16_f32 v31, v178, v179
  v_mfma_f32_16x16x32_bf16 v[168:171], v[160:163], a[116:119], v[168:171]
  v_mfma_f32_16x16x32_bf16 v[168:171], v[164:167], a[128:131], v[168:171]
  v_mfma_f32_16x16x32_bf16 v[168:171], v[172:175], a[140:143], v[168:171]
  s_branch L_s
L_fin:
  s_nop 5
  v_cvt_pk_bf16_f32 v50, v52, v53
  v_cvt_pk_bf16_f32 v51, v54, v55
  buffer_store_dwordx4 v[48:51], v8, s[24:27], s43 offen nt
  s_waitcnt lgkmcnt(0)
  s_barrier
  ds_read_b128 v[116:119], v1
  s_waitcnt lgkmcnt(0)
  v_or3_b32 v116, v116, v117, v118
  v_or_b32 v116, v116, v119
  s_nop 0
  v_readfirstlane_b32 s36, v116
  s_nop 3
  s_andn2_b32 s36, s36, s31
  s_cbranch_scc1 L_redo
  s_endpgm
L_epi:
  v_mul_f32 v129, v15, v129
  v_pk_mul_f32 v[130:131], v[130:131], v[14:15] op_sel:[0,1] op_sel_hi:[1,1]
  v_cvt_pk_bf16_f32 v126, v128, v129
  v_cvt_pk_bf16_f32 v127, v130, v131
  ds_write_b128 v4, v[124:127] offset:768
  v_pk_mul_f32 v[140:141], v[140:141], v[14:15] op_sel:[0,1] op_sel_hi:[1,1]
  v_pk_mul_f32 v[142:143], v[142:143], v[14:15] op_sel:[0,1] op_sel_hi:[1,1]
  v_cvt_pk_bf16_f32 v140, v140, v141
  v_cvt_pk_bf16_f32 v141, v142, v143
  ds_write_b64 v5, v[140:141] offset:768
  v_rcp_f32 v13, v13
  v_pk_mul_f32 v[116:117], v[116:117], v[14:15] op_sel:[0,0] op_sel_hi:[1,0]
  v_pk_mul_f32 v[118:119], v[118:119], v[14:15] op_sel:[0,0] op_sel_hi:[1,0]
  v_cvt_pk_bf16_f32 v116, v116, v117
  v_cvt_pk_bf16_f32 v117, v118, v119
  v_pk_mul_f32 v[120:121], v[120:121], v[14:15] op_sel:[0,0] op_sel_hi:[1,0]
  v_pk_mul_f32 v[122:123], v[122:123], v[14:15] op_sel:[0,0] op_sel_hi:[1,0]
  v_cvt_pk_bf16_f32 v118, v120, v121
  v_cvt_pk_bf16_f32 v119, v122, v123
  ds_write_b128 v4, v[116:119] offset:512
  v_pk_mul_f32 v[156:157], v[156:157], v[14:15] op_sel:[0,0] op_sel_hi:[1,0]
  v_pk_mul_f32 v[158:159], v[158:159], v[14:15] op_sel:[0,0] op_sel_hi:[1,0]
  v_cvt_pk_bf16_f32 v156, v156, v157
  v_cvt_pk_bf16_f32 v157, v158, v159
  ds_write_b64 v5, v[156:157] offset:512
  v_rcp_f32 v12, v12
  s_nop 0
  v_pk_mul_f32 v[132:133], v[132:133], v[12:13] op_sel:[0,1] op_sel_hi:[1,1]
  v_pk_mul_f32 v[134:135], v[134:135], v[12:13] op_sel:[0,1] op_sel_hi:[1,1]
  v_cvt_pk_bf16_f32 v132, v132, v133
  v_cvt_pk_bf16_f32 v133, v134, v135
  v_pk_mul_f32 v[136:137], v[136:137], v[12:13] op_sel:[0,1] op_sel_hi:[1,1]
  v_pk_mul_f32 v[138:139], v[138:139], v[12:13] op_sel:[0,1] op_sel_hi:[1,1]
  v_cvt_pk_bf16_f32 v134, v136, v137
  v_cvt_pk_bf16_f32 v135, v138, v139
  ds_write_b128 v4, v[132:135] offset:256
  v_pk_mul_f32 v[160:161], v[160:161], v[12:13] op_sel:[0,1] op_sel_hi:[1,1]
  v_pk_mul_f32 v[162:163], v[162:163], v[12:13] op_sel:[0,1] op_sel_hi:[1,1]
  v_cvt_pk_bf16_f32 v160, v160, v161
  v_cvt_pk_bf16_f32 v161, v162, v163
  ds_write_b64 v5, v[160:161] offset:256
  v_pk_mul_f32 v[148:149], v[148:149], v[12:13] op_sel:[0,0] op_sel_hi:[1,0]
  v_pk_mul_f32 v[150:151], v[150:151], v[12:13] op_sel:[0,0] op_sel_hi:[1,0]
  v_cvt_pk_bf16_f32 v148, v148, v149
  v_cvt_pk_bf16_f32 v149, v150, v151
  v_pk_mul_f32 v[152:153], v[152:153], v[12:13] op_sel:[0,0] op_sel_hi:[1,0]
  v_pk_mul_f32 v[154:155], v[154:155], v[12:13] op_sel:[0,0] op_sel_hi:[1,0]
  v_cvt_pk_bf16_f32 v150, v152, v153
  v_cvt_pk_bf16_f32 v151, v154, v155
  ds_write_b128 v4, v[148:151] offset:0
  v_pk_mul_f32 v[172:173], v[172:173], v[12:13] op_sel:[0,0] op_sel_hi:[1,0]
  v_pk_mul_f32 v[174:175], v[174:175], v[12:13] op_sel:[0,0] op_sel_hi:[1,0]
  v_cvt_pk_bf16_f32 v172, v172, v173
  v_cvt_pk_bf16_f32 v173, v174, v175
  ds_write_b64 v5, v[172:173] offset:0
  v_max3_f32 v9, v12, v13, v9
  v_max3_f32 v9, v14, v15, v9
  v_min3_f32 v11, v12, v13, v11
  v_min3_f32 v11, v14, v15, v11
  v_subrev_u32 v3, s7, v3
  v_subrev_u32 v2, s7, v2
  v_cmp_nle_f32 vcc, 0x2b800000, v11
  s_lshl_b32 s39, s4, 2
  s_add_u32 s39, s39, 139264
  v_mov_b32 v0, s39
  s_nop 0
  s_mov_b64 s[36:37], vcc
  v_cmp_nge_f32 vcc, 0x53800000, v9
  s_waitcnt lgkmcnt(0)
  s_barrier
  ds_read_b128 a[244:247], v3 offset:0
  ds_read_b128 a[248:251], v3 offset:4096
  ds_read_b128 a[252:255], v3 offset:8192
  ds_read_b128 v[180:183], v3 offset:12288
  ds_read_b128 v[64:67], v3 offset:16384
  ds_read_b128 v[68:71], v3 offset:20480
  s_add_u32 s40, s48, s52
  s_add_u32 s41, s48, s53
  s_add_u32 s42, s48, s54
  s_add_u32 s43, s48, s55
  s_or_b64 vcc, vcc, s[36:37]
  s_cselect_b32 s38, 1, 0
  v_mov_b32 v1, s38
  ds_write_b32 v0, v1
  v_mov_b32 v1, 139264
  s_cmp_eq_u32 0, 0
  s_waitcnt lgkmcnt(1)
  s_branch L_pj
L_redo:
  s_mov_b32 s31, 1
  s_waitcnt vmcnt(0) lgkmcnt(0)
  v_mbcnt_lo_u32_b32 v0, -1, 0
  v_mbcnt_hi_u32_b32 v0, -1, v0
  v_add_u32 v0, s3, v0
  s_barrier
  s_branch L_again
L_special0:
  buffer_load_dwordx4 v6, s[8:11], s49 offen offset:256 nt lds
  s_add_u32 s48, s48, 6291456
  s_add_u32 s49, s48, 786432
  s_add_u32 m0, s32, 65536
  ds_read_b64_tr_b16 a[100:101], v13 offset:49152
  buffer_load_dwordx4 v6, s[8:11], s48 offen offset:0 nt lds
  ds_read_b64_tr_b16 a[102:103], v13 offset:49664
  ds_read_b64_tr_b16 a[104:105], v14 offset:49152
  ds_read_b64_tr_b16 a[106:107], v14 offset:49664
  ds_read_b64_tr_b16 a[108:109], v12 offset:61440
  s_add_u32 m0, s32, 73600
  ds_read_b64_tr_b16 a[110:111], v12 offset:61952
  buffer_load_dwordx4 v6, s[8:11], s48 offen offset:128 nt lds
  ds_read_b64_tr_b16 a[112:113], v13 offset:61440
  ds_read_b64_tr_b16 a[114:115], v13 offset:61952
  ds_read_b64_tr_b16 a[116:117], v14 offset:61440
  ds_read_b64_tr_b16 a[118:119], v14 offset:61952
  s_add_u32 m0, s32, 81664
  s_nop 0
  buffer_load_dwordx4 v6, s[8:11], s48 offen offset:256 nt lds
  s_waitcnt lgkmcnt(0)
  s_waitcnt vmcnt(9)
  s_barrier
  ds_read_b64_tr_b16 a[120:121], v15 offset:0
  ds_read_b64_tr_b16 a[122:123], v15 offset:512
  ds_read_b64_tr_b16 a[124:125], v9 offset:0
  ds_read_b64_tr_b16 a[126:127], v9 offset:512
  ds_read_b64_tr_b16 a[128:129], v11 offset:0
  ds_read_b64_tr_b16 a[130:131], v11 offset:512
  ds_read_b64_tr_b16 a[132:133], v15 offset:12288
  ds_read_b64_tr_b16 a[134:135], v15 offset:12800
  ds_read_b64_tr_b16 a[136:137], v9 offset:12288
  ds_read_b64_tr_b16 a[138:139], v9 offset:12800
  ds_read_b64_tr_b16 a[140:141], v11 offset:12288
  ds_read_b64_tr_b16 a[142:143], v11 offset:12800
  v_mfma_f32_16x16x16_bf16 v[124:127], v[62:63], v[74:75], v[124:127]
  v_mfma_f32_16x16x16_bf16 v[120:123], v[80:81], v[74:75], v[120:123]
  v_mfma_f32_16x16x16_bf16 v[128:131], v[86:87], v[74:75], v[128:131]
  v_mfma_f32_16x16x32_bf16 v[132:135], v[46:49], v[64:67], v[160:163]
  v_mfma_f32_16x16x32_bf16 v[140:143], v[58:61], v[64:67], v[180:183]
  v_mfma_f32_16x16x32_bf16 v[136:139], v[76:79], v[64:67], v[100:103]
  v_mfma_f32_16x16x32_bf16 v[144:147], v[82:85], v[64:67], v[96:99]
  v_mfma_f32_16x16x16_bf16 v[132:135], v[50:51], v[68:69], v[132:135]
  v_mfma_f32_16x16x16_bf16 v[140:143], v[62:63], v[68:69], v[140:143]
  v_mfma_f32_16x16x16_bf16 v[136:139], v[80:81], v[68:69], v[136:139]
  v_mfma_f32_16x16x16_bf16 v[144:147], v[86:87], v[68:69], v[144:147]
  v_mfma_f32_16x16x32_bf16 v[148:151], v[46:49], v[52:55], v[104:107]
  v_mfma_f32_16x16x32_bf16 v[156:159], v[58:61], v[52:55], v[100:103]
  v_mfma_f32_16x16x32_bf16 v[152:155], v[76:79], v[52:55], v[152:155]
  v_mfma_f32_16x16x32_bf16 v[160:163], v[82:85], v[52:55], v[168:171]
  v_mfma_f32_16x16x16_bf16 v[148:151], v[50:51], v[56:57], v[148:151]
  v_mfma_f32_16x16x16_bf16 v[156:159], v[62:63], v[56:57], v[156:159]
  v_mfma_f32_16x16x16_bf16 v[152:155], v[80:81], v[56:57], v[152:155]
  v_mfma_f32_16x16x16_bf16 v[160:163], v[86:87], v[56:57], v[160:163]
  v_mfma_f32_16x16x32_bf16 v[164:167], v[46:49], v[40:43], v[100:103]
  v_mfma_f32_16x16x32_bf16 v[172:175], v[58:61], v[40:43], v[96:99]
  v_mfma_f32_16x16x32_bf16 v[168:171], v[76:79], v[40:43], v[168:171]
  v_mfma_f32_16x16x32_bf16 v[176:179], v[82:85], v[40:43], v[176:179]
  v_mfma_f32_16x16x16_bf16 v[164:167], v[50:51], v[44:45], v[164:167]
  v_mfma_f32_16x16x16_bf16 v[172:175], v[62:63], v[44:45], v[172:175]
  v_mfma_f32_16x16x16_bf16 v[168:171], v[80:81], v[44:45], v[168:171]
  v_mfma_f32_16x16x16_bf16 v[176:179], v[86:87], v[44:45], v[176:179]
  s_branch L_sp2
L_special:
  v_mfma_f32_16x16x16_bf16 v[124:127], v[62:63], v[74:75], v[124:127]
  v_mfma_f32_16x16x16_bf16 v[120:123], v[80:81], v[74:75], v[120:123]
  v_mfma_f32_16x16x16_bf16 v[128:131], v[86:87], v[74:75], v[128:131]
  v_mfma_f32_16x16x32_bf16 v[132:135], v[46:49], v[64:67], v[108:111]
  v_mfma_f32_16x16x32_bf16 v[140:143], v[58:61], v[64:67], v[104:107]
  v_mfma_f32_16x16x32_bf16 v[136:139], v[76:79], v[64:67], v[100:103]
  v_mfma_f32_16x16x32_bf16 v[144:147], v[82:85], v[64:67], v[96:99]
  v_mfma_f32_16x16x16_bf16 v[132:135], v[50:51], v[68:69], v[132:135]
  v_mfma_f32_16x16x16_bf16 v[140:143], v[62:63], v[68:69], v[140:143]
  v_mfma_f32_16x16x16_bf16 v[136:139], v[80:81], v[68:69], v[136:139]
  v_mfma_f32_16x16x16_bf16 v[144:147], v[86:87], v[68:69], v[144:147]
  v_mfma_f32_16x16x32_bf16 v[148:151], v[46:49], v[52:55], v[104:107]
  v_mfma_f32_16x16x32_bf16 v[156:159], v[58:61], v[52:55], v[100:103]
  v_mfma_f32_16x16x32_bf16 v[152:155], v[76:79], v[52:55], v[96:99]
  v_mfma_f32_16x16x32_bf16 v[160:163], v[82:85], v[52:55], v[92:95]
  v_mfma_f32_16x16x16_bf16 v[148:151], v[50:51], v[56:57], v[148:151]
  v_mfma_f32_16x16x16_bf16 v[156:159], v[62:63], v[56:57], v[156:159]
  v_mfma_f32_16x16x16_bf16 v[152:155], v[80:81], v[56:57], v[152:155]
  v_mfma_f32_16x16x16_bf16 v[160:163], v[86:87], v[56:57], v[160:163]
  v_mfma_f32_16x16x32_bf16 v[164:167], v[46:49], v[40:43], v[100:103]
  v_mfma_f32_16x16x32_bf16 v[172:175], v[58:61], v[40:43], v[96:99]
  v_mfma_f32_16x16x32_bf16 v[168:171], v[76:79], v[40:43], v[92:95]
  v_mfma_f32_16x16x32_bf16 v[176:179], v[82:85], v[40:43], v[88:91]
  v_mfma_f32_16x16x16_bf16 v[164:167], v[50:51], v[44:45], v[164:167]
  v_mfma_f32_16x16x16_bf16 v[172:175], v[62:63], v[44:45], v[172:175]
  v_mfma_f32_16x16x16_bf16 v[168:171], v[80:81], v[44:45], v[168:171]
  v_mfma_f32_16x16x16_bf16 v[176:179], v[86:87], v[44:45], v[176:179]
  ds_read_b128 v[64:67], v3 offset:16384
  ds_read_b128 v[68:71], v3 offset:20480
L_sp2:
  s_nop 15
  v_max_f32 v40, v164, v165
  v_max3_f32 v40, v166, v167, v40
  v_max3_f32 v40, v172, v173, v40
  v_max3_f32 v40, v174, v175, v40
  v_max3_f32 v40, v168, v169, v40
  v_max3_f32 v40, v170, v171, v40
  v_max3_f32 v40, v176, v177, v40
  v_max3_f32 v40, v178, v179, v40
  v_mov_b32 v41, v40
  s_nop 1
  v_permlane32_swap_b32 v40, v41
  v_max_f32 v40, v40, v41
  v_mov_b32 v41, v40
  s_nop 1
  v_permlane16_swap_b32 v40, v41
  v_max_f32 v40, v40, v41
  v_sub_f32 v164, v164, v40
  v_sub_f32 v165, v165, v40
  v_sub_f32 v166, v166, v40
  v_sub_f32 v167, v167, v40
  v_sub_f32 v172, v172, v40
  v_sub_f32 v173, v173, v40
  v_sub_f32 v174, v174, v40
  v_sub_f32 v175, v175, v40
  v_sub_f32 v168, v168, v40
  v_sub_f32 v169, v169, v40
  v_sub_f32 v170, v170, v40
  v_sub_f32 v171, v171, v40
  v_sub_f32 v176, v176, v40
  v_sub_f32 v177, v177, v40
  v_sub_f32 v178, v178, v40
  v_sub_f32 v179, v179, v40
  v_max_f32 v40, v148, v149
  v_max3_f32 v40, v150, v151, v40
  v_max3_f32 v40, v156, v157, v40
  v_max3_f32 v40, v158, v159, v40
  v_max3_f32 v40, v152, v153, v40
  v_max3_f32 v40, v154, v155, v40
  v_max3_f32 v40, v160, v161, v40
  v_max3_f32 v40, v162, v163, v40
  v_mov_b32 v41, v40
  s_nop 1
  v_permlane32_swap_b32 v40, v41
  v_max_f32 v40, v40, v41
  v_mov_b32 v41, v40
  s_nop 1
  v_permlane16_swap_b32 v40, v41
  v_max_f32 v40, v40, v41
  v_sub_f32 v148, v148, v40
  v_sub_f32 v149, v149, v40
  v_sub_f32 v150, v150, v40
  v_sub_f32 v151, v151, v40
  v_sub_f32 v156, v156, v40
  v_sub_f32 v157, v157, v40
  v_sub_f32 v158, v158, v40
  v_sub_f32 v159, v159, v40
  v_sub_f32 v152, v152, v40
  v_sub_f32 v153, v153, v40
  v_sub_f32 v154, v154, v40
  v_sub_f32 v155, v155, v40
  v_sub_f32 v160, v160, v40
  v_sub_f32 v161, v161, v40
  v_sub_f32 v162, v162, v40
  v_sub_f32 v163, v163, v40
  v_max_f32 v40, v132, v133
  v_max3_f32 v40, v134, v135, v40
  v_max3_f32 v40, v140, v141, v40
  v_max3_f32 v40, v142, v143, v40
  v_max3_f32 v40, v136, v137, v40
  v_max3_f32 v40, v138, v139, v40
  v_max3_f32 v40, v144, v145, v40
  v_max3_f32 v40, v146, v147, v40
  v_mov_b32 v41, v40
  s_nop 1
  v_permlane32_swap_b32 v40, v41
  v_max_f32 v40, v40, v41
  v_mov_b32 v41, v40
  s_nop 1
  v_permlane16_swap_b32 v40, v41
  v_max_f32 v40, v40, v41
  v_sub_f32 v132, v132, v40
  v_sub_f32 v133, v133, v40
  v_sub_f32 v134, v134, v40
  v_sub_f32 v135, v135, v40
  v_sub_f32 v140, v140, v40
  v_sub_f32 v141, v141, v40
  v_sub_f32 v142, v142, v40
  v_sub_f32 v143, v143, v40
  v_sub_f32 v136, v136, v40
  v_sub_f32 v137, v137, v40
  v_sub_f32 v138, v138, v40
  v_sub_f32 v139, v139, v40
  v_sub_f32 v144, v144, v40
  v_sub_f32 v145, v145, v40
  v_sub_f32 v146, v146, v40
  v_sub_f32 v147, v147, v40
  v_max_f32 v40, v116, v117
  v_max3_f32 v40, v118, v119, v40
  v_max3_f32 v40, v124, v125, v40
  v_max3_f32 v40, v126, v127, v40
  v_max3_f32 v40, v120, v121, v40
  v_max3_f32 v40, v122, v123, v40
  v_max3_f32 v40, v128, v129, v40
  v_max3_f32 v40, v130, v131, v40
  v_mov_b32 v41, v40
  s_nop 1
  v_permlane32_swap_b32 v40, v41
  v_max_f32 v40, v40, v41
  v_mov_b32 v41, v40
  s_nop 1
  v_permlane16_swap_b32 v40, v41
  v_max_f32 v40, v40, v41
  v_sub_f32 v116, v116, v40
  v_sub_f32 v117, v117, v40
  v_sub_f32 v118, v118, v40
  v_sub_f32 v119, v119, v40
  v_sub_f32 v124, v124, v40
  v_sub_f32 v125, v125, v40
  v_sub_f32 v126, v126, v40
  v_sub_f32 v127, v127, v40
  v_sub_f32 v120, v120, v40
  v_sub_f32 v121, v121, v40
  v_sub_f32 v122, v122, v40
  v_sub_f32 v123, v123, v40
  v_sub_f32 v128, v128, v40
  v_sub_f32 v129, v129, v40
  v_sub_f32 v130, v130, v40
  v_sub_f32 v131, v131, v40
  v_exp_f32 v116, v116
  v_exp_f32 v117, v117
  v_exp_f32 v118, v118
  v_exp_f32 v119, v119
  v_perm_b32 v116, v117, v116, s61
  v_perm_b32 v117, v119, v118, s61
  v_exp_f32 v124, v124
  v_exp_f32 v125, v125
  v_exp_f32 v126, v126
  s_waitcnt lgkmcnt(0)
  s_nop 7
  s_cmp_eq_u32 s35, 1
  s_cbranch_scc1 L_enter
  v_exp_f32 v127, v127
  v_perm_b32 v118, v125, v124, s61
  v_perm_b32 v119, v127, v126, s61
  v_exp_f32 v120, v120
  v_exp_f32 v121, v121
  v_exp_f32 v122, v122
  v_exp_f32 v123, v123
  v_perm_b32 v120, v121, v120, s61
  v_perm_b32 v121, v123, v122, s61
  v_exp_f32 v128, v128
  v_exp_f32 v129, v129
  v_exp_f32 v130, v130
  v_exp_f32 v131, v131
  v_perm_b32 v122, v129, v128, s61
  v_perm_b32 v123, v131, v130, s61
  v_exp_f32 v132, v132
  v_exp_f32 v133, v133
  v_exp_f32 v134, v134
  v_perm_b32 v132, v133, v132, s61
  s_nop 7
  s_branch L_pj
L_end:
  s_endpgm
.fill (standalone__window_attn_swin__vision_kernel + 33280 - .) / 4, 4, 0xbf810000
.section .rodata,"a"
.p2align 6
.amdhsa_kernel standalone__window_attn_swin__vision_kernel
  .amdhsa_next_free_vgpr 512
  .amdhsa_next_free_sgpr 102
  .amdhsa_accum_offset 256
  .amdhsa_group_segment_fixed_size 0
  .amdhsa_kernarg_size 72
  .amdhsa_user_sgpr_count 2
  .amdhsa_user_sgpr_kernarg_segment_ptr 1
  .amdhsa_system_sgpr_workgroup_id_x 1
.end_amdhsa_kernel
```

```asm
; @launch grid=(256,1,1) block=(256,1,1) lds=163840
.amdgcn_target "amdgcn-amd-amdhsa--gfx950"
.text
.globl standalone__window_attn_swin__vision_kernel
.p2align 12
.type standalone__window_attn_swin__vision_kernel,@function
standalone__window_attn_swin__vision_kernel:
  s_mov_b32 s31, 0
  s_mov_b64 s[56:57], 0
L_again:
  s_load_dwordx2 s[8:9], s[0:1], 0
  s_load_dwordx2 s[12:13], s[0:1], 8
  s_cmpk_ge_u32 s2, 256
  s_cbranch_scc1 L_end
  s_getpc_b64 s[42:43]
  s_lshr_b32 s44, s2, 3
  s_lshl_b32 s45, s44, 10
  v_lshl_add_u32 v2, v0, 2, s45
  v_mov_b32 v3, 0
  v_lshl_add_u64 v[2:3], v[2:3], 0, s[42:43]
  global_load_dword v64, v[2:3], off
  v_readfirstlane_b32 s3, v0
  s_load_dwordx2 s[20:21], s[0:1], 24
  s_mov_b32 s11, 0x20000
  s_mov_b32 s15, s11
  s_mov_b32 s14, 223232
  s_mulk_i32 s44, 6912
  v_lshlrev_b32 v26, 5, v0
  s_lshr_b32 s28, s2, 2
  s_or_b32 s28, s28, 1
  s_and_b32 s29, s2, 1
  s_sub_u32 s28, s28, s29
  s_bfe_u32 s29, s2, 0x20001
  s_lshr_b32 s4, s3, 6
  s_lshl_b32 s36, s28, 3
  v_bfe_u32 v21, v0, 3, 3
  v_add3_u32 v25, s36, 4, v21
  v_and_b32 v25, 0x1ff, v25
  v_mul_u32_u24 v25, 0x180, v25
  v_lshrrev_b32 v23, 4, v0
  v_lshrrev_b32 v24, 1, v0
  v_and_b32 v24, 4, v24
  v_bitop3_b32 v24, v24, v23, v0 bitop3:0x96
  v_and_b32 v24, 7, v24
  v_lshl_add_u32 v6, v24, 4, v25
  s_lshl3_add_u32 s36, s29, s4
  s_add_u32 s48, s36, 484
  s_add_u32 s49, s48, 4
  s_and_b32 s49, s49, 0x1ff
  s_mov_b32 s37, 196608
  s_mul_i32 s48, s48, s37
  s_mul_i32 s49, s49, s37
  s_mov_b32 s10, 100663296
  s_waitcnt lgkmcnt(0)
  s_sub_u32 s12, s12, 2048
  s_subb_u32 s13, s13, 0
  buffer_load_dword v65, v26, s[12:15], s44 offen offset:2048
  v_and_b32 v22, 4, v23
  v_and_b32 v24, 2, v21
  v_bitop3_b32 v24, v24, v22, v0 bitop3:0x96
  v_and_b32 v24, 7, v24
  v_mul_u32_u24 v25, 1152, v21
  v_lshl_add_u32 v25, v24, 4, v25
  v_add_u32 v136, 2048, v25
  v_add_u32 v137, 1152, v25
  v_add_u32 v138, 256, v25
  s_mul_i32 s62, s4, 9216
  s_mul_i32 s58, s4, 3072
  s_add_u32 s63, s58, 40960
  s_mov_b32 s22, 1800
  s_mov_b32 s23, s11
  v_lshlrev_b32 v34, 4, v0
  s_lshl_b32 s37, s4, 10
  s_add_u32 m0, s37, 24576
  v_mul_u32_u24 v35, 9, v0
  buffer_load_dwordx4 v34, s[20:23], 0 offen lds
  v_and_b32 v35, -4, v35
  s_load_dwordx2 s[16:17], s[0:1], 16
  s_load_dwordx2 s[24:25], s[0:1], 48
  s_load_dwordx2 s[20:21], s[0:1], 56
  v_and_b32 v16, 63, v0
  v_and_b32 v17, 15, v16
  v_lshrrev_b32 v18, 4, v16
  v_lshrrev_b32 v20, 2, v17
  v_and_b32 v27, 1, v18
  s_add_u32 m0, s63, 0
  s_add_u32 s36, s62, 0
  buffer_load_dwordx4 v136, s[12:15], s36 offen offset:0 lds
  v_lshrrev_b32 v28, 3, v17
  v_lshl_add_u32 v21, v27, 1, v28
  v_mul_u32_u24 v22, 3072, v18
  v_lshl_add_u32 v22, v20, 7, v22
  v_lshl_add_u32 v22, v21, 5, v22
  v_and_b32 v29, 3, v17
  v_lshl_add_u32 v22, v29, 3, v22
  s_mul_i32 s37, s4, 3
  buffer_load_dwordx4 v137, s[12:15], s36 offen offset:1024 lds
  s_and_b32 s38, s37, 3
  s_lshl_b32 s38, s38, 5
  s_lshr_b32 s39, s37, 2
  s_lshl_b32 s39, s39, 10
  s_add_u32 s39, s39, 40960
  v_xor_b32 v23, s38, v22
  v_add_u32 v12, s39, v23
  v_add_u32 v15, 73728, v12
  buffer_load_dwordx4 v138, s[12:15], s36 offen offset:2048 lds
  s_add_u32 s37, s37, 1
  s_and_b32 s38, s37, 3
  s_lshl_b32 s38, s38, 5
  s_lshr_b32 s39, s37, 2
  s_lshl_b32 s39, s39, 10
  s_add_u32 s39, s39, 40960
  s_mov_b64 exec, 0
  s_cmp_eq_u32 s4, 0
  s_cbranch_scc1 L_hop0
  s_cmp_eq_u32 s4, 1
  s_cbranch_scc1 L_hop1
  s_cmp_eq_u32 s4, 2
  s_cbranch_scc1 L_hop2
  s_branch L_hop3
L_hopped:
  s_mov_b64 exec, -1
  v_xor_b32 v23, s38, v22
  s_add_u32 m0, s63, 12288
  s_add_u32 s36, s62, 36864
  buffer_load_dwordx4 v136, s[12:15], s36 offen offset:0 lds
  v_add_u32 v13, s39, v23
  v_add_u32 v9, 73728, v13
  s_add_u32 s37, s37, 1
  s_and_b32 s38, s37, 3
  s_lshl_b32 s38, s38, 5
  s_lshr_b32 s39, s37, 2
  s_lshl_b32 s39, s39, 10
  s_add_u32 s39, s39, 40960
  buffer_load_dwordx4 v137, s[12:15], s36 offen offset:1024 lds
  v_xor_b32 v23, s38, v22
  v_add_u32 v14, s39, v23
  v_add_u32 v11, 73728, v14
  s_mov_b32 s46, 0x3e553b95
  s_mov_b32 s47, s46
  s_mov_b32 s44, 0xffff0000
  v_bfe_u32 v19, v17, 1, 3
  v_and_b32 v21, 1, v17
  buffer_load_dwordx4 v138, s[12:15], s36 offen offset:2048 lds
  v_lshlrev_b32 v21, 2, v21
  v_xor_b32 v19, v19, v21
  v_xor_b32 v21, v18, v19
  v_lshlrev_b32 v21, 4, v21
  v_lshl_add_u32 v0, v17, 7, v21
  s_lshl_b32 s32, s4, 10
  v_subrev_u32 v10, s32, v0
  v_and_b32 v21, 1, v17
  s_add_u32 m0, s63, 24576
  s_add_u32 s36, s62, 73728
  buffer_load_dwordx4 v136, s[12:15], s36 offen offset:0 lds
  v_mul_u32_u24 v21, 0xaaaa, v21
  v_add_u32 v21, 0x4444, v21
  v_lshl_add_u32 v10, v10, 16, v21
  v_xor_b32 v1, 64, v0
  v_lshlrev_b32 v22, 4, v17
  v_lshl_add_u32 v23, v18, 10, v22
  s_and_b32 s5, s4, 1
  s_lshl_b32 s37, s5, 9
  s_add_u32 s38, s37, 114688
  v_add_u32 v3, s38, v23
  s_sub_u32 s38, 114688, s37
  v_add_u32 v2, s38, v23
  s_lshl_b32 s37, s4, 12
  s_add_u32 s37, s37, 90112
  v_add_u32 v4, s37, v23
  s_lshl_b32 s37, s4, 11
  s_add_u32 s37, s37, 106496
  v_lshrrev_b32 v23, 1, v18
  v_lshl_add_u32 v24, v23, 10, v22
  v_lshl_add_u32 v24, v27, 3, v24
  v_add_u32 v5, s37, v24
  s_mov_b32 s7, 24576
  v_sub_u32 v24, v28, v23
  v_mul_i32_i24 v24, 15, v24
  v_and_b32 v26, 7, v17
  v_lshlrev_b32 v25, 2, v27
  v_sub_u32 v30, v26, v25
  v_add3_u32 v24, v24, v30, 19
  s_lshl_b32 s37, s4, 1
  s_and_b32 s37, s37, 0
  s_waitcnt lgkmcnt(0)
  s_mov_b32 s18, 73728
  s_mov_b32 s19, s11
  s_mul_i32 s60, s4, 0x02020000
  s_add_u32 s60, s60, 0x01000c0c
  s_add_u32 s37, s37, 24576
  v_lshl_add_u32 v144, v24, 3, s37
  v_add_u32 v145, 960, v144
  s_lshl_b32 s37, s28, 3
  v_add3_u32 v24, s37, 4, v26
  v_and_b32 v24, 0x1ff, v24
  v_mul_u32_u24 v24, 0x180, v24
  v_mul_u32_u24 v26, 196608, v28
  v_add_u32 v24, v24, v26
  v_lshl_add_u32 v24, v18, 4, v24
  s_lshr_b32 s37, s4, 1
  s_lshl_b32 s38, s37, 6
  s_add_u32 s39, s38, 256
  v_add_u32 v8, s39, v24
  s_lshl_b32 s39, s5, 7
  s_add_u32 s38, s38, s39
  v_add_u32 v7, s38, v24
  v_and_b32 v24, 16, v16
  v_lshlrev_b32 v24, 2, v24
  v_lshlrev_b32 v26, 4, v16
  v_xor_b32 v24, v24, v26
  v_accvgpr_write_b32 a228, v24
  v_add_u32 v30, v25, v20
  v_mul_u32_u24 v31, 3072, v23
  v_lshl_add_u32 v31, v29, 4, v31
  v_mad_u32_u24 v32, v30, 3, s5
  v_lshrrev_b32 v33, 1, v32
  v_xor_b32 v33, s37, v33
  v_and_b32 v33, 1, v33
  v_lshl_add_u32 v32, v32, 1, v33
  buffer_load_dwordx4 v137, s[12:15], s36 offen offset:1024 lds
  v_lshl_add_u32 v32, v32, 6, v31
  v_add_u32 v32, 114688, v32
  v_accvgpr_write_b32 a229, v32
  v_mad_u32_u24 v32, v30, 3, 2
  v_lshrrev_b32 v33, 1, v32
  v_xor_b32 v33, s37, v33
  v_and_b32 v33, 1, v33
  v_lshl_add_u32 v32, v32, 1, v33
  v_lshl_add_u32 v32, v32, 6, v31
  v_add_u32 v32, 114688, v32
  v_accvgpr_write_b32 a230, v32
  v_mul_u32_u24 v31, 3072, v18
  buffer_load_dwordx4 v138, s[12:15], s36 offen offset:2048 lds
  v_lshl_add_u32 v31, v29, 4, v31
  v_mad_u32_u24 v32, v20, 3, s5
  v_lshrrev_b32 v33, 1, v32
  v_xor_b32 v33, s37, v33
  v_and_b32 v33, 1, v33
  v_lshl_add_u32 v32, v32, 1, v33
  v_lshl_add_u32 v32, v32, 6, v31
  v_accvgpr_write_b32 a231, v32
  v_mad_u32_u24 v32, v20, 3, 2
  v_lshrrev_b32 v33, 1, v32
  v_xor_b32 v33, s37, v33
  v_and_b32 v33, 1, v33
  s_add_u32 m0, s63, 36864
  s_add_u32 s36, s62, 110592
  buffer_load_dwordx4 v136, s[12:15], s36 offen offset:0 lds
  v_lshl_add_u32 v32, v32, 1, v33
  v_lshl_add_u32 v32, v32, 6, v31
  v_accvgpr_write_b32 a232, v32
  s_mul_i32 s59, s37, 12288
  s_add_u32 s59, s59, s58
  v_cmp_gt_u32 vcc, 2, v29
  v_mov_b32 v31, 0x3f803f80
  s_mov_b32 s26, 100663296
  s_mov_b32 s27, s11
  v_cndmask_b32 v31, 0, v31, vcc
  v_accvgpr_write_b32 a240, v31
  v_accvgpr_write_b32 a241, v31
  buffer_load_dwordx4 v137, s[12:15], s36 offen offset:1024 lds
  v_accvgpr_write_b32 a242, v31
  v_accvgpr_write_b32 a243, v31
  v_lshrrev_b32 v150, 2, v16
  v_xor_b32 v151, v16, v150
  s_cmp_eq_u32 s28, 63
  s_cselect_b32 s37, 4, 0
  v_and_b32 v151, s37, v151
  v_cmp_eq_u32 vcc, 0, v151
  s_cmp_eq_u32 s29, 3
  s_cselect_b32 s37, 0xc31044fe, 0
  v_mov_b32 v150, s37
  v_mov_b32 v149, 0xc31044fe
  buffer_load_dwordx4 v138, s[12:15], s36 offen offset:2048 lds
  v_cndmask_b32 v151, 0, v150, vcc
  s_waitcnt vmcnt(12)
  s_barrier
  ds_read_b64 v[156:157], v144 offset:24
  v_cndmask_b32 v150, v149, 0, vcc
  ds_read_b64 v[158:159], v144 offset:16
  s_mov_b32 s45, 0x3fb8aa3b
  ds_read_b64 v[152:153], v144 offset:8
  s_lshl_b32 s37, s29, 3
  ds_read_b64 v[154:155], v144 offset:0
  s_lshl_b32 s38, s5, 2
  s_add_u32 m0, s63, 49152
  s_add_u32 s36, s62, 147456
  buffer_load_dwordx4 v136, s[12:15], s36 offen offset:0 lds
  s_xor_b32 s39, s38, 0
  ds_read_b64 v[160:161], v144 offset:264
  s_add_u32 s40, s39, s37
  ds_read_b64 v[162:163], v144 offset:256
  s_add_u32 s40, s40, 484
  ds_read_b64 v[164:165], v144 offset:248
  s_and_b32 s40, s40, 0x1ff
  s_mul_i32 s40, s40, 196608
  ds_read_b64 v[166:167], v144 offset:240
  s_sub_u32 s39, s39, s4
  ds_read_b64 v[172:173], v144 offset:504
  s_mul_i32 s52, s39, 196608
  buffer_load_dwordx4 v137, s[12:15], s36 offen offset:1024 lds
  ds_read_b64 v[174:175], v144 offset:496
  s_xor_b32 s39, s38, 2
  ds_read_b64 v[168:169], v144 offset:488
  s_add_u32 s41, s39, s37
  s_add_u32 s41, s41, 484
  ds_read_b64 v[170:171], v144 offset:480
  s_and_b32 s41, s41, 0x1ff
  ds_read_b64 v[176:177], v144 offset:744
  s_mul_i32 s41, s41, 196608
  ds_read_b64 v[178:179], v144 offset:736
  s_sub_u32 s39, s39, s4
  s_mul_i32 s53, s39, 196608
  buffer_load_dwordx4 v138, s[12:15], s36 offen offset:2048 lds
  ds_read_b64 v[180:181], v144 offset:728
  s_xor_b32 s39, s38, 4
  ds_read_b64 v[182:183], v144 offset:720
  s_add_u32 s42, s39, s37
  ds_read_b64 v[116:117], v144 offset:984
  s_add_u32 s42, s42, 484
  ds_read_b64 v[118:119], v144 offset:976
  s_and_b32 s42, s42, 0x1ff
  s_mul_i32 s42, s42, 196608
  ds_read_b64 v[124:125], v144 offset:968
  s_sub_u32 s39, s39, s4
  ds_read_b64 v[126:127], v144 offset:960
  s_add_u32 m0, s63, 61440
  s_add_u32 s36, s62, 184320
  buffer_load_dwordx4 v136, s[12:15], s36 offen offset:0 lds
  s_mul_i32 s54, s39, 196608
  ds_read_b64 v[120:121], v144 offset:1224
  s_xor_b32 s39, s38, 6
  s_add_u32 s43, s39, s37
  ds_read_b64 v[122:123], v144 offset:1216
  s_add_u32 s43, s43, 484
  ds_read_b64 v[128:129], v144 offset:1208
  s_and_b32 s43, s43, 0x1ff
  ds_read_b64 v[130:131], v144 offset:1200
  s_mul_i32 s43, s43, 196608
  ds_read_b64 v[132:133], v144 offset:1464
  s_sub_u32 s39, s39, s4
  buffer_load_dwordx4 v137, s[12:15], s36 offen offset:1024 lds
  s_mul_i32 s55, s39, 196608
  ds_read_b64 v[134:135], v144 offset:1456
  s_mul_i32 s34, s32, 3
  ds_read_b64 v[140:141], v144 offset:1448
  s_add_u32 s34, s34, 106496
  ds_read_b64 v[142:143], v144 offset:1440
  s_mov_b32 s35, 1
  s_mov_b32 s30, 1
  s_waitcnt vmcnt(11)
  s_barrier
  ds_read_b64_tr_b16 v[184:185], v12 offset:0
  ds_read_b64_tr_b16 v[186:187], v12 offset:512
  buffer_load_dwordx4 v138, s[12:15], s36 offen offset:2048 lds
  ds_read_b64_tr_b16 v[188:189], v13 offset:0
  ds_read_b64_tr_b16 v[190:191], v13 offset:512
  ds_read_b64_tr_b16 v[192:193], v14 offset:0
  ds_read_b64_tr_b16 v[194:195], v14 offset:512
  ds_read_b64_tr_b16 v[196:197], v12 offset:12288
  ds_read_b64_tr_b16 v[198:199], v12 offset:12800
  ds_read_b64_tr_b16 v[200:201], v13 offset:12288
  ds_read_b64_tr_b16 v[202:203], v13 offset:12800
  ds_read_b64_tr_b16 v[204:205], v14 offset:12288
  ds_read_b64_tr_b16 v[206:207], v14 offset:12800
  s_waitcnt lgkmcnt(12)
  v_perm_b32 v88, v157, v156, s60
  s_lshl_b32 m0, s3, 4
  s_nop 0
  buffer_load_dwordx4 v6, s[8:11], s48 offen offset:0 nt lds
  v_perm_b32 v89, v159, v158, s60
  v_perm_b32 v90, v153, v152, s60
  v_perm_b32 v91, v155, v154, s60
  v_perm_b32 v92, v161, v160, s60
  v_perm_b32 v93, v163, v162, s60
  v_perm_b32 v94, v165, v164, s60
  v_perm_b32 v95, v167, v166, s60
  v_perm_b32 v96, v173, v172, s60
  v_perm_b32 v97, v175, v174, s60
  v_perm_b32 v98, v169, v168, s60
  v_perm_b32 v99, v171, v170, s60
  v_perm_b32 v100, v177, v176, s60
  s_addk_i32 m0, 8064
  s_nop 0
  buffer_load_dwordx4 v6, s[8:11], s48 offen offset:128 nt lds
  v_perm_b32 v101, v179, v178, s60
  v_perm_b32 v102, v181, v180, s60
  v_perm_b32 v103, v183, v182, s60
  v_perm_b32 v104, v117, v116, s60
  v_perm_b32 v105, v119, v118, s60
  v_perm_b32 v106, v125, v124, s60
  v_perm_b32 v107, v127, v126, s60
  v_perm_b32 v108, v121, v120, s60
  v_perm_b32 v109, v123, v122, s60
  v_perm_b32 v110, v129, v128, s60
  v_perm_b32 v111, v131, v130, s60
  v_perm_b32 v112, v133, v132, s60
  s_addk_i32 m0, 8064
  s_nop 0
  buffer_load_dwordx4 v6, s[8:11], s48 offen offset:256 nt lds
  v_perm_b32 v113, v135, v134, s60
  v_perm_b32 v114, v141, v140, s60
  v_perm_b32 v115, v143, v142, s60
  s_waitcnt lgkmcnt(10)
  v_lshlrev_b32 v40, 16, v184
  v_and_b32 v41, s44, v184
  v_lshlrev_b32 v42, 16, v185
  v_and_b32 v43, s44, v185
  v_lshlrev_b32 v44, 16, v186
  v_and_b32 v45, s44, v186
  v_lshlrev_b32 v46, 16, v187
  v_and_b32 v47, s44, v187
  s_lshl_b32 m0, s3, 4
  s_addk_i32 m0, 4096
  s_nop 0
  buffer_load_dwordx4 v6, s[8:11], s49 offen offset:0 nt lds
  v_pk_mul_f32 v[40:41], v[40:41], s[46:47]
  v_pk_mul_f32 v[42:43], v[42:43], s[46:47]
  v_pk_mul_f32 v[44:45], v[44:45], s[46:47]
  v_pk_mul_f32 v[46:47], v[46:47], s[46:47]
  v_cvt_pk_bf16_f32 v184, v40, v41
  v_cvt_pk_bf16_f32 v185, v42, v43
  v_cvt_pk_bf16_f32 v186, v44, v45
  s_waitcnt lgkmcnt(0)
  v_cvt_pk_bf16_f32 v187, v46, v47
  v_lshlrev_b32 v48, 16, v188
  v_and_b32 v49, s44, v188
  v_lshlrev_b32 v50, 16, v189
  s_addk_i32 m0, 8064
  s_nop 0
  buffer_load_dwordx4 v6, s[8:11], s49 offen offset:128 nt lds
  v_and_b32 v51, s44, v189
  v_lshlrev_b32 v52, 16, v190
  v_and_b32 v53, s44, v190
  v_lshlrev_b32 v54, 16, v191
  v_and_b32 v55, s44, v191
  v_pk_mul_f32 v[48:49], v[48:49], s[46:47]
  v_pk_mul_f32 v[50:51], v[50:51], s[46:47]
  v_pk_mul_f32 v[52:53], v[52:53], s[46:47]
  v_pk_mul_f32 v[54:55], v[54:55], s[46:47]
  v_cvt_pk_bf16_f32 v188, v48, v49
  v_cvt_pk_bf16_f32 v189, v50, v51
  v_cvt_pk_bf16_f32 v190, v52, v53
  s_addk_i32 m0, 8064
  s_nop 0
  buffer_load_dwordx4 v6, s[8:11], s49 offen offset:256 nt lds
  v_cvt_pk_bf16_f32 v191, v54, v55
  v_lshlrev_b32 v56, 16, v192
  v_and_b32 v57, s44, v192
  v_lshlrev_b32 v58, 16, v193
  v_and_b32 v59, s44, v193
  v_lshlrev_b32 v60, 16, v194
  v_and_b32 v61, s44, v194
  v_lshlrev_b32 v62, 16, v195
  v_and_b32 v63, s44, v195
  v_pk_mul_f32 v[56:57], v[56:57], s[46:47]
  v_pk_mul_f32 v[58:59], v[58:59], s[46:47]
  v_pk_mul_f32 v[60:61], v[60:61], s[46:47]
  s_lshr_b32 s36, s2, 3
  s_mulk_i32 s36, 2304
  buffer_load_dword v66, v35, s[16:19], s36 offen
  v_pk_mul_f32 v[62:63], v[62:63], s[46:47]
  v_cvt_pk_bf16_f32 v192, v56, v57
  v_cvt_pk_bf16_f32 v193, v58, v59
  v_cvt_pk_bf16_f32 v194, v60, v61
  v_cvt_pk_bf16_f32 v195, v62, v63
  v_lshlrev_b32 v40, 16, v196
  v_and_b32 v41, s44, v196
  v_lshlrev_b32 v42, 16, v197
  v_and_b32 v43, s44, v197
  v_lshlrev_b32 v44, 16, v198
  v_and_b32 v45, s44, v198
  v_lshlrev_b32 v46, 16, v199
  v_and_b32 v47, s44, v199
  v_pk_mul_f32 v[40:41], v[40:41], s[46:47]
  v_pk_mul_f32 v[42:43], v[42:43], s[46:47]
  v_pk_mul_f32 v[44:45], v[44:45], s[46:47]
  v_pk_mul_f32 v[46:47], v[46:47], s[46:47]
  v_cvt_pk_bf16_f32 v196, v40, v41
  v_cvt_pk_bf16_f32 v197, v42, v43
  v_cvt_pk_bf16_f32 v198, v44, v45
  v_cvt_pk_bf16_f32 v199, v46, v47
  v_lshlrev_b32 v48, 16, v200
  v_and_b32 v49, s44, v200
  v_lshlrev_b32 v50, 16, v201
  v_and_b32 v51, s44, v201
  v_lshlrev_b32 v52, 16, v202
  v_and_b32 v53, s44, v202
  v_lshlrev_b32 v54, 16, v203
  v_and_b32 v55, s44, v203
  v_pk_mul_f32 v[48:49], v[48:49], s[46:47]
  v_pk_mul_f32 v[50:51], v[50:51], s[46:47]
  v_pk_mul_f32 v[52:53], v[52:53], s[46:47]
  v_pk_mul_f32 v[54:55], v[54:55], s[46:47]
  v_cvt_pk_bf16_f32 v200, v48, v49
  v_cvt_pk_bf16_f32 v201, v50, v51
  v_cvt_pk_bf16_f32 v202, v52, v53
  v_cvt_pk_bf16_f32 v203, v54, v55
  v_lshlrev_b32 v56, 16, v204
  v_and_b32 v57, s44, v204
  v_lshlrev_b32 v58, 16, v205
  v_and_b32 v59, s44, v205
  v_lshlrev_b32 v60, 16, v206
  v_and_b32 v61, s44, v206
  v_lshlrev_b32 v62, 16, v207
  v_and_b32 v63, s44, v207
  v_pk_mul_f32 v[56:57], v[56:57], s[46:47]
  v_pk_mul_f32 v[58:59], v[58:59], s[46:47]
  v_pk_mul_f32 v[60:61], v[60:61], s[46:47]
  v_pk_mul_f32 v[62:63], v[62:63], s[46:47]
  v_cvt_pk_bf16_f32 v204, v56, v57
  v_cvt_pk_bf16_f32 v205, v58, v59
  v_cvt_pk_bf16_f32 v206, v60, v61
  v_cvt_pk_bf16_f32 v207, v62, v63
  s_waitcnt vmcnt(13)
  s_barrier
  ds_read_b64_tr_b16 v[208:209], v12 offset:24576
  ds_read_b64_tr_b16 v[210:211], v12 offset:25088
  ds_read_b64_tr_b16 v[212:213], v13 offset:24576
  ds_read_b64_tr_b16 v[214:215], v13 offset:25088
  ds_read_b64_tr_b16 v[216:217], v14 offset:24576
  ds_read_b64_tr_b16 v[218:219], v14 offset:25088
  ds_read_b64_tr_b16 v[220:221], v12 offset:36864
  ds_read_b64_tr_b16 v[222:223], v12 offset:37376
  ds_read_b64_tr_b16 v[224:225], v13 offset:36864
  ds_read_b64_tr_b16 v[226:227], v13 offset:37376
  ds_read_b64_tr_b16 v[228:229], v14 offset:36864
  ds_read_b64_tr_b16 v[230:231], v14 offset:37376
  s_waitcnt lgkmcnt(10)
  v_lshlrev_b32 v40, 16, v208
  v_and_b32 v41, s44, v208
  v_lshlrev_b32 v42, 16, v209
  v_and_b32 v43, s44, v209
  v_lshlrev_b32 v44, 16, v210
  v_and_b32 v45, s44, v210
  v_lshlrev_b32 v46, 16, v211
  v_and_b32 v47, s44, v211
  v_pk_mul_f32 v[40:41], v[40:41], s[46:47]
  v_pk_mul_f32 v[42:43], v[42:43], s[46:47]
  v_pk_mul_f32 v[44:45], v[44:45], s[46:47]
  v_pk_mul_f32 v[46:47], v[46:47], s[46:47]
  v_cvt_pk_bf16_f32 v208, v40, v41
  v_cvt_pk_bf16_f32 v209, v42, v43
  v_cvt_pk_bf16_f32 v210, v44, v45
L_hop0:
  s_cbranch_execz L_hopped
  s_waitcnt lgkmcnt(0)
  v_cvt_pk_bf16_f32 v211, v46, v47
  v_lshlrev_b32 v48, 16, v212
  v_and_b32 v49, s44, v212
  v_lshlrev_b32 v50, 16, v213
  v_and_b32 v51, s44, v213
  v_lshlrev_b32 v52, 16, v214
  v_and_b32 v53, s44, v214
  v_lshlrev_b32 v54, 16, v215
  v_and_b32 v55, s44, v215
  v_pk_mul_f32 v[48:49], v[48:49], s[46:47]
  v_pk_mul_f32 v[50:51], v[50:51], s[46:47]
  v_pk_mul_f32 v[52:53], v[52:53], s[46:47]
  v_pk_mul_f32 v[54:55], v[54:55], s[46:47]
  v_cvt_pk_bf16_f32 v212, v48, v49
  v_cvt_pk_bf16_f32 v213, v50, v51
  v_cvt_pk_bf16_f32 v214, v52, v53
  v_cvt_pk_bf16_f32 v215, v54, v55
  v_lshlrev_b32 v56, 16, v216
  v_and_b32 v57, s44, v216
  v_lshlrev_b32 v58, 16, v217
  v_and_b32 v59, s44, v217
  v_lshlrev_b32 v60, 16, v218
  v_and_b32 v61, s44, v218
  v_lshlrev_b32 v62, 16, v219
  v_and_b32 v63, s44, v219
  v_pk_mul_f32 v[56:57], v[56:57], s[46:47]
  v_pk_mul_f32 v[58:59], v[58:59], s[46:47]
  v_pk_mul_f32 v[60:61], v[60:61], s[46:47]
  v_pk_mul_f32 v[62:63], v[62:63], s[46:47]
  v_cvt_pk_bf16_f32 v216, v56, v57
  v_cvt_pk_bf16_f32 v217, v58, v59
  v_cvt_pk_bf16_f32 v218, v60, v61
  v_cvt_pk_bf16_f32 v219, v62, v63
  v_lshlrev_b32 v40, 16, v220
  v_and_b32 v41, s44, v220
  v_lshlrev_b32 v42, 16, v221
  v_and_b32 v43, s44, v221
  v_lshlrev_b32 v44, 16, v222
  v_and_b32 v45, s44, v222
  v_lshlrev_b32 v46, 16, v223
  v_and_b32 v47, s44, v223
  v_pk_mul_f32 v[40:41], v[40:41], s[46:47]
  v_pk_mul_f32 v[42:43], v[42:43], s[46:47]
  v_pk_mul_f32 v[44:45], v[44:45], s[46:47]
  v_pk_mul_f32 v[46:47], v[46:47], s[46:47]
  v_cvt_pk_bf16_f32 v220, v40, v41
  v_cvt_pk_bf16_f32 v221, v42, v43
  v_cvt_pk_bf16_f32 v222, v44, v45
  v_cvt_pk_bf16_f32 v223, v46, v47
  v_lshlrev_b32 v48, 16, v224
  v_and_b32 v49, s44, v224
  v_lshlrev_b32 v50, 16, v225
  v_and_b32 v51, s44, v225
  v_lshlrev_b32 v52, 16, v226
  v_and_b32 v53, s44, v226
  v_lshlrev_b32 v54, 16, v227
  v_and_b32 v55, s44, v227
  v_pk_mul_f32 v[48:49], v[48:49], s[46:47]
  v_pk_mul_f32 v[50:51], v[50:51], s[46:47]
  v_pk_mul_f32 v[52:53], v[52:53], s[46:47]
  v_pk_mul_f32 v[54:55], v[54:55], s[46:47]
  v_cvt_pk_bf16_f32 v224, v48, v49
  v_cvt_pk_bf16_f32 v225, v50, v51
  v_cvt_pk_bf16_f32 v226, v52, v53
  v_cvt_pk_bf16_f32 v227, v54, v55
  v_lshlrev_b32 v56, 16, v228
  v_and_b32 v57, s44, v228
  v_lshlrev_b32 v58, 16, v229
  v_and_b32 v59, s44, v229
  v_lshlrev_b32 v60, 16, v230
  v_and_b32 v61, s44, v230
  v_lshlrev_b32 v62, 16, v231
  v_and_b32 v63, s44, v231
  s_add_u32 m0, s63, 73728
  s_add_u32 s36, s62, 384
  buffer_load_dwordx4 v136, s[12:15], s36 offen offset:0 lds
  v_pk_mul_f32 v[56:57], v[56:57], s[46:47]
  v_pk_mul_f32 v[58:59], v[58:59], s[46:47]
  v_pk_mul_f32 v[60:61], v[60:61], s[46:47]
  v_pk_mul_f32 v[62:63], v[62:63], s[46:47]
  v_cvt_pk_bf16_f32 v228, v56, v57
  v_cvt_pk_bf16_f32 v229, v58, v59
  v_cvt_pk_bf16_f32 v230, v60, v61
  v_cvt_pk_bf16_f32 v231, v62, v63
  s_waitcnt vmcnt(8)
  s_barrier
  ds_read_b64_tr_b16 v[232:233], v12 offset:49152
  ds_read_b64_tr_b16 v[234:235], v12 offset:49664
  ds_read_b64_tr_b16 v[236:237], v13 offset:49152
  ds_read_b64_tr_b16 v[238:239], v13 offset:49664
  ds_read_b64_tr_b16 v[240:241], v14 offset:49152
  ds_read_b64_tr_b16 v[242:243], v14 offset:49664
  ds_read_b64_tr_b16 v[244:245], v12 offset:61440
  ds_read_b64_tr_b16 v[246:247], v12 offset:61952
  ds_read_b64_tr_b16 v[248:249], v13 offset:61440
  ds_read_b64_tr_b16 v[250:251], v13 offset:61952
  buffer_load_dwordx4 v137, s[12:15], s36 offen offset:1024 lds
  ds_read_b64_tr_b16 v[252:253], v14 offset:61440
  ds_read_b64_tr_b16 v[254:255], v14 offset:61952
  s_waitcnt lgkmcnt(10)
  v_lshlrev_b32 v40, 16, v232
  v_and_b32 v41, s44, v232
  v_lshlrev_b32 v42, 16, v233
  v_and_b32 v43, s44, v233
  v_lshlrev_b32 v44, 16, v234
  v_and_b32 v45, s44, v234
  v_lshlrev_b32 v46, 16, v235
  v_and_b32 v47, s44, v235
  v_pk_mul_f32 v[40:41], v[40:41], s[46:47]
  v_pk_mul_f32 v[42:43], v[42:43], s[46:47]
  v_pk_mul_f32 v[44:45], v[44:45], s[46:47]
  v_pk_mul_f32 v[46:47], v[46:47], s[46:47]
  v_cvt_pk_bf16_f32 v232, v40, v41
  v_cvt_pk_bf16_f32 v233, v42, v43
  v_cvt_pk_bf16_f32 v234, v44, v45
  s_waitcnt lgkmcnt(0)
  v_cvt_pk_bf16_f32 v235, v46, v47
  buffer_load_dwordx4 v138, s[12:15], s36 offen offset:2048 lds
  v_lshlrev_b32 v48, 16, v236
  v_and_b32 v49, s44, v236
  v_lshlrev_b32 v50, 16, v237
  v_and_b32 v51, s44, v237
  v_lshlrev_b32 v52, 16, v238
  v_and_b32 v53, s44, v238
  v_lshlrev_b32 v54, 16, v239
  v_and_b32 v55, s44, v239
  v_pk_mul_f32 v[48:49], v[48:49], s[46:47]
  v_pk_mul_f32 v[50:51], v[50:51], s[46:47]
  v_pk_mul_f32 v[52:53], v[52:53], s[46:47]
  v_pk_mul_f32 v[54:55], v[54:55], s[46:47]
  v_cvt_pk_bf16_f32 v236, v48, v49
  v_cvt_pk_bf16_f32 v237, v50, v51
  v_cvt_pk_bf16_f32 v238, v52, v53
  v_cvt_pk_bf16_f32 v239, v54, v55
  v_lshlrev_b32 v56, 16, v240
  v_and_b32 v57, s44, v240
  v_lshlrev_b32 v58, 16, v241
  v_and_b32 v59, s44, v241
  s_add_u32 m0, s63, 86016
  s_add_u32 s36, s62, 37248
  buffer_load_dwordx4 v136, s[12:15], s36 offen offset:0 lds
  v_lshlrev_b32 v60, 16, v242
  v_and_b32 v61, s44, v242
  v_lshlrev_b32 v62, 16, v243
  v_and_b32 v63, s44, v243
  v_pk_mul_f32 v[56:57], v[56:57], s[46:47]
  v_pk_mul_f32 v[58:59], v[58:59], s[46:47]
  v_pk_mul_f32 v[60:61], v[60:61], s[46:47]
  v_pk_mul_f32 v[62:63], v[62:63], s[46:47]
  v_cvt_pk_bf16_f32 v240, v56, v57
  v_cvt_pk_bf16_f32 v241, v58, v59
  v_cvt_pk_bf16_f32 v242, v60, v61
  v_cvt_pk_bf16_f32 v243, v62, v63
  v_lshlrev_b32 v40, 16, v244
  v_and_b32 v41, s44, v244
  v_lshlrev_b32 v42, 16, v245
  v_and_b32 v43, s44, v245
  v_lshlrev_b32 v44, 16, v246
  v_and_b32 v45, s44, v246
  v_lshlrev_b32 v46, 16, v247
  v_and_b32 v47, s44, v247
  buffer_load_dwordx4 v137, s[12:15], s36 offen offset:1024 lds
  v_pk_mul_f32 v[40:41], v[40:41], s[46:47]
  v_pk_mul_f32 v[42:43], v[42:43], s[46:47]
  v_pk_mul_f32 v[44:45], v[44:45], s[46:47]
  v_pk_mul_f32 v[46:47], v[46:47], s[46:47]
  v_cvt_pk_bf16_f32 v244, v40, v41
  v_cvt_pk_bf16_f32 v245, v42, v43
  v_cvt_pk_bf16_f32 v246, v44, v45
  v_cvt_pk_bf16_f32 v247, v46, v47
  v_lshlrev_b32 v48, 16, v248
  v_and_b32 v49, s44, v248
  v_lshlrev_b32 v50, 16, v249
  v_and_b32 v51, s44, v249
  v_lshlrev_b32 v52, 16, v250
  v_and_b32 v53, s44, v250
  v_lshlrev_b32 v54, 16, v251
  v_and_b32 v55, s44, v251
  v_pk_mul_f32 v[48:49], v[48:49], s[46:47]
  v_pk_mul_f32 v[50:51], v[50:51], s[46:47]
  v_pk_mul_f32 v[52:53], v[52:53], s[46:47]
  v_pk_mul_f32 v[54:55], v[54:55], s[46:47]
  buffer_load_dwordx4 v138, s[12:15], s36 offen offset:2048 lds
  v_cvt_pk_bf16_f32 v248, v48, v49
  v_cvt_pk_bf16_f32 v249, v50, v51
  v_cvt_pk_bf16_f32 v250, v52, v53
  v_cvt_pk_bf16_f32 v251, v54, v55
  v_lshlrev_b32 v56, 16, v252
  v_and_b32 v57, s44, v252
  v_lshlrev_b32 v58, 16, v253
  v_and_b32 v59, s44, v253
  v_lshlrev_b32 v60, 16, v254
  v_and_b32 v61, s44, v254
  v_lshlrev_b32 v62, 16, v255
  v_and_b32 v63, s44, v255
  v_pk_mul_f32 v[56:57], v[56:57], s[46:47]
  v_pk_mul_f32 v[58:59], v[58:59], s[46:47]
  v_pk_mul_f32 v[60:61], v[60:61], s[46:47]
  v_pk_mul_f32 v[62:63], v[62:63], s[46:47]
  v_cvt_pk_bf16_f32 v252, v56, v57
  v_cvt_pk_bf16_f32 v253, v58, v59
  v_cvt_pk_bf16_f32 v254, v60, v61
  v_cvt_pk_bf16_f32 v255, v62, v63
  s_lshl3_add_u32 s48, s29, s4
  s_add_u32 s48, s48, 4
  s_mul_i32 s48, s48, 196608
  s_add_u32 s49, s48, 786432
  s_add_u32 s50, s48, 100663296
  s_mov_b32 s10, 95158272
  s_waitcnt vmcnt(10)
  s_barrier
  ds_read_b128 a[144:147], v0 offset:0
  ds_read_b128 a[148:151], v1 offset:0
  ds_read_b128 a[152:155], v0 offset:8192
  ds_read_b128 a[156:159], v1 offset:8192
  ds_read_b128 a[160:163], v0 offset:16384
  ds_read_b128 a[164:167], v1 offset:16384
  s_waitcnt lgkmcnt(4)
  v_mfma_f32_16x16x32_bf16 v[164:167], v[184:187], a[144:147], 0
  v_mfma_f32_16x16x32_bf16 v[164:167], v[196:199], a[148:151], v[164:167]
  s_waitcnt lgkmcnt(0)
  v_mfma_f32_16x16x32_bf16 v[164:167], v[208:211], a[152:155], v[164:167]
  s_add_u32 m0, s63, 98304
  s_add_u32 s36, s62, 74112
  v_mfma_f32_16x16x32_bf16 v[164:167], v[220:223], a[156:159], v[164:167]
  buffer_load_dwordx4 v136, s[12:15], s36 offen offset:0 lds
  v_mfma_f32_16x16x32_bf16 v[164:167], v[232:235], a[160:163], v[164:167]
  v_fma_f32 v88, v88, s45, v150
  v_fma_f32 v89, v89, s45, v150
  v_mfma_f32_16x16x32_bf16 v[164:167], v[244:247], a[164:167], v[164:167]
  ds_read_b128 a[168:171], v0 offset:2048
  ds_read_b128 a[172:175], v1 offset:2048
  v_mfma_f32_16x16x32_bf16 v[172:175], v[248:251], a[164:167], 0
  ds_read_b128 a[176:179], v0 offset:10240
  ds_read_b128 a[180:183], v1 offset:10240
  v_mfma_f32_16x16x32_bf16 v[172:175], v[236:239], a[160:163], v[172:175]
  ds_read_b128 a[184:187], v0 offset:18432
  ds_read_b128 a[188:191], v1 offset:18432
  v_mfma_f32_16x16x32_bf16 v[172:175], v[224:227], a[156:159], v[172:175]
  v_cvt_pk_bf16_f32 v40, v164, v165
  v_cvt_pk_bf16_f32 v41, v166, v167
  v_mfma_f32_16x16x32_bf16 v[172:175], v[212:215], a[152:155], v[172:175]
  buffer_load_dwordx4 v137, s[12:15], s36 offen offset:1024 lds
  v_mfma_f32_16x16x32_bf16 v[172:175], v[200:203], a[148:151], v[172:175]
  buffer_load_dwordx4 v138, s[12:15], s36 offen offset:2048 lds
  v_mfma_f32_16x16x32_bf16 v[172:175], v[188:191], a[144:147], v[172:175]
  v_fma_f32 v90, v90, s45, v150
  v_fma_f32 v91, v91, s45, v150
  v_mfma_f32_16x16x32_bf16 v[164:167], v[192:195], a[144:147], 0
  s_add_u32 m0, s63, 110592
  s_add_u32 s36, s62, 110976
  v_mfma_f32_16x16x32_bf16 v[164:167], v[204:207], a[148:151], v[164:167]
  buffer_load_dwordx4 v136, s[12:15], s36 offen offset:0 lds
  v_mfma_f32_16x16x32_bf16 v[164:167], v[216:219], a[152:155], v[164:167]
  v_cvt_pk_bf16_f32 v42, v172, v173
  v_cvt_pk_bf16_f32 v43, v174, v175
  v_mfma_f32_16x16x32_bf16 v[164:167], v[228:231], a[156:159], v[164:167]
  v_fma_f32 v92, v92, s45, v150
  v_fma_f32 v93, v93, s45, v150
  v_mfma_f32_16x16x32_bf16 v[164:167], v[240:243], a[160:163], v[164:167]
  v_fma_f32 v94, v94, s45, v150
  v_fma_f32 v95, v95, s45, v150
  v_mfma_f32_16x16x32_bf16 v[164:167], v[252:255], a[164:167], v[164:167]
  s_waitcnt lgkmcnt(0)
  v_fma_f32 v96, v96, s45, v150
  v_mfma_f32_16x16x32_bf16 v[172:175], v[184:187], a[168:171], 0
  buffer_load_dwordx4 v137, s[12:15], s36 offen offset:1024 lds
  v_mfma_f32_16x16x32_bf16 v[172:175], v[196:199], a[172:175], v[172:175]
  s_waitcnt vmcnt(12)
  s_barrier
  v_mfma_f32_16x16x32_bf16 v[172:175], v[208:211], a[176:179], v[172:175]
  v_cvt_pk_bf16_f32 v44, v164, v165
  v_cvt_pk_bf16_f32 v45, v166, v167
  v_mfma_f32_16x16x32_bf16 v[172:175], v[220:223], a[180:183], v[172:175]
  ds_read_b128 a[192:195], v0 offset:4096
  ds_read_b128 a[196:199], v1 offset:4096
  v_mfma_f32_16x16x32_bf16 v[172:175], v[232:235], a[184:187], v[172:175]
  ds_read_b128 a[200:203], v0 offset:12288
  ds_read_b128 a[204:207], v1 offset:12288
  v_mfma_f32_16x16x32_bf16 v[172:175], v[244:247], a[188:191], v[172:175]
  ds_read_b128 a[208:211], v0 offset:20480
  ds_read_b128 a[212:215], v1 offset:20480
  v_mfma_f32_16x16x32_bf16 v[164:167], v[248:251], a[188:191], 0
  buffer_load_dwordx4 v138, s[12:15], s36 offen offset:2048 lds
  v_mfma_f32_16x16x32_bf16 v[164:167], v[236:239], a[184:187], v[164:167]
  s_add_u32 m0, s63, 0
  s_add_u32 s36, s62, 147840
  v_mfma_f32_16x16x32_bf16 v[164:167], v[224:227], a[180:183], v[164:167]
  v_cvt_pk_bf16_f32 v52, v172, v173
  v_cvt_pk_bf16_f32 v53, v174, v175
  v_mfma_f32_16x16x32_bf16 v[164:167], v[212:215], a[176:179], v[164:167]
  buffer_load_dwordx4 v136, s[12:15], s36 offen offset:0 lds
  v_mfma_f32_16x16x32_bf16 v[164:167], v[200:203], a[172:175], v[164:167]
  v_fma_f32 v97, v97, s45, v150
  v_fma_f32 v98, v98, s45, v150
  v_mfma_f32_16x16x32_bf16 v[164:167], v[188:191], a[168:171], v[164:167]
  v_fma_f32 v99, v99, s45, v150
  v_fma_f32 v100, v100, s45, v150
  v_mfma_f32_16x16x32_bf16 v[172:175], v[192:195], a[168:171], 0
  buffer_load_dwordx4 v137, s[12:15], s36 offen offset:1024 lds
  v_mfma_f32_16x16x32_bf16 v[172:175], v[204:207], a[172:175], v[172:175]
  v_fma_f32 v101, v101, s45, v150
  v_fma_f32 v102, v102, s45, v150
  v_mfma_f32_16x16x32_bf16 v[172:175], v[216:219], a[176:179], v[172:175]
  v_cvt_pk_bf16_f32 v54, v164, v165
  v_cvt_pk_bf16_f32 v55, v166, v167
  v_mfma_f32_16x16x32_bf16 v[172:175], v[228:231], a[180:183], v[172:175]
  v_fma_f32 v103, v103, s45, v150
  v_fma_f32 v104, v104, s45, v150
  v_mfma_f32_16x16x32_bf16 v[172:175], v[240:243], a[184:187], v[172:175]
  buffer_load_dwordx4 v138, s[12:15], s36 offen offset:2048 lds
  v_mfma_f32_16x16x32_bf16 v[172:175], v[252:255], a[188:191], v[172:175]
  s_waitcnt lgkmcnt(0)
  v_fma_f32 v105, v105, s45, v150
  v_mfma_f32_16x16x32_bf16 v[164:167], v[184:187], a[192:195], 0
  v_fma_f32 v106, v106, s45, v150
  v_fma_f32 v107, v107, s45, v150
  v_mfma_f32_16x16x32_bf16 v[164:167], v[196:199], a[196:199], v[164:167]
  v_fma_f32 v108, v108, s45, v150
  v_fma_f32 v109, v109, s45, v150
  v_mfma_f32_16x16x32_bf16 v[164:167], v[208:211], a[200:203], v[164:167]
  v_cvt_pk_bf16_f32 v56, v172, v173
  v_cvt_pk_bf16_f32 v57, v174, v175
  v_mfma_f32_16x16x32_bf16 v[164:167], v[220:223], a[204:207], v[164:167]
  ds_read_b128 a[216:219], v0 offset:6144
  ds_read_b128 a[220:223], v1 offset:6144
  v_mfma_f32_16x16x32_bf16 v[164:167], v[232:235], a[208:211], v[164:167]
  ds_read_b128 a[224:227], v0 offset:14336
  ds_read_b128 a[244:247], v1 offset:14336
  v_mfma_f32_16x16x32_bf16 v[164:167], v[244:247], a[212:215], v[164:167]
  ds_read_b128 a[248:251], v0 offset:22528
  ds_read_b128 a[252:255], v1 offset:22528
  v_mfma_f32_16x16x32_bf16 v[172:175], v[248:251], a[212:215], 0
  s_add_u32 m0, s63, 12288
  s_add_u32 s36, s62, 184704
  v_mfma_f32_16x16x32_bf16 v[172:175], v[236:239], a[208:211], v[172:175]
  buffer_load_dwordx4 v136, s[12:15], s36 offen offset:0 lds
  v_mfma_f32_16x16x32_bf16 v[172:175], v[224:227], a[204:207], v[172:175]
  v_cvt_pk_bf16_f32 v64, v164, v165
  v_cvt_pk_bf16_f32 v65, v166, v167
  v_mfma_f32_16x16x32_bf16 v[172:175], v[212:215], a[200:203], v[172:175]
  s_waitcnt vmcnt(10)
  s_barrier
  v_mfma_f32_16x16x32_bf16 v[172:175], v[200:203], a[196:199], v[172:175]
  buffer_load_dwordx4 v137, s[12:15], s36 offen offset:1024 lds
  v_mfma_f32_16x16x32_bf16 v[172:175], v[188:191], a[192:195], v[172:175]
  buffer_load_dwordx4 v138, s[12:15], s36 offen offset:2048 lds
  v_mfma_f32_16x16x32_bf16 v[164:167], v[192:195], a[192:195], 0
  ds_read_b64_tr_b16 a[0:1], v15 offset:0
  ds_read_b64_tr_b16 a[2:3], v15 offset:512
  v_mfma_f32_16x16x32_bf16 v[164:167], v[204:207], a[196:199], v[164:167]
  s_add_u32 m0, s63, 24576
  s_add_u32 s36, s62, 768
  v_mfma_f32_16x16x32_bf16 v[164:167], v[216:219], a[200:203], v[164:167]
  v_cvt_pk_bf16_f32 v66, v172, v173
  v_cvt_pk_bf16_f32 v67, v174, v175
  v_mfma_f32_16x16x32_bf16 v[164:167], v[228:231], a[204:207], v[164:167]
  buffer_load_dwordx4 v136, s[12:15], s36 offen offset:0 lds
  v_mfma_f32_16x16x32_bf16 v[164:167], v[240:243], a[208:211], v[164:167]
  ds_read_b64_tr_b16 a[4:5], v9 offset:0
  ds_read_b64_tr_b16 a[6:7], v9 offset:512
  v_mfma_f32_16x16x32_bf16 v[164:167], v[252:255], a[212:215], v[164:167]
  s_waitcnt lgkmcnt(4)
  ds_read_b64_tr_b16 a[8:9], v11 offset:0
  v_mfma_f32_16x16x32_bf16 v[172:175], v[184:187], a[216:219], 0
  ds_read_b64_tr_b16 a[10:11], v11 offset:512
  ds_read_b64_tr_b16 a[12:13], v15 offset:12288
  v_mfma_f32_16x16x32_bf16 v[172:175], v[196:199], a[220:223], v[172:175]
  buffer_load_dwordx4 v137, s[12:15], s36 offen offset:1024 lds
  v_mfma_f32_16x16x32_bf16 v[172:175], v[208:211], a[224:227], v[172:175]
  v_cvt_pk_bf16_f32 v68, v164, v165
  v_cvt_pk_bf16_f32 v69, v166, v167
  v_mfma_f32_16x16x32_bf16 v[172:175], v[220:223], a[244:247], v[172:175]
  ds_read_b64_tr_b16 a[14:15], v15 offset:12800
  ds_read_b64_tr_b16 a[16:17], v9 offset:12288
  v_mfma_f32_16x16x32_bf16 v[172:175], v[232:235], a[248:251], v[172:175]
  ds_read_b64_tr_b16 a[18:19], v9 offset:12800
  ds_read_b64_tr_b16 a[20:21], v11 offset:12288
  v_mfma_f32_16x16x32_bf16 v[172:175], v[244:247], a[252:255], v[172:175]
  buffer_load_dwordx4 v138, s[12:15], s36 offen offset:2048 lds
  v_mfma_f32_16x16x32_bf16 v[164:167], v[248:251], a[252:255], 0
  ds_read_b64_tr_b16 a[22:23], v11 offset:12800
  v_fma_f32 v110, v110, s45, v150
  v_mfma_f32_16x16x32_bf16 v[164:167], v[236:239], a[248:251], v[164:167]
  v_fma_f32 v111, v111, s45, v150
  v_fma_f32 v112, v112, s45, v150
  v_mfma_f32_16x16x32_bf16 v[164:167], v[224:227], a[244:247], v[164:167]
  v_cvt_pk_bf16_f32 v70, v172, v173
  v_cvt_pk_bf16_f32 v71, v174, v175
  v_mfma_f32_16x16x32_bf16 v[164:167], v[212:215], a[224:227], v[164:167]
  s_add_u32 m0, s63, 36864
  s_add_u32 s36, s62, 37632
  v_mfma_f32_16x16x32_bf16 v[164:167], v[200:203], a[220:223], v[164:167]
  buffer_load_dwordx4 v136, s[12:15], s36 offen offset:0 lds
  v_mfma_f32_16x16x32_bf16 v[164:167], v[188:191], a[216:219], v[164:167]
  v_fma_f32 v113, v113, s45, v150
  v_fma_f32 v114, v114, s45, v150
  v_mfma_f32_16x16x32_bf16 v[172:175], v[192:195], a[216:219], 0
  v_fma_f32 v115, v115, s45, v150
  v_add_f32 v156, v151, v112
  v_mfma_f32_16x16x32_bf16 v[172:175], v[204:207], a[220:223], v[172:175]
  v_add_f32 v157, v151, v113
  v_add_f32 v158, v151, v114
  v_mfma_f32_16x16x32_bf16 v[172:175], v[216:219], a[224:227], v[172:175]
  v_cvt_pk_bf16_f32 v72, v164, v165
  v_cvt_pk_bf16_f32 v73, v166, v167
  v_mfma_f32_16x16x32_bf16 v[172:175], v[228:231], a[244:247], v[172:175]
  buffer_load_dwordx4 v137, s[12:15], s36 offen offset:1024 lds
  v_mfma_f32_16x16x32_bf16 v[172:175], v[240:243], a[248:251], v[172:175]
  s_waitcnt lgkmcnt(0)
  s_waitcnt vmcnt(11)
  s_barrier
  v_mfma_f32_16x16x32_bf16 v[172:175], v[252:255], a[252:255], v[172:175]
  ds_read_b64_tr_b16 a[24:25], v15 offset:24576
  v_mfma_f32_16x16x32_bf16 v[116:119], a[0:3], a[144:147], 0
  buffer_load_dwordx4 v138, s[12:15], s36 offen offset:2048 lds
  v_mfma_f32_16x16x32_bf16 v[116:119], a[12:15], a[148:151], v[116:119]
  ds_read_b64_tr_b16 a[26:27], v15 offset:25088
  ds_read_b64_tr_b16 a[28:29], v9 offset:24576
  v_mfma_f32_16x16x32_bf16 v[124:127], a[16:19], a[148:151], 0
  v_cvt_pk_bf16_f32 v74, v172, v173
  v_cvt_pk_bf16_f32 v75, v174, v175
  v_mfma_f32_16x16x32_bf16 v[124:127], a[4:7], a[144:147], v[124:127]
  s_add_u32 m0, s63, 49152
  s_add_u32 s36, s62, 74496
  v_mfma_f32_16x16x32_bf16 v[120:123], a[8:11], a[144:147], 0
  buffer_load_dwordx4 v136, s[12:15], s36 offen offset:0 lds
  v_mfma_f32_16x16x32_bf16 v[120:123], a[20:23], a[148:151], v[120:123]
  ds_read_b64_tr_b16 a[30:31], v9 offset:25088
  ds_read_b64_tr_b16 a[32:33], v11 offset:24576
  v_mfma_f32_16x16x32_bf16 v[128:131], a[0:3], a[168:171], 0
  ds_read_b64_tr_b16 a[34:35], v11 offset:25088
  ds_read_b64_tr_b16 a[36:37], v15 offset:36864
  v_mfma_f32_16x16x32_bf16 v[128:131], a[12:15], a[172:175], v[128:131]
  ds_read_b64_tr_b16 a[38:39], v15 offset:37376
  ds_read_b64_tr_b16 a[40:41], v9 offset:36864
  v_mfma_f32_16x16x32_bf16 v[132:135], a[16:19], a[172:175], 0
  buffer_load_dwordx4 v137, s[12:15], s36 offen offset:1024 lds
  v_mfma_f32_16x16x32_bf16 v[132:135], a[4:7], a[168:171], v[132:135]
  ds_read_b64_tr_b16 a[42:43], v9 offset:37376
  ds_read_b64_tr_b16 a[44:45], v11 offset:36864
  v_mfma_f32_16x16x32_bf16 v[140:143], a[8:11], a[168:171], 0
  ds_read_b64_tr_b16 a[46:47], v11 offset:37376
  v_add_f32 v159, v151, v115
  v_mfma_f32_16x16x32_bf16 v[140:143], a[20:23], a[172:175], v[140:143]
  v_add_f32 v160, v151, v108
  v_add_f32 v161, v151, v109
  v_mfma_f32_16x16x32_bf16 v[16:19], a[0:3], a[192:195], 0
  v_add_f32 v162, v151, v110
  v_add_f32 v163, v151, v111
  v_mfma_f32_16x16x32_bf16 v[16:19], a[12:15], a[196:199], v[16:19]
  buffer_load_dwordx4 v138, s[12:15], s36 offen offset:2048 lds
  v_mfma_f32_16x16x32_bf16 v[20:23], a[16:19], a[196:199], 0
  v_add_f32 v180, v151, v104
  v_add_f32 v181, v151, v105
  v_mfma_f32_16x16x32_bf16 v[20:23], a[4:7], a[192:195], v[20:23]
  v_add_f32 v182, v151, v106
  v_add_f32 v183, v151, v107
  v_mfma_f32_16x16x32_bf16 v[24:27], a[8:11], a[192:195], 0
  s_add_u32 m0, s63, 61440
  s_add_u32 s36, s62, 111360
  v_mfma_f32_16x16x32_bf16 v[24:27], a[20:23], a[196:199], v[24:27]
  buffer_load_dwordx4 v136, s[12:15], s36 offen offset:0 lds
  v_mfma_f32_16x16x32_bf16 v[28:31], a[0:3], a[216:219], 0
  v_add_f32 v152, v151, v96
  v_add_f32 v153, v151, v97
  v_mfma_f32_16x16x32_bf16 v[28:31], a[12:15], a[220:223], v[28:31]
  v_add_f32 v154, v151, v98
  v_add_f32 v155, v151, v99
  v_mfma_f32_16x16x32_bf16 v[32:35], a[16:19], a[220:223], 0
  v_add_f32 v168, v151, v92
  v_add_f32 v169, v151, v93
  v_mfma_f32_16x16x32_bf16 v[32:35], a[4:7], a[216:219], v[32:35]
  buffer_load_dwordx4 v137, s[12:15], s36 offen offset:1024 lds
  v_mfma_f32_16x16x32_bf16 v[36:39], a[8:11], a[216:219], 0
  v_add_f32 v170, v151, v94
  v_add_f32 v171, v151, v95
  v_mfma_f32_16x16x32_bf16 v[36:39], a[20:23], a[220:223], v[36:39]
  s_waitcnt lgkmcnt(0)
  v_add_f32 v176, v151, v88
  v_mfma_f32_16x16x32_bf16 v[116:119], a[24:27], a[152:155], v[116:119]
  s_waitcnt vmcnt(11)
  s_barrier
  v_mfma_f32_16x16x32_bf16 v[116:119], a[36:39], a[156:159], v[116:119]
  buffer_load_dwordx4 v138, s[12:15], s36 offen offset:2048 lds
  v_mfma_f32_16x16x32_bf16 v[124:127], a[40:43], a[156:159], v[124:127]
  ds_read_b64_tr_b16 a[48:49], v12 offset:0
  ds_read_b64_tr_b16 a[50:51], v12 offset:512
  v_mfma_f32_16x16x32_bf16 v[124:127], a[28:31], a[152:155], v[124:127]
  ds_read_b64_tr_b16 a[52:53], v13 offset:0
  ds_read_b64_tr_b16 a[54:55], v13 offset:512
  v_mfma_f32_16x16x32_bf16 v[120:123], a[32:35], a[152:155], v[120:123]
  s_add_u32 m0, s63, 73728
  s_add_u32 s36, s62, 148224
  v_mfma_f32_16x16x32_bf16 v[120:123], a[44:47], a[156:159], v[120:123]
  buffer_load_dwordx4 v136, s[12:15], s36 offen offset:0 lds
  v_mfma_f32_16x16x32_bf16 v[128:131], a[24:27], a[176:179], v[128:131]
  ds_read_b64_tr_b16 a[56:57], v14 offset:0
  ds_read_b64_tr_b16 a[58:59], v14 offset:512
  v_mfma_f32_16x16x32_bf16 v[128:131], a[36:39], a[180:183], v[128:131]
  ds_read_b64_tr_b16 a[60:61], v12 offset:12288
  ds_read_b64_tr_b16 a[62:63], v12 offset:12800
  v_mfma_f32_16x16x32_bf16 v[132:135], a[40:43], a[180:183], v[132:135]
  ds_read_b64_tr_b16 a[64:65], v13 offset:12288
  ds_read_b64_tr_b16 a[66:67], v13 offset:12800
  v_mfma_f32_16x16x32_bf16 v[132:135], a[28:31], a[176:179], v[132:135]
  ds_read_b64_tr_b16 a[68:69], v14 offset:12288
  ds_read_b64_tr_b16 a[70:71], v14 offset:12800
  v_mfma_f32_16x16x32_bf16 v[140:143], a[32:35], a[176:179], v[140:143]
  buffer_load_dwordx4 v137, s[12:15], s36 offen offset:1024 lds
  v_mfma_f32_16x16x32_bf16 v[140:143], a[44:47], a[180:183], v[140:143]
  v_add_f32 v177, v151, v89
  v_add_f32 v178, v151, v90
  v_mfma_f32_16x16x32_bf16 v[16:19], a[24:27], a[200:203], v[16:19]
  v_add_f32 v179, v151, v91
  s_and_b32 s38, s28, -2
  v_mfma_f32_16x16x32_bf16 v[16:19], a[36:39], a[204:207], v[16:19]
  s_min_u32 s38, s38, 60
  s_lshl_b32 s37, s38, 1
  v_mfma_f32_16x16x32_bf16 v[20:23], a[40:43], a[204:207], v[20:23]
  buffer_load_dwordx4 v138, s[12:15], s36 offen offset:2048 lds
  v_mfma_f32_16x16x32_bf16 v[20:23], a[28:31], a[200:203], v[20:23]
  s_mov_b32 s22, 4
  s_add_u32 s46, s4, 68
  v_mfma_f32_16x16x32_bf16 v[24:27], a[32:35], a[200:203], v[24:27]
  s_mul_i32 s46, s46, 196608
  s_mov_b32 s47, 24576
  v_mfma_f32_16x16x32_bf16 v[24:27], a[44:47], a[204:207], v[24:27]
  s_add_u32 m0, s63, 86016
  s_add_u32 s36, s62, 185088
  v_mfma_f32_16x16x32_bf16 v[28:31], a[24:27], a[224:227], v[28:31]
  buffer_load_dwordx4 v136, s[12:15], s36 offen offset:0 lds
  v_mfma_f32_16x16x32_bf16 v[28:31], a[36:39], a[244:247], v[28:31]
  v_mfma_f32_16x16x32_bf16 v[32:35], a[40:43], a[244:247], v[32:35]
  s_waitcnt lgkmcnt(0)
  s_waitcnt vmcnt(10)
  s_barrier
  v_mfma_f32_16x16x32_bf16 v[32:35], a[28:31], a[224:227], v[32:35]
  ds_read_b64_tr_b16 a[72:73], v12 offset:24576
  ds_read_b64_tr_b16 a[74:75], v12 offset:25088
  v_mfma_f32_16x16x32_bf16 v[36:39], a[32:35], a[224:227], v[36:39]
  buffer_load_dwordx4 v137, s[12:15], s36 offen offset:1024 lds
  v_mfma_f32_16x16x32_bf16 v[36:39], a[44:47], a[244:247], v[36:39]
  ds_read_b64_tr_b16 a[76:77], v13 offset:24576
  v_mfma_f32_16x16x32_bf16 v[116:119], a[48:51], a[160:163], v[116:119]
  ds_read_b64_tr_b16 a[78:79], v13 offset:25088
  ds_read_b64_tr_b16 a[80:81], v14 offset:24576
  v_mfma_f32_16x16x32_bf16 v[116:119], a[60:63], a[164:167], v[116:119]
  ds_read_b64_tr_b16 a[82:83], v14 offset:25088
  ds_read_b64_tr_b16 a[84:85], v12 offset:36864
  v_mfma_f32_16x16x32_bf16 v[124:127], a[64:67], a[164:167], v[124:127]
  buffer_load_dwordx4 v138, s[12:15], s36 offen offset:2048 lds
  v_mfma_f32_16x16x32_bf16 v[124:127], a[52:55], a[160:163], v[124:127]
  ds_read_b64_tr_b16 a[86:87], v12 offset:37376
  ds_read_b64_tr_b16 a[88:89], v13 offset:36864
  v_mfma_f32_16x16x32_bf16 v[120:123], a[56:59], a[160:163], v[120:123]
  v_cvt_pk_bf16_f32 v46, v116, v117
  v_cvt_pk_bf16_f32 v47, v118, v119
  v_mfma_f32_16x16x32_bf16 v[120:123], a[68:71], a[164:167], v[120:123]
  s_add_u32 m0, s32, 40960
  ds_read_b64_tr_b16 a[90:91], v13 offset:37376
  v_mfma_f32_16x16x32_bf16 v[128:131], a[48:51], a[184:187], v[128:131]
  v_cvt_pk_bf16_f32 v48, v124, v125
  v_cvt_pk_bf16_f32 v49, v126, v127
  v_mfma_f32_16x16x32_bf16 v[128:131], a[60:63], a[188:191], v[128:131]
  buffer_load_dwordx4 v6, s[8:11], s48 offen offset:0 nt lds
  v_mfma_f32_16x16x32_bf16 v[132:135], a[64:67], a[188:191], v[132:135]
  v_cvt_pk_bf16_f32 v50, v120, v121
  v_cvt_pk_bf16_f32 v51, v122, v123
  v_mfma_f32_16x16x32_bf16 v[132:135], a[52:55], a[184:187], v[132:135]
  s_add_u32 m0, s32, 49024
  ds_read_b64_tr_b16 a[92:93], v14 offset:36864
  v_mfma_f32_16x16x32_bf16 v[140:143], a[56:59], a[184:187], v[140:143]
  v_cvt_pk_bf16_f32 v58, v128, v129
  v_cvt_pk_bf16_f32 v59, v130, v131
  v_mfma_f32_16x16x32_bf16 v[140:143], a[68:71], a[188:191], v[140:143]
  buffer_load_dwordx4 v6, s[8:11], s48 offen offset:128 nt lds
  v_mfma_f32_16x16x32_bf16 v[16:19], a[48:51], a[208:211], v[16:19]
  v_cvt_pk_bf16_f32 v60, v132, v133
  v_cvt_pk_bf16_f32 v61, v134, v135
  v_mfma_f32_16x16x32_bf16 v[16:19], a[60:63], a[212:215], v[16:19]
  s_add_u32 m0, s32, 57088
  ds_read_b64_tr_b16 a[94:95], v14 offset:37376
L_hop1:
  s_cbranch_execz L_hopped
  v_mfma_f32_16x16x32_bf16 v[20:23], a[64:67], a[212:215], v[20:23]
  v_cvt_pk_bf16_f32 v62, v140, v141
  v_cvt_pk_bf16_f32 v63, v142, v143
  v_mfma_f32_16x16x32_bf16 v[20:23], a[52:55], a[208:211], v[20:23]
  buffer_load_dwordx4 v6, s[8:11], s48 offen offset:256 nt lds
  v_mfma_f32_16x16x32_bf16 v[24:27], a[56:59], a[208:211], v[24:27]
  v_cvt_pk_bf16_f32 v76, v16, v17
  v_cvt_pk_bf16_f32 v77, v18, v19
  v_mfma_f32_16x16x32_bf16 v[24:27], a[68:71], a[212:215], v[24:27]
  s_add_u32 m0, s32, 45056
  v_mfma_f32_16x16x32_bf16 v[28:31], a[48:51], a[248:251], v[28:31]
  v_cvt_pk_bf16_f32 v78, v20, v21
  v_cvt_pk_bf16_f32 v79, v22, v23
  v_mfma_f32_16x16x32_bf16 v[28:31], a[60:63], a[252:255], v[28:31]
  s_waitcnt lgkmcnt(0)
  s_waitcnt vmcnt(9)
  s_barrier
  v_mfma_f32_16x16x32_bf16 v[32:35], a[64:67], a[252:255], v[32:35]
  v_cvt_pk_bf16_f32 v80, v24, v25
  v_cvt_pk_bf16_f32 v81, v26, v27
  v_mfma_f32_16x16x32_bf16 v[32:35], a[52:55], a[248:251], v[32:35]
  buffer_load_dwordx4 v6, s[8:11], s49 offen offset:0 nt lds
  v_mfma_f32_16x16x32_bf16 v[36:39], a[56:59], a[248:251], v[36:39]
  v_cvt_pk_bf16_f32 v82, v28, v29
  v_cvt_pk_bf16_f32 v83, v30, v31
  v_mfma_f32_16x16x32_bf16 v[36:39], a[68:71], a[252:255], v[36:39]
  s_add_u32 m0, s32, 53120
  ds_read_b64_tr_b16 a[96:97], v12 offset:49152
  v_mfma_f32_16x16x32_bf16 v[116:119], v[46:49], v[70:73], v[156:159]
  v_cvt_pk_bf16_f32 v84, v32, v33
  v_cvt_pk_bf16_f32 v85, v34, v35
  v_mfma_f32_16x16x32_bf16 v[124:127], v[58:61], v[70:73], v[160:163]
  buffer_load_dwordx4 v6, s[8:11], s49 offen offset:128 nt lds
  v_mfma_f32_16x16x32_bf16 v[120:123], v[76:79], v[70:73], v[104:107]
  v_cvt_pk_bf16_f32 v86, v36, v37
  v_cvt_pk_bf16_f32 v87, v38, v39
  v_mfma_f32_16x16x32_bf16 v[128:131], v[82:85], v[70:73], v[100:103]
  s_add_u32 m0, s32, 61184
  ds_read_b64_tr_b16 a[98:99], v12 offset:49664
  v_mfma_f32_16x16x16_bf16 v[116:119], v[50:51], v[74:75], v[116:119]
  s_cmp_lg_u32 s31, 0
  s_cbranch_scc1 L_special0
  v_mfma_f32_16x16x16_bf16 v[124:127], v[62:63], v[74:75], v[124:127]
  buffer_load_dwordx4 v6, s[8:11], s49 offen offset:256 nt lds
  v_mfma_f32_16x16x16_bf16 v[120:123], v[80:81], v[74:75], v[120:123]
  s_add_u32 s48, s48, 6291456
  s_add_u32 s49, s48, 786432
  v_mfma_f32_16x16x16_bf16 v[128:131], v[86:87], v[74:75], v[128:131]
  s_add_u32 m0, s32, 65536
  ds_read_b64_tr_b16 a[100:101], v13 offset:49152
  v_mfma_f32_16x16x32_bf16 v[132:135], v[46:49], v[64:67], v[160:163]
  buffer_load_dwordx4 v6, s[8:11], s48 offen offset:0 nt lds
  v_mfma_f32_16x16x32_bf16 v[140:143], v[58:61], v[64:67], v[180:183]
  ds_read_b64_tr_b16 a[102:103], v13 offset:49664
  ds_read_b64_tr_b16 a[104:105], v14 offset:49152
  v_mfma_f32_16x16x32_bf16 v[136:139], v[76:79], v[64:67], v[100:103]
  ds_read_b64_tr_b16 a[106:107], v14 offset:49664
  ds_read_b64_tr_b16 a[108:109], v12 offset:61440
  v_mfma_f32_16x16x32_bf16 v[144:147], v[82:85], v[64:67], v[96:99]
  s_add_u32 m0, s32, 73600
  ds_read_b64_tr_b16 a[110:111], v12 offset:61952
  v_mfma_f32_16x16x16_bf16 v[132:135], v[50:51], v[68:69], v[132:135]
  buffer_load_dwordx4 v6, s[8:11], s48 offen offset:128 nt lds
  v_mfma_f32_16x16x16_bf16 v[140:143], v[62:63], v[68:69], v[140:143]
  ds_read_b64_tr_b16 a[112:113], v13 offset:61440
  ds_read_b64_tr_b16 a[114:115], v13 offset:61952
  v_mfma_f32_16x16x16_bf16 v[136:139], v[80:81], v[68:69], v[136:139]
  ds_read_b64_tr_b16 a[116:117], v14 offset:61440
  ds_read_b64_tr_b16 a[118:119], v14 offset:61952
  v_mfma_f32_16x16x16_bf16 v[144:147], v[86:87], v[68:69], v[144:147]
  s_add_u32 m0, s32, 81664
  v_mfma_f32_16x16x32_bf16 v[148:151], v[46:49], v[52:55], v[104:107]
  buffer_load_dwordx4 v6, s[8:11], s48 offen offset:256 nt lds
  v_mfma_f32_16x16x32_bf16 v[156:159], v[58:61], v[52:55], v[100:103]
  v_exp_f32 v116, v116
  v_mfma_f32_16x16x32_bf16 v[152:155], v[76:79], v[52:55], v[152:155]
  v_exp_f32 v117, v117
  v_mfma_f32_16x16x32_bf16 v[160:163], v[82:85], v[52:55], v[168:171]
  v_exp_f32 v118, v118
  v_mfma_f32_16x16x16_bf16 v[148:151], v[50:51], v[56:57], v[148:151]
  s_waitcnt lgkmcnt(0)
  s_waitcnt vmcnt(9)
  s_barrier
  v_mfma_f32_16x16x16_bf16 v[156:159], v[62:63], v[56:57], v[156:159]
  ds_read_b64_tr_b16 a[120:121], v15 offset:0
  ds_read_b64_tr_b16 a[122:123], v15 offset:512
  v_mfma_f32_16x16x16_bf16 v[152:155], v[80:81], v[56:57], v[152:155]
  ds_read_b64_tr_b16 a[124:125], v9 offset:0
  ds_read_b64_tr_b16 a[126:127], v9 offset:512
  v_mfma_f32_16x16x16_bf16 v[160:163], v[86:87], v[56:57], v[160:163]
  ds_read_b64_tr_b16 a[128:129], v11 offset:0
  ds_read_b64_tr_b16 a[130:131], v11 offset:512
  v_mfma_f32_16x16x32_bf16 v[164:167], v[46:49], v[40:43], v[100:103]
  ds_read_b64_tr_b16 a[132:133], v15 offset:12288
  ds_read_b64_tr_b16 a[134:135], v15 offset:12800
  v_mfma_f32_16x16x32_bf16 v[172:175], v[58:61], v[40:43], v[96:99]
  ds_read_b64_tr_b16 a[136:137], v9 offset:12288
  ds_read_b64_tr_b16 a[138:139], v9 offset:12800
  v_mfma_f32_16x16x32_bf16 v[168:171], v[76:79], v[40:43], v[168:171]
  ds_read_b64_tr_b16 a[140:141], v11 offset:12288
  ds_read_b64_tr_b16 a[142:143], v11 offset:12800
  v_mfma_f32_16x16x32_bf16 v[176:179], v[82:85], v[40:43], v[176:179]
  v_exp_f32 v119, v119
  v_mfma_f32_16x16x16_bf16 v[164:167], v[50:51], v[44:45], v[164:167]
  v_cvt_pk_bf16_f32 v116, v116, v117
  v_cvt_pk_bf16_f32 v117, v118, v119
  v_mfma_f32_16x16x16_bf16 v[172:175], v[62:63], v[44:45], v[172:175]
  v_exp_f32 v124, v124
  v_mfma_f32_16x16x16_bf16 v[168:171], v[80:81], v[44:45], v[168:171]
  v_exp_f32 v125, v125
  v_mfma_f32_16x16x16_bf16 v[176:179], v[86:87], v[44:45], v[176:179]
  v_exp_f32 v126, v126
L_enter:
  v_mfma_f32_16x16x32_bf16 v[40:43], a[144:147], a[72:75], 0
  v_exp_f32 v127, v127
  v_mfma_f32_16x16x32_bf16 v[40:43], a[148:151], a[84:87], v[40:43]
  v_cvt_pk_bf16_f32 v118, v124, v125
  v_cvt_pk_bf16_f32 v119, v126, v127
  v_mfma_f32_16x16x32_bf16 v[40:43], a[152:155], a[96:99], v[40:43]
  v_exp_f32 v120, v120
  v_mfma_f32_16x16x32_bf16 v[40:43], a[156:159], a[108:111], v[40:43]
  s_waitcnt lgkmcnt(0)
  v_mfma_f32_16x16x32_bf16 v[40:43], a[160:163], a[120:123], v[40:43]
  v_exp_f32 v121, v121
  v_mfma_f32_16x16x32_bf16 v[40:43], a[164:167], a[132:135], v[40:43]
  v_exp_f32 v122, v122
  v_mfma_f32_16x16x32_bf16 v[44:47], a[164:167], a[136:139], 0
  v_exp_f32 v123, v123
  v_mfma_f32_16x16x32_bf16 v[44:47], a[160:163], a[124:127], v[44:47]
  v_cvt_pk_bf16_f32 v120, v120, v121
  v_cvt_pk_bf16_f32 v121, v122, v123
  v_mfma_f32_16x16x32_bf16 v[44:47], a[156:159], a[112:115], v[44:47]
  v_cvt_pk_bf16_f32 v16, v40, v41
  v_cvt_pk_bf16_f32 v17, v42, v43
  v_mfma_f32_16x16x32_bf16 v[44:47], a[152:155], a[100:103], v[44:47]
  v_exp_f32 v128, v128
  v_mfma_f32_16x16x32_bf16 v[44:47], a[148:151], a[88:91], v[44:47]
  v_exp_f32 v129, v129
  v_mfma_f32_16x16x32_bf16 v[44:47], a[144:147], a[76:79], v[44:47]
  v_exp_f32 v130, v130
  v_mfma_f32_16x16x32_bf16 v[40:43], a[144:147], a[80:83], 0
  v_exp_f32 v131, v131
  v_mfma_f32_16x16x32_bf16 v[40:43], a[148:151], a[92:95], v[40:43]
  v_cvt_pk_bf16_f32 v122, v128, v129
  v_cvt_pk_bf16_f32 v123, v130, v131
  v_mfma_f32_16x16x32_bf16 v[40:43], a[152:155], a[104:107], v[40:43]
  v_cvt_pk_bf16_f32 v24, v44, v45
  v_cvt_pk_bf16_f32 v25, v46, v47
  v_mfma_f32_16x16x32_bf16 v[40:43], a[156:159], a[116:119], v[40:43]
  v_exp_f32 v132, v132
  v_mfma_f32_16x16x32_bf16 v[40:43], a[160:163], a[128:131], v[40:43]
  v_exp_f32 v133, v133
  v_mfma_f32_16x16x32_bf16 v[40:43], a[164:167], a[140:143], v[40:43]
  v_exp_f32 v134, v134
  v_mfma_f32_16x16x32_bf16 v[44:47], a[168:171], a[72:75], 0
  v_cvt_pk_bf16_f32 v132, v132, v133
  v_mfma_f32_16x16x32_bf16 v[44:47], a[172:175], a[84:87], v[44:47]
  v_exp_f32 v135, v135
  v_mfma_f32_16x16x32_bf16 v[44:47], a[176:179], a[96:99], v[44:47]
  v_cvt_pk_bf16_f32 v32, v40, v41
  v_cvt_pk_bf16_f32 v33, v42, v43
  v_mfma_f32_16x16x32_bf16 v[44:47], a[180:183], a[108:111], v[44:47]
  v_exp_f32 v140, v140
  v_mfma_f32_16x16x32_bf16 v[44:47], a[184:187], a[120:123], v[44:47]
  v_exp_f32 v141, v141
  v_mfma_f32_16x16x32_bf16 v[44:47], a[188:191], a[132:135], v[44:47]
  v_cvt_pk_bf16_f32 v133, v134, v135
  v_cvt_pk_bf16_f32 v134, v140, v141
  v_mfma_f32_16x16x32_bf16 v[40:43], a[188:191], a[136:139], 0
  v_exp_f32 v142, v142
  v_mfma_f32_16x16x32_bf16 v[40:43], a[184:187], a[124:127], v[40:43]
  v_exp_f32 v143, v143
  v_mfma_f32_16x16x32_bf16 v[40:43], a[180:183], a[112:115], v[40:43]
  v_cvt_pk_bf16_f32 v18, v44, v45
  v_cvt_pk_bf16_f32 v19, v46, v47
  v_mfma_f32_16x16x32_bf16 v[40:43], a[176:179], a[100:103], v[40:43]
  v_cvt_pk_bf16_f32 v135, v142, v143
  v_mfma_f32_16x16x32_bf16 v[40:43], a[172:175], a[88:91], v[40:43]
  v_exp_f32 v136, v136
  v_mfma_f32_16x16x32_bf16 v[40:43], a[168:171], a[76:79], v[40:43]
  v_exp_f32 v137, v137
  v_mfma_f32_16x16x32_bf16 v[44:47], a[168:171], a[80:83], 0
  v_exp_f32 v138, v138
  v_mfma_f32_16x16x32_bf16 v[44:47], a[172:175], a[92:95], v[44:47]
  v_exp_f32 v139, v139
  v_mfma_f32_16x16x32_bf16 v[44:47], a[176:179], a[104:107], v[44:47]
  v_cvt_pk_bf16_f32 v26, v40, v41
  v_cvt_pk_bf16_f32 v27, v42, v43
  v_mfma_f32_16x16x32_bf16 v[44:47], a[180:183], a[116:119], v[44:47]
  v_cvt_pk_bf16_f32 v136, v136, v137
  v_cvt_pk_bf16_f32 v137, v138, v139
  v_mfma_f32_16x16x32_bf16 v[44:47], a[184:187], a[128:131], v[44:47]
  v_exp_f32 v144, v144
  v_mfma_f32_16x16x32_bf16 v[44:47], a[188:191], a[140:143], v[44:47]
  v_exp_f32 v145, v145
  v_mfma_f32_16x16x32_bf16 v[40:43], a[192:195], a[72:75], 0
  v_exp_f32 v146, v146
  v_mfma_f32_16x16x32_bf16 v[40:43], a[196:199], a[84:87], v[40:43]
  v_exp_f32 v147, v147
  v_mfma_f32_16x16x32_bf16 v[40:43], a[200:203], a[96:99], v[40:43]
  v_cvt_pk_bf16_f32 v34, v44, v45
  v_cvt_pk_bf16_f32 v35, v46, v47
  v_mfma_f32_16x16x32_bf16 v[40:43], a[204:207], a[108:111], v[40:43]
  v_cvt_pk_bf16_f32 v138, v144, v145
  v_cvt_pk_bf16_f32 v139, v146, v147
  v_mfma_f32_16x16x32_bf16 v[40:43], a[208:211], a[120:123], v[40:43]
  v_exp_f32 v148, v148
  v_mfma_f32_16x16x32_bf16 v[40:43], a[212:215], a[132:135], v[40:43]
  v_exp_f32 v149, v149
  v_mfma_f32_16x16x32_bf16 v[44:47], a[212:215], a[136:139], 0
  v_mov_b64 v[144:145], 0
  v_cvt_pk_bf16_f32 v148, v148, v149
  v_mfma_f32_16x16x32_bf16 v[44:47], a[208:211], a[124:127], v[44:47]
  v_exp_f32 v150, v150
  v_mfma_f32_16x16x32_bf16 v[44:47], a[204:207], a[112:115], v[44:47]
  v_cvt_pk_bf16_f32 v20, v40, v41
  v_cvt_pk_bf16_f32 v21, v42, v43
  v_mfma_f32_16x16x32_bf16 v[44:47], a[200:203], a[100:103], v[44:47]
  v_exp_f32 v151, v151
  v_mfma_f32_16x16x32_bf16 v[44:47], a[196:199], a[88:91], v[44:47]
  v_exp_f32 v156, v156
  v_mfma_f32_16x16x32_bf16 v[44:47], a[192:195], a[76:79], v[44:47]
  v_exp_f32 v157, v157
  v_mfma_f32_16x16x32_bf16 v[40:43], a[192:195], a[80:83], 0
  v_cvt_pk_bf16_f32 v149, v150, v151
  v_cvt_pk_bf16_f32 v150, v156, v157
  v_mfma_f32_16x16x32_bf16 v[40:43], a[196:199], a[92:95], v[40:43]
  v_exp_f32 v158, v158
  v_mfma_f32_16x16x32_bf16 v[40:43], a[200:203], a[104:107], v[40:43]
  v_cvt_pk_bf16_f32 v28, v44, v45
  v_cvt_pk_bf16_f32 v29, v46, v47
  v_mfma_f32_16x16x32_bf16 v[40:43], a[204:207], a[116:119], v[40:43]
  v_exp_f32 v159, v159
  v_mfma_f32_16x16x32_bf16 v[40:43], a[208:211], a[128:131], v[40:43]
  v_cvt_pk_bf16_f32 v151, v158, v159
  v_mfma_f32_16x16x32_bf16 v[40:43], a[212:215], a[140:143], v[40:43]
  v_exp_f32 v152, v152
  v_mfma_f32_16x16x32_bf16 v[44:47], a[216:219], a[72:75], 0
  v_exp_f32 v153, v153
  v_mfma_f32_16x16x32_bf16 v[44:47], a[220:223], a[84:87], v[44:47]
  v_exp_f32 v154, v154
  v_mfma_f32_16x16x32_bf16 v[44:47], a[224:227], a[96:99], v[44:47]
  v_cvt_pk_bf16_f32 v36, v40, v41
  v_cvt_pk_bf16_f32 v37, v42, v43
  v_mfma_f32_16x16x32_bf16 v[44:47], a[244:247], a[108:111], v[44:47]
  v_exp_f32 v155, v155
  v_mfma_f32_16x16x32_bf16 v[44:47], a[248:251], a[120:123], v[44:47]
  v_cvt_pk_bf16_f32 v152, v152, v153
  v_cvt_pk_bf16_f32 v153, v154, v155
  v_mfma_f32_16x16x32_bf16 v[44:47], a[252:255], a[132:135], v[44:47]
  v_exp_f32 v160, v160
  v_mfma_f32_16x16x32_bf16 v[40:43], a[252:255], a[136:139], 0
  v_exp_f32 v161, v161
  v_mfma_f32_16x16x32_bf16 v[40:43], a[248:251], a[124:127], v[40:43]
  v_exp_f32 v162, v162
  v_mfma_f32_16x16x32_bf16 v[40:43], a[244:247], a[112:115], v[40:43]
  v_cvt_pk_bf16_f32 v22, v44, v45
  v_cvt_pk_bf16_f32 v23, v46, v47
  v_mfma_f32_16x16x32_bf16 v[40:43], a[224:227], a[100:103], v[40:43]
  v_exp_f32 v163, v163
  v_mfma_f32_16x16x32_bf16 v[40:43], a[220:223], a[88:91], v[40:43]
  v_cvt_pk_bf16_f32 v154, v160, v161
  v_cvt_pk_bf16_f32 v155, v162, v163
  v_mfma_f32_16x16x32_bf16 v[40:43], a[216:219], a[76:79], v[40:43]
  v_exp_f32 v164, v164
  v_mfma_f32_16x16x32_bf16 v[44:47], a[216:219], a[80:83], 0
  v_exp_f32 v165, v165
  v_mfma_f32_16x16x32_bf16 v[44:47], a[220:223], a[92:95], v[44:47]
  v_exp_f32 v166, v166
  v_mfma_f32_16x16x32_bf16 v[44:47], a[224:227], a[104:107], v[44:47]
  v_cvt_pk_bf16_f32 v30, v40, v41
  v_cvt_pk_bf16_f32 v31, v42, v43
  v_mfma_f32_16x16x32_bf16 v[44:47], a[244:247], a[116:119], v[44:47]
  v_exp_f32 v167, v167
  v_mfma_f32_16x16x32_bf16 v[44:47], a[248:251], a[128:131], v[44:47]
  v_cvt_pk_bf16_f32 v164, v164, v165
  v_cvt_pk_bf16_f32 v165, v166, v167
  v_mfma_f32_16x16x32_bf16 v[44:47], a[252:255], a[140:143], v[44:47]
  v_exp_f32 v172, v172
  s_add_u32 s32, s32, 40960
  v_mad_i32_i16 v0, v10, 1, s32 op_sel:[1,0,0,0]
  v_xor_b32 v1, 64, v0
  s_add_u32 s20, s20, s37
  s_addc_u32 s21, s21, 0
  v_exp_f32 v173, v173
  v_exp_f32 v174, v174
  v_smfmac_f32_16x16x64_bf16 v[144:147], a[240:243], v[116:123], v10
  v_exp_f32 v175, v175
  v_mfma_f32_16x16x32_bf16 v[124:127], v[20:23], v[120:123], 0
  v_cvt_pk_bf16_f32 v166, v172, v173
  v_cvt_pk_bf16_f32 v167, v174, v175
  v_mfma_f32_16x16x32_bf16 v[124:127], v[16:19], v[116:119], v[124:127]
  v_cvt_pk_bf16_f32 v38, v44, v45
  v_cvt_pk_bf16_f32 v39, v46, v47
  v_mfma_f32_16x16x32_bf16 v[128:131], v[24:27], v[116:119], 0
  v_add_f32 v15, v144, v145
  v_mov_b64 v[144:145], 0
  v_mfma_f32_16x16x32_bf16 v[128:131], v[28:31], v[120:123], v[128:131]
  v_exp_f32 v168, v168
  v_mfma_f32_16x16x32_bf16 v[140:143], v[36:39], v[120:123], 0
  v_exp_f32 v169, v169
  v_mfma_f32_16x16x32_bf16 v[140:143], v[32:35], v[116:119], v[140:143]
  v_exp_f32 v170, v170
  v_smfmac_f32_16x16x64_bf16 v[144:147], a[240:243], v[132:139], v10
  v_exp_f32 v171, v171
  v_mfma_f32_16x16x32_bf16 v[116:119], v[20:23], v[136:139], 0
  v_cvt_pk_bf16_f32 v168, v168, v169
  v_cvt_pk_bf16_f32 v169, v170, v171
  v_mfma_f32_16x16x32_bf16 v[116:119], v[16:19], v[132:135], v[116:119]
  v_exp_f32 v176, v176
  v_mfma_f32_16x16x32_bf16 v[120:123], v[24:27], v[132:135], 0
  v_add_f32 v14, v144, v145
  v_mov_b64 v[144:145], 0
  v_mfma_f32_16x16x32_bf16 v[120:123], v[28:31], v[136:139], v[120:123]
  v_exp_f32 v177, v177
  v_mfma_f32_16x16x32_bf16 v[156:159], v[36:39], v[136:139], 0
  v_exp_f32 v178, v178
  v_mfma_f32_16x16x32_bf16 v[156:159], v[32:35], v[132:135], v[156:159]
  v_exp_f32 v179, v179
  v_smfmac_f32_16x16x64_bf16 v[144:147], a[240:243], v[148:155], v10
  v_cvt_pk_bf16_f32 v170, v176, v177
  v_cvt_pk_bf16_f32 v171, v178, v179
  v_mfma_f32_16x16x32_bf16 v[132:135], v[20:23], v[152:155], 0
  s_add_u32 m0, s32, 28672
  v_max_f32 v9, v14, v15
  v_mfma_f32_16x16x32_bf16 v[132:135], v[16:19], v[148:151], v[132:135]
  s_waitcnt vmcnt(6)
  s_barrier
  v_mfma_f32_16x16x32_bf16 v[136:139], v[24:27], v[148:151], 0
  v_add_f32 v13, v144, v145
  v_mov_b64 v[144:145], 0
  v_mfma_f32_16x16x32_bf16 v[136:139], v[28:31], v[152:155], v[136:139]
  ds_read_b128 a[244:247], v0 offset:0
  ds_read_b128 a[248:251], v1 offset:0
  v_mfma_f32_16x16x32_bf16 v[160:163], v[36:39], v[152:155], 0
  buffer_load_dwordx4 v6, s[8:11], s49 offen offset:0 nt lds
  v_mfma_f32_16x16x32_bf16 v[160:163], v[32:35], v[148:151], v[160:163]
  ds_read_b128 a[252:255], v0 offset:8192
  ds_read_b128 v[180:183], v1 offset:8192
  v_smfmac_f32_16x16x64_bf16 v[144:147], a[240:243], v[164:171], v10
  s_add_u32 m0, s32, 36736
  v_mfma_f32_16x16x32_bf16 v[148:151], v[20:23], v[168:171], 0
  ds_read_b128 v[64:67], v0 offset:16384
  ds_read_b128 v[68:71], v1 offset:16384
  v_mfma_f32_16x16x32_bf16 v[148:151], v[16:19], v[164:167], v[148:151]
  buffer_load_dwordx4 v6, s[8:11], s49 offen offset:128 nt lds
  v_mfma_f32_16x16x32_bf16 v[152:155], v[24:27], v[164:167], 0
  v_add_f32 v12, v144, v145
  s_add_u32 m0, s32, 44800
  v_mfma_f32_16x16x32_bf16 v[152:155], v[28:31], v[168:171], v[152:155]
  buffer_load_dwordx4 v6, s[8:11], s49 offen offset:256 nt lds
  v_mfma_f32_16x16x32_bf16 v[172:175], v[36:39], v[168:171], 0
  v_rcp_f32 v15, v15
  v_mfma_f32_16x16x32_bf16 v[172:175], v[32:35], v[164:167], v[172:175]
  s_waitcnt lgkmcnt(4)
  v_mfma_f32_16x16x32_bf16 v[76:79], v[184:187], a[244:247], 0
  v_rcp_f32 v14, v14
  v_mfma_f32_16x16x32_bf16 v[76:79], v[196:199], a[248:251], v[76:79]
  s_waitcnt lgkmcnt(2)
  v_mul_f32 v124, v15, v124
  v_mfma_f32_16x16x32_bf16 v[76:79], v[208:211], a[252:255], v[76:79]
  v_mul_f32 v125, v15, v125
  v_mul_f32 v126, v15, v126
  v_mfma_f32_16x16x32_bf16 v[76:79], v[220:223], v[180:183], v[76:79]
  s_waitcnt lgkmcnt(0)
  v_mul_f32 v127, v15, v127
  v_mfma_f32_16x16x32_bf16 v[76:79], v[232:235], v[64:67], v[76:79]
  v_cvt_pk_bf16_f32 v124, v124, v125
  v_cvt_pk_bf16_f32 v125, v126, v127
  v_mfma_f32_16x16x32_bf16 v[76:79], v[244:247], v[68:71], v[76:79]
  v_mul_f32 v128, v15, v128
  v_mul_f32 v129, v15, v129
  v_mfma_f32_16x16x32_bf16 v[80:83], v[248:251], v[68:71], 0
  v_mul_f32 v130, v15, v130
  v_mul_f32 v131, v15, v131
  v_mfma_f32_16x16x32_bf16 v[80:83], v[236:239], v[64:67], v[80:83]
  v_cvt_pk_bf16_f32 v126, v128, v129
  v_cvt_pk_bf16_f32 v127, v130, v131
  v_mfma_f32_16x16x32_bf16 v[80:83], v[224:227], v[180:183], v[80:83]
  v_cvt_pk_bf16_f32 v40, v76, v77
  v_cvt_pk_bf16_f32 v41, v78, v79
  v_mfma_f32_16x16x32_bf16 v[80:83], v[212:215], a[252:255], v[80:83]
  ds_write_b128 v4, v[124:127] offset:768
  v_mfma_f32_16x16x32_bf16 v[80:83], v[200:203], a[248:251], v[80:83]
  v_mul_f32 v140, v15, v140
  v_mul_f32 v141, v15, v141
  v_mfma_f32_16x16x32_bf16 v[80:83], v[188:191], a[244:247], v[80:83]
  v_mul_f32 v142, v15, v142
  v_mul_f32 v143, v15, v143
  v_mfma_f32_16x16x32_bf16 v[76:79], v[192:195], a[244:247], 0
  v_cvt_pk_bf16_f32 v140, v140, v141
  v_cvt_pk_bf16_f32 v141, v142, v143
  v_mfma_f32_16x16x32_bf16 v[76:79], v[204:207], a[248:251], v[76:79]
  ds_write_b64 v5, v[140:141] offset:768
  v_mfma_f32_16x16x32_bf16 v[76:79], v[216:219], a[252:255], v[76:79]
  v_cvt_pk_bf16_f32 v42, v80, v81
  v_cvt_pk_bf16_f32 v43, v82, v83
  v_mfma_f32_16x16x32_bf16 v[76:79], v[228:231], v[180:183], v[76:79]
  v_max3_f32 v9, v12, v13, v9
  v_mfma_f32_16x16x32_bf16 v[76:79], v[240:243], v[64:67], v[76:79]
  v_rcp_f32 v13, v13
  v_mfma_f32_16x16x32_bf16 v[76:79], v[252:255], v[68:71], v[76:79]
  v_mul_f32 v116, v14, v116
  v_mul_f32 v117, v14, v117
  v_mfma_f32_16x16x32_bf16 v[80:83], a[60:63], v[68:71], 0
  v_mul_f32 v118, v14, v118
  v_mul_f32 v119, v14, v119
  v_mfma_f32_16x16x32_bf16 v[80:83], a[48:51], v[64:67], v[80:83]
  v_cvt_pk_bf16_f32 v116, v116, v117
  v_cvt_pk_bf16_f32 v117, v118, v119
  v_mfma_f32_16x16x32_bf16 v[80:83], a[36:39], v[180:183], v[80:83]
  v_cvt_pk_bf16_f32 v44, v76, v77
  v_cvt_pk_bf16_f32 v45, v78, v79
  v_mfma_f32_16x16x32_bf16 v[80:83], a[24:27], a[252:255], v[80:83]
  v_mul_f32 v120, v14, v120
  v_mul_f32 v121, v14, v121
  v_mfma_f32_16x16x32_bf16 v[80:83], a[12:15], a[248:251], v[80:83]
  v_mul_f32 v122, v14, v122
  v_mul_f32 v123, v14, v123
  v_mfma_f32_16x16x32_bf16 v[80:83], a[0:3], a[244:247], v[80:83]
  v_cvt_pk_bf16_f32 v118, v120, v121
  v_cvt_pk_bf16_f32 v119, v122, v123
  v_mfma_f32_16x16x32_bf16 v[76:79], a[4:7], a[244:247], 0
  ds_write_b128 v4, v[116:119] offset:512
  v_mfma_f32_16x16x32_bf16 v[76:79], a[16:19], a[248:251], v[76:79]
  v_mul_f32 v156, v14, v156
  v_mul_f32 v157, v14, v157
  v_mfma_f32_16x16x32_bf16 v[76:79], a[28:31], a[252:255], v[76:79]
  v_cvt_pk_bf16_f32 v46, v80, v81
  v_cvt_pk_bf16_f32 v47, v82, v83
  v_mfma_f32_16x16x32_bf16 v[76:79], a[40:43], v[180:183], v[76:79]
  v_mul_f32 v158, v14, v158
  v_mul_f32 v159, v14, v159
  v_mfma_f32_16x16x32_bf16 v[76:79], a[52:55], v[64:67], v[76:79]
  v_cvt_pk_bf16_f32 v156, v156, v157
  v_cvt_pk_bf16_f32 v157, v158, v159
  v_mfma_f32_16x16x32_bf16 v[76:79], a[64:67], v[68:71], v[76:79]
  ds_write_b64 v5, v[156:157] offset:512
  v_mfma_f32_16x16x32_bf16 v[80:83], a[68:71], v[68:71], 0
  v_rcp_f32 v12, v12
  v_mfma_f32_16x16x32_bf16 v[80:83], a[56:59], v[64:67], v[80:83]
  v_mul_f32 v132, v13, v132
  v_mul_f32 v133, v13, v133
  v_mfma_f32_16x16x32_bf16 v[80:83], a[44:47], v[180:183], v[80:83]
  v_cvt_pk_bf16_f32 v48, v76, v77
  v_cvt_pk_bf16_f32 v49, v78, v79
  v_mfma_f32_16x16x32_bf16 v[80:83], a[32:35], a[252:255], v[80:83]
  v_mul_f32 v134, v13, v134
  v_mul_f32 v135, v13, v135
  v_mfma_f32_16x16x32_bf16 v[80:83], a[20:23], a[248:251], v[80:83]
  v_cvt_pk_bf16_f32 v132, v132, v133
  v_cvt_pk_bf16_f32 v133, v134, v135
  v_mfma_f32_16x16x32_bf16 v[80:83], a[8:11], a[244:247], v[80:83]
  v_mul_f32 v136, v13, v136
  v_mul_f32 v137, v13, v137
  v_mfma_f32_16x16x32_bf16 v[76:79], a[244:247], a[72:75], 0
  v_mul_f32 v138, v13, v138
  v_mul_f32 v139, v13, v139
  v_mfma_f32_16x16x32_bf16 v[76:79], a[248:251], a[84:87], v[76:79]
  v_cvt_pk_bf16_f32 v134, v136, v137
  v_cvt_pk_bf16_f32 v135, v138, v139
  v_mfma_f32_16x16x32_bf16 v[76:79], a[252:255], a[96:99], v[76:79]
  v_cvt_pk_bf16_f32 v50, v80, v81
  v_cvt_pk_bf16_f32 v51, v82, v83
  v_mfma_f32_16x16x32_bf16 v[76:79], v[180:183], a[108:111], v[76:79]
  ds_read_b128 v[72:75], v0 offset:2048
  v_mfma_f32_16x16x32_bf16 v[76:79], v[64:67], a[120:123], v[76:79]
  ds_read_b128 v[84:87], v1 offset:2048
  v_mfma_f32_16x16x32_bf16 v[76:79], v[68:71], a[132:135], v[76:79]
  ds_read_b128 v[164:167], v0 offset:10240
  v_mfma_f32_16x16x32_bf16 v[80:83], v[68:71], a[136:139], 0
  ds_read_b128 v[168:171], v1 offset:10240
  v_mfma_f32_16x16x32_bf16 v[80:83], v[64:67], a[124:127], v[80:83]
  ds_read_b128 v[176:179], v0 offset:18432
  v_mfma_f32_16x16x32_bf16 v[80:83], v[180:183], a[112:115], v[80:83]
  v_cvt_pk_bf16_f32 v16, v76, v77
  v_cvt_pk_bf16_f32 v17, v78, v79
  v_mfma_f32_16x16x32_bf16 v[80:83], a[252:255], a[100:103], v[80:83]
  ds_read_b128 v[144:147], v1 offset:18432
  v_mfma_f32_16x16x32_bf16 v[80:83], a[248:251], a[88:91], v[80:83]
  ds_write_b128 v4, v[132:135] offset:256
  v_mfma_f32_16x16x32_bf16 v[80:83], a[244:247], a[76:79], v[80:83]
  v_mul_f32 v160, v13, v160
  v_mul_f32 v161, v13, v161
  v_mfma_f32_16x16x32_bf16 v[76:79], a[244:247], a[80:83], 0
  v_mul_f32 v162, v13, v162
  v_mul_f32 v163, v13, v163
  v_mfma_f32_16x16x32_bf16 v[76:79], a[248:251], a[92:95], v[76:79]
  v_cvt_pk_bf16_f32 v160, v160, v161
  v_cvt_pk_bf16_f32 v161, v162, v163
  v_mfma_f32_16x16x32_bf16 v[76:79], a[252:255], a[104:107], v[76:79]
  v_cvt_pk_bf16_f32 v24, v80, v81
  v_cvt_pk_bf16_f32 v25, v82, v83
  v_mfma_f32_16x16x32_bf16 v[76:79], v[180:183], a[116:119], v[76:79]
  ds_write_b64 v5, v[160:161] offset:256
  v_mfma_f32_16x16x32_bf16 v[76:79], v[64:67], a[128:131], v[76:79]
  v_mul_f32 v148, v12, v148
  v_mul_f32 v149, v12, v149
  v_mfma_f32_16x16x32_bf16 v[76:79], v[68:71], a[140:143], v[76:79]
  s_waitcnt lgkmcnt(2)
  v_mul_f32 v150, v12, v150
  v_mfma_f32_16x16x32_bf16 v[80:83], v[184:187], v[72:75], 0
  v_mul_f32 v151, v12, v151
  v_cvt_pk_bf16_f32 v148, v148, v149
  v_mfma_f32_16x16x32_bf16 v[80:83], v[196:199], v[84:87], v[80:83]
  v_cvt_pk_bf16_f32 v149, v150, v151
  v_mul_f32 v152, v12, v152
  v_mfma_f32_16x16x32_bf16 v[80:83], v[208:211], v[164:167], v[80:83]
  v_cvt_pk_bf16_f32 v32, v76, v77
  v_cvt_pk_bf16_f32 v33, v78, v79
  v_mfma_f32_16x16x32_bf16 v[80:83], v[220:223], v[168:171], v[80:83]
  v_mul_f32 v153, v12, v153
  v_mul_f32 v154, v12, v154
  v_mfma_f32_16x16x32_bf16 v[80:83], v[232:235], v[176:179], v[80:83]
  v_mul_f32 v155, v12, v155
  v_cvt_pk_bf16_f32 v150, v152, v153
  v_mfma_f32_16x16x32_bf16 v[80:83], v[244:247], v[144:147], v[80:83]
  v_cvt_pk_bf16_f32 v151, v154, v155
  v_mfma_f32_16x16x32_bf16 v[76:79], v[248:251], v[144:147], 0
  ds_write_b128 v4, v[148:151] offset:0
  v_mfma_f32_16x16x32_bf16 v[76:79], v[236:239], v[176:179], v[76:79]
  v_mul_f32 v172, v12, v172
  v_mul_f32 v173, v12, v173
  v_mfma_f32_16x16x32_bf16 v[76:79], v[224:227], v[168:171], v[76:79]
  v_cvt_pk_bf16_f32 v52, v80, v81
  v_cvt_pk_bf16_f32 v53, v82, v83
  v_mfma_f32_16x16x32_bf16 v[76:79], v[212:215], v[164:167], v[76:79]
  v_mul_f32 v174, v12, v174
  v_mul_f32 v175, v12, v175
  v_mfma_f32_16x16x32_bf16 v[76:79], v[200:203], v[84:87], v[76:79]
  v_cvt_pk_bf16_f32 v172, v172, v173
  v_cvt_pk_bf16_f32 v173, v174, v175
  v_mfma_f32_16x16x32_bf16 v[76:79], v[188:191], v[72:75], v[76:79]
  ds_write_b64 v5, v[172:173] offset:0
  v_mfma_f32_16x16x32_bf16 v[80:83], v[192:195], v[72:75], 0
  v_subrev_u32 v3, s7, v3
  v_subrev_u32 v2, s7, v2
  v_mfma_f32_16x16x32_bf16 v[80:83], v[204:207], v[84:87], v[80:83]
  v_add_u32 v4, s7, v4
  v_add_u32 v5, s7, v5
  v_mfma_f32_16x16x32_bf16 v[80:83], v[216:219], v[164:167], v[80:83]
  v_cvt_pk_bf16_f32 v54, v76, v77
  v_cvt_pk_bf16_f32 v55, v78, v79
  v_mfma_f32_16x16x32_bf16 v[80:83], v[228:231], v[168:171], v[80:83]
  s_sub_u32 s7, 0, s7
  v_max3_f32 v9, v12, v13, v9
  v_mfma_f32_16x16x32_bf16 v[80:83], v[240:243], v[176:179], v[80:83]
  v_max3_f32 v9, v14, v15, v9
  v_accvgpr_read_b32 v180, a228
  v_mfma_f32_16x16x32_bf16 v[80:83], v[252:255], v[144:147], v[80:83]
  s_add_u32 m0, s58, 114688
  s_add_u32 s36, s58, 0
  v_mfma_f32_16x16x32_bf16 v[76:79], a[60:63], v[144:147], 0
  buffer_load_dwordx4 v180, s[16:19], s36 offen offset:0 lds
  v_mfma_f32_16x16x32_bf16 v[76:79], a[48:51], v[176:179], v[76:79]
  buffer_load_dwordx4 v180, s[16:19], s36 offen offset:1024 lds
  v_mfma_f32_16x16x32_bf16 v[76:79], a[36:39], v[168:171], v[76:79]
  v_cvt_pk_bf16_f32 v56, v80, v81
  v_cvt_pk_bf16_f32 v57, v82, v83
  v_mfma_f32_16x16x32_bf16 v[76:79], a[24:27], v[164:167], v[76:79]
  buffer_load_dwordx4 v180, s[16:19], s36 offen offset:2048 lds
  v_mfma_f32_16x16x32_bf16 v[76:79], a[12:15], v[84:87], v[76:79]
  s_add_u32 m0, s58, 126976
  s_add_u32 s36, s58, 18432
  v_mfma_f32_16x16x32_bf16 v[76:79], a[0:3], v[72:75], v[76:79]
  buffer_load_dwordx4 v180, s[16:19], s36 offen offset:0 lds
  v_mfma_f32_16x16x32_bf16 v[80:83], a[4:7], v[72:75], 0
  buffer_load_dwordx4 v180, s[16:19], s36 offen offset:1024 lds
  v_mfma_f32_16x16x32_bf16 v[80:83], a[16:19], v[84:87], v[80:83]
  buffer_load_dwordx4 v180, s[16:19], s36 offen offset:2048 lds
  v_mfma_f32_16x16x32_bf16 v[80:83], a[28:31], v[164:167], v[80:83]
  v_cvt_pk_bf16_f32 v58, v76, v77
  v_cvt_pk_bf16_f32 v59, v78, v79
  v_mfma_f32_16x16x32_bf16 v[80:83], a[40:43], v[168:171], v[80:83]
  s_add_u32 m0, s58, 139264
  s_add_u32 s36, s58, 36864
  v_mfma_f32_16x16x32_bf16 v[80:83], a[52:55], v[176:179], v[80:83]
  buffer_load_dwordx4 v180, s[16:19], s36 offen offset:0 lds
  v_mfma_f32_16x16x32_bf16 v[80:83], a[64:67], v[144:147], v[80:83]
  s_add_u32 s37, s28, 4
  s_lshr_b32 s37, s37, 6
  v_mfma_f32_16x16x32_bf16 v[76:79], a[68:71], v[144:147], 0
  s_add_u32 s39, s28, 1
  s_lshr_b32 s39, s39, 6
  v_mfma_f32_16x16x32_bf16 v[76:79], a[56:59], v[176:179], v[76:79]
  buffer_load_dwordx4 v180, s[16:19], s36 offen offset:1024 lds
  v_mfma_f32_16x16x32_bf16 v[76:79], a[44:47], v[168:171], v[76:79]
  v_cvt_pk_bf16_f32 v60, v80, v81
  v_cvt_pk_bf16_f32 v61, v82, v83
L_hop2:
  s_cbranch_execz L_hopped
  v_mfma_f32_16x16x32_bf16 v[76:79], a[32:35], v[164:167], v[76:79]
  s_sub_u32 s62, s38, s28
  s_mulk_i32 s62, 3072
  v_mfma_f32_16x16x32_bf16 v[76:79], a[20:23], v[84:87], v[76:79]
  s_add_u32 s62, s62, s46
  s_mul_i32 s14, s37, -42
  v_mfma_f32_16x16x32_bf16 v[76:79], a[8:11], v[72:75], v[76:79]
  buffer_load_dwordx4 v180, s[16:19], s36 offen offset:2048 lds
  v_mfma_f32_16x16x32_bf16 v[80:83], v[72:75], a[72:75], 0
  s_waitcnt vmcnt(15)
  s_barrier
  v_mfma_f32_16x16x32_bf16 v[80:83], v[84:87], a[84:87], v[80:83]
  s_addk_i32 s14, 128
  s_mul_i32 s15, s37, -3072
  v_mfma_f32_16x16x32_bf16 v[80:83], v[164:167], a[96:99], v[80:83]
  v_cvt_pk_bf16_f32 v62, v76, v77
  v_cvt_pk_bf16_f32 v63, v78, v79
  v_mfma_f32_16x16x32_bf16 v[80:83], v[168:171], a[108:111], v[80:83]
  ds_read_b128 v[116:119], v0 offset:4096
  s_add_u32 s15, s15, 1566720
  v_mfma_f32_16x16x32_bf16 v[80:83], v[176:179], a[120:123], v[80:83]
  ds_read_b128 v[124:127], v1 offset:4096
  s_lshl3_add_u32 s12, s39, 48
  v_mfma_f32_16x16x32_bf16 v[80:83], v[144:147], a[132:135], v[80:83]
  ds_read_b128 v[120:123], v0 offset:12288
  s_lshl2_add_u32 s13, s37, 104
  v_mfma_f32_16x16x32_bf16 v[76:79], v[144:147], a[136:139], 0
  ds_read_b128 v[128:131], v1 offset:12288
  s_sub_u32 s13, s13, s12
  v_mfma_f32_16x16x32_bf16 v[76:79], v[176:179], a[124:127], v[76:79]
  ds_read_b128 v[132:135], v0 offset:20480
  s_or_b32 s39, s39, s31
  v_mfma_f32_16x16x32_bf16 v[76:79], v[168:171], a[112:115], v[76:79]
  v_cvt_pk_bf16_f32 v18, v80, v81
  v_cvt_pk_bf16_f32 v19, v82, v83
  v_mfma_f32_16x16x32_bf16 v[76:79], v[164:167], a[100:103], v[76:79]
  ds_read_b128 v[140:143], v1 offset:20480
  s_or_b32 s39, s39, s4
  v_mfma_f32_16x16x32_bf16 v[76:79], v[84:87], a[88:91], v[76:79]
  s_add_u32 m0, s58, 151552
  s_add_u32 s36, s58, 55296
  v_mfma_f32_16x16x32_bf16 v[76:79], v[72:75], a[76:79], v[76:79]
  buffer_load_dwordx4 v180, s[16:19], s36 offen offset:0 lds
  v_mfma_f32_16x16x32_bf16 v[80:83], v[72:75], a[80:83], 0
  buffer_load_dwordx4 v180, s[16:19], s36 offen offset:1024 lds
  v_mfma_f32_16x16x32_bf16 v[80:83], v[84:87], a[92:95], v[80:83]
  buffer_load_dwordx4 v180, s[16:19], s36 offen offset:2048 lds
  v_mfma_f32_16x16x32_bf16 v[80:83], v[164:167], a[104:107], v[80:83]
  v_cvt_pk_bf16_f32 v26, v76, v77
  v_cvt_pk_bf16_f32 v27, v78, v79
  v_mfma_f32_16x16x32_bf16 v[80:83], v[168:171], a[116:119], v[80:83]
  s_add_u32 m0, s58, 0
  s_add_u32 s36, s59, 12288
  v_mfma_f32_16x16x32_bf16 v[80:83], v[176:179], a[128:131], v[80:83]
  buffer_load_dwordx4 v180, s[16:19], s36 offen offset:0 lds
  v_mfma_f32_16x16x32_bf16 v[80:83], v[144:147], a[140:143], v[80:83]
  s_waitcnt lgkmcnt(0)
  s_lshl_b32 s39, s39, 8
  v_mfma_f32_16x16x32_bf16 v[148:151], v[184:187], v[116:119], 0
  buffer_load_dwordx4 v180, s[16:19], s36 offen offset:1024 lds
  v_mfma_f32_16x16x32_bf16 v[148:151], v[196:199], v[124:127], v[148:151]
  s_add_u32 s63, s12, s39
  s_add_u32 s60, s63, s29
  v_mfma_f32_16x16x32_bf16 v[148:151], v[208:211], v[120:123], v[148:151]
  v_cvt_pk_bf16_f32 v34, v80, v81
  v_cvt_pk_bf16_f32 v35, v82, v83
  v_mfma_f32_16x16x32_bf16 v[148:151], v[220:223], v[128:131], v[148:151]
  buffer_load_dwordx4 v180, s[16:19], s36 offen offset:2048 lds
  v_mfma_f32_16x16x32_bf16 v[148:151], v[232:235], v[132:135], v[148:151]
  s_sub_u32 s60, s60, 4
  v_mfma_f32_16x16x32_bf16 v[148:151], v[244:247], v[140:143], v[148:151]
  v_mfma_f32_16x16x32_bf16 v[156:159], v[248:251], v[140:143], 0
  ds_read_b128 v[136:139], v0 offset:6144
  v_mfma_f32_16x16x32_bf16 v[156:159], v[236:239], v[132:135], v[156:159]
  ds_read_b128 v[144:147], v1 offset:6144
  v_mfma_f32_16x16x32_bf16 v[156:159], v[224:227], v[128:131], v[156:159]
  v_cvt_pk_bf16_f32 v64, v148, v149
  v_cvt_pk_bf16_f32 v65, v150, v151
  v_mfma_f32_16x16x32_bf16 v[156:159], v[212:215], v[120:123], v[156:159]
  ds_read_b128 v[152:155], v0 offset:14336
  v_mfma_f32_16x16x32_bf16 v[156:159], v[200:203], v[124:127], v[156:159]
  ds_read_b128 v[160:163], v1 offset:14336
  v_mfma_f32_16x16x32_bf16 v[156:159], v[188:191], v[116:119], v[156:159]
  ds_read_b128 v[164:167], v0 offset:22528
  v_mfma_f32_16x16x32_bf16 v[148:151], v[192:195], v[116:119], 0
  ds_read_b128 v[172:175], v1 offset:22528
  v_mfma_f32_16x16x32_bf16 v[148:151], v[204:207], v[124:127], v[148:151]
  s_add_u32 m0, s58, 12288
  s_add_u32 s36, s59, 49152
  v_mfma_f32_16x16x32_bf16 v[148:151], v[216:219], v[120:123], v[148:151]
  v_cvt_pk_bf16_f32 v66, v156, v157
  v_cvt_pk_bf16_f32 v67, v158, v159
  v_mfma_f32_16x16x32_bf16 v[148:151], v[228:231], v[128:131], v[148:151]
  buffer_load_dwordx4 v180, s[16:19], s36 offen offset:0 lds
  v_mfma_f32_16x16x32_bf16 v[148:151], v[240:243], v[132:135], v[148:151]
  buffer_load_dwordx4 v180, s[16:19], s36 offen offset:1024 lds
  v_mfma_f32_16x16x32_bf16 v[148:151], v[252:255], v[140:143], v[148:151]
  buffer_load_dwordx4 v180, s[16:19], s36 offen offset:2048 lds
  v_mfma_f32_16x16x32_bf16 v[156:159], a[60:63], v[140:143], 0
  v_accvgpr_read_b32 v180, a229
  v_accvgpr_read_b32 v181, a230
  v_mfma_f32_16x16x32_bf16 v[156:159], a[48:51], v[132:135], v[156:159]
  v_accvgpr_read_b32 v182, a231
  v_accvgpr_read_b32 v183, a232
  v_mfma_f32_16x16x32_bf16 v[156:159], a[36:39], v[128:131], v[156:159]
  v_cvt_pk_bf16_f32 v68, v148, v149
  v_cvt_pk_bf16_f32 v69, v150, v151
  v_mfma_f32_16x16x32_bf16 v[156:159], a[24:27], v[120:123], v[156:159]
  s_add_u32 s48, s48, 6291456
  s_add_u32 s49, s48, 786432
  v_mfma_f32_16x16x32_bf16 v[156:159], a[12:15], v[124:127], v[156:159]
  s_sub_u32 s33, s32, 40960
  s_add_u32 s32, s33, 65536
  v_mfma_f32_16x16x32_bf16 v[156:159], a[0:3], v[116:119], v[156:159]
  s_mov_b32 s35, 2
  s_mov_b64 vcc, 0
  v_mfma_f32_16x16x32_bf16 v[148:151], a[4:7], v[116:119], 0
  s_sub_u32 s50, s48, 12582912
  s_sub_u32 s51, s48, 6291456
  v_mfma_f32_16x16x32_bf16 v[148:151], a[16:19], v[124:127], v[148:151]
  s_sub_u32 s6, s48, 0
  s_add_u32 s44, s29, 8
  v_mfma_f32_16x16x32_bf16 v[148:151], a[28:31], v[120:123], v[148:151]
  v_cvt_pk_bf16_f32 v76, v156, v157
  v_cvt_pk_bf16_f32 v77, v158, v159
  v_mfma_f32_16x16x32_bf16 v[148:151], a[40:43], v[128:131], v[148:151]
  s_mov_b32 s45, 0
  v_mov_b32 v11, 0
  v_mfma_f32_16x16x32_bf16 v[148:151], a[52:55], v[132:135], v[148:151]
  v_mad_i32_i16 v0, v10, 1, s32 op_sel:[1,0,0,0]
  v_xor_b32 v1, 64, v0
  v_mfma_f32_16x16x32_bf16 v[148:151], a[64:67], v[140:143], v[148:151]
  s_waitcnt lgkmcnt(0)
  s_barrier
  v_mfma_f32_16x16x32_bf16 v[156:159], a[68:71], v[140:143], 0
  v_mfma_f32_16x16x32_bf16 v[156:159], a[56:59], v[132:135], v[156:159]
  s_add_u32 m0, s33, 40960
  v_mfma_f32_16x16x32_bf16 v[156:159], a[44:47], v[128:131], v[156:159]
  v_cvt_pk_bf16_f32 v78, v148, v149
  v_cvt_pk_bf16_f32 v79, v150, v151
  v_mfma_f32_16x16x32_bf16 v[156:159], a[32:35], v[120:123], v[156:159]
  buffer_load_dwordx4 v6, s[8:11], s48 offen offset:0 nt lds
  v_mfma_f32_16x16x32_bf16 v[156:159], a[20:23], v[124:127], v[156:159]
  v_mfma_f32_16x16x32_bf16 v[156:159], a[8:11], v[116:119], v[156:159]
  v_mfma_f32_16x16x32_bf16 v[148:151], v[116:119], a[72:75], 0
  s_add_u32 m0, s33, 49024
  v_mfma_f32_16x16x32_bf16 v[148:151], v[124:127], a[84:87], v[148:151]
  buffer_load_dwordx4 v6, s[8:11], s48 offen offset:128 nt lds
  v_mfma_f32_16x16x32_bf16 v[148:151], v[120:123], a[96:99], v[148:151]
  v_cvt_pk_bf16_f32 v80, v156, v157
  v_cvt_pk_bf16_f32 v81, v158, v159
  v_mfma_f32_16x16x32_bf16 v[148:151], v[128:131], a[108:111], v[148:151]
  v_mfma_f32_16x16x32_bf16 v[148:151], v[132:135], a[120:123], v[148:151]
  v_mfma_f32_16x16x32_bf16 v[148:151], v[140:143], a[132:135], v[148:151]
  s_add_u32 m0, s33, 57088
  v_mfma_f32_16x16x32_bf16 v[156:159], v[140:143], a[136:139], 0
  buffer_load_dwordx4 v6, s[8:11], s48 offen offset:256 nt lds
  v_mfma_f32_16x16x32_bf16 v[156:159], v[132:135], a[124:127], v[156:159]
  v_mfma_f32_16x16x32_bf16 v[156:159], v[128:131], a[112:115], v[156:159]
  v_cvt_pk_bf16_f32 v20, v148, v149
  v_cvt_pk_bf16_f32 v21, v150, v151
  v_mfma_f32_16x16x32_bf16 v[156:159], v[120:123], a[100:103], v[156:159]
  s_add_u32 m0, s33, 45056
  v_mfma_f32_16x16x32_bf16 v[156:159], v[124:127], a[88:91], v[156:159]
  s_waitcnt vmcnt(3)
  s_barrier
  v_mfma_f32_16x16x32_bf16 v[156:159], v[116:119], a[76:79], v[156:159]
  buffer_load_dwordx4 v6, s[8:11], s49 offen offset:0 nt lds
  v_mfma_f32_16x16x32_bf16 v[148:151], v[116:119], a[80:83], 0
  ds_read_b64_tr_b16 a[144:145], v180 offset:0
  ds_read_b64_tr_b16 a[146:147], v180 offset:6144
  v_mfma_f32_16x16x32_bf16 v[148:151], v[124:127], a[92:95], v[148:151]
  ds_read_b64_tr_b16 a[148:149], v180 offset:8
  v_mfma_f32_16x16x32_bf16 v[148:151], v[120:123], a[104:107], v[148:151]
  v_cvt_pk_bf16_f32 v28, v156, v157
  v_cvt_pk_bf16_f32 v29, v158, v159
  v_mfma_f32_16x16x32_bf16 v[148:151], v[128:131], a[116:119], v[148:151]
  s_add_u32 m0, s33, 53120
  ds_read_b64_tr_b16 a[150:151], v180 offset:6152
  v_mfma_f32_16x16x32_bf16 v[148:151], v[132:135], a[128:131], v[148:151]
  buffer_load_dwordx4 v6, s[8:11], s49 offen offset:128 nt lds
  v_mfma_f32_16x16x32_bf16 v[148:151], v[140:143], a[140:143], v[148:151]
  ds_read_b64_tr_b16 a[152:153], v181 offset:0
  v_mfma_f32_16x16x32_bf16 v[168:171], v[184:187], v[136:139], 0
  ds_read_b64_tr_b16 a[154:155], v181 offset:6144
  ds_read_b64_tr_b16 a[156:157], v181 offset:8
  v_mfma_f32_16x16x32_bf16 v[168:171], v[196:199], v[144:147], v[168:171]
  s_add_u32 m0, s33, 61184
  ds_read_b64_tr_b16 a[158:159], v181 offset:6152
  v_mfma_f32_16x16x32_bf16 v[168:171], v[208:211], v[152:155], v[168:171]
  v_cvt_pk_bf16_f32 v36, v148, v149
  v_cvt_pk_bf16_f32 v37, v150, v151
  v_mfma_f32_16x16x32_bf16 v[168:171], v[220:223], v[160:163], v[168:171]
  buffer_load_dwordx4 v6, s[8:11], s49 offen offset:256 nt lds
  v_mfma_f32_16x16x32_bf16 v[168:171], v[232:235], v[164:167], v[168:171]
  ds_read_b64_tr_b16 a[160:161], v180 offset:12288
  s_add_u32 s48, s48, 6291456
  v_mfma_f32_16x16x32_bf16 v[168:171], v[244:247], v[172:175], v[168:171]
  ds_read_b64_tr_b16 a[162:163], v180 offset:18432
  ds_read_b64_tr_b16 a[164:165], v180 offset:12296
  v_mfma_f32_16x16x32_bf16 v[176:179], v[248:251], v[172:175], 0
  ds_read_b64_tr_b16 a[166:167], v180 offset:18440
  s_add_u32 s49, s48, 786432
  v_mfma_f32_16x16x32_bf16 v[176:179], v[236:239], v[164:167], v[176:179]
  ds_read_b64_tr_b16 a[168:169], v181 offset:12288
  ds_read_b64_tr_b16 a[170:171], v181 offset:18432
  v_mfma_f32_16x16x32_bf16 v[176:179], v[224:227], v[160:163], v[176:179]
  v_cvt_pk_bf16_f32 v70, v168, v169
  v_cvt_pk_bf16_f32 v71, v170, v171
  v_mfma_f32_16x16x32_bf16 v[176:179], v[212:215], v[152:155], v[176:179]
  ds_read_b64_tr_b16 a[172:173], v181 offset:12296
  v_mfma_f32_16x16x32_bf16 v[176:179], v[200:203], v[144:147], v[176:179]
  ds_read_b64_tr_b16 a[174:175], v181 offset:18440
  ds_read_b64_tr_b16 a[176:177], v180 offset:24576
  v_mfma_f32_16x16x32_bf16 v[176:179], v[188:191], v[136:139], v[176:179]
  ds_read_b64_tr_b16 a[178:179], v180 offset:30720
  v_mfma_f32_16x16x32_bf16 v[168:171], v[192:195], v[136:139], 0
  ds_read_b64_tr_b16 a[180:181], v180 offset:24584
  ds_read_b64_tr_b16 a[182:183], v180 offset:30728
  v_mfma_f32_16x16x32_bf16 v[168:171], v[204:207], v[144:147], v[168:171]
  ds_read_b64_tr_b16 a[184:185], v181 offset:24576
  v_mfma_f32_16x16x32_bf16 v[168:171], v[216:219], v[152:155], v[168:171]
  v_cvt_pk_bf16_f32 v72, v176, v177
  v_cvt_pk_bf16_f32 v73, v178, v179
  v_mfma_f32_16x16x32_bf16 v[168:171], v[228:231], v[160:163], v[168:171]
  ds_read_b64_tr_b16 a[186:187], v181 offset:30720
  ds_read_b64_tr_b16 a[188:189], v181 offset:24584
  v_mfma_f32_16x16x32_bf16 v[168:171], v[240:243], v[164:167], v[168:171]
  ds_read_b64_tr_b16 a[190:191], v181 offset:30728
  v_mfma_f32_16x16x32_bf16 v[168:171], v[252:255], v[172:175], v[168:171]
  ds_read_b64_tr_b16 a[192:193], v180 offset:36864
  ds_read_b64_tr_b16 a[194:195], v180 offset:43008
  v_mfma_f32_16x16x32_bf16 v[176:179], a[60:63], v[172:175], 0
  ds_read_b64_tr_b16 a[196:197], v180 offset:36872
  v_mfma_f32_16x16x32_bf16 v[176:179], a[48:51], v[164:167], v[176:179]
  ds_read_b64_tr_b16 a[198:199], v180 offset:43016
  ds_read_b64_tr_b16 a[200:201], v181 offset:36864
  v_mfma_f32_16x16x32_bf16 v[176:179], a[36:39], v[160:163], v[176:179]
  v_cvt_pk_bf16_f32 v74, v168, v169
  v_cvt_pk_bf16_f32 v75, v170, v171
  v_mfma_f32_16x16x32_bf16 v[176:179], a[24:27], v[152:155], v[176:179]
  ds_read_b64_tr_b16 a[202:203], v181 offset:43008
  v_mfma_f32_16x16x32_bf16 v[176:179], a[12:15], v[144:147], v[176:179]
  ds_read_b64_tr_b16 a[204:205], v181 offset:36872
  ds_read_b64_tr_b16 a[206:207], v181 offset:43016
  v_mfma_f32_16x16x32_bf16 v[176:179], a[0:3], v[136:139], v[176:179]
  ds_read_b64_tr_b16 a[208:209], v182 offset:0
  v_mfma_f32_16x16x32_bf16 v[168:171], a[4:7], v[136:139], 0
  ds_read_b64_tr_b16 a[210:211], v182 offset:1536
  ds_read_b64_tr_b16 a[212:213], v182 offset:8
  v_mfma_f32_16x16x32_bf16 v[168:171], a[16:19], v[144:147], v[168:171]
  ds_read_b64_tr_b16 a[214:215], v182 offset:1544
  v_mfma_f32_16x16x32_bf16 v[168:171], a[28:31], v[152:155], v[168:171]
  v_cvt_pk_bf16_f32 v82, v176, v177
  v_cvt_pk_bf16_f32 v83, v178, v179
  v_mfma_f32_16x16x32_bf16 v[168:171], a[40:43], v[160:163], v[168:171]
  ds_read_b64_tr_b16 a[216:217], v183 offset:0
  ds_read_b64_tr_b16 a[218:219], v183 offset:1536
  v_mfma_f32_16x16x32_bf16 v[168:171], a[52:55], v[164:167], v[168:171]
  ds_read_b64_tr_b16 a[220:221], v183 offset:8
  v_mfma_f32_16x16x32_bf16 v[168:171], a[64:67], v[172:175], v[168:171]
  ds_read_b64_tr_b16 a[222:223], v183 offset:1544
  ds_read_b64_tr_b16 a[224:225], v182 offset:12288
  v_mfma_f32_16x16x32_bf16 v[176:179], a[68:71], v[172:175], 0
  ds_read_b64_tr_b16 a[226:227], v182 offset:13824
  v_mfma_f32_16x16x32_bf16 v[176:179], a[56:59], v[164:167], v[176:179]
  ds_read_b64_tr_b16 a[228:229], v182 offset:12296
  v_mfma_f32_16x16x32_bf16 v[176:179], a[44:47], v[160:163], v[176:179]
  v_cvt_pk_bf16_f32 v84, v168, v169
  v_cvt_pk_bf16_f32 v85, v170, v171
  v_mfma_f32_16x16x32_bf16 v[176:179], a[32:35], v[152:155], v[176:179]
  ds_read_b64_tr_b16 a[230:231], v182 offset:13832
  v_mfma_f32_16x16x32_bf16 v[176:179], a[20:23], v[144:147], v[176:179]
  ds_read_b64_tr_b16 a[232:233], v183 offset:12288
  v_mfma_f32_16x16x32_bf16 v[176:179], a[8:11], v[136:139], v[176:179]
  ds_read_b64_tr_b16 a[234:235], v183 offset:13824
  v_mfma_f32_16x16x32_bf16 v[168:171], v[136:139], a[72:75], 0
  ds_read_b64_tr_b16 a[236:237], v183 offset:12296
  v_mfma_f32_16x16x32_bf16 v[168:171], v[144:147], a[84:87], v[168:171]
  ds_read_b64_tr_b16 a[238:239], v183 offset:13832
  v_mfma_f32_16x16x32_bf16 v[168:171], v[152:155], a[96:99], v[168:171]
  v_cvt_pk_bf16_f32 v86, v176, v177
  v_cvt_pk_bf16_f32 v87, v178, v179
  v_mfma_f32_16x16x32_bf16 v[168:171], v[160:163], a[108:111], v[168:171]
  v_mfma_f32_16x16x32_bf16 v[168:171], v[164:167], a[120:123], v[168:171]
  v_mfma_f32_16x16x32_bf16 v[168:171], v[172:175], a[132:135], v[168:171]
  v_mfma_f32_16x16x32_bf16 v[176:179], v[172:175], a[136:139], 0
  s_waitcnt lgkmcnt(0)
  s_waitcnt vmcnt(24)
  s_barrier
  v_mfma_f32_16x16x32_bf16 v[176:179], v[164:167], a[124:127], v[176:179]
  v_mfma_f32_16x16x32_bf16 v[176:179], v[160:163], a[112:115], v[176:179]
  v_cvt_pk_bf16_f32 v22, v168, v169
  v_cvt_pk_bf16_f32 v23, v170, v171
  v_mfma_f32_16x16x32_bf16 v[176:179], v[152:155], a[100:103], v[176:179]
  ds_read_b128 a[244:247], v3 offset:0
  v_mfma_f32_16x16x32_bf16 v[176:179], v[144:147], a[88:91], v[176:179]
  ds_read_b128 a[248:251], v3 offset:4096
  v_mfma_f32_16x16x32_bf16 v[176:179], v[136:139], a[76:79], v[176:179]
  ds_read_b128 a[252:255], v3 offset:8192
  v_mfma_f32_16x16x32_bf16 v[168:171], v[136:139], a[80:83], 0
  ds_read_b128 v[180:183], v3 offset:12288
  v_mfma_f32_16x16x32_bf16 v[168:171], v[144:147], a[92:95], v[168:171]
  v_mfma_f32_16x16x32_bf16 v[168:171], v[152:155], a[104:107], v[168:171]
  v_cvt_pk_bf16_f32 v30, v176, v177
  v_cvt_pk_bf16_f32 v31, v178, v179
  v_mfma_f32_16x16x32_bf16 v[168:171], v[160:163], a[116:119], v[168:171]
  s_cmp_lg_u32 s31, 0
  v_mfma_f32_16x16x32_bf16 v[168:171], v[164:167], a[128:131], v[168:171]
  v_mfma_f32_16x16x32_bf16 v[168:171], v[172:175], a[140:143], v[168:171]
  s_cbranch_scc0 L_s
  s_branch L_special
.fill (0x4000 - 768 + standalone__window_attn_swin__vision_kernel - .) / 4, 4, 0xbf800000
L_hop3:
  s_branch L_hop4
  s_nop 0
L_s:
  v_mfma_f32_16x16x32_bf16 v[116:119], v[46:49], v[70:73], v[112:115]
  v_mfma_f32_16x16x32_bf16 v[124:127], v[58:61], v[70:73], v[108:111]
  v_mfma_f32_16x16x32_bf16 v[120:123], v[76:79], v[70:73], v[104:107]
  v_cvt_pk_bf16_f32 v38, v168, v169
  v_cvt_pk_bf16_f32 v39, v170, v171
  v_mfma_f32_16x16x32_bf16 v[128:131], v[82:85], v[70:73], v[100:103]
  v_mfma_f32_16x16x16_bf16 v[116:119], v[50:51], v[74:75], v[116:119]
  v_mfma_f32_16x16x16_bf16 v[124:127], v[62:63], v[74:75], v[124:127]
  v_mfma_f32_16x16x16_bf16 v[120:123], v[80:81], v[74:75], v[120:123]
  v_mfma_f32_16x16x16_bf16 v[128:131], v[86:87], v[74:75], v[128:131]
  v_exp_f32 v116, v116
  v_mfma_f32_16x16x32_bf16 v[132:135], v[46:49], v[64:67], v[108:111]
  v_exp_f32 v117, v117
  v_mfma_f32_16x16x32_bf16 v[140:143], v[58:61], v[64:67], v[104:107]
  v_exp_f32 v118, v118
  v_mfma_f32_16x16x32_bf16 v[136:139], v[76:79], v[64:67], v[100:103]
  v_exp_f32 v119, v119
  v_mfma_f32_16x16x32_bf16 v[144:147], v[82:85], v[64:67], v[96:99]
  v_cvt_pk_bf16_f32 v116, v116, v117
  v_cvt_pk_bf16_f32 v117, v118, v119
  v_mfma_f32_16x16x16_bf16 v[132:135], v[50:51], v[68:69], v[132:135]
  v_exp_f32 v124, v124
  v_mfma_f32_16x16x16_bf16 v[140:143], v[62:63], v[68:69], v[140:143]
  v_exp_f32 v125, v125
  v_mfma_f32_16x16x16_bf16 v[136:139], v[80:81], v[68:69], v[136:139]
  v_exp_f32 v126, v126
  v_mfma_f32_16x16x16_bf16 v[144:147], v[86:87], v[68:69], v[144:147]
  ds_read_b128 v[64:67], v3 offset:16384
  ds_read_b128 v[68:71], v3 offset:20480
  v_mfma_f32_16x16x32_bf16 v[148:151], v[46:49], v[52:55], v[104:107]
  v_exp_f32 v127, v127
  v_mfma_f32_16x16x32_bf16 v[156:159], v[58:61], v[52:55], v[100:103]
  v_cvt_pk_bf16_f32 v118, v124, v125
  v_cvt_pk_bf16_f32 v119, v126, v127
  v_mfma_f32_16x16x32_bf16 v[152:155], v[76:79], v[52:55], v[96:99]
  v_exp_f32 v120, v120
  v_mfma_f32_16x16x32_bf16 v[160:163], v[82:85], v[52:55], v[92:95]
  v_exp_f32 v121, v121
  v_mfma_f32_16x16x16_bf16 v[148:151], v[50:51], v[56:57], v[148:151]
  v_exp_f32 v122, v122
  v_mfma_f32_16x16x16_bf16 v[156:159], v[62:63], v[56:57], v[156:159]
  v_exp_f32 v123, v123
  v_mfma_f32_16x16x16_bf16 v[152:155], v[80:81], v[56:57], v[152:155]
  v_cvt_pk_bf16_f32 v120, v120, v121
  v_cvt_pk_bf16_f32 v121, v122, v123
  v_mfma_f32_16x16x16_bf16 v[160:163], v[86:87], v[56:57], v[160:163]
  v_exp_f32 v128, v128
  v_mfma_f32_16x16x32_bf16 v[164:167], v[46:49], v[40:43], v[100:103]
  v_exp_f32 v129, v129
  v_mfma_f32_16x16x32_bf16 v[172:175], v[58:61], v[40:43], v[96:99]
  v_exp_f32 v130, v130
  v_mfma_f32_16x16x32_bf16 v[168:171], v[76:79], v[40:43], v[92:95]
  v_exp_f32 v131, v131
  v_mfma_f32_16x16x32_bf16 v[176:179], v[82:85], v[40:43], v[88:91]
  v_cvt_pk_bf16_f32 v122, v128, v129
  v_cvt_pk_bf16_f32 v123, v130, v131
  v_mfma_f32_16x16x16_bf16 v[164:167], v[50:51], v[44:45], v[164:167]
  v_exp_f32 v132, v132
  v_mfma_f32_16x16x16_bf16 v[172:175], v[62:63], v[44:45], v[172:175]
  v_exp_f32 v133, v133
  v_mfma_f32_16x16x16_bf16 v[168:171], v[80:81], v[44:45], v[168:171]
  v_exp_f32 v134, v134
  v_mfma_f32_16x16x16_bf16 v[176:179], v[86:87], v[44:45], v[176:179]
  s_waitcnt lgkmcnt(0)
  v_cvt_pk_bf16_f32 v132, v132, v133
L_pj:
  v_mfma_f32_16x16x32_bf16 v[40:43], a[144:147], a[244:247], 0
  ds_read_b128 v[72:75], v3 offset:256
  ds_read_b128 v[56:59], v3 offset:4352
  v_mfma_f32_16x16x32_bf16 v[40:43], a[160:163], a[248:251], v[40:43]
  v_exp_f32 v135, v135
  v_mfma_f32_16x16x32_bf16 v[40:43], a[176:179], a[252:255], v[40:43]
  ds_read_b128 v[60:63], v3 offset:8448
  ds_read_b128 v[76:79], v3 offset:12544
  v_mfma_f32_16x16x32_bf16 v[40:43], a[192:195], v[180:183], v[40:43]
  v_exp_f32 v140, v140
  v_mfma_f32_16x16x32_bf16 v[40:43], a[208:211], v[64:67], v[40:43]
  ds_read_b128 v[80:83], v3 offset:16640
  ds_read_b128 v[84:87], v3 offset:20736
  v_mfma_f32_16x16x32_bf16 v[40:43], a[224:227], v[68:71], v[40:43]
  v_exp_f32 v141, v141
  v_mfma_f32_16x16x32_bf16 v[44:47], a[228:231], v[68:71], 0
  v_cvt_pk_bf16_f32 v133, v134, v135
  v_cvt_pk_bf16_f32 v134, v140, v141
  v_mfma_f32_16x16x32_bf16 v[44:47], a[212:215], v[64:67], v[44:47]
  v_exp_f32 v142, v142
  v_mfma_f32_16x16x32_bf16 v[44:47], a[196:199], v[180:183], v[44:47]
  v_cvt_pk_bf16_f32 v40, v40, v41
  v_cvt_pk_bf16_f32 v41, v42, v43
  v_mfma_f32_16x16x32_bf16 v[44:47], a[180:183], a[252:255], v[44:47]
  ds_read_b128 v[124:127], v2 offset:512
  ds_read_b128 v[128:131], v2 offset:4608
  v_mfma_f32_16x16x32_bf16 v[44:47], a[164:167], a[248:251], v[44:47]
  v_exp_f32 v143, v143
  v_mfma_f32_16x16x32_bf16 v[44:47], a[148:151], a[244:247], v[44:47]
  s_waitcnt lgkmcnt(2)
  v_cvt_pk_bf16_f32 v135, v142, v143
  v_mfma_f32_16x16x32_bf16 v[48:51], a[144:147], v[72:75], 0
  ds_read_b128 a[244:247], v2 offset:8704
  ds_read_b128 a[248:251], v2 offset:12800
  v_mfma_f32_16x16x32_bf16 v[48:51], a[160:163], v[56:59], v[48:51]
  v_exp_f32 v136, v136
  v_mfma_f32_16x16x32_bf16 v[48:51], a[176:179], v[60:63], v[48:51]
  v_cvt_pk_bf16_f32 v42, v44, v45
  v_cvt_pk_bf16_f32 v43, v46, v47
  v_mfma_f32_16x16x32_bf16 v[48:51], a[192:195], v[76:79], v[48:51]
  buffer_store_dwordx4 v[40:43], v7, s[24:27], s40 offen nt
  v_mfma_f32_16x16x32_bf16 v[48:51], a[208:211], v[80:83], v[48:51]
  ds_read_b128 a[252:255], v2 offset:16896
  ds_read_b128 v[180:183], v2 offset:20992
  v_mfma_f32_16x16x32_bf16 v[48:51], a[224:227], v[84:87], v[48:51]
  v_exp_f32 v137, v137
  v_mfma_f32_16x16x32_bf16 v[52:55], a[228:231], v[84:87], 0
  v_exp_f32 v138, v138
  v_mfma_f32_16x16x32_bf16 v[52:55], a[212:215], v[80:83], v[52:55]
  v_exp_f32 v139, v139
  v_mfma_f32_16x16x32_bf16 v[52:55], a[196:199], v[76:79], v[52:55]
  v_cvt_pk_bf16_f32 v48, v48, v49
  v_cvt_pk_bf16_f32 v49, v50, v51
  v_mfma_f32_16x16x32_bf16 v[52:55], a[180:183], v[60:63], v[52:55]
  v_cvt_pk_bf16_f32 v136, v136, v137
  v_cvt_pk_bf16_f32 v137, v138, v139
  v_mfma_f32_16x16x32_bf16 v[52:55], a[164:167], v[56:59], v[52:55]
  v_exp_f32 v144, v144
  v_mfma_f32_16x16x32_bf16 v[52:55], a[148:151], v[72:75], v[52:55]
  s_waitcnt lgkmcnt(0)
  v_mfma_f32_16x16x32_bf16 v[40:43], a[144:147], v[124:127], 0
  v_exp_f32 v145, v145
  v_mfma_f32_16x16x32_bf16 v[40:43], a[160:163], v[128:131], v[40:43]
  v_exp_f32 v146, v146
  v_mfma_f32_16x16x32_bf16 v[40:43], a[176:179], a[244:247], v[40:43]
  v_cvt_pk_bf16_f32 v50, v52, v53
  v_cvt_pk_bf16_f32 v51, v54, v55
  v_mfma_f32_16x16x32_bf16 v[40:43], a[192:195], a[248:251], v[40:43]
  buffer_store_dwordx4 v[48:51], v7, s[24:27], s41 offen nt
  v_mfma_f32_16x16x32_bf16 v[40:43], a[208:211], a[252:255], v[40:43]
  ds_read_b128 v[72:75], v2 offset:768
  ds_read_b128 v[56:59], v2 offset:4864
  v_mfma_f32_16x16x32_bf16 v[40:43], a[224:227], v[180:183], v[40:43]
  v_exp_f32 v147, v147
  v_mfma_f32_16x16x32_bf16 v[44:47], a[228:231], v[180:183], 0
  ds_read_b128 v[60:63], v2 offset:8960
  ds_read_b128 v[76:79], v2 offset:13056
  v_mfma_f32_16x16x32_bf16 v[44:47], a[212:215], a[252:255], v[44:47]
  v_cvt_pk_bf16_f32 v138, v144, v145
  v_cvt_pk_bf16_f32 v139, v146, v147
  v_mfma_f32_16x16x32_bf16 v[44:47], a[196:199], a[248:251], v[44:47]
  v_cvt_pk_bf16_f32 v40, v40, v41
  v_cvt_pk_bf16_f32 v41, v42, v43
  v_mfma_f32_16x16x32_bf16 v[44:47], a[180:183], a[244:247], v[44:47]
  ds_read_b128 v[80:83], v2 offset:17152
  ds_read_b128 v[84:87], v2 offset:21248
  v_mfma_f32_16x16x32_bf16 v[44:47], a[164:167], v[128:131], v[44:47]
  v_exp_f32 v148, v148
  v_mfma_f32_16x16x32_bf16 v[44:47], a[148:151], v[124:127], v[44:47]
  v_exp_f32 v149, v149
  v_mfma_f32_16x16x32_bf16 v[48:51], a[152:155], v[124:127], 0
  v_mov_b64 v[144:145], 0
  v_cvt_pk_bf16_f32 v148, v148, v149
  v_mfma_f32_16x16x32_bf16 v[48:51], a[168:171], v[128:131], v[48:51]
  v_exp_f32 v150, v150
  v_mfma_f32_16x16x32_bf16 v[48:51], a[184:187], a[244:247], v[48:51]
  v_cvt_pk_bf16_f32 v42, v44, v45
  v_cvt_pk_bf16_f32 v43, v46, v47
  v_mfma_f32_16x16x32_bf16 v[48:51], a[200:203], a[248:251], v[48:51]
  buffer_store_dwordx4 v[40:43], v7, s[24:27], s42 offen nt
  v_mfma_f32_16x16x32_bf16 v[48:51], a[216:219], a[252:255], v[48:51]
  v_exp_f32 v151, v151
  v_mfma_f32_16x16x32_bf16 v[48:51], a[232:235], v[180:183], v[48:51]
  v_exp_f32 v156, v156
  v_mfma_f32_16x16x32_bf16 v[52:55], a[236:239], v[180:183], 0
  v_exp_f32 v157, v157
  v_mfma_f32_16x16x32_bf16 v[52:55], a[220:223], a[252:255], v[52:55]
  v_cvt_pk_bf16_f32 v149, v150, v151
  v_cvt_pk_bf16_f32 v150, v156, v157
  v_mfma_f32_16x16x32_bf16 v[52:55], a[204:207], a[248:251], v[52:55]
  v_cvt_pk_bf16_f32 v48, v48, v49
  v_cvt_pk_bf16_f32 v49, v50, v51
  v_mfma_f32_16x16x32_bf16 v[52:55], a[188:191], a[244:247], v[52:55]
  v_exp_f32 v158, v158
  v_mfma_f32_16x16x32_bf16 v[52:55], a[172:175], v[128:131], v[52:55]
  v_exp_f32 v159, v159
  v_mfma_f32_16x16x32_bf16 v[52:55], a[156:159], v[124:127], v[52:55]
  s_waitcnt lgkmcnt(0)
  v_cvt_pk_bf16_f32 v151, v158, v159
  v_mfma_f32_16x16x32_bf16 v[40:43], a[144:147], v[72:75], 0
  v_exp_f32 v152, v152
  v_mfma_f32_16x16x32_bf16 v[40:43], a[160:163], v[56:59], v[40:43]
  v_exp_f32 v153, v153
  v_mfma_f32_16x16x32_bf16 v[40:43], a[176:179], v[60:63], v[40:43]
  v_cvt_pk_bf16_f32 v50, v52, v53
  v_cvt_pk_bf16_f32 v51, v54, v55
  v_mfma_f32_16x16x32_bf16 v[40:43], a[192:195], v[76:79], v[40:43]
  buffer_store_dwordx4 v[48:51], v8, s[24:27], s42 offen nt
  v_mfma_f32_16x16x32_bf16 v[40:43], a[208:211], v[80:83], v[40:43]
  v_exp_f32 v154, v154
  v_mfma_f32_16x16x32_bf16 v[40:43], a[224:227], v[84:87], v[40:43]
  v_exp_f32 v155, v155
  v_mfma_f32_16x16x32_bf16 v[44:47], a[228:231], v[84:87], 0
  v_cvt_pk_bf16_f32 v152, v152, v153
  v_cvt_pk_bf16_f32 v153, v154, v155
  v_mfma_f32_16x16x32_bf16 v[44:47], a[212:215], v[80:83], v[44:47]
  v_exp_f32 v160, v160
  v_mfma_f32_16x16x32_bf16 v[44:47], a[196:199], v[76:79], v[44:47]
  v_cvt_pk_bf16_f32 v40, v40, v41
  v_cvt_pk_bf16_f32 v41, v42, v43
  v_mfma_f32_16x16x32_bf16 v[44:47], a[180:183], v[60:63], v[44:47]
  v_exp_f32 v161, v161
  v_mfma_f32_16x16x32_bf16 v[44:47], a[164:167], v[56:59], v[44:47]
  v_exp_f32 v162, v162
  v_mfma_f32_16x16x32_bf16 v[44:47], a[148:151], v[72:75], v[44:47]
  v_exp_f32 v163, v163
  v_mfma_f32_16x16x32_bf16 v[48:51], a[152:155], v[72:75], 0
  v_cvt_pk_bf16_f32 v154, v160, v161
  v_cvt_pk_bf16_f32 v155, v162, v163
  v_mfma_f32_16x16x32_bf16 v[48:51], a[168:171], v[56:59], v[48:51]
  v_exp_f32 v164, v164
  v_mfma_f32_16x16x32_bf16 v[48:51], a[184:187], v[60:63], v[48:51]
  v_cvt_pk_bf16_f32 v42, v44, v45
  v_cvt_pk_bf16_f32 v43, v46, v47
  v_mfma_f32_16x16x32_bf16 v[48:51], a[200:203], v[76:79], v[48:51]
  buffer_store_dwordx4 v[40:43], v7, s[24:27], s43 offen nt
  v_mfma_f32_16x16x32_bf16 v[48:51], a[216:219], v[80:83], v[48:51]
  v_exp_f32 v165, v165
  v_mfma_f32_16x16x32_bf16 v[48:51], a[232:235], v[84:87], v[48:51]
  v_exp_f32 v166, v166
  v_mfma_f32_16x16x32_bf16 v[52:55], a[236:239], v[84:87], 0
  v_exp_f32 v167, v167
  v_mfma_f32_16x16x32_bf16 v[52:55], a[220:223], v[80:83], v[52:55]
  v_cvt_pk_bf16_f32 v164, v164, v165
  v_cvt_pk_bf16_f32 v165, v166, v167
  v_mfma_f32_16x16x32_bf16 v[52:55], a[204:207], v[76:79], v[52:55]
  v_cvt_pk_bf16_f32 v48, v48, v49
  v_cvt_pk_bf16_f32 v49, v50, v51
  v_mfma_f32_16x16x32_bf16 v[52:55], a[188:191], v[60:63], v[52:55]
  v_exp_f32 v172, v172
  v_mfma_f32_16x16x32_bf16 v[52:55], a[172:175], v[56:59], v[52:55]
  v_exp_f32 v173, v173
  v_mfma_f32_16x16x32_bf16 v[52:55], a[156:159], v[72:75], v[52:55]
  v_exp_f32 v174, v174
  v_smfmac_f32_16x16x64_bf16 v[144:147], a[240:243], v[116:123], v10
  v_exp_f32 v175, v175
  v_mfma_f32_16x16x32_bf16 v[124:127], v[20:23], v[120:123], 0
  v_cvt_pk_bf16_f32 v166, v172, v173
  v_cvt_pk_bf16_f32 v167, v174, v175
  v_mfma_f32_16x16x32_bf16 v[124:127], v[16:19], v[116:119], v[124:127]
  v_cvt_pk_bf16_f32 v50, v52, v53
  v_cvt_pk_bf16_f32 v51, v54, v55
  v_mfma_f32_16x16x32_bf16 v[128:131], v[24:27], v[116:119], 0
  v_add_f32 v15, v144, v145
  v_mov_b64 v[144:145], 0
  v_mfma_f32_16x16x32_bf16 v[128:131], v[28:31], v[120:123], v[128:131]
  buffer_store_dwordx4 v[48:51], v8, s[24:27], s43 offen nt
  v_mfma_f32_16x16x32_bf16 v[140:143], v[36:39], v[120:123], 0
  v_exp_f32 v168, v168
  v_mfma_f32_16x16x32_bf16 v[140:143], v[32:35], v[116:119], v[140:143]
  v_exp_f32 v169, v169
  v_smfmac_f32_16x16x64_bf16 v[144:147], a[240:243], v[132:139], v10
  v_exp_f32 v170, v170
  v_mfma_f32_16x16x32_bf16 v[116:119], v[20:23], v[136:139], 0
  v_exp_f32 v171, v171
  v_mfma_f32_16x16x32_bf16 v[116:119], v[16:19], v[132:135], v[116:119]
  v_cvt_pk_bf16_f32 v168, v168, v169
  v_cvt_pk_bf16_f32 v169, v170, v171
  v_mfma_f32_16x16x32_bf16 v[120:123], v[24:27], v[132:135], 0
  v_add_f32 v14, v144, v145
  v_mov_b64 v[144:145], 0
  v_mfma_f32_16x16x32_bf16 v[120:123], v[28:31], v[136:139], v[120:123]
  v_exp_f32 v176, v176
  v_mfma_f32_16x16x32_bf16 v[156:159], v[36:39], v[136:139], 0
  v_exp_f32 v177, v177
  v_mfma_f32_16x16x32_bf16 v[156:159], v[32:35], v[132:135], v[156:159]
  v_exp_f32 v178, v178
  v_smfmac_f32_16x16x64_bf16 v[144:147], a[240:243], v[148:155], v10
  v_exp_f32 v179, v179
  v_mfma_f32_16x16x32_bf16 v[132:135], v[20:23], v[152:155], 0
  v_cvt_pk_bf16_f32 v170, v176, v177
  v_cvt_pk_bf16_f32 v171, v178, v179
  v_mfma_f32_16x16x32_bf16 v[132:135], v[16:19], v[148:151], v[132:135]
  v_max3_f32 v9, v14, v15, v9
  v_mfma_f32_16x16x32_bf16 v[136:139], v[24:27], v[148:151], 0
  v_add_f32 v13, v144, v145
  v_mov_b64 v[144:145], 0
  v_mfma_f32_16x16x32_bf16 v[136:139], v[28:31], v[152:155], v[136:139]
  ds_read_b128 a[244:247], v0 offset:0
  ds_read_b128 a[248:251], v1 offset:0
  v_mfma_f32_16x16x32_bf16 v[160:163], v[36:39], v[152:155], 0
  v_rcp_f32 v15, v15
  v_mfma_f32_16x16x32_bf16 v[160:163], v[32:35], v[148:151], v[160:163]
  ds_read_b128 a[252:255], v0 offset:8192
  ds_read_b128 v[180:183], v1 offset:8192
  v_smfmac_f32_16x16x64_bf16 v[144:147], a[240:243], v[164:171], v10
  v_rcp_f32 v14, v14
  v_mfma_f32_16x16x32_bf16 v[148:151], v[20:23], v[168:171], 0
  ds_read_b128 v[64:67], v0 offset:16384
  ds_read_b128 v[68:71], v1 offset:16384
  v_mfma_f32_16x16x32_bf16 v[148:151], v[16:19], v[164:167], v[148:151]
  v_mul_f32 v124, v15, v124
  v_mul_f32 v125, v15, v125
  v_mfma_f32_16x16x32_bf16 v[152:155], v[24:27], v[164:167], 0
  v_add_f32 v12, v144, v145
  v_mul_f32 v126, v15, v126
  v_mfma_f32_16x16x32_bf16 v[152:155], v[28:31], v[168:171], v[152:155]
  v_mul_f32 v127, v15, v127
  v_cvt_pk_bf16_f32 v124, v124, v125
  v_mfma_f32_16x16x32_bf16 v[172:175], v[36:39], v[168:171], 0
  s_waitcnt lgkmcnt(4)
  v_cvt_pk_bf16_f32 v125, v126, v127
  v_mfma_f32_16x16x32_bf16 v[172:175], v[32:35], v[164:167], v[172:175]
  s_cbranch_vccnz L_epi
  v_mfma_f32_16x16x32_bf16 v[76:79], v[184:187], a[244:247], 0
  ds_write_b32 v4, v124 offset:768
  v_mfma_f32_16x16x32_bf16 v[76:79], v[196:199], a[248:251], v[76:79]
  s_waitcnt lgkmcnt(3)
  v_mul_f32 v128, v15, v128
  v_mfma_f32_16x16x32_bf16 v[76:79], v[208:211], a[252:255], v[76:79]
  ds_write_b32 v4, v125 offset:772
  v_mfma_f32_16x16x32_bf16 v[76:79], v[220:223], v[180:183], v[76:79]
  s_waitcnt lgkmcnt(2)
  v_mul_f32 v129, v15, v129
  v_mfma_f32_16x16x32_bf16 v[76:79], v[232:235], v[64:67], v[76:79]
  v_mul_f32 v130, v15, v130
  v_mul_f32 v131, v15, v131
  v_mfma_f32_16x16x32_bf16 v[76:79], v[244:247], v[68:71], v[76:79]
  v_cvt_pk_bf16_f32 v128, v128, v129
  v_cvt_pk_bf16_f32 v129, v130, v131
  v_mfma_f32_16x16x32_bf16 v[80:83], v[248:251], v[68:71], 0
  ds_write_b32 v4, v128 offset:776
  v_mfma_f32_16x16x32_bf16 v[80:83], v[236:239], v[64:67], v[80:83]
  ds_write_b32 v4, v129 offset:780
  v_mfma_f32_16x16x32_bf16 v[80:83], v[224:227], v[180:183], v[80:83]
  v_cvt_pk_bf16_f32 v40, v76, v77
  v_cvt_pk_bf16_f32 v41, v78, v79
  v_mfma_f32_16x16x32_bf16 v[80:83], v[212:215], a[252:255], v[80:83]
  v_mul_f32 v140, v15, v140
  v_mul_f32 v141, v15, v141
  v_mfma_f32_16x16x32_bf16 v[80:83], v[200:203], a[248:251], v[80:83]
  v_mul_f32 v142, v15, v142
  v_mul_f32 v143, v15, v143
  v_mfma_f32_16x16x32_bf16 v[80:83], v[188:191], a[244:247], v[80:83]
  s_add_u32 m0, s33, 0
  v_cvt_pk_bf16_f32 v140, v140, v141
  v_mfma_f32_16x16x32_bf16 v[76:79], v[192:195], a[244:247], 0
  buffer_load_dwordx4 v6, s[8:11], s48 offen offset:0 nt lds
  v_mfma_f32_16x16x32_bf16 v[76:79], v[204:207], a[248:251], v[76:79]
  v_cvt_pk_bf16_f32 v141, v142, v143
  v_max3_f32 v9, v12, v13, v9
  v_mfma_f32_16x16x32_bf16 v[76:79], v[216:219], a[252:255], v[76:79]
  v_cvt_pk_bf16_f32 v42, v80, v81
  v_cvt_pk_bf16_f32 v43, v82, v83
  v_mfma_f32_16x16x32_bf16 v[76:79], v[228:231], v[180:183], v[76:79]
  ds_write_b32 v5, v140 offset:768
  v_mfma_f32_16x16x32_bf16 v[76:79], v[240:243], v[64:67], v[76:79]
  ds_write_b32 v5, v141 offset:772
  v_mfma_f32_16x16x32_bf16 v[76:79], v[252:255], v[68:71], v[76:79]
  v_rcp_f32 v13, v13
  v_mfma_f32_16x16x32_bf16 v[80:83], a[60:63], v[68:71], 0
  v_mul_f32 v116, v14, v116
  v_mul_f32 v117, v14, v117
  v_mfma_f32_16x16x32_bf16 v[80:83], a[48:51], v[64:67], v[80:83]
  s_add_u32 m0, s33, 8064
  v_mul_f32 v118, v14, v118
  v_mfma_f32_16x16x32_bf16 v[80:83], a[36:39], v[180:183], v[80:83]
  v_cvt_pk_bf16_f32 v44, v76, v77
  v_cvt_pk_bf16_f32 v45, v78, v79
  v_mfma_f32_16x16x32_bf16 v[80:83], a[24:27], a[252:255], v[80:83]
  buffer_load_dwordx4 v6, s[8:11], s48 offen offset:128 nt lds
  v_mfma_f32_16x16x32_bf16 v[80:83], a[12:15], a[248:251], v[80:83]
  v_mul_f32 v119, v14, v119
  v_cvt_pk_bf16_f32 v116, v116, v117
  v_mfma_f32_16x16x32_bf16 v[80:83], a[0:3], a[244:247], v[80:83]
  v_cvt_pk_bf16_f32 v117, v118, v119
  v_mul_f32 v120, v14, v120
  v_mfma_f32_16x16x32_bf16 v[76:79], a[4:7], a[244:247], 0
  ds_write_b32 v4, v116 offset:512
  v_mfma_f32_16x16x32_bf16 v[76:79], a[16:19], a[248:251], v[76:79]
  ds_write_b32 v4, v117 offset:516
  v_mfma_f32_16x16x32_bf16 v[76:79], a[28:31], a[252:255], v[76:79]
  v_cvt_pk_bf16_f32 v46, v80, v81
  v_cvt_pk_bf16_f32 v47, v82, v83
  v_mfma_f32_16x16x32_bf16 v[76:79], a[40:43], v[180:183], v[76:79]
  s_add_u32 m0, s33, 16128
  v_mul_f32 v121, v14, v121
  v_mfma_f32_16x16x32_bf16 v[76:79], a[52:55], v[64:67], v[76:79]
  buffer_load_dwordx4 v6, s[8:11], s48 offen offset:256 nt lds
  v_mfma_f32_16x16x32_bf16 v[76:79], a[64:67], v[68:71], v[76:79]
  v_mul_f32 v122, v14, v122
  v_mul_f32 v123, v14, v123
  v_mfma_f32_16x16x32_bf16 v[80:83], a[68:71], v[68:71], 0
  v_cvt_pk_bf16_f32 v120, v120, v121
  v_cvt_pk_bf16_f32 v121, v122, v123
  v_mfma_f32_16x16x32_bf16 v[80:83], a[56:59], v[64:67], v[80:83]
  ds_write_b32 v4, v120 offset:520
  v_mfma_f32_16x16x32_bf16 v[80:83], a[44:47], v[180:183], v[80:83]
  v_cvt_pk_bf16_f32 v48, v76, v77
  v_cvt_pk_bf16_f32 v49, v78, v79
  v_mfma_f32_16x16x32_bf16 v[80:83], a[32:35], a[252:255], v[80:83]
  ds_write_b32 v4, v121 offset:524
  v_mfma_f32_16x16x32_bf16 v[80:83], a[20:23], a[248:251], v[80:83]
  v_mul_f32 v156, v14, v156
  v_mul_f32 v157, v14, v157
  v_mfma_f32_16x16x32_bf16 v[80:83], a[8:11], a[244:247], v[80:83]
  s_add_u32 m0, s33, 4096
  v_mul_f32 v158, v14, v158
  v_mfma_f32_16x16x32_bf16 v[76:79], a[244:247], a[72:75], 0
  buffer_load_dwordx4 v6, s[8:11], s49 offen offset:0 nt lds
  v_mfma_f32_16x16x32_bf16 v[76:79], a[248:251], a[84:87], v[76:79]
  v_mul_f32 v159, v14, v159
  v_cvt_pk_bf16_f32 v156, v156, v157
  v_mfma_f32_16x16x32_bf16 v[76:79], a[252:255], a[96:99], v[76:79]
  v_cvt_pk_bf16_f32 v50, v80, v81
  v_cvt_pk_bf16_f32 v51, v82, v83
  v_mfma_f32_16x16x32_bf16 v[76:79], v[180:183], a[108:111], v[76:79]
  ds_read_b128 v[72:75], v0 offset:2048
  v_cvt_pk_bf16_f32 v157, v158, v159
  v_mfma_f32_16x16x32_bf16 v[76:79], v[64:67], a[120:123], v[76:79]
  ds_read_b128 v[84:87], v1 offset:2048
  v_mfma_f32_16x16x32_bf16 v[76:79], v[68:71], a[132:135], v[76:79]
  ds_read_b128 v[164:167], v0 offset:10240
  v_mfma_f32_16x16x32_bf16 v[80:83], v[68:71], a[136:139], 0
  ds_read_b128 v[168:171], v1 offset:10240
  v_mfma_f32_16x16x32_bf16 v[80:83], v[64:67], a[124:127], v[80:83]
  ds_read_b128 v[176:179], v0 offset:18432
  v_mfma_f32_16x16x32_bf16 v[80:83], v[180:183], a[112:115], v[80:83]
  v_cvt_pk_bf16_f32 v16, v76, v77
  v_cvt_pk_bf16_f32 v17, v78, v79
  v_mfma_f32_16x16x32_bf16 v[80:83], a[252:255], a[100:103], v[80:83]
  ds_read_b128 v[144:147], v1 offset:18432
  s_add_u32 m0, s33, 12160
  v_mfma_f32_16x16x32_bf16 v[80:83], a[248:251], a[88:91], v[80:83]
  buffer_load_dwordx4 v6, s[8:11], s49 offen offset:128 nt lds
  v_mfma_f32_16x16x32_bf16 v[80:83], a[244:247], a[76:79], v[80:83]
  ds_write_b32 v5, v156 offset:512
  v_mfma_f32_16x16x32_bf16 v[76:79], a[244:247], a[80:83], 0
  ds_write_b32 v5, v157 offset:516
  v_mfma_f32_16x16x32_bf16 v[76:79], a[248:251], a[92:95], v[76:79]
  v_rcp_f32 v12, v12
  v_mfma_f32_16x16x32_bf16 v[76:79], a[252:255], a[104:107], v[76:79]
  v_cvt_pk_bf16_f32 v24, v80, v81
  v_cvt_pk_bf16_f32 v25, v82, v83
  v_mfma_f32_16x16x32_bf16 v[76:79], v[180:183], a[116:119], v[76:79]
  s_add_u32 m0, s33, 20224
  v_mul_f32 v132, v13, v132
  v_mfma_f32_16x16x32_bf16 v[76:79], v[64:67], a[128:131], v[76:79]
  buffer_load_dwordx4 v6, s[8:11], s49 offen offset:256 nt lds
  v_mfma_f32_16x16x32_bf16 v[76:79], v[68:71], a[140:143], v[76:79]
  s_waitcnt lgkmcnt(2)
  v_mul_f32 v133, v13, v133
  v_mfma_f32_16x16x32_bf16 v[80:83], v[184:187], v[72:75], 0
  v_mul_f32 v134, v13, v134
  v_mul_f32 v135, v13, v135
  v_mfma_f32_16x16x32_bf16 v[80:83], v[196:199], v[84:87], v[80:83]
  s_waitcnt vmcnt(12)
  s_lshl2_add_u32 m0, s3, s47
  v_mfma_f32_16x16x32_bf16 v[80:83], v[208:211], v[164:167], v[80:83]
  v_cvt_pk_bf16_f32 v32, v76, v77
  v_cvt_pk_bf16_f32 v33, v78, v79
  v_mfma_f32_16x16x32_bf16 v[80:83], v[220:223], v[168:171], v[80:83]
  ds_write_addtid_b32 v11
  v_mfma_f32_16x16x32_bf16 v[80:83], v[232:235], v[176:179], v[80:83]
  v_mov_b32 v11, 0
  v_cvt_pk_bf16_f32 v132, v132, v133
  v_mfma_f32_16x16x32_bf16 v[80:83], v[244:247], v[144:147], v[80:83]
  s_cmp_eq_u32 s44, s63
  v_cvt_pk_bf16_f32 v133, v134, v135
  v_mfma_f32_16x16x32_bf16 v[76:79], v[248:251], v[144:147], 0
  ds_write_b32 v4, v132 offset:256
  v_mfma_f32_16x16x32_bf16 v[76:79], v[236:239], v[176:179], v[76:79]
  s_cbranch_scc1 L_cl0
L_cb0:
  v_mfma_f32_16x16x32_bf16 v[76:79], v[224:227], v[168:171], v[76:79]
  v_cvt_pk_bf16_f32 v52, v80, v81
  v_cvt_pk_bf16_f32 v53, v82, v83
  v_mfma_f32_16x16x32_bf16 v[76:79], v[212:215], v[164:167], v[76:79]
  ds_write_b32 v4, v133 offset:260
  v_mfma_f32_16x16x32_bf16 v[76:79], v[200:203], v[84:87], v[76:79]
  v_mul_f32 v136, v13, v136
  v_mul_f32 v137, v13, v137
  v_mfma_f32_16x16x32_bf16 v[76:79], v[188:191], v[72:75], v[76:79]
  v_mul_f32 v138, v13, v138
  v_mul_f32 v139, v13, v139
  v_mfma_f32_16x16x32_bf16 v[80:83], v[192:195], v[72:75], 0
  v_cvt_pk_bf16_f32 v136, v136, v137
  v_cvt_pk_bf16_f32 v137, v138, v139
  v_mfma_f32_16x16x32_bf16 v[80:83], v[204:207], v[84:87], v[80:83]
  ds_write_b32 v4, v136 offset:264
  v_mfma_f32_16x16x32_bf16 v[80:83], v[216:219], v[164:167], v[80:83]
  v_cvt_pk_bf16_f32 v54, v76, v77
  v_cvt_pk_bf16_f32 v55, v78, v79
  v_mfma_f32_16x16x32_bf16 v[80:83], v[228:231], v[168:171], v[80:83]
  ds_write_b32 v4, v137 offset:268
  v_mfma_f32_16x16x32_bf16 v[80:83], v[240:243], v[176:179], v[80:83]
  v_mul_f32 v160, v13, v160
  v_mul_f32 v161, v13, v161
  v_mfma_f32_16x16x32_bf16 v[80:83], v[252:255], v[144:147], v[80:83]
  v_mul_f32 v162, v13, v162
  v_mul_f32 v163, v13, v163
  v_mfma_f32_16x16x32_bf16 v[76:79], a[60:63], v[144:147], 0
  v_cvt_pk_bf16_f32 v160, v160, v161
  v_cvt_pk_bf16_f32 v161, v162, v163
  v_mfma_f32_16x16x32_bf16 v[76:79], a[48:51], v[176:179], v[76:79]
  ds_write_b32 v5, v160 offset:256
  v_mfma_f32_16x16x32_bf16 v[76:79], a[36:39], v[168:171], v[76:79]
  v_cvt_pk_bf16_f32 v56, v80, v81
  v_cvt_pk_bf16_f32 v57, v82, v83
  v_mfma_f32_16x16x32_bf16 v[76:79], a[24:27], v[164:167], v[76:79]
  ds_write_b32 v5, v161 offset:260
  v_mfma_f32_16x16x32_bf16 v[76:79], a[12:15], v[84:87], v[76:79]
  v_mul_f32 v148, v12, v148
  v_mul_f32 v149, v12, v149
  v_mfma_f32_16x16x32_bf16 v[76:79], a[0:3], v[72:75], v[76:79]
  v_mul_f32 v150, v12, v150
  v_mul_f32 v151, v12, v151
  v_mfma_f32_16x16x32_bf16 v[80:83], a[4:7], v[72:75], 0
  v_cvt_pk_bf16_f32 v148, v148, v149
  v_cvt_pk_bf16_f32 v149, v150, v151
  v_mfma_f32_16x16x32_bf16 v[80:83], a[16:19], v[84:87], v[80:83]
  ds_write_b32 v4, v148 offset:0
  v_mfma_f32_16x16x32_bf16 v[80:83], a[28:31], v[164:167], v[80:83]
  v_cvt_pk_bf16_f32 v58, v76, v77
  v_cvt_pk_bf16_f32 v59, v78, v79
  v_mfma_f32_16x16x32_bf16 v[80:83], a[40:43], v[168:171], v[80:83]
  ds_write_b32 v4, v149 offset:4
  v_mfma_f32_16x16x32_bf16 v[80:83], a[52:55], v[176:179], v[80:83]
  v_mul_f32 v152, v12, v152
  v_mul_f32 v153, v12, v153
  v_mfma_f32_16x16x32_bf16 v[80:83], a[64:67], v[144:147], v[80:83]
  v_mul_f32 v154, v12, v154
  v_mul_f32 v155, v12, v155
  v_mfma_f32_16x16x32_bf16 v[76:79], a[68:71], v[144:147], 0
  v_cvt_pk_bf16_f32 v152, v152, v153
  v_cvt_pk_bf16_f32 v153, v154, v155
  v_mfma_f32_16x16x32_bf16 v[76:79], a[56:59], v[176:179], v[76:79]
  ds_write_b32 v4, v152 offset:8
  v_mfma_f32_16x16x32_bf16 v[76:79], a[44:47], v[168:171], v[76:79]
  v_cvt_pk_bf16_f32 v60, v80, v81
  v_cvt_pk_bf16_f32 v61, v82, v83
  v_mfma_f32_16x16x32_bf16 v[76:79], a[32:35], v[164:167], v[76:79]
  ds_write_b32 v4, v153 offset:12
  v_mfma_f32_16x16x32_bf16 v[76:79], a[20:23], v[84:87], v[76:79]
  v_mul_f32 v172, v12, v172
  v_mul_f32 v173, v12, v173
  v_mfma_f32_16x16x32_bf16 v[76:79], a[8:11], v[72:75], v[76:79]
  v_mul_f32 v174, v12, v174
  v_mul_f32 v175, v12, v175
  v_mfma_f32_16x16x32_bf16 v[80:83], v[72:75], a[72:75], 0
  v_cvt_pk_bf16_f32 v172, v172, v173
  v_cvt_pk_bf16_f32 v173, v174, v175
  v_mfma_f32_16x16x32_bf16 v[80:83], v[84:87], a[84:87], v[80:83]
  ds_write_b32 v5, v172 offset:0
  v_mfma_f32_16x16x32_bf16 v[80:83], v[164:167], a[96:99], v[80:83]
  v_cvt_pk_bf16_f32 v62, v76, v77
  v_cvt_pk_bf16_f32 v63, v78, v79
  v_mfma_f32_16x16x32_bf16 v[80:83], v[168:171], a[108:111], v[80:83]
  ds_read_b128 v[116:119], v0 offset:4096
  v_mfma_f32_16x16x32_bf16 v[80:83], v[176:179], a[120:123], v[80:83]
  ds_read_b128 v[124:127], v1 offset:4096
  v_mfma_f32_16x16x32_bf16 v[80:83], v[144:147], a[132:135], v[80:83]
  ds_read_b128 v[120:123], v0 offset:12288
  v_mfma_f32_16x16x32_bf16 v[76:79], v[144:147], a[136:139], 0
  ds_read_b128 v[128:131], v1 offset:12288
  v_mfma_f32_16x16x32_bf16 v[76:79], v[176:179], a[124:127], v[76:79]
  ds_read_b128 v[132:135], v0 offset:20480
  v_mfma_f32_16x16x32_bf16 v[76:79], v[168:171], a[112:115], v[76:79]
  v_cvt_pk_bf16_f32 v18, v80, v81
  v_cvt_pk_bf16_f32 v19, v82, v83
  v_mfma_f32_16x16x32_bf16 v[76:79], v[164:167], a[100:103], v[76:79]
  ds_read_b128 v[140:143], v1 offset:20480
  v_mfma_f32_16x16x32_bf16 v[76:79], v[84:87], a[88:91], v[76:79]
  ds_write_b32 v5, v173 offset:4
  v_mfma_f32_16x16x32_bf16 v[76:79], v[72:75], a[76:79], v[76:79]
  v_subrev_u32 v3, s7, v3
  v_subrev_u32 v2, s7, v2
  v_mfma_f32_16x16x32_bf16 v[80:83], v[72:75], a[80:83], 0
  v_add_u32 v4, s7, v4
  v_add_u32 v5, s7, v5
  v_mfma_f32_16x16x32_bf16 v[80:83], v[84:87], a[92:95], v[80:83]
  s_sub_u32 s7, 0, s7
  v_max3_f32 v9, v12, v13, v9
  v_mfma_f32_16x16x32_bf16 v[80:83], v[164:167], a[104:107], v[80:83]
  v_cvt_pk_bf16_f32 v26, v76, v77
  v_cvt_pk_bf16_f32 v27, v78, v79
  v_mfma_f32_16x16x32_bf16 v[80:83], v[168:171], a[116:119], v[80:83]
  v_max3_f32 v9, v14, v15, v9
  v_mfma_f32_16x16x32_bf16 v[80:83], v[176:179], a[128:131], v[80:83]
L_hop4:
  s_cbranch_execz L_hopped
  v_mfma_f32_16x16x32_bf16 v[80:83], v[144:147], a[140:143], v[80:83]
  s_waitcnt lgkmcnt(1)
  v_mfma_f32_16x16x32_bf16 v[148:151], v[184:187], v[116:119], 0
  v_mfma_f32_16x16x32_bf16 v[148:151], v[196:199], v[124:127], v[148:151]
  v_mfma_f32_16x16x32_bf16 v[148:151], v[208:211], v[120:123], v[148:151]
  v_cvt_pk_bf16_f32 v34, v80, v81
  v_cvt_pk_bf16_f32 v35, v82, v83
  v_mfma_f32_16x16x32_bf16 v[148:151], v[220:223], v[128:131], v[148:151]
  v_mfma_f32_16x16x32_bf16 v[148:151], v[232:235], v[132:135], v[148:151]
  v_mfma_f32_16x16x32_bf16 v[148:151], v[244:247], v[140:143], v[148:151]
  v_mfma_f32_16x16x32_bf16 v[156:159], v[248:251], v[140:143], 0
  v_mfma_f32_16x16x32_bf16 v[156:159], v[236:239], v[132:135], v[156:159]
  v_mfma_f32_16x16x32_bf16 v[156:159], v[224:227], v[128:131], v[156:159]
  v_cvt_pk_bf16_f32 v64, v148, v149
  v_cvt_pk_bf16_f32 v65, v150, v151
  v_mfma_f32_16x16x32_bf16 v[156:159], v[212:215], v[120:123], v[156:159]
  v_mfma_f32_16x16x32_bf16 v[156:159], v[200:203], v[124:127], v[156:159]
  v_mfma_f32_16x16x32_bf16 v[156:159], v[188:191], v[116:119], v[156:159]
  v_mfma_f32_16x16x32_bf16 v[148:151], v[192:195], v[116:119], 0
  v_mfma_f32_16x16x32_bf16 v[148:151], v[204:207], v[124:127], v[148:151]
  v_mfma_f32_16x16x32_bf16 v[148:151], v[216:219], v[120:123], v[148:151]
  v_cvt_pk_bf16_f32 v66, v156, v157
  v_cvt_pk_bf16_f32 v67, v158, v159
  v_mfma_f32_16x16x32_bf16 v[148:151], v[228:231], v[128:131], v[148:151]
  s_mov_b32 m0, s47
  s_xor_b32 s47, s47, 1024
  v_mfma_f32_16x16x32_bf16 v[148:151], v[240:243], v[132:135], v[148:151]
  s_add_u32 s40, s50, s52
  s_add_u32 s41, s50, s53
  v_mfma_f32_16x16x32_bf16 v[148:151], v[252:255], v[140:143], v[148:151]
  s_add_u32 s42, s50, s54
  s_add_u32 s43, s50, s55
  v_mfma_f32_16x16x32_bf16 v[156:159], a[60:63], v[140:143], 0
  s_cmp_ge_u32 s6, 94765056
  s_cselect_b64 vcc, -1, 0
  v_mfma_f32_16x16x32_bf16 v[156:159], a[48:51], v[132:135], v[156:159]
  s_mov_b32 s50, s51
  s_mov_b32 s51, s6
  v_mfma_f32_16x16x32_bf16 v[156:159], a[36:39], v[128:131], v[156:159]
  v_cvt_pk_bf16_f32 v68, v148, v149
  v_cvt_pk_bf16_f32 v69, v150, v151
  v_mfma_f32_16x16x32_bf16 v[156:159], a[24:27], v[120:123], v[156:159]
  s_mov_b32 s6, s48
  s_add_u32 s36, s32, s33
  v_mfma_f32_16x16x32_bf16 v[156:159], a[12:15], v[124:127], v[156:159]
  s_mov_b32 s33, s32
  s_sub_u32 s32, s34, s36
  v_mfma_f32_16x16x32_bf16 v[156:159], a[0:3], v[116:119], v[156:159]
  v_mfma_f32_16x16x32_bf16 v[148:151], a[4:7], v[116:119], 0
  v_mfma_f32_16x16x32_bf16 v[148:151], a[16:19], v[124:127], v[148:151]
  v_mfma_f32_16x16x32_bf16 v[148:151], a[28:31], v[120:123], v[148:151]
  v_cvt_pk_bf16_f32 v76, v156, v157
  v_cvt_pk_bf16_f32 v77, v158, v159
  v_mfma_f32_16x16x32_bf16 v[148:151], a[40:43], v[128:131], v[148:151]
  v_mfma_f32_16x16x32_bf16 v[148:151], a[52:55], v[132:135], v[148:151]
  v_mfma_f32_16x16x32_bf16 v[148:151], a[64:67], v[140:143], v[148:151]
  v_mfma_f32_16x16x32_bf16 v[156:159], a[68:71], v[140:143], 0
  v_mfma_f32_16x16x32_bf16 v[156:159], a[56:59], v[132:135], v[156:159]
  v_mfma_f32_16x16x32_bf16 v[156:159], a[44:47], v[128:131], v[156:159]
  v_cvt_pk_bf16_f32 v78, v148, v149
  v_cvt_pk_bf16_f32 v79, v150, v151
  v_mfma_f32_16x16x32_bf16 v[156:159], a[32:35], v[120:123], v[156:159]
  v_mfma_f32_16x16x32_bf16 v[156:159], a[20:23], v[124:127], v[156:159]
  v_mfma_f32_16x16x32_bf16 v[156:159], a[8:11], v[116:119], v[156:159]
  v_mfma_f32_16x16x32_bf16 v[148:151], v[116:119], a[72:75], 0
  v_mfma_f32_16x16x32_bf16 v[148:151], v[124:127], a[84:87], v[148:151]
  v_mfma_f32_16x16x32_bf16 v[148:151], v[120:123], a[96:99], v[148:151]
  v_cvt_pk_bf16_f32 v80, v156, v157
  v_cvt_pk_bf16_f32 v81, v158, v159
  v_mfma_f32_16x16x32_bf16 v[148:151], v[128:131], a[108:111], v[148:151]
  ds_read_b128 v[136:139], v0 offset:6144
  v_mfma_f32_16x16x32_bf16 v[148:151], v[132:135], a[120:123], v[148:151]
  ds_read_b128 v[144:147], v1 offset:6144
  v_mfma_f32_16x16x32_bf16 v[148:151], v[140:143], a[132:135], v[148:151]
  ds_read_b128 v[152:155], v0 offset:14336
  v_mfma_f32_16x16x32_bf16 v[156:159], v[140:143], a[136:139], 0
  ds_read_b128 v[160:163], v1 offset:14336
  v_mfma_f32_16x16x32_bf16 v[156:159], v[132:135], a[124:127], v[156:159]
  ds_read_b128 v[164:167], v0 offset:22528
  v_mfma_f32_16x16x32_bf16 v[156:159], v[128:131], a[112:115], v[156:159]
  v_cvt_pk_bf16_f32 v20, v148, v149
  v_cvt_pk_bf16_f32 v21, v150, v151
  v_mfma_f32_16x16x32_bf16 v[156:159], v[120:123], a[100:103], v[156:159]
  ds_read_b128 v[172:175], v1 offset:22528
  v_mfma_f32_16x16x32_bf16 v[156:159], v[124:127], a[88:91], v[156:159]
  v_mfma_f32_16x16x32_bf16 v[156:159], v[116:119], a[76:79], v[156:159]
  v_mfma_f32_16x16x32_bf16 v[148:151], v[116:119], a[80:83], 0
  s_cmp_eq_u32 s44, s60
  v_mfma_f32_16x16x32_bf16 v[148:151], v[124:127], a[92:95], v[148:151]
  v_mfma_f32_16x16x32_bf16 v[148:151], v[120:123], a[104:107], v[148:151]
  v_cvt_pk_bf16_f32 v28, v156, v157
  v_cvt_pk_bf16_f32 v29, v158, v159
  v_mfma_f32_16x16x32_bf16 v[148:151], v[128:131], a[116:119], v[148:151]
  s_cbranch_scc1 L_cl1
L_cb1:
  v_mfma_f32_16x16x32_bf16 v[148:151], v[132:135], a[128:131], v[148:151]
  v_mfma_f32_16x16x32_bf16 v[148:151], v[140:143], a[140:143], v[148:151]
  s_waitcnt lgkmcnt(0)
  v_mfma_f32_16x16x32_bf16 v[168:171], v[184:187], v[136:139], 0
  v_mfma_f32_16x16x32_bf16 v[168:171], v[196:199], v[144:147], v[168:171]
  v_mfma_f32_16x16x32_bf16 v[168:171], v[208:211], v[152:155], v[168:171]
  v_cvt_pk_bf16_f32 v36, v148, v149
  v_cvt_pk_bf16_f32 v37, v150, v151
  v_mfma_f32_16x16x32_bf16 v[168:171], v[220:223], v[160:163], v[168:171]
  v_mfma_f32_16x16x32_bf16 v[168:171], v[232:235], v[164:167], v[168:171]
  v_mfma_f32_16x16x32_bf16 v[168:171], v[244:247], v[172:175], v[168:171]
  v_mfma_f32_16x16x32_bf16 v[176:179], v[248:251], v[172:175], 0
  v_mfma_f32_16x16x32_bf16 v[176:179], v[236:239], v[164:167], v[176:179]
  v_mfma_f32_16x16x32_bf16 v[176:179], v[224:227], v[160:163], v[176:179]
  v_cvt_pk_bf16_f32 v70, v168, v169
  v_cvt_pk_bf16_f32 v71, v170, v171
  v_mfma_f32_16x16x32_bf16 v[176:179], v[212:215], v[152:155], v[176:179]
  v_mfma_f32_16x16x32_bf16 v[176:179], v[200:203], v[144:147], v[176:179]
  s_barrier
  v_mfma_f32_16x16x32_bf16 v[176:179], v[188:191], v[136:139], v[176:179]
  ds_read_addtid_b32 v116
  v_mad_i32_i16 v0, v10, 1, s32 op_sel:[1,0,0,0]
  v_mfma_f32_16x16x32_bf16 v[168:171], v[192:195], v[136:139], 0
  v_xor_b32 v1, 64, v0
  v_mfma_f32_16x16x32_bf16 v[168:171], v[204:207], v[144:147], v[168:171]
  v_mfma_f32_16x16x32_bf16 v[168:171], v[216:219], v[152:155], v[168:171]
  v_cvt_pk_bf16_f32 v72, v176, v177
  v_cvt_pk_bf16_f32 v73, v178, v179
  v_mfma_f32_16x16x32_bf16 v[168:171], v[228:231], v[160:163], v[168:171]
  v_mfma_f32_16x16x32_bf16 v[168:171], v[240:243], v[164:167], v[168:171]
  v_mfma_f32_16x16x32_bf16 v[168:171], v[252:255], v[172:175], v[168:171]
  s_waitcnt lgkmcnt(0)
  v_readfirstlane_b32 s36, v116
  v_mfma_f32_16x16x32_bf16 v[176:179], a[60:63], v[172:175], 0
  v_mfma_f32_16x16x32_bf16 v[176:179], a[48:51], v[164:167], v[176:179]
  s_add_u32 s36, s36, s44
  s_min_u32 s36, s36, s13
  v_mfma_f32_16x16x32_bf16 v[176:179], a[36:39], v[160:163], v[176:179]
  v_cvt_pk_bf16_f32 v74, v168, v169
  v_cvt_pk_bf16_f32 v75, v170, v171
  v_mfma_f32_16x16x32_bf16 v[176:179], a[24:27], v[152:155], v[176:179]
  s_max_u32 s45, s45, s36
  s_min_u32 s36, s45, s12
  v_mfma_f32_16x16x32_bf16 v[176:179], a[12:15], v[144:147], v[176:179]
  s_cselect_b32 s48, s46, s62
  s_sub_u32 s37, s45, s36
  v_mfma_f32_16x16x32_bf16 v[176:179], a[0:3], v[136:139], v[176:179]
  s_mul_i32 s36, s36, 1572864
  s_add_u32 s48, s48, s36
  v_mfma_f32_16x16x32_bf16 v[168:171], a[4:7], v[136:139], 0
  s_mul_i32 s36, s37, s14
  s_lshr_b32 s36, s36, 8
  v_mfma_f32_16x16x32_bf16 v[168:171], a[16:19], v[144:147], v[168:171]
  s_mul_i32 s36, s36, s15
  s_add_u32 s48, s48, s36
  v_mfma_f32_16x16x32_bf16 v[168:171], a[28:31], v[152:155], v[168:171]
  v_cvt_pk_bf16_f32 v82, v176, v177
  v_cvt_pk_bf16_f32 v83, v178, v179
  v_mfma_f32_16x16x32_bf16 v[168:171], a[40:43], v[160:163], v[168:171]
  s_mulk_i32 s37, 3072
  s_add_u32 s48, s48, s37
  v_mfma_f32_16x16x32_bf16 v[168:171], a[52:55], v[164:167], v[168:171]
  s_add_u32 s49, s48, 786432
  s_bitset1_b64 s[56:57], s45
  v_mfma_f32_16x16x32_bf16 v[168:171], a[64:67], v[172:175], v[168:171]
  s_add_u32 s44, s44, 4
  s_min_u32 s44, s44, s12
  v_mfma_f32_16x16x32_bf16 v[176:179], a[68:71], v[172:175], 0
  s_cmp_ge_u32 s45, s13
  s_cselect_b32 s63, -2, s63
  v_mfma_f32_16x16x32_bf16 v[176:179], a[56:59], v[164:167], v[176:179]
  v_mfma_f32_16x16x32_bf16 v[176:179], a[44:47], v[160:163], v[176:179]
  v_cvt_pk_bf16_f32 v84, v168, v169
  v_cvt_pk_bf16_f32 v85, v170, v171
  v_mfma_f32_16x16x32_bf16 v[176:179], a[32:35], v[152:155], v[176:179]
  v_mfma_f32_16x16x32_bf16 v[176:179], a[20:23], v[144:147], v[176:179]
  v_mfma_f32_16x16x32_bf16 v[176:179], a[8:11], v[136:139], v[176:179]
  v_mfma_f32_16x16x32_bf16 v[168:171], v[136:139], a[72:75], 0
  v_mfma_f32_16x16x32_bf16 v[168:171], v[144:147], a[84:87], v[168:171]
  v_mfma_f32_16x16x32_bf16 v[168:171], v[152:155], a[96:99], v[168:171]
  v_cvt_pk_bf16_f32 v86, v176, v177
  v_cvt_pk_bf16_f32 v87, v178, v179
  v_mfma_f32_16x16x32_bf16 v[168:171], v[160:163], a[108:111], v[168:171]
  v_mfma_f32_16x16x32_bf16 v[168:171], v[164:167], a[120:123], v[168:171]
  v_mfma_f32_16x16x32_bf16 v[168:171], v[172:175], a[132:135], v[168:171]
  v_mfma_f32_16x16x32_bf16 v[176:179], v[172:175], a[136:139], 0
  v_mfma_f32_16x16x32_bf16 v[176:179], v[164:167], a[124:127], v[176:179]
  v_mfma_f32_16x16x32_bf16 v[176:179], v[160:163], a[112:115], v[176:179]
  v_cvt_pk_bf16_f32 v22, v168, v169
  v_cvt_pk_bf16_f32 v23, v170, v171
  v_mfma_f32_16x16x32_bf16 v[176:179], v[152:155], a[100:103], v[176:179]
  ds_read_b128 a[244:247], v3 offset:0
  v_mfma_f32_16x16x32_bf16 v[176:179], v[144:147], a[88:91], v[176:179]
  ds_read_b128 a[248:251], v3 offset:4096
  v_mfma_f32_16x16x32_bf16 v[176:179], v[136:139], a[76:79], v[176:179]
  ds_read_b128 a[252:255], v3 offset:8192
  v_mfma_f32_16x16x32_bf16 v[168:171], v[136:139], a[80:83], 0
  ds_read_b128 v[180:183], v3 offset:12288
  v_mfma_f32_16x16x32_bf16 v[168:171], v[144:147], a[92:95], v[168:171]
  v_mfma_f32_16x16x32_bf16 v[168:171], v[152:155], a[104:107], v[168:171]
  v_cvt_pk_bf16_f32 v30, v176, v177
  v_cvt_pk_bf16_f32 v31, v178, v179
  v_mfma_f32_16x16x32_bf16 v[168:171], v[160:163], a[116:119], v[168:171]
  s_cmp_lg_u32 s31, 0
  v_mfma_f32_16x16x32_bf16 v[168:171], v[164:167], a[128:131], v[168:171]
  v_mfma_f32_16x16x32_bf16 v[168:171], v[172:175], a[140:143], v[168:171]
  s_cbranch_scc0 L_s
  s_branch L_special
L_cl0:
  v_mov_b32 v11, 1
  v_lshrrev_b32 v180, 16, v10
  buffer_atomic_add v11, v180, s[20:23], 0 offen sc0 sc1
  s_branch L_cb0
L_cl1:
  v_mov_b32 v11, 1
  v_lshrrev_b32 v180, 16, v10
  buffer_atomic_add v11, v180, s[20:23], 0 offen sc0 sc1
  s_branch L_cb1
L_epi:
  ds_write_b32 v4, v124 offset:768
  ds_write_b32 v4, v125 offset:772
  v_pk_mul_f32 v[128:129], v[128:129], v[14:15] op_sel:[0,1] op_sel_hi:[1,1]
  v_pk_mul_f32 v[130:131], v[130:131], v[14:15] op_sel:[0,1] op_sel_hi:[1,1]
  v_cvt_pk_bf16_f32 v128, v128, v129
  v_cvt_pk_bf16_f32 v129, v130, v131
  ds_write_b32 v4, v128 offset:776
  ds_write_b32 v4, v129 offset:780
  v_pk_mul_f32 v[140:141], v[140:141], v[14:15] op_sel:[0,1] op_sel_hi:[1,1]
  v_pk_mul_f32 v[142:143], v[142:143], v[14:15] op_sel:[0,1] op_sel_hi:[1,1]
  v_cvt_pk_bf16_f32 v140, v140, v141
  v_cvt_pk_bf16_f32 v141, v142, v143
  ds_write_b32 v5, v140 offset:768
  ds_write_b32 v5, v141 offset:772
  v_pk_mul_f32 v[116:117], v[116:117], v[14:15] op_sel:[0,0] op_sel_hi:[1,0]
  v_pk_mul_f32 v[118:119], v[118:119], v[14:15] op_sel:[0,0] op_sel_hi:[1,0]
  v_cvt_pk_bf16_f32 v116, v116, v117
  v_cvt_pk_bf16_f32 v117, v118, v119
  v_pk_mul_f32 v[120:121], v[120:121], v[14:15] op_sel:[0,0] op_sel_hi:[1,0]
  v_pk_mul_f32 v[122:123], v[122:123], v[14:15] op_sel:[0,0] op_sel_hi:[1,0]
  v_cvt_pk_bf16_f32 v118, v120, v121
  v_cvt_pk_bf16_f32 v119, v122, v123
  ds_write_b128 v4, v[116:119] offset:512
  v_pk_mul_f32 v[156:157], v[156:157], v[14:15] op_sel:[0,0] op_sel_hi:[1,0]
  v_pk_mul_f32 v[158:159], v[158:159], v[14:15] op_sel:[0,0] op_sel_hi:[1,0]
  v_cvt_pk_bf16_f32 v156, v156, v157
  v_cvt_pk_bf16_f32 v157, v158, v159
  ds_write_b64 v5, v[156:157] offset:512
  s_mul_i32 s36, s5, 768
  s_add_u32 s37, s7, s36
  s_sub_u32 s36, s7, s36
  v_subrev_u32 v3, s37, v3
  v_subrev_u32 v2, s36, v2
  v_max3_f32 v9, v12, v13, v9
  v_rcp_f32 v13, v13
  v_rcp_f32 v12, v12
  s_lshl_b32 s36, s5, 1
  s_add_u32 s37, s36, s4
  s_sub_u32 s36, s36, s4
  s_mul_i32 s37, s37, 196608
  s_mul_i32 s36, s36, 196608
  s_sub_u32 s37, s50, s37
  s_add_u32 s36, s50, s36
  s_add_u32 s40, s37, 1179648
  s_waitcnt lgkmcnt(0)
  s_barrier
  ds_read_b128 a[244:247], v3 offset:768
  ds_read_b128 a[248:251], v3 offset:4864
  v_pk_mul_f32 v[132:133], v[132:133], v[12:13] op_sel:[0,1] op_sel_hi:[1,1]
  v_pk_mul_f32 v[134:135], v[134:135], v[12:13] op_sel:[0,1] op_sel_hi:[1,1]
  v_cvt_pk_bf16_f32 v132, v132, v133
  ds_read_b128 a[252:255], v3 offset:8960
  v_cvt_pk_bf16_f32 v133, v134, v135
  v_pk_mul_f32 v[136:137], v[136:137], v[12:13] op_sel:[0,1] op_sel_hi:[1,1]
  v_pk_mul_f32 v[138:139], v[138:139], v[12:13] op_sel:[0,1] op_sel_hi:[1,1]
  ds_read_b128 v[180:183], v3 offset:13056
  v_cvt_pk_bf16_f32 v134, v136, v137
  v_cvt_pk_bf16_f32 v135, v138, v139
  v_pk_mul_f32 v[160:161], v[160:161], v[12:13] op_sel:[0,1] op_sel_hi:[1,1]
  ds_read_b128 v[64:67], v3 offset:17152
  v_pk_mul_f32 v[162:163], v[162:163], v[12:13] op_sel:[0,1] op_sel_hi:[1,1]
  v_cvt_pk_bf16_f32 v160, v160, v161
  v_cvt_pk_bf16_f32 v161, v162, v163
  ds_read_b128 v[68:71], v3 offset:21248
  v_pk_mul_f32 v[148:149], v[148:149], v[12:13] op_sel:[0,0] op_sel_hi:[1,0]
  v_pk_mul_f32 v[150:151], v[150:151], v[12:13] op_sel:[0,0] op_sel_hi:[1,0]
  v_pk_mul_f32 v[152:153], v[152:153], v[12:13] op_sel:[0,0] op_sel_hi:[1,0]
  v_pk_mul_f32 v[154:155], v[154:155], v[12:13] op_sel:[0,0] op_sel_hi:[1,0]
  s_waitcnt lgkmcnt(4)
  v_mfma_f32_16x16x32_bf16 v[40:43], a[144:147], a[244:247], 0
  v_cvt_pk_bf16_f32 v148, v148, v149
  v_cvt_pk_bf16_f32 v149, v150, v151
  v_mfma_f32_16x16x32_bf16 v[40:43], a[160:163], a[248:251], v[40:43]
  s_waitcnt lgkmcnt(2)
  v_cvt_pk_bf16_f32 v150, v152, v153
  v_mfma_f32_16x16x32_bf16 v[40:43], a[176:179], a[252:255], v[40:43]
  v_cvt_pk_bf16_f32 v151, v154, v155
  v_mfma_f32_16x16x32_bf16 v[40:43], a[192:195], v[180:183], v[40:43]
  s_waitcnt lgkmcnt(0)
  v_mfma_f32_16x16x32_bf16 v[40:43], a[208:211], v[64:67], v[40:43]
  ds_write_b128 v4, v[132:135] offset:256
  v_mfma_f32_16x16x32_bf16 v[40:43], a[224:227], v[68:71], v[40:43]
  ds_write_b64 v5, v[160:161] offset:256
  v_mfma_f32_16x16x32_bf16 v[44:47], a[228:231], v[68:71], 0
  ds_write_b128 v4, v[148:151] offset:0
  v_mfma_f32_16x16x32_bf16 v[44:47], a[212:215], v[64:67], v[44:47]
  v_mul_f32 v172, v12, v172
  v_mul_f32 v173, v12, v173
  v_mfma_f32_16x16x32_bf16 v[44:47], a[196:199], v[180:183], v[44:47]
  v_cvt_pk_bf16_f32 v40, v40, v41
  v_cvt_pk_bf16_f32 v41, v42, v43
  v_mfma_f32_16x16x32_bf16 v[44:47], a[180:183], a[252:255], v[44:47]
  v_mul_f32 v174, v12, v174
  v_mul_f32 v175, v12, v175
  v_mfma_f32_16x16x32_bf16 v[44:47], a[164:167], a[248:251], v[44:47]
  v_cvt_pk_bf16_f32 v172, v172, v173
  v_cvt_pk_bf16_f32 v173, v174, v175
  v_mfma_f32_16x16x32_bf16 v[44:47], a[148:151], a[244:247], v[44:47]
  ds_write_b64 v5, v[172:173] offset:0
  v_mfma_f32_16x16x32_bf16 v[48:51], a[152:155], a[244:247], 0
  ds_read_b128 v[72:75], v2 offset:512
  v_mfma_f32_16x16x32_bf16 v[48:51], a[168:171], a[248:251], v[48:51]
  ds_read_b128 v[56:59], v2 offset:4608
  v_mfma_f32_16x16x32_bf16 v[48:51], a[184:187], a[252:255], v[48:51]
  v_cvt_pk_bf16_f32 v42, v44, v45
  v_cvt_pk_bf16_f32 v43, v46, v47
  v_mfma_f32_16x16x32_bf16 v[48:51], a[200:203], v[180:183], v[48:51]
  buffer_store_dwordx4 v[40:43], v7, s[24:27], s40 offen nt
  v_mfma_f32_16x16x32_bf16 v[48:51], a[216:219], v[64:67], v[48:51]
  ds_read_b128 v[60:63], v2 offset:8704
  v_mfma_f32_16x16x32_bf16 v[48:51], a[232:235], v[68:71], v[48:51]
  ds_read_b128 v[76:79], v2 offset:12800
  v_mfma_f32_16x16x32_bf16 v[52:55], a[236:239], v[68:71], 0
  ds_read_b128 v[80:83], v2 offset:16896
  v_mfma_f32_16x16x32_bf16 v[52:55], a[220:223], v[64:67], v[52:55]
  ds_read_b128 v[84:87], v2 offset:20992
  v_mfma_f32_16x16x32_bf16 v[52:55], a[204:207], v[180:183], v[52:55]
  v_cvt_pk_bf16_f32 v48, v48, v49
  v_cvt_pk_bf16_f32 v49, v50, v51
  v_mfma_f32_16x16x32_bf16 v[52:55], a[188:191], a[252:255], v[52:55]
  v_mfma_f32_16x16x32_bf16 v[52:55], a[172:175], a[248:251], v[52:55]
  s_waitcnt lgkmcnt(6)
  s_barrier
  v_mfma_f32_16x16x32_bf16 v[52:55], a[156:159], a[244:247], v[52:55]
  s_waitcnt lgkmcnt(0)
  ds_read_b128 v[124:127], v3 offset:256
  v_mfma_f32_16x16x32_bf16 v[40:43], a[144:147], v[72:75], 0
  ds_read_b128 v[128:131], v3 offset:4352
  s_add_u32 s41, s36, 786432
  v_mfma_f32_16x16x32_bf16 v[40:43], a[160:163], v[56:59], v[40:43]
  ds_read_b128 v[140:143], v3 offset:8448
  v_mfma_f32_16x16x32_bf16 v[40:43], a[176:179], v[60:63], v[40:43]
  v_cvt_pk_bf16_f32 v50, v52, v53
  v_cvt_pk_bf16_f32 v51, v54, v55
  v_mfma_f32_16x16x32_bf16 v[40:43], a[192:195], v[76:79], v[40:43]
  buffer_store_dwordx4 v[48:51], v8, s[24:27], s40 offen nt
  v_mfma_f32_16x16x32_bf16 v[40:43], a[208:211], v[80:83], v[40:43]
  ds_read_b128 v[116:119], v3 offset:12544
  s_add_u32 s42, s37, 393216
  v_mfma_f32_16x16x32_bf16 v[40:43], a[224:227], v[84:87], v[40:43]
  ds_read_b128 v[120:123], v3 offset:16640
  v_mfma_f32_16x16x32_bf16 v[44:47], a[228:231], v[84:87], 0
  ds_read_b128 v[156:159], v3 offset:20736
  s_add_u32 s43, s36, 0
  v_mfma_f32_16x16x32_bf16 v[44:47], a[212:215], v[80:83], v[44:47]
  v_mfma_f32_16x16x32_bf16 v[44:47], a[196:199], v[76:79], v[44:47]
  v_cvt_pk_bf16_f32 v40, v40, v41
  v_cvt_pk_bf16_f32 v41, v42, v43
  v_mfma_f32_16x16x32_bf16 v[44:47], a[180:183], v[60:63], v[44:47]
  v_mfma_f32_16x16x32_bf16 v[44:47], a[164:167], v[56:59], v[44:47]
  v_mfma_f32_16x16x32_bf16 v[44:47], a[148:151], v[72:75], v[44:47]
  s_waitcnt lgkmcnt(0)
  v_mfma_f32_16x16x32_bf16 v[48:51], a[144:147], v[124:127], 0
  v_mfma_f32_16x16x32_bf16 v[48:51], a[160:163], v[128:131], v[48:51]
  v_mfma_f32_16x16x32_bf16 v[48:51], a[176:179], v[140:143], v[48:51]
  v_cvt_pk_bf16_f32 v42, v44, v45
  v_cvt_pk_bf16_f32 v43, v46, v47
  v_mfma_f32_16x16x32_bf16 v[48:51], a[192:195], v[116:119], v[48:51]
  buffer_store_dwordx4 v[40:43], v7, s[24:27], s41 offen nt
  v_mfma_f32_16x16x32_bf16 v[48:51], a[208:211], v[120:123], v[48:51]
  ds_read_b128 v[16:19], v2 offset:0
  v_mfma_f32_16x16x32_bf16 v[48:51], a[224:227], v[156:159], v[48:51]
  ds_read_b128 v[20:23], v2 offset:4096
  v_max3_f32 v9, v12, v13, v9
  v_mfma_f32_16x16x32_bf16 v[52:55], a[228:231], v[156:159], 0
  ds_read_b128 v[24:27], v2 offset:8192
  v_max3_f32 v9, v14, v15, v9
  v_mfma_f32_16x16x32_bf16 v[52:55], a[212:215], v[120:123], v[52:55]
  ds_read_b128 v[28:31], v2 offset:12288
  v_mfma_f32_16x16x32_bf16 v[52:55], a[196:199], v[116:119], v[52:55]
  v_cvt_pk_bf16_f32 v48, v48, v49
  v_cvt_pk_bf16_f32 v49, v50, v51
  v_mfma_f32_16x16x32_bf16 v[52:55], a[180:183], v[140:143], v[52:55]
  ds_read_b128 v[32:35], v2 offset:16384
  s_lshl_b32 s39, s4, 2
  v_mfma_f32_16x16x32_bf16 v[52:55], a[164:167], v[128:131], v[52:55]
  ds_read_b128 v[36:39], v2 offset:20480
  s_add_u32 s39, s39, 28672
  v_mfma_f32_16x16x32_bf16 v[52:55], a[148:151], v[124:127], v[52:55]
  v_mov_b32 v0, s39
  v_mfma_f32_16x16x32_bf16 v[40:43], a[152:155], v[124:127], 0
  s_mov_b64 s[36:37], 0
  v_mfma_f32_16x16x32_bf16 v[40:43], a[168:171], v[128:131], v[40:43]
  v_cmp_nge_f32 vcc, 0x53800000, v9
  v_mfma_f32_16x16x32_bf16 v[40:43], a[184:187], v[140:143], v[40:43]
  v_cvt_pk_bf16_f32 v50, v52, v53
  v_cvt_pk_bf16_f32 v51, v54, v55
  v_mfma_f32_16x16x32_bf16 v[40:43], a[200:203], v[116:119], v[40:43]
  buffer_store_dwordx4 v[48:51], v7, s[24:27], s42 offen nt
  v_mfma_f32_16x16x32_bf16 v[40:43], a[216:219], v[120:123], v[40:43]
  s_or_b64 vcc, vcc, s[36:37]
  s_cselect_b32 s38, 1, 0
  v_mfma_f32_16x16x32_bf16 v[40:43], a[232:235], v[156:159], v[40:43]
  v_mov_b32 v1, s38
  v_mfma_f32_16x16x32_bf16 v[44:47], a[236:239], v[156:159], 0
  ds_write_b32 v0, v1
  v_mfma_f32_16x16x32_bf16 v[44:47], a[220:223], v[120:123], v[44:47]
  v_mov_b32 v1, 28672
  v_mfma_f32_16x16x32_bf16 v[44:47], a[204:207], v[116:119], v[44:47]
  v_cvt_pk_bf16_f32 v40, v40, v41
  v_cvt_pk_bf16_f32 v41, v42, v43
  v_mfma_f32_16x16x32_bf16 v[44:47], a[188:191], v[140:143], v[44:47]
  v_mfma_f32_16x16x32_bf16 v[44:47], a[172:175], v[128:131], v[44:47]
  v_mfma_f32_16x16x32_bf16 v[44:47], a[156:159], v[124:127], v[44:47]
  s_waitcnt lgkmcnt(1)
  v_mfma_f32_16x16x32_bf16 v[48:51], a[144:147], v[16:19], 0
  v_mfma_f32_16x16x32_bf16 v[48:51], a[160:163], v[20:23], v[48:51]
  v_mfma_f32_16x16x32_bf16 v[48:51], a[176:179], v[24:27], v[48:51]
  v_cvt_pk_bf16_f32 v42, v44, v45
  v_cvt_pk_bf16_f32 v43, v46, v47
  v_mfma_f32_16x16x32_bf16 v[48:51], a[192:195], v[28:31], v[48:51]
  buffer_store_dwordx4 v[40:43], v8, s[24:27], s42 offen nt
  v_mfma_f32_16x16x32_bf16 v[48:51], a[208:211], v[32:35], v[48:51]
  v_mfma_f32_16x16x32_bf16 v[48:51], a[224:227], v[36:39], v[48:51]
  v_mfma_f32_16x16x32_bf16 v[52:55], a[228:231], v[36:39], 0
  v_mfma_f32_16x16x32_bf16 v[52:55], a[212:215], v[32:35], v[52:55]
  v_mfma_f32_16x16x32_bf16 v[52:55], a[196:199], v[28:31], v[52:55]
  v_cvt_pk_bf16_f32 v48, v48, v49
  v_cvt_pk_bf16_f32 v49, v50, v51
  v_mfma_f32_16x16x32_bf16 v[52:55], a[180:183], v[24:27], v[52:55]
  v_mfma_f32_16x16x32_bf16 v[52:55], a[164:167], v[20:23], v[52:55]
  v_mfma_f32_16x16x32_bf16 v[52:55], a[148:151], v[16:19], v[52:55]
  s_nop 7
  v_cvt_pk_bf16_f32 v50, v52, v53
  v_cvt_pk_bf16_f32 v51, v54, v55
  buffer_store_dwordx4 v[48:51], v7, s[24:27], s43 offen nt
  s_waitcnt lgkmcnt(0)
  s_barrier
  ds_read_b128 v[116:119], v1
  s_waitcnt lgkmcnt(0)
  v_or3_b32 v116, v116, v117, v118
  v_or_b32 v116, v116, v119
  s_nop 0
  v_readfirstlane_b32 s36, v116
  s_nop 3
  s_andn2_b32 s36, s36, s31
  s_cbranch_scc1 L_redo
  s_endpgm
L_redo:
  s_mov_b64 s[100:101], s[56:57]
  s_mov_b32 s31, 1
  s_waitcnt vmcnt(0) lgkmcnt(0)
  v_mbcnt_lo_u32_b32 v0, -1, 0
  v_mbcnt_hi_u32_b32 v0, -1, v0
  v_add_u32 v0, s3, v0
  s_barrier
  s_branch L_again
L_special0:
  buffer_load_dwordx4 v6, s[8:11], s49 offen offset:256 nt lds
  s_add_u32 s48, s48, 6291456
  s_add_u32 s49, s48, 786432
  s_add_u32 m0, s32, 65536
  ds_read_b64_tr_b16 a[100:101], v13 offset:49152
  buffer_load_dwordx4 v6, s[8:11], s48 offen offset:0 nt lds
  ds_read_b64_tr_b16 a[102:103], v13 offset:49664
  ds_read_b64_tr_b16 a[104:105], v14 offset:49152
  ds_read_b64_tr_b16 a[106:107], v14 offset:49664
  ds_read_b64_tr_b16 a[108:109], v12 offset:61440
  s_add_u32 m0, s32, 73600
  ds_read_b64_tr_b16 a[110:111], v12 offset:61952
  buffer_load_dwordx4 v6, s[8:11], s48 offen offset:128 nt lds
  ds_read_b64_tr_b16 a[112:113], v13 offset:61440
  ds_read_b64_tr_b16 a[114:115], v13 offset:61952
  ds_read_b64_tr_b16 a[116:117], v14 offset:61440
  ds_read_b64_tr_b16 a[118:119], v14 offset:61952
  s_add_u32 m0, s32, 81664
  s_nop 0
  buffer_load_dwordx4 v6, s[8:11], s48 offen offset:256 nt lds
  s_waitcnt lgkmcnt(0)
  s_waitcnt vmcnt(9)
  s_barrier
  ds_read_b64_tr_b16 a[120:121], v15 offset:0
  ds_read_b64_tr_b16 a[122:123], v15 offset:512
  ds_read_b64_tr_b16 a[124:125], v9 offset:0
  ds_read_b64_tr_b16 a[126:127], v9 offset:512
  ds_read_b64_tr_b16 a[128:129], v11 offset:0
  ds_read_b64_tr_b16 a[130:131], v11 offset:512
  ds_read_b64_tr_b16 a[132:133], v15 offset:12288
  ds_read_b64_tr_b16 a[134:135], v15 offset:12800
  ds_read_b64_tr_b16 a[136:137], v9 offset:12288
  ds_read_b64_tr_b16 a[138:139], v9 offset:12800
  ds_read_b64_tr_b16 a[140:141], v11 offset:12288
  ds_read_b64_tr_b16 a[142:143], v11 offset:12800
  v_mfma_f32_16x16x16_bf16 v[124:127], v[62:63], v[74:75], v[124:127]
  v_mfma_f32_16x16x16_bf16 v[120:123], v[80:81], v[74:75], v[120:123]
  v_mfma_f32_16x16x16_bf16 v[128:131], v[86:87], v[74:75], v[128:131]
  v_mfma_f32_16x16x32_bf16 v[132:135], v[46:49], v[64:67], v[160:163]
  v_mfma_f32_16x16x32_bf16 v[140:143], v[58:61], v[64:67], v[180:183]
  v_mfma_f32_16x16x32_bf16 v[136:139], v[76:79], v[64:67], v[100:103]
  v_mfma_f32_16x16x32_bf16 v[144:147], v[82:85], v[64:67], v[96:99]
  v_mfma_f32_16x16x16_bf16 v[132:135], v[50:51], v[68:69], v[132:135]
  v_mfma_f32_16x16x16_bf16 v[140:143], v[62:63], v[68:69], v[140:143]
  v_mfma_f32_16x16x16_bf16 v[136:139], v[80:81], v[68:69], v[136:139]
  v_mfma_f32_16x16x16_bf16 v[144:147], v[86:87], v[68:69], v[144:147]
  v_mfma_f32_16x16x32_bf16 v[148:151], v[46:49], v[52:55], v[104:107]
  v_mfma_f32_16x16x32_bf16 v[156:159], v[58:61], v[52:55], v[100:103]
  v_mfma_f32_16x16x32_bf16 v[152:155], v[76:79], v[52:55], v[152:155]
  v_mfma_f32_16x16x32_bf16 v[160:163], v[82:85], v[52:55], v[168:171]
  v_mfma_f32_16x16x16_bf16 v[148:151], v[50:51], v[56:57], v[148:151]
  v_mfma_f32_16x16x16_bf16 v[156:159], v[62:63], v[56:57], v[156:159]
  v_mfma_f32_16x16x16_bf16 v[152:155], v[80:81], v[56:57], v[152:155]
  v_mfma_f32_16x16x16_bf16 v[160:163], v[86:87], v[56:57], v[160:163]
  v_mfma_f32_16x16x32_bf16 v[164:167], v[46:49], v[40:43], v[100:103]
  v_mfma_f32_16x16x32_bf16 v[172:175], v[58:61], v[40:43], v[96:99]
  v_mfma_f32_16x16x32_bf16 v[168:171], v[76:79], v[40:43], v[168:171]
  v_mfma_f32_16x16x32_bf16 v[176:179], v[82:85], v[40:43], v[176:179]
  v_mfma_f32_16x16x16_bf16 v[164:167], v[50:51], v[44:45], v[164:167]
  v_mfma_f32_16x16x16_bf16 v[172:175], v[62:63], v[44:45], v[172:175]
  v_mfma_f32_16x16x16_bf16 v[168:171], v[80:81], v[44:45], v[168:171]
  v_mfma_f32_16x16x16_bf16 v[176:179], v[86:87], v[44:45], v[176:179]
  s_branch L_sp2
L_special:
  s_ff1_i32_b64 s44, s[100:101]
  s_bitset0_b64 s[100:101], s44
  s_nop 4
  v_cvt_pk_bf16_f32 v38, v168, v169
  v_cvt_pk_bf16_f32 v39, v170, v171
  v_mfma_f32_16x16x32_bf16 v[116:119], v[46:49], v[70:73], v[112:115]
  v_mfma_f32_16x16x32_bf16 v[124:127], v[58:61], v[70:73], v[108:111]
  v_mfma_f32_16x16x32_bf16 v[120:123], v[76:79], v[70:73], v[104:107]
  v_mfma_f32_16x16x32_bf16 v[128:131], v[82:85], v[70:73], v[100:103]
  v_mfma_f32_16x16x16_bf16 v[116:119], v[50:51], v[74:75], v[116:119]
  v_mfma_f32_16x16x16_bf16 v[124:127], v[62:63], v[74:75], v[124:127]
  v_mfma_f32_16x16x16_bf16 v[120:123], v[80:81], v[74:75], v[120:123]
  v_mfma_f32_16x16x16_bf16 v[128:131], v[86:87], v[74:75], v[128:131]
  v_mfma_f32_16x16x32_bf16 v[132:135], v[46:49], v[64:67], v[108:111]
  v_mfma_f32_16x16x32_bf16 v[140:143], v[58:61], v[64:67], v[104:107]
  v_mfma_f32_16x16x32_bf16 v[136:139], v[76:79], v[64:67], v[100:103]
  v_mfma_f32_16x16x32_bf16 v[144:147], v[82:85], v[64:67], v[96:99]
  v_mfma_f32_16x16x16_bf16 v[132:135], v[50:51], v[68:69], v[132:135]
  v_mfma_f32_16x16x16_bf16 v[140:143], v[62:63], v[68:69], v[140:143]
  v_mfma_f32_16x16x16_bf16 v[136:139], v[80:81], v[68:69], v[136:139]
  v_mfma_f32_16x16x16_bf16 v[144:147], v[86:87], v[68:69], v[144:147]
  v_mfma_f32_16x16x32_bf16 v[148:151], v[46:49], v[52:55], v[104:107]
  v_mfma_f32_16x16x32_bf16 v[156:159], v[58:61], v[52:55], v[100:103]
  v_mfma_f32_16x16x32_bf16 v[152:155], v[76:79], v[52:55], v[96:99]
  v_mfma_f32_16x16x32_bf16 v[160:163], v[82:85], v[52:55], v[92:95]
  v_mfma_f32_16x16x16_bf16 v[148:151], v[50:51], v[56:57], v[148:151]
  v_mfma_f32_16x16x16_bf16 v[156:159], v[62:63], v[56:57], v[156:159]
  v_mfma_f32_16x16x16_bf16 v[152:155], v[80:81], v[56:57], v[152:155]
  v_mfma_f32_16x16x16_bf16 v[160:163], v[86:87], v[56:57], v[160:163]
  v_mfma_f32_16x16x32_bf16 v[164:167], v[46:49], v[40:43], v[100:103]
  v_mfma_f32_16x16x32_bf16 v[172:175], v[58:61], v[40:43], v[96:99]
  v_mfma_f32_16x16x32_bf16 v[168:171], v[76:79], v[40:43], v[92:95]
  v_mfma_f32_16x16x32_bf16 v[176:179], v[82:85], v[40:43], v[88:91]
  v_mfma_f32_16x16x16_bf16 v[164:167], v[50:51], v[44:45], v[164:167]
  v_mfma_f32_16x16x16_bf16 v[172:175], v[62:63], v[44:45], v[172:175]
  v_mfma_f32_16x16x16_bf16 v[168:171], v[80:81], v[44:45], v[168:171]
  v_mfma_f32_16x16x16_bf16 v[176:179], v[86:87], v[44:45], v[176:179]
  ds_read_b128 v[64:67], v3 offset:16384
  ds_read_b128 v[68:71], v3 offset:20480
L_sp2:
  s_nop 15
  v_max_f32 v40, v164, v165
  v_max3_f32 v40, v166, v167, v40
  v_max3_f32 v40, v172, v173, v40
  v_max3_f32 v40, v174, v175, v40
  v_max3_f32 v40, v168, v169, v40
  v_max3_f32 v40, v170, v171, v40
  v_max3_f32 v40, v176, v177, v40
  v_max3_f32 v40, v178, v179, v40
  v_mov_b32 v41, v40
  s_nop 1
  v_permlane32_swap_b32 v40, v41
  v_max_f32 v40, v40, v41
  v_mov_b32 v41, v40
  s_nop 1
  v_permlane16_swap_b32 v40, v41
  v_max_f32 v40, v40, v41
  v_sub_f32 v164, v164, v40
  v_sub_f32 v165, v165, v40
  v_sub_f32 v166, v166, v40
  v_sub_f32 v167, v167, v40
  v_sub_f32 v172, v172, v40
  v_sub_f32 v173, v173, v40
  v_sub_f32 v174, v174, v40
  v_sub_f32 v175, v175, v40
  v_sub_f32 v168, v168, v40
  v_sub_f32 v169, v169, v40
  v_sub_f32 v170, v170, v40
  v_sub_f32 v171, v171, v40
  v_sub_f32 v176, v176, v40
  v_sub_f32 v177, v177, v40
  v_sub_f32 v178, v178, v40
  v_sub_f32 v179, v179, v40
  v_max_f32 v40, v148, v149
  v_max3_f32 v40, v150, v151, v40
  v_max3_f32 v40, v156, v157, v40
  v_max3_f32 v40, v158, v159, v40
  v_max3_f32 v40, v152, v153, v40
  v_max3_f32 v40, v154, v155, v40
  v_max3_f32 v40, v160, v161, v40
  v_max3_f32 v40, v162, v163, v40
  v_mov_b32 v41, v40
  s_nop 1
  v_permlane32_swap_b32 v40, v41
  v_max_f32 v40, v40, v41
  v_mov_b32 v41, v40
  s_nop 1
  v_permlane16_swap_b32 v40, v41
  v_max_f32 v40, v40, v41
  v_sub_f32 v148, v148, v40
  v_sub_f32 v149, v149, v40
  v_sub_f32 v150, v150, v40
  v_sub_f32 v151, v151, v40
  v_sub_f32 v156, v156, v40
  v_sub_f32 v157, v157, v40
  v_sub_f32 v158, v158, v40
  v_sub_f32 v159, v159, v40
  v_sub_f32 v152, v152, v40
  v_sub_f32 v153, v153, v40
  v_sub_f32 v154, v154, v40
  v_sub_f32 v155, v155, v40
  v_sub_f32 v160, v160, v40
  v_sub_f32 v161, v161, v40
  v_sub_f32 v162, v162, v40
  v_sub_f32 v163, v163, v40
  v_max_f32 v40, v132, v133
  v_max3_f32 v40, v134, v135, v40
  v_max3_f32 v40, v140, v141, v40
  v_max3_f32 v40, v142, v143, v40
  v_max3_f32 v40, v136, v137, v40
  v_max3_f32 v40, v138, v139, v40
  v_max3_f32 v40, v144, v145, v40
  v_max3_f32 v40, v146, v147, v40
  v_mov_b32 v41, v40
  s_nop 1
  v_permlane32_swap_b32 v40, v41
  v_max_f32 v40, v40, v41
  v_mov_b32 v41, v40
  s_nop 1
  v_permlane16_swap_b32 v40, v41
  v_max_f32 v40, v40, v41
  v_sub_f32 v132, v132, v40
  v_sub_f32 v133, v133, v40
  v_sub_f32 v134, v134, v40
  v_sub_f32 v135, v135, v40
  v_sub_f32 v140, v140, v40
  v_sub_f32 v141, v141, v40
  v_sub_f32 v142, v142, v40
  v_sub_f32 v143, v143, v40
  v_sub_f32 v136, v136, v40
  v_sub_f32 v137, v137, v40
  v_sub_f32 v138, v138, v40
  v_sub_f32 v139, v139, v40
  v_sub_f32 v144, v144, v40
  v_sub_f32 v145, v145, v40
  v_sub_f32 v146, v146, v40
  v_sub_f32 v147, v147, v40
  v_max_f32 v40, v116, v117
  v_max3_f32 v40, v118, v119, v40
  v_max3_f32 v40, v124, v125, v40
  v_max3_f32 v40, v126, v127, v40
  v_max3_f32 v40, v120, v121, v40
  v_max3_f32 v40, v122, v123, v40
  v_max3_f32 v40, v128, v129, v40
  v_max3_f32 v40, v130, v131, v40
  v_mov_b32 v41, v40
  s_nop 1
  v_permlane32_swap_b32 v40, v41
  v_max_f32 v40, v40, v41
  v_mov_b32 v41, v40
  s_nop 1
  v_permlane16_swap_b32 v40, v41
  v_max_f32 v40, v40, v41
  v_sub_f32 v116, v116, v40
  v_sub_f32 v117, v117, v40
  v_sub_f32 v118, v118, v40
  v_sub_f32 v119, v119, v40
  v_sub_f32 v124, v124, v40
  v_sub_f32 v125, v125, v40
  v_sub_f32 v126, v126, v40
  v_sub_f32 v127, v127, v40
  v_sub_f32 v120, v120, v40
  v_sub_f32 v121, v121, v40
  v_sub_f32 v122, v122, v40
  v_sub_f32 v123, v123, v40
  v_sub_f32 v128, v128, v40
  v_sub_f32 v129, v129, v40
  v_sub_f32 v130, v130, v40
  v_sub_f32 v131, v131, v40
  v_exp_f32 v116, v116
  v_exp_f32 v117, v117
  v_exp_f32 v118, v118
  v_exp_f32 v119, v119
  v_cvt_pk_bf16_f32 v116, v116, v117
  v_cvt_pk_bf16_f32 v117, v118, v119
  v_exp_f32 v124, v124
  v_exp_f32 v125, v125
  v_exp_f32 v126, v126
  s_waitcnt lgkmcnt(0)
  s_nop 7
  s_cmp_eq_u32 s35, 1
  s_cbranch_scc1 L_enter
  v_exp_f32 v127, v127
  v_cvt_pk_bf16_f32 v118, v124, v125
  v_cvt_pk_bf16_f32 v119, v126, v127
  v_exp_f32 v120, v120
  v_exp_f32 v121, v121
  v_exp_f32 v122, v122
  v_exp_f32 v123, v123
  v_cvt_pk_bf16_f32 v120, v120, v121
  v_cvt_pk_bf16_f32 v121, v122, v123
  v_exp_f32 v128, v128
  v_exp_f32 v129, v129
  v_exp_f32 v130, v130
  v_exp_f32 v131, v131
  v_cvt_pk_bf16_f32 v122, v128, v129
  v_cvt_pk_bf16_f32 v123, v130, v131
  v_exp_f32 v132, v132
  v_exp_f32 v133, v133
  v_exp_f32 v134, v134
  v_cvt_pk_bf16_f32 v132, v132, v133
  s_nop 7
  s_branch L_pj
L_end:
  s_endpgm
.fill (standalone__window_attn_swin__vision_kernel + 33280 - .) / 4, 4, 0xbf810000
.section .rodata,"a"
.p2align 6
.amdhsa_kernel standalone__window_attn_swin__vision_kernel
  .amdhsa_next_free_vgpr 512
  .amdhsa_next_free_sgpr 102
  .amdhsa_accum_offset 256
  .amdhsa_group_segment_fixed_size 0
  .amdhsa_kernarg_size 72
  .amdhsa_user_sgpr_count 2
  .amdhsa_user_sgpr_kernarg_segment_ptr 1
  .amdhsa_system_sgpr_workgroup_id_x 1
.end_amdhsa_kernel
```

```asm
; @launch grid=(256,1,1) block=(256,1,1) lds=163840
.amdgcn_target "amdgcn-amd-amdhsa--gfx950"
.text
.globl standalone__window_attn_swin__vision_kernel
.p2align 12
.type standalone__window_attn_swin__vision_kernel,@function
standalone__window_attn_swin__vision_kernel:
  s_mov_b32 s31, 0
  s_mov_b64 s[56:57], 0
L_again:
  s_load_dwordx2 s[8:9], s[0:1], 0
  s_load_dwordx2 s[12:13], s[0:1], 8
  s_cmpk_ge_u32 s2, 256
  s_cbranch_scc1 L_end
  s_getpc_b64 s[42:43]
  s_lshr_b32 s44, s2, 3
  s_lshl_b32 s45, s44, 10
  v_lshl_add_u32 v2, v0, 2, s45
  v_mov_b32 v3, 0
  v_lshl_add_u64 v[2:3], v[2:3], 0, s[42:43]
  global_load_dword v64, v[2:3], off
  v_readfirstlane_b32 s3, v0
  s_load_dwordx2 s[20:21], s[0:1], 24
  s_mov_b32 s11, 0x20000
  s_mov_b32 s15, s11
  s_mov_b32 s14, 223232
  s_mulk_i32 s44, 6912
  v_lshlrev_b32 v26, 5, v0
  s_lshr_b32 s28, s2, 2
  s_or_b32 s28, s28, 1
  s_and_b32 s29, s2, 1
  s_sub_u32 s28, s28, s29
  s_bfe_u32 s29, s2, 0x20001
  s_lshr_b32 s4, s3, 6
  s_lshl_b32 s36, s28, 3
  v_bfe_u32 v21, v0, 3, 3
  v_add3_u32 v25, s36, 4, v21
  v_and_b32 v25, 0x1ff, v25
  v_mul_u32_u24 v25, 0x180, v25
  v_lshrrev_b32 v23, 4, v0
  v_lshrrev_b32 v24, 1, v0
  v_and_b32 v24, 4, v24
  v_bitop3_b32 v24, v24, v23, v0 bitop3:0x96
  v_and_b32 v24, 7, v24
  v_lshl_add_u32 v6, v24, 4, v25
  s_lshl3_add_u32 s36, s29, s4
  s_add_u32 s48, s36, 484
  s_add_u32 s49, s48, 4
  s_and_b32 s49, s49, 0x1ff
  s_mov_b32 s37, 196608
  s_mul_i32 s48, s48, s37
  s_mul_i32 s49, s49, s37
  s_mov_b32 s10, 100663296
  s_waitcnt lgkmcnt(0)
  s_sub_u32 s12, s12, 2048
  s_subb_u32 s13, s13, 0
  buffer_load_dword v65, v26, s[12:15], s44 offen offset:2048
  v_and_b32 v22, 4, v23
  v_and_b32 v24, 2, v21
  v_bitop3_b32 v24, v24, v22, v0 bitop3:0x96
  v_and_b32 v24, 7, v24
  v_mul_u32_u24 v25, 1152, v21
  v_lshl_add_u32 v25, v24, 4, v25
  v_add_u32 v136, 2048, v25
  v_add_u32 v137, 1152, v25
  v_add_u32 v138, 256, v25
  s_mul_i32 s62, s4, 9216
  s_mul_i32 s58, s4, 3072
  s_add_u32 s63, s58, 40960
  s_mov_b32 s22, 1800
  s_mov_b32 s23, s11
  v_lshlrev_b32 v34, 4, v0
  s_lshl_b32 s37, s4, 10
  s_add_u32 m0, s37, 24576
  v_mul_u32_u24 v35, 9, v0
  buffer_load_dwordx4 v34, s[20:23], 0 offen lds
  v_and_b32 v35, -4, v35
  s_load_dwordx2 s[16:17], s[0:1], 16
  s_load_dwordx2 s[24:25], s[0:1], 48
  s_load_dwordx2 s[20:21], s[0:1], 56
  v_and_b32 v16, 63, v0
  v_and_b32 v17, 15, v16
  v_lshrrev_b32 v18, 4, v16
  v_lshrrev_b32 v20, 2, v17
  v_and_b32 v27, 1, v18
  s_add_u32 m0, s63, 0
  s_add_u32 s36, s62, 0
  buffer_load_dwordx4 v136, s[12:15], s36 offen offset:0 lds
  v_lshrrev_b32 v28, 3, v17
  v_lshl_add_u32 v21, v27, 1, v28
  v_mul_u32_u24 v22, 3072, v18
  v_lshl_add_u32 v22, v20, 7, v22
  v_lshl_add_u32 v22, v21, 5, v22
  v_and_b32 v29, 3, v17
  v_lshl_add_u32 v22, v29, 3, v22
  s_mul_i32 s37, s4, 3
  buffer_load_dwordx4 v137, s[12:15], s36 offen offset:1024 lds
  s_and_b32 s38, s37, 3
  s_lshl_b32 s38, s38, 5
  s_lshr_b32 s39, s37, 2
  s_lshl_b32 s39, s39, 10
  s_add_u32 s39, s39, 40960
  v_xor_b32 v23, s38, v22
  v_add_u32 v12, s39, v23
  v_add_u32 v15, 73728, v12
  buffer_load_dwordx4 v138, s[12:15], s36 offen offset:2048 lds
  s_add_u32 s37, s37, 1
  s_and_b32 s38, s37, 3
  s_lshl_b32 s38, s38, 5
  s_lshr_b32 s39, s37, 2
  s_lshl_b32 s39, s39, 10
  s_add_u32 s39, s39, 40960
  s_mov_b64 exec, 0
  s_cmp_eq_u32 s4, 0
  s_cbranch_scc1 L_hop0
  s_cmp_eq_u32 s4, 1
  s_cbranch_scc1 L_hop1
  s_cmp_eq_u32 s4, 2
  s_cbranch_scc1 L_hop2
  s_branch L_hop3
L_hopped:
  s_mov_b64 exec, -1
  v_xor_b32 v23, s38, v22
  s_add_u32 m0, s63, 12288
  s_add_u32 s36, s62, 36864
  buffer_load_dwordx4 v136, s[12:15], s36 offen offset:0 lds
  v_add_u32 v13, s39, v23
  v_add_u32 v9, 73728, v13
  s_add_u32 s37, s37, 1
  s_and_b32 s38, s37, 3
  s_lshl_b32 s38, s38, 5
  s_lshr_b32 s39, s37, 2
  s_lshl_b32 s39, s39, 10
  s_add_u32 s39, s39, 40960
  buffer_load_dwordx4 v137, s[12:15], s36 offen offset:1024 lds
  v_xor_b32 v23, s38, v22
  v_add_u32 v14, s39, v23
  v_add_u32 v11, 73728, v14
  s_mov_b32 s46, 0x3e553b95
  s_mov_b32 s47, s46
  s_mov_b32 s44, 0xffff0000
  v_bfe_u32 v19, v17, 1, 3
  v_and_b32 v21, 1, v17
  buffer_load_dwordx4 v138, s[12:15], s36 offen offset:2048 lds
  v_lshlrev_b32 v21, 2, v21
  v_xor_b32 v19, v19, v21
  v_xor_b32 v21, v18, v19
  v_lshlrev_b32 v21, 4, v21
  v_lshl_add_u32 v0, v17, 7, v21
  s_lshl_b32 s32, s4, 10
  v_subrev_u32 v10, s32, v0
  v_and_b32 v21, 1, v17
  s_add_u32 m0, s63, 24576
  s_add_u32 s36, s62, 73728
  buffer_load_dwordx4 v136, s[12:15], s36 offen offset:0 lds
  v_mul_u32_u24 v21, 0xaaaa, v21
  v_add_u32 v21, 0x4444, v21
  v_lshl_add_u32 v10, v10, 16, v21
  v_xor_b32 v1, 64, v0
  v_lshlrev_b32 v22, 4, v17
  v_lshl_add_u32 v23, v18, 10, v22
  s_and_b32 s5, s4, 1
  s_lshl_b32 s37, s5, 9
  s_add_u32 s38, s37, 114688
  v_add_u32 v3, s38, v23
  s_sub_u32 s38, 114688, s37
  v_add_u32 v2, s38, v23
  s_lshl_b32 s37, s4, 12
  s_add_u32 s37, s37, 90112
  v_add_u32 v4, s37, v23
  s_lshl_b32 s37, s4, 11
  s_add_u32 s37, s37, 106496
  v_lshrrev_b32 v23, 1, v18
  v_lshl_add_u32 v24, v23, 10, v22
  v_lshl_add_u32 v24, v27, 3, v24
  v_add_u32 v5, s37, v24
  s_mov_b32 s7, 24576
  v_sub_u32 v24, v28, v23
  v_mul_i32_i24 v24, 15, v24
  v_and_b32 v26, 7, v17
  v_lshlrev_b32 v25, 2, v27
  v_sub_u32 v30, v26, v25
  v_add3_u32 v24, v24, v30, 19
  s_lshl_b32 s37, s4, 1
  s_and_b32 s37, s37, 0
  s_waitcnt lgkmcnt(0)
  s_mov_b32 s18, 73728
  s_mov_b32 s19, s11
  s_mul_i32 s60, s4, 0x02020000
  s_add_u32 s60, s60, 0x01000c0c
  s_add_u32 s37, s37, 24576
  v_lshl_add_u32 v144, v24, 3, s37
  v_add_u32 v145, 960, v144
  s_lshl_b32 s37, s28, 3
  v_add3_u32 v24, s37, 4, v26
  v_and_b32 v24, 0x1ff, v24
  v_mul_u32_u24 v24, 0x180, v24
  v_mul_u32_u24 v26, 196608, v28
  v_add_u32 v24, v24, v26
  v_lshl_add_u32 v24, v18, 4, v24
  s_lshr_b32 s37, s4, 1
  s_lshl_b32 s38, s37, 6
  s_add_u32 s39, s38, 256
  v_add_u32 v8, s39, v24
  s_lshl_b32 s39, s5, 7
  s_add_u32 s38, s38, s39
  v_add_u32 v7, s38, v24
  v_and_b32 v24, 16, v16
  v_lshlrev_b32 v24, 2, v24
  v_lshlrev_b32 v26, 4, v16
  v_xor_b32 v24, v24, v26
  v_accvgpr_write_b32 a228, v24
  v_add_u32 v30, v25, v20
  v_mul_u32_u24 v31, 3072, v23
  v_lshl_add_u32 v31, v29, 4, v31
  v_mad_u32_u24 v32, v30, 3, s5
  v_lshrrev_b32 v33, 1, v32
  v_xor_b32 v33, s37, v33
  v_and_b32 v33, 1, v33
  v_lshl_add_u32 v32, v32, 1, v33
  buffer_load_dwordx4 v137, s[12:15], s36 offen offset:1024 lds
  v_lshl_add_u32 v32, v32, 6, v31
  v_add_u32 v32, 114688, v32
  v_accvgpr_write_b32 a229, v32
  v_mad_u32_u24 v32, v30, 3, 2
  v_lshrrev_b32 v33, 1, v32
  v_xor_b32 v33, s37, v33
  v_and_b32 v33, 1, v33
  v_lshl_add_u32 v32, v32, 1, v33
  v_lshl_add_u32 v32, v32, 6, v31
  v_add_u32 v32, 114688, v32
  v_accvgpr_write_b32 a230, v32
  v_mul_u32_u24 v31, 3072, v18
  buffer_load_dwordx4 v138, s[12:15], s36 offen offset:2048 lds
  v_lshl_add_u32 v31, v29, 4, v31
  v_mad_u32_u24 v32, v20, 3, s5
  v_lshrrev_b32 v33, 1, v32
  v_xor_b32 v33, s37, v33
  v_and_b32 v33, 1, v33
  v_lshl_add_u32 v32, v32, 1, v33
  v_lshl_add_u32 v32, v32, 6, v31
  v_accvgpr_write_b32 a231, v32
  v_mad_u32_u24 v32, v20, 3, 2
  v_lshrrev_b32 v33, 1, v32
  v_xor_b32 v33, s37, v33
  v_and_b32 v33, 1, v33
  s_add_u32 m0, s63, 36864
  s_add_u32 s36, s62, 110592
  buffer_load_dwordx4 v136, s[12:15], s36 offen offset:0 lds
  v_lshl_add_u32 v32, v32, 1, v33
  v_lshl_add_u32 v32, v32, 6, v31
  v_accvgpr_write_b32 a232, v32
  s_mul_i32 s59, s37, 12288
  s_add_u32 s59, s59, s58
  v_cmp_gt_u32 vcc, 2, v29
  v_mov_b32 v31, 0x3f803f80
  s_mov_b32 s26, 100663296
  s_mov_b32 s27, s11
  v_cndmask_b32 v31, 0, v31, vcc
  v_accvgpr_write_b32 a240, v31
  v_accvgpr_write_b32 a241, v31
  buffer_load_dwordx4 v137, s[12:15], s36 offen offset:1024 lds
  v_accvgpr_write_b32 a242, v31
  v_accvgpr_write_b32 a243, v31
  v_lshrrev_b32 v150, 2, v16
  v_xor_b32 v151, v16, v150
  s_cmp_eq_u32 s28, 63
  s_cselect_b32 s37, 4, 0
  v_and_b32 v151, s37, v151
  v_cmp_eq_u32 vcc, 0, v151
  s_cmp_eq_u32 s29, 3
  s_cselect_b32 s37, 0xc31044fe, 0
  v_mov_b32 v150, s37
  v_mov_b32 v149, 0xc31044fe
  buffer_load_dwordx4 v138, s[12:15], s36 offen offset:2048 lds
  v_cndmask_b32 v151, 0, v150, vcc
  s_waitcnt vmcnt(12)
  s_barrier
  ds_read_b64 v[156:157], v144 offset:24
  v_cndmask_b32 v150, v149, 0, vcc
  ds_read_b64 v[158:159], v144 offset:16
  s_mov_b32 s45, 0x3fb8aa3b
  ds_read_b64 v[152:153], v144 offset:8
  s_lshl_b32 s37, s29, 3
  ds_read_b64 v[154:155], v144 offset:0
  s_lshl_b32 s38, s5, 2
  s_add_u32 m0, s63, 49152
  s_add_u32 s36, s62, 147456
  buffer_load_dwordx4 v136, s[12:15], s36 offen offset:0 lds
  s_xor_b32 s39, s38, 0
  ds_read_b64 v[160:161], v144 offset:264
  s_add_u32 s40, s39, s37
  ds_read_b64 v[162:163], v144 offset:256
  s_add_u32 s40, s40, 484
  ds_read_b64 v[164:165], v144 offset:248
  s_and_b32 s40, s40, 0x1ff
  s_mul_i32 s40, s40, 196608
  ds_read_b64 v[166:167], v144 offset:240
  s_sub_u32 s39, s39, s4
  ds_read_b64 v[172:173], v144 offset:504
  s_mul_i32 s52, s39, 196608
  buffer_load_dwordx4 v137, s[12:15], s36 offen offset:1024 lds
  ds_read_b64 v[174:175], v144 offset:496
  s_xor_b32 s39, s38, 2
  ds_read_b64 v[168:169], v144 offset:488
  s_add_u32 s41, s39, s37
  s_add_u32 s41, s41, 484
  ds_read_b64 v[170:171], v144 offset:480
  s_and_b32 s41, s41, 0x1ff
  ds_read_b64 v[176:177], v144 offset:744
  s_mul_i32 s41, s41, 196608
  ds_read_b64 v[178:179], v144 offset:736
  s_sub_u32 s39, s39, s4
  s_mul_i32 s53, s39, 196608
  buffer_load_dwordx4 v138, s[12:15], s36 offen offset:2048 lds
  ds_read_b64 v[180:181], v144 offset:728
  s_xor_b32 s39, s38, 4
  ds_read_b64 v[182:183], v144 offset:720
  s_add_u32 s42, s39, s37
  ds_read_b64 v[116:117], v144 offset:984
  s_add_u32 s42, s42, 484
  ds_read_b64 v[118:119], v144 offset:976
  s_and_b32 s42, s42, 0x1ff
  s_mul_i32 s42, s42, 196608
  ds_read_b64 v[124:125], v144 offset:968
  s_sub_u32 s39, s39, s4
  ds_read_b64 v[126:127], v144 offset:960
  s_add_u32 m0, s63, 61440
  s_add_u32 s36, s62, 184320
  buffer_load_dwordx4 v136, s[12:15], s36 offen offset:0 lds
  s_mul_i32 s54, s39, 196608
  ds_read_b64 v[120:121], v144 offset:1224
  s_xor_b32 s39, s38, 6
  s_add_u32 s43, s39, s37
  ds_read_b64 v[122:123], v144 offset:1216
  s_add_u32 s43, s43, 484
  ds_read_b64 v[128:129], v144 offset:1208
  s_and_b32 s43, s43, 0x1ff
  ds_read_b64 v[130:131], v144 offset:1200
  s_mul_i32 s43, s43, 196608
  ds_read_b64 v[132:133], v144 offset:1464
  s_sub_u32 s39, s39, s4
  buffer_load_dwordx4 v137, s[12:15], s36 offen offset:1024 lds
  s_mul_i32 s55, s39, 196608
  ds_read_b64 v[134:135], v144 offset:1456
  s_mul_i32 s34, s32, 3
  ds_read_b64 v[140:141], v144 offset:1448
  s_add_u32 s34, s34, 106496
  ds_read_b64 v[142:143], v144 offset:1440
  s_mov_b32 s35, 1
  s_mov_b32 s30, 1
  s_waitcnt vmcnt(11)
  s_barrier
  ds_read_b64_tr_b16 v[184:185], v12 offset:0
  ds_read_b64_tr_b16 v[186:187], v12 offset:512
  buffer_load_dwordx4 v138, s[12:15], s36 offen offset:2048 lds
  ds_read_b64_tr_b16 v[188:189], v13 offset:0
  ds_read_b64_tr_b16 v[190:191], v13 offset:512
  ds_read_b64_tr_b16 v[192:193], v14 offset:0
  ds_read_b64_tr_b16 v[194:195], v14 offset:512
  ds_read_b64_tr_b16 v[196:197], v12 offset:12288
  ds_read_b64_tr_b16 v[198:199], v12 offset:12800
  ds_read_b64_tr_b16 v[200:201], v13 offset:12288
  ds_read_b64_tr_b16 v[202:203], v13 offset:12800
  ds_read_b64_tr_b16 v[204:205], v14 offset:12288
  ds_read_b64_tr_b16 v[206:207], v14 offset:12800
  s_waitcnt lgkmcnt(12)
  v_perm_b32 v88, v157, v156, s60
  s_lshl_b32 m0, s3, 4
  s_nop 0
  buffer_load_dwordx4 v6, s[8:11], s48 offen offset:0 nt lds
  v_perm_b32 v89, v159, v158, s60
  v_perm_b32 v90, v153, v152, s60
  v_perm_b32 v91, v155, v154, s60
  v_perm_b32 v92, v161, v160, s60
  v_perm_b32 v93, v163, v162, s60
  v_perm_b32 v94, v165, v164, s60
  v_perm_b32 v95, v167, v166, s60
  v_perm_b32 v96, v173, v172, s60
  v_perm_b32 v97, v175, v174, s60
  v_perm_b32 v98, v169, v168, s60
  v_perm_b32 v99, v171, v170, s60
  v_perm_b32 v100, v177, v176, s60
  s_addk_i32 m0, 8064
  s_nop 0
  buffer_load_dwordx4 v6, s[8:11], s48 offen offset:128 nt lds
  v_perm_b32 v101, v179, v178, s60
  v_perm_b32 v102, v181, v180, s60
  v_perm_b32 v103, v183, v182, s60
  v_perm_b32 v104, v117, v116, s60
  v_perm_b32 v105, v119, v118, s60
  v_perm_b32 v106, v125, v124, s60
  v_perm_b32 v107, v127, v126, s60
  v_perm_b32 v108, v121, v120, s60
  v_perm_b32 v109, v123, v122, s60
  v_perm_b32 v110, v129, v128, s60
  v_perm_b32 v111, v131, v130, s60
  v_perm_b32 v112, v133, v132, s60
  s_addk_i32 m0, 8064
  s_nop 0
  buffer_load_dwordx4 v6, s[8:11], s48 offen offset:256 nt lds
  v_perm_b32 v113, v135, v134, s60
  v_perm_b32 v114, v141, v140, s60
  v_perm_b32 v115, v143, v142, s60
  s_waitcnt lgkmcnt(10)
  v_lshlrev_b32 v40, 16, v184
  v_and_b32 v41, s44, v184
  v_lshlrev_b32 v42, 16, v185
  v_and_b32 v43, s44, v185
  v_lshlrev_b32 v44, 16, v186
  v_and_b32 v45, s44, v186
  v_lshlrev_b32 v46, 16, v187
  v_and_b32 v47, s44, v187
  s_lshl_b32 m0, s3, 4
  s_addk_i32 m0, 4096
  s_nop 0
  buffer_load_dwordx4 v6, s[8:11], s49 offen offset:0 nt lds
  v_pk_mul_f32 v[40:41], v[40:41], s[46:47]
  v_pk_mul_f32 v[42:43], v[42:43], s[46:47]
  v_pk_mul_f32 v[44:45], v[44:45], s[46:47]
  v_pk_mul_f32 v[46:47], v[46:47], s[46:47]
  v_cvt_pk_bf16_f32 v184, v40, v41
  v_cvt_pk_bf16_f32 v185, v42, v43
  v_cvt_pk_bf16_f32 v186, v44, v45
  s_waitcnt lgkmcnt(0)
  v_cvt_pk_bf16_f32 v187, v46, v47
  v_lshlrev_b32 v48, 16, v188
  v_and_b32 v49, s44, v188
  v_lshlrev_b32 v50, 16, v189
  s_addk_i32 m0, 8064
  s_nop 0
  buffer_load_dwordx4 v6, s[8:11], s49 offen offset:128 nt lds
  v_and_b32 v51, s44, v189
  v_lshlrev_b32 v52, 16, v190
  v_and_b32 v53, s44, v190
  v_lshlrev_b32 v54, 16, v191
  v_and_b32 v55, s44, v191
  v_pk_mul_f32 v[48:49], v[48:49], s[46:47]
  v_pk_mul_f32 v[50:51], v[50:51], s[46:47]
  v_pk_mul_f32 v[52:53], v[52:53], s[46:47]
  v_pk_mul_f32 v[54:55], v[54:55], s[46:47]
  v_cvt_pk_bf16_f32 v188, v48, v49
  v_cvt_pk_bf16_f32 v189, v50, v51
  v_cvt_pk_bf16_f32 v190, v52, v53
  s_addk_i32 m0, 8064
  s_nop 0
  buffer_load_dwordx4 v6, s[8:11], s49 offen offset:256 nt lds
  v_cvt_pk_bf16_f32 v191, v54, v55
  v_lshlrev_b32 v56, 16, v192
  v_and_b32 v57, s44, v192
  v_lshlrev_b32 v58, 16, v193
  v_and_b32 v59, s44, v193
  v_lshlrev_b32 v60, 16, v194
  v_and_b32 v61, s44, v194
  v_lshlrev_b32 v62, 16, v195
  v_and_b32 v63, s44, v195
  v_pk_mul_f32 v[56:57], v[56:57], s[46:47]
  v_pk_mul_f32 v[58:59], v[58:59], s[46:47]
  v_pk_mul_f32 v[60:61], v[60:61], s[46:47]
  s_lshr_b32 s36, s2, 3
  s_mulk_i32 s36, 2304
  buffer_load_dword v66, v35, s[16:19], s36 offen
  v_pk_mul_f32 v[62:63], v[62:63], s[46:47]
  v_cvt_pk_bf16_f32 v192, v56, v57
  v_cvt_pk_bf16_f32 v193, v58, v59
  v_cvt_pk_bf16_f32 v194, v60, v61
  v_cvt_pk_bf16_f32 v195, v62, v63
  v_lshlrev_b32 v40, 16, v196
  v_and_b32 v41, s44, v196
  v_lshlrev_b32 v42, 16, v197
  v_and_b32 v43, s44, v197
  v_lshlrev_b32 v44, 16, v198
  v_and_b32 v45, s44, v198
  v_lshlrev_b32 v46, 16, v199
  v_and_b32 v47, s44, v199
  v_pk_mul_f32 v[40:41], v[40:41], s[46:47]
  v_pk_mul_f32 v[42:43], v[42:43], s[46:47]
  v_pk_mul_f32 v[44:45], v[44:45], s[46:47]
  v_pk_mul_f32 v[46:47], v[46:47], s[46:47]
  v_cvt_pk_bf16_f32 v196, v40, v41
  v_cvt_pk_bf16_f32 v197, v42, v43
  v_cvt_pk_bf16_f32 v198, v44, v45
  v_cvt_pk_bf16_f32 v199, v46, v47
  v_lshlrev_b32 v48, 16, v200
  v_and_b32 v49, s44, v200
  v_lshlrev_b32 v50, 16, v201
  v_and_b32 v51, s44, v201
  v_lshlrev_b32 v52, 16, v202
  v_and_b32 v53, s44, v202
  v_lshlrev_b32 v54, 16, v203
  v_and_b32 v55, s44, v203
  v_pk_mul_f32 v[48:49], v[48:49], s[46:47]
  v_pk_mul_f32 v[50:51], v[50:51], s[46:47]
  v_pk_mul_f32 v[52:53], v[52:53], s[46:47]
  v_pk_mul_f32 v[54:55], v[54:55], s[46:47]
  v_cvt_pk_bf16_f32 v200, v48, v49
  v_cvt_pk_bf16_f32 v201, v50, v51
  v_cvt_pk_bf16_f32 v202, v52, v53
  v_cvt_pk_bf16_f32 v203, v54, v55
  v_lshlrev_b32 v56, 16, v204
  v_and_b32 v57, s44, v204
  v_lshlrev_b32 v58, 16, v205
  v_and_b32 v59, s44, v205
  v_lshlrev_b32 v60, 16, v206
  v_and_b32 v61, s44, v206
  v_lshlrev_b32 v62, 16, v207
  v_and_b32 v63, s44, v207
  v_pk_mul_f32 v[56:57], v[56:57], s[46:47]
  v_pk_mul_f32 v[58:59], v[58:59], s[46:47]
  v_pk_mul_f32 v[60:61], v[60:61], s[46:47]
  v_pk_mul_f32 v[62:63], v[62:63], s[46:47]
  v_cvt_pk_bf16_f32 v204, v56, v57
  v_cvt_pk_bf16_f32 v205, v58, v59
  v_cvt_pk_bf16_f32 v206, v60, v61
  v_cvt_pk_bf16_f32 v207, v62, v63
  s_waitcnt vmcnt(13)
  s_barrier
  ds_read_b64_tr_b16 v[208:209], v12 offset:24576
  ds_read_b64_tr_b16 v[210:211], v12 offset:25088
  ds_read_b64_tr_b16 v[212:213], v13 offset:24576
  ds_read_b64_tr_b16 v[214:215], v13 offset:25088
  ds_read_b64_tr_b16 v[216:217], v14 offset:24576
  ds_read_b64_tr_b16 v[218:219], v14 offset:25088
  ds_read_b64_tr_b16 v[220:221], v12 offset:36864
  ds_read_b64_tr_b16 v[222:223], v12 offset:37376
  ds_read_b64_tr_b16 v[224:225], v13 offset:36864
  ds_read_b64_tr_b16 v[226:227], v13 offset:37376
  ds_read_b64_tr_b16 v[228:229], v14 offset:36864
  ds_read_b64_tr_b16 v[230:231], v14 offset:37376
  s_waitcnt lgkmcnt(10)
  v_lshlrev_b32 v40, 16, v208
  v_and_b32 v41, s44, v208
  v_lshlrev_b32 v42, 16, v209
  v_and_b32 v43, s44, v209
  v_lshlrev_b32 v44, 16, v210
  v_and_b32 v45, s44, v210
  v_lshlrev_b32 v46, 16, v211
  v_and_b32 v47, s44, v211
  v_pk_mul_f32 v[40:41], v[40:41], s[46:47]
  v_pk_mul_f32 v[42:43], v[42:43], s[46:47]
  v_pk_mul_f32 v[44:45], v[44:45], s[46:47]
  v_pk_mul_f32 v[46:47], v[46:47], s[46:47]
  v_cvt_pk_bf16_f32 v208, v40, v41
  v_cvt_pk_bf16_f32 v209, v42, v43
  v_cvt_pk_bf16_f32 v210, v44, v45
L_hop0:
  s_cbranch_execz L_hopped
  s_waitcnt lgkmcnt(0)
  v_cvt_pk_bf16_f32 v211, v46, v47
  v_lshlrev_b32 v48, 16, v212
  v_and_b32 v49, s44, v212
  v_lshlrev_b32 v50, 16, v213
  v_and_b32 v51, s44, v213
  v_lshlrev_b32 v52, 16, v214
  v_and_b32 v53, s44, v214
  v_lshlrev_b32 v54, 16, v215
  v_and_b32 v55, s44, v215
  v_pk_mul_f32 v[48:49], v[48:49], s[46:47]
  v_pk_mul_f32 v[50:51], v[50:51], s[46:47]
  v_pk_mul_f32 v[52:53], v[52:53], s[46:47]
  v_pk_mul_f32 v[54:55], v[54:55], s[46:47]
  v_cvt_pk_bf16_f32 v212, v48, v49
  v_cvt_pk_bf16_f32 v213, v50, v51
  v_cvt_pk_bf16_f32 v214, v52, v53
  v_cvt_pk_bf16_f32 v215, v54, v55
  v_lshlrev_b32 v56, 16, v216
  v_and_b32 v57, s44, v216
  v_lshlrev_b32 v58, 16, v217
  v_and_b32 v59, s44, v217
  v_lshlrev_b32 v60, 16, v218
  v_and_b32 v61, s44, v218
  v_lshlrev_b32 v62, 16, v219
  v_and_b32 v63, s44, v219
  v_pk_mul_f32 v[56:57], v[56:57], s[46:47]
  v_pk_mul_f32 v[58:59], v[58:59], s[46:47]
  v_pk_mul_f32 v[60:61], v[60:61], s[46:47]
  v_pk_mul_f32 v[62:63], v[62:63], s[46:47]
  v_cvt_pk_bf16_f32 v216, v56, v57
  v_cvt_pk_bf16_f32 v217, v58, v59
  v_cvt_pk_bf16_f32 v218, v60, v61
  v_cvt_pk_bf16_f32 v219, v62, v63
  v_lshlrev_b32 v40, 16, v220
  v_and_b32 v41, s44, v220
  v_lshlrev_b32 v42, 16, v221
  v_and_b32 v43, s44, v221
  v_lshlrev_b32 v44, 16, v222
  v_and_b32 v45, s44, v222
  v_lshlrev_b32 v46, 16, v223
  v_and_b32 v47, s44, v223
  v_pk_mul_f32 v[40:41], v[40:41], s[46:47]
  v_pk_mul_f32 v[42:43], v[42:43], s[46:47]
  v_pk_mul_f32 v[44:45], v[44:45], s[46:47]
  v_pk_mul_f32 v[46:47], v[46:47], s[46:47]
  v_cvt_pk_bf16_f32 v220, v40, v41
  v_cvt_pk_bf16_f32 v221, v42, v43
  v_cvt_pk_bf16_f32 v222, v44, v45
  v_cvt_pk_bf16_f32 v223, v46, v47
  v_lshlrev_b32 v48, 16, v224
  v_and_b32 v49, s44, v224
  v_lshlrev_b32 v50, 16, v225
  v_and_b32 v51, s44, v225
  v_lshlrev_b32 v52, 16, v226
  v_and_b32 v53, s44, v226
  v_lshlrev_b32 v54, 16, v227
  v_and_b32 v55, s44, v227
  v_pk_mul_f32 v[48:49], v[48:49], s[46:47]
  v_pk_mul_f32 v[50:51], v[50:51], s[46:47]
  v_pk_mul_f32 v[52:53], v[52:53], s[46:47]
  v_pk_mul_f32 v[54:55], v[54:55], s[46:47]
  v_cvt_pk_bf16_f32 v224, v48, v49
  v_cvt_pk_bf16_f32 v225, v50, v51
  v_cvt_pk_bf16_f32 v226, v52, v53
  v_cvt_pk_bf16_f32 v227, v54, v55
  v_lshlrev_b32 v56, 16, v228
  v_and_b32 v57, s44, v228
  v_lshlrev_b32 v58, 16, v229
  v_and_b32 v59, s44, v229
  v_lshlrev_b32 v60, 16, v230
  v_and_b32 v61, s44, v230
  v_lshlrev_b32 v62, 16, v231
  v_and_b32 v63, s44, v231
  s_add_u32 m0, s63, 73728
  s_add_u32 s36, s62, 384
  buffer_load_dwordx4 v136, s[12:15], s36 offen offset:0 lds
  v_pk_mul_f32 v[56:57], v[56:57], s[46:47]
  v_pk_mul_f32 v[58:59], v[58:59], s[46:47]
  v_pk_mul_f32 v[60:61], v[60:61], s[46:47]
  v_pk_mul_f32 v[62:63], v[62:63], s[46:47]
  v_cvt_pk_bf16_f32 v228, v56, v57
  v_cvt_pk_bf16_f32 v229, v58, v59
  v_cvt_pk_bf16_f32 v230, v60, v61
  v_cvt_pk_bf16_f32 v231, v62, v63
  s_waitcnt vmcnt(8)
  s_barrier
  ds_read_b64_tr_b16 v[232:233], v12 offset:49152
  ds_read_b64_tr_b16 v[234:235], v12 offset:49664
  ds_read_b64_tr_b16 v[236:237], v13 offset:49152
  ds_read_b64_tr_b16 v[238:239], v13 offset:49664
  ds_read_b64_tr_b16 v[240:241], v14 offset:49152
  ds_read_b64_tr_b16 v[242:243], v14 offset:49664
  ds_read_b64_tr_b16 v[244:245], v12 offset:61440
  ds_read_b64_tr_b16 v[246:247], v12 offset:61952
  ds_read_b64_tr_b16 v[248:249], v13 offset:61440
  ds_read_b64_tr_b16 v[250:251], v13 offset:61952
  buffer_load_dwordx4 v137, s[12:15], s36 offen offset:1024 lds
  ds_read_b64_tr_b16 v[252:253], v14 offset:61440
  ds_read_b64_tr_b16 v[254:255], v14 offset:61952
  s_waitcnt lgkmcnt(10)
  v_lshlrev_b32 v40, 16, v232
  v_and_b32 v41, s44, v232
  v_lshlrev_b32 v42, 16, v233
  v_and_b32 v43, s44, v233
  v_lshlrev_b32 v44, 16, v234
  v_and_b32 v45, s44, v234
  v_lshlrev_b32 v46, 16, v235
  v_and_b32 v47, s44, v235
  v_pk_mul_f32 v[40:41], v[40:41], s[46:47]
  v_pk_mul_f32 v[42:43], v[42:43], s[46:47]
  v_pk_mul_f32 v[44:45], v[44:45], s[46:47]
  v_pk_mul_f32 v[46:47], v[46:47], s[46:47]
  v_cvt_pk_bf16_f32 v232, v40, v41
  v_cvt_pk_bf16_f32 v233, v42, v43
  v_cvt_pk_bf16_f32 v234, v44, v45
  s_waitcnt lgkmcnt(0)
  v_cvt_pk_bf16_f32 v235, v46, v47
  buffer_load_dwordx4 v138, s[12:15], s36 offen offset:2048 lds
  v_lshlrev_b32 v48, 16, v236
  v_and_b32 v49, s44, v236
  v_lshlrev_b32 v50, 16, v237
  v_and_b32 v51, s44, v237
  v_lshlrev_b32 v52, 16, v238
  v_and_b32 v53, s44, v238
  v_lshlrev_b32 v54, 16, v239
  v_and_b32 v55, s44, v239
  v_pk_mul_f32 v[48:49], v[48:49], s[46:47]
  v_pk_mul_f32 v[50:51], v[50:51], s[46:47]
  v_pk_mul_f32 v[52:53], v[52:53], s[46:47]
  v_pk_mul_f32 v[54:55], v[54:55], s[46:47]
  v_cvt_pk_bf16_f32 v236, v48, v49
  v_cvt_pk_bf16_f32 v237, v50, v51
  v_cvt_pk_bf16_f32 v238, v52, v53
  v_cvt_pk_bf16_f32 v239, v54, v55
  v_lshlrev_b32 v56, 16, v240
  v_and_b32 v57, s44, v240
  v_lshlrev_b32 v58, 16, v241
  v_and_b32 v59, s44, v241
  s_add_u32 m0, s63, 86016
  s_add_u32 s36, s62, 37248
  buffer_load_dwordx4 v136, s[12:15], s36 offen offset:0 lds
  v_lshlrev_b32 v60, 16, v242
  v_and_b32 v61, s44, v242
  v_lshlrev_b32 v62, 16, v243
  v_and_b32 v63, s44, v243
  v_pk_mul_f32 v[56:57], v[56:57], s[46:47]
  v_pk_mul_f32 v[58:59], v[58:59], s[46:47]
  v_pk_mul_f32 v[60:61], v[60:61], s[46:47]
  v_pk_mul_f32 v[62:63], v[62:63], s[46:47]
  v_cvt_pk_bf16_f32 v240, v56, v57
  v_cvt_pk_bf16_f32 v241, v58, v59
  v_cvt_pk_bf16_f32 v242, v60, v61
  v_cvt_pk_bf16_f32 v243, v62, v63
  v_lshlrev_b32 v40, 16, v244
  v_and_b32 v41, s44, v244
  v_lshlrev_b32 v42, 16, v245
  v_and_b32 v43, s44, v245
  v_lshlrev_b32 v44, 16, v246
  v_and_b32 v45, s44, v246
  v_lshlrev_b32 v46, 16, v247
  v_and_b32 v47, s44, v247
  buffer_load_dwordx4 v137, s[12:15], s36 offen offset:1024 lds
  v_pk_mul_f32 v[40:41], v[40:41], s[46:47]
  v_pk_mul_f32 v[42:43], v[42:43], s[46:47]
  v_pk_mul_f32 v[44:45], v[44:45], s[46:47]
  v_pk_mul_f32 v[46:47], v[46:47], s[46:47]
  v_cvt_pk_bf16_f32 v244, v40, v41
  v_cvt_pk_bf16_f32 v245, v42, v43
  v_cvt_pk_bf16_f32 v246, v44, v45
  v_cvt_pk_bf16_f32 v247, v46, v47
  v_lshlrev_b32 v48, 16, v248
  v_and_b32 v49, s44, v248
  v_lshlrev_b32 v50, 16, v249
  v_and_b32 v51, s44, v249
  v_lshlrev_b32 v52, 16, v250
  v_and_b32 v53, s44, v250
  v_lshlrev_b32 v54, 16, v251
  v_and_b32 v55, s44, v251
  v_pk_mul_f32 v[48:49], v[48:49], s[46:47]
  v_pk_mul_f32 v[50:51], v[50:51], s[46:47]
  v_pk_mul_f32 v[52:53], v[52:53], s[46:47]
  v_pk_mul_f32 v[54:55], v[54:55], s[46:47]
  buffer_load_dwordx4 v138, s[12:15], s36 offen offset:2048 lds
  v_cvt_pk_bf16_f32 v248, v48, v49
  v_cvt_pk_bf16_f32 v249, v50, v51
  v_cvt_pk_bf16_f32 v250, v52, v53
  v_cvt_pk_bf16_f32 v251, v54, v55
  v_lshlrev_b32 v56, 16, v252
  v_and_b32 v57, s44, v252
  v_lshlrev_b32 v58, 16, v253
  v_and_b32 v59, s44, v253
  v_lshlrev_b32 v60, 16, v254
  v_and_b32 v61, s44, v254
  v_lshlrev_b32 v62, 16, v255
  v_and_b32 v63, s44, v255
  v_pk_mul_f32 v[56:57], v[56:57], s[46:47]
  v_pk_mul_f32 v[58:59], v[58:59], s[46:47]
  v_pk_mul_f32 v[60:61], v[60:61], s[46:47]
  v_pk_mul_f32 v[62:63], v[62:63], s[46:47]
  v_cvt_pk_bf16_f32 v252, v56, v57
  v_cvt_pk_bf16_f32 v253, v58, v59
  v_cvt_pk_bf16_f32 v254, v60, v61
  v_cvt_pk_bf16_f32 v255, v62, v63
  s_lshl3_add_u32 s48, s29, s4
  s_add_u32 s48, s48, 4
  s_mul_i32 s48, s48, 196608
  s_add_u32 s49, s48, 786432
  s_add_u32 s50, s48, 100663296
  s_mov_b32 s10, 95158272
  s_waitcnt vmcnt(10)
  s_barrier
  ds_read_b128 a[144:147], v0 offset:0
  ds_read_b128 a[148:151], v1 offset:0
  ds_read_b128 a[152:155], v0 offset:8192
  ds_read_b128 a[156:159], v1 offset:8192
  ds_read_b128 a[160:163], v0 offset:16384
  ds_read_b128 a[164:167], v1 offset:16384
  s_waitcnt lgkmcnt(4)
  v_mfma_f32_16x16x32_bf16 v[164:167], v[184:187], a[144:147], 0
  v_mfma_f32_16x16x32_bf16 v[164:167], v[196:199], a[148:151], v[164:167]
  s_waitcnt lgkmcnt(0)
  v_mfma_f32_16x16x32_bf16 v[164:167], v[208:211], a[152:155], v[164:167]
  s_add_u32 m0, s63, 98304
  s_add_u32 s36, s62, 74112
  v_mfma_f32_16x16x32_bf16 v[164:167], v[220:223], a[156:159], v[164:167]
  buffer_load_dwordx4 v136, s[12:15], s36 offen offset:0 lds
  v_mfma_f32_16x16x32_bf16 v[164:167], v[232:235], a[160:163], v[164:167]
  v_fma_f32 v88, v88, s45, v150
  v_fma_f32 v89, v89, s45, v150
  v_mfma_f32_16x16x32_bf16 v[164:167], v[244:247], a[164:167], v[164:167]
  ds_read_b128 a[168:171], v0 offset:2048
  ds_read_b128 a[172:175], v1 offset:2048
  v_mfma_f32_16x16x32_bf16 v[172:175], v[248:251], a[164:167], 0
  ds_read_b128 a[176:179], v0 offset:10240
  ds_read_b128 a[180:183], v1 offset:10240
  v_mfma_f32_16x16x32_bf16 v[172:175], v[236:239], a[160:163], v[172:175]
  ds_read_b128 a[184:187], v0 offset:18432
  ds_read_b128 a[188:191], v1 offset:18432
  v_mfma_f32_16x16x32_bf16 v[172:175], v[224:227], a[156:159], v[172:175]
  v_cvt_pk_bf16_f32 v40, v164, v165
  v_cvt_pk_bf16_f32 v41, v166, v167
  v_mfma_f32_16x16x32_bf16 v[172:175], v[212:215], a[152:155], v[172:175]
  buffer_load_dwordx4 v137, s[12:15], s36 offen offset:1024 lds
  v_mfma_f32_16x16x32_bf16 v[172:175], v[200:203], a[148:151], v[172:175]
  buffer_load_dwordx4 v138, s[12:15], s36 offen offset:2048 lds
  v_mfma_f32_16x16x32_bf16 v[172:175], v[188:191], a[144:147], v[172:175]
  v_fma_f32 v90, v90, s45, v150
  v_fma_f32 v91, v91, s45, v150
  v_mfma_f32_16x16x32_bf16 v[164:167], v[192:195], a[144:147], 0
  s_add_u32 m0, s63, 110592
  s_add_u32 s36, s62, 110976
  v_mfma_f32_16x16x32_bf16 v[164:167], v[204:207], a[148:151], v[164:167]
  buffer_load_dwordx4 v136, s[12:15], s36 offen offset:0 lds
  v_mfma_f32_16x16x32_bf16 v[164:167], v[216:219], a[152:155], v[164:167]
  v_cvt_pk_bf16_f32 v42, v172, v173
  v_cvt_pk_bf16_f32 v43, v174, v175
  v_mfma_f32_16x16x32_bf16 v[164:167], v[228:231], a[156:159], v[164:167]
  v_fma_f32 v92, v92, s45, v150
  v_fma_f32 v93, v93, s45, v150
  v_mfma_f32_16x16x32_bf16 v[164:167], v[240:243], a[160:163], v[164:167]
  v_fma_f32 v94, v94, s45, v150
  v_fma_f32 v95, v95, s45, v150
  v_mfma_f32_16x16x32_bf16 v[164:167], v[252:255], a[164:167], v[164:167]
  s_waitcnt lgkmcnt(0)
  v_fma_f32 v96, v96, s45, v150
  v_mfma_f32_16x16x32_bf16 v[172:175], v[184:187], a[168:171], 0
  buffer_load_dwordx4 v137, s[12:15], s36 offen offset:1024 lds
  v_mfma_f32_16x16x32_bf16 v[172:175], v[196:199], a[172:175], v[172:175]
  s_waitcnt vmcnt(12)
  s_barrier
  v_mfma_f32_16x16x32_bf16 v[172:175], v[208:211], a[176:179], v[172:175]
  v_cvt_pk_bf16_f32 v44, v164, v165
  v_cvt_pk_bf16_f32 v45, v166, v167
  v_mfma_f32_16x16x32_bf16 v[172:175], v[220:223], a[180:183], v[172:175]
  ds_read_b128 a[192:195], v0 offset:4096
  ds_read_b128 a[196:199], v1 offset:4096
  v_mfma_f32_16x16x32_bf16 v[172:175], v[232:235], a[184:187], v[172:175]
  ds_read_b128 a[200:203], v0 offset:12288
  ds_read_b128 a[204:207], v1 offset:12288
  v_mfma_f32_16x16x32_bf16 v[172:175], v[244:247], a[188:191], v[172:175]
  ds_read_b128 a[208:211], v0 offset:20480
  ds_read_b128 a[212:215], v1 offset:20480
  v_mfma_f32_16x16x32_bf16 v[164:167], v[248:251], a[188:191], 0
  buffer_load_dwordx4 v138, s[12:15], s36 offen offset:2048 lds
  v_mfma_f32_16x16x32_bf16 v[164:167], v[236:239], a[184:187], v[164:167]
  s_add_u32 m0, s63, 0
  s_add_u32 s36, s62, 147840
  v_mfma_f32_16x16x32_bf16 v[164:167], v[224:227], a[180:183], v[164:167]
  v_cvt_pk_bf16_f32 v52, v172, v173
  v_cvt_pk_bf16_f32 v53, v174, v175
  v_mfma_f32_16x16x32_bf16 v[164:167], v[212:215], a[176:179], v[164:167]
  buffer_load_dwordx4 v136, s[12:15], s36 offen offset:0 lds
  v_mfma_f32_16x16x32_bf16 v[164:167], v[200:203], a[172:175], v[164:167]
  v_fma_f32 v97, v97, s45, v150
  v_fma_f32 v98, v98, s45, v150
  v_mfma_f32_16x16x32_bf16 v[164:167], v[188:191], a[168:171], v[164:167]
  v_fma_f32 v99, v99, s45, v150
  v_fma_f32 v100, v100, s45, v150
  v_mfma_f32_16x16x32_bf16 v[172:175], v[192:195], a[168:171], 0
  buffer_load_dwordx4 v137, s[12:15], s36 offen offset:1024 lds
  v_mfma_f32_16x16x32_bf16 v[172:175], v[204:207], a[172:175], v[172:175]
  v_fma_f32 v101, v101, s45, v150
  v_fma_f32 v102, v102, s45, v150
  v_mfma_f32_16x16x32_bf16 v[172:175], v[216:219], a[176:179], v[172:175]
  v_cvt_pk_bf16_f32 v54, v164, v165
  v_cvt_pk_bf16_f32 v55, v166, v167
  v_mfma_f32_16x16x32_bf16 v[172:175], v[228:231], a[180:183], v[172:175]
  v_fma_f32 v103, v103, s45, v150
  v_fma_f32 v104, v104, s45, v150
  v_mfma_f32_16x16x32_bf16 v[172:175], v[240:243], a[184:187], v[172:175]
  buffer_load_dwordx4 v138, s[12:15], s36 offen offset:2048 lds
  v_mfma_f32_16x16x32_bf16 v[172:175], v[252:255], a[188:191], v[172:175]
  s_waitcnt lgkmcnt(0)
  v_fma_f32 v105, v105, s45, v150
  v_mfma_f32_16x16x32_bf16 v[164:167], v[184:187], a[192:195], 0
  v_fma_f32 v106, v106, s45, v150
  v_fma_f32 v107, v107, s45, v150
  v_mfma_f32_16x16x32_bf16 v[164:167], v[196:199], a[196:199], v[164:167]
  v_fma_f32 v108, v108, s45, v150
  v_fma_f32 v109, v109, s45, v150
  v_mfma_f32_16x16x32_bf16 v[164:167], v[208:211], a[200:203], v[164:167]
  v_cvt_pk_bf16_f32 v56, v172, v173
  v_cvt_pk_bf16_f32 v57, v174, v175
  v_mfma_f32_16x16x32_bf16 v[164:167], v[220:223], a[204:207], v[164:167]
  ds_read_b128 a[216:219], v0 offset:6144
  ds_read_b128 a[220:223], v1 offset:6144
  v_mfma_f32_16x16x32_bf16 v[164:167], v[232:235], a[208:211], v[164:167]
  ds_read_b128 a[224:227], v0 offset:14336
  ds_read_b128 a[244:247], v1 offset:14336
  v_mfma_f32_16x16x32_bf16 v[164:167], v[244:247], a[212:215], v[164:167]
  ds_read_b128 a[248:251], v0 offset:22528
  ds_read_b128 a[252:255], v1 offset:22528
  v_mfma_f32_16x16x32_bf16 v[172:175], v[248:251], a[212:215], 0
  s_add_u32 m0, s63, 12288
  s_add_u32 s36, s62, 184704
  v_mfma_f32_16x16x32_bf16 v[172:175], v[236:239], a[208:211], v[172:175]
  buffer_load_dwordx4 v136, s[12:15], s36 offen offset:0 lds
  v_mfma_f32_16x16x32_bf16 v[172:175], v[224:227], a[204:207], v[172:175]
  v_cvt_pk_bf16_f32 v64, v164, v165
  v_cvt_pk_bf16_f32 v65, v166, v167
  v_mfma_f32_16x16x32_bf16 v[172:175], v[212:215], a[200:203], v[172:175]
  s_waitcnt vmcnt(10)
  s_barrier
  v_mfma_f32_16x16x32_bf16 v[172:175], v[200:203], a[196:199], v[172:175]
  buffer_load_dwordx4 v137, s[12:15], s36 offen offset:1024 lds
  v_mfma_f32_16x16x32_bf16 v[172:175], v[188:191], a[192:195], v[172:175]
  buffer_load_dwordx4 v138, s[12:15], s36 offen offset:2048 lds
  v_mfma_f32_16x16x32_bf16 v[164:167], v[192:195], a[192:195], 0
  ds_read_b64_tr_b16 a[0:1], v15 offset:0
  ds_read_b64_tr_b16 a[2:3], v15 offset:512
  v_mfma_f32_16x16x32_bf16 v[164:167], v[204:207], a[196:199], v[164:167]
  s_add_u32 m0, s63, 24576
  s_add_u32 s36, s62, 768
  v_mfma_f32_16x16x32_bf16 v[164:167], v[216:219], a[200:203], v[164:167]
  v_cvt_pk_bf16_f32 v66, v172, v173
  v_cvt_pk_bf16_f32 v67, v174, v175
  v_mfma_f32_16x16x32_bf16 v[164:167], v[228:231], a[204:207], v[164:167]
  buffer_load_dwordx4 v136, s[12:15], s36 offen offset:0 lds
  v_mfma_f32_16x16x32_bf16 v[164:167], v[240:243], a[208:211], v[164:167]
  ds_read_b64_tr_b16 a[4:5], v9 offset:0
  ds_read_b64_tr_b16 a[6:7], v9 offset:512
  v_mfma_f32_16x16x32_bf16 v[164:167], v[252:255], a[212:215], v[164:167]
  s_waitcnt lgkmcnt(4)
  ds_read_b64_tr_b16 a[8:9], v11 offset:0
  v_mfma_f32_16x16x32_bf16 v[172:175], v[184:187], a[216:219], 0
  ds_read_b64_tr_b16 a[10:11], v11 offset:512
  ds_read_b64_tr_b16 a[12:13], v15 offset:12288
  v_mfma_f32_16x16x32_bf16 v[172:175], v[196:199], a[220:223], v[172:175]
  buffer_load_dwordx4 v137, s[12:15], s36 offen offset:1024 lds
  v_mfma_f32_16x16x32_bf16 v[172:175], v[208:211], a[224:227], v[172:175]
  v_cvt_pk_bf16_f32 v68, v164, v165
  v_cvt_pk_bf16_f32 v69, v166, v167
  v_mfma_f32_16x16x32_bf16 v[172:175], v[220:223], a[244:247], v[172:175]
  ds_read_b64_tr_b16 a[14:15], v15 offset:12800
  ds_read_b64_tr_b16 a[16:17], v9 offset:12288
  v_mfma_f32_16x16x32_bf16 v[172:175], v[232:235], a[248:251], v[172:175]
  ds_read_b64_tr_b16 a[18:19], v9 offset:12800
  ds_read_b64_tr_b16 a[20:21], v11 offset:12288
  v_mfma_f32_16x16x32_bf16 v[172:175], v[244:247], a[252:255], v[172:175]
  buffer_load_dwordx4 v138, s[12:15], s36 offen offset:2048 lds
  v_mfma_f32_16x16x32_bf16 v[164:167], v[248:251], a[252:255], 0
  ds_read_b64_tr_b16 a[22:23], v11 offset:12800
  v_fma_f32 v110, v110, s45, v150
  v_mfma_f32_16x16x32_bf16 v[164:167], v[236:239], a[248:251], v[164:167]
  v_fma_f32 v111, v111, s45, v150
  v_fma_f32 v112, v112, s45, v150
  v_mfma_f32_16x16x32_bf16 v[164:167], v[224:227], a[244:247], v[164:167]
  v_cvt_pk_bf16_f32 v70, v172, v173
  v_cvt_pk_bf16_f32 v71, v174, v175
  v_mfma_f32_16x16x32_bf16 v[164:167], v[212:215], a[224:227], v[164:167]
  s_add_u32 m0, s63, 36864
  s_add_u32 s36, s62, 37632
  v_mfma_f32_16x16x32_bf16 v[164:167], v[200:203], a[220:223], v[164:167]
  buffer_load_dwordx4 v136, s[12:15], s36 offen offset:0 lds
  v_mfma_f32_16x16x32_bf16 v[164:167], v[188:191], a[216:219], v[164:167]
  v_fma_f32 v113, v113, s45, v150
  v_fma_f32 v114, v114, s45, v150
  v_mfma_f32_16x16x32_bf16 v[172:175], v[192:195], a[216:219], 0
  v_fma_f32 v115, v115, s45, v150
  v_add_f32 v156, v151, v112
  v_mfma_f32_16x16x32_bf16 v[172:175], v[204:207], a[220:223], v[172:175]
  v_add_f32 v157, v151, v113
  v_add_f32 v158, v151, v114
  v_mfma_f32_16x16x32_bf16 v[172:175], v[216:219], a[224:227], v[172:175]
  v_cvt_pk_bf16_f32 v72, v164, v165
  v_cvt_pk_bf16_f32 v73, v166, v167
  v_mfma_f32_16x16x32_bf16 v[172:175], v[228:231], a[244:247], v[172:175]
  buffer_load_dwordx4 v137, s[12:15], s36 offen offset:1024 lds
  v_mfma_f32_16x16x32_bf16 v[172:175], v[240:243], a[248:251], v[172:175]
  s_waitcnt lgkmcnt(0)
  s_waitcnt vmcnt(11)
  s_barrier
  v_mfma_f32_16x16x32_bf16 v[172:175], v[252:255], a[252:255], v[172:175]
  ds_read_b64_tr_b16 a[24:25], v15 offset:24576
  v_mfma_f32_16x16x32_bf16 v[116:119], a[0:3], a[144:147], 0
  buffer_load_dwordx4 v138, s[12:15], s36 offen offset:2048 lds
  v_mfma_f32_16x16x32_bf16 v[116:119], a[12:15], a[148:151], v[116:119]
  ds_read_b64_tr_b16 a[26:27], v15 offset:25088
  ds_read_b64_tr_b16 a[28:29], v9 offset:24576
  v_mfma_f32_16x16x32_bf16 v[124:127], a[16:19], a[148:151], 0
  v_cvt_pk_bf16_f32 v74, v172, v173
  v_cvt_pk_bf16_f32 v75, v174, v175
  v_mfma_f32_16x16x32_bf16 v[124:127], a[4:7], a[144:147], v[124:127]
  s_add_u32 m0, s63, 49152
  s_add_u32 s36, s62, 74496
  v_mfma_f32_16x16x32_bf16 v[120:123], a[8:11], a[144:147], 0
  buffer_load_dwordx4 v136, s[12:15], s36 offen offset:0 lds
  v_mfma_f32_16x16x32_bf16 v[120:123], a[20:23], a[148:151], v[120:123]
  ds_read_b64_tr_b16 a[30:31], v9 offset:25088
  ds_read_b64_tr_b16 a[32:33], v11 offset:24576
  v_mfma_f32_16x16x32_bf16 v[128:131], a[0:3], a[168:171], 0
  ds_read_b64_tr_b16 a[34:35], v11 offset:25088
  ds_read_b64_tr_b16 a[36:37], v15 offset:36864
  v_mfma_f32_16x16x32_bf16 v[128:131], a[12:15], a[172:175], v[128:131]
  ds_read_b64_tr_b16 a[38:39], v15 offset:37376
  ds_read_b64_tr_b16 a[40:41], v9 offset:36864
  v_mfma_f32_16x16x32_bf16 v[132:135], a[16:19], a[172:175], 0
  buffer_load_dwordx4 v137, s[12:15], s36 offen offset:1024 lds
  v_mfma_f32_16x16x32_bf16 v[132:135], a[4:7], a[168:171], v[132:135]
  ds_read_b64_tr_b16 a[42:43], v9 offset:37376
  ds_read_b64_tr_b16 a[44:45], v11 offset:36864
  v_mfma_f32_16x16x32_bf16 v[140:143], a[8:11], a[168:171], 0
  ds_read_b64_tr_b16 a[46:47], v11 offset:37376
  v_add_f32 v159, v151, v115
  v_mfma_f32_16x16x32_bf16 v[140:143], a[20:23], a[172:175], v[140:143]
  v_add_f32 v160, v151, v108
  v_add_f32 v161, v151, v109
  v_mfma_f32_16x16x32_bf16 v[16:19], a[0:3], a[192:195], 0
  v_add_f32 v162, v151, v110
  v_add_f32 v163, v151, v111
  v_mfma_f32_16x16x32_bf16 v[16:19], a[12:15], a[196:199], v[16:19]
  buffer_load_dwordx4 v138, s[12:15], s36 offen offset:2048 lds
  v_mfma_f32_16x16x32_bf16 v[20:23], a[16:19], a[196:199], 0
  v_add_f32 v180, v151, v104
  v_add_f32 v181, v151, v105
  v_mfma_f32_16x16x32_bf16 v[20:23], a[4:7], a[192:195], v[20:23]
  v_add_f32 v182, v151, v106
  v_add_f32 v183, v151, v107
  v_mfma_f32_16x16x32_bf16 v[24:27], a[8:11], a[192:195], 0
  s_add_u32 m0, s63, 61440
  s_add_u32 s36, s62, 111360
  v_mfma_f32_16x16x32_bf16 v[24:27], a[20:23], a[196:199], v[24:27]
  buffer_load_dwordx4 v136, s[12:15], s36 offen offset:0 lds
  v_mfma_f32_16x16x32_bf16 v[28:31], a[0:3], a[216:219], 0
  v_add_f32 v152, v151, v96
  v_add_f32 v153, v151, v97
  v_mfma_f32_16x16x32_bf16 v[28:31], a[12:15], a[220:223], v[28:31]
  v_add_f32 v154, v151, v98
  v_add_f32 v155, v151, v99
  v_mfma_f32_16x16x32_bf16 v[32:35], a[16:19], a[220:223], 0
  v_add_f32 v168, v151, v92
  v_add_f32 v169, v151, v93
  v_mfma_f32_16x16x32_bf16 v[32:35], a[4:7], a[216:219], v[32:35]
  buffer_load_dwordx4 v137, s[12:15], s36 offen offset:1024 lds
  v_mfma_f32_16x16x32_bf16 v[36:39], a[8:11], a[216:219], 0
  v_add_f32 v170, v151, v94
  v_add_f32 v171, v151, v95
  v_mfma_f32_16x16x32_bf16 v[36:39], a[20:23], a[220:223], v[36:39]
  s_waitcnt lgkmcnt(0)
  v_add_f32 v176, v151, v88
  v_mfma_f32_16x16x32_bf16 v[116:119], a[24:27], a[152:155], v[116:119]
  s_waitcnt vmcnt(11)
  s_barrier
  v_mfma_f32_16x16x32_bf16 v[116:119], a[36:39], a[156:159], v[116:119]
  buffer_load_dwordx4 v138, s[12:15], s36 offen offset:2048 lds
  v_mfma_f32_16x16x32_bf16 v[124:127], a[40:43], a[156:159], v[124:127]
  ds_read_b64_tr_b16 a[48:49], v12 offset:0
  ds_read_b64_tr_b16 a[50:51], v12 offset:512
  v_mfma_f32_16x16x32_bf16 v[124:127], a[28:31], a[152:155], v[124:127]
  ds_read_b64_tr_b16 a[52:53], v13 offset:0
  ds_read_b64_tr_b16 a[54:55], v13 offset:512
  v_mfma_f32_16x16x32_bf16 v[120:123], a[32:35], a[152:155], v[120:123]
  s_add_u32 m0, s63, 73728
  s_add_u32 s36, s62, 148224
  v_mfma_f32_16x16x32_bf16 v[120:123], a[44:47], a[156:159], v[120:123]
  buffer_load_dwordx4 v136, s[12:15], s36 offen offset:0 lds
  v_mfma_f32_16x16x32_bf16 v[128:131], a[24:27], a[176:179], v[128:131]
  ds_read_b64_tr_b16 a[56:57], v14 offset:0
  ds_read_b64_tr_b16 a[58:59], v14 offset:512
  v_mfma_f32_16x16x32_bf16 v[128:131], a[36:39], a[180:183], v[128:131]
  ds_read_b64_tr_b16 a[60:61], v12 offset:12288
  ds_read_b64_tr_b16 a[62:63], v12 offset:12800
  v_mfma_f32_16x16x32_bf16 v[132:135], a[40:43], a[180:183], v[132:135]
  ds_read_b64_tr_b16 a[64:65], v13 offset:12288
  ds_read_b64_tr_b16 a[66:67], v13 offset:12800
  v_mfma_f32_16x16x32_bf16 v[132:135], a[28:31], a[176:179], v[132:135]
  ds_read_b64_tr_b16 a[68:69], v14 offset:12288
  ds_read_b64_tr_b16 a[70:71], v14 offset:12800
  v_mfma_f32_16x16x32_bf16 v[140:143], a[32:35], a[176:179], v[140:143]
  buffer_load_dwordx4 v137, s[12:15], s36 offen offset:1024 lds
  v_mfma_f32_16x16x32_bf16 v[140:143], a[44:47], a[180:183], v[140:143]
  v_add_f32 v177, v151, v89
  v_add_f32 v178, v151, v90
  v_mfma_f32_16x16x32_bf16 v[16:19], a[24:27], a[200:203], v[16:19]
  v_add_f32 v179, v151, v91
  s_and_b32 s38, s28, -2
  v_mfma_f32_16x16x32_bf16 v[16:19], a[36:39], a[204:207], v[16:19]
  s_min_u32 s38, s38, 60
  s_lshl_b32 s37, s38, 1
  v_mfma_f32_16x16x32_bf16 v[20:23], a[40:43], a[204:207], v[20:23]
  buffer_load_dwordx4 v138, s[12:15], s36 offen offset:2048 lds
  v_mfma_f32_16x16x32_bf16 v[20:23], a[28:31], a[200:203], v[20:23]
  s_mov_b32 s22, 4
  s_add_u32 s46, s4, 68
  v_mfma_f32_16x16x32_bf16 v[24:27], a[32:35], a[200:203], v[24:27]
  s_mul_i32 s46, s46, 196608
  s_mov_b32 s47, 24576
  v_mfma_f32_16x16x32_bf16 v[24:27], a[44:47], a[204:207], v[24:27]
  s_add_u32 m0, s63, 86016
  s_add_u32 s36, s62, 185088
  v_mfma_f32_16x16x32_bf16 v[28:31], a[24:27], a[224:227], v[28:31]
  buffer_load_dwordx4 v136, s[12:15], s36 offen offset:0 lds
  v_mfma_f32_16x16x32_bf16 v[28:31], a[36:39], a[244:247], v[28:31]
  v_mfma_f32_16x16x32_bf16 v[32:35], a[40:43], a[244:247], v[32:35]
  s_waitcnt lgkmcnt(0)
  s_waitcnt vmcnt(10)
  s_barrier
  v_mfma_f32_16x16x32_bf16 v[32:35], a[28:31], a[224:227], v[32:35]
  ds_read_b64_tr_b16 a[72:73], v12 offset:24576
  ds_read_b64_tr_b16 a[74:75], v12 offset:25088
  v_mfma_f32_16x16x32_bf16 v[36:39], a[32:35], a[224:227], v[36:39]
  buffer_load_dwordx4 v137, s[12:15], s36 offen offset:1024 lds
  v_mfma_f32_16x16x32_bf16 v[36:39], a[44:47], a[244:247], v[36:39]
  ds_read_b64_tr_b16 a[76:77], v13 offset:24576
  v_mfma_f32_16x16x32_bf16 v[116:119], a[48:51], a[160:163], v[116:119]
  ds_read_b64_tr_b16 a[78:79], v13 offset:25088
  ds_read_b64_tr_b16 a[80:81], v14 offset:24576
  v_mfma_f32_16x16x32_bf16 v[116:119], a[60:63], a[164:167], v[116:119]
  ds_read_b64_tr_b16 a[82:83], v14 offset:25088
  ds_read_b64_tr_b16 a[84:85], v12 offset:36864
  v_mfma_f32_16x16x32_bf16 v[124:127], a[64:67], a[164:167], v[124:127]
  buffer_load_dwordx4 v138, s[12:15], s36 offen offset:2048 lds
  v_mfma_f32_16x16x32_bf16 v[124:127], a[52:55], a[160:163], v[124:127]
  ds_read_b64_tr_b16 a[86:87], v12 offset:37376
  ds_read_b64_tr_b16 a[88:89], v13 offset:36864
  v_mfma_f32_16x16x32_bf16 v[120:123], a[56:59], a[160:163], v[120:123]
  v_cvt_pk_bf16_f32 v46, v116, v117
  v_cvt_pk_bf16_f32 v47, v118, v119
  v_mfma_f32_16x16x32_bf16 v[120:123], a[68:71], a[164:167], v[120:123]
  s_add_u32 m0, s32, 40960
  ds_read_b64_tr_b16 a[90:91], v13 offset:37376
  v_mfma_f32_16x16x32_bf16 v[128:131], a[48:51], a[184:187], v[128:131]
  v_cvt_pk_bf16_f32 v48, v124, v125
  v_cvt_pk_bf16_f32 v49, v126, v127
  v_mfma_f32_16x16x32_bf16 v[128:131], a[60:63], a[188:191], v[128:131]
  buffer_load_dwordx4 v6, s[8:11], s48 offen offset:0 nt lds
  v_mfma_f32_16x16x32_bf16 v[132:135], a[64:67], a[188:191], v[132:135]
  v_cvt_pk_bf16_f32 v50, v120, v121
  v_cvt_pk_bf16_f32 v51, v122, v123
  v_mfma_f32_16x16x32_bf16 v[132:135], a[52:55], a[184:187], v[132:135]
  s_add_u32 m0, s32, 49024
  ds_read_b64_tr_b16 a[92:93], v14 offset:36864
  v_mfma_f32_16x16x32_bf16 v[140:143], a[56:59], a[184:187], v[140:143]
  v_cvt_pk_bf16_f32 v58, v128, v129
  v_cvt_pk_bf16_f32 v59, v130, v131
  v_mfma_f32_16x16x32_bf16 v[140:143], a[68:71], a[188:191], v[140:143]
  buffer_load_dwordx4 v6, s[8:11], s48 offen offset:128 nt lds
  v_mfma_f32_16x16x32_bf16 v[16:19], a[48:51], a[208:211], v[16:19]
  v_cvt_pk_bf16_f32 v60, v132, v133
  v_cvt_pk_bf16_f32 v61, v134, v135
  v_mfma_f32_16x16x32_bf16 v[16:19], a[60:63], a[212:215], v[16:19]
  s_add_u32 m0, s32, 57088
  ds_read_b64_tr_b16 a[94:95], v14 offset:37376
L_hop1:
  s_cbranch_execz L_hopped
  v_mfma_f32_16x16x32_bf16 v[20:23], a[64:67], a[212:215], v[20:23]
  v_cvt_pk_bf16_f32 v62, v140, v141
  v_cvt_pk_bf16_f32 v63, v142, v143
  v_mfma_f32_16x16x32_bf16 v[20:23], a[52:55], a[208:211], v[20:23]
  buffer_load_dwordx4 v6, s[8:11], s48 offen offset:256 nt lds
  v_mfma_f32_16x16x32_bf16 v[24:27], a[56:59], a[208:211], v[24:27]
  v_cvt_pk_bf16_f32 v76, v16, v17
  v_cvt_pk_bf16_f32 v77, v18, v19
  v_mfma_f32_16x16x32_bf16 v[24:27], a[68:71], a[212:215], v[24:27]
  s_add_u32 m0, s32, 45056
  v_mfma_f32_16x16x32_bf16 v[28:31], a[48:51], a[248:251], v[28:31]
  v_cvt_pk_bf16_f32 v78, v20, v21
  v_cvt_pk_bf16_f32 v79, v22, v23
  v_mfma_f32_16x16x32_bf16 v[28:31], a[60:63], a[252:255], v[28:31]
  s_waitcnt lgkmcnt(0)
  s_waitcnt vmcnt(9)
  s_barrier
  v_mfma_f32_16x16x32_bf16 v[32:35], a[64:67], a[252:255], v[32:35]
  v_cvt_pk_bf16_f32 v80, v24, v25
  v_cvt_pk_bf16_f32 v81, v26, v27
  v_mfma_f32_16x16x32_bf16 v[32:35], a[52:55], a[248:251], v[32:35]
  buffer_load_dwordx4 v6, s[8:11], s49 offen offset:0 nt lds
  v_mfma_f32_16x16x32_bf16 v[36:39], a[56:59], a[248:251], v[36:39]
  v_cvt_pk_bf16_f32 v82, v28, v29
  v_cvt_pk_bf16_f32 v83, v30, v31
  v_mfma_f32_16x16x32_bf16 v[36:39], a[68:71], a[252:255], v[36:39]
  s_add_u32 m0, s32, 53120
  ds_read_b64_tr_b16 a[96:97], v12 offset:49152
  v_mfma_f32_16x16x32_bf16 v[116:119], v[46:49], v[70:73], v[156:159]
  v_cvt_pk_bf16_f32 v84, v32, v33
  v_cvt_pk_bf16_f32 v85, v34, v35
  v_mfma_f32_16x16x32_bf16 v[124:127], v[58:61], v[70:73], v[160:163]
  buffer_load_dwordx4 v6, s[8:11], s49 offen offset:128 nt lds
  v_mfma_f32_16x16x32_bf16 v[120:123], v[76:79], v[70:73], v[104:107]
  v_cvt_pk_bf16_f32 v86, v36, v37
  v_cvt_pk_bf16_f32 v87, v38, v39
  v_mfma_f32_16x16x32_bf16 v[128:131], v[82:85], v[70:73], v[100:103]
  s_add_u32 m0, s32, 61184
  ds_read_b64_tr_b16 a[98:99], v12 offset:49664
  v_mfma_f32_16x16x16_bf16 v[116:119], v[50:51], v[74:75], v[116:119]
  s_cmp_lg_u32 s31, 0
  s_cbranch_scc1 L_special0
  v_mfma_f32_16x16x16_bf16 v[124:127], v[62:63], v[74:75], v[124:127]
  buffer_load_dwordx4 v6, s[8:11], s49 offen offset:256 nt lds
  v_mfma_f32_16x16x16_bf16 v[120:123], v[80:81], v[74:75], v[120:123]
  s_add_u32 s48, s48, 6291456
  s_add_u32 s49, s48, 786432
  v_mfma_f32_16x16x16_bf16 v[128:131], v[86:87], v[74:75], v[128:131]
  s_add_u32 m0, s32, 65536
  ds_read_b64_tr_b16 a[100:101], v13 offset:49152
  v_mfma_f32_16x16x16_bf16 v[132:135], v[50:51], v[68:69], v[160:163]
  buffer_load_dwordx4 v6, s[8:11], s48 offen offset:0 nt lds
  v_mfma_f32_16x16x16_bf16 v[140:143], v[62:63], v[68:69], v[180:183]
  ds_read_b64_tr_b16 a[102:103], v13 offset:49664
  ds_read_b64_tr_b16 a[104:105], v14 offset:49152
  v_mfma_f32_16x16x16_bf16 v[136:139], v[80:81], v[68:69], v[100:103]
  ds_read_b64_tr_b16 a[106:107], v14 offset:49664
  ds_read_b64_tr_b16 a[108:109], v12 offset:61440
  v_mfma_f32_16x16x16_bf16 v[144:147], v[86:87], v[68:69], v[96:99]
  s_add_u32 m0, s32, 73600
  ds_read_b64_tr_b16 a[110:111], v12 offset:61952
  v_mfma_f32_16x16x16_bf16 v[148:151], v[50:51], v[56:57], v[104:107]
  buffer_load_dwordx4 v6, s[8:11], s48 offen offset:128 nt lds
  v_mfma_f32_16x16x16_bf16 v[156:159], v[62:63], v[56:57], v[100:103]
  ds_read_b64_tr_b16 a[112:113], v13 offset:61440
  ds_read_b64_tr_b16 a[114:115], v13 offset:61952
  v_mfma_f32_16x16x16_bf16 v[152:155], v[80:81], v[56:57], v[152:155]
  ds_read_b64_tr_b16 a[116:117], v14 offset:61440
  ds_read_b64_tr_b16 a[118:119], v14 offset:61952
  v_mfma_f32_16x16x16_bf16 v[160:163], v[86:87], v[56:57], v[168:171]
  s_add_u32 m0, s32, 81664
  v_mfma_f32_16x16x16_bf16 v[164:167], v[50:51], v[44:45], v[100:103]
  buffer_load_dwordx4 v6, s[8:11], s48 offen offset:256 nt lds
  v_mfma_f32_16x16x16_bf16 v[172:175], v[62:63], v[44:45], v[96:99]
  v_exp_f32 v116, v116
  v_mfma_f32_16x16x16_bf16 v[168:171], v[80:81], v[44:45], v[168:171]
  v_exp_f32 v117, v117
  v_mfma_f32_16x16x16_bf16 v[176:179], v[86:87], v[44:45], v[176:179]
  v_exp_f32 v118, v118
  v_mfma_f32_16x16x32_bf16 v[132:135], v[46:49], v[64:67], v[132:135]
  s_waitcnt lgkmcnt(0)
  s_waitcnt vmcnt(9)
  s_barrier
  v_mfma_f32_16x16x32_bf16 v[140:143], v[58:61], v[64:67], v[140:143]
  ds_read_b64_tr_b16 a[120:121], v15 offset:0
  ds_read_b64_tr_b16 a[122:123], v15 offset:512
  v_mfma_f32_16x16x32_bf16 v[136:139], v[76:79], v[64:67], v[136:139]
  ds_read_b64_tr_b16 a[124:125], v9 offset:0
  ds_read_b64_tr_b16 a[126:127], v9 offset:512
  v_mfma_f32_16x16x32_bf16 v[144:147], v[82:85], v[64:67], v[144:147]
  ds_read_b64_tr_b16 a[128:129], v11 offset:0
  ds_read_b64_tr_b16 a[130:131], v11 offset:512
  v_mfma_f32_16x16x32_bf16 v[148:151], v[46:49], v[52:55], v[148:151]
  ds_read_b64_tr_b16 a[132:133], v15 offset:12288
  ds_read_b64_tr_b16 a[134:135], v15 offset:12800
  v_mfma_f32_16x16x32_bf16 v[156:159], v[58:61], v[52:55], v[156:159]
  ds_read_b64_tr_b16 a[136:137], v9 offset:12288
  ds_read_b64_tr_b16 a[138:139], v9 offset:12800
  v_mfma_f32_16x16x32_bf16 v[152:155], v[76:79], v[52:55], v[152:155]
  ds_read_b64_tr_b16 a[140:141], v11 offset:12288
  ds_read_b64_tr_b16 a[142:143], v11 offset:12800
  v_mfma_f32_16x16x32_bf16 v[160:163], v[82:85], v[52:55], v[160:163]
  v_exp_f32 v119, v119
  v_mfma_f32_16x16x32_bf16 v[164:167], v[46:49], v[40:43], v[164:167]
  v_cvt_pk_bf16_f32 v116, v116, v117
  v_cvt_pk_bf16_f32 v117, v118, v119
  v_mfma_f32_16x16x32_bf16 v[172:175], v[58:61], v[40:43], v[172:175]
  v_exp_f32 v124, v124
  v_mfma_f32_16x16x32_bf16 v[168:171], v[76:79], v[40:43], v[168:171]
  v_exp_f32 v125, v125
  v_mfma_f32_16x16x32_bf16 v[176:179], v[82:85], v[40:43], v[176:179]
  v_exp_f32 v126, v126
L_enter:
  v_mfma_f32_16x16x32_bf16 v[40:43], a[144:147], a[72:75], 0
  v_exp_f32 v127, v127
  v_mfma_f32_16x16x32_bf16 v[40:43], a[148:151], a[84:87], v[40:43]
  v_cvt_pk_bf16_f32 v118, v124, v125
  v_cvt_pk_bf16_f32 v119, v126, v127
  v_mfma_f32_16x16x32_bf16 v[40:43], a[152:155], a[96:99], v[40:43]
  v_exp_f32 v120, v120
  v_mfma_f32_16x16x32_bf16 v[40:43], a[156:159], a[108:111], v[40:43]
  s_waitcnt lgkmcnt(0)
  v_mfma_f32_16x16x32_bf16 v[40:43], a[160:163], a[120:123], v[40:43]
  v_exp_f32 v121, v121
  v_mfma_f32_16x16x32_bf16 v[40:43], a[164:167], a[132:135], v[40:43]
  v_exp_f32 v122, v122
  v_mfma_f32_16x16x32_bf16 v[44:47], a[164:167], a[136:139], 0
  v_exp_f32 v123, v123
  v_mfma_f32_16x16x32_bf16 v[44:47], a[160:163], a[124:127], v[44:47]
  v_cvt_pk_bf16_f32 v120, v120, v121
  v_cvt_pk_bf16_f32 v121, v122, v123
  v_mfma_f32_16x16x32_bf16 v[44:47], a[156:159], a[112:115], v[44:47]
  v_cvt_pk_bf16_f32 v16, v40, v41
  v_cvt_pk_bf16_f32 v17, v42, v43
  v_mfma_f32_16x16x32_bf16 v[44:47], a[152:155], a[100:103], v[44:47]
  v_exp_f32 v128, v128
  v_mfma_f32_16x16x32_bf16 v[44:47], a[148:151], a[88:91], v[44:47]
  v_exp_f32 v129, v129
  v_mfma_f32_16x16x32_bf16 v[44:47], a[144:147], a[76:79], v[44:47]
  v_exp_f32 v130, v130
  v_mfma_f32_16x16x32_bf16 v[40:43], a[144:147], a[80:83], 0
  v_exp_f32 v131, v131
  v_mfma_f32_16x16x32_bf16 v[40:43], a[148:151], a[92:95], v[40:43]
  v_cvt_pk_bf16_f32 v122, v128, v129
  v_cvt_pk_bf16_f32 v123, v130, v131
  v_mfma_f32_16x16x32_bf16 v[40:43], a[152:155], a[104:107], v[40:43]
  v_cvt_pk_bf16_f32 v24, v44, v45
  v_cvt_pk_bf16_f32 v25, v46, v47
  v_mfma_f32_16x16x32_bf16 v[40:43], a[156:159], a[116:119], v[40:43]
  v_exp_f32 v132, v132
  v_mfma_f32_16x16x32_bf16 v[40:43], a[160:163], a[128:131], v[40:43]
  v_exp_f32 v133, v133
  v_mfma_f32_16x16x32_bf16 v[40:43], a[164:167], a[140:143], v[40:43]
  v_exp_f32 v134, v134
  v_mfma_f32_16x16x32_bf16 v[44:47], a[168:171], a[72:75], 0
  v_cvt_pk_bf16_f32 v132, v132, v133
  v_mfma_f32_16x16x32_bf16 v[44:47], a[172:175], a[84:87], v[44:47]
  v_exp_f32 v135, v135
  v_mfma_f32_16x16x32_bf16 v[44:47], a[176:179], a[96:99], v[44:47]
  v_cvt_pk_bf16_f32 v32, v40, v41
  v_cvt_pk_bf16_f32 v33, v42, v43
  v_mfma_f32_16x16x32_bf16 v[44:47], a[180:183], a[108:111], v[44:47]
  v_exp_f32 v140, v140
  v_mfma_f32_16x16x32_bf16 v[44:47], a[184:187], a[120:123], v[44:47]
  v_exp_f32 v141, v141
  v_mfma_f32_16x16x32_bf16 v[44:47], a[188:191], a[132:135], v[44:47]
  v_cvt_pk_bf16_f32 v133, v134, v135
  v_cvt_pk_bf16_f32 v134, v140, v141
  v_mfma_f32_16x16x32_bf16 v[40:43], a[188:191], a[136:139], 0
  v_exp_f32 v142, v142
  v_mfma_f32_16x16x32_bf16 v[40:43], a[184:187], a[124:127], v[40:43]
  v_exp_f32 v143, v143
  v_mfma_f32_16x16x32_bf16 v[40:43], a[180:183], a[112:115], v[40:43]
  v_cvt_pk_bf16_f32 v18, v44, v45
  v_cvt_pk_bf16_f32 v19, v46, v47
  v_mfma_f32_16x16x32_bf16 v[40:43], a[176:179], a[100:103], v[40:43]
  v_cvt_pk_bf16_f32 v135, v142, v143
  v_mfma_f32_16x16x32_bf16 v[40:43], a[172:175], a[88:91], v[40:43]
  v_exp_f32 v136, v136
  v_mfma_f32_16x16x32_bf16 v[40:43], a[168:171], a[76:79], v[40:43]
  v_exp_f32 v137, v137
  v_mfma_f32_16x16x32_bf16 v[44:47], a[168:171], a[80:83], 0
  v_exp_f32 v138, v138
  v_mfma_f32_16x16x32_bf16 v[44:47], a[172:175], a[92:95], v[44:47]
  v_exp_f32 v139, v139
  v_mfma_f32_16x16x32_bf16 v[44:47], a[176:179], a[104:107], v[44:47]
  v_cvt_pk_bf16_f32 v26, v40, v41
  v_cvt_pk_bf16_f32 v27, v42, v43
  v_mfma_f32_16x16x32_bf16 v[44:47], a[180:183], a[116:119], v[44:47]
  v_cvt_pk_bf16_f32 v136, v136, v137
  v_cvt_pk_bf16_f32 v137, v138, v139
  v_mfma_f32_16x16x32_bf16 v[44:47], a[184:187], a[128:131], v[44:47]
  v_exp_f32 v144, v144
  v_mfma_f32_16x16x32_bf16 v[44:47], a[188:191], a[140:143], v[44:47]
  v_exp_f32 v145, v145
  v_mfma_f32_16x16x32_bf16 v[40:43], a[192:195], a[72:75], 0
  v_exp_f32 v146, v146
  v_mfma_f32_16x16x32_bf16 v[40:43], a[196:199], a[84:87], v[40:43]
  v_exp_f32 v147, v147
  v_mfma_f32_16x16x32_bf16 v[40:43], a[200:203], a[96:99], v[40:43]
  v_cvt_pk_bf16_f32 v34, v44, v45
  v_cvt_pk_bf16_f32 v35, v46, v47
  v_mfma_f32_16x16x32_bf16 v[40:43], a[204:207], a[108:111], v[40:43]
  v_cvt_pk_bf16_f32 v138, v144, v145
  v_cvt_pk_bf16_f32 v139, v146, v147
  v_mfma_f32_16x16x32_bf16 v[40:43], a[208:211], a[120:123], v[40:43]
  v_exp_f32 v148, v148
  v_mfma_f32_16x16x32_bf16 v[40:43], a[212:215], a[132:135], v[40:43]
  v_exp_f32 v149, v149
  v_mfma_f32_16x16x32_bf16 v[44:47], a[212:215], a[136:139], 0
  v_mov_b64 v[144:145], 0
  v_cvt_pk_bf16_f32 v148, v148, v149
  v_mfma_f32_16x16x32_bf16 v[44:47], a[208:211], a[124:127], v[44:47]
  v_exp_f32 v150, v150
  v_mfma_f32_16x16x32_bf16 v[44:47], a[204:207], a[112:115], v[44:47]
  v_cvt_pk_bf16_f32 v20, v40, v41
  v_cvt_pk_bf16_f32 v21, v42, v43
  v_mfma_f32_16x16x32_bf16 v[44:47], a[200:203], a[100:103], v[44:47]
  v_exp_f32 v151, v151
  v_mfma_f32_16x16x32_bf16 v[44:47], a[196:199], a[88:91], v[44:47]
  v_exp_f32 v156, v156
  v_mfma_f32_16x16x32_bf16 v[44:47], a[192:195], a[76:79], v[44:47]
  v_exp_f32 v157, v157
  v_mfma_f32_16x16x32_bf16 v[40:43], a[192:195], a[80:83], 0
  v_cvt_pk_bf16_f32 v149, v150, v151
  v_cvt_pk_bf16_f32 v150, v156, v157
  v_mfma_f32_16x16x32_bf16 v[40:43], a[196:199], a[92:95], v[40:43]
  v_exp_f32 v158, v158
  v_mfma_f32_16x16x32_bf16 v[40:43], a[200:203], a[104:107], v[40:43]
  v_cvt_pk_bf16_f32 v28, v44, v45
  v_cvt_pk_bf16_f32 v29, v46, v47
  v_mfma_f32_16x16x32_bf16 v[40:43], a[204:207], a[116:119], v[40:43]
  v_exp_f32 v159, v159
  v_mfma_f32_16x16x32_bf16 v[40:43], a[208:211], a[128:131], v[40:43]
  v_cvt_pk_bf16_f32 v151, v158, v159
  v_mfma_f32_16x16x32_bf16 v[40:43], a[212:215], a[140:143], v[40:43]
  v_exp_f32 v152, v152
  v_mfma_f32_16x16x32_bf16 v[44:47], a[216:219], a[72:75], 0
  v_exp_f32 v153, v153
  v_mfma_f32_16x16x32_bf16 v[44:47], a[220:223], a[84:87], v[44:47]
  v_exp_f32 v154, v154
  v_mfma_f32_16x16x32_bf16 v[44:47], a[224:227], a[96:99], v[44:47]
  v_cvt_pk_bf16_f32 v36, v40, v41
  v_cvt_pk_bf16_f32 v37, v42, v43
  v_mfma_f32_16x16x32_bf16 v[44:47], a[244:247], a[108:111], v[44:47]
  v_exp_f32 v155, v155
  v_mfma_f32_16x16x32_bf16 v[44:47], a[248:251], a[120:123], v[44:47]
  v_cvt_pk_bf16_f32 v152, v152, v153
  v_cvt_pk_bf16_f32 v153, v154, v155
  v_mfma_f32_16x16x32_bf16 v[44:47], a[252:255], a[132:135], v[44:47]
  v_exp_f32 v160, v160
  v_mfma_f32_16x16x32_bf16 v[40:43], a[252:255], a[136:139], 0
  v_exp_f32 v161, v161
  v_mfma_f32_16x16x32_bf16 v[40:43], a[248:251], a[124:127], v[40:43]
  v_exp_f32 v162, v162
  v_mfma_f32_16x16x32_bf16 v[40:43], a[244:247], a[112:115], v[40:43]
  v_cvt_pk_bf16_f32 v22, v44, v45
  v_cvt_pk_bf16_f32 v23, v46, v47
  v_mfma_f32_16x16x32_bf16 v[40:43], a[224:227], a[100:103], v[40:43]
  v_exp_f32 v163, v163
  v_mfma_f32_16x16x32_bf16 v[40:43], a[220:223], a[88:91], v[40:43]
  v_cvt_pk_bf16_f32 v154, v160, v161
  v_cvt_pk_bf16_f32 v155, v162, v163
  v_mfma_f32_16x16x32_bf16 v[40:43], a[216:219], a[76:79], v[40:43]
  v_exp_f32 v164, v164
  v_mfma_f32_16x16x32_bf16 v[44:47], a[216:219], a[80:83], 0
  v_exp_f32 v165, v165
  v_mfma_f32_16x16x32_bf16 v[44:47], a[220:223], a[92:95], v[44:47]
  v_exp_f32 v166, v166
  v_mfma_f32_16x16x32_bf16 v[44:47], a[224:227], a[104:107], v[44:47]
  v_cvt_pk_bf16_f32 v30, v40, v41
  v_cvt_pk_bf16_f32 v31, v42, v43
  v_mfma_f32_16x16x32_bf16 v[44:47], a[244:247], a[116:119], v[44:47]
  v_exp_f32 v167, v167
  v_mfma_f32_16x16x32_bf16 v[44:47], a[248:251], a[128:131], v[44:47]
  v_cvt_pk_bf16_f32 v164, v164, v165
  v_cvt_pk_bf16_f32 v165, v166, v167
  v_mfma_f32_16x16x32_bf16 v[44:47], a[252:255], a[140:143], v[44:47]
  v_exp_f32 v172, v172
  s_add_u32 s32, s32, 40960
  v_mad_i32_i16 v0, v10, 1, s32 op_sel:[1,0,0,0]
  v_xor_b32 v1, 64, v0
  s_add_u32 s20, s20, s37
  s_addc_u32 s21, s21, 0
  v_exp_f32 v173, v173
  v_exp_f32 v174, v174
  v_smfmac_f32_16x16x64_bf16 v[144:147], a[240:243], v[116:123], v10
  v_exp_f32 v175, v175
  v_mfma_f32_16x16x32_bf16 v[124:127], v[20:23], v[120:123], 0
  v_cvt_pk_bf16_f32 v166, v172, v173
  v_cvt_pk_bf16_f32 v167, v174, v175
  v_mfma_f32_16x16x32_bf16 v[124:127], v[16:19], v[116:119], v[124:127]
  v_cvt_pk_bf16_f32 v38, v44, v45
  v_cvt_pk_bf16_f32 v39, v46, v47
  v_mfma_f32_16x16x32_bf16 v[128:131], v[24:27], v[116:119], 0
  v_add_f32 v15, v144, v145
  v_mov_b64 v[144:145], 0
  v_mfma_f32_16x16x32_bf16 v[128:131], v[28:31], v[120:123], v[128:131]
  v_exp_f32 v168, v168
  v_mfma_f32_16x16x32_bf16 v[140:143], v[36:39], v[120:123], 0
  v_exp_f32 v169, v169
  v_mfma_f32_16x16x32_bf16 v[140:143], v[32:35], v[116:119], v[140:143]
  v_exp_f32 v170, v170
  v_smfmac_f32_16x16x64_bf16 v[144:147], a[240:243], v[132:139], v10
  v_exp_f32 v171, v171
  v_mfma_f32_16x16x32_bf16 v[116:119], v[20:23], v[136:139], 0
  v_cvt_pk_bf16_f32 v168, v168, v169
  v_cvt_pk_bf16_f32 v169, v170, v171
  v_mfma_f32_16x16x32_bf16 v[116:119], v[16:19], v[132:135], v[116:119]
  v_exp_f32 v176, v176
  v_mfma_f32_16x16x32_bf16 v[120:123], v[24:27], v[132:135], 0
  v_add_f32 v14, v144, v145
  v_mov_b64 v[144:145], 0
  v_mfma_f32_16x16x32_bf16 v[120:123], v[28:31], v[136:139], v[120:123]
  v_exp_f32 v177, v177
  v_mfma_f32_16x16x32_bf16 v[156:159], v[36:39], v[136:139], 0
  v_exp_f32 v178, v178
  v_mfma_f32_16x16x32_bf16 v[156:159], v[32:35], v[132:135], v[156:159]
  v_exp_f32 v179, v179
  v_smfmac_f32_16x16x64_bf16 v[144:147], a[240:243], v[148:155], v10
  v_cvt_pk_bf16_f32 v170, v176, v177
  v_cvt_pk_bf16_f32 v171, v178, v179
  v_mfma_f32_16x16x32_bf16 v[132:135], v[20:23], v[152:155], 0
  s_add_u32 m0, s32, 28672
  v_max_f32 v9, v14, v15
  v_mfma_f32_16x16x32_bf16 v[132:135], v[16:19], v[148:151], v[132:135]
  s_waitcnt vmcnt(6)
  s_barrier
  v_mfma_f32_16x16x32_bf16 v[136:139], v[24:27], v[148:151], 0
  v_add_f32 v13, v144, v145
  v_mov_b64 v[144:145], 0
  v_mfma_f32_16x16x32_bf16 v[136:139], v[28:31], v[152:155], v[136:139]
  ds_read_b128 a[244:247], v0 offset:0
  ds_read_b128 a[248:251], v1 offset:0
  v_mfma_f32_16x16x32_bf16 v[160:163], v[36:39], v[152:155], 0
  buffer_load_dwordx4 v6, s[8:11], s49 offen offset:0 nt lds
  v_mfma_f32_16x16x32_bf16 v[160:163], v[32:35], v[148:151], v[160:163]
  ds_read_b128 a[252:255], v0 offset:8192
  ds_read_b128 v[180:183], v1 offset:8192
  v_smfmac_f32_16x16x64_bf16 v[144:147], a[240:243], v[164:171], v10
  s_add_u32 m0, s32, 36736
  v_mfma_f32_16x16x32_bf16 v[148:151], v[20:23], v[168:171], 0
  ds_read_b128 v[64:67], v0 offset:16384
  ds_read_b128 v[68:71], v1 offset:16384
  v_mfma_f32_16x16x32_bf16 v[148:151], v[16:19], v[164:167], v[148:151]
  buffer_load_dwordx4 v6, s[8:11], s49 offen offset:128 nt lds
  v_mfma_f32_16x16x32_bf16 v[152:155], v[24:27], v[164:167], 0
  v_add_f32 v12, v144, v145
  s_add_u32 m0, s32, 44800
  v_mfma_f32_16x16x32_bf16 v[152:155], v[28:31], v[168:171], v[152:155]
  buffer_load_dwordx4 v6, s[8:11], s49 offen offset:256 nt lds
  v_mfma_f32_16x16x32_bf16 v[172:175], v[36:39], v[168:171], 0
  v_rcp_f32 v15, v15
  v_mfma_f32_16x16x32_bf16 v[172:175], v[32:35], v[164:167], v[172:175]
  s_waitcnt lgkmcnt(4)
  v_mfma_f32_16x16x32_bf16 v[76:79], v[184:187], a[244:247], 0
  v_rcp_f32 v14, v14
  v_mfma_f32_16x16x32_bf16 v[76:79], v[196:199], a[248:251], v[76:79]
  s_waitcnt lgkmcnt(2)
  v_mul_f32 v124, v15, v124
  v_mfma_f32_16x16x32_bf16 v[76:79], v[208:211], a[252:255], v[76:79]
  v_mul_f32 v125, v15, v125
  v_mul_f32 v126, v15, v126
  v_mfma_f32_16x16x32_bf16 v[76:79], v[220:223], v[180:183], v[76:79]
  s_waitcnt lgkmcnt(0)
  v_mul_f32 v127, v15, v127
  v_mfma_f32_16x16x32_bf16 v[76:79], v[232:235], v[64:67], v[76:79]
  v_cvt_pk_bf16_f32 v124, v124, v125
  v_cvt_pk_bf16_f32 v125, v126, v127
  v_mfma_f32_16x16x32_bf16 v[76:79], v[244:247], v[68:71], v[76:79]
  v_mul_f32 v128, v15, v128
  v_mul_f32 v129, v15, v129
  v_mfma_f32_16x16x32_bf16 v[80:83], v[248:251], v[68:71], 0
  v_mul_f32 v130, v15, v130
  v_mul_f32 v131, v15, v131
  v_mfma_f32_16x16x32_bf16 v[80:83], v[236:239], v[64:67], v[80:83]
  v_cvt_pk_bf16_f32 v126, v128, v129
  v_cvt_pk_bf16_f32 v127, v130, v131
  v_mfma_f32_16x16x32_bf16 v[80:83], v[224:227], v[180:183], v[80:83]
  v_cvt_pk_bf16_f32 v40, v76, v77
  v_cvt_pk_bf16_f32 v41, v78, v79
  v_mfma_f32_16x16x32_bf16 v[80:83], v[212:215], a[252:255], v[80:83]
  ds_write_b128 v4, v[124:127] offset:768
  v_mfma_f32_16x16x32_bf16 v[80:83], v[200:203], a[248:251], v[80:83]
  v_mul_f32 v140, v15, v140
  v_mul_f32 v141, v15, v141
  v_mfma_f32_16x16x32_bf16 v[80:83], v[188:191], a[244:247], v[80:83]
  v_mul_f32 v142, v15, v142
  v_mul_f32 v143, v15, v143
  v_mfma_f32_16x16x32_bf16 v[76:79], v[192:195], a[244:247], 0
  v_cvt_pk_bf16_f32 v140, v140, v141
  v_cvt_pk_bf16_f32 v141, v142, v143
  v_mfma_f32_16x16x32_bf16 v[76:79], v[204:207], a[248:251], v[76:79]
  ds_write_b64 v5, v[140:141] offset:768
  v_mfma_f32_16x16x32_bf16 v[76:79], v[216:219], a[252:255], v[76:79]
  v_cvt_pk_bf16_f32 v42, v80, v81
  v_cvt_pk_bf16_f32 v43, v82, v83
  v_mfma_f32_16x16x32_bf16 v[76:79], v[228:231], v[180:183], v[76:79]
  v_max3_f32 v9, v12, v13, v9
  v_mfma_f32_16x16x32_bf16 v[76:79], v[240:243], v[64:67], v[76:79]
  v_rcp_f32 v13, v13
  v_mfma_f32_16x16x32_bf16 v[76:79], v[252:255], v[68:71], v[76:79]
  v_mul_f32 v116, v14, v116
  v_mul_f32 v117, v14, v117
  v_mfma_f32_16x16x32_bf16 v[80:83], a[60:63], v[68:71], 0
  v_mul_f32 v118, v14, v118
  v_mul_f32 v119, v14, v119
  v_mfma_f32_16x16x32_bf16 v[80:83], a[48:51], v[64:67], v[80:83]
  v_cvt_pk_bf16_f32 v116, v116, v117
  v_cvt_pk_bf16_f32 v117, v118, v119
  v_mfma_f32_16x16x32_bf16 v[80:83], a[36:39], v[180:183], v[80:83]
  v_cvt_pk_bf16_f32 v44, v76, v77
  v_cvt_pk_bf16_f32 v45, v78, v79
  v_mfma_f32_16x16x32_bf16 v[80:83], a[24:27], a[252:255], v[80:83]
  v_mul_f32 v120, v14, v120
  v_mul_f32 v121, v14, v121
  v_mfma_f32_16x16x32_bf16 v[80:83], a[12:15], a[248:251], v[80:83]
  v_mul_f32 v122, v14, v122
  v_mul_f32 v123, v14, v123
  v_mfma_f32_16x16x32_bf16 v[80:83], a[0:3], a[244:247], v[80:83]
  v_cvt_pk_bf16_f32 v118, v120, v121
  v_cvt_pk_bf16_f32 v119, v122, v123
  v_mfma_f32_16x16x32_bf16 v[76:79], a[4:7], a[244:247], 0
  ds_write_b128 v4, v[116:119] offset:512
  v_mfma_f32_16x16x32_bf16 v[76:79], a[16:19], a[248:251], v[76:79]
  v_mul_f32 v156, v14, v156
  v_mul_f32 v157, v14, v157
  v_mfma_f32_16x16x32_bf16 v[76:79], a[28:31], a[252:255], v[76:79]
  v_cvt_pk_bf16_f32 v46, v80, v81
  v_cvt_pk_bf16_f32 v47, v82, v83
  v_mfma_f32_16x16x32_bf16 v[76:79], a[40:43], v[180:183], v[76:79]
  v_mul_f32 v158, v14, v158
  v_mul_f32 v159, v14, v159
  v_mfma_f32_16x16x32_bf16 v[76:79], a[52:55], v[64:67], v[76:79]
  v_cvt_pk_bf16_f32 v156, v156, v157
  v_cvt_pk_bf16_f32 v157, v158, v159
  v_mfma_f32_16x16x32_bf16 v[76:79], a[64:67], v[68:71], v[76:79]
  ds_write_b64 v5, v[156:157] offset:512
  v_mfma_f32_16x16x32_bf16 v[80:83], a[68:71], v[68:71], 0
  v_rcp_f32 v12, v12
  v_mfma_f32_16x16x32_bf16 v[80:83], a[56:59], v[64:67], v[80:83]
  v_mul_f32 v132, v13, v132
  v_mul_f32 v133, v13, v133
  v_mfma_f32_16x16x32_bf16 v[80:83], a[44:47], v[180:183], v[80:83]
  v_cvt_pk_bf16_f32 v48, v76, v77
  v_cvt_pk_bf16_f32 v49, v78, v79
  v_mfma_f32_16x16x32_bf16 v[80:83], a[32:35], a[252:255], v[80:83]
  v_mul_f32 v134, v13, v134
  v_mul_f32 v135, v13, v135
  v_mfma_f32_16x16x32_bf16 v[80:83], a[20:23], a[248:251], v[80:83]
  v_cvt_pk_bf16_f32 v132, v132, v133
  v_cvt_pk_bf16_f32 v133, v134, v135
  v_mfma_f32_16x16x32_bf16 v[80:83], a[8:11], a[244:247], v[80:83]
  v_mul_f32 v136, v13, v136
  v_mul_f32 v137, v13, v137
  v_mfma_f32_16x16x32_bf16 v[76:79], a[244:247], a[72:75], 0
  v_mul_f32 v138, v13, v138
  v_mul_f32 v139, v13, v139
  v_mfma_f32_16x16x32_bf16 v[76:79], a[248:251], a[84:87], v[76:79]
  v_cvt_pk_bf16_f32 v134, v136, v137
  v_cvt_pk_bf16_f32 v135, v138, v139
  v_mfma_f32_16x16x32_bf16 v[76:79], a[252:255], a[96:99], v[76:79]
  v_cvt_pk_bf16_f32 v50, v80, v81
  v_cvt_pk_bf16_f32 v51, v82, v83
  v_mfma_f32_16x16x32_bf16 v[76:79], v[180:183], a[108:111], v[76:79]
  ds_read_b128 v[72:75], v0 offset:2048
  v_mfma_f32_16x16x32_bf16 v[76:79], v[64:67], a[120:123], v[76:79]
  ds_read_b128 v[84:87], v1 offset:2048
  v_mfma_f32_16x16x32_bf16 v[76:79], v[68:71], a[132:135], v[76:79]
  ds_read_b128 v[164:167], v0 offset:10240
  v_mfma_f32_16x16x32_bf16 v[80:83], v[68:71], a[136:139], 0
  ds_read_b128 v[168:171], v1 offset:10240
  v_mfma_f32_16x16x32_bf16 v[80:83], v[64:67], a[124:127], v[80:83]
  ds_read_b128 v[176:179], v0 offset:18432
  v_mfma_f32_16x16x32_bf16 v[80:83], v[180:183], a[112:115], v[80:83]
  v_cvt_pk_bf16_f32 v16, v76, v77
  v_cvt_pk_bf16_f32 v17, v78, v79
  v_mfma_f32_16x16x32_bf16 v[80:83], a[252:255], a[100:103], v[80:83]
  ds_read_b128 v[144:147], v1 offset:18432
  v_mfma_f32_16x16x32_bf16 v[80:83], a[248:251], a[88:91], v[80:83]
  ds_write_b128 v4, v[132:135] offset:256
  v_mfma_f32_16x16x32_bf16 v[80:83], a[244:247], a[76:79], v[80:83]
  v_mul_f32 v160, v13, v160
  v_mul_f32 v161, v13, v161
  v_mfma_f32_16x16x32_bf16 v[76:79], a[244:247], a[80:83], 0
  v_mul_f32 v162, v13, v162
  v_mul_f32 v163, v13, v163
  v_mfma_f32_16x16x32_bf16 v[76:79], a[248:251], a[92:95], v[76:79]
  v_cvt_pk_bf16_f32 v160, v160, v161
  v_cvt_pk_bf16_f32 v161, v162, v163
  v_mfma_f32_16x16x32_bf16 v[76:79], a[252:255], a[104:107], v[76:79]
  v_cvt_pk_bf16_f32 v24, v80, v81
  v_cvt_pk_bf16_f32 v25, v82, v83
  v_mfma_f32_16x16x32_bf16 v[76:79], v[180:183], a[116:119], v[76:79]
  ds_write_b64 v5, v[160:161] offset:256
  v_mfma_f32_16x16x32_bf16 v[76:79], v[64:67], a[128:131], v[76:79]
  v_mul_f32 v148, v12, v148
  v_mul_f32 v149, v12, v149
  v_mfma_f32_16x16x32_bf16 v[76:79], v[68:71], a[140:143], v[76:79]
  s_waitcnt lgkmcnt(2)
  v_mul_f32 v150, v12, v150
  v_mfma_f32_16x16x32_bf16 v[80:83], v[184:187], v[72:75], 0
  v_mul_f32 v151, v12, v151
  v_cvt_pk_bf16_f32 v148, v148, v149
  v_mfma_f32_16x16x32_bf16 v[80:83], v[196:199], v[84:87], v[80:83]
  v_cvt_pk_bf16_f32 v149, v150, v151
  v_mul_f32 v152, v12, v152
  v_mfma_f32_16x16x32_bf16 v[80:83], v[208:211], v[164:167], v[80:83]
  v_cvt_pk_bf16_f32 v32, v76, v77
  v_cvt_pk_bf16_f32 v33, v78, v79
  v_mfma_f32_16x16x32_bf16 v[80:83], v[220:223], v[168:171], v[80:83]
  v_mul_f32 v153, v12, v153
  v_mul_f32 v154, v12, v154
  v_mfma_f32_16x16x32_bf16 v[80:83], v[232:235], v[176:179], v[80:83]
  v_mul_f32 v155, v12, v155
  v_cvt_pk_bf16_f32 v150, v152, v153
  v_mfma_f32_16x16x32_bf16 v[80:83], v[244:247], v[144:147], v[80:83]
  v_cvt_pk_bf16_f32 v151, v154, v155
  v_mfma_f32_16x16x32_bf16 v[76:79], v[248:251], v[144:147], 0
  ds_write_b128 v4, v[148:151] offset:0
  v_mfma_f32_16x16x32_bf16 v[76:79], v[236:239], v[176:179], v[76:79]
  v_mul_f32 v172, v12, v172
  v_mul_f32 v173, v12, v173
  v_mfma_f32_16x16x32_bf16 v[76:79], v[224:227], v[168:171], v[76:79]
  v_cvt_pk_bf16_f32 v52, v80, v81
  v_cvt_pk_bf16_f32 v53, v82, v83
  v_mfma_f32_16x16x32_bf16 v[76:79], v[212:215], v[164:167], v[76:79]
  v_mul_f32 v174, v12, v174
  v_mul_f32 v175, v12, v175
  v_mfma_f32_16x16x32_bf16 v[76:79], v[200:203], v[84:87], v[76:79]
  v_cvt_pk_bf16_f32 v172, v172, v173
  v_cvt_pk_bf16_f32 v173, v174, v175
  v_mfma_f32_16x16x32_bf16 v[76:79], v[188:191], v[72:75], v[76:79]
  ds_write_b64 v5, v[172:173] offset:0
  v_mfma_f32_16x16x32_bf16 v[80:83], v[192:195], v[72:75], 0
  v_subrev_u32 v3, s7, v3
  v_subrev_u32 v2, s7, v2
  v_mfma_f32_16x16x32_bf16 v[80:83], v[204:207], v[84:87], v[80:83]
  v_add_u32 v4, s7, v4
  v_add_u32 v5, s7, v5
  v_mfma_f32_16x16x32_bf16 v[80:83], v[216:219], v[164:167], v[80:83]
  v_cvt_pk_bf16_f32 v54, v76, v77
  v_cvt_pk_bf16_f32 v55, v78, v79
  v_mfma_f32_16x16x32_bf16 v[80:83], v[228:231], v[168:171], v[80:83]
  s_sub_u32 s7, 0, s7
  v_max3_f32 v9, v12, v13, v9
  v_mfma_f32_16x16x32_bf16 v[80:83], v[240:243], v[176:179], v[80:83]
  v_max3_f32 v9, v14, v15, v9
  v_accvgpr_read_b32 v180, a228
  v_mfma_f32_16x16x32_bf16 v[80:83], v[252:255], v[144:147], v[80:83]
  s_add_u32 m0, s58, 114688
  s_add_u32 s36, s58, 0
  v_mfma_f32_16x16x32_bf16 v[76:79], a[60:63], v[144:147], 0
  buffer_load_dwordx4 v180, s[16:19], s36 offen offset:0 lds
  v_mfma_f32_16x16x32_bf16 v[76:79], a[48:51], v[176:179], v[76:79]
  buffer_load_dwordx4 v180, s[16:19], s36 offen offset:1024 lds
  v_mfma_f32_16x16x32_bf16 v[76:79], a[36:39], v[168:171], v[76:79]
  v_cvt_pk_bf16_f32 v56, v80, v81
  v_cvt_pk_bf16_f32 v57, v82, v83
  v_mfma_f32_16x16x32_bf16 v[76:79], a[24:27], v[164:167], v[76:79]
  buffer_load_dwordx4 v180, s[16:19], s36 offen offset:2048 lds
  v_mfma_f32_16x16x32_bf16 v[76:79], a[12:15], v[84:87], v[76:79]
  s_add_u32 m0, s58, 126976
  s_add_u32 s36, s58, 18432
  v_mfma_f32_16x16x32_bf16 v[76:79], a[0:3], v[72:75], v[76:79]
  buffer_load_dwordx4 v180, s[16:19], s36 offen offset:0 lds
  v_mfma_f32_16x16x32_bf16 v[80:83], a[4:7], v[72:75], 0
  buffer_load_dwordx4 v180, s[16:19], s36 offen offset:1024 lds
  v_mfma_f32_16x16x32_bf16 v[80:83], a[16:19], v[84:87], v[80:83]
  buffer_load_dwordx4 v180, s[16:19], s36 offen offset:2048 lds
  v_mfma_f32_16x16x32_bf16 v[80:83], a[28:31], v[164:167], v[80:83]
  v_cvt_pk_bf16_f32 v58, v76, v77
  v_cvt_pk_bf16_f32 v59, v78, v79
  v_mfma_f32_16x16x32_bf16 v[80:83], a[40:43], v[168:171], v[80:83]
  s_add_u32 m0, s58, 139264
  s_add_u32 s36, s58, 36864
  v_mfma_f32_16x16x32_bf16 v[80:83], a[52:55], v[176:179], v[80:83]
  buffer_load_dwordx4 v180, s[16:19], s36 offen offset:0 lds
  v_mfma_f32_16x16x32_bf16 v[80:83], a[64:67], v[144:147], v[80:83]
  s_add_u32 s37, s28, 4
  s_lshr_b32 s37, s37, 6
  v_mfma_f32_16x16x32_bf16 v[76:79], a[68:71], v[144:147], 0
  s_add_u32 s39, s28, 1
  s_lshr_b32 s39, s39, 6
  v_mfma_f32_16x16x32_bf16 v[76:79], a[56:59], v[176:179], v[76:79]
  buffer_load_dwordx4 v180, s[16:19], s36 offen offset:1024 lds
  v_mfma_f32_16x16x32_bf16 v[76:79], a[44:47], v[168:171], v[76:79]
  v_cvt_pk_bf16_f32 v60, v80, v81
  v_cvt_pk_bf16_f32 v61, v82, v83
L_hop2:
  s_cbranch_execz L_hopped
  v_mfma_f32_16x16x32_bf16 v[76:79], a[32:35], v[164:167], v[76:79]
  s_sub_u32 s62, s38, s28
  s_mulk_i32 s62, 3072
  v_mfma_f32_16x16x32_bf16 v[76:79], a[20:23], v[84:87], v[76:79]
  s_add_u32 s62, s62, s46
  s_mul_i32 s14, s37, -42
  v_mfma_f32_16x16x32_bf16 v[76:79], a[8:11], v[72:75], v[76:79]
  buffer_load_dwordx4 v180, s[16:19], s36 offen offset:2048 lds
  v_mfma_f32_16x16x32_bf16 v[80:83], v[72:75], a[72:75], 0
  s_waitcnt vmcnt(15)
  s_barrier
  v_mfma_f32_16x16x32_bf16 v[80:83], v[84:87], a[84:87], v[80:83]
  s_addk_i32 s14, 128
  s_mul_i32 s15, s37, -3072
  v_mfma_f32_16x16x32_bf16 v[80:83], v[164:167], a[96:99], v[80:83]
  v_cvt_pk_bf16_f32 v62, v76, v77
  v_cvt_pk_bf16_f32 v63, v78, v79
  v_mfma_f32_16x16x32_bf16 v[80:83], v[168:171], a[108:111], v[80:83]
  ds_read_b128 v[116:119], v0 offset:4096
  s_add_u32 s15, s15, 1566720
  v_mfma_f32_16x16x32_bf16 v[80:83], v[176:179], a[120:123], v[80:83]
  ds_read_b128 v[124:127], v1 offset:4096
  s_lshl3_add_u32 s12, s39, 48
  v_mfma_f32_16x16x32_bf16 v[80:83], v[144:147], a[132:135], v[80:83]
  ds_read_b128 v[120:123], v0 offset:12288
  s_lshl2_add_u32 s13, s37, 104
  v_mfma_f32_16x16x32_bf16 v[76:79], v[144:147], a[136:139], 0
  ds_read_b128 v[128:131], v1 offset:12288
  s_sub_u32 s13, s13, s12
  v_mfma_f32_16x16x32_bf16 v[76:79], v[176:179], a[124:127], v[76:79]
  ds_read_b128 v[132:135], v0 offset:20480
  s_or_b32 s39, s39, s31
  v_mfma_f32_16x16x32_bf16 v[76:79], v[168:171], a[112:115], v[76:79]
  v_cvt_pk_bf16_f32 v18, v80, v81
  v_cvt_pk_bf16_f32 v19, v82, v83
  v_mfma_f32_16x16x32_bf16 v[76:79], v[164:167], a[100:103], v[76:79]
  ds_read_b128 v[140:143], v1 offset:20480
  s_or_b32 s39, s39, s4
  v_mfma_f32_16x16x32_bf16 v[76:79], v[84:87], a[88:91], v[76:79]
  s_add_u32 m0, s58, 151552
  s_add_u32 s36, s58, 55296
  v_mfma_f32_16x16x32_bf16 v[76:79], v[72:75], a[76:79], v[76:79]
  buffer_load_dwordx4 v180, s[16:19], s36 offen offset:0 lds
  v_mfma_f32_16x16x32_bf16 v[80:83], v[72:75], a[80:83], 0
  buffer_load_dwordx4 v180, s[16:19], s36 offen offset:1024 lds
  v_mfma_f32_16x16x32_bf16 v[80:83], v[84:87], a[92:95], v[80:83]
  buffer_load_dwordx4 v180, s[16:19], s36 offen offset:2048 lds
  v_mfma_f32_16x16x32_bf16 v[80:83], v[164:167], a[104:107], v[80:83]
  v_cvt_pk_bf16_f32 v26, v76, v77
  v_cvt_pk_bf16_f32 v27, v78, v79
  v_mfma_f32_16x16x32_bf16 v[80:83], v[168:171], a[116:119], v[80:83]
  s_add_u32 m0, s58, 0
  s_add_u32 s36, s59, 12288
  v_mfma_f32_16x16x32_bf16 v[80:83], v[176:179], a[128:131], v[80:83]
  buffer_load_dwordx4 v180, s[16:19], s36 offen offset:0 lds
  v_mfma_f32_16x16x32_bf16 v[80:83], v[144:147], a[140:143], v[80:83]
  s_waitcnt lgkmcnt(0)
  s_lshl_b32 s39, s39, 8
  v_mfma_f32_16x16x32_bf16 v[148:151], v[184:187], v[116:119], 0
  buffer_load_dwordx4 v180, s[16:19], s36 offen offset:1024 lds
  v_mfma_f32_16x16x32_bf16 v[148:151], v[196:199], v[124:127], v[148:151]
  s_add_u32 s63, s12, s39
  s_add_u32 s60, s63, s29
  v_mfma_f32_16x16x32_bf16 v[148:151], v[208:211], v[120:123], v[148:151]
  v_cvt_pk_bf16_f32 v34, v80, v81
  v_cvt_pk_bf16_f32 v35, v82, v83
  v_mfma_f32_16x16x32_bf16 v[148:151], v[220:223], v[128:131], v[148:151]
  buffer_load_dwordx4 v180, s[16:19], s36 offen offset:2048 lds
  v_mfma_f32_16x16x32_bf16 v[148:151], v[232:235], v[132:135], v[148:151]
  s_sub_u32 s60, s60, 4
  v_mfma_f32_16x16x32_bf16 v[148:151], v[244:247], v[140:143], v[148:151]
  v_mfma_f32_16x16x32_bf16 v[156:159], v[248:251], v[140:143], 0
  ds_read_b128 v[136:139], v0 offset:6144
  v_mfma_f32_16x16x32_bf16 v[156:159], v[236:239], v[132:135], v[156:159]
  ds_read_b128 v[144:147], v1 offset:6144
  v_mfma_f32_16x16x32_bf16 v[156:159], v[224:227], v[128:131], v[156:159]
  v_cvt_pk_bf16_f32 v64, v148, v149
  v_cvt_pk_bf16_f32 v65, v150, v151
  v_mfma_f32_16x16x32_bf16 v[156:159], v[212:215], v[120:123], v[156:159]
  ds_read_b128 v[152:155], v0 offset:14336
  v_mfma_f32_16x16x32_bf16 v[156:159], v[200:203], v[124:127], v[156:159]
  ds_read_b128 v[160:163], v1 offset:14336
  v_mfma_f32_16x16x32_bf16 v[156:159], v[188:191], v[116:119], v[156:159]
  ds_read_b128 v[164:167], v0 offset:22528
  v_mfma_f32_16x16x32_bf16 v[148:151], v[192:195], v[116:119], 0
  ds_read_b128 v[172:175], v1 offset:22528
  v_mfma_f32_16x16x32_bf16 v[148:151], v[204:207], v[124:127], v[148:151]
  s_add_u32 m0, s58, 12288
  s_add_u32 s36, s59, 49152
  v_mfma_f32_16x16x32_bf16 v[148:151], v[216:219], v[120:123], v[148:151]
  v_cvt_pk_bf16_f32 v66, v156, v157
  v_cvt_pk_bf16_f32 v67, v158, v159
  v_mfma_f32_16x16x32_bf16 v[148:151], v[228:231], v[128:131], v[148:151]
  buffer_load_dwordx4 v180, s[16:19], s36 offen offset:0 lds
  v_mfma_f32_16x16x32_bf16 v[148:151], v[240:243], v[132:135], v[148:151]
  buffer_load_dwordx4 v180, s[16:19], s36 offen offset:1024 lds
  v_mfma_f32_16x16x32_bf16 v[148:151], v[252:255], v[140:143], v[148:151]
  buffer_load_dwordx4 v180, s[16:19], s36 offen offset:2048 lds
  v_mfma_f32_16x16x32_bf16 v[156:159], a[60:63], v[140:143], 0
  v_accvgpr_read_b32 v180, a229
  v_accvgpr_read_b32 v181, a230
  v_mfma_f32_16x16x32_bf16 v[156:159], a[48:51], v[132:135], v[156:159]
  v_accvgpr_read_b32 v182, a231
  v_accvgpr_read_b32 v183, a232
  v_mfma_f32_16x16x32_bf16 v[156:159], a[36:39], v[128:131], v[156:159]
  v_cvt_pk_bf16_f32 v68, v148, v149
  v_cvt_pk_bf16_f32 v69, v150, v151
  v_mfma_f32_16x16x32_bf16 v[156:159], a[24:27], v[120:123], v[156:159]
  s_add_u32 s48, s48, 6291456
  s_add_u32 s49, s48, 786432
  v_mfma_f32_16x16x32_bf16 v[156:159], a[12:15], v[124:127], v[156:159]
  s_sub_u32 s33, s32, 40960
  s_add_u32 s32, s33, 65536
  v_mfma_f32_16x16x32_bf16 v[156:159], a[0:3], v[116:119], v[156:159]
  s_mov_b32 s35, 2
  s_mov_b64 vcc, 0
  v_mfma_f32_16x16x32_bf16 v[148:151], a[4:7], v[116:119], 0
  s_sub_u32 s50, s48, 12582912
  s_sub_u32 s51, s48, 6291456
  v_mfma_f32_16x16x32_bf16 v[148:151], a[16:19], v[124:127], v[148:151]
  s_sub_u32 s6, s48, 0
  s_add_u32 s44, s29, 8
  v_mfma_f32_16x16x32_bf16 v[148:151], a[28:31], v[120:123], v[148:151]
  v_cvt_pk_bf16_f32 v76, v156, v157
  v_cvt_pk_bf16_f32 v77, v158, v159
  v_mfma_f32_16x16x32_bf16 v[148:151], a[40:43], v[128:131], v[148:151]
  s_mov_b32 s45, 0
  v_mov_b32 v11, 0
  v_mfma_f32_16x16x32_bf16 v[148:151], a[52:55], v[132:135], v[148:151]
  v_mad_i32_i16 v0, v10, 1, s32 op_sel:[1,0,0,0]
  v_xor_b32 v1, 64, v0
  v_mfma_f32_16x16x32_bf16 v[148:151], a[64:67], v[140:143], v[148:151]
  s_waitcnt lgkmcnt(0)
  s_barrier
  v_mfma_f32_16x16x32_bf16 v[156:159], a[68:71], v[140:143], 0
  v_mfma_f32_16x16x32_bf16 v[156:159], a[56:59], v[132:135], v[156:159]
  s_add_u32 m0, s33, 40960
  v_mfma_f32_16x16x32_bf16 v[156:159], a[44:47], v[128:131], v[156:159]
  v_cvt_pk_bf16_f32 v78, v148, v149
  v_cvt_pk_bf16_f32 v79, v150, v151
  v_mfma_f32_16x16x32_bf16 v[156:159], a[32:35], v[120:123], v[156:159]
  buffer_load_dwordx4 v6, s[8:11], s48 offen offset:0 nt lds
  v_mfma_f32_16x16x32_bf16 v[156:159], a[20:23], v[124:127], v[156:159]
  v_mfma_f32_16x16x32_bf16 v[156:159], a[8:11], v[116:119], v[156:159]
  v_mfma_f32_16x16x32_bf16 v[148:151], v[116:119], a[72:75], 0
  s_add_u32 m0, s33, 49024
  v_mfma_f32_16x16x32_bf16 v[148:151], v[124:127], a[84:87], v[148:151]
  buffer_load_dwordx4 v6, s[8:11], s48 offen offset:128 nt lds
  v_mfma_f32_16x16x32_bf16 v[148:151], v[120:123], a[96:99], v[148:151]
  v_cvt_pk_bf16_f32 v80, v156, v157
  v_cvt_pk_bf16_f32 v81, v158, v159
  v_mfma_f32_16x16x32_bf16 v[148:151], v[128:131], a[108:111], v[148:151]
  v_mfma_f32_16x16x32_bf16 v[148:151], v[132:135], a[120:123], v[148:151]
  v_mfma_f32_16x16x32_bf16 v[148:151], v[140:143], a[132:135], v[148:151]
  s_add_u32 m0, s33, 57088
  v_mfma_f32_16x16x32_bf16 v[156:159], v[140:143], a[136:139], 0
  buffer_load_dwordx4 v6, s[8:11], s48 offen offset:256 nt lds
  v_mfma_f32_16x16x32_bf16 v[156:159], v[132:135], a[124:127], v[156:159]
  v_mfma_f32_16x16x32_bf16 v[156:159], v[128:131], a[112:115], v[156:159]
  v_cvt_pk_bf16_f32 v20, v148, v149
  v_cvt_pk_bf16_f32 v21, v150, v151
  v_mfma_f32_16x16x32_bf16 v[156:159], v[120:123], a[100:103], v[156:159]
  s_add_u32 m0, s33, 45056
  v_mfma_f32_16x16x32_bf16 v[156:159], v[124:127], a[88:91], v[156:159]
  s_waitcnt vmcnt(3)
  s_barrier
  v_mfma_f32_16x16x32_bf16 v[156:159], v[116:119], a[76:79], v[156:159]
  buffer_load_dwordx4 v6, s[8:11], s49 offen offset:0 nt lds
  v_mfma_f32_16x16x32_bf16 v[148:151], v[116:119], a[80:83], 0
  ds_read_b64_tr_b16 a[144:145], v180 offset:0
  ds_read_b64_tr_b16 a[146:147], v180 offset:6144
  v_mfma_f32_16x16x32_bf16 v[148:151], v[124:127], a[92:95], v[148:151]
  ds_read_b64_tr_b16 a[148:149], v180 offset:8
  v_mfma_f32_16x16x32_bf16 v[148:151], v[120:123], a[104:107], v[148:151]
  v_cvt_pk_bf16_f32 v28, v156, v157
  v_cvt_pk_bf16_f32 v29, v158, v159
  v_mfma_f32_16x16x32_bf16 v[148:151], v[128:131], a[116:119], v[148:151]
  s_add_u32 m0, s33, 53120
  ds_read_b64_tr_b16 a[150:151], v180 offset:6152
  v_mfma_f32_16x16x32_bf16 v[148:151], v[132:135], a[128:131], v[148:151]
  buffer_load_dwordx4 v6, s[8:11], s49 offen offset:128 nt lds
  v_mfma_f32_16x16x32_bf16 v[148:151], v[140:143], a[140:143], v[148:151]
  ds_read_b64_tr_b16 a[152:153], v181 offset:0
  v_mfma_f32_16x16x32_bf16 v[168:171], v[184:187], v[136:139], 0
  ds_read_b64_tr_b16 a[154:155], v181 offset:6144
  ds_read_b64_tr_b16 a[156:157], v181 offset:8
  v_mfma_f32_16x16x32_bf16 v[168:171], v[196:199], v[144:147], v[168:171]
  s_add_u32 m0, s33, 61184
  ds_read_b64_tr_b16 a[158:159], v181 offset:6152
  v_mfma_f32_16x16x32_bf16 v[168:171], v[208:211], v[152:155], v[168:171]
  v_cvt_pk_bf16_f32 v36, v148, v149
  v_cvt_pk_bf16_f32 v37, v150, v151
  v_mfma_f32_16x16x32_bf16 v[168:171], v[220:223], v[160:163], v[168:171]
  buffer_load_dwordx4 v6, s[8:11], s49 offen offset:256 nt lds
  v_mfma_f32_16x16x32_bf16 v[168:171], v[232:235], v[164:167], v[168:171]
  ds_read_b64_tr_b16 a[160:161], v180 offset:12288
  s_add_u32 s48, s48, 6291456
  v_mfma_f32_16x16x32_bf16 v[168:171], v[244:247], v[172:175], v[168:171]
  ds_read_b64_tr_b16 a[162:163], v180 offset:18432
  ds_read_b64_tr_b16 a[164:165], v180 offset:12296
  v_mfma_f32_16x16x32_bf16 v[176:179], v[248:251], v[172:175], 0
  ds_read_b64_tr_b16 a[166:167], v180 offset:18440
  s_add_u32 s49, s48, 786432
  v_mfma_f32_16x16x32_bf16 v[176:179], v[236:239], v[164:167], v[176:179]
  ds_read_b64_tr_b16 a[168:169], v181 offset:12288
  ds_read_b64_tr_b16 a[170:171], v181 offset:18432
  v_mfma_f32_16x16x32_bf16 v[176:179], v[224:227], v[160:163], v[176:179]
  v_cvt_pk_bf16_f32 v70, v168, v169
  v_cvt_pk_bf16_f32 v71, v170, v171
  v_mfma_f32_16x16x32_bf16 v[176:179], v[212:215], v[152:155], v[176:179]
  ds_read_b64_tr_b16 a[172:173], v181 offset:12296
  v_mfma_f32_16x16x32_bf16 v[176:179], v[200:203], v[144:147], v[176:179]
  ds_read_b64_tr_b16 a[174:175], v181 offset:18440
  ds_read_b64_tr_b16 a[176:177], v180 offset:24576
  v_mfma_f32_16x16x32_bf16 v[176:179], v[188:191], v[136:139], v[176:179]
  ds_read_b64_tr_b16 a[178:179], v180 offset:30720
  v_mfma_f32_16x16x32_bf16 v[168:171], v[192:195], v[136:139], 0
  ds_read_b64_tr_b16 a[180:181], v180 offset:24584
  ds_read_b64_tr_b16 a[182:183], v180 offset:30728
  v_mfma_f32_16x16x32_bf16 v[168:171], v[204:207], v[144:147], v[168:171]
  ds_read_b64_tr_b16 a[184:185], v181 offset:24576
  v_mfma_f32_16x16x32_bf16 v[168:171], v[216:219], v[152:155], v[168:171]
  v_cvt_pk_bf16_f32 v72, v176, v177
  v_cvt_pk_bf16_f32 v73, v178, v179
  v_mfma_f32_16x16x32_bf16 v[168:171], v[228:231], v[160:163], v[168:171]
  ds_read_b64_tr_b16 a[186:187], v181 offset:30720
  ds_read_b64_tr_b16 a[188:189], v181 offset:24584
  v_mfma_f32_16x16x32_bf16 v[168:171], v[240:243], v[164:167], v[168:171]
  ds_read_b64_tr_b16 a[190:191], v181 offset:30728
  v_mfma_f32_16x16x32_bf16 v[168:171], v[252:255], v[172:175], v[168:171]
  ds_read_b64_tr_b16 a[192:193], v180 offset:36864
  ds_read_b64_tr_b16 a[194:195], v180 offset:43008
  v_mfma_f32_16x16x32_bf16 v[176:179], a[60:63], v[172:175], 0
  ds_read_b64_tr_b16 a[196:197], v180 offset:36872
  v_mfma_f32_16x16x32_bf16 v[176:179], a[48:51], v[164:167], v[176:179]
  ds_read_b64_tr_b16 a[198:199], v180 offset:43016
  ds_read_b64_tr_b16 a[200:201], v181 offset:36864
  v_mfma_f32_16x16x32_bf16 v[176:179], a[36:39], v[160:163], v[176:179]
  v_cvt_pk_bf16_f32 v74, v168, v169
  v_cvt_pk_bf16_f32 v75, v170, v171
  v_mfma_f32_16x16x32_bf16 v[176:179], a[24:27], v[152:155], v[176:179]
  ds_read_b64_tr_b16 a[202:203], v181 offset:43008
  v_mfma_f32_16x16x32_bf16 v[176:179], a[12:15], v[144:147], v[176:179]
  ds_read_b64_tr_b16 a[204:205], v181 offset:36872
  ds_read_b64_tr_b16 a[206:207], v181 offset:43016
  v_mfma_f32_16x16x32_bf16 v[176:179], a[0:3], v[136:139], v[176:179]
  ds_read_b64_tr_b16 a[208:209], v182 offset:0
  v_mfma_f32_16x16x32_bf16 v[168:171], a[4:7], v[136:139], 0
  ds_read_b64_tr_b16 a[210:211], v182 offset:1536
  ds_read_b64_tr_b16 a[212:213], v182 offset:8
  v_mfma_f32_16x16x32_bf16 v[168:171], a[16:19], v[144:147], v[168:171]
  ds_read_b64_tr_b16 a[214:215], v182 offset:1544
  v_mfma_f32_16x16x32_bf16 v[168:171], a[28:31], v[152:155], v[168:171]
  v_cvt_pk_bf16_f32 v82, v176, v177
  v_cvt_pk_bf16_f32 v83, v178, v179
  v_mfma_f32_16x16x32_bf16 v[168:171], a[40:43], v[160:163], v[168:171]
  ds_read_b64_tr_b16 a[216:217], v183 offset:0
  ds_read_b64_tr_b16 a[218:219], v183 offset:1536
  v_mfma_f32_16x16x32_bf16 v[168:171], a[52:55], v[164:167], v[168:171]
  ds_read_b64_tr_b16 a[220:221], v183 offset:8
  v_mfma_f32_16x16x32_bf16 v[168:171], a[64:67], v[172:175], v[168:171]
  ds_read_b64_tr_b16 a[222:223], v183 offset:1544
  ds_read_b64_tr_b16 a[224:225], v182 offset:12288
  v_mfma_f32_16x16x32_bf16 v[176:179], a[68:71], v[172:175], 0
  ds_read_b64_tr_b16 a[226:227], v182 offset:13824
  v_mfma_f32_16x16x32_bf16 v[176:179], a[56:59], v[164:167], v[176:179]
  ds_read_b64_tr_b16 a[228:229], v182 offset:12296
  v_mfma_f32_16x16x32_bf16 v[176:179], a[44:47], v[160:163], v[176:179]
  v_cvt_pk_bf16_f32 v84, v168, v169
  v_cvt_pk_bf16_f32 v85, v170, v171
  v_mfma_f32_16x16x32_bf16 v[176:179], a[32:35], v[152:155], v[176:179]
  ds_read_b64_tr_b16 a[230:231], v182 offset:13832
  v_mfma_f32_16x16x32_bf16 v[176:179], a[20:23], v[144:147], v[176:179]
  ds_read_b64_tr_b16 a[232:233], v183 offset:12288
  v_mfma_f32_16x16x32_bf16 v[176:179], a[8:11], v[136:139], v[176:179]
  ds_read_b64_tr_b16 a[234:235], v183 offset:13824
  v_mfma_f32_16x16x32_bf16 v[168:171], v[136:139], a[72:75], 0
  ds_read_b64_tr_b16 a[236:237], v183 offset:12296
  v_mfma_f32_16x16x32_bf16 v[168:171], v[144:147], a[84:87], v[168:171]
  ds_read_b64_tr_b16 a[238:239], v183 offset:13832
  v_mfma_f32_16x16x32_bf16 v[168:171], v[152:155], a[96:99], v[168:171]
  v_cvt_pk_bf16_f32 v86, v176, v177
  v_cvt_pk_bf16_f32 v87, v178, v179
  v_mfma_f32_16x16x32_bf16 v[168:171], v[160:163], a[108:111], v[168:171]
  v_mfma_f32_16x16x32_bf16 v[168:171], v[164:167], a[120:123], v[168:171]
  v_mfma_f32_16x16x32_bf16 v[168:171], v[172:175], a[132:135], v[168:171]
  v_mfma_f32_16x16x32_bf16 v[176:179], v[172:175], a[136:139], 0
  s_waitcnt lgkmcnt(0)
  s_waitcnt vmcnt(24)
  s_barrier
  v_mfma_f32_16x16x32_bf16 v[176:179], v[164:167], a[124:127], v[176:179]
  v_mfma_f32_16x16x32_bf16 v[176:179], v[160:163], a[112:115], v[176:179]
  v_cvt_pk_bf16_f32 v22, v168, v169
  v_cvt_pk_bf16_f32 v23, v170, v171
  v_mfma_f32_16x16x32_bf16 v[176:179], v[152:155], a[100:103], v[176:179]
  ds_read_b128 a[244:247], v3 offset:0
  v_mfma_f32_16x16x32_bf16 v[176:179], v[144:147], a[88:91], v[176:179]
  ds_read_b128 a[248:251], v3 offset:4096
  v_mfma_f32_16x16x32_bf16 v[176:179], v[136:139], a[76:79], v[176:179]
  ds_read_b128 a[252:255], v3 offset:8192
  v_mfma_f32_16x16x32_bf16 v[168:171], v[136:139], a[80:83], 0
  ds_read_b128 v[180:183], v3 offset:12288
  v_mfma_f32_16x16x32_bf16 v[168:171], v[144:147], a[92:95], v[168:171]
  v_mfma_f32_16x16x32_bf16 v[168:171], v[152:155], a[104:107], v[168:171]
  v_cvt_pk_bf16_f32 v30, v176, v177
  v_cvt_pk_bf16_f32 v31, v178, v179
  v_mfma_f32_16x16x32_bf16 v[168:171], v[160:163], a[116:119], v[168:171]
  s_cmp_lg_u32 s31, 0
  v_mfma_f32_16x16x32_bf16 v[168:171], v[164:167], a[128:131], v[168:171]
  v_mfma_f32_16x16x32_bf16 v[168:171], v[172:175], a[140:143], v[168:171]
  s_cbranch_scc0 L_s
  s_branch L_special
.fill (0x4000 - 768 + standalone__window_attn_swin__vision_kernel - .) / 4, 4, 0xbf800000
L_hop3:
  s_branch L_hop4
  s_nop 0
L_s:
  v_mfma_f32_16x16x32_bf16 v[116:119], v[46:49], v[70:73], v[112:115]
  v_mfma_f32_16x16x32_bf16 v[124:127], v[58:61], v[70:73], v[108:111]
  v_mfma_f32_16x16x32_bf16 v[120:123], v[76:79], v[70:73], v[104:107]
  v_cvt_pk_bf16_f32 v38, v168, v169
  v_cvt_pk_bf16_f32 v39, v170, v171
  v_mfma_f32_16x16x32_bf16 v[128:131], v[82:85], v[70:73], v[100:103]
  v_mfma_f32_16x16x16_bf16 v[116:119], v[50:51], v[74:75], v[116:119]
  v_mfma_f32_16x16x16_bf16 v[124:127], v[62:63], v[74:75], v[124:127]
  v_mfma_f32_16x16x16_bf16 v[120:123], v[80:81], v[74:75], v[120:123]
  v_mfma_f32_16x16x16_bf16 v[128:131], v[86:87], v[74:75], v[128:131]
  v_exp_f32 v116, v116
  v_mfma_f32_16x16x16_bf16 v[132:135], v[50:51], v[68:69], v[108:111]
  v_exp_f32 v117, v117
  v_mfma_f32_16x16x16_bf16 v[140:143], v[62:63], v[68:69], v[104:107]
  v_exp_f32 v118, v118
  v_mfma_f32_16x16x16_bf16 v[136:139], v[80:81], v[68:69], v[100:103]
  v_exp_f32 v119, v119
  v_mfma_f32_16x16x16_bf16 v[144:147], v[86:87], v[68:69], v[96:99]
  v_cvt_pk_bf16_f32 v116, v116, v117
  v_cvt_pk_bf16_f32 v117, v118, v119
  v_mfma_f32_16x16x16_bf16 v[148:151], v[50:51], v[56:57], v[104:107]
  v_exp_f32 v124, v124
  v_mfma_f32_16x16x16_bf16 v[156:159], v[62:63], v[56:57], v[100:103]
  v_exp_f32 v125, v125
  v_mfma_f32_16x16x16_bf16 v[152:155], v[80:81], v[56:57], v[96:99]
  v_exp_f32 v126, v126
  v_mfma_f32_16x16x16_bf16 v[160:163], v[86:87], v[56:57], v[92:95]
  v_exp_f32 v127, v127
  v_mfma_f32_16x16x16_bf16 v[164:167], v[50:51], v[44:45], v[100:103]
  v_cvt_pk_bf16_f32 v118, v124, v125
  v_cvt_pk_bf16_f32 v119, v126, v127
  v_mfma_f32_16x16x16_bf16 v[172:175], v[62:63], v[44:45], v[96:99]
  v_exp_f32 v120, v120
  v_mfma_f32_16x16x16_bf16 v[168:171], v[80:81], v[44:45], v[92:95]
  v_exp_f32 v121, v121
  v_mfma_f32_16x16x16_bf16 v[176:179], v[86:87], v[44:45], v[88:91]
  v_exp_f32 v122, v122
  v_mfma_f32_16x16x32_bf16 v[132:135], v[46:49], v[64:67], v[132:135]
  v_exp_f32 v123, v123
  v_mfma_f32_16x16x32_bf16 v[140:143], v[58:61], v[64:67], v[140:143]
  v_cvt_pk_bf16_f32 v120, v120, v121
  v_cvt_pk_bf16_f32 v121, v122, v123
  v_mfma_f32_16x16x32_bf16 v[136:139], v[76:79], v[64:67], v[136:139]
  v_exp_f32 v128, v128
  v_mfma_f32_16x16x32_bf16 v[144:147], v[82:85], v[64:67], v[144:147]
  ds_read_b128 v[64:67], v3 offset:16384
  ds_read_b128 v[68:71], v3 offset:20480
  v_mfma_f32_16x16x32_bf16 v[148:151], v[46:49], v[52:55], v[148:151]
  v_exp_f32 v129, v129
  v_mfma_f32_16x16x32_bf16 v[156:159], v[58:61], v[52:55], v[156:159]
  v_exp_f32 v130, v130
  v_mfma_f32_16x16x32_bf16 v[152:155], v[76:79], v[52:55], v[152:155]
  v_exp_f32 v131, v131
  v_mfma_f32_16x16x32_bf16 v[160:163], v[82:85], v[52:55], v[160:163]
  v_cvt_pk_bf16_f32 v122, v128, v129
  v_cvt_pk_bf16_f32 v123, v130, v131
  v_mfma_f32_16x16x32_bf16 v[164:167], v[46:49], v[40:43], v[164:167]
  v_exp_f32 v132, v132
  v_mfma_f32_16x16x32_bf16 v[172:175], v[58:61], v[40:43], v[172:175]
  v_exp_f32 v133, v133
  v_mfma_f32_16x16x32_bf16 v[168:171], v[76:79], v[40:43], v[168:171]
  v_exp_f32 v134, v134
  v_mfma_f32_16x16x32_bf16 v[176:179], v[82:85], v[40:43], v[176:179]
  s_waitcnt lgkmcnt(0)
  v_cvt_pk_bf16_f32 v132, v132, v133
L_pj:
  v_mfma_f32_16x16x32_bf16 v[40:43], a[144:147], a[244:247], 0
  ds_read_b128 v[72:75], v3 offset:256
  ds_read_b128 v[56:59], v3 offset:4352
  v_mfma_f32_16x16x32_bf16 v[40:43], a[160:163], a[248:251], v[40:43]
  v_exp_f32 v135, v135
  v_mfma_f32_16x16x32_bf16 v[40:43], a[176:179], a[252:255], v[40:43]
  ds_read_b128 v[60:63], v3 offset:8448
  ds_read_b128 v[76:79], v3 offset:12544
  v_mfma_f32_16x16x32_bf16 v[40:43], a[192:195], v[180:183], v[40:43]
  v_exp_f32 v140, v140
  v_mfma_f32_16x16x32_bf16 v[40:43], a[208:211], v[64:67], v[40:43]
  ds_read_b128 v[80:83], v3 offset:16640
  ds_read_b128 v[84:87], v3 offset:20736
  v_mfma_f32_16x16x32_bf16 v[40:43], a[224:227], v[68:71], v[40:43]
  v_exp_f32 v141, v141
  v_mfma_f32_16x16x32_bf16 v[44:47], a[228:231], v[68:71], 0
  v_cvt_pk_bf16_f32 v133, v134, v135
  v_cvt_pk_bf16_f32 v134, v140, v141
  v_mfma_f32_16x16x32_bf16 v[44:47], a[212:215], v[64:67], v[44:47]
  v_exp_f32 v142, v142
  v_mfma_f32_16x16x32_bf16 v[44:47], a[196:199], v[180:183], v[44:47]
  v_cvt_pk_bf16_f32 v40, v40, v41
  v_cvt_pk_bf16_f32 v41, v42, v43
  v_mfma_f32_16x16x32_bf16 v[44:47], a[180:183], a[252:255], v[44:47]
  ds_read_b128 v[124:127], v2 offset:512
  ds_read_b128 v[128:131], v2 offset:4608
  v_mfma_f32_16x16x32_bf16 v[44:47], a[164:167], a[248:251], v[44:47]
  v_exp_f32 v143, v143
  v_mfma_f32_16x16x32_bf16 v[44:47], a[148:151], a[244:247], v[44:47]
  s_waitcnt lgkmcnt(2)
  v_cvt_pk_bf16_f32 v135, v142, v143
  v_mfma_f32_16x16x32_bf16 v[48:51], a[144:147], v[72:75], 0
  ds_read_b128 a[244:247], v2 offset:8704
  ds_read_b128 a[248:251], v2 offset:12800
  v_mfma_f32_16x16x32_bf16 v[48:51], a[160:163], v[56:59], v[48:51]
  v_exp_f32 v136, v136
  v_mfma_f32_16x16x32_bf16 v[48:51], a[176:179], v[60:63], v[48:51]
  v_cvt_pk_bf16_f32 v42, v44, v45
  v_cvt_pk_bf16_f32 v43, v46, v47
  v_mfma_f32_16x16x32_bf16 v[48:51], a[192:195], v[76:79], v[48:51]
  buffer_store_dwordx4 v[40:43], v7, s[24:27], s40 offen nt
  v_mfma_f32_16x16x32_bf16 v[48:51], a[208:211], v[80:83], v[48:51]
  ds_read_b128 a[252:255], v2 offset:16896
  ds_read_b128 v[180:183], v2 offset:20992
  v_mfma_f32_16x16x32_bf16 v[48:51], a[224:227], v[84:87], v[48:51]
  v_exp_f32 v137, v137
  v_mfma_f32_16x16x32_bf16 v[52:55], a[228:231], v[84:87], 0
  v_exp_f32 v138, v138
  v_mfma_f32_16x16x32_bf16 v[52:55], a[212:215], v[80:83], v[52:55]
  v_exp_f32 v139, v139
  v_mfma_f32_16x16x32_bf16 v[52:55], a[196:199], v[76:79], v[52:55]
  v_cvt_pk_bf16_f32 v48, v48, v49
  v_cvt_pk_bf16_f32 v49, v50, v51
  v_mfma_f32_16x16x32_bf16 v[52:55], a[180:183], v[60:63], v[52:55]
  v_cvt_pk_bf16_f32 v136, v136, v137
  v_cvt_pk_bf16_f32 v137, v138, v139
  v_mfma_f32_16x16x32_bf16 v[52:55], a[164:167], v[56:59], v[52:55]
  v_exp_f32 v144, v144
  v_mfma_f32_16x16x32_bf16 v[52:55], a[148:151], v[72:75], v[52:55]
  s_waitcnt lgkmcnt(0)
  v_mfma_f32_16x16x32_bf16 v[40:43], a[144:147], v[124:127], 0
  v_exp_f32 v145, v145
  v_mfma_f32_16x16x32_bf16 v[40:43], a[160:163], v[128:131], v[40:43]
  v_exp_f32 v146, v146
  v_mfma_f32_16x16x32_bf16 v[40:43], a[176:179], a[244:247], v[40:43]
  v_cvt_pk_bf16_f32 v50, v52, v53
  v_cvt_pk_bf16_f32 v51, v54, v55
  v_mfma_f32_16x16x32_bf16 v[40:43], a[192:195], a[248:251], v[40:43]
  buffer_store_dwordx4 v[48:51], v7, s[24:27], s41 offen nt
  v_mfma_f32_16x16x32_bf16 v[40:43], a[208:211], a[252:255], v[40:43]
  ds_read_b128 v[72:75], v2 offset:768
  ds_read_b128 v[56:59], v2 offset:4864
  v_mfma_f32_16x16x32_bf16 v[40:43], a[224:227], v[180:183], v[40:43]
  v_exp_f32 v147, v147
  v_mfma_f32_16x16x32_bf16 v[44:47], a[228:231], v[180:183], 0
  ds_read_b128 v[60:63], v2 offset:8960
  ds_read_b128 v[76:79], v2 offset:13056
  v_mfma_f32_16x16x32_bf16 v[44:47], a[212:215], a[252:255], v[44:47]
  v_cvt_pk_bf16_f32 v138, v144, v145
  v_cvt_pk_bf16_f32 v139, v146, v147
  v_mfma_f32_16x16x32_bf16 v[44:47], a[196:199], a[248:251], v[44:47]
  v_cvt_pk_bf16_f32 v40, v40, v41
  v_cvt_pk_bf16_f32 v41, v42, v43
  v_mfma_f32_16x16x32_bf16 v[44:47], a[180:183], a[244:247], v[44:47]
  ds_read_b128 v[80:83], v2 offset:17152
  ds_read_b128 v[84:87], v2 offset:21248
  v_mfma_f32_16x16x32_bf16 v[44:47], a[164:167], v[128:131], v[44:47]
  v_exp_f32 v148, v148
  v_mfma_f32_16x16x32_bf16 v[44:47], a[148:151], v[124:127], v[44:47]
  v_exp_f32 v149, v149
  v_mfma_f32_16x16x32_bf16 v[48:51], a[152:155], v[124:127], 0
  v_mov_b64 v[144:145], 0
  v_cvt_pk_bf16_f32 v148, v148, v149
  v_mfma_f32_16x16x32_bf16 v[48:51], a[168:171], v[128:131], v[48:51]
  v_exp_f32 v150, v150
  v_mfma_f32_16x16x32_bf16 v[48:51], a[184:187], a[244:247], v[48:51]
  v_cvt_pk_bf16_f32 v42, v44, v45
  v_cvt_pk_bf16_f32 v43, v46, v47
  v_mfma_f32_16x16x32_bf16 v[48:51], a[200:203], a[248:251], v[48:51]
  buffer_store_dwordx4 v[40:43], v7, s[24:27], s42 offen nt
  v_mfma_f32_16x16x32_bf16 v[48:51], a[216:219], a[252:255], v[48:51]
  v_exp_f32 v151, v151
  v_mfma_f32_16x16x32_bf16 v[48:51], a[232:235], v[180:183], v[48:51]
  v_exp_f32 v156, v156
  v_mfma_f32_16x16x32_bf16 v[52:55], a[236:239], v[180:183], 0
  v_exp_f32 v157, v157
  v_mfma_f32_16x16x32_bf16 v[52:55], a[220:223], a[252:255], v[52:55]
  v_cvt_pk_bf16_f32 v149, v150, v151
  v_cvt_pk_bf16_f32 v150, v156, v157
  v_mfma_f32_16x16x32_bf16 v[52:55], a[204:207], a[248:251], v[52:55]
  v_cvt_pk_bf16_f32 v48, v48, v49
  v_cvt_pk_bf16_f32 v49, v50, v51
  v_mfma_f32_16x16x32_bf16 v[52:55], a[188:191], a[244:247], v[52:55]
  v_exp_f32 v158, v158
  v_mfma_f32_16x16x32_bf16 v[52:55], a[172:175], v[128:131], v[52:55]
  v_exp_f32 v159, v159
  v_mfma_f32_16x16x32_bf16 v[52:55], a[156:159], v[124:127], v[52:55]
  s_waitcnt lgkmcnt(0)
  v_cvt_pk_bf16_f32 v151, v158, v159
  v_mfma_f32_16x16x32_bf16 v[40:43], a[144:147], v[72:75], 0
  v_exp_f32 v152, v152
  v_mfma_f32_16x16x32_bf16 v[40:43], a[160:163], v[56:59], v[40:43]
  v_exp_f32 v153, v153
  v_mfma_f32_16x16x32_bf16 v[40:43], a[176:179], v[60:63], v[40:43]
  v_cvt_pk_bf16_f32 v50, v52, v53
  v_cvt_pk_bf16_f32 v51, v54, v55
  v_mfma_f32_16x16x32_bf16 v[40:43], a[192:195], v[76:79], v[40:43]
  buffer_store_dwordx4 v[48:51], v8, s[24:27], s42 offen nt
  v_mfma_f32_16x16x32_bf16 v[40:43], a[208:211], v[80:83], v[40:43]
  v_exp_f32 v154, v154
  v_mfma_f32_16x16x32_bf16 v[40:43], a[224:227], v[84:87], v[40:43]
  v_exp_f32 v155, v155
  v_mfma_f32_16x16x32_bf16 v[44:47], a[228:231], v[84:87], 0
  v_cvt_pk_bf16_f32 v152, v152, v153
  v_cvt_pk_bf16_f32 v153, v154, v155
  v_mfma_f32_16x16x32_bf16 v[44:47], a[212:215], v[80:83], v[44:47]
  v_exp_f32 v160, v160
  v_mfma_f32_16x16x32_bf16 v[44:47], a[196:199], v[76:79], v[44:47]
  v_cvt_pk_bf16_f32 v40, v40, v41
  v_cvt_pk_bf16_f32 v41, v42, v43
  v_mfma_f32_16x16x32_bf16 v[44:47], a[180:183], v[60:63], v[44:47]
  v_exp_f32 v161, v161
  v_mfma_f32_16x16x32_bf16 v[44:47], a[164:167], v[56:59], v[44:47]
  v_exp_f32 v162, v162
  v_mfma_f32_16x16x32_bf16 v[44:47], a[148:151], v[72:75], v[44:47]
  v_exp_f32 v163, v163
  v_mfma_f32_16x16x32_bf16 v[48:51], a[152:155], v[72:75], 0
  v_cvt_pk_bf16_f32 v154, v160, v161
  v_cvt_pk_bf16_f32 v155, v162, v163
  v_mfma_f32_16x16x32_bf16 v[48:51], a[168:171], v[56:59], v[48:51]
  v_exp_f32 v164, v164
  v_mfma_f32_16x16x32_bf16 v[48:51], a[184:187], v[60:63], v[48:51]
  v_cvt_pk_bf16_f32 v42, v44, v45
  v_cvt_pk_bf16_f32 v43, v46, v47
  v_mfma_f32_16x16x32_bf16 v[48:51], a[200:203], v[76:79], v[48:51]
  buffer_store_dwordx4 v[40:43], v7, s[24:27], s43 offen nt
  v_mfma_f32_16x16x32_bf16 v[48:51], a[216:219], v[80:83], v[48:51]
  v_exp_f32 v165, v165
  v_mfma_f32_16x16x32_bf16 v[48:51], a[232:235], v[84:87], v[48:51]
  v_exp_f32 v166, v166
  v_mfma_f32_16x16x32_bf16 v[52:55], a[236:239], v[84:87], 0
  v_exp_f32 v167, v167
  v_mfma_f32_16x16x32_bf16 v[52:55], a[220:223], v[80:83], v[52:55]
  v_cvt_pk_bf16_f32 v164, v164, v165
  v_cvt_pk_bf16_f32 v165, v166, v167
  v_mfma_f32_16x16x32_bf16 v[52:55], a[204:207], v[76:79], v[52:55]
  v_cvt_pk_bf16_f32 v48, v48, v49
  v_cvt_pk_bf16_f32 v49, v50, v51
  v_mfma_f32_16x16x32_bf16 v[52:55], a[188:191], v[60:63], v[52:55]
  v_exp_f32 v172, v172
  v_mfma_f32_16x16x32_bf16 v[52:55], a[172:175], v[56:59], v[52:55]
  v_exp_f32 v173, v173
  v_mfma_f32_16x16x32_bf16 v[52:55], a[156:159], v[72:75], v[52:55]
  v_exp_f32 v174, v174
  v_smfmac_f32_16x16x64_bf16 v[144:147], a[240:243], v[116:123], v10
  v_exp_f32 v175, v175
  v_mfma_f32_16x16x32_bf16 v[124:127], v[20:23], v[120:123], 0
  v_cvt_pk_bf16_f32 v166, v172, v173
  v_cvt_pk_bf16_f32 v167, v174, v175
  v_mfma_f32_16x16x32_bf16 v[124:127], v[16:19], v[116:119], v[124:127]
  v_cvt_pk_bf16_f32 v50, v52, v53
  v_cvt_pk_bf16_f32 v51, v54, v55
  v_mfma_f32_16x16x32_bf16 v[128:131], v[24:27], v[116:119], 0
  v_add_f32 v15, v144, v145
  v_mov_b64 v[144:145], 0
  v_mfma_f32_16x16x32_bf16 v[128:131], v[28:31], v[120:123], v[128:131]
  buffer_store_dwordx4 v[48:51], v8, s[24:27], s43 offen nt
  v_mfma_f32_16x16x32_bf16 v[140:143], v[36:39], v[120:123], 0
  v_exp_f32 v168, v168
  v_mfma_f32_16x16x32_bf16 v[140:143], v[32:35], v[116:119], v[140:143]
  v_exp_f32 v169, v169
  v_smfmac_f32_16x16x64_bf16 v[144:147], a[240:243], v[132:139], v10
  v_exp_f32 v170, v170
  v_mfma_f32_16x16x32_bf16 v[116:119], v[20:23], v[136:139], 0
  v_exp_f32 v171, v171
  v_mfma_f32_16x16x32_bf16 v[116:119], v[16:19], v[132:135], v[116:119]
  v_cvt_pk_bf16_f32 v168, v168, v169
  v_cvt_pk_bf16_f32 v169, v170, v171
  v_mfma_f32_16x16x32_bf16 v[120:123], v[24:27], v[132:135], 0
  v_add_f32 v14, v144, v145
  v_mov_b64 v[144:145], 0
  v_mfma_f32_16x16x32_bf16 v[120:123], v[28:31], v[136:139], v[120:123]
  v_exp_f32 v176, v176
  v_mfma_f32_16x16x32_bf16 v[156:159], v[36:39], v[136:139], 0
  v_exp_f32 v177, v177
  v_mfma_f32_16x16x32_bf16 v[156:159], v[32:35], v[132:135], v[156:159]
  v_exp_f32 v178, v178
  v_smfmac_f32_16x16x64_bf16 v[144:147], a[240:243], v[148:155], v10
  v_exp_f32 v179, v179
  v_mfma_f32_16x16x32_bf16 v[132:135], v[20:23], v[152:155], 0
  v_cvt_pk_bf16_f32 v170, v176, v177
  v_cvt_pk_bf16_f32 v171, v178, v179
  v_mfma_f32_16x16x32_bf16 v[132:135], v[16:19], v[148:151], v[132:135]
  v_max3_f32 v9, v14, v15, v9
  v_mfma_f32_16x16x32_bf16 v[136:139], v[24:27], v[148:151], 0
  v_add_f32 v13, v144, v145
  v_mov_b64 v[144:145], 0
  v_mfma_f32_16x16x32_bf16 v[136:139], v[28:31], v[152:155], v[136:139]
  ds_read_b128 a[244:247], v0 offset:0
  ds_read_b128 a[248:251], v1 offset:0
  v_mfma_f32_16x16x32_bf16 v[160:163], v[36:39], v[152:155], 0
  v_rcp_f32 v15, v15
  v_mfma_f32_16x16x32_bf16 v[160:163], v[32:35], v[148:151], v[160:163]
  ds_read_b128 a[252:255], v0 offset:8192
  ds_read_b128 v[180:183], v1 offset:8192
  v_smfmac_f32_16x16x64_bf16 v[144:147], a[240:243], v[164:171], v10
  v_rcp_f32 v14, v14
  v_mfma_f32_16x16x32_bf16 v[148:151], v[20:23], v[168:171], 0
  ds_read_b128 v[64:67], v0 offset:16384
  ds_read_b128 v[68:71], v1 offset:16384
  v_mfma_f32_16x16x32_bf16 v[148:151], v[16:19], v[164:167], v[148:151]
  v_mul_f32 v124, v15, v124
  v_mul_f32 v125, v15, v125
  v_mfma_f32_16x16x32_bf16 v[152:155], v[24:27], v[164:167], 0
  v_add_f32 v12, v144, v145
  v_mul_f32 v126, v15, v126
  v_mfma_f32_16x16x32_bf16 v[152:155], v[28:31], v[168:171], v[152:155]
  v_mul_f32 v127, v15, v127
  v_cvt_pk_bf16_f32 v124, v124, v125
  v_mfma_f32_16x16x32_bf16 v[172:175], v[36:39], v[168:171], 0
  s_waitcnt lgkmcnt(4)
  v_cvt_pk_bf16_f32 v125, v126, v127
  v_mfma_f32_16x16x32_bf16 v[172:175], v[32:35], v[164:167], v[172:175]
  s_cbranch_vccnz L_epi
  v_mfma_f32_16x16x32_bf16 v[76:79], v[184:187], a[244:247], 0
  ds_write_b32 v4, v124 offset:768
  v_mfma_f32_16x16x32_bf16 v[76:79], v[196:199], a[248:251], v[76:79]
  s_waitcnt lgkmcnt(3)
  v_mul_f32 v128, v15, v128
  v_mfma_f32_16x16x32_bf16 v[76:79], v[208:211], a[252:255], v[76:79]
  ds_write_b32 v4, v125 offset:772
  v_mfma_f32_16x16x32_bf16 v[76:79], v[220:223], v[180:183], v[76:79]
  s_waitcnt lgkmcnt(2)
  v_mul_f32 v129, v15, v129
  v_mfma_f32_16x16x32_bf16 v[76:79], v[232:235], v[64:67], v[76:79]
  v_mul_f32 v130, v15, v130
  v_mul_f32 v131, v15, v131
  v_mfma_f32_16x16x32_bf16 v[76:79], v[244:247], v[68:71], v[76:79]
  v_cvt_pk_bf16_f32 v128, v128, v129
  v_cvt_pk_bf16_f32 v129, v130, v131
  v_mfma_f32_16x16x32_bf16 v[80:83], v[248:251], v[68:71], 0
  ds_write_b32 v4, v128 offset:776
  v_mfma_f32_16x16x32_bf16 v[80:83], v[236:239], v[64:67], v[80:83]
  ds_write_b32 v4, v129 offset:780
  v_mfma_f32_16x16x32_bf16 v[80:83], v[224:227], v[180:183], v[80:83]
  v_cvt_pk_bf16_f32 v40, v76, v77
  v_cvt_pk_bf16_f32 v41, v78, v79
  v_mfma_f32_16x16x32_bf16 v[80:83], v[212:215], a[252:255], v[80:83]
  s_add_u32 m0, s33, 0
  v_mul_f32 v140, v15, v140
  v_mfma_f32_16x16x32_bf16 v[80:83], v[200:203], a[248:251], v[80:83]
  buffer_load_dwordx4 v6, s[8:11], s48 offen offset:0 nt lds
  v_mfma_f32_16x16x32_bf16 v[80:83], v[188:191], a[244:247], v[80:83]
  v_mul_f32 v141, v15, v141
  v_mul_f32 v142, v15, v142
  v_mfma_f32_16x16x32_bf16 v[76:79], v[192:195], a[244:247], 0
  v_mul_f32 v143, v15, v143
  v_cvt_pk_bf16_f32 v140, v140, v141
  v_mfma_f32_16x16x32_bf16 v[76:79], v[204:207], a[248:251], v[76:79]
  v_cvt_pk_bf16_f32 v141, v142, v143
  v_max3_f32 v9, v12, v13, v9
  v_mfma_f32_16x16x32_bf16 v[76:79], v[216:219], a[252:255], v[76:79]
  v_cvt_pk_bf16_f32 v42, v80, v81
  v_cvt_pk_bf16_f32 v43, v82, v83
  v_mfma_f32_16x16x32_bf16 v[76:79], v[228:231], v[180:183], v[76:79]
  ds_write_b32 v5, v140 offset:768
  v_mfma_f32_16x16x32_bf16 v[76:79], v[240:243], v[64:67], v[76:79]
  ds_write_b32 v5, v141 offset:772
  v_mfma_f32_16x16x32_bf16 v[76:79], v[252:255], v[68:71], v[76:79]
  v_rcp_f32 v13, v13
  v_mfma_f32_16x16x32_bf16 v[80:83], a[60:63], v[68:71], 0
  s_add_u32 m0, s33, 8064
  v_mul_f32 v116, v14, v116
  v_mfma_f32_16x16x32_bf16 v[80:83], a[48:51], v[64:67], v[80:83]
  buffer_load_dwordx4 v6, s[8:11], s48 offen offset:128 nt lds
  v_mfma_f32_16x16x32_bf16 v[80:83], a[36:39], v[180:183], v[80:83]
  v_cvt_pk_bf16_f32 v44, v76, v77
  v_cvt_pk_bf16_f32 v45, v78, v79
  v_mfma_f32_16x16x32_bf16 v[80:83], a[24:27], a[252:255], v[80:83]
  v_mul_f32 v117, v14, v117
  v_mul_f32 v118, v14, v118
  v_mfma_f32_16x16x32_bf16 v[80:83], a[12:15], a[248:251], v[80:83]
  v_mul_f32 v119, v14, v119
  v_cvt_pk_bf16_f32 v116, v116, v117
  v_mfma_f32_16x16x32_bf16 v[80:83], a[0:3], a[244:247], v[80:83]
  v_cvt_pk_bf16_f32 v117, v118, v119
  v_mul_f32 v120, v14, v120
  v_mfma_f32_16x16x32_bf16 v[76:79], a[4:7], a[244:247], 0
  ds_write_b32 v4, v116 offset:512
  v_mfma_f32_16x16x32_bf16 v[76:79], a[16:19], a[248:251], v[76:79]
  ds_write_b32 v4, v117 offset:516
  v_mfma_f32_16x16x32_bf16 v[76:79], a[28:31], a[252:255], v[76:79]
  v_cvt_pk_bf16_f32 v46, v80, v81
  v_cvt_pk_bf16_f32 v47, v82, v83
  v_mfma_f32_16x16x32_bf16 v[76:79], a[40:43], v[180:183], v[76:79]
  s_add_u32 m0, s33, 16128
  v_mul_f32 v121, v14, v121
  v_mfma_f32_16x16x32_bf16 v[76:79], a[52:55], v[64:67], v[76:79]
  buffer_load_dwordx4 v6, s[8:11], s48 offen offset:256 nt lds
  v_mfma_f32_16x16x32_bf16 v[76:79], a[64:67], v[68:71], v[76:79]
  v_mul_f32 v122, v14, v122
  v_mul_f32 v123, v14, v123
  v_mfma_f32_16x16x32_bf16 v[80:83], a[68:71], v[68:71], 0
  v_cvt_pk_bf16_f32 v120, v120, v121
  v_cvt_pk_bf16_f32 v121, v122, v123
  v_mfma_f32_16x16x32_bf16 v[80:83], a[56:59], v[64:67], v[80:83]
  ds_write_b32 v4, v120 offset:520
  v_mfma_f32_16x16x32_bf16 v[80:83], a[44:47], v[180:183], v[80:83]
  v_cvt_pk_bf16_f32 v48, v76, v77
  v_cvt_pk_bf16_f32 v49, v78, v79
  v_mfma_f32_16x16x32_bf16 v[80:83], a[32:35], a[252:255], v[80:83]
  ds_write_b32 v4, v121 offset:524
  v_mfma_f32_16x16x32_bf16 v[80:83], a[20:23], a[248:251], v[80:83]
  v_mul_f32 v156, v14, v156
  v_mul_f32 v157, v14, v157
  v_mfma_f32_16x16x32_bf16 v[80:83], a[8:11], a[244:247], v[80:83]
  v_mul_f32 v158, v14, v158
  v_mul_f32 v159, v14, v159
  v_mfma_f32_16x16x32_bf16 v[76:79], a[244:247], a[72:75], 0
  s_add_u32 m0, s33, 4096
  v_cvt_pk_bf16_f32 v156, v156, v157
  v_mfma_f32_16x16x32_bf16 v[76:79], a[248:251], a[84:87], v[76:79]
  buffer_load_dwordx4 v6, s[8:11], s49 offen offset:0 nt lds
  v_mfma_f32_16x16x32_bf16 v[76:79], a[252:255], a[96:99], v[76:79]
  v_cvt_pk_bf16_f32 v50, v80, v81
  v_cvt_pk_bf16_f32 v51, v82, v83
  v_mfma_f32_16x16x32_bf16 v[76:79], v[180:183], a[108:111], v[76:79]
  ds_read_b128 v[72:75], v0 offset:2048
  v_cvt_pk_bf16_f32 v157, v158, v159
  v_mfma_f32_16x16x32_bf16 v[76:79], v[64:67], a[120:123], v[76:79]
  ds_read_b128 v[84:87], v1 offset:2048
  v_mfma_f32_16x16x32_bf16 v[76:79], v[68:71], a[132:135], v[76:79]
  ds_read_b128 v[164:167], v0 offset:10240
  v_mfma_f32_16x16x32_bf16 v[80:83], v[68:71], a[136:139], 0
  ds_read_b128 v[168:171], v1 offset:10240
  v_mfma_f32_16x16x32_bf16 v[80:83], v[64:67], a[124:127], v[80:83]
  ds_read_b128 v[176:179], v0 offset:18432
  v_mfma_f32_16x16x32_bf16 v[80:83], v[180:183], a[112:115], v[80:83]
  v_cvt_pk_bf16_f32 v16, v76, v77
  v_cvt_pk_bf16_f32 v17, v78, v79
  v_mfma_f32_16x16x32_bf16 v[80:83], a[252:255], a[100:103], v[80:83]
  ds_read_b128 v[144:147], v1 offset:18432
  s_add_u32 m0, s33, 12160
  v_mfma_f32_16x16x32_bf16 v[80:83], a[248:251], a[88:91], v[80:83]
  buffer_load_dwordx4 v6, s[8:11], s49 offen offset:128 nt lds
  v_mfma_f32_16x16x32_bf16 v[80:83], a[244:247], a[76:79], v[80:83]
  ds_write_b32 v5, v156 offset:512
  v_mfma_f32_16x16x32_bf16 v[76:79], a[244:247], a[80:83], 0
  ds_write_b32 v5, v157 offset:516
  v_mfma_f32_16x16x32_bf16 v[76:79], a[248:251], a[92:95], v[76:79]
  v_rcp_f32 v12, v12
  v_mfma_f32_16x16x32_bf16 v[76:79], a[252:255], a[104:107], v[76:79]
  v_cvt_pk_bf16_f32 v24, v80, v81
  v_cvt_pk_bf16_f32 v25, v82, v83
  v_mfma_f32_16x16x32_bf16 v[76:79], v[180:183], a[116:119], v[76:79]
  v_mul_f32 v132, v13, v132
  v_mul_f32 v133, v13, v133
  v_mfma_f32_16x16x32_bf16 v[76:79], v[64:67], a[128:131], v[76:79]
  v_mul_f32 v134, v13, v134
  v_mul_f32 v135, v13, v135
  v_mfma_f32_16x16x32_bf16 v[76:79], v[68:71], a[140:143], v[76:79]
  s_waitcnt lgkmcnt(2)
  v_cvt_pk_bf16_f32 v132, v132, v133
  v_mfma_f32_16x16x32_bf16 v[80:83], v[184:187], v[72:75], 0
  s_add_u32 m0, s33, 20224
  v_cvt_pk_bf16_f32 v133, v134, v135
  v_mfma_f32_16x16x32_bf16 v[80:83], v[196:199], v[84:87], v[80:83]
  buffer_load_dwordx4 v6, s[8:11], s49 offen offset:256 nt lds
  v_mfma_f32_16x16x32_bf16 v[80:83], v[208:211], v[164:167], v[80:83]
  v_cvt_pk_bf16_f32 v32, v76, v77
  v_cvt_pk_bf16_f32 v33, v78, v79
  v_mfma_f32_16x16x32_bf16 v[80:83], v[220:223], v[168:171], v[80:83]
  s_waitcnt vmcnt(12)
  s_lshl2_add_u32 m0, s3, s47
  v_mfma_f32_16x16x32_bf16 v[80:83], v[232:235], v[176:179], v[80:83]
  ds_write_addtid_b32 v11
  v_mfma_f32_16x16x32_bf16 v[80:83], v[244:247], v[144:147], v[80:83]
  v_mov_b32 v11, 0
  v_mul_f32 v136, v13, v136
  v_mfma_f32_16x16x32_bf16 v[76:79], v[248:251], v[144:147], 0
  s_cmp_eq_u32 s44, s63
  v_mul_f32 v137, v13, v137
  v_mfma_f32_16x16x32_bf16 v[76:79], v[236:239], v[176:179], v[76:79]
  ds_write_b32 v4, v132 offset:256
  v_mfma_f32_16x16x32_bf16 v[76:79], v[224:227], v[168:171], v[76:79]
  v_cvt_pk_bf16_f32 v52, v80, v81
  v_cvt_pk_bf16_f32 v53, v82, v83
  v_mfma_f32_16x16x32_bf16 v[76:79], v[212:215], v[164:167], v[76:79]
  s_cbranch_scc1 L_cl0
L_cb0:
  v_mfma_f32_16x16x32_bf16 v[76:79], v[200:203], v[84:87], v[76:79]
  ds_write_b32 v4, v133 offset:260
  v_mfma_f32_16x16x32_bf16 v[76:79], v[188:191], v[72:75], v[76:79]
  v_mul_f32 v138, v13, v138
  v_mul_f32 v139, v13, v139
  v_mfma_f32_16x16x32_bf16 v[80:83], v[192:195], v[72:75], 0
  v_cvt_pk_bf16_f32 v136, v136, v137
  v_cvt_pk_bf16_f32 v137, v138, v139
  v_mfma_f32_16x16x32_bf16 v[80:83], v[204:207], v[84:87], v[80:83]
  ds_write_b32 v4, v136 offset:264
  v_mfma_f32_16x16x32_bf16 v[80:83], v[216:219], v[164:167], v[80:83]
  v_cvt_pk_bf16_f32 v54, v76, v77
  v_cvt_pk_bf16_f32 v55, v78, v79
  v_mfma_f32_16x16x32_bf16 v[80:83], v[228:231], v[168:171], v[80:83]
  ds_write_b32 v4, v137 offset:268
  v_mfma_f32_16x16x32_bf16 v[80:83], v[240:243], v[176:179], v[80:83]
  v_mul_f32 v160, v13, v160
  v_mul_f32 v161, v13, v161
  v_mfma_f32_16x16x32_bf16 v[80:83], v[252:255], v[144:147], v[80:83]
  v_mul_f32 v162, v13, v162
  v_mul_f32 v163, v13, v163
  v_mfma_f32_16x16x32_bf16 v[76:79], a[60:63], v[144:147], 0
  v_cvt_pk_bf16_f32 v160, v160, v161
  v_cvt_pk_bf16_f32 v161, v162, v163
  v_mfma_f32_16x16x32_bf16 v[76:79], a[48:51], v[176:179], v[76:79]
  ds_write_b32 v5, v160 offset:256
  v_mfma_f32_16x16x32_bf16 v[76:79], a[36:39], v[168:171], v[76:79]
  v_cvt_pk_bf16_f32 v56, v80, v81
  v_cvt_pk_bf16_f32 v57, v82, v83
  v_mfma_f32_16x16x32_bf16 v[76:79], a[24:27], v[164:167], v[76:79]
  ds_write_b32 v5, v161 offset:260
  v_mfma_f32_16x16x32_bf16 v[76:79], a[12:15], v[84:87], v[76:79]
  v_mul_f32 v148, v12, v148
  v_mul_f32 v149, v12, v149
  v_mfma_f32_16x16x32_bf16 v[76:79], a[0:3], v[72:75], v[76:79]
  v_mul_f32 v150, v12, v150
  v_mul_f32 v151, v12, v151
  v_mfma_f32_16x16x32_bf16 v[80:83], a[4:7], v[72:75], 0
  v_cvt_pk_bf16_f32 v148, v148, v149
  v_cvt_pk_bf16_f32 v149, v150, v151
  v_mfma_f32_16x16x32_bf16 v[80:83], a[16:19], v[84:87], v[80:83]
  ds_write_b32 v4, v148 offset:0
  v_mfma_f32_16x16x32_bf16 v[80:83], a[28:31], v[164:167], v[80:83]
  v_cvt_pk_bf16_f32 v58, v76, v77
  v_cvt_pk_bf16_f32 v59, v78, v79
  v_mfma_f32_16x16x32_bf16 v[80:83], a[40:43], v[168:171], v[80:83]
  ds_write_b32 v4, v149 offset:4
  v_mfma_f32_16x16x32_bf16 v[80:83], a[52:55], v[176:179], v[80:83]
  v_mul_f32 v152, v12, v152
  v_mul_f32 v153, v12, v153
  v_mfma_f32_16x16x32_bf16 v[80:83], a[64:67], v[144:147], v[80:83]
  v_mul_f32 v154, v12, v154
  v_mul_f32 v155, v12, v155
  v_mfma_f32_16x16x32_bf16 v[76:79], a[68:71], v[144:147], 0
  v_cvt_pk_bf16_f32 v152, v152, v153
  v_cvt_pk_bf16_f32 v153, v154, v155
  v_mfma_f32_16x16x32_bf16 v[76:79], a[56:59], v[176:179], v[76:79]
  ds_write_b32 v4, v152 offset:8
  v_mfma_f32_16x16x32_bf16 v[76:79], a[44:47], v[168:171], v[76:79]
  v_cvt_pk_bf16_f32 v60, v80, v81
  v_cvt_pk_bf16_f32 v61, v82, v83
  v_mfma_f32_16x16x32_bf16 v[76:79], a[32:35], v[164:167], v[76:79]
  ds_write_b32 v4, v153 offset:12
  v_mfma_f32_16x16x32_bf16 v[76:79], a[20:23], v[84:87], v[76:79]
  v_mul_f32 v172, v12, v172
  v_mul_f32 v173, v12, v173
  v_mfma_f32_16x16x32_bf16 v[76:79], a[8:11], v[72:75], v[76:79]
  v_mul_f32 v174, v12, v174
  v_mul_f32 v175, v12, v175
  v_mfma_f32_16x16x32_bf16 v[80:83], v[72:75], a[72:75], 0
  v_cvt_pk_bf16_f32 v172, v172, v173
  v_cvt_pk_bf16_f32 v173, v174, v175
  v_mfma_f32_16x16x32_bf16 v[80:83], v[84:87], a[84:87], v[80:83]
  ds_write_b32 v5, v172 offset:0
  v_mfma_f32_16x16x32_bf16 v[80:83], v[164:167], a[96:99], v[80:83]
  v_cvt_pk_bf16_f32 v62, v76, v77
  v_cvt_pk_bf16_f32 v63, v78, v79
  v_mfma_f32_16x16x32_bf16 v[80:83], v[168:171], a[108:111], v[80:83]
  ds_read_b128 v[116:119], v0 offset:4096
  v_mfma_f32_16x16x32_bf16 v[80:83], v[176:179], a[120:123], v[80:83]
  ds_read_b128 v[124:127], v1 offset:4096
  v_mfma_f32_16x16x32_bf16 v[80:83], v[144:147], a[132:135], v[80:83]
  ds_read_b128 v[120:123], v0 offset:12288
  v_mfma_f32_16x16x32_bf16 v[76:79], v[144:147], a[136:139], 0
  ds_read_b128 v[128:131], v1 offset:12288
  v_mfma_f32_16x16x32_bf16 v[76:79], v[176:179], a[124:127], v[76:79]
  ds_read_b128 v[132:135], v0 offset:20480
  v_mfma_f32_16x16x32_bf16 v[76:79], v[168:171], a[112:115], v[76:79]
  v_cvt_pk_bf16_f32 v18, v80, v81
  v_cvt_pk_bf16_f32 v19, v82, v83
  v_mfma_f32_16x16x32_bf16 v[76:79], v[164:167], a[100:103], v[76:79]
  ds_read_b128 v[140:143], v1 offset:20480
  v_mfma_f32_16x16x32_bf16 v[76:79], v[84:87], a[88:91], v[76:79]
  ds_write_b32 v5, v173 offset:4
  v_mfma_f32_16x16x32_bf16 v[76:79], v[72:75], a[76:79], v[76:79]
  v_subrev_u32 v3, s7, v3
  v_subrev_u32 v2, s7, v2
  v_mfma_f32_16x16x32_bf16 v[80:83], v[72:75], a[80:83], 0
  v_add_u32 v4, s7, v4
  v_add_u32 v5, s7, v5
  v_mfma_f32_16x16x32_bf16 v[80:83], v[84:87], a[92:95], v[80:83]
  s_sub_u32 s7, 0, s7
  v_max3_f32 v9, v12, v13, v9
  v_mfma_f32_16x16x32_bf16 v[80:83], v[164:167], a[104:107], v[80:83]
  v_cvt_pk_bf16_f32 v26, v76, v77
  v_cvt_pk_bf16_f32 v27, v78, v79
  v_mfma_f32_16x16x32_bf16 v[80:83], v[168:171], a[116:119], v[80:83]
  v_max3_f32 v9, v14, v15, v9
  v_mfma_f32_16x16x32_bf16 v[80:83], v[176:179], a[128:131], v[80:83]
L_hop4:
  s_cbranch_execz L_hopped
  v_mfma_f32_16x16x32_bf16 v[80:83], v[144:147], a[140:143], v[80:83]
  s_waitcnt lgkmcnt(1)
  v_mfma_f32_16x16x32_bf16 v[148:151], v[184:187], v[116:119], 0
  v_mfma_f32_16x16x32_bf16 v[148:151], v[196:199], v[124:127], v[148:151]
  v_mfma_f32_16x16x32_bf16 v[148:151], v[208:211], v[120:123], v[148:151]
  v_cvt_pk_bf16_f32 v34, v80, v81
  v_cvt_pk_bf16_f32 v35, v82, v83
  v_mfma_f32_16x16x32_bf16 v[148:151], v[220:223], v[128:131], v[148:151]
  v_mfma_f32_16x16x32_bf16 v[148:151], v[232:235], v[132:135], v[148:151]
  v_mfma_f32_16x16x32_bf16 v[148:151], v[244:247], v[140:143], v[148:151]
  v_mfma_f32_16x16x32_bf16 v[156:159], v[248:251], v[140:143], 0
  v_mfma_f32_16x16x32_bf16 v[156:159], v[236:239], v[132:135], v[156:159]
  v_mfma_f32_16x16x32_bf16 v[156:159], v[224:227], v[128:131], v[156:159]
  v_cvt_pk_bf16_f32 v64, v148, v149
  v_cvt_pk_bf16_f32 v65, v150, v151
  v_mfma_f32_16x16x32_bf16 v[156:159], v[212:215], v[120:123], v[156:159]
  v_mfma_f32_16x16x32_bf16 v[156:159], v[200:203], v[124:127], v[156:159]
  v_mfma_f32_16x16x32_bf16 v[156:159], v[188:191], v[116:119], v[156:159]
  v_mfma_f32_16x16x32_bf16 v[148:151], v[192:195], v[116:119], 0
  v_mfma_f32_16x16x32_bf16 v[148:151], v[204:207], v[124:127], v[148:151]
  v_mfma_f32_16x16x32_bf16 v[148:151], v[216:219], v[120:123], v[148:151]
  v_cvt_pk_bf16_f32 v66, v156, v157
  v_cvt_pk_bf16_f32 v67, v158, v159
  v_mfma_f32_16x16x32_bf16 v[148:151], v[228:231], v[128:131], v[148:151]
  s_mov_b32 m0, s47
  s_xor_b32 s47, s47, 1024
  v_mfma_f32_16x16x32_bf16 v[148:151], v[240:243], v[132:135], v[148:151]
  s_add_u32 s40, s50, s52
  s_add_u32 s41, s50, s53
  v_mfma_f32_16x16x32_bf16 v[148:151], v[252:255], v[140:143], v[148:151]
  s_add_u32 s42, s50, s54
  s_add_u32 s43, s50, s55
  v_mfma_f32_16x16x32_bf16 v[156:159], a[60:63], v[140:143], 0
  s_cmp_ge_u32 s6, 94765056
  s_cselect_b64 vcc, -1, 0
  v_mfma_f32_16x16x32_bf16 v[156:159], a[48:51], v[132:135], v[156:159]
  s_mov_b32 s50, s51
  s_mov_b32 s51, s6
  v_mfma_f32_16x16x32_bf16 v[156:159], a[36:39], v[128:131], v[156:159]
  v_cvt_pk_bf16_f32 v68, v148, v149
  v_cvt_pk_bf16_f32 v69, v150, v151
  v_mfma_f32_16x16x32_bf16 v[156:159], a[24:27], v[120:123], v[156:159]
  s_mov_b32 s6, s48
  s_add_u32 s36, s32, s33
  v_mfma_f32_16x16x32_bf16 v[156:159], a[12:15], v[124:127], v[156:159]
  s_mov_b32 s33, s32
  s_sub_u32 s32, s34, s36
  v_mfma_f32_16x16x32_bf16 v[156:159], a[0:3], v[116:119], v[156:159]
  v_mfma_f32_16x16x32_bf16 v[148:151], a[4:7], v[116:119], 0
  v_mfma_f32_16x16x32_bf16 v[148:151], a[16:19], v[124:127], v[148:151]
  v_mfma_f32_16x16x32_bf16 v[148:151], a[28:31], v[120:123], v[148:151]
  v_cvt_pk_bf16_f32 v76, v156, v157
  v_cvt_pk_bf16_f32 v77, v158, v159
  v_mfma_f32_16x16x32_bf16 v[148:151], a[40:43], v[128:131], v[148:151]
  v_mfma_f32_16x16x32_bf16 v[148:151], a[52:55], v[132:135], v[148:151]
  v_mfma_f32_16x16x32_bf16 v[148:151], a[64:67], v[140:143], v[148:151]
  v_mfma_f32_16x16x32_bf16 v[156:159], a[68:71], v[140:143], 0
  v_mfma_f32_16x16x32_bf16 v[156:159], a[56:59], v[132:135], v[156:159]
  v_mfma_f32_16x16x32_bf16 v[156:159], a[44:47], v[128:131], v[156:159]
  v_cvt_pk_bf16_f32 v78, v148, v149
  v_cvt_pk_bf16_f32 v79, v150, v151
  v_mfma_f32_16x16x32_bf16 v[156:159], a[32:35], v[120:123], v[156:159]
  v_mfma_f32_16x16x32_bf16 v[156:159], a[20:23], v[124:127], v[156:159]
  v_mfma_f32_16x16x32_bf16 v[156:159], a[8:11], v[116:119], v[156:159]
  v_mfma_f32_16x16x32_bf16 v[148:151], v[116:119], a[72:75], 0
  v_mfma_f32_16x16x32_bf16 v[148:151], v[124:127], a[84:87], v[148:151]
  v_mfma_f32_16x16x32_bf16 v[148:151], v[120:123], a[96:99], v[148:151]
  v_cvt_pk_bf16_f32 v80, v156, v157
  v_cvt_pk_bf16_f32 v81, v158, v159
  v_mfma_f32_16x16x32_bf16 v[148:151], v[128:131], a[108:111], v[148:151]
  ds_read_b128 v[136:139], v0 offset:6144
  v_mfma_f32_16x16x32_bf16 v[148:151], v[132:135], a[120:123], v[148:151]
  ds_read_b128 v[144:147], v1 offset:6144
  v_mfma_f32_16x16x32_bf16 v[148:151], v[140:143], a[132:135], v[148:151]
  ds_read_b128 v[152:155], v0 offset:14336
  v_mfma_f32_16x16x32_bf16 v[156:159], v[140:143], a[136:139], 0
  ds_read_b128 v[160:163], v1 offset:14336
  v_mfma_f32_16x16x32_bf16 v[156:159], v[132:135], a[124:127], v[156:159]
  ds_read_b128 v[164:167], v0 offset:22528
  v_mfma_f32_16x16x32_bf16 v[156:159], v[128:131], a[112:115], v[156:159]
  v_cvt_pk_bf16_f32 v20, v148, v149
  v_cvt_pk_bf16_f32 v21, v150, v151
  v_mfma_f32_16x16x32_bf16 v[156:159], v[120:123], a[100:103], v[156:159]
  ds_read_b128 v[172:175], v1 offset:22528
  v_mfma_f32_16x16x32_bf16 v[156:159], v[124:127], a[88:91], v[156:159]
  v_mfma_f32_16x16x32_bf16 v[156:159], v[116:119], a[76:79], v[156:159]
  v_mfma_f32_16x16x32_bf16 v[148:151], v[116:119], a[80:83], 0
  v_mfma_f32_16x16x32_bf16 v[148:151], v[124:127], a[92:95], v[148:151]
  v_mfma_f32_16x16x32_bf16 v[148:151], v[120:123], a[104:107], v[148:151]
  v_cvt_pk_bf16_f32 v28, v156, v157
  v_cvt_pk_bf16_f32 v29, v158, v159
  v_mfma_f32_16x16x32_bf16 v[148:151], v[128:131], a[116:119], v[148:151]
  s_cmp_eq_u32 s44, s60
  v_mfma_f32_16x16x32_bf16 v[148:151], v[132:135], a[128:131], v[148:151]
  v_mfma_f32_16x16x32_bf16 v[148:151], v[140:143], a[140:143], v[148:151]
  s_waitcnt lgkmcnt(0)
  v_mfma_f32_16x16x32_bf16 v[168:171], v[184:187], v[136:139], 0
  s_cbranch_scc1 L_cl1
L_cb1:
  v_mfma_f32_16x16x32_bf16 v[168:171], v[196:199], v[144:147], v[168:171]
  v_mfma_f32_16x16x32_bf16 v[168:171], v[208:211], v[152:155], v[168:171]
  v_cvt_pk_bf16_f32 v36, v148, v149
  v_cvt_pk_bf16_f32 v37, v150, v151
  v_mfma_f32_16x16x32_bf16 v[168:171], v[220:223], v[160:163], v[168:171]
  v_mfma_f32_16x16x32_bf16 v[168:171], v[232:235], v[164:167], v[168:171]
  v_mfma_f32_16x16x32_bf16 v[168:171], v[244:247], v[172:175], v[168:171]
  v_mfma_f32_16x16x32_bf16 v[176:179], v[248:251], v[172:175], 0
  v_mfma_f32_16x16x32_bf16 v[176:179], v[236:239], v[164:167], v[176:179]
  v_mfma_f32_16x16x32_bf16 v[176:179], v[224:227], v[160:163], v[176:179]
  v_cvt_pk_bf16_f32 v70, v168, v169
  v_cvt_pk_bf16_f32 v71, v170, v171
  v_mfma_f32_16x16x32_bf16 v[176:179], v[212:215], v[152:155], v[176:179]
  v_mfma_f32_16x16x32_bf16 v[176:179], v[200:203], v[144:147], v[176:179]
  s_barrier
  v_mfma_f32_16x16x32_bf16 v[176:179], v[188:191], v[136:139], v[176:179]
  ds_read_addtid_b32 v116
  v_mad_i32_i16 v0, v10, 1, s32 op_sel:[1,0,0,0]
  v_mfma_f32_16x16x32_bf16 v[168:171], v[192:195], v[136:139], 0
  v_xor_b32 v1, 64, v0
  v_mfma_f32_16x16x32_bf16 v[168:171], v[204:207], v[144:147], v[168:171]
  v_mfma_f32_16x16x32_bf16 v[168:171], v[216:219], v[152:155], v[168:171]
  v_cvt_pk_bf16_f32 v72, v176, v177
  v_cvt_pk_bf16_f32 v73, v178, v179
  v_mfma_f32_16x16x32_bf16 v[168:171], v[228:231], v[160:163], v[168:171]
  v_mfma_f32_16x16x32_bf16 v[168:171], v[240:243], v[164:167], v[168:171]
  v_mfma_f32_16x16x32_bf16 v[168:171], v[252:255], v[172:175], v[168:171]
  s_waitcnt lgkmcnt(0)
  v_readfirstlane_b32 s36, v116
  v_mfma_f32_16x16x32_bf16 v[176:179], a[60:63], v[172:175], 0
  v_mfma_f32_16x16x32_bf16 v[176:179], a[48:51], v[164:167], v[176:179]
  s_add_u32 s36, s36, s44
  s_min_u32 s36, s36, s13
  v_mfma_f32_16x16x32_bf16 v[176:179], a[36:39], v[160:163], v[176:179]
  v_cvt_pk_bf16_f32 v74, v168, v169
  v_cvt_pk_bf16_f32 v75, v170, v171
  v_mfma_f32_16x16x32_bf16 v[176:179], a[24:27], v[152:155], v[176:179]
  s_max_u32 s45, s45, s36
  s_min_u32 s36, s45, s12
  v_mfma_f32_16x16x32_bf16 v[176:179], a[12:15], v[144:147], v[176:179]
  s_cselect_b32 s48, s46, s62
  s_sub_u32 s37, s45, s36
  v_mfma_f32_16x16x32_bf16 v[176:179], a[0:3], v[136:139], v[176:179]
  s_mul_i32 s36, s36, 1572864
  s_add_u32 s48, s48, s36
  v_mfma_f32_16x16x32_bf16 v[168:171], a[4:7], v[136:139], 0
  s_mul_i32 s36, s37, s14
  s_lshr_b32 s36, s36, 8
  v_mfma_f32_16x16x32_bf16 v[168:171], a[16:19], v[144:147], v[168:171]
  s_mul_i32 s36, s36, s15
  s_add_u32 s48, s48, s36
  v_mfma_f32_16x16x32_bf16 v[168:171], a[28:31], v[152:155], v[168:171]
  v_cvt_pk_bf16_f32 v82, v176, v177
  v_cvt_pk_bf16_f32 v83, v178, v179
  v_mfma_f32_16x16x32_bf16 v[168:171], a[40:43], v[160:163], v[168:171]
  s_mulk_i32 s37, 3072
  s_add_u32 s48, s48, s37
  v_mfma_f32_16x16x32_bf16 v[168:171], a[52:55], v[164:167], v[168:171]
  s_add_u32 s49, s48, 786432
  s_bitset1_b64 s[56:57], s45
  v_mfma_f32_16x16x32_bf16 v[168:171], a[64:67], v[172:175], v[168:171]
  s_add_u32 s44, s44, 4
  s_min_u32 s44, s44, s12
  v_mfma_f32_16x16x32_bf16 v[176:179], a[68:71], v[172:175], 0
  s_cmp_ge_u32 s45, s13
  s_cselect_b32 s63, -2, s63
  v_mfma_f32_16x16x32_bf16 v[176:179], a[56:59], v[164:167], v[176:179]
  v_mfma_f32_16x16x32_bf16 v[176:179], a[44:47], v[160:163], v[176:179]
  v_cvt_pk_bf16_f32 v84, v168, v169
  v_cvt_pk_bf16_f32 v85, v170, v171
  v_mfma_f32_16x16x32_bf16 v[176:179], a[32:35], v[152:155], v[176:179]
  v_mfma_f32_16x16x32_bf16 v[176:179], a[20:23], v[144:147], v[176:179]
  v_mfma_f32_16x16x32_bf16 v[176:179], a[8:11], v[136:139], v[176:179]
  v_mfma_f32_16x16x32_bf16 v[168:171], v[136:139], a[72:75], 0
  v_mfma_f32_16x16x32_bf16 v[168:171], v[144:147], a[84:87], v[168:171]
  v_mfma_f32_16x16x32_bf16 v[168:171], v[152:155], a[96:99], v[168:171]
  v_cvt_pk_bf16_f32 v86, v176, v177
  v_cvt_pk_bf16_f32 v87, v178, v179
  v_mfma_f32_16x16x32_bf16 v[168:171], v[160:163], a[108:111], v[168:171]
  v_mfma_f32_16x16x32_bf16 v[168:171], v[164:167], a[120:123], v[168:171]
  v_mfma_f32_16x16x32_bf16 v[168:171], v[172:175], a[132:135], v[168:171]
  v_mfma_f32_16x16x32_bf16 v[176:179], v[172:175], a[136:139], 0
  v_mfma_f32_16x16x32_bf16 v[176:179], v[164:167], a[124:127], v[176:179]
  v_mfma_f32_16x16x32_bf16 v[176:179], v[160:163], a[112:115], v[176:179]
  v_cvt_pk_bf16_f32 v22, v168, v169
  v_cvt_pk_bf16_f32 v23, v170, v171
  v_mfma_f32_16x16x32_bf16 v[176:179], v[152:155], a[100:103], v[176:179]
  ds_read_b128 a[244:247], v3 offset:0
  v_mfma_f32_16x16x32_bf16 v[176:179], v[144:147], a[88:91], v[176:179]
  ds_read_b128 a[248:251], v3 offset:4096
  v_mfma_f32_16x16x32_bf16 v[176:179], v[136:139], a[76:79], v[176:179]
  ds_read_b128 a[252:255], v3 offset:8192
  v_mfma_f32_16x16x32_bf16 v[168:171], v[136:139], a[80:83], 0
  ds_read_b128 v[180:183], v3 offset:12288
  v_mfma_f32_16x16x32_bf16 v[168:171], v[144:147], a[92:95], v[168:171]
  v_mfma_f32_16x16x32_bf16 v[168:171], v[152:155], a[104:107], v[168:171]
  v_cvt_pk_bf16_f32 v30, v176, v177
  v_cvt_pk_bf16_f32 v31, v178, v179
  v_mfma_f32_16x16x32_bf16 v[168:171], v[160:163], a[116:119], v[168:171]
  s_cmp_lg_u32 s31, 0
  v_mfma_f32_16x16x32_bf16 v[168:171], v[164:167], a[128:131], v[168:171]
  v_mfma_f32_16x16x32_bf16 v[168:171], v[172:175], a[140:143], v[168:171]
  s_cbranch_scc0 L_s
  s_branch L_special
L_cl0:
  v_mov_b32 v11, 1
  v_lshrrev_b32 v180, 16, v10
  buffer_atomic_add v11, v180, s[20:23], 0 offen sc0 sc1
  s_branch L_cb0
L_cl1:
  v_mov_b32 v11, 1
  v_lshrrev_b32 v180, 16, v10
  buffer_atomic_add v11, v180, s[20:23], 0 offen sc0 sc1
  s_branch L_cb1
L_epi:
  ds_write_b32 v4, v124 offset:768
  ds_write_b32 v4, v125 offset:772
  v_pk_mul_f32 v[128:129], v[128:129], v[14:15] op_sel:[0,1] op_sel_hi:[1,1]
  v_pk_mul_f32 v[130:131], v[130:131], v[14:15] op_sel:[0,1] op_sel_hi:[1,1]
  v_cvt_pk_bf16_f32 v128, v128, v129
  v_cvt_pk_bf16_f32 v129, v130, v131
  ds_write_b32 v4, v128 offset:776
  ds_write_b32 v4, v129 offset:780
  v_pk_mul_f32 v[140:141], v[140:141], v[14:15] op_sel:[0,1] op_sel_hi:[1,1]
  v_pk_mul_f32 v[142:143], v[142:143], v[14:15] op_sel:[0,1] op_sel_hi:[1,1]
  v_cvt_pk_bf16_f32 v140, v140, v141
  v_cvt_pk_bf16_f32 v141, v142, v143
  ds_write_b32 v5, v140 offset:768
  ds_write_b32 v5, v141 offset:772
  v_pk_mul_f32 v[116:117], v[116:117], v[14:15] op_sel:[0,0] op_sel_hi:[1,0]
  v_pk_mul_f32 v[118:119], v[118:119], v[14:15] op_sel:[0,0] op_sel_hi:[1,0]
  v_cvt_pk_bf16_f32 v116, v116, v117
  v_cvt_pk_bf16_f32 v117, v118, v119
  v_pk_mul_f32 v[120:121], v[120:121], v[14:15] op_sel:[0,0] op_sel_hi:[1,0]
  v_pk_mul_f32 v[122:123], v[122:123], v[14:15] op_sel:[0,0] op_sel_hi:[1,0]
  v_cvt_pk_bf16_f32 v118, v120, v121
  v_cvt_pk_bf16_f32 v119, v122, v123
  ds_write_b128 v4, v[116:119] offset:512
  v_pk_mul_f32 v[156:157], v[156:157], v[14:15] op_sel:[0,0] op_sel_hi:[1,0]
  v_pk_mul_f32 v[158:159], v[158:159], v[14:15] op_sel:[0,0] op_sel_hi:[1,0]
  v_cvt_pk_bf16_f32 v156, v156, v157
  v_cvt_pk_bf16_f32 v157, v158, v159
  ds_write_b64 v5, v[156:157] offset:512
  s_mul_i32 s36, s5, 768
  s_add_u32 s37, s7, s36
  s_sub_u32 s36, s7, s36
  v_subrev_u32 v3, s37, v3
  v_subrev_u32 v2, s36, v2
  v_max3_f32 v9, v12, v13, v9
  v_rcp_f32 v13, v13
  v_rcp_f32 v12, v12
  s_lshl_b32 s36, s5, 1
  s_add_u32 s37, s36, s4
  s_sub_u32 s36, s36, s4
  s_mul_i32 s37, s37, 196608
  s_mul_i32 s36, s36, 196608
  s_sub_u32 s37, s50, s37
  s_add_u32 s36, s50, s36
  s_add_u32 s40, s37, 1179648
  s_waitcnt lgkmcnt(0)
  s_barrier
  ds_read_b128 a[244:247], v3 offset:768
  ds_read_b128 a[248:251], v3 offset:4864
  v_pk_mul_f32 v[132:133], v[132:133], v[12:13] op_sel:[0,1] op_sel_hi:[1,1]
  v_pk_mul_f32 v[134:135], v[134:135], v[12:13] op_sel:[0,1] op_sel_hi:[1,1]
  v_cvt_pk_bf16_f32 v132, v132, v133
  ds_read_b128 a[252:255], v3 offset:8960
  v_cvt_pk_bf16_f32 v133, v134, v135
  v_pk_mul_f32 v[136:137], v[136:137], v[12:13] op_sel:[0,1] op_sel_hi:[1,1]
  v_pk_mul_f32 v[138:139], v[138:139], v[12:13] op_sel:[0,1] op_sel_hi:[1,1]
  ds_read_b128 v[180:183], v3 offset:13056
  v_cvt_pk_bf16_f32 v134, v136, v137
  v_cvt_pk_bf16_f32 v135, v138, v139
  v_pk_mul_f32 v[160:161], v[160:161], v[12:13] op_sel:[0,1] op_sel_hi:[1,1]
  ds_read_b128 v[64:67], v3 offset:17152
  v_pk_mul_f32 v[162:163], v[162:163], v[12:13] op_sel:[0,1] op_sel_hi:[1,1]
  v_cvt_pk_bf16_f32 v160, v160, v161
  v_cvt_pk_bf16_f32 v161, v162, v163
  ds_read_b128 v[68:71], v3 offset:21248
  v_pk_mul_f32 v[148:149], v[148:149], v[12:13] op_sel:[0,0] op_sel_hi:[1,0]
  v_pk_mul_f32 v[150:151], v[150:151], v[12:13] op_sel:[0,0] op_sel_hi:[1,0]
  v_pk_mul_f32 v[152:153], v[152:153], v[12:13] op_sel:[0,0] op_sel_hi:[1,0]
  v_pk_mul_f32 v[154:155], v[154:155], v[12:13] op_sel:[0,0] op_sel_hi:[1,0]
  s_waitcnt lgkmcnt(4)
  v_mfma_f32_16x16x32_bf16 v[40:43], a[144:147], a[244:247], 0
  v_cvt_pk_bf16_f32 v148, v148, v149
  v_cvt_pk_bf16_f32 v149, v150, v151
  v_mfma_f32_16x16x32_bf16 v[40:43], a[160:163], a[248:251], v[40:43]
  s_waitcnt lgkmcnt(2)
  v_cvt_pk_bf16_f32 v150, v152, v153
  v_mfma_f32_16x16x32_bf16 v[40:43], a[176:179], a[252:255], v[40:43]
  v_cvt_pk_bf16_f32 v151, v154, v155
  v_mfma_f32_16x16x32_bf16 v[40:43], a[192:195], v[180:183], v[40:43]
  s_waitcnt lgkmcnt(0)
  v_mfma_f32_16x16x32_bf16 v[40:43], a[208:211], v[64:67], v[40:43]
  ds_write_b128 v4, v[132:135] offset:256
  v_mfma_f32_16x16x32_bf16 v[40:43], a[224:227], v[68:71], v[40:43]
  ds_write_b64 v5, v[160:161] offset:256
  v_mfma_f32_16x16x32_bf16 v[44:47], a[228:231], v[68:71], 0
  ds_write_b128 v4, v[148:151] offset:0
  v_mfma_f32_16x16x32_bf16 v[44:47], a[212:215], v[64:67], v[44:47]
  v_mul_f32 v172, v12, v172
  v_mul_f32 v173, v12, v173
  v_mfma_f32_16x16x32_bf16 v[44:47], a[196:199], v[180:183], v[44:47]
  v_cvt_pk_bf16_f32 v40, v40, v41
  v_cvt_pk_bf16_f32 v41, v42, v43
  v_mfma_f32_16x16x32_bf16 v[44:47], a[180:183], a[252:255], v[44:47]
  v_mul_f32 v174, v12, v174
  v_mul_f32 v175, v12, v175
  v_mfma_f32_16x16x32_bf16 v[44:47], a[164:167], a[248:251], v[44:47]
  v_cvt_pk_bf16_f32 v172, v172, v173
  v_cvt_pk_bf16_f32 v173, v174, v175
  v_mfma_f32_16x16x32_bf16 v[44:47], a[148:151], a[244:247], v[44:47]
  ds_write_b64 v5, v[172:173] offset:0
  v_mfma_f32_16x16x32_bf16 v[48:51], a[152:155], a[244:247], 0
  ds_read_b128 v[72:75], v2 offset:512
  v_mfma_f32_16x16x32_bf16 v[48:51], a[168:171], a[248:251], v[48:51]
  ds_read_b128 v[56:59], v2 offset:4608
  v_mfma_f32_16x16x32_bf16 v[48:51], a[184:187], a[252:255], v[48:51]
  v_cvt_pk_bf16_f32 v42, v44, v45
  v_cvt_pk_bf16_f32 v43, v46, v47
  v_mfma_f32_16x16x32_bf16 v[48:51], a[200:203], v[180:183], v[48:51]
  buffer_store_dwordx4 v[40:43], v7, s[24:27], s40 offen nt
  v_mfma_f32_16x16x32_bf16 v[48:51], a[216:219], v[64:67], v[48:51]
  ds_read_b128 v[60:63], v2 offset:8704
  v_mfma_f32_16x16x32_bf16 v[48:51], a[232:235], v[68:71], v[48:51]
  ds_read_b128 v[76:79], v2 offset:12800
  v_mfma_f32_16x16x32_bf16 v[52:55], a[236:239], v[68:71], 0
  ds_read_b128 v[80:83], v2 offset:16896
  v_mfma_f32_16x16x32_bf16 v[52:55], a[220:223], v[64:67], v[52:55]
  ds_read_b128 v[84:87], v2 offset:20992
  v_mfma_f32_16x16x32_bf16 v[52:55], a[204:207], v[180:183], v[52:55]
  v_cvt_pk_bf16_f32 v48, v48, v49
  v_cvt_pk_bf16_f32 v49, v50, v51
  v_mfma_f32_16x16x32_bf16 v[52:55], a[188:191], a[252:255], v[52:55]
  v_mfma_f32_16x16x32_bf16 v[52:55], a[172:175], a[248:251], v[52:55]
  s_waitcnt lgkmcnt(6)
  s_barrier
  v_mfma_f32_16x16x32_bf16 v[52:55], a[156:159], a[244:247], v[52:55]
  s_waitcnt lgkmcnt(0)
  ds_read_b128 v[124:127], v3 offset:256
  v_mfma_f32_16x16x32_bf16 v[40:43], a[144:147], v[72:75], 0
  ds_read_b128 v[128:131], v3 offset:4352
  s_add_u32 s41, s36, 786432
  v_mfma_f32_16x16x32_bf16 v[40:43], a[160:163], v[56:59], v[40:43]
  ds_read_b128 v[140:143], v3 offset:8448
  v_mfma_f32_16x16x32_bf16 v[40:43], a[176:179], v[60:63], v[40:43]
  v_cvt_pk_bf16_f32 v50, v52, v53
  v_cvt_pk_bf16_f32 v51, v54, v55
  v_mfma_f32_16x16x32_bf16 v[40:43], a[192:195], v[76:79], v[40:43]
  buffer_store_dwordx4 v[48:51], v8, s[24:27], s40 offen nt
  v_mfma_f32_16x16x32_bf16 v[40:43], a[208:211], v[80:83], v[40:43]
  ds_read_b128 v[116:119], v3 offset:12544
  s_add_u32 s42, s37, 393216
  v_mfma_f32_16x16x32_bf16 v[40:43], a[224:227], v[84:87], v[40:43]
  ds_read_b128 v[120:123], v3 offset:16640
  v_mfma_f32_16x16x32_bf16 v[44:47], a[228:231], v[84:87], 0
  ds_read_b128 v[156:159], v3 offset:20736
  s_add_u32 s43, s36, 0
  v_mfma_f32_16x16x32_bf16 v[44:47], a[212:215], v[80:83], v[44:47]
  v_mfma_f32_16x16x32_bf16 v[44:47], a[196:199], v[76:79], v[44:47]
  v_cvt_pk_bf16_f32 v40, v40, v41
  v_cvt_pk_bf16_f32 v41, v42, v43
  v_mfma_f32_16x16x32_bf16 v[44:47], a[180:183], v[60:63], v[44:47]
  v_mfma_f32_16x16x32_bf16 v[44:47], a[164:167], v[56:59], v[44:47]
  v_mfma_f32_16x16x32_bf16 v[44:47], a[148:151], v[72:75], v[44:47]
  s_waitcnt lgkmcnt(0)
  v_mfma_f32_16x16x32_bf16 v[48:51], a[144:147], v[124:127], 0
  v_mfma_f32_16x16x32_bf16 v[48:51], a[160:163], v[128:131], v[48:51]
  v_mfma_f32_16x16x32_bf16 v[48:51], a[176:179], v[140:143], v[48:51]
  v_cvt_pk_bf16_f32 v42, v44, v45
  v_cvt_pk_bf16_f32 v43, v46, v47
  v_mfma_f32_16x16x32_bf16 v[48:51], a[192:195], v[116:119], v[48:51]
  buffer_store_dwordx4 v[40:43], v7, s[24:27], s41 offen nt
  v_mfma_f32_16x16x32_bf16 v[48:51], a[208:211], v[120:123], v[48:51]
  ds_read_b128 v[16:19], v2 offset:0
  v_mfma_f32_16x16x32_bf16 v[48:51], a[224:227], v[156:159], v[48:51]
  ds_read_b128 v[20:23], v2 offset:4096
  v_max3_f32 v9, v12, v13, v9
  v_mfma_f32_16x16x32_bf16 v[52:55], a[228:231], v[156:159], 0
  ds_read_b128 v[24:27], v2 offset:8192
  v_max3_f32 v9, v14, v15, v9
  v_mfma_f32_16x16x32_bf16 v[52:55], a[212:215], v[120:123], v[52:55]
  ds_read_b128 v[28:31], v2 offset:12288
  v_mfma_f32_16x16x32_bf16 v[52:55], a[196:199], v[116:119], v[52:55]
  v_cvt_pk_bf16_f32 v48, v48, v49
  v_cvt_pk_bf16_f32 v49, v50, v51
  v_mfma_f32_16x16x32_bf16 v[52:55], a[180:183], v[140:143], v[52:55]
  ds_read_b128 v[32:35], v2 offset:16384
  s_lshl_b32 s39, s4, 2
  v_mfma_f32_16x16x32_bf16 v[52:55], a[164:167], v[128:131], v[52:55]
  ds_read_b128 v[36:39], v2 offset:20480
  s_add_u32 s39, s39, 28672
  v_mfma_f32_16x16x32_bf16 v[52:55], a[148:151], v[124:127], v[52:55]
  v_mov_b32 v0, s39
  v_mfma_f32_16x16x32_bf16 v[40:43], a[152:155], v[124:127], 0
  s_mov_b64 s[36:37], 0
  v_mfma_f32_16x16x32_bf16 v[40:43], a[168:171], v[128:131], v[40:43]
  v_cmp_nge_f32 vcc, 0x53800000, v9
  v_mfma_f32_16x16x32_bf16 v[40:43], a[184:187], v[140:143], v[40:43]
  v_cvt_pk_bf16_f32 v50, v52, v53
  v_cvt_pk_bf16_f32 v51, v54, v55
  v_mfma_f32_16x16x32_bf16 v[40:43], a[200:203], v[116:119], v[40:43]
  buffer_store_dwordx4 v[48:51], v7, s[24:27], s42 offen nt
  v_mfma_f32_16x16x32_bf16 v[40:43], a[216:219], v[120:123], v[40:43]
  s_or_b64 vcc, vcc, s[36:37]
  s_cselect_b32 s38, 1, 0
  v_mfma_f32_16x16x32_bf16 v[40:43], a[232:235], v[156:159], v[40:43]
  v_mov_b32 v1, s38
  v_mfma_f32_16x16x32_bf16 v[44:47], a[236:239], v[156:159], 0
  ds_write_b32 v0, v1
  v_mfma_f32_16x16x32_bf16 v[44:47], a[220:223], v[120:123], v[44:47]
  v_mov_b32 v1, 28672
  v_mfma_f32_16x16x32_bf16 v[44:47], a[204:207], v[116:119], v[44:47]
  v_cvt_pk_bf16_f32 v40, v40, v41
  v_cvt_pk_bf16_f32 v41, v42, v43
  v_mfma_f32_16x16x32_bf16 v[44:47], a[188:191], v[140:143], v[44:47]
  v_mfma_f32_16x16x32_bf16 v[44:47], a[172:175], v[128:131], v[44:47]
  v_mfma_f32_16x16x32_bf16 v[44:47], a[156:159], v[124:127], v[44:47]
  s_waitcnt lgkmcnt(1)
  v_mfma_f32_16x16x32_bf16 v[48:51], a[144:147], v[16:19], 0
  v_mfma_f32_16x16x32_bf16 v[48:51], a[160:163], v[20:23], v[48:51]
  v_mfma_f32_16x16x32_bf16 v[48:51], a[176:179], v[24:27], v[48:51]
  v_cvt_pk_bf16_f32 v42, v44, v45
  v_cvt_pk_bf16_f32 v43, v46, v47
  v_mfma_f32_16x16x32_bf16 v[48:51], a[192:195], v[28:31], v[48:51]
  buffer_store_dwordx4 v[40:43], v8, s[24:27], s42 offen nt
  v_mfma_f32_16x16x32_bf16 v[48:51], a[208:211], v[32:35], v[48:51]
  v_mfma_f32_16x16x32_bf16 v[48:51], a[224:227], v[36:39], v[48:51]
  v_mfma_f32_16x16x32_bf16 v[52:55], a[228:231], v[36:39], 0
  v_mfma_f32_16x16x32_bf16 v[52:55], a[212:215], v[32:35], v[52:55]
  v_mfma_f32_16x16x32_bf16 v[52:55], a[196:199], v[28:31], v[52:55]
  v_cvt_pk_bf16_f32 v48, v48, v49
  v_cvt_pk_bf16_f32 v49, v50, v51
  v_mfma_f32_16x16x32_bf16 v[52:55], a[180:183], v[24:27], v[52:55]
  v_mfma_f32_16x16x32_bf16 v[52:55], a[164:167], v[20:23], v[52:55]
  v_mfma_f32_16x16x32_bf16 v[52:55], a[148:151], v[16:19], v[52:55]
  s_nop 7
  v_cvt_pk_bf16_f32 v50, v52, v53
  v_cvt_pk_bf16_f32 v51, v54, v55
  buffer_store_dwordx4 v[48:51], v7, s[24:27], s43 offen nt
  s_waitcnt lgkmcnt(0)
  s_barrier
  ds_read_b128 v[116:119], v1
  s_waitcnt lgkmcnt(0)
  v_or3_b32 v116, v116, v117, v118
  v_or_b32 v116, v116, v119
  s_nop 0
  v_readfirstlane_b32 s36, v116
  s_nop 3
  s_andn2_b32 s36, s36, s31
  s_cbranch_scc1 L_redo
  s_endpgm
L_redo:
  s_mov_b64 s[100:101], s[56:57]
  s_mov_b32 s31, 1
  s_waitcnt vmcnt(0) lgkmcnt(0)
  v_mbcnt_lo_u32_b32 v0, -1, 0
  v_mbcnt_hi_u32_b32 v0, -1, v0
  v_add_u32 v0, s3, v0
  s_barrier
  s_branch L_again
L_special0:
  buffer_load_dwordx4 v6, s[8:11], s49 offen offset:256 nt lds
  s_add_u32 s48, s48, 6291456
  s_add_u32 s49, s48, 786432
  s_add_u32 m0, s32, 65536
  ds_read_b64_tr_b16 a[100:101], v13 offset:49152
  buffer_load_dwordx4 v6, s[8:11], s48 offen offset:0 nt lds
  ds_read_b64_tr_b16 a[102:103], v13 offset:49664
  ds_read_b64_tr_b16 a[104:105], v14 offset:49152
  ds_read_b64_tr_b16 a[106:107], v14 offset:49664
  ds_read_b64_tr_b16 a[108:109], v12 offset:61440
  s_add_u32 m0, s32, 73600
  ds_read_b64_tr_b16 a[110:111], v12 offset:61952
  buffer_load_dwordx4 v6, s[8:11], s48 offen offset:128 nt lds
  ds_read_b64_tr_b16 a[112:113], v13 offset:61440
  ds_read_b64_tr_b16 a[114:115], v13 offset:61952
  ds_read_b64_tr_b16 a[116:117], v14 offset:61440
  ds_read_b64_tr_b16 a[118:119], v14 offset:61952
  s_add_u32 m0, s32, 81664
  s_nop 0
  buffer_load_dwordx4 v6, s[8:11], s48 offen offset:256 nt lds
  s_waitcnt lgkmcnt(0)
  s_waitcnt vmcnt(9)
  s_barrier
  ds_read_b64_tr_b16 a[120:121], v15 offset:0
  ds_read_b64_tr_b16 a[122:123], v15 offset:512
  ds_read_b64_tr_b16 a[124:125], v9 offset:0
  ds_read_b64_tr_b16 a[126:127], v9 offset:512
  ds_read_b64_tr_b16 a[128:129], v11 offset:0
  ds_read_b64_tr_b16 a[130:131], v11 offset:512
  ds_read_b64_tr_b16 a[132:133], v15 offset:12288
  ds_read_b64_tr_b16 a[134:135], v15 offset:12800
  ds_read_b64_tr_b16 a[136:137], v9 offset:12288
  ds_read_b64_tr_b16 a[138:139], v9 offset:12800
  ds_read_b64_tr_b16 a[140:141], v11 offset:12288
  ds_read_b64_tr_b16 a[142:143], v11 offset:12800
  v_mfma_f32_16x16x16_bf16 v[124:127], v[62:63], v[74:75], v[124:127]
  v_mfma_f32_16x16x16_bf16 v[120:123], v[80:81], v[74:75], v[120:123]
  v_mfma_f32_16x16x16_bf16 v[128:131], v[86:87], v[74:75], v[128:131]
  v_mfma_f32_16x16x16_bf16 v[132:135], v[50:51], v[68:69], v[160:163]
  v_mfma_f32_16x16x16_bf16 v[140:143], v[62:63], v[68:69], v[180:183]
  v_mfma_f32_16x16x16_bf16 v[136:139], v[80:81], v[68:69], v[100:103]
  v_mfma_f32_16x16x16_bf16 v[144:147], v[86:87], v[68:69], v[96:99]
  v_mfma_f32_16x16x16_bf16 v[148:151], v[50:51], v[56:57], v[104:107]
  v_mfma_f32_16x16x16_bf16 v[156:159], v[62:63], v[56:57], v[100:103]
  v_mfma_f32_16x16x16_bf16 v[152:155], v[80:81], v[56:57], v[152:155]
  v_mfma_f32_16x16x16_bf16 v[160:163], v[86:87], v[56:57], v[168:171]
  v_mfma_f32_16x16x16_bf16 v[164:167], v[50:51], v[44:45], v[100:103]
  v_mfma_f32_16x16x16_bf16 v[172:175], v[62:63], v[44:45], v[96:99]
  v_mfma_f32_16x16x16_bf16 v[168:171], v[80:81], v[44:45], v[168:171]
  v_mfma_f32_16x16x16_bf16 v[176:179], v[86:87], v[44:45], v[176:179]
  v_mfma_f32_16x16x32_bf16 v[132:135], v[46:49], v[64:67], v[132:135]
  v_mfma_f32_16x16x32_bf16 v[140:143], v[58:61], v[64:67], v[140:143]
  v_mfma_f32_16x16x32_bf16 v[136:139], v[76:79], v[64:67], v[136:139]
  v_mfma_f32_16x16x32_bf16 v[144:147], v[82:85], v[64:67], v[144:147]
  v_mfma_f32_16x16x32_bf16 v[148:151], v[46:49], v[52:55], v[148:151]
  v_mfma_f32_16x16x32_bf16 v[156:159], v[58:61], v[52:55], v[156:159]
  v_mfma_f32_16x16x32_bf16 v[152:155], v[76:79], v[52:55], v[152:155]
  v_mfma_f32_16x16x32_bf16 v[160:163], v[82:85], v[52:55], v[160:163]
  v_mfma_f32_16x16x32_bf16 v[164:167], v[46:49], v[40:43], v[164:167]
  v_mfma_f32_16x16x32_bf16 v[172:175], v[58:61], v[40:43], v[172:175]
  v_mfma_f32_16x16x32_bf16 v[168:171], v[76:79], v[40:43], v[168:171]
  v_mfma_f32_16x16x32_bf16 v[176:179], v[82:85], v[40:43], v[176:179]
  s_branch L_sp2
L_special:
  s_ff1_i32_b64 s44, s[100:101]
  s_bitset0_b64 s[100:101], s44
  s_nop 4
  v_cvt_pk_bf16_f32 v38, v168, v169
  v_cvt_pk_bf16_f32 v39, v170, v171
  v_mfma_f32_16x16x32_bf16 v[116:119], v[46:49], v[70:73], v[112:115]
  v_mfma_f32_16x16x32_bf16 v[124:127], v[58:61], v[70:73], v[108:111]
  v_mfma_f32_16x16x32_bf16 v[120:123], v[76:79], v[70:73], v[104:107]
  v_mfma_f32_16x16x32_bf16 v[128:131], v[82:85], v[70:73], v[100:103]
  v_mfma_f32_16x16x16_bf16 v[116:119], v[50:51], v[74:75], v[116:119]
  v_mfma_f32_16x16x16_bf16 v[124:127], v[62:63], v[74:75], v[124:127]
  v_mfma_f32_16x16x16_bf16 v[120:123], v[80:81], v[74:75], v[120:123]
  v_mfma_f32_16x16x16_bf16 v[128:131], v[86:87], v[74:75], v[128:131]
  v_mfma_f32_16x16x16_bf16 v[132:135], v[50:51], v[68:69], v[108:111]
  v_mfma_f32_16x16x16_bf16 v[140:143], v[62:63], v[68:69], v[104:107]
  v_mfma_f32_16x16x16_bf16 v[136:139], v[80:81], v[68:69], v[100:103]
  v_mfma_f32_16x16x16_bf16 v[144:147], v[86:87], v[68:69], v[96:99]
  v_mfma_f32_16x16x16_bf16 v[148:151], v[50:51], v[56:57], v[104:107]
  v_mfma_f32_16x16x16_bf16 v[156:159], v[62:63], v[56:57], v[100:103]
  v_mfma_f32_16x16x16_bf16 v[152:155], v[80:81], v[56:57], v[96:99]
  v_mfma_f32_16x16x16_bf16 v[160:163], v[86:87], v[56:57], v[92:95]
  v_mfma_f32_16x16x16_bf16 v[164:167], v[50:51], v[44:45], v[100:103]
  v_mfma_f32_16x16x16_bf16 v[172:175], v[62:63], v[44:45], v[96:99]
  v_mfma_f32_16x16x16_bf16 v[168:171], v[80:81], v[44:45], v[92:95]
  v_mfma_f32_16x16x16_bf16 v[176:179], v[86:87], v[44:45], v[88:91]
  v_mfma_f32_16x16x32_bf16 v[132:135], v[46:49], v[64:67], v[132:135]
  v_mfma_f32_16x16x32_bf16 v[140:143], v[58:61], v[64:67], v[140:143]
  v_mfma_f32_16x16x32_bf16 v[136:139], v[76:79], v[64:67], v[136:139]
  v_mfma_f32_16x16x32_bf16 v[144:147], v[82:85], v[64:67], v[144:147]
  v_mfma_f32_16x16x32_bf16 v[148:151], v[46:49], v[52:55], v[148:151]
  v_mfma_f32_16x16x32_bf16 v[156:159], v[58:61], v[52:55], v[156:159]
  v_mfma_f32_16x16x32_bf16 v[152:155], v[76:79], v[52:55], v[152:155]
  v_mfma_f32_16x16x32_bf16 v[160:163], v[82:85], v[52:55], v[160:163]
  v_mfma_f32_16x16x32_bf16 v[164:167], v[46:49], v[40:43], v[164:167]
  v_mfma_f32_16x16x32_bf16 v[172:175], v[58:61], v[40:43], v[172:175]
  v_mfma_f32_16x16x32_bf16 v[168:171], v[76:79], v[40:43], v[168:171]
  v_mfma_f32_16x16x32_bf16 v[176:179], v[82:85], v[40:43], v[176:179]
  ds_read_b128 v[64:67], v3 offset:16384
  ds_read_b128 v[68:71], v3 offset:20480
L_sp2:
  s_nop 15
  v_max_f32 v40, v164, v165
  v_max3_f32 v40, v166, v167, v40
  v_max3_f32 v40, v172, v173, v40
  v_max3_f32 v40, v174, v175, v40
  v_max3_f32 v40, v168, v169, v40
  v_max3_f32 v40, v170, v171, v40
  v_max3_f32 v40, v176, v177, v40
  v_max3_f32 v40, v178, v179, v40
  v_mov_b32 v41, v40
  s_nop 1
  v_permlane32_swap_b32 v40, v41
  v_max_f32 v40, v40, v41
  v_mov_b32 v41, v40
  s_nop 1
  v_permlane16_swap_b32 v40, v41
  v_max_f32 v40, v40, v41
  v_sub_f32 v164, v164, v40
  v_sub_f32 v165, v165, v40
  v_sub_f32 v166, v166, v40
  v_sub_f32 v167, v167, v40
  v_sub_f32 v172, v172, v40
  v_sub_f32 v173, v173, v40
  v_sub_f32 v174, v174, v40
  v_sub_f32 v175, v175, v40
  v_sub_f32 v168, v168, v40
  v_sub_f32 v169, v169, v40
  v_sub_f32 v170, v170, v40
  v_sub_f32 v171, v171, v40
  v_sub_f32 v176, v176, v40
  v_sub_f32 v177, v177, v40
  v_sub_f32 v178, v178, v40
  v_sub_f32 v179, v179, v40
  v_max_f32 v40, v148, v149
  v_max3_f32 v40, v150, v151, v40
  v_max3_f32 v40, v156, v157, v40
  v_max3_f32 v40, v158, v159, v40
  v_max3_f32 v40, v152, v153, v40
  v_max3_f32 v40, v154, v155, v40
  v_max3_f32 v40, v160, v161, v40
  v_max3_f32 v40, v162, v163, v40
  v_mov_b32 v41, v40
  s_nop 1
  v_permlane32_swap_b32 v40, v41
  v_max_f32 v40, v40, v41
  v_mov_b32 v41, v40
  s_nop 1
  v_permlane16_swap_b32 v40, v41
  v_max_f32 v40, v40, v41
  v_sub_f32 v148, v148, v40
  v_sub_f32 v149, v149, v40
  v_sub_f32 v150, v150, v40
  v_sub_f32 v151, v151, v40
  v_sub_f32 v156, v156, v40
  v_sub_f32 v157, v157, v40
  v_sub_f32 v158, v158, v40
  v_sub_f32 v159, v159, v40
  v_sub_f32 v152, v152, v40
  v_sub_f32 v153, v153, v40
  v_sub_f32 v154, v154, v40
  v_sub_f32 v155, v155, v40
  v_sub_f32 v160, v160, v40
  v_sub_f32 v161, v161, v40
  v_sub_f32 v162, v162, v40
  v_sub_f32 v163, v163, v40
  v_max_f32 v40, v132, v133
  v_max3_f32 v40, v134, v135, v40
  v_max3_f32 v40, v140, v141, v40
  v_max3_f32 v40, v142, v143, v40
  v_max3_f32 v40, v136, v137, v40
  v_max3_f32 v40, v138, v139, v40
  v_max3_f32 v40, v144, v145, v40
  v_max3_f32 v40, v146, v147, v40
  v_mov_b32 v41, v40
  s_nop 1
  v_permlane32_swap_b32 v40, v41
  v_max_f32 v40, v40, v41
  v_mov_b32 v41, v40
  s_nop 1
  v_permlane16_swap_b32 v40, v41
  v_max_f32 v40, v40, v41
  v_sub_f32 v132, v132, v40
  v_sub_f32 v133, v133, v40
  v_sub_f32 v134, v134, v40
  v_sub_f32 v135, v135, v40
  v_sub_f32 v140, v140, v40
  v_sub_f32 v141, v141, v40
  v_sub_f32 v142, v142, v40
  v_sub_f32 v143, v143, v40
  v_sub_f32 v136, v136, v40
  v_sub_f32 v137, v137, v40
  v_sub_f32 v138, v138, v40
  v_sub_f32 v139, v139, v40
  v_sub_f32 v144, v144, v40
  v_sub_f32 v145, v145, v40
  v_sub_f32 v146, v146, v40
  v_sub_f32 v147, v147, v40
  v_max_f32 v40, v116, v117
  v_max3_f32 v40, v118, v119, v40
  v_max3_f32 v40, v124, v125, v40
  v_max3_f32 v40, v126, v127, v40
  v_max3_f32 v40, v120, v121, v40
  v_max3_f32 v40, v122, v123, v40
  v_max3_f32 v40, v128, v129, v40
  v_max3_f32 v40, v130, v131, v40
  v_mov_b32 v41, v40
  s_nop 1
  v_permlane32_swap_b32 v40, v41
  v_max_f32 v40, v40, v41
  v_mov_b32 v41, v40
  s_nop 1
  v_permlane16_swap_b32 v40, v41
  v_max_f32 v40, v40, v41
  v_sub_f32 v116, v116, v40
  v_sub_f32 v117, v117, v40
  v_sub_f32 v118, v118, v40
  v_sub_f32 v119, v119, v40
  v_sub_f32 v124, v124, v40
  v_sub_f32 v125, v125, v40
  v_sub_f32 v126, v126, v40
  v_sub_f32 v127, v127, v40
  v_sub_f32 v120, v120, v40
  v_sub_f32 v121, v121, v40
  v_sub_f32 v122, v122, v40
  v_sub_f32 v123, v123, v40
  v_sub_f32 v128, v128, v40
  v_sub_f32 v129, v129, v40
  v_sub_f32 v130, v130, v40
  v_sub_f32 v131, v131, v40
  v_exp_f32 v116, v116
  v_exp_f32 v117, v117
  v_exp_f32 v118, v118
  v_exp_f32 v119, v119
  v_cvt_pk_bf16_f32 v116, v116, v117
  v_cvt_pk_bf16_f32 v117, v118, v119
  v_exp_f32 v124, v124
  v_exp_f32 v125, v125
  v_exp_f32 v126, v126
  s_waitcnt lgkmcnt(0)
  s_nop 7
  s_cmp_eq_u32 s35, 1
  s_cbranch_scc1 L_enter
  v_exp_f32 v127, v127
  v_cvt_pk_bf16_f32 v118, v124, v125
  v_cvt_pk_bf16_f32 v119, v126, v127
  v_exp_f32 v120, v120
  v_exp_f32 v121, v121
  v_exp_f32 v122, v122
  v_exp_f32 v123, v123
  v_cvt_pk_bf16_f32 v120, v120, v121
  v_cvt_pk_bf16_f32 v121, v122, v123
  v_exp_f32 v128, v128
  v_exp_f32 v129, v129
  v_exp_f32 v130, v130
  v_exp_f32 v131, v131
  v_cvt_pk_bf16_f32 v122, v128, v129
  v_cvt_pk_bf16_f32 v123, v130, v131
  v_exp_f32 v132, v132
  v_exp_f32 v133, v133
  v_exp_f32 v134, v134
  v_cvt_pk_bf16_f32 v132, v132, v133
  s_nop 7
  s_branch L_pj
L_end:
  s_endpgm
.fill (standalone__window_attn_swin__vision_kernel + 33280 - .) / 4, 4, 0xbf810000
.section .rodata,"a"
.p2align 6
.amdhsa_kernel standalone__window_attn_swin__vision_kernel
  .amdhsa_next_free_vgpr 512
  .amdhsa_next_free_sgpr 102
  .amdhsa_accum_offset 256
  .amdhsa_group_segment_fixed_size 0
  .amdhsa_kernarg_size 72
  .amdhsa_user_sgpr_count 2
  .amdhsa_user_sgpr_kernarg_segment_ptr 1
  .amdhsa_system_sgpr_workgroup_id_x 1
.end_amdhsa_kernel
```

```asm
; @launch grid=(256,1,1) block=(256,1,1) lds=163840
.amdgcn_target "amdgcn-amd-amdhsa--gfx950"
.text
.globl standalone__window_attn_swin__vision_kernel
.p2align 12
.p2align 8
.type standalone__window_attn_swin__vision_kernel,@function
standalone__window_attn_swin__vision_kernel:
  s_mov_b32 s31, 0
  s_mov_b64 s[56:57], 0
L_again:
  s_load_dwordx2 s[8:9], s[0:1], 0
  s_load_dwordx2 s[12:13], s[0:1], 8
  s_cmpk_ge_u32 s2, 256
  s_cbranch_scc1 L_end
  s_getpc_b64 s[42:43]
  s_lshr_b32 s44, s2, 3
  s_lshl_b32 s45, s44, 10
  v_lshl_add_u32 v2, v0, 2, s45
  v_mov_b32 v3, 0
  v_lshl_add_u64 v[2:3], v[2:3], 0, s[42:43]
  global_load_dword v64, v[2:3], off
  v_readfirstlane_b32 s3, v0
  s_load_dwordx2 s[20:21], s[0:1], 24
  s_mov_b32 s11, 0x20000
  s_mov_b32 s15, s11
  s_mov_b32 s14, 223232
  s_mulk_i32 s44, 6912
  v_lshlrev_b32 v26, 5, v0
  s_lshr_b32 s28, s2, 2
  s_or_b32 s28, s28, 1
  s_and_b32 s29, s2, 1
  s_sub_u32 s28, s28, s29
  s_bfe_u32 s29, s2, 0x20001
  s_lshr_b32 s4, s3, 6
  s_lshl_b32 s36, s28, 3
  v_bfe_u32 v21, v0, 3, 3
  v_add3_u32 v25, s36, 4, v21
  v_and_b32 v25, 0x1ff, v25
  v_mul_u32_u24 v25, 0x180, v25
  v_lshrrev_b32 v23, 4, v0
  v_lshrrev_b32 v24, 1, v0
  v_and_b32 v24, 4, v24
  v_bitop3_b32 v24, v24, v23, v0 bitop3:0x96
  v_and_b32 v24, 7, v24
  v_lshl_add_u32 v6, v24, 4, v25
  s_lshl3_add_u32 s36, s29, s4
  s_add_u32 s48, s36, 484
  s_add_u32 s49, s48, 4
  s_and_b32 s49, s49, 0x1ff
  s_mov_b32 s37, 196608
  s_mul_i32 s48, s48, s37
  s_mul_i32 s49, s49, s37
  s_mov_b32 s10, 100663296
  s_waitcnt lgkmcnt(0)
  s_sub_u32 s12, s12, 2048
  s_subb_u32 s13, s13, 0
  buffer_load_dword v65, v26, s[12:15], s44 offen offset:2048
  v_and_b32 v22, 4, v23
  v_and_b32 v24, 2, v21
  v_bitop3_b32 v24, v24, v22, v0 bitop3:0x96
  v_and_b32 v24, 7, v24
  v_mul_u32_u24 v25, 1152, v21
  v_lshl_add_u32 v25, v24, 4, v25
  v_add_u32 v136, 2048, v25
  v_add_u32 v137, 1152, v25
  v_add_u32 v138, 256, v25
  s_mul_i32 s62, s4, 9216
  s_mul_i32 s58, s4, 3072
  s_add_u32 s63, s58, 40960
  s_mov_b32 s22, 1800
  s_mov_b32 s23, s11
  v_lshlrev_b32 v34, 4, v0
  s_lshl_b32 s37, s4, 10
  s_add_u32 m0, s37, 24576
  v_mul_u32_u24 v35, 9, v0
  buffer_load_dwordx4 v34, s[20:23], 0 offen lds
  v_and_b32 v35, -4, v35
  s_load_dwordx2 s[16:17], s[0:1], 16
  s_load_dwordx2 s[24:25], s[0:1], 48
  s_load_dwordx2 s[20:21], s[0:1], 56
  v_and_b32 v16, 63, v0
  v_and_b32 v17, 15, v16
  v_lshrrev_b32 v18, 4, v16
  v_lshrrev_b32 v20, 2, v17
  v_and_b32 v27, 1, v18
  s_add_u32 m0, s63, 0
  s_add_u32 s36, s62, 0
  buffer_load_dwordx4 v136, s[12:15], s36 offen offset:0 lds
  v_lshrrev_b32 v28, 3, v17
  v_lshl_add_u32 v21, v27, 1, v28
  v_mul_u32_u24 v22, 3072, v18
  v_lshl_add_u32 v22, v20, 7, v22
  v_lshl_add_u32 v22, v21, 5, v22
  v_and_b32 v29, 3, v17
  v_lshl_add_u32 v22, v29, 3, v22
  s_mul_i32 s37, s4, 3
  buffer_load_dwordx4 v137, s[12:15], s36 offen offset:1024 lds
  s_and_b32 s38, s37, 3
  s_lshl_b32 s38, s38, 5
  s_lshr_b32 s39, s37, 2
  s_lshl_b32 s39, s39, 10
  s_add_u32 s39, s39, 40960
  v_xor_b32 v23, s38, v22
  v_add_u32 v12, s39, v23
  v_add_u32 v15, 73728, v12
  buffer_load_dwordx4 v138, s[12:15], s36 offen offset:2048 lds
  s_add_u32 s37, s37, 1
  s_and_b32 s38, s37, 3
  s_lshl_b32 s38, s38, 5
  s_lshr_b32 s39, s37, 2
  s_lshl_b32 s39, s39, 10
  s_add_u32 s39, s39, 40960
  s_mov_b64 exec, 0
  s_cmp_eq_u32 s4, 0
  s_cbranch_scc1 L_hop0
  s_cmp_eq_u32 s4, 1
  s_cbranch_scc1 L_hop1
  s_cmp_eq_u32 s4, 2
  s_cbranch_scc1 L_hop2
  s_branch L_hop3
L_hopped:
  s_mov_b64 exec, -1
  v_xor_b32 v23, s38, v22
  s_add_u32 m0, s63, 12288
  s_add_u32 s36, s62, 36864
  buffer_load_dwordx4 v136, s[12:15], s36 offen offset:0 lds
  v_add_u32 v13, s39, v23
  v_add_u32 v9, 73728, v13
  s_add_u32 s37, s37, 1
  s_and_b32 s38, s37, 3
  s_lshl_b32 s38, s38, 5
  s_lshr_b32 s39, s37, 2
  s_lshl_b32 s39, s39, 10
  s_add_u32 s39, s39, 40960
  buffer_load_dwordx4 v137, s[12:15], s36 offen offset:1024 lds
  v_xor_b32 v23, s38, v22
  v_add_u32 v14, s39, v23
  v_add_u32 v11, 73728, v14
  s_mov_b32 s46, 0x3e553b95
  s_mov_b32 s47, s46
  s_mov_b32 s44, 0xffff0000
  v_bfe_u32 v19, v17, 1, 3
  v_and_b32 v21, 1, v17
  buffer_load_dwordx4 v138, s[12:15], s36 offen offset:2048 lds
  v_lshlrev_b32 v21, 2, v21
  v_xor_b32 v19, v19, v21
  v_xor_b32 v21, v18, v19
  v_lshlrev_b32 v21, 4, v21
  v_lshl_add_u32 v0, v17, 7, v21
  s_lshl_b32 s32, s4, 10
  v_subrev_u32 v10, s32, v0
  v_and_b32 v21, 1, v17
  s_add_u32 m0, s63, 24576
  s_add_u32 s36, s62, 73728
  buffer_load_dwordx4 v136, s[12:15], s36 offen offset:0 lds
  v_mul_u32_u24 v21, 0xaaaa, v21
  v_add_u32 v21, 0x4444, v21
  v_lshl_add_u32 v10, v10, 16, v21
  v_xor_b32 v1, 64, v0
  v_lshlrev_b32 v22, 4, v17
  v_lshl_add_u32 v23, v18, 10, v22
  s_and_b32 s5, s4, 1
  s_lshl_b32 s37, s5, 9
  s_add_u32 s38, s37, 114688
  v_add_u32 v3, s38, v23
  s_sub_u32 s38, 114688, s37
  v_add_u32 v2, s38, v23
  s_lshl_b32 s37, s4, 12
  s_add_u32 s37, s37, 90112
  v_add_u32 v4, s37, v23
  s_lshl_b32 s37, s4, 11
  s_add_u32 s37, s37, 106496
  v_lshrrev_b32 v23, 1, v18
  v_lshl_add_u32 v24, v23, 10, v22
  v_lshl_add_u32 v24, v27, 3, v24
  v_add_u32 v5, s37, v24
  s_mov_b32 s7, 24576
  v_sub_u32 v24, v28, v23
  v_mul_i32_i24 v24, 15, v24
  v_and_b32 v26, 7, v17
  v_lshlrev_b32 v25, 2, v27
  v_sub_u32 v30, v26, v25
  v_add3_u32 v24, v24, v30, 19
  s_lshl_b32 s37, s4, 1
  s_and_b32 s37, s37, 0
  s_waitcnt lgkmcnt(0)
  s_mov_b32 s18, 73728
  s_mov_b32 s19, s11
  s_mul_i32 s60, s4, 0x02020000
  s_add_u32 s60, s60, 0x01000c0c
  s_add_u32 s37, s37, 24576
  v_lshl_add_u32 v144, v24, 3, s37
  v_add_u32 v145, 960, v144
  s_lshl_b32 s37, s28, 3
  v_add3_u32 v24, s37, 4, v26
  v_and_b32 v24, 0x1ff, v24
  v_mul_u32_u24 v24, 0x180, v24
  v_mul_u32_u24 v26, 196608, v28
  v_add_u32 v24, v24, v26
  v_lshl_add_u32 v24, v18, 4, v24
  s_lshr_b32 s37, s4, 1
  s_lshl_b32 s38, s37, 6
  s_add_u32 s39, s38, 256
  v_add_u32 v8, s39, v24
  s_lshl_b32 s39, s5, 7
  s_add_u32 s38, s38, s39
  v_add_u32 v7, s38, v24
  v_and_b32 v24, 16, v16
  v_lshlrev_b32 v24, 2, v24
  v_lshlrev_b32 v26, 4, v16
  v_xor_b32 v24, v24, v26
  v_accvgpr_write_b32 a228, v24
  v_add_u32 v30, v25, v20
  v_mul_u32_u24 v31, 3072, v23
  v_lshl_add_u32 v31, v29, 4, v31
  v_mad_u32_u24 v32, v30, 3, s5
  v_lshrrev_b32 v33, 1, v32
  v_xor_b32 v33, s37, v33
  v_and_b32 v33, 1, v33
  v_lshl_add_u32 v32, v32, 1, v33
  buffer_load_dwordx4 v137, s[12:15], s36 offen offset:1024 lds
  v_lshl_add_u32 v32, v32, 6, v31
  v_add_u32 v32, 114688, v32
  v_accvgpr_write_b32 a229, v32
  v_mad_u32_u24 v32, v30, 3, 2
  v_lshrrev_b32 v33, 1, v32
  v_xor_b32 v33, s37, v33
  v_and_b32 v33, 1, v33
  v_lshl_add_u32 v32, v32, 1, v33
  v_lshl_add_u32 v32, v32, 6, v31
  v_add_u32 v32, 114688, v32
  v_accvgpr_write_b32 a230, v32
  v_mul_u32_u24 v31, 3072, v18
  buffer_load_dwordx4 v138, s[12:15], s36 offen offset:2048 lds
  v_lshl_add_u32 v31, v29, 4, v31
  v_mad_u32_u24 v32, v20, 3, s5
  v_lshrrev_b32 v33, 1, v32
  v_xor_b32 v33, s37, v33
  v_and_b32 v33, 1, v33
  v_lshl_add_u32 v32, v32, 1, v33
  v_lshl_add_u32 v32, v32, 6, v31
  v_accvgpr_write_b32 a231, v32
  v_mad_u32_u24 v32, v20, 3, 2
  v_lshrrev_b32 v33, 1, v32
  v_xor_b32 v33, s37, v33
  v_and_b32 v33, 1, v33
  s_add_u32 m0, s63, 36864
  s_add_u32 s36, s62, 110592
  buffer_load_dwordx4 v136, s[12:15], s36 offen offset:0 lds
  v_lshl_add_u32 v32, v32, 1, v33
  v_lshl_add_u32 v32, v32, 6, v31
  v_accvgpr_write_b32 a232, v32
  s_mul_i32 s59, s37, 12288
  s_add_u32 s59, s59, s58
  v_cmp_gt_u32 vcc, 2, v29
  v_mov_b32 v31, 0x3f803f80
  s_mov_b32 s26, 100663296
  s_mov_b32 s27, s11
  v_cndmask_b32 v31, 0, v31, vcc
  v_accvgpr_write_b32 a240, v31
  v_accvgpr_write_b32 a241, v31
  buffer_load_dwordx4 v137, s[12:15], s36 offen offset:1024 lds
  v_accvgpr_write_b32 a242, v31
  v_accvgpr_write_b32 a243, v31
  v_lshrrev_b32 v150, 2, v16
  v_xor_b32 v151, v16, v150
  s_cmp_eq_u32 s28, 63
  s_cselect_b32 s37, 4, 0
  v_and_b32 v151, s37, v151
  v_cmp_eq_u32 vcc, 0, v151
  s_cmp_eq_u32 s29, 3
  s_cselect_b32 s37, 0xc31044fe, 0
  v_mov_b32 v150, s37
  v_mov_b32 v149, 0xc31044fe
  buffer_load_dwordx4 v138, s[12:15], s36 offen offset:2048 lds
  v_cndmask_b32 v151, 0, v150, vcc
  s_waitcnt vmcnt(12)
  s_barrier
  ds_read_b64 v[156:157], v144 offset:24
  v_cndmask_b32 v150, v149, 0, vcc
  ds_read_b64 v[158:159], v144 offset:16
  s_mov_b32 s45, 0x3fb8aa3b
  ds_read_b64 v[152:153], v144 offset:8
  s_lshl_b32 s37, s29, 3
  ds_read_b64 v[154:155], v144 offset:0
  s_lshl_b32 s38, s5, 2
  s_add_u32 m0, s63, 49152
  s_add_u32 s36, s62, 147456
  buffer_load_dwordx4 v136, s[12:15], s36 offen offset:0 lds
  s_xor_b32 s39, s38, 0
  ds_read_b64 v[160:161], v144 offset:264
  s_add_u32 s40, s39, s37
  ds_read_b64 v[162:163], v144 offset:256
  s_add_u32 s40, s40, 484
  ds_read_b64 v[164:165], v144 offset:248
  s_and_b32 s40, s40, 0x1ff
  s_mul_i32 s40, s40, 196608
  ds_read_b64 v[166:167], v144 offset:240
  s_sub_u32 s39, s39, s4
  ds_read_b64 v[172:173], v144 offset:504
  s_mul_i32 s52, s39, 196608
  buffer_load_dwordx4 v137, s[12:15], s36 offen offset:1024 lds
  ds_read_b64 v[174:175], v144 offset:496
  s_xor_b32 s39, s38, 2
  ds_read_b64 v[168:169], v144 offset:488
  s_add_u32 s41, s39, s37
  s_add_u32 s41, s41, 484
  ds_read_b64 v[170:171], v144 offset:480
  s_and_b32 s41, s41, 0x1ff
  ds_read_b64 v[176:177], v144 offset:744
  s_mul_i32 s41, s41, 196608
  ds_read_b64 v[178:179], v144 offset:736
  s_sub_u32 s39, s39, s4
  s_mul_i32 s53, s39, 196608
  buffer_load_dwordx4 v138, s[12:15], s36 offen offset:2048 lds
  ds_read_b64 v[180:181], v144 offset:728
  s_xor_b32 s39, s38, 4
  ds_read_b64 v[182:183], v144 offset:720
  s_add_u32 s42, s39, s37
  ds_read_b64 v[116:117], v144 offset:984
  s_add_u32 s42, s42, 484
  ds_read_b64 v[118:119], v144 offset:976
  s_and_b32 s42, s42, 0x1ff
  s_mul_i32 s42, s42, 196608
  ds_read_b64 v[124:125], v144 offset:968
  s_sub_u32 s39, s39, s4
  ds_read_b64 v[126:127], v144 offset:960
  s_add_u32 m0, s63, 61440
  s_add_u32 s36, s62, 184320
  buffer_load_dwordx4 v136, s[12:15], s36 offen offset:0 lds
  s_mul_i32 s54, s39, 196608
  ds_read_b64 v[120:121], v144 offset:1224
  s_xor_b32 s39, s38, 6
  s_add_u32 s43, s39, s37
  ds_read_b64 v[122:123], v144 offset:1216
  s_add_u32 s43, s43, 484
  ds_read_b64 v[128:129], v144 offset:1208
  s_and_b32 s43, s43, 0x1ff
  ds_read_b64 v[130:131], v144 offset:1200
  s_mul_i32 s43, s43, 196608
  ds_read_b64 v[132:133], v144 offset:1464
  s_sub_u32 s39, s39, s4
  buffer_load_dwordx4 v137, s[12:15], s36 offen offset:1024 lds
  s_mul_i32 s55, s39, 196608
  ds_read_b64 v[134:135], v144 offset:1456
  s_mul_i32 s34, s32, 3
  ds_read_b64 v[140:141], v144 offset:1448
  s_add_u32 s34, s34, 106496
  ds_read_b64 v[142:143], v144 offset:1440
  s_mov_b32 s35, 1
  s_mov_b32 s30, 1
  s_waitcnt vmcnt(11)
  s_barrier
  ds_read_b64_tr_b16 v[184:185], v12 offset:0
  ds_read_b64_tr_b16 v[186:187], v12 offset:512
  buffer_load_dwordx4 v138, s[12:15], s36 offen offset:2048 lds
  ds_read_b64_tr_b16 v[188:189], v13 offset:0
  ds_read_b64_tr_b16 v[190:191], v13 offset:512
  ds_read_b64_tr_b16 v[192:193], v14 offset:0
  ds_read_b64_tr_b16 v[194:195], v14 offset:512
  ds_read_b64_tr_b16 v[196:197], v12 offset:12288
  ds_read_b64_tr_b16 v[198:199], v12 offset:12800
  ds_read_b64_tr_b16 v[200:201], v13 offset:12288
  ds_read_b64_tr_b16 v[202:203], v13 offset:12800
  ds_read_b64_tr_b16 v[204:205], v14 offset:12288
  ds_read_b64_tr_b16 v[206:207], v14 offset:12800
  s_waitcnt lgkmcnt(12)
  v_perm_b32 v88, v157, v156, s60
  s_lshl_b32 m0, s3, 4
  s_nop 0
  buffer_load_dwordx4 v6, s[8:11], s48 offen offset:0 nt lds
  v_perm_b32 v89, v159, v158, s60
  v_perm_b32 v90, v153, v152, s60
  v_perm_b32 v91, v155, v154, s60
  v_perm_b32 v92, v161, v160, s60
  v_perm_b32 v93, v163, v162, s60
  v_perm_b32 v94, v165, v164, s60
  v_perm_b32 v95, v167, v166, s60
  v_perm_b32 v96, v173, v172, s60
  v_perm_b32 v97, v175, v174, s60
  v_perm_b32 v98, v169, v168, s60
  v_perm_b32 v99, v171, v170, s60
  v_perm_b32 v100, v177, v176, s60
  s_addk_i32 m0, 8064
  s_nop 0
  buffer_load_dwordx4 v6, s[8:11], s48 offen offset:128 nt lds
  v_perm_b32 v101, v179, v178, s60
  v_perm_b32 v102, v181, v180, s60
  v_perm_b32 v103, v183, v182, s60
  v_perm_b32 v104, v117, v116, s60
  v_perm_b32 v105, v119, v118, s60
  v_perm_b32 v106, v125, v124, s60
  v_perm_b32 v107, v127, v126, s60
  v_perm_b32 v108, v121, v120, s60
  v_perm_b32 v109, v123, v122, s60
  v_perm_b32 v110, v129, v128, s60
  v_perm_b32 v111, v131, v130, s60
  v_perm_b32 v112, v133, v132, s60
  s_addk_i32 m0, 8064
  s_nop 0
  buffer_load_dwordx4 v6, s[8:11], s48 offen offset:256 nt lds
  v_perm_b32 v113, v135, v134, s60
  v_perm_b32 v114, v141, v140, s60
  v_perm_b32 v115, v143, v142, s60
  s_waitcnt lgkmcnt(10)
  v_lshlrev_b32 v40, 16, v184
  v_and_b32 v41, s44, v184
  v_lshlrev_b32 v42, 16, v185
  v_and_b32 v43, s44, v185
  v_lshlrev_b32 v44, 16, v186
  v_and_b32 v45, s44, v186
  v_lshlrev_b32 v46, 16, v187
  v_and_b32 v47, s44, v187
  s_lshl_b32 m0, s3, 4
  s_addk_i32 m0, 4096
  s_nop 0
  buffer_load_dwordx4 v6, s[8:11], s49 offen offset:0 nt lds
  v_pk_mul_f32 v[40:41], v[40:41], s[46:47]
  v_pk_mul_f32 v[42:43], v[42:43], s[46:47]
  v_pk_mul_f32 v[44:45], v[44:45], s[46:47]
  v_pk_mul_f32 v[46:47], v[46:47], s[46:47]
  v_cvt_pk_bf16_f32 v184, v40, v41
  v_cvt_pk_bf16_f32 v185, v42, v43
  v_cvt_pk_bf16_f32 v186, v44, v45
  s_waitcnt lgkmcnt(0)
  v_cvt_pk_bf16_f32 v187, v46, v47
  v_lshlrev_b32 v48, 16, v188
  v_and_b32 v49, s44, v188
  v_lshlrev_b32 v50, 16, v189
  s_addk_i32 m0, 8064
  s_nop 0
  buffer_load_dwordx4 v6, s[8:11], s49 offen offset:128 nt lds
  v_and_b32 v51, s44, v189
  v_lshlrev_b32 v52, 16, v190
  v_and_b32 v53, s44, v190
  v_lshlrev_b32 v54, 16, v191
  v_and_b32 v55, s44, v191
  v_pk_mul_f32 v[48:49], v[48:49], s[46:47]
  v_pk_mul_f32 v[50:51], v[50:51], s[46:47]
  v_pk_mul_f32 v[52:53], v[52:53], s[46:47]
  v_pk_mul_f32 v[54:55], v[54:55], s[46:47]
  v_cvt_pk_bf16_f32 v188, v48, v49
  v_cvt_pk_bf16_f32 v189, v50, v51
  v_cvt_pk_bf16_f32 v190, v52, v53
  s_addk_i32 m0, 8064
  s_nop 0
  buffer_load_dwordx4 v6, s[8:11], s49 offen offset:256 nt lds
  v_cvt_pk_bf16_f32 v191, v54, v55
  v_lshlrev_b32 v56, 16, v192
  v_and_b32 v57, s44, v192
  v_lshlrev_b32 v58, 16, v193
  v_and_b32 v59, s44, v193
  v_lshlrev_b32 v60, 16, v194
  v_and_b32 v61, s44, v194
  v_lshlrev_b32 v62, 16, v195
  v_and_b32 v63, s44, v195
  v_pk_mul_f32 v[56:57], v[56:57], s[46:47]
  v_pk_mul_f32 v[58:59], v[58:59], s[46:47]
  v_pk_mul_f32 v[60:61], v[60:61], s[46:47]
  s_lshr_b32 s36, s2, 3
  s_mulk_i32 s36, 2304
  buffer_load_dword v66, v35, s[16:19], s36 offen
  v_pk_mul_f32 v[62:63], v[62:63], s[46:47]
  v_cvt_pk_bf16_f32 v192, v56, v57
  v_cvt_pk_bf16_f32 v193, v58, v59
  v_cvt_pk_bf16_f32 v194, v60, v61
  v_cvt_pk_bf16_f32 v195, v62, v63
  v_lshlrev_b32 v40, 16, v196
  v_and_b32 v41, s44, v196
  v_lshlrev_b32 v42, 16, v197
  v_and_b32 v43, s44, v197
  v_lshlrev_b32 v44, 16, v198
  v_and_b32 v45, s44, v198
  v_lshlrev_b32 v46, 16, v199
  v_and_b32 v47, s44, v199
  v_pk_mul_f32 v[40:41], v[40:41], s[46:47]
  v_pk_mul_f32 v[42:43], v[42:43], s[46:47]
  v_pk_mul_f32 v[44:45], v[44:45], s[46:47]
  v_pk_mul_f32 v[46:47], v[46:47], s[46:47]
  v_cvt_pk_bf16_f32 v196, v40, v41
  v_cvt_pk_bf16_f32 v197, v42, v43
  v_cvt_pk_bf16_f32 v198, v44, v45
  v_cvt_pk_bf16_f32 v199, v46, v47
  v_lshlrev_b32 v48, 16, v200
  v_and_b32 v49, s44, v200
  v_lshlrev_b32 v50, 16, v201
  v_and_b32 v51, s44, v201
  v_lshlrev_b32 v52, 16, v202
  v_and_b32 v53, s44, v202
  v_lshlrev_b32 v54, 16, v203
  v_and_b32 v55, s44, v203
  v_pk_mul_f32 v[48:49], v[48:49], s[46:47]
  v_pk_mul_f32 v[50:51], v[50:51], s[46:47]
  v_pk_mul_f32 v[52:53], v[52:53], s[46:47]
  v_pk_mul_f32 v[54:55], v[54:55], s[46:47]
  v_cvt_pk_bf16_f32 v200, v48, v49
  v_cvt_pk_bf16_f32 v201, v50, v51
  v_cvt_pk_bf16_f32 v202, v52, v53
  v_cvt_pk_bf16_f32 v203, v54, v55
  v_lshlrev_b32 v56, 16, v204
  v_and_b32 v57, s44, v204
  v_lshlrev_b32 v58, 16, v205
  v_and_b32 v59, s44, v205
  v_lshlrev_b32 v60, 16, v206
  v_and_b32 v61, s44, v206
  v_lshlrev_b32 v62, 16, v207
  v_and_b32 v63, s44, v207
  v_pk_mul_f32 v[56:57], v[56:57], s[46:47]
  v_pk_mul_f32 v[58:59], v[58:59], s[46:47]
  v_pk_mul_f32 v[60:61], v[60:61], s[46:47]
  v_pk_mul_f32 v[62:63], v[62:63], s[46:47]
  v_cvt_pk_bf16_f32 v204, v56, v57
  v_cvt_pk_bf16_f32 v205, v58, v59
  v_cvt_pk_bf16_f32 v206, v60, v61
  v_cvt_pk_bf16_f32 v207, v62, v63
  s_waitcnt vmcnt(13)
  s_barrier
  ds_read_b64_tr_b16 v[208:209], v12 offset:24576
  ds_read_b64_tr_b16 v[210:211], v12 offset:25088
  ds_read_b64_tr_b16 v[212:213], v13 offset:24576
  ds_read_b64_tr_b16 v[214:215], v13 offset:25088
  ds_read_b64_tr_b16 v[216:217], v14 offset:24576
  ds_read_b64_tr_b16 v[218:219], v14 offset:25088
  ds_read_b64_tr_b16 v[220:221], v12 offset:36864
  ds_read_b64_tr_b16 v[222:223], v12 offset:37376
  ds_read_b64_tr_b16 v[224:225], v13 offset:36864
  ds_read_b64_tr_b16 v[226:227], v13 offset:37376
  ds_read_b64_tr_b16 v[228:229], v14 offset:36864
  ds_read_b64_tr_b16 v[230:231], v14 offset:37376
  s_waitcnt lgkmcnt(10)
  v_lshlrev_b32 v40, 16, v208
  v_and_b32 v41, s44, v208
  v_lshlrev_b32 v42, 16, v209
  v_and_b32 v43, s44, v209
  v_lshlrev_b32 v44, 16, v210
  v_and_b32 v45, s44, v210
  v_lshlrev_b32 v46, 16, v211
  v_and_b32 v47, s44, v211
  v_pk_mul_f32 v[40:41], v[40:41], s[46:47]
  v_pk_mul_f32 v[42:43], v[42:43], s[46:47]
  v_pk_mul_f32 v[44:45], v[44:45], s[46:47]
  v_pk_mul_f32 v[46:47], v[46:47], s[46:47]
  v_cvt_pk_bf16_f32 v208, v40, v41
  v_cvt_pk_bf16_f32 v209, v42, v43
  v_cvt_pk_bf16_f32 v210, v44, v45
L_hop0:
  s_cbranch_execz L_hopped
  s_waitcnt lgkmcnt(0)
  v_cvt_pk_bf16_f32 v211, v46, v47
  v_lshlrev_b32 v48, 16, v212
  v_and_b32 v49, s44, v212
  v_lshlrev_b32 v50, 16, v213
  v_and_b32 v51, s44, v213
  v_lshlrev_b32 v52, 16, v214
  v_and_b32 v53, s44, v214
  v_lshlrev_b32 v54, 16, v215
  v_and_b32 v55, s44, v215
  v_pk_mul_f32 v[48:49], v[48:49], s[46:47]
  v_pk_mul_f32 v[50:51], v[50:51], s[46:47]
  v_pk_mul_f32 v[52:53], v[52:53], s[46:47]
  v_pk_mul_f32 v[54:55], v[54:55], s[46:47]
  v_cvt_pk_bf16_f32 v212, v48, v49
  v_cvt_pk_bf16_f32 v213, v50, v51
  v_cvt_pk_bf16_f32 v214, v52, v53
  v_cvt_pk_bf16_f32 v215, v54, v55
  v_lshlrev_b32 v56, 16, v216
  v_and_b32 v57, s44, v216
  v_lshlrev_b32 v58, 16, v217
  v_and_b32 v59, s44, v217
  v_lshlrev_b32 v60, 16, v218
  v_and_b32 v61, s44, v218
  v_lshlrev_b32 v62, 16, v219
  v_and_b32 v63, s44, v219
  v_pk_mul_f32 v[56:57], v[56:57], s[46:47]
  v_pk_mul_f32 v[58:59], v[58:59], s[46:47]
  v_pk_mul_f32 v[60:61], v[60:61], s[46:47]
  v_pk_mul_f32 v[62:63], v[62:63], s[46:47]
  v_cvt_pk_bf16_f32 v216, v56, v57
  v_cvt_pk_bf16_f32 v217, v58, v59
  v_cvt_pk_bf16_f32 v218, v60, v61
  v_cvt_pk_bf16_f32 v219, v62, v63
  v_lshlrev_b32 v40, 16, v220
  v_and_b32 v41, s44, v220
  v_lshlrev_b32 v42, 16, v221
  v_and_b32 v43, s44, v221
  v_lshlrev_b32 v44, 16, v222
  v_and_b32 v45, s44, v222
  v_lshlrev_b32 v46, 16, v223
  v_and_b32 v47, s44, v223
  v_pk_mul_f32 v[40:41], v[40:41], s[46:47]
  v_pk_mul_f32 v[42:43], v[42:43], s[46:47]
  v_pk_mul_f32 v[44:45], v[44:45], s[46:47]
  v_pk_mul_f32 v[46:47], v[46:47], s[46:47]
  v_cvt_pk_bf16_f32 v220, v40, v41
  v_cvt_pk_bf16_f32 v221, v42, v43
  v_cvt_pk_bf16_f32 v222, v44, v45
  v_cvt_pk_bf16_f32 v223, v46, v47
  v_lshlrev_b32 v48, 16, v224
  v_and_b32 v49, s44, v224
  v_lshlrev_b32 v50, 16, v225
  v_and_b32 v51, s44, v225
  v_lshlrev_b32 v52, 16, v226
  v_and_b32 v53, s44, v226
  v_lshlrev_b32 v54, 16, v227
  v_and_b32 v55, s44, v227
  v_pk_mul_f32 v[48:49], v[48:49], s[46:47]
  v_pk_mul_f32 v[50:51], v[50:51], s[46:47]
  v_pk_mul_f32 v[52:53], v[52:53], s[46:47]
  v_pk_mul_f32 v[54:55], v[54:55], s[46:47]
  v_cvt_pk_bf16_f32 v224, v48, v49
  v_cvt_pk_bf16_f32 v225, v50, v51
  v_cvt_pk_bf16_f32 v226, v52, v53
  v_cvt_pk_bf16_f32 v227, v54, v55
  v_lshlrev_b32 v56, 16, v228
  v_and_b32 v57, s44, v228
  v_lshlrev_b32 v58, 16, v229
  v_and_b32 v59, s44, v229
  v_lshlrev_b32 v60, 16, v230
  v_and_b32 v61, s44, v230
  v_lshlrev_b32 v62, 16, v231
  v_and_b32 v63, s44, v231
  s_add_u32 m0, s63, 73728
  s_add_u32 s36, s62, 384
  buffer_load_dwordx4 v136, s[12:15], s36 offen offset:0 lds
  v_pk_mul_f32 v[56:57], v[56:57], s[46:47]
  v_pk_mul_f32 v[58:59], v[58:59], s[46:47]
  v_pk_mul_f32 v[60:61], v[60:61], s[46:47]
  v_pk_mul_f32 v[62:63], v[62:63], s[46:47]
  v_cvt_pk_bf16_f32 v228, v56, v57
  v_cvt_pk_bf16_f32 v229, v58, v59
  v_cvt_pk_bf16_f32 v230, v60, v61
  v_cvt_pk_bf16_f32 v231, v62, v63
  s_waitcnt vmcnt(8)
  s_barrier
  ds_read_b64_tr_b16 v[232:233], v12 offset:49152
  ds_read_b64_tr_b16 v[234:235], v12 offset:49664
  ds_read_b64_tr_b16 v[236:237], v13 offset:49152
  ds_read_b64_tr_b16 v[238:239], v13 offset:49664
  ds_read_b64_tr_b16 v[240:241], v14 offset:49152
  ds_read_b64_tr_b16 v[242:243], v14 offset:49664
  ds_read_b64_tr_b16 v[244:245], v12 offset:61440
  ds_read_b64_tr_b16 v[246:247], v12 offset:61952
  ds_read_b64_tr_b16 v[248:249], v13 offset:61440
  ds_read_b64_tr_b16 v[250:251], v13 offset:61952
  buffer_load_dwordx4 v137, s[12:15], s36 offen offset:1024 lds
  ds_read_b64_tr_b16 v[252:253], v14 offset:61440
  ds_read_b64_tr_b16 v[254:255], v14 offset:61952
  s_waitcnt lgkmcnt(10)
  v_lshlrev_b32 v40, 16, v232
  v_and_b32 v41, s44, v232
  v_lshlrev_b32 v42, 16, v233
  v_and_b32 v43, s44, v233
  v_lshlrev_b32 v44, 16, v234
  v_and_b32 v45, s44, v234
  v_lshlrev_b32 v46, 16, v235
  v_and_b32 v47, s44, v235
  v_pk_mul_f32 v[40:41], v[40:41], s[46:47]
  v_pk_mul_f32 v[42:43], v[42:43], s[46:47]
  v_pk_mul_f32 v[44:45], v[44:45], s[46:47]
  v_pk_mul_f32 v[46:47], v[46:47], s[46:47]
  v_cvt_pk_bf16_f32 v232, v40, v41
  v_cvt_pk_bf16_f32 v233, v42, v43
  v_cvt_pk_bf16_f32 v234, v44, v45
  s_waitcnt lgkmcnt(0)
  v_cvt_pk_bf16_f32 v235, v46, v47
  buffer_load_dwordx4 v138, s[12:15], s36 offen offset:2048 lds
  v_lshlrev_b32 v48, 16, v236
  v_and_b32 v49, s44, v236
  v_lshlrev_b32 v50, 16, v237
  v_and_b32 v51, s44, v237
  v_lshlrev_b32 v52, 16, v238
  v_and_b32 v53, s44, v238
  v_lshlrev_b32 v54, 16, v239
  v_and_b32 v55, s44, v239
  v_pk_mul_f32 v[48:49], v[48:49], s[46:47]
  v_pk_mul_f32 v[50:51], v[50:51], s[46:47]
  v_pk_mul_f32 v[52:53], v[52:53], s[46:47]
  v_pk_mul_f32 v[54:55], v[54:55], s[46:47]
  v_cvt_pk_bf16_f32 v236, v48, v49
  v_cvt_pk_bf16_f32 v237, v50, v51
  v_cvt_pk_bf16_f32 v238, v52, v53
  v_cvt_pk_bf16_f32 v239, v54, v55
  v_lshlrev_b32 v56, 16, v240
  v_and_b32 v57, s44, v240
  v_lshlrev_b32 v58, 16, v241
  v_and_b32 v59, s44, v241
  s_add_u32 m0, s63, 86016
  s_add_u32 s36, s62, 37248
  buffer_load_dwordx4 v136, s[12:15], s36 offen offset:0 lds
  v_lshlrev_b32 v60, 16, v242
  v_and_b32 v61, s44, v242
  v_lshlrev_b32 v62, 16, v243
  v_and_b32 v63, s44, v243
  v_pk_mul_f32 v[56:57], v[56:57], s[46:47]
  v_pk_mul_f32 v[58:59], v[58:59], s[46:47]
  v_pk_mul_f32 v[60:61], v[60:61], s[46:47]
  v_pk_mul_f32 v[62:63], v[62:63], s[46:47]
  v_cvt_pk_bf16_f32 v240, v56, v57
  v_cvt_pk_bf16_f32 v241, v58, v59
  v_cvt_pk_bf16_f32 v242, v60, v61
  v_cvt_pk_bf16_f32 v243, v62, v63
  v_lshlrev_b32 v40, 16, v244
  v_and_b32 v41, s44, v244
  v_lshlrev_b32 v42, 16, v245
  v_and_b32 v43, s44, v245
  v_lshlrev_b32 v44, 16, v246
  v_and_b32 v45, s44, v246
  v_lshlrev_b32 v46, 16, v247
  v_and_b32 v47, s44, v247
  buffer_load_dwordx4 v137, s[12:15], s36 offen offset:1024 lds
  v_pk_mul_f32 v[40:41], v[40:41], s[46:47]
  v_pk_mul_f32 v[42:43], v[42:43], s[46:47]
  v_pk_mul_f32 v[44:45], v[44:45], s[46:47]
  v_pk_mul_f32 v[46:47], v[46:47], s[46:47]
  v_cvt_pk_bf16_f32 v244, v40, v41
  v_cvt_pk_bf16_f32 v245, v42, v43
  v_cvt_pk_bf16_f32 v246, v44, v45
  v_cvt_pk_bf16_f32 v247, v46, v47
  v_lshlrev_b32 v48, 16, v248
  v_and_b32 v49, s44, v248
  v_lshlrev_b32 v50, 16, v249
  v_and_b32 v51, s44, v249
  v_lshlrev_b32 v52, 16, v250
  v_and_b32 v53, s44, v250
  v_lshlrev_b32 v54, 16, v251
  v_and_b32 v55, s44, v251
  v_pk_mul_f32 v[48:49], v[48:49], s[46:47]
  v_pk_mul_f32 v[50:51], v[50:51], s[46:47]
  v_pk_mul_f32 v[52:53], v[52:53], s[46:47]
  v_pk_mul_f32 v[54:55], v[54:55], s[46:47]
  buffer_load_dwordx4 v138, s[12:15], s36 offen offset:2048 lds
  v_cvt_pk_bf16_f32 v248, v48, v49
  v_cvt_pk_bf16_f32 v249, v50, v51
  v_cvt_pk_bf16_f32 v250, v52, v53
  v_cvt_pk_bf16_f32 v251, v54, v55
  v_lshlrev_b32 v56, 16, v252
  v_and_b32 v57, s44, v252
  v_lshlrev_b32 v58, 16, v253
  v_and_b32 v59, s44, v253
  v_lshlrev_b32 v60, 16, v254
  v_and_b32 v61, s44, v254
  v_lshlrev_b32 v62, 16, v255
  v_and_b32 v63, s44, v255
  v_pk_mul_f32 v[56:57], v[56:57], s[46:47]
  v_pk_mul_f32 v[58:59], v[58:59], s[46:47]
  v_pk_mul_f32 v[60:61], v[60:61], s[46:47]
  v_pk_mul_f32 v[62:63], v[62:63], s[46:47]
  v_cvt_pk_bf16_f32 v252, v56, v57
  v_cvt_pk_bf16_f32 v253, v58, v59
  v_cvt_pk_bf16_f32 v254, v60, v61
  v_cvt_pk_bf16_f32 v255, v62, v63
  s_lshl3_add_u32 s48, s29, s4
  s_add_u32 s48, s48, 4
  s_mul_i32 s48, s48, 196608
  s_add_u32 s49, s48, 786432
  s_add_u32 s50, s48, 100663296
  s_mov_b32 s10, 95158272
  s_waitcnt vmcnt(10)
  s_barrier
  ds_read_b128 a[144:147], v0 offset:0
  ds_read_b128 a[148:151], v1 offset:0
  ds_read_b128 a[152:155], v0 offset:8192
  ds_read_b128 a[156:159], v1 offset:8192
  ds_read_b128 a[160:163], v0 offset:16384
  ds_read_b128 a[164:167], v1 offset:16384
  s_waitcnt lgkmcnt(4)
  v_mfma_f32_16x16x32_bf16 v[164:167], v[184:187], a[144:147], 0
  v_mfma_f32_16x16x32_bf16 v[164:167], v[196:199], a[148:151], v[164:167]
  s_waitcnt lgkmcnt(0)
  v_mfma_f32_16x16x32_bf16 v[164:167], v[208:211], a[152:155], v[164:167]
  s_add_u32 m0, s63, 98304
  s_add_u32 s36, s62, 74112
  v_mfma_f32_16x16x32_bf16 v[164:167], v[220:223], a[156:159], v[164:167]
  buffer_load_dwordx4 v136, s[12:15], s36 offen offset:0 lds
  v_mfma_f32_16x16x32_bf16 v[164:167], v[232:235], a[160:163], v[164:167]
  v_fma_f32 v88, v88, s45, v150
  v_fma_f32 v89, v89, s45, v150
  v_mfma_f32_16x16x32_bf16 v[164:167], v[244:247], a[164:167], v[164:167]
  ds_read_b128 a[168:171], v0 offset:2048
  ds_read_b128 a[172:175], v1 offset:2048
  v_mfma_f32_16x16x32_bf16 v[172:175], v[248:251], a[164:167], 0
  ds_read_b128 a[176:179], v0 offset:10240
  ds_read_b128 a[180:183], v1 offset:10240
  v_mfma_f32_16x16x32_bf16 v[172:175], v[236:239], a[160:163], v[172:175]
  ds_read_b128 a[184:187], v0 offset:18432
  ds_read_b128 a[188:191], v1 offset:18432
  v_mfma_f32_16x16x32_bf16 v[172:175], v[224:227], a[156:159], v[172:175]
  v_cvt_pk_bf16_f32 v40, v164, v165
  v_cvt_pk_bf16_f32 v41, v166, v167
  v_mfma_f32_16x16x32_bf16 v[172:175], v[212:215], a[152:155], v[172:175]
  buffer_load_dwordx4 v137, s[12:15], s36 offen offset:1024 lds
  v_mfma_f32_16x16x32_bf16 v[172:175], v[200:203], a[148:151], v[172:175]
  buffer_load_dwordx4 v138, s[12:15], s36 offen offset:2048 lds
  v_mfma_f32_16x16x32_bf16 v[172:175], v[188:191], a[144:147], v[172:175]
  v_fma_f32 v90, v90, s45, v150
  v_fma_f32 v91, v91, s45, v150
  v_mfma_f32_16x16x32_bf16 v[164:167], v[192:195], a[144:147], 0
  s_add_u32 m0, s63, 110592
  s_add_u32 s36, s62, 110976
  v_mfma_f32_16x16x32_bf16 v[164:167], v[204:207], a[148:151], v[164:167]
  buffer_load_dwordx4 v136, s[12:15], s36 offen offset:0 lds
  v_mfma_f32_16x16x32_bf16 v[164:167], v[216:219], a[152:155], v[164:167]
  v_cvt_pk_bf16_f32 v42, v172, v173
  v_cvt_pk_bf16_f32 v43, v174, v175
  v_mfma_f32_16x16x32_bf16 v[164:167], v[228:231], a[156:159], v[164:167]
  v_fma_f32 v92, v92, s45, v150
  v_fma_f32 v93, v93, s45, v150
  v_mfma_f32_16x16x32_bf16 v[164:167], v[240:243], a[160:163], v[164:167]
  v_fma_f32 v94, v94, s45, v150
  v_fma_f32 v95, v95, s45, v150
  v_mfma_f32_16x16x32_bf16 v[164:167], v[252:255], a[164:167], v[164:167]
  s_waitcnt lgkmcnt(0)
  v_fma_f32 v96, v96, s45, v150
  v_mfma_f32_16x16x32_bf16 v[172:175], v[184:187], a[168:171], 0
  buffer_load_dwordx4 v137, s[12:15], s36 offen offset:1024 lds
  v_mfma_f32_16x16x32_bf16 v[172:175], v[196:199], a[172:175], v[172:175]
  s_waitcnt vmcnt(12)
  s_barrier
  v_mfma_f32_16x16x32_bf16 v[172:175], v[208:211], a[176:179], v[172:175]
  v_cvt_pk_bf16_f32 v44, v164, v165
  v_cvt_pk_bf16_f32 v45, v166, v167
  v_mfma_f32_16x16x32_bf16 v[172:175], v[220:223], a[180:183], v[172:175]
  ds_read_b128 a[192:195], v0 offset:4096
  ds_read_b128 a[196:199], v1 offset:4096
  v_mfma_f32_16x16x32_bf16 v[172:175], v[232:235], a[184:187], v[172:175]
  ds_read_b128 a[200:203], v0 offset:12288
  ds_read_b128 a[204:207], v1 offset:12288
  v_mfma_f32_16x16x32_bf16 v[172:175], v[244:247], a[188:191], v[172:175]
  ds_read_b128 a[208:211], v0 offset:20480
  ds_read_b128 a[212:215], v1 offset:20480
  v_mfma_f32_16x16x32_bf16 v[164:167], v[248:251], a[188:191], 0
  buffer_load_dwordx4 v138, s[12:15], s36 offen offset:2048 lds
  v_mfma_f32_16x16x32_bf16 v[164:167], v[236:239], a[184:187], v[164:167]
  s_add_u32 m0, s63, 0
  s_add_u32 s36, s62, 147840
  v_mfma_f32_16x16x32_bf16 v[164:167], v[224:227], a[180:183], v[164:167]
  v_cvt_pk_bf16_f32 v52, v172, v173
  v_cvt_pk_bf16_f32 v53, v174, v175
  v_mfma_f32_16x16x32_bf16 v[164:167], v[212:215], a[176:179], v[164:167]
  buffer_load_dwordx4 v136, s[12:15], s36 offen offset:0 lds
  v_mfma_f32_16x16x32_bf16 v[164:167], v[200:203], a[172:175], v[164:167]
  v_fma_f32 v97, v97, s45, v150
  v_fma_f32 v98, v98, s45, v150
  v_mfma_f32_16x16x32_bf16 v[164:167], v[188:191], a[168:171], v[164:167]
  v_fma_f32 v99, v99, s45, v150
  v_fma_f32 v100, v100, s45, v150
  v_mfma_f32_16x16x32_bf16 v[172:175], v[192:195], a[168:171], 0
  buffer_load_dwordx4 v137, s[12:15], s36 offen offset:1024 lds
  v_mfma_f32_16x16x32_bf16 v[172:175], v[204:207], a[172:175], v[172:175]
  v_fma_f32 v101, v101, s45, v150
  v_fma_f32 v102, v102, s45, v150
  v_mfma_f32_16x16x32_bf16 v[172:175], v[216:219], a[176:179], v[172:175]
  v_cvt_pk_bf16_f32 v54, v164, v165
  v_cvt_pk_bf16_f32 v55, v166, v167
  v_mfma_f32_16x16x32_bf16 v[172:175], v[228:231], a[180:183], v[172:175]
  v_fma_f32 v103, v103, s45, v150
  v_fma_f32 v104, v104, s45, v150
  v_mfma_f32_16x16x32_bf16 v[172:175], v[240:243], a[184:187], v[172:175]
  buffer_load_dwordx4 v138, s[12:15], s36 offen offset:2048 lds
  v_mfma_f32_16x16x32_bf16 v[172:175], v[252:255], a[188:191], v[172:175]
  s_waitcnt lgkmcnt(0)
  v_fma_f32 v105, v105, s45, v150
  v_mfma_f32_16x16x32_bf16 v[164:167], v[184:187], a[192:195], 0
  v_fma_f32 v106, v106, s45, v150
  v_fma_f32 v107, v107, s45, v150
  v_mfma_f32_16x16x32_bf16 v[164:167], v[196:199], a[196:199], v[164:167]
  v_fma_f32 v108, v108, s45, v150
  v_fma_f32 v109, v109, s45, v150
  v_mfma_f32_16x16x32_bf16 v[164:167], v[208:211], a[200:203], v[164:167]
  v_cvt_pk_bf16_f32 v56, v172, v173
  v_cvt_pk_bf16_f32 v57, v174, v175
  v_mfma_f32_16x16x32_bf16 v[164:167], v[220:223], a[204:207], v[164:167]
  ds_read_b128 a[216:219], v0 offset:6144
  ds_read_b128 a[220:223], v1 offset:6144
  v_mfma_f32_16x16x32_bf16 v[164:167], v[232:235], a[208:211], v[164:167]
  ds_read_b128 a[224:227], v0 offset:14336
  ds_read_b128 a[244:247], v1 offset:14336
  v_mfma_f32_16x16x32_bf16 v[164:167], v[244:247], a[212:215], v[164:167]
  ds_read_b128 a[248:251], v0 offset:22528
  ds_read_b128 a[252:255], v1 offset:22528
  v_mfma_f32_16x16x32_bf16 v[172:175], v[248:251], a[212:215], 0
  s_add_u32 m0, s63, 12288
  s_add_u32 s36, s62, 184704
  v_mfma_f32_16x16x32_bf16 v[172:175], v[236:239], a[208:211], v[172:175]
  buffer_load_dwordx4 v136, s[12:15], s36 offen offset:0 lds
  v_mfma_f32_16x16x32_bf16 v[172:175], v[224:227], a[204:207], v[172:175]
  v_cvt_pk_bf16_f32 v64, v164, v165
  v_cvt_pk_bf16_f32 v65, v166, v167
  v_mfma_f32_16x16x32_bf16 v[172:175], v[212:215], a[200:203], v[172:175]
  s_waitcnt vmcnt(10)
  s_barrier
  v_mfma_f32_16x16x32_bf16 v[172:175], v[200:203], a[196:199], v[172:175]
  buffer_load_dwordx4 v137, s[12:15], s36 offen offset:1024 lds
  v_mfma_f32_16x16x32_bf16 v[172:175], v[188:191], a[192:195], v[172:175]
  buffer_load_dwordx4 v138, s[12:15], s36 offen offset:2048 lds
  v_mfma_f32_16x16x32_bf16 v[164:167], v[192:195], a[192:195], 0
  ds_read_b64_tr_b16 a[0:1], v15 offset:0
  ds_read_b64_tr_b16 a[2:3], v15 offset:512
  v_mfma_f32_16x16x32_bf16 v[164:167], v[204:207], a[196:199], v[164:167]
  s_add_u32 m0, s63, 24576
  s_add_u32 s36, s62, 768
  v_mfma_f32_16x16x32_bf16 v[164:167], v[216:219], a[200:203], v[164:167]
  v_cvt_pk_bf16_f32 v66, v172, v173
  v_cvt_pk_bf16_f32 v67, v174, v175
  v_mfma_f32_16x16x32_bf16 v[164:167], v[228:231], a[204:207], v[164:167]
  buffer_load_dwordx4 v136, s[12:15], s36 offen offset:0 lds
  v_mfma_f32_16x16x32_bf16 v[164:167], v[240:243], a[208:211], v[164:167]
  ds_read_b64_tr_b16 a[4:5], v9 offset:0
  ds_read_b64_tr_b16 a[6:7], v9 offset:512
  v_mfma_f32_16x16x32_bf16 v[164:167], v[252:255], a[212:215], v[164:167]
  s_waitcnt lgkmcnt(4)
  ds_read_b64_tr_b16 a[8:9], v11 offset:0
  v_mfma_f32_16x16x32_bf16 v[172:175], v[184:187], a[216:219], 0
  ds_read_b64_tr_b16 a[10:11], v11 offset:512
  ds_read_b64_tr_b16 a[12:13], v15 offset:12288
  v_mfma_f32_16x16x32_bf16 v[172:175], v[196:199], a[220:223], v[172:175]
  buffer_load_dwordx4 v137, s[12:15], s36 offen offset:1024 lds
  v_mfma_f32_16x16x32_bf16 v[172:175], v[208:211], a[224:227], v[172:175]
  v_cvt_pk_bf16_f32 v68, v164, v165
  v_cvt_pk_bf16_f32 v69, v166, v167
  v_mfma_f32_16x16x32_bf16 v[172:175], v[220:223], a[244:247], v[172:175]
  ds_read_b64_tr_b16 a[14:15], v15 offset:12800
  ds_read_b64_tr_b16 a[16:17], v9 offset:12288
  v_mfma_f32_16x16x32_bf16 v[172:175], v[232:235], a[248:251], v[172:175]
  ds_read_b64_tr_b16 a[18:19], v9 offset:12800
  ds_read_b64_tr_b16 a[20:21], v11 offset:12288
  v_mfma_f32_16x16x32_bf16 v[172:175], v[244:247], a[252:255], v[172:175]
  buffer_load_dwordx4 v138, s[12:15], s36 offen offset:2048 lds
  v_mfma_f32_16x16x32_bf16 v[164:167], v[248:251], a[252:255], 0
  ds_read_b64_tr_b16 a[22:23], v11 offset:12800
  v_fma_f32 v110, v110, s45, v150
  v_mfma_f32_16x16x32_bf16 v[164:167], v[236:239], a[248:251], v[164:167]
  v_fma_f32 v111, v111, s45, v150
  v_fma_f32 v112, v112, s45, v150
  v_mfma_f32_16x16x32_bf16 v[164:167], v[224:227], a[244:247], v[164:167]
  v_cvt_pk_bf16_f32 v70, v172, v173
  v_cvt_pk_bf16_f32 v71, v174, v175
  v_mfma_f32_16x16x32_bf16 v[164:167], v[212:215], a[224:227], v[164:167]
  s_add_u32 m0, s63, 36864
  s_add_u32 s36, s62, 37632
  v_mfma_f32_16x16x32_bf16 v[164:167], v[200:203], a[220:223], v[164:167]
  buffer_load_dwordx4 v136, s[12:15], s36 offen offset:0 lds
  v_mfma_f32_16x16x32_bf16 v[164:167], v[188:191], a[216:219], v[164:167]
  v_fma_f32 v113, v113, s45, v150
  v_fma_f32 v114, v114, s45, v150
  v_mfma_f32_16x16x32_bf16 v[172:175], v[192:195], a[216:219], 0
  v_fma_f32 v115, v115, s45, v150
  v_add_f32 v156, v151, v112
  v_mfma_f32_16x16x32_bf16 v[172:175], v[204:207], a[220:223], v[172:175]
  v_add_f32 v157, v151, v113
  v_add_f32 v158, v151, v114
  v_mfma_f32_16x16x32_bf16 v[172:175], v[216:219], a[224:227], v[172:175]
  v_cvt_pk_bf16_f32 v72, v164, v165
  v_cvt_pk_bf16_f32 v73, v166, v167
  v_mfma_f32_16x16x32_bf16 v[172:175], v[228:231], a[244:247], v[172:175]
  buffer_load_dwordx4 v137, s[12:15], s36 offen offset:1024 lds
  v_mfma_f32_16x16x32_bf16 v[172:175], v[240:243], a[248:251], v[172:175]
  s_waitcnt lgkmcnt(0)
  s_waitcnt vmcnt(11)
  s_barrier
  v_mfma_f32_16x16x32_bf16 v[172:175], v[252:255], a[252:255], v[172:175]
  ds_read_b64_tr_b16 a[24:25], v15 offset:24576
  v_mfma_f32_16x16x32_bf16 v[116:119], a[0:3], a[144:147], 0
  buffer_load_dwordx4 v138, s[12:15], s36 offen offset:2048 lds
  v_mfma_f32_16x16x32_bf16 v[116:119], a[12:15], a[148:151], v[116:119]
  ds_read_b64_tr_b16 a[26:27], v15 offset:25088
  ds_read_b64_tr_b16 a[28:29], v9 offset:24576
  v_mfma_f32_16x16x32_bf16 v[124:127], a[16:19], a[148:151], 0
  v_cvt_pk_bf16_f32 v74, v172, v173
  v_cvt_pk_bf16_f32 v75, v174, v175
  v_mfma_f32_16x16x32_bf16 v[124:127], a[4:7], a[144:147], v[124:127]
  s_add_u32 m0, s63, 49152
  s_add_u32 s36, s62, 74496
  v_mfma_f32_16x16x32_bf16 v[120:123], a[8:11], a[144:147], 0
  buffer_load_dwordx4 v136, s[12:15], s36 offen offset:0 lds
  v_mfma_f32_16x16x32_bf16 v[120:123], a[20:23], a[148:151], v[120:123]
  ds_read_b64_tr_b16 a[30:31], v9 offset:25088
  ds_read_b64_tr_b16 a[32:33], v11 offset:24576
  v_mfma_f32_16x16x32_bf16 v[128:131], a[0:3], a[168:171], 0
  ds_read_b64_tr_b16 a[34:35], v11 offset:25088
  ds_read_b64_tr_b16 a[36:37], v15 offset:36864
  v_mfma_f32_16x16x32_bf16 v[128:131], a[12:15], a[172:175], v[128:131]
  ds_read_b64_tr_b16 a[38:39], v15 offset:37376
  ds_read_b64_tr_b16 a[40:41], v9 offset:36864
  v_mfma_f32_16x16x32_bf16 v[132:135], a[16:19], a[172:175], 0
  buffer_load_dwordx4 v137, s[12:15], s36 offen offset:1024 lds
  v_mfma_f32_16x16x32_bf16 v[132:135], a[4:7], a[168:171], v[132:135]
  ds_read_b64_tr_b16 a[42:43], v9 offset:37376
  ds_read_b64_tr_b16 a[44:45], v11 offset:36864
  v_mfma_f32_16x16x32_bf16 v[140:143], a[8:11], a[168:171], 0
  ds_read_b64_tr_b16 a[46:47], v11 offset:37376
  v_add_f32 v159, v151, v115
  v_mfma_f32_16x16x32_bf16 v[140:143], a[20:23], a[172:175], v[140:143]
  v_add_f32 v160, v151, v108
  v_add_f32 v161, v151, v109
  v_mfma_f32_16x16x32_bf16 v[16:19], a[0:3], a[192:195], 0
  v_add_f32 v162, v151, v110
  v_add_f32 v163, v151, v111
  v_mfma_f32_16x16x32_bf16 v[16:19], a[12:15], a[196:199], v[16:19]
  buffer_load_dwordx4 v138, s[12:15], s36 offen offset:2048 lds
  v_mfma_f32_16x16x32_bf16 v[20:23], a[16:19], a[196:199], 0
  v_add_f32 v180, v151, v104
  v_add_f32 v181, v151, v105
  v_mfma_f32_16x16x32_bf16 v[20:23], a[4:7], a[192:195], v[20:23]
  v_add_f32 v182, v151, v106
  v_add_f32 v183, v151, v107
  v_mfma_f32_16x16x32_bf16 v[24:27], a[8:11], a[192:195], 0
  s_add_u32 m0, s63, 61440
  s_add_u32 s36, s62, 111360
  v_mfma_f32_16x16x32_bf16 v[24:27], a[20:23], a[196:199], v[24:27]
  buffer_load_dwordx4 v136, s[12:15], s36 offen offset:0 lds
  v_mfma_f32_16x16x32_bf16 v[28:31], a[0:3], a[216:219], 0
  v_add_f32 v152, v151, v96
  v_add_f32 v153, v151, v97
  v_mfma_f32_16x16x32_bf16 v[28:31], a[12:15], a[220:223], v[28:31]
  v_add_f32 v154, v151, v98
  v_add_f32 v155, v151, v99
  v_mfma_f32_16x16x32_bf16 v[32:35], a[16:19], a[220:223], 0
  v_add_f32 v168, v151, v92
  v_add_f32 v169, v151, v93
  v_mfma_f32_16x16x32_bf16 v[32:35], a[4:7], a[216:219], v[32:35]
  buffer_load_dwordx4 v137, s[12:15], s36 offen offset:1024 lds
  v_mfma_f32_16x16x32_bf16 v[36:39], a[8:11], a[216:219], 0
  v_add_f32 v170, v151, v94
  v_add_f32 v171, v151, v95
  v_mfma_f32_16x16x32_bf16 v[36:39], a[20:23], a[220:223], v[36:39]
  s_waitcnt lgkmcnt(0)
  v_add_f32 v176, v151, v88
  v_mfma_f32_16x16x32_bf16 v[116:119], a[24:27], a[152:155], v[116:119]
  s_waitcnt vmcnt(11)
  s_barrier
  v_mfma_f32_16x16x32_bf16 v[116:119], a[36:39], a[156:159], v[116:119]
  buffer_load_dwordx4 v138, s[12:15], s36 offen offset:2048 lds
  v_mfma_f32_16x16x32_bf16 v[124:127], a[40:43], a[156:159], v[124:127]
  ds_read_b64_tr_b16 a[48:49], v12 offset:0
  ds_read_b64_tr_b16 a[50:51], v12 offset:512
  v_mfma_f32_16x16x32_bf16 v[124:127], a[28:31], a[152:155], v[124:127]
  ds_read_b64_tr_b16 a[52:53], v13 offset:0
  ds_read_b64_tr_b16 a[54:55], v13 offset:512
  v_mfma_f32_16x16x32_bf16 v[120:123], a[32:35], a[152:155], v[120:123]
  s_add_u32 m0, s63, 73728
  s_add_u32 s36, s62, 148224
  v_mfma_f32_16x16x32_bf16 v[120:123], a[44:47], a[156:159], v[120:123]
  buffer_load_dwordx4 v136, s[12:15], s36 offen offset:0 lds
  v_mfma_f32_16x16x32_bf16 v[128:131], a[24:27], a[176:179], v[128:131]
  ds_read_b64_tr_b16 a[56:57], v14 offset:0
  ds_read_b64_tr_b16 a[58:59], v14 offset:512
  v_mfma_f32_16x16x32_bf16 v[128:131], a[36:39], a[180:183], v[128:131]
  ds_read_b64_tr_b16 a[60:61], v12 offset:12288
  ds_read_b64_tr_b16 a[62:63], v12 offset:12800
  v_mfma_f32_16x16x32_bf16 v[132:135], a[40:43], a[180:183], v[132:135]
  ds_read_b64_tr_b16 a[64:65], v13 offset:12288
  ds_read_b64_tr_b16 a[66:67], v13 offset:12800
  v_mfma_f32_16x16x32_bf16 v[132:135], a[28:31], a[176:179], v[132:135]
  ds_read_b64_tr_b16 a[68:69], v14 offset:12288
  ds_read_b64_tr_b16 a[70:71], v14 offset:12800
  v_mfma_f32_16x16x32_bf16 v[140:143], a[32:35], a[176:179], v[140:143]
  buffer_load_dwordx4 v137, s[12:15], s36 offen offset:1024 lds
  v_mfma_f32_16x16x32_bf16 v[140:143], a[44:47], a[180:183], v[140:143]
  v_add_f32 v177, v151, v89
  v_add_f32 v178, v151, v90
  v_mfma_f32_16x16x32_bf16 v[16:19], a[24:27], a[200:203], v[16:19]
  v_add_f32 v179, v151, v91
  s_and_b32 s38, s28, -2
  v_mfma_f32_16x16x32_bf16 v[16:19], a[36:39], a[204:207], v[16:19]
  s_min_u32 s38, s38, 60
  s_lshl_b32 s37, s38, 1
  v_mfma_f32_16x16x32_bf16 v[20:23], a[40:43], a[204:207], v[20:23]
  buffer_load_dwordx4 v138, s[12:15], s36 offen offset:2048 lds
  v_mfma_f32_16x16x32_bf16 v[20:23], a[28:31], a[200:203], v[20:23]
  s_mov_b32 s22, 4
  s_add_u32 s46, s4, 68
  v_mfma_f32_16x16x32_bf16 v[24:27], a[32:35], a[200:203], v[24:27]
  s_mul_i32 s46, s46, 196608
  s_mov_b32 s47, 24576
  v_mfma_f32_16x16x32_bf16 v[24:27], a[44:47], a[204:207], v[24:27]
  s_add_u32 m0, s63, 86016
  s_add_u32 s36, s62, 185088
  v_mfma_f32_16x16x32_bf16 v[28:31], a[24:27], a[224:227], v[28:31]
  buffer_load_dwordx4 v136, s[12:15], s36 offen offset:0 lds
  v_mfma_f32_16x16x32_bf16 v[28:31], a[36:39], a[244:247], v[28:31]
  v_mfma_f32_16x16x32_bf16 v[32:35], a[40:43], a[244:247], v[32:35]
  s_waitcnt lgkmcnt(0)
  s_waitcnt vmcnt(10)
  s_barrier
  v_mfma_f32_16x16x32_bf16 v[32:35], a[28:31], a[224:227], v[32:35]
  ds_read_b64_tr_b16 a[72:73], v12 offset:24576
  ds_read_b64_tr_b16 a[74:75], v12 offset:25088
  v_mfma_f32_16x16x32_bf16 v[36:39], a[32:35], a[224:227], v[36:39]
  buffer_load_dwordx4 v137, s[12:15], s36 offen offset:1024 lds
  v_mfma_f32_16x16x32_bf16 v[36:39], a[44:47], a[244:247], v[36:39]
  ds_read_b64_tr_b16 a[76:77], v13 offset:24576
  v_mfma_f32_16x16x32_bf16 v[116:119], a[48:51], a[160:163], v[116:119]
  ds_read_b64_tr_b16 a[78:79], v13 offset:25088
  ds_read_b64_tr_b16 a[80:81], v14 offset:24576
  v_mfma_f32_16x16x32_bf16 v[116:119], a[60:63], a[164:167], v[116:119]
  ds_read_b64_tr_b16 a[82:83], v14 offset:25088
  ds_read_b64_tr_b16 a[84:85], v12 offset:36864
  v_mfma_f32_16x16x32_bf16 v[124:127], a[64:67], a[164:167], v[124:127]
  buffer_load_dwordx4 v138, s[12:15], s36 offen offset:2048 lds
  v_mfma_f32_16x16x32_bf16 v[124:127], a[52:55], a[160:163], v[124:127]
  ds_read_b64_tr_b16 a[86:87], v12 offset:37376
  ds_read_b64_tr_b16 a[88:89], v13 offset:36864
  v_mfma_f32_16x16x32_bf16 v[120:123], a[56:59], a[160:163], v[120:123]
  v_cvt_pk_bf16_f32 v46, v116, v117
  v_cvt_pk_bf16_f32 v47, v118, v119
  v_mfma_f32_16x16x32_bf16 v[120:123], a[68:71], a[164:167], v[120:123]
  s_add_u32 m0, s32, 40960
  ds_read_b64_tr_b16 a[90:91], v13 offset:37376
  v_mfma_f32_16x16x32_bf16 v[128:131], a[48:51], a[184:187], v[128:131]
  v_cvt_pk_bf16_f32 v48, v124, v125
  v_cvt_pk_bf16_f32 v49, v126, v127
  v_mfma_f32_16x16x32_bf16 v[128:131], a[60:63], a[188:191], v[128:131]
  buffer_load_dwordx4 v6, s[8:11], s48 offen offset:0 nt lds
  v_mfma_f32_16x16x32_bf16 v[132:135], a[64:67], a[188:191], v[132:135]
  v_cvt_pk_bf16_f32 v50, v120, v121
  v_cvt_pk_bf16_f32 v51, v122, v123
  v_mfma_f32_16x16x32_bf16 v[132:135], a[52:55], a[184:187], v[132:135]
  s_add_u32 m0, s32, 49024
  ds_read_b64_tr_b16 a[92:93], v14 offset:36864
  v_mfma_f32_16x16x32_bf16 v[140:143], a[56:59], a[184:187], v[140:143]
  v_cvt_pk_bf16_f32 v58, v128, v129
  v_cvt_pk_bf16_f32 v59, v130, v131
  v_mfma_f32_16x16x32_bf16 v[140:143], a[68:71], a[188:191], v[140:143]
  buffer_load_dwordx4 v6, s[8:11], s48 offen offset:128 nt lds
  v_mfma_f32_16x16x32_bf16 v[16:19], a[48:51], a[208:211], v[16:19]
  v_cvt_pk_bf16_f32 v60, v132, v133
  v_cvt_pk_bf16_f32 v61, v134, v135
  v_mfma_f32_16x16x32_bf16 v[16:19], a[60:63], a[212:215], v[16:19]
  s_add_u32 m0, s32, 57088
  ds_read_b64_tr_b16 a[94:95], v14 offset:37376
L_hop1:
  s_cbranch_execz L_hopped
  v_mfma_f32_16x16x32_bf16 v[20:23], a[64:67], a[212:215], v[20:23]
  v_cvt_pk_bf16_f32 v62, v140, v141
  v_cvt_pk_bf16_f32 v63, v142, v143
  v_mfma_f32_16x16x32_bf16 v[20:23], a[52:55], a[208:211], v[20:23]
  buffer_load_dwordx4 v6, s[8:11], s48 offen offset:256 nt lds
  v_mfma_f32_16x16x32_bf16 v[24:27], a[56:59], a[208:211], v[24:27]
  v_cvt_pk_bf16_f32 v76, v16, v17
  v_cvt_pk_bf16_f32 v77, v18, v19
  v_mfma_f32_16x16x32_bf16 v[24:27], a[68:71], a[212:215], v[24:27]
  s_add_u32 m0, s32, 45056
  v_mfma_f32_16x16x32_bf16 v[28:31], a[48:51], a[248:251], v[28:31]
  v_cvt_pk_bf16_f32 v78, v20, v21
  v_cvt_pk_bf16_f32 v79, v22, v23
  v_mfma_f32_16x16x32_bf16 v[28:31], a[60:63], a[252:255], v[28:31]
  s_waitcnt lgkmcnt(0)
  s_waitcnt vmcnt(9)
  s_barrier
  v_mfma_f32_16x16x32_bf16 v[32:35], a[64:67], a[252:255], v[32:35]
  v_cvt_pk_bf16_f32 v80, v24, v25
  v_cvt_pk_bf16_f32 v81, v26, v27
  v_mfma_f32_16x16x32_bf16 v[32:35], a[52:55], a[248:251], v[32:35]
  buffer_load_dwordx4 v6, s[8:11], s49 offen offset:0 nt lds
  v_mfma_f32_16x16x32_bf16 v[36:39], a[56:59], a[248:251], v[36:39]
  v_cvt_pk_bf16_f32 v82, v28, v29
  v_cvt_pk_bf16_f32 v83, v30, v31
  v_mfma_f32_16x16x32_bf16 v[36:39], a[68:71], a[252:255], v[36:39]
  s_add_u32 m0, s32, 53120
  ds_read_b64_tr_b16 a[96:97], v12 offset:49152
  v_mfma_f32_16x16x32_bf16 v[116:119], v[46:49], v[70:73], v[156:159]
  v_cvt_pk_bf16_f32 v84, v32, v33
  v_cvt_pk_bf16_f32 v85, v34, v35
  v_mfma_f32_16x16x32_bf16 v[124:127], v[58:61], v[70:73], v[160:163]
  buffer_load_dwordx4 v6, s[8:11], s49 offen offset:128 nt lds
  v_mfma_f32_16x16x32_bf16 v[120:123], v[76:79], v[70:73], v[104:107]
  v_cvt_pk_bf16_f32 v86, v36, v37
  v_cvt_pk_bf16_f32 v87, v38, v39
  v_mfma_f32_16x16x32_bf16 v[128:131], v[82:85], v[70:73], v[100:103]
  s_add_u32 m0, s32, 61184
  ds_read_b64_tr_b16 a[98:99], v12 offset:49664
  v_mfma_f32_16x16x16_bf16 v[116:119], v[50:51], v[74:75], v[116:119]
  s_cmp_lg_u32 s31, 0
  s_cbranch_scc1 L_special0
  v_mfma_f32_16x16x16_bf16 v[124:127], v[62:63], v[74:75], v[124:127]
  buffer_load_dwordx4 v6, s[8:11], s49 offen offset:256 nt lds
  v_mfma_f32_16x16x16_bf16 v[120:123], v[80:81], v[74:75], v[120:123]
  s_add_u32 s48, s48, 6291456
  s_add_u32 s49, s48, 786432
  v_mfma_f32_16x16x16_bf16 v[128:131], v[86:87], v[74:75], v[128:131]
  s_add_u32 m0, s32, 65536
  ds_read_b64_tr_b16 a[100:101], v13 offset:49152
  v_mfma_f32_16x16x16_bf16 v[132:135], v[50:51], v[68:69], v[160:163]
  buffer_load_dwordx4 v6, s[8:11], s48 offen offset:0 nt lds
  v_mfma_f32_16x16x16_bf16 v[140:143], v[62:63], v[68:69], v[180:183]
  ds_read_b64_tr_b16 a[102:103], v13 offset:49664
  ds_read_b64_tr_b16 a[104:105], v14 offset:49152
  v_mfma_f32_16x16x16_bf16 v[136:139], v[80:81], v[68:69], v[100:103]
  ds_read_b64_tr_b16 a[106:107], v14 offset:49664
  ds_read_b64_tr_b16 a[108:109], v12 offset:61440
  v_mfma_f32_16x16x16_bf16 v[144:147], v[86:87], v[68:69], v[96:99]
  s_add_u32 m0, s32, 73600
  ds_read_b64_tr_b16 a[110:111], v12 offset:61952
  v_mfma_f32_16x16x16_bf16 v[148:151], v[50:51], v[56:57], v[104:107]
  buffer_load_dwordx4 v6, s[8:11], s48 offen offset:128 nt lds
  v_mfma_f32_16x16x16_bf16 v[156:159], v[62:63], v[56:57], v[100:103]
  ds_read_b64_tr_b16 a[112:113], v13 offset:61440
  ds_read_b64_tr_b16 a[114:115], v13 offset:61952
  v_mfma_f32_16x16x16_bf16 v[152:155], v[80:81], v[56:57], v[152:155]
  ds_read_b64_tr_b16 a[116:117], v14 offset:61440
  ds_read_b64_tr_b16 a[118:119], v14 offset:61952
  v_mfma_f32_16x16x16_bf16 v[160:163], v[86:87], v[56:57], v[168:171]
  s_add_u32 m0, s32, 81664
  v_mfma_f32_16x16x16_bf16 v[164:167], v[50:51], v[44:45], v[100:103]
  buffer_load_dwordx4 v6, s[8:11], s48 offen offset:256 nt lds
  v_mfma_f32_16x16x16_bf16 v[172:175], v[62:63], v[44:45], v[96:99]
  v_exp_f32 v116, v116
  v_mfma_f32_16x16x16_bf16 v[168:171], v[80:81], v[44:45], v[168:171]
  v_exp_f32 v117, v117
  v_mfma_f32_16x16x16_bf16 v[176:179], v[86:87], v[44:45], v[176:179]
  v_exp_f32 v118, v118
  v_mfma_f32_16x16x32_bf16 v[132:135], v[46:49], v[64:67], v[132:135]
  s_waitcnt lgkmcnt(0)
  s_waitcnt vmcnt(9)
  s_barrier
  v_mfma_f32_16x16x32_bf16 v[140:143], v[58:61], v[64:67], v[140:143]
  ds_read_b64_tr_b16 a[120:121], v15 offset:0
  ds_read_b64_tr_b16 a[122:123], v15 offset:512
  v_mfma_f32_16x16x32_bf16 v[136:139], v[76:79], v[64:67], v[136:139]
  ds_read_b64_tr_b16 a[124:125], v9 offset:0
  ds_read_b64_tr_b16 a[126:127], v9 offset:512
  v_mfma_f32_16x16x32_bf16 v[144:147], v[82:85], v[64:67], v[144:147]
  ds_read_b64_tr_b16 a[128:129], v11 offset:0
  ds_read_b64_tr_b16 a[130:131], v11 offset:512
  v_mfma_f32_16x16x32_bf16 v[148:151], v[46:49], v[52:55], v[148:151]
  ds_read_b64_tr_b16 a[132:133], v15 offset:12288
  ds_read_b64_tr_b16 a[134:135], v15 offset:12800
  v_mfma_f32_16x16x32_bf16 v[156:159], v[58:61], v[52:55], v[156:159]
  ds_read_b64_tr_b16 a[136:137], v9 offset:12288
  ds_read_b64_tr_b16 a[138:139], v9 offset:12800
  v_mfma_f32_16x16x32_bf16 v[152:155], v[76:79], v[52:55], v[152:155]
  ds_read_b64_tr_b16 a[140:141], v11 offset:12288
  ds_read_b64_tr_b16 a[142:143], v11 offset:12800
  v_mfma_f32_16x16x32_bf16 v[160:163], v[82:85], v[52:55], v[160:163]
  v_exp_f32 v119, v119
  v_mfma_f32_16x16x32_bf16 v[164:167], v[46:49], v[40:43], v[164:167]
  v_cvt_pk_bf16_f32 v116, v116, v117
  v_cvt_pk_bf16_f32 v117, v118, v119
  v_mfma_f32_16x16x32_bf16 v[172:175], v[58:61], v[40:43], v[172:175]
  v_exp_f32 v124, v124
  v_mfma_f32_16x16x32_bf16 v[168:171], v[76:79], v[40:43], v[168:171]
  v_exp_f32 v125, v125
  v_mfma_f32_16x16x32_bf16 v[176:179], v[82:85], v[40:43], v[176:179]
  v_exp_f32 v126, v126
L_enter:
  v_mfma_f32_16x16x32_bf16 v[40:43], a[144:147], a[72:75], 0
  v_exp_f32 v127, v127
  v_mfma_f32_16x16x32_bf16 v[40:43], a[148:151], a[84:87], v[40:43]
  v_cvt_pk_bf16_f32 v118, v124, v125
  v_cvt_pk_bf16_f32 v119, v126, v127
  v_mfma_f32_16x16x32_bf16 v[40:43], a[152:155], a[96:99], v[40:43]
  v_exp_f32 v120, v120
  v_mfma_f32_16x16x32_bf16 v[40:43], a[156:159], a[108:111], v[40:43]
  s_waitcnt lgkmcnt(0)
  v_mfma_f32_16x16x32_bf16 v[40:43], a[160:163], a[120:123], v[40:43]
  v_exp_f32 v121, v121
  v_mfma_f32_16x16x32_bf16 v[40:43], a[164:167], a[132:135], v[40:43]
  v_exp_f32 v122, v122
  v_mfma_f32_16x16x32_bf16 v[44:47], a[164:167], a[136:139], 0
  v_exp_f32 v123, v123
  v_mfma_f32_16x16x32_bf16 v[44:47], a[160:163], a[124:127], v[44:47]
  v_cvt_pk_bf16_f32 v120, v120, v121
  v_cvt_pk_bf16_f32 v121, v122, v123
  v_mfma_f32_16x16x32_bf16 v[44:47], a[156:159], a[112:115], v[44:47]
  v_cvt_pk_bf16_f32 v16, v40, v41
  v_cvt_pk_bf16_f32 v17, v42, v43
  v_mfma_f32_16x16x32_bf16 v[44:47], a[152:155], a[100:103], v[44:47]
  v_exp_f32 v128, v128
  v_mfma_f32_16x16x32_bf16 v[44:47], a[148:151], a[88:91], v[44:47]
  v_exp_f32 v129, v129
  v_mfma_f32_16x16x32_bf16 v[44:47], a[144:147], a[76:79], v[44:47]
  v_exp_f32 v130, v130
  v_mfma_f32_16x16x32_bf16 v[40:43], a[144:147], a[80:83], 0
  v_exp_f32 v131, v131
  v_mfma_f32_16x16x32_bf16 v[40:43], a[148:151], a[92:95], v[40:43]
  v_cvt_pk_bf16_f32 v122, v128, v129
  v_cvt_pk_bf16_f32 v123, v130, v131
  v_mfma_f32_16x16x32_bf16 v[40:43], a[152:155], a[104:107], v[40:43]
  v_cvt_pk_bf16_f32 v24, v44, v45
  v_cvt_pk_bf16_f32 v25, v46, v47
  v_mfma_f32_16x16x32_bf16 v[40:43], a[156:159], a[116:119], v[40:43]
  v_exp_f32 v132, v132
  v_mfma_f32_16x16x32_bf16 v[40:43], a[160:163], a[128:131], v[40:43]
  v_exp_f32 v133, v133
  v_mfma_f32_16x16x32_bf16 v[40:43], a[164:167], a[140:143], v[40:43]
  v_exp_f32 v134, v134
  v_mfma_f32_16x16x32_bf16 v[44:47], a[168:171], a[72:75], 0
  v_cvt_pk_bf16_f32 v132, v132, v133
  v_mfma_f32_16x16x32_bf16 v[44:47], a[172:175], a[84:87], v[44:47]
  v_exp_f32 v135, v135
  v_mfma_f32_16x16x32_bf16 v[44:47], a[176:179], a[96:99], v[44:47]
  v_cvt_pk_bf16_f32 v32, v40, v41
  v_cvt_pk_bf16_f32 v33, v42, v43
  v_mfma_f32_16x16x32_bf16 v[44:47], a[180:183], a[108:111], v[44:47]
  v_exp_f32 v140, v140
  v_mfma_f32_16x16x32_bf16 v[44:47], a[184:187], a[120:123], v[44:47]
  v_exp_f32 v141, v141
  v_mfma_f32_16x16x32_bf16 v[44:47], a[188:191], a[132:135], v[44:47]
  v_cvt_pk_bf16_f32 v133, v134, v135
  v_cvt_pk_bf16_f32 v134, v140, v141
  v_mfma_f32_16x16x32_bf16 v[40:43], a[188:191], a[136:139], 0
  v_exp_f32 v142, v142
  v_mfma_f32_16x16x32_bf16 v[40:43], a[184:187], a[124:127], v[40:43]
  v_exp_f32 v143, v143
  v_mfma_f32_16x16x32_bf16 v[40:43], a[180:183], a[112:115], v[40:43]
  v_cvt_pk_bf16_f32 v18, v44, v45
  v_cvt_pk_bf16_f32 v19, v46, v47
  v_mfma_f32_16x16x32_bf16 v[40:43], a[176:179], a[100:103], v[40:43]
  v_cvt_pk_bf16_f32 v135, v142, v143
  v_mfma_f32_16x16x32_bf16 v[40:43], a[172:175], a[88:91], v[40:43]
  v_exp_f32 v136, v136
  v_mfma_f32_16x16x32_bf16 v[40:43], a[168:171], a[76:79], v[40:43]
  v_exp_f32 v137, v137
  v_mfma_f32_16x16x32_bf16 v[44:47], a[168:171], a[80:83], 0
  v_exp_f32 v138, v138
  v_mfma_f32_16x16x32_bf16 v[44:47], a[172:175], a[92:95], v[44:47]
  v_exp_f32 v139, v139
  v_mfma_f32_16x16x32_bf16 v[44:47], a[176:179], a[104:107], v[44:47]
  v_cvt_pk_bf16_f32 v26, v40, v41
  v_cvt_pk_bf16_f32 v27, v42, v43
  v_mfma_f32_16x16x32_bf16 v[44:47], a[180:183], a[116:119], v[44:47]
  v_cvt_pk_bf16_f32 v136, v136, v137
  v_cvt_pk_bf16_f32 v137, v138, v139
  v_mfma_f32_16x16x32_bf16 v[44:47], a[184:187], a[128:131], v[44:47]
  v_exp_f32 v144, v144
  v_mfma_f32_16x16x32_bf16 v[44:47], a[188:191], a[140:143], v[44:47]
  v_exp_f32 v145, v145
  v_mfma_f32_16x16x32_bf16 v[40:43], a[192:195], a[72:75], 0
  v_exp_f32 v146, v146
  v_mfma_f32_16x16x32_bf16 v[40:43], a[196:199], a[84:87], v[40:43]
  v_exp_f32 v147, v147
  v_mfma_f32_16x16x32_bf16 v[40:43], a[200:203], a[96:99], v[40:43]
  v_cvt_pk_bf16_f32 v34, v44, v45
  v_cvt_pk_bf16_f32 v35, v46, v47
  v_mfma_f32_16x16x32_bf16 v[40:43], a[204:207], a[108:111], v[40:43]
  v_cvt_pk_bf16_f32 v138, v144, v145
  v_cvt_pk_bf16_f32 v139, v146, v147
  v_mfma_f32_16x16x32_bf16 v[40:43], a[208:211], a[120:123], v[40:43]
  v_exp_f32 v148, v148
  v_mfma_f32_16x16x32_bf16 v[40:43], a[212:215], a[132:135], v[40:43]
  v_exp_f32 v149, v149
  v_mfma_f32_16x16x32_bf16 v[44:47], a[212:215], a[136:139], 0
  v_mov_b64 v[144:145], 0
  v_cvt_pk_bf16_f32 v148, v148, v149
  v_mfma_f32_16x16x32_bf16 v[44:47], a[208:211], a[124:127], v[44:47]
  v_exp_f32 v150, v150
  v_mfma_f32_16x16x32_bf16 v[44:47], a[204:207], a[112:115], v[44:47]
  v_cvt_pk_bf16_f32 v20, v40, v41
  v_cvt_pk_bf16_f32 v21, v42, v43
  v_mfma_f32_16x16x32_bf16 v[44:47], a[200:203], a[100:103], v[44:47]
  v_exp_f32 v151, v151
  v_mfma_f32_16x16x32_bf16 v[44:47], a[196:199], a[88:91], v[44:47]
  v_exp_f32 v156, v156
  v_mfma_f32_16x16x32_bf16 v[44:47], a[192:195], a[76:79], v[44:47]
  v_exp_f32 v157, v157
  v_mfma_f32_16x16x32_bf16 v[40:43], a[192:195], a[80:83], 0
  v_cvt_pk_bf16_f32 v149, v150, v151
  v_cvt_pk_bf16_f32 v150, v156, v157
  v_mfma_f32_16x16x32_bf16 v[40:43], a[196:199], a[92:95], v[40:43]
  v_exp_f32 v158, v158
  v_mfma_f32_16x16x32_bf16 v[40:43], a[200:203], a[104:107], v[40:43]
  v_cvt_pk_bf16_f32 v28, v44, v45
  v_cvt_pk_bf16_f32 v29, v46, v47
  v_mfma_f32_16x16x32_bf16 v[40:43], a[204:207], a[116:119], v[40:43]
  v_exp_f32 v159, v159
  v_mfma_f32_16x16x32_bf16 v[40:43], a[208:211], a[128:131], v[40:43]
  v_cvt_pk_bf16_f32 v151, v158, v159
  v_mfma_f32_16x16x32_bf16 v[40:43], a[212:215], a[140:143], v[40:43]
  v_exp_f32 v152, v152
  v_mfma_f32_16x16x32_bf16 v[44:47], a[216:219], a[72:75], 0
  v_exp_f32 v153, v153
  v_mfma_f32_16x16x32_bf16 v[44:47], a[220:223], a[84:87], v[44:47]
  v_exp_f32 v154, v154
  v_mfma_f32_16x16x32_bf16 v[44:47], a[224:227], a[96:99], v[44:47]
  v_cvt_pk_bf16_f32 v36, v40, v41
  v_cvt_pk_bf16_f32 v37, v42, v43
  v_mfma_f32_16x16x32_bf16 v[44:47], a[244:247], a[108:111], v[44:47]
  v_exp_f32 v155, v155
  v_mfma_f32_16x16x32_bf16 v[44:47], a[248:251], a[120:123], v[44:47]
  v_cvt_pk_bf16_f32 v152, v152, v153
  v_cvt_pk_bf16_f32 v153, v154, v155
  v_mfma_f32_16x16x32_bf16 v[44:47], a[252:255], a[132:135], v[44:47]
  v_exp_f32 v160, v160
  v_mfma_f32_16x16x32_bf16 v[40:43], a[252:255], a[136:139], 0
  v_exp_f32 v161, v161
  v_mfma_f32_16x16x32_bf16 v[40:43], a[248:251], a[124:127], v[40:43]
  v_exp_f32 v162, v162
  v_mfma_f32_16x16x32_bf16 v[40:43], a[244:247], a[112:115], v[40:43]
  v_cvt_pk_bf16_f32 v22, v44, v45
  v_cvt_pk_bf16_f32 v23, v46, v47
  v_mfma_f32_16x16x32_bf16 v[40:43], a[224:227], a[100:103], v[40:43]
  v_exp_f32 v163, v163
  v_mfma_f32_16x16x32_bf16 v[40:43], a[220:223], a[88:91], v[40:43]
  v_cvt_pk_bf16_f32 v154, v160, v161
  v_cvt_pk_bf16_f32 v155, v162, v163
  v_mfma_f32_16x16x32_bf16 v[40:43], a[216:219], a[76:79], v[40:43]
  v_exp_f32 v164, v164
  v_mfma_f32_16x16x32_bf16 v[44:47], a[216:219], a[80:83], 0
  v_exp_f32 v165, v165
  v_mfma_f32_16x16x32_bf16 v[44:47], a[220:223], a[92:95], v[44:47]
  v_exp_f32 v166, v166
  v_mfma_f32_16x16x32_bf16 v[44:47], a[224:227], a[104:107], v[44:47]
  v_cvt_pk_bf16_f32 v30, v40, v41
  v_cvt_pk_bf16_f32 v31, v42, v43
  v_mfma_f32_16x16x32_bf16 v[44:47], a[244:247], a[116:119], v[44:47]
  v_exp_f32 v167, v167
  v_mfma_f32_16x16x32_bf16 v[44:47], a[248:251], a[128:131], v[44:47]
  v_cvt_pk_bf16_f32 v164, v164, v165
  v_cvt_pk_bf16_f32 v165, v166, v167
  v_mfma_f32_16x16x32_bf16 v[44:47], a[252:255], a[140:143], v[44:47]
  v_exp_f32 v172, v172
  s_add_u32 s32, s32, 40960
  v_mad_i32_i16 v0, v10, 1, s32 op_sel:[1,0,0,0]
  v_xor_b32 v1, 64, v0
  s_add_u32 s20, s20, s37
  s_addc_u32 s21, s21, 0
  v_exp_f32 v173, v173
  v_exp_f32 v174, v174
  v_smfmac_f32_16x16x64_bf16 v[144:147], a[240:243], v[116:123], v10
  v_exp_f32 v175, v175
  v_mfma_f32_16x16x32_bf16 v[124:127], v[20:23], v[120:123], 0
  v_cvt_pk_bf16_f32 v166, v172, v173
  v_cvt_pk_bf16_f32 v167, v174, v175
  v_mfma_f32_16x16x32_bf16 v[124:127], v[16:19], v[116:119], v[124:127]
  v_cvt_pk_bf16_f32 v38, v44, v45
  v_cvt_pk_bf16_f32 v39, v46, v47
  v_mfma_f32_16x16x32_bf16 v[128:131], v[24:27], v[116:119], 0
  v_add_f32 v15, v144, v145
  v_mov_b64 v[144:145], 0
  v_mfma_f32_16x16x32_bf16 v[128:131], v[28:31], v[120:123], v[128:131]
  v_exp_f32 v168, v168
  v_mfma_f32_16x16x32_bf16 v[140:143], v[36:39], v[120:123], 0
  v_exp_f32 v169, v169
  v_mfma_f32_16x16x32_bf16 v[140:143], v[32:35], v[116:119], v[140:143]
  v_exp_f32 v170, v170
  v_smfmac_f32_16x16x64_bf16 v[144:147], a[240:243], v[132:139], v10
  v_exp_f32 v171, v171
  v_mfma_f32_16x16x32_bf16 v[116:119], v[20:23], v[136:139], 0
  v_cvt_pk_bf16_f32 v168, v168, v169
  v_cvt_pk_bf16_f32 v169, v170, v171
  v_mfma_f32_16x16x32_bf16 v[116:119], v[16:19], v[132:135], v[116:119]
  v_exp_f32 v176, v176
  v_mfma_f32_16x16x32_bf16 v[120:123], v[24:27], v[132:135], 0
  v_add_f32 v14, v144, v145
  v_mov_b64 v[144:145], 0
  v_mfma_f32_16x16x32_bf16 v[120:123], v[28:31], v[136:139], v[120:123]
  v_exp_f32 v177, v177
  v_mfma_f32_16x16x32_bf16 v[156:159], v[36:39], v[136:139], 0
  v_exp_f32 v178, v178
  v_mfma_f32_16x16x32_bf16 v[156:159], v[32:35], v[132:135], v[156:159]
  v_exp_f32 v179, v179
  v_smfmac_f32_16x16x64_bf16 v[144:147], a[240:243], v[148:155], v10
  v_cvt_pk_bf16_f32 v170, v176, v177
  v_cvt_pk_bf16_f32 v171, v178, v179
  v_mfma_f32_16x16x32_bf16 v[132:135], v[20:23], v[152:155], 0
  s_add_u32 m0, s32, 28672
  v_max_f32 v9, v14, v15
  v_mfma_f32_16x16x32_bf16 v[132:135], v[16:19], v[148:151], v[132:135]
  s_waitcnt vmcnt(6)
  s_barrier
  v_mfma_f32_16x16x32_bf16 v[136:139], v[24:27], v[148:151], 0
  v_add_f32 v13, v144, v145
  v_mov_b64 v[144:145], 0
  v_mfma_f32_16x16x32_bf16 v[136:139], v[28:31], v[152:155], v[136:139]
  ds_read_b128 a[244:247], v0 offset:0
  ds_read_b128 a[248:251], v1 offset:0
  v_mfma_f32_16x16x32_bf16 v[160:163], v[36:39], v[152:155], 0
  buffer_load_dwordx4 v6, s[8:11], s49 offen offset:0 nt lds
  v_mfma_f32_16x16x32_bf16 v[160:163], v[32:35], v[148:151], v[160:163]
  ds_read_b128 a[252:255], v0 offset:8192
  ds_read_b128 v[180:183], v1 offset:8192
  v_smfmac_f32_16x16x64_bf16 v[144:147], a[240:243], v[164:171], v10
  s_add_u32 m0, s32, 36736
  v_mfma_f32_16x16x32_bf16 v[148:151], v[20:23], v[168:171], 0
  ds_read_b128 v[64:67], v0 offset:16384
  ds_read_b128 v[68:71], v1 offset:16384
  v_mfma_f32_16x16x32_bf16 v[148:151], v[16:19], v[164:167], v[148:151]
  buffer_load_dwordx4 v6, s[8:11], s49 offen offset:128 nt lds
  v_mfma_f32_16x16x32_bf16 v[152:155], v[24:27], v[164:167], 0
  v_add_f32 v12, v144, v145
  s_add_u32 m0, s32, 44800
  v_mfma_f32_16x16x32_bf16 v[152:155], v[28:31], v[168:171], v[152:155]
  buffer_load_dwordx4 v6, s[8:11], s49 offen offset:256 nt lds
  v_mfma_f32_16x16x32_bf16 v[172:175], v[36:39], v[168:171], 0
  v_rcp_f32 v15, v15
  v_mfma_f32_16x16x32_bf16 v[172:175], v[32:35], v[164:167], v[172:175]
  s_waitcnt lgkmcnt(4)
  v_mfma_f32_16x16x32_bf16 v[76:79], v[184:187], a[244:247], 0
  v_rcp_f32 v14, v14
  v_mfma_f32_16x16x32_bf16 v[76:79], v[196:199], a[248:251], v[76:79]
  s_waitcnt lgkmcnt(2)
  v_mul_f32 v124, v15, v124
  v_mfma_f32_16x16x32_bf16 v[76:79], v[208:211], a[252:255], v[76:79]
  v_mul_f32 v125, v15, v125
  v_mul_f32 v126, v15, v126
  v_mfma_f32_16x16x32_bf16 v[76:79], v[220:223], v[180:183], v[76:79]
  s_waitcnt lgkmcnt(0)
  v_mul_f32 v127, v15, v127
  v_mfma_f32_16x16x32_bf16 v[76:79], v[232:235], v[64:67], v[76:79]
  v_cvt_pk_bf16_f32 v124, v124, v125
  v_cvt_pk_bf16_f32 v125, v126, v127
  v_mfma_f32_16x16x32_bf16 v[76:79], v[244:247], v[68:71], v[76:79]
  v_mul_f32 v128, v15, v128
  v_mul_f32 v129, v15, v129
  v_mfma_f32_16x16x32_bf16 v[80:83], v[248:251], v[68:71], 0
  v_mul_f32 v130, v15, v130
  v_mul_f32 v131, v15, v131
  v_mfma_f32_16x16x32_bf16 v[80:83], v[236:239], v[64:67], v[80:83]
  v_cvt_pk_bf16_f32 v126, v128, v129
  v_cvt_pk_bf16_f32 v127, v130, v131
  v_mfma_f32_16x16x32_bf16 v[80:83], v[224:227], v[180:183], v[80:83]
  v_cvt_pk_bf16_f32 v40, v76, v77
  v_cvt_pk_bf16_f32 v41, v78, v79
  v_mfma_f32_16x16x32_bf16 v[80:83], v[212:215], a[252:255], v[80:83]
  ds_write_b128 v4, v[124:127] offset:768
  v_mfma_f32_16x16x32_bf16 v[80:83], v[200:203], a[248:251], v[80:83]
  v_mul_f32 v140, v15, v140
  v_mul_f32 v141, v15, v141
  v_mfma_f32_16x16x32_bf16 v[80:83], v[188:191], a[244:247], v[80:83]
  v_mul_f32 v142, v15, v142
  v_mul_f32 v143, v15, v143
  v_mfma_f32_16x16x32_bf16 v[76:79], v[192:195], a[244:247], 0
  v_cvt_pk_bf16_f32 v140, v140, v141
  v_cvt_pk_bf16_f32 v141, v142, v143
  v_mfma_f32_16x16x32_bf16 v[76:79], v[204:207], a[248:251], v[76:79]
  ds_write_b64 v5, v[140:141] offset:768
  v_mfma_f32_16x16x32_bf16 v[76:79], v[216:219], a[252:255], v[76:79]
  v_cvt_pk_bf16_f32 v42, v80, v81
  v_cvt_pk_bf16_f32 v43, v82, v83
  v_mfma_f32_16x16x32_bf16 v[76:79], v[228:231], v[180:183], v[76:79]
  v_max3_f32 v9, v12, v13, v9
  v_mfma_f32_16x16x32_bf16 v[76:79], v[240:243], v[64:67], v[76:79]
  v_rcp_f32 v13, v13
  v_mfma_f32_16x16x32_bf16 v[76:79], v[252:255], v[68:71], v[76:79]
  v_mul_f32 v116, v14, v116
  v_mul_f32 v117, v14, v117
  v_mfma_f32_16x16x32_bf16 v[80:83], a[60:63], v[68:71], 0
  v_mul_f32 v118, v14, v118
  v_mul_f32 v119, v14, v119
  v_mfma_f32_16x16x32_bf16 v[80:83], a[48:51], v[64:67], v[80:83]
  v_cvt_pk_bf16_f32 v116, v116, v117
  v_cvt_pk_bf16_f32 v117, v118, v119
  v_mfma_f32_16x16x32_bf16 v[80:83], a[36:39], v[180:183], v[80:83]
  v_cvt_pk_bf16_f32 v44, v76, v77
  v_cvt_pk_bf16_f32 v45, v78, v79
  v_mfma_f32_16x16x32_bf16 v[80:83], a[24:27], a[252:255], v[80:83]
  v_mul_f32 v120, v14, v120
  v_mul_f32 v121, v14, v121
  v_mfma_f32_16x16x32_bf16 v[80:83], a[12:15], a[248:251], v[80:83]
  v_mul_f32 v122, v14, v122
  v_mul_f32 v123, v14, v123
  v_mfma_f32_16x16x32_bf16 v[80:83], a[0:3], a[244:247], v[80:83]
  v_cvt_pk_bf16_f32 v118, v120, v121
  v_cvt_pk_bf16_f32 v119, v122, v123
  v_mfma_f32_16x16x32_bf16 v[76:79], a[4:7], a[244:247], 0
  ds_write_b128 v4, v[116:119] offset:512
  v_mfma_f32_16x16x32_bf16 v[76:79], a[16:19], a[248:251], v[76:79]
  v_mul_f32 v156, v14, v156
  v_mul_f32 v157, v14, v157
  v_mfma_f32_16x16x32_bf16 v[76:79], a[28:31], a[252:255], v[76:79]
  v_cvt_pk_bf16_f32 v46, v80, v81
  v_cvt_pk_bf16_f32 v47, v82, v83
  v_mfma_f32_16x16x32_bf16 v[76:79], a[40:43], v[180:183], v[76:79]
  v_mul_f32 v158, v14, v158
  v_mul_f32 v159, v14, v159
  v_mfma_f32_16x16x32_bf16 v[76:79], a[52:55], v[64:67], v[76:79]
  v_cvt_pk_bf16_f32 v156, v156, v157
  v_cvt_pk_bf16_f32 v157, v158, v159
  v_mfma_f32_16x16x32_bf16 v[76:79], a[64:67], v[68:71], v[76:79]
  ds_write_b64 v5, v[156:157] offset:512
  v_mfma_f32_16x16x32_bf16 v[80:83], a[68:71], v[68:71], 0
  v_rcp_f32 v12, v12
  v_mfma_f32_16x16x32_bf16 v[80:83], a[56:59], v[64:67], v[80:83]
  v_mul_f32 v132, v13, v132
  v_mul_f32 v133, v13, v133
  v_mfma_f32_16x16x32_bf16 v[80:83], a[44:47], v[180:183], v[80:83]
  v_cvt_pk_bf16_f32 v48, v76, v77
  v_cvt_pk_bf16_f32 v49, v78, v79
  v_mfma_f32_16x16x32_bf16 v[80:83], a[32:35], a[252:255], v[80:83]
  v_mul_f32 v134, v13, v134
  v_mul_f32 v135, v13, v135
  v_mfma_f32_16x16x32_bf16 v[80:83], a[20:23], a[248:251], v[80:83]
  v_cvt_pk_bf16_f32 v132, v132, v133
  v_cvt_pk_bf16_f32 v133, v134, v135
  v_mfma_f32_16x16x32_bf16 v[80:83], a[8:11], a[244:247], v[80:83]
  v_mul_f32 v136, v13, v136
  v_mul_f32 v137, v13, v137
  v_mfma_f32_16x16x32_bf16 v[76:79], a[244:247], a[72:75], 0
  v_mul_f32 v138, v13, v138
  v_mul_f32 v139, v13, v139
  v_mfma_f32_16x16x32_bf16 v[76:79], a[248:251], a[84:87], v[76:79]
  v_cvt_pk_bf16_f32 v134, v136, v137
  v_cvt_pk_bf16_f32 v135, v138, v139
  v_mfma_f32_16x16x32_bf16 v[76:79], a[252:255], a[96:99], v[76:79]
  v_cvt_pk_bf16_f32 v50, v80, v81
  v_cvt_pk_bf16_f32 v51, v82, v83
  v_mfma_f32_16x16x32_bf16 v[76:79], v[180:183], a[108:111], v[76:79]
  ds_read_b128 v[72:75], v0 offset:2048
  v_mul_f32 v160, v13, v160
  v_mfma_f32_16x16x32_bf16 v[76:79], v[64:67], a[120:123], v[76:79]
  ds_read_b128 v[84:87], v1 offset:2048
  v_mul_f32 v161, v13, v161
  v_mfma_f32_16x16x32_bf16 v[76:79], v[68:71], a[132:135], v[76:79]
  ds_read_b128 v[164:167], v0 offset:10240
  v_mul_f32 v162, v13, v162
  v_mfma_f32_16x16x32_bf16 v[80:83], v[68:71], a[136:139], 0
  ds_read_b128 v[168:171], v1 offset:10240
  v_mul_f32 v163, v13, v163
  v_mfma_f32_16x16x32_bf16 v[80:83], v[64:67], a[124:127], v[80:83]
  ds_read_b128 v[176:179], v0 offset:18432
  v_cvt_pk_bf16_f32 v160, v160, v161
  v_mfma_f32_16x16x32_bf16 v[80:83], v[180:183], a[112:115], v[80:83]
  v_cvt_pk_bf16_f32 v16, v76, v77
  v_cvt_pk_bf16_f32 v17, v78, v79
  v_mfma_f32_16x16x32_bf16 v[80:83], a[252:255], a[100:103], v[80:83]
  ds_read_b128 v[144:147], v1 offset:18432
  v_cvt_pk_bf16_f32 v161, v162, v163
  v_mfma_f32_16x16x32_bf16 v[80:83], a[248:251], a[88:91], v[80:83]
  ds_write_b128 v4, v[132:135] offset:256
  v_mfma_f32_16x16x32_bf16 v[80:83], a[244:247], a[76:79], v[80:83]
  ds_write_b64 v5, v[160:161] offset:256
  v_mfma_f32_16x16x32_bf16 v[76:79], a[244:247], a[80:83], 0
  v_mul_f32 v148, v12, v148
  v_mul_f32 v149, v12, v149
  v_mfma_f32_16x16x32_bf16 v[76:79], a[248:251], a[92:95], v[76:79]
  v_mul_f32 v150, v12, v150
  v_mul_f32 v151, v12, v151
  v_mfma_f32_16x16x32_bf16 v[76:79], a[252:255], a[104:107], v[76:79]
  v_cvt_pk_bf16_f32 v24, v80, v81
  v_cvt_pk_bf16_f32 v25, v82, v83
  v_mfma_f32_16x16x32_bf16 v[76:79], v[180:183], a[116:119], v[76:79]
  v_cvt_pk_bf16_f32 v148, v148, v149
  v_cvt_pk_bf16_f32 v149, v150, v151
  v_mfma_f32_16x16x32_bf16 v[76:79], v[64:67], a[128:131], v[76:79]
  v_mul_f32 v152, v12, v152
  v_mul_f32 v153, v12, v153
  v_mfma_f32_16x16x32_bf16 v[76:79], v[68:71], a[140:143], v[76:79]
  s_waitcnt lgkmcnt(2)
  v_mul_f32 v154, v12, v154
  v_mfma_f32_16x16x32_bf16 v[80:83], v[184:187], v[72:75], 0
  v_mul_f32 v155, v12, v155
  v_cvt_pk_bf16_f32 v150, v152, v153
  v_mfma_f32_16x16x32_bf16 v[80:83], v[196:199], v[84:87], v[80:83]
  v_cvt_pk_bf16_f32 v151, v154, v155
  v_mul_f32 v172, v12, v172
  v_mfma_f32_16x16x32_bf16 v[80:83], v[208:211], v[164:167], v[80:83]
  v_cvt_pk_bf16_f32 v32, v76, v77
  v_cvt_pk_bf16_f32 v33, v78, v79
  v_mfma_f32_16x16x32_bf16 v[80:83], v[220:223], v[168:171], v[80:83]
  ds_write_b128 v4, v[148:151] offset:0
  v_mfma_f32_16x16x32_bf16 v[80:83], v[232:235], v[176:179], v[80:83]
  v_mul_f32 v173, v12, v173
  v_mul_f32 v174, v12, v174
  v_mfma_f32_16x16x32_bf16 v[80:83], v[244:247], v[144:147], v[80:83]
  v_mul_f32 v175, v12, v175
  v_cvt_pk_bf16_f32 v172, v172, v173
  v_mfma_f32_16x16x32_bf16 v[76:79], v[248:251], v[144:147], 0
  v_cvt_pk_bf16_f32 v173, v174, v175
  v_mfma_f32_16x16x32_bf16 v[76:79], v[236:239], v[176:179], v[76:79]
  ds_write_b64 v5, v[172:173] offset:0
  v_mfma_f32_16x16x32_bf16 v[76:79], v[224:227], v[168:171], v[76:79]
  v_cvt_pk_bf16_f32 v52, v80, v81
  v_cvt_pk_bf16_f32 v53, v82, v83
  v_mfma_f32_16x16x32_bf16 v[76:79], v[212:215], v[164:167], v[76:79]
  v_subrev_u32 v3, s7, v3
  v_subrev_u32 v2, s7, v2
  v_mfma_f32_16x16x32_bf16 v[76:79], v[200:203], v[84:87], v[76:79]
  v_add_u32 v4, s7, v4
  v_add_u32 v5, s7, v5
  v_mfma_f32_16x16x32_bf16 v[76:79], v[188:191], v[72:75], v[76:79]
  s_sub_u32 s7, 0, s7
  v_max3_f32 v9, v12, v13, v9
  v_mfma_f32_16x16x32_bf16 v[80:83], v[192:195], v[72:75], 0
  v_max3_f32 v9, v14, v15, v9
  v_accvgpr_read_b32 v180, a228
  v_mfma_f32_16x16x32_bf16 v[80:83], v[204:207], v[84:87], v[80:83]
  s_add_u32 m0, s58, 114688
  s_add_u32 s36, s58, 0
  v_mfma_f32_16x16x32_bf16 v[80:83], v[216:219], v[164:167], v[80:83]
  v_cvt_pk_bf16_f32 v54, v76, v77
  v_cvt_pk_bf16_f32 v55, v78, v79
  v_mfma_f32_16x16x32_bf16 v[80:83], v[228:231], v[168:171], v[80:83]
  buffer_load_dwordx4 v180, s[16:19], s36 offen offset:0 lds
  v_mfma_f32_16x16x32_bf16 v[80:83], v[240:243], v[176:179], v[80:83]
  s_add_u32 s37, s28, 4
  s_lshr_b32 s37, s37, 6
  v_mfma_f32_16x16x32_bf16 v[80:83], v[252:255], v[144:147], v[80:83]
  buffer_load_dwordx4 v180, s[16:19], s36 offen offset:1024 lds
  v_mfma_f32_16x16x32_bf16 v[76:79], a[60:63], v[144:147], 0
  s_add_u32 s39, s28, 1
  s_lshr_b32 s39, s39, 6
  v_mfma_f32_16x16x32_bf16 v[76:79], a[48:51], v[176:179], v[76:79]
  s_sub_u32 s62, s38, s28
  s_mulk_i32 s62, 3072
  v_mfma_f32_16x16x32_bf16 v[76:79], a[36:39], v[168:171], v[76:79]
  v_cvt_pk_bf16_f32 v56, v80, v81
  v_cvt_pk_bf16_f32 v57, v82, v83
  v_mfma_f32_16x16x32_bf16 v[76:79], a[24:27], v[164:167], v[76:79]
  buffer_load_dwordx4 v180, s[16:19], s36 offen offset:2048 lds
  v_mfma_f32_16x16x32_bf16 v[76:79], a[12:15], v[84:87], v[76:79]
  s_add_u32 s62, s62, s46
  s_mul_i32 s14, s37, -42
  v_mfma_f32_16x16x32_bf16 v[76:79], a[0:3], v[72:75], v[76:79]
  s_add_u32 m0, s58, 126976
  s_add_u32 s36, s58, 18432
  v_mfma_f32_16x16x32_bf16 v[80:83], a[4:7], v[72:75], 0
  buffer_load_dwordx4 v180, s[16:19], s36 offen offset:0 lds
  v_mfma_f32_16x16x32_bf16 v[80:83], a[16:19], v[84:87], v[80:83]
  s_addk_i32 s14, 128
  s_mul_i32 s15, s37, -3072
  v_mfma_f32_16x16x32_bf16 v[80:83], a[28:31], v[164:167], v[80:83]
  v_cvt_pk_bf16_f32 v58, v76, v77
  v_cvt_pk_bf16_f32 v59, v78, v79
  v_mfma_f32_16x16x32_bf16 v[80:83], a[40:43], v[168:171], v[80:83]
  s_add_u32 s15, s15, 1566720
  s_lshl3_add_u32 s12, s39, 48
  v_mfma_f32_16x16x32_bf16 v[80:83], a[52:55], v[176:179], v[80:83]
  buffer_load_dwordx4 v180, s[16:19], s36 offen offset:1024 lds
  v_mfma_f32_16x16x32_bf16 v[80:83], a[64:67], v[144:147], v[80:83]
  s_lshl2_add_u32 s13, s37, 104
  s_sub_u32 s13, s13, s12
  v_mfma_f32_16x16x32_bf16 v[76:79], a[68:71], v[144:147], 0
  s_or_b32 s39, s39, s31
  s_or_b32 s39, s39, s4
  v_mfma_f32_16x16x32_bf16 v[76:79], a[56:59], v[176:179], v[76:79]
L_hop2:
  s_cbranch_execz L_hopped
  buffer_load_dwordx4 v180, s[16:19], s36 offen offset:2048 lds
  v_mfma_f32_16x16x32_bf16 v[76:79], a[44:47], v[168:171], v[76:79]
  v_cvt_pk_bf16_f32 v60, v80, v81
  v_cvt_pk_bf16_f32 v61, v82, v83
  v_mfma_f32_16x16x32_bf16 v[76:79], a[32:35], v[164:167], v[76:79]
  s_lshl_b32 s39, s39, 8
  s_add_u32 s63, s12, s39
  v_mfma_f32_16x16x32_bf16 v[76:79], a[20:23], v[84:87], v[76:79]
  s_add_u32 m0, s58, 139264
  s_add_u32 s36, s58, 36864
  v_mfma_f32_16x16x32_bf16 v[76:79], a[8:11], v[72:75], v[76:79]
  buffer_load_dwordx4 v180, s[16:19], s36 offen offset:0 lds
  v_mfma_f32_16x16x32_bf16 v[80:83], v[72:75], a[72:75], 0
  s_waitcnt vmcnt(13)
  s_barrier
  v_mfma_f32_16x16x32_bf16 v[80:83], v[84:87], a[84:87], v[80:83]
  s_add_u32 s60, s63, s29
  s_sub_u32 s60, s60, 4
  v_mfma_f32_16x16x32_bf16 v[80:83], v[164:167], a[96:99], v[80:83]
  v_cvt_pk_bf16_f32 v62, v76, v77
  v_cvt_pk_bf16_f32 v63, v78, v79
  v_mfma_f32_16x16x32_bf16 v[80:83], v[168:171], a[108:111], v[80:83]
  ds_read_b128 v[116:119], v0 offset:4096
  ds_read_b128 v[124:127], v1 offset:4096
  v_mfma_f32_16x16x32_bf16 v[80:83], v[176:179], a[120:123], v[80:83]
  buffer_load_dwordx4 v180, s[16:19], s36 offen offset:1024 lds
  v_mfma_f32_16x16x32_bf16 v[80:83], v[144:147], a[132:135], v[80:83]
  ds_read_b128 v[120:123], v0 offset:12288
  ds_read_b128 v[128:131], v1 offset:12288
  v_mfma_f32_16x16x32_bf16 v[76:79], v[144:147], a[136:139], 0
  buffer_load_dwordx4 v180, s[16:19], s36 offen offset:2048 lds
  v_mfma_f32_16x16x32_bf16 v[76:79], v[176:179], a[124:127], v[76:79]
  ds_read_b128 v[132:135], v0 offset:20480
  ds_read_b128 v[140:143], v1 offset:20480
  v_mfma_f32_16x16x32_bf16 v[76:79], v[168:171], a[112:115], v[76:79]
  v_cvt_pk_bf16_f32 v18, v80, v81
  v_cvt_pk_bf16_f32 v19, v82, v83
  v_mfma_f32_16x16x32_bf16 v[76:79], v[164:167], a[100:103], v[76:79]
  s_add_u32 m0, s58, 151552
  s_add_u32 s36, s58, 55296
  v_mfma_f32_16x16x32_bf16 v[76:79], v[84:87], a[88:91], v[76:79]
  buffer_load_dwordx4 v180, s[16:19], s36 offen offset:0 lds
  v_mfma_f32_16x16x32_bf16 v[76:79], v[72:75], a[76:79], v[76:79]
  v_mfma_f32_16x16x32_bf16 v[80:83], v[72:75], a[80:83], 0
  v_mfma_f32_16x16x32_bf16 v[80:83], v[84:87], a[92:95], v[80:83]
  buffer_load_dwordx4 v180, s[16:19], s36 offen offset:1024 lds
  v_mfma_f32_16x16x32_bf16 v[80:83], v[164:167], a[104:107], v[80:83]
  v_cvt_pk_bf16_f32 v26, v76, v77
  v_cvt_pk_bf16_f32 v27, v78, v79
  v_mfma_f32_16x16x32_bf16 v[80:83], v[168:171], a[116:119], v[80:83]
  v_mfma_f32_16x16x32_bf16 v[80:83], v[176:179], a[128:131], v[80:83]
  buffer_load_dwordx4 v180, s[16:19], s36 offen offset:2048 lds
  v_mfma_f32_16x16x32_bf16 v[80:83], v[144:147], a[140:143], v[80:83]
  s_waitcnt lgkmcnt(0)
  v_mfma_f32_16x16x32_bf16 v[148:151], v[184:187], v[116:119], 0
  v_mfma_f32_16x16x32_bf16 v[148:151], v[196:199], v[124:127], v[148:151]
  s_add_u32 m0, s58, 0
  s_add_u32 s36, s59, 12288
  v_mfma_f32_16x16x32_bf16 v[148:151], v[208:211], v[120:123], v[148:151]
  v_cvt_pk_bf16_f32 v34, v80, v81
  v_cvt_pk_bf16_f32 v35, v82, v83
  v_mfma_f32_16x16x32_bf16 v[148:151], v[220:223], v[128:131], v[148:151]
  buffer_load_dwordx4 v180, s[16:19], s36 offen offset:0 lds
  v_mfma_f32_16x16x32_bf16 v[148:151], v[232:235], v[132:135], v[148:151]
  v_mfma_f32_16x16x32_bf16 v[148:151], v[244:247], v[140:143], v[148:151]
  buffer_load_dwordx4 v180, s[16:19], s36 offen offset:1024 lds
  v_mfma_f32_16x16x32_bf16 v[156:159], v[248:251], v[140:143], 0
  ds_read_b128 v[136:139], v0 offset:6144
  ds_read_b128 v[144:147], v1 offset:6144
  v_mfma_f32_16x16x32_bf16 v[156:159], v[236:239], v[132:135], v[156:159]
  v_mfma_f32_16x16x32_bf16 v[156:159], v[224:227], v[128:131], v[156:159]
  v_cvt_pk_bf16_f32 v64, v148, v149
  v_cvt_pk_bf16_f32 v65, v150, v151
  v_mfma_f32_16x16x32_bf16 v[156:159], v[212:215], v[120:123], v[156:159]
  ds_read_b128 v[152:155], v0 offset:14336
  ds_read_b128 v[160:163], v1 offset:14336
  v_mfma_f32_16x16x32_bf16 v[156:159], v[200:203], v[124:127], v[156:159]
  buffer_load_dwordx4 v180, s[16:19], s36 offen offset:2048 lds
  v_mfma_f32_16x16x32_bf16 v[156:159], v[188:191], v[116:119], v[156:159]
  ds_read_b128 v[164:167], v0 offset:22528
  ds_read_b128 v[172:175], v1 offset:22528
  v_mfma_f32_16x16x32_bf16 v[148:151], v[192:195], v[116:119], 0
  s_add_u32 m0, s58, 12288
  s_add_u32 s36, s59, 49152
  v_mfma_f32_16x16x32_bf16 v[148:151], v[204:207], v[124:127], v[148:151]
  buffer_load_dwordx4 v180, s[16:19], s36 offen offset:0 lds
  v_mfma_f32_16x16x32_bf16 v[148:151], v[216:219], v[120:123], v[148:151]
  v_cvt_pk_bf16_f32 v66, v156, v157
  v_cvt_pk_bf16_f32 v67, v158, v159
  v_mfma_f32_16x16x32_bf16 v[148:151], v[228:231], v[128:131], v[148:151]
  v_mfma_f32_16x16x32_bf16 v[148:151], v[240:243], v[132:135], v[148:151]
  buffer_load_dwordx4 v180, s[16:19], s36 offen offset:1024 lds
  v_mfma_f32_16x16x32_bf16 v[148:151], v[252:255], v[140:143], v[148:151]
  v_mfma_f32_16x16x32_bf16 v[156:159], a[60:63], v[140:143], 0
  v_mfma_f32_16x16x32_bf16 v[156:159], a[48:51], v[132:135], v[156:159]
  v_mfma_f32_16x16x32_bf16 v[156:159], a[36:39], v[128:131], v[156:159]
  v_cvt_pk_bf16_f32 v68, v148, v149
  v_cvt_pk_bf16_f32 v69, v150, v151
  v_mfma_f32_16x16x32_bf16 v[156:159], a[24:27], v[120:123], v[156:159]
  buffer_load_dwordx4 v180, s[16:19], s36 offen offset:2048 lds
  v_mfma_f32_16x16x32_bf16 v[156:159], a[12:15], v[124:127], v[156:159]
  v_accvgpr_read_b32 v180, a229
  v_accvgpr_read_b32 v181, a230
  v_mfma_f32_16x16x32_bf16 v[156:159], a[0:3], v[116:119], v[156:159]
  v_accvgpr_read_b32 v182, a231
  v_accvgpr_read_b32 v183, a232
  v_mfma_f32_16x16x32_bf16 v[148:151], a[4:7], v[116:119], 0
  s_add_u32 s48, s48, 6291456
  s_add_u32 s49, s48, 786432
  v_mfma_f32_16x16x32_bf16 v[148:151], a[16:19], v[124:127], v[148:151]
  s_sub_u32 s33, s32, 40960
  s_add_u32 s32, s33, 65536
  v_mfma_f32_16x16x32_bf16 v[148:151], a[28:31], v[120:123], v[148:151]
  v_cvt_pk_bf16_f32 v76, v156, v157
  v_cvt_pk_bf16_f32 v77, v158, v159
  v_mfma_f32_16x16x32_bf16 v[148:151], a[40:43], v[128:131], v[148:151]
  s_mov_b32 s35, 2
  s_mov_b64 vcc, 0
  v_mfma_f32_16x16x32_bf16 v[148:151], a[52:55], v[132:135], v[148:151]
  s_sub_u32 s50, s48, 12582912
  s_sub_u32 s51, s48, 6291456
  v_mfma_f32_16x16x32_bf16 v[148:151], a[64:67], v[140:143], v[148:151]
  s_sub_u32 s6, s48, 0
  s_add_u32 s44, s29, 8
  v_mfma_f32_16x16x32_bf16 v[156:159], a[68:71], v[140:143], 0
  s_mov_b32 s45, 0
  v_mov_b32 v11, 0
  v_mfma_f32_16x16x32_bf16 v[156:159], a[56:59], v[132:135], v[156:159]
  v_mad_i32_i16 v0, v10, 1, s32 op_sel:[1,0,0,0]
  v_xor_b32 v1, 64, v0
  v_mfma_f32_16x16x32_bf16 v[156:159], a[44:47], v[128:131], v[156:159]
  v_cvt_pk_bf16_f32 v78, v148, v149
  v_cvt_pk_bf16_f32 v79, v150, v151
  v_mfma_f32_16x16x32_bf16 v[156:159], a[32:35], v[120:123], v[156:159]
  s_waitcnt lgkmcnt(0)
  s_waitcnt vmcnt(9)
  s_barrier
  v_mfma_f32_16x16x32_bf16 v[156:159], a[20:23], v[124:127], v[156:159]
  s_add_u32 m0, s33, 40960
  ds_read_b64_tr_b16 a[144:145], v180 offset:0
  v_mfma_f32_16x16x32_bf16 v[156:159], a[8:11], v[116:119], v[156:159]
  buffer_load_dwordx4 v6, s[8:11], s48 offen offset:0 nt lds
  v_mfma_f32_16x16x32_bf16 v[148:151], v[116:119], a[72:75], 0
  ds_read_b64_tr_b16 a[146:147], v180 offset:6144
  ds_read_b64_tr_b16 a[148:149], v180 offset:8
  v_mfma_f32_16x16x32_bf16 v[148:151], v[124:127], a[84:87], v[148:151]
  ds_read_b64_tr_b16 a[150:151], v180 offset:6152
  v_mfma_f32_16x16x32_bf16 v[148:151], v[120:123], a[96:99], v[148:151]
  v_cvt_pk_bf16_f32 v80, v156, v157
  v_cvt_pk_bf16_f32 v81, v158, v159
  v_mfma_f32_16x16x32_bf16 v[148:151], v[128:131], a[108:111], v[148:151]
  s_add_u32 m0, s33, 49024
  ds_read_b64_tr_b16 a[152:153], v181 offset:0
  v_mfma_f32_16x16x32_bf16 v[148:151], v[132:135], a[120:123], v[148:151]
  buffer_load_dwordx4 v6, s[8:11], s48 offen offset:128 nt lds
  v_mfma_f32_16x16x32_bf16 v[148:151], v[140:143], a[132:135], v[148:151]
  ds_read_b64_tr_b16 a[154:155], v181 offset:6144
  ds_read_b64_tr_b16 a[156:157], v181 offset:8
  v_mfma_f32_16x16x32_bf16 v[156:159], v[140:143], a[136:139], 0
  ds_read_b64_tr_b16 a[158:159], v181 offset:6152
  v_mfma_f32_16x16x32_bf16 v[156:159], v[132:135], a[124:127], v[156:159]
  s_add_u32 m0, s33, 57088
  ds_read_b64_tr_b16 a[160:161], v180 offset:12288
  v_mfma_f32_16x16x32_bf16 v[156:159], v[128:131], a[112:115], v[156:159]
  v_cvt_pk_bf16_f32 v20, v148, v149
  v_cvt_pk_bf16_f32 v21, v150, v151
  v_mfma_f32_16x16x32_bf16 v[156:159], v[120:123], a[100:103], v[156:159]
  buffer_load_dwordx4 v6, s[8:11], s48 offen offset:256 nt lds
  v_mfma_f32_16x16x32_bf16 v[156:159], v[124:127], a[88:91], v[156:159]
  ds_read_b64_tr_b16 a[162:163], v180 offset:18432
  ds_read_b64_tr_b16 a[164:165], v180 offset:12296
  v_mfma_f32_16x16x32_bf16 v[156:159], v[116:119], a[76:79], v[156:159]
  ds_read_b64_tr_b16 a[166:167], v180 offset:18440
  v_mfma_f32_16x16x32_bf16 v[148:151], v[116:119], a[80:83], 0
  ds_read_b64_tr_b16 a[168:169], v181 offset:12288
  ds_read_b64_tr_b16 a[170:171], v181 offset:18432
  v_mfma_f32_16x16x32_bf16 v[148:151], v[124:127], a[92:95], v[148:151]
  s_add_u32 m0, s33, 45056
  ds_read_b64_tr_b16 a[172:173], v181 offset:12296
  v_mfma_f32_16x16x32_bf16 v[148:151], v[120:123], a[104:107], v[148:151]
  v_cvt_pk_bf16_f32 v28, v156, v157
  v_cvt_pk_bf16_f32 v29, v158, v159
  v_mfma_f32_16x16x32_bf16 v[148:151], v[128:131], a[116:119], v[148:151]
  buffer_load_dwordx4 v6, s[8:11], s49 offen offset:0 nt lds
  v_mfma_f32_16x16x32_bf16 v[148:151], v[132:135], a[128:131], v[148:151]
  ds_read_b64_tr_b16 a[174:175], v181 offset:18440
  v_mfma_f32_16x16x32_bf16 v[148:151], v[140:143], a[140:143], v[148:151]
  ds_read_b64_tr_b16 a[176:177], v180 offset:24576
  v_mfma_f32_16x16x32_bf16 v[168:171], v[184:187], v[136:139], 0
  s_add_u32 m0, s33, 53120
  ds_read_b64_tr_b16 a[178:179], v180 offset:30720
  v_mfma_f32_16x16x32_bf16 v[168:171], v[196:199], v[144:147], v[168:171]
  s_waitcnt vmcnt(4)
  s_barrier
  v_mfma_f32_16x16x32_bf16 v[168:171], v[208:211], v[152:155], v[168:171]
  v_cvt_pk_bf16_f32 v36, v148, v149
  v_cvt_pk_bf16_f32 v37, v150, v151
  v_mfma_f32_16x16x32_bf16 v[168:171], v[220:223], v[160:163], v[168:171]
  buffer_load_dwordx4 v6, s[8:11], s49 offen offset:128 nt lds
  v_mfma_f32_16x16x32_bf16 v[168:171], v[232:235], v[164:167], v[168:171]
  ds_read_b64_tr_b16 a[180:181], v180 offset:24584
  ds_read_b64_tr_b16 a[182:183], v180 offset:30728
  v_mfma_f32_16x16x32_bf16 v[168:171], v[244:247], v[172:175], v[168:171]
  s_add_u32 m0, s33, 61184
  ds_read_b64_tr_b16 a[184:185], v181 offset:24576
  v_mfma_f32_16x16x32_bf16 v[176:179], v[248:251], v[172:175], 0
  buffer_load_dwordx4 v6, s[8:11], s49 offen offset:256 nt lds
  v_mfma_f32_16x16x32_bf16 v[176:179], v[236:239], v[164:167], v[176:179]
  ds_read_b64_tr_b16 a[186:187], v181 offset:30720
  s_add_u32 s48, s48, 6291456
  v_mfma_f32_16x16x32_bf16 v[176:179], v[224:227], v[160:163], v[176:179]
  v_cvt_pk_bf16_f32 v70, v168, v169
  v_cvt_pk_bf16_f32 v71, v170, v171
  v_mfma_f32_16x16x32_bf16 v[176:179], v[212:215], v[152:155], v[176:179]
  ds_read_b64_tr_b16 a[188:189], v181 offset:24584
  ds_read_b64_tr_b16 a[190:191], v181 offset:30728
  v_mfma_f32_16x16x32_bf16 v[176:179], v[200:203], v[144:147], v[176:179]
  ds_read_b64_tr_b16 a[192:193], v180 offset:36864
  s_add_u32 s49, s48, 786432
  v_mfma_f32_16x16x32_bf16 v[176:179], v[188:191], v[136:139], v[176:179]
  ds_read_b64_tr_b16 a[194:195], v180 offset:43008
  ds_read_b64_tr_b16 a[196:197], v180 offset:36872
  v_mfma_f32_16x16x32_bf16 v[168:171], v[192:195], v[136:139], 0
  ds_read_b64_tr_b16 a[198:199], v180 offset:43016
  v_mfma_f32_16x16x32_bf16 v[168:171], v[204:207], v[144:147], v[168:171]
  ds_read_b64_tr_b16 a[200:201], v181 offset:36864
  v_mfma_f32_16x16x32_bf16 v[168:171], v[216:219], v[152:155], v[168:171]
  v_cvt_pk_bf16_f32 v72, v176, v177
  v_cvt_pk_bf16_f32 v73, v178, v179
  v_mfma_f32_16x16x32_bf16 v[168:171], v[228:231], v[160:163], v[168:171]
  ds_read_b64_tr_b16 a[202:203], v181 offset:43008
  v_mfma_f32_16x16x32_bf16 v[168:171], v[240:243], v[164:167], v[168:171]
  ds_read_b64_tr_b16 a[204:205], v181 offset:36872
  v_mfma_f32_16x16x32_bf16 v[168:171], v[252:255], v[172:175], v[168:171]
  ds_read_b64_tr_b16 a[206:207], v181 offset:43016
  v_mfma_f32_16x16x32_bf16 v[176:179], a[60:63], v[172:175], 0
  ds_read_b64_tr_b16 a[208:209], v182 offset:0
  v_mfma_f32_16x16x32_bf16 v[176:179], a[48:51], v[164:167], v[176:179]
  ds_read_b64_tr_b16 a[210:211], v182 offset:1536
  v_mfma_f32_16x16x32_bf16 v[176:179], a[36:39], v[160:163], v[176:179]
  v_cvt_pk_bf16_f32 v74, v168, v169
  v_cvt_pk_bf16_f32 v75, v170, v171
  v_mfma_f32_16x16x32_bf16 v[176:179], a[24:27], v[152:155], v[176:179]
  ds_read_b64_tr_b16 a[212:213], v182 offset:8
  v_mfma_f32_16x16x32_bf16 v[176:179], a[12:15], v[144:147], v[176:179]
  ds_read_b64_tr_b16 a[214:215], v182 offset:1544
  v_mfma_f32_16x16x32_bf16 v[176:179], a[0:3], v[136:139], v[176:179]
  ds_read_b64_tr_b16 a[216:217], v183 offset:0
  v_mfma_f32_16x16x32_bf16 v[168:171], a[4:7], v[136:139], 0
  ds_read_b64_tr_b16 a[218:219], v183 offset:1536
  v_mfma_f32_16x16x32_bf16 v[168:171], a[16:19], v[144:147], v[168:171]
  ds_read_b64_tr_b16 a[220:221], v183 offset:8
  v_mfma_f32_16x16x32_bf16 v[168:171], a[28:31], v[152:155], v[168:171]
  v_cvt_pk_bf16_f32 v82, v176, v177
  v_cvt_pk_bf16_f32 v83, v178, v179
  v_mfma_f32_16x16x32_bf16 v[168:171], a[40:43], v[160:163], v[168:171]
  ds_read_b64_tr_b16 a[222:223], v183 offset:1544
  v_mfma_f32_16x16x32_bf16 v[168:171], a[52:55], v[164:167], v[168:171]
  ds_read_b64_tr_b16 a[224:225], v182 offset:12288
  v_mfma_f32_16x16x32_bf16 v[168:171], a[64:67], v[172:175], v[168:171]
  ds_read_b64_tr_b16 a[226:227], v182 offset:13824
  v_mfma_f32_16x16x32_bf16 v[176:179], a[68:71], v[172:175], 0
  ds_read_b64_tr_b16 a[228:229], v182 offset:12296
  v_mfma_f32_16x16x32_bf16 v[176:179], a[56:59], v[164:167], v[176:179]
  ds_read_b64_tr_b16 a[230:231], v182 offset:13832
  v_mfma_f32_16x16x32_bf16 v[176:179], a[44:47], v[160:163], v[176:179]
  v_cvt_pk_bf16_f32 v84, v168, v169
  v_cvt_pk_bf16_f32 v85, v170, v171
  v_mfma_f32_16x16x32_bf16 v[176:179], a[32:35], v[152:155], v[176:179]
  ds_read_b64_tr_b16 a[232:233], v183 offset:12288
  v_mfma_f32_16x16x32_bf16 v[176:179], a[20:23], v[144:147], v[176:179]
  ds_read_b64_tr_b16 a[234:235], v183 offset:13824
  v_mfma_f32_16x16x32_bf16 v[176:179], a[8:11], v[136:139], v[176:179]
  ds_read_b64_tr_b16 a[236:237], v183 offset:12296
  v_mfma_f32_16x16x32_bf16 v[168:171], v[136:139], a[72:75], 0
  ds_read_b64_tr_b16 a[238:239], v183 offset:13832
  v_mfma_f32_16x16x32_bf16 v[168:171], v[144:147], a[84:87], v[168:171]
  v_mfma_f32_16x16x32_bf16 v[168:171], v[152:155], a[96:99], v[168:171]
  v_cvt_pk_bf16_f32 v86, v176, v177
  v_cvt_pk_bf16_f32 v87, v178, v179
  v_mfma_f32_16x16x32_bf16 v[168:171], v[160:163], a[108:111], v[168:171]
  v_mfma_f32_16x16x32_bf16 v[168:171], v[164:167], a[120:123], v[168:171]
  v_mfma_f32_16x16x32_bf16 v[168:171], v[172:175], a[132:135], v[168:171]
  v_mfma_f32_16x16x32_bf16 v[176:179], v[172:175], a[136:139], 0
  s_waitcnt lgkmcnt(0)
  s_waitcnt vmcnt(24)
  s_barrier
  v_mfma_f32_16x16x32_bf16 v[176:179], v[164:167], a[124:127], v[176:179]
  v_mfma_f32_16x16x32_bf16 v[176:179], v[160:163], a[112:115], v[176:179]
  v_cvt_pk_bf16_f32 v22, v168, v169
  v_cvt_pk_bf16_f32 v23, v170, v171
  v_mfma_f32_16x16x32_bf16 v[176:179], v[152:155], a[100:103], v[176:179]
  ds_read_b128 a[244:247], v3 offset:0
  v_mfma_f32_16x16x32_bf16 v[176:179], v[144:147], a[88:91], v[176:179]
  ds_read_b128 a[248:251], v3 offset:4096
  v_mfma_f32_16x16x32_bf16 v[176:179], v[136:139], a[76:79], v[176:179]
  ds_read_b128 a[252:255], v3 offset:8192
  v_mfma_f32_16x16x32_bf16 v[168:171], v[136:139], a[80:83], 0
  ds_read_b128 v[180:183], v3 offset:12288
  v_mfma_f32_16x16x32_bf16 v[168:171], v[144:147], a[92:95], v[168:171]
  v_mfma_f32_16x16x32_bf16 v[168:171], v[152:155], a[104:107], v[168:171]
  v_cvt_pk_bf16_f32 v30, v176, v177
  v_cvt_pk_bf16_f32 v31, v178, v179
  v_mfma_f32_16x16x32_bf16 v[168:171], v[160:163], a[116:119], v[168:171]
  s_cmp_lg_u32 s31, 0
  v_mfma_f32_16x16x32_bf16 v[168:171], v[164:167], a[128:131], v[168:171]
  v_mfma_f32_16x16x32_bf16 v[168:171], v[172:175], a[140:143], v[168:171]
  s_cbranch_scc0 L_s
  s_branch L_special
.fill (0x4000 - 768 + standalone__window_attn_swin__vision_kernel - .) / 4, 4, 0xbf810000
L_hop3:
  s_branch L_hopped
  s_nop 0
L_s:
  v_mfma_f32_16x16x32_bf16 v[116:119], v[46:49], v[70:73], v[112:115]
  v_mfma_f32_16x16x32_bf16 v[124:127], v[58:61], v[70:73], v[108:111]
  v_mfma_f32_16x16x32_bf16 v[120:123], v[76:79], v[70:73], v[104:107]
  v_cvt_pk_bf16_f32 v38, v168, v169
  v_cvt_pk_bf16_f32 v39, v170, v171
  v_mfma_f32_16x16x32_bf16 v[128:131], v[82:85], v[70:73], v[100:103]
  v_mfma_f32_16x16x16_bf16 v[116:119], v[50:51], v[74:75], v[116:119]
  v_mfma_f32_16x16x16_bf16 v[124:127], v[62:63], v[74:75], v[124:127]
  v_mfma_f32_16x16x16_bf16 v[120:123], v[80:81], v[74:75], v[120:123]
  v_mfma_f32_16x16x16_bf16 v[128:131], v[86:87], v[74:75], v[128:131]
  v_exp_f32 v116, v116
  v_mfma_f32_16x16x16_bf16 v[132:135], v[50:51], v[68:69], v[108:111]
  v_exp_f32 v117, v117
  v_mfma_f32_16x16x16_bf16 v[140:143], v[62:63], v[68:69], v[104:107]
  v_exp_f32 v118, v118
  v_mfma_f32_16x16x16_bf16 v[136:139], v[80:81], v[68:69], v[100:103]
  v_exp_f32 v119, v119
  v_mfma_f32_16x16x16_bf16 v[144:147], v[86:87], v[68:69], v[96:99]
  v_cvt_pk_bf16_f32 v116, v116, v117
  v_cvt_pk_bf16_f32 v117, v118, v119
  v_mfma_f32_16x16x16_bf16 v[148:151], v[50:51], v[56:57], v[104:107]
  v_exp_f32 v124, v124
  v_mfma_f32_16x16x16_bf16 v[156:159], v[62:63], v[56:57], v[100:103]
  v_exp_f32 v125, v125
  v_mfma_f32_16x16x16_bf16 v[152:155], v[80:81], v[56:57], v[96:99]
  v_exp_f32 v126, v126
  v_mfma_f32_16x16x16_bf16 v[160:163], v[86:87], v[56:57], v[92:95]
  v_exp_f32 v127, v127
  v_mfma_f32_16x16x16_bf16 v[164:167], v[50:51], v[44:45], v[100:103]
  v_cvt_pk_bf16_f32 v118, v124, v125
  v_cvt_pk_bf16_f32 v119, v126, v127
  v_mfma_f32_16x16x16_bf16 v[172:175], v[62:63], v[44:45], v[96:99]
  v_exp_f32 v120, v120
  v_mfma_f32_16x16x16_bf16 v[168:171], v[80:81], v[44:45], v[92:95]
  v_exp_f32 v121, v121
  v_mfma_f32_16x16x16_bf16 v[176:179], v[86:87], v[44:45], v[88:91]
  v_exp_f32 v122, v122
  v_mfma_f32_16x16x32_bf16 v[132:135], v[46:49], v[64:67], v[132:135]
  v_exp_f32 v123, v123
  v_mfma_f32_16x16x32_bf16 v[140:143], v[58:61], v[64:67], v[140:143]
  v_cvt_pk_bf16_f32 v120, v120, v121
  v_cvt_pk_bf16_f32 v121, v122, v123
  v_mfma_f32_16x16x32_bf16 v[136:139], v[76:79], v[64:67], v[136:139]
  v_exp_f32 v128, v128
  v_mfma_f32_16x16x32_bf16 v[144:147], v[82:85], v[64:67], v[144:147]
  ds_read_b128 v[64:67], v3 offset:16384
  ds_read_b128 v[68:71], v3 offset:20480
  v_mfma_f32_16x16x32_bf16 v[148:151], v[46:49], v[52:55], v[148:151]
  v_exp_f32 v129, v129
  v_mfma_f32_16x16x32_bf16 v[156:159], v[58:61], v[52:55], v[156:159]
  v_exp_f32 v130, v130
  v_mfma_f32_16x16x32_bf16 v[152:155], v[76:79], v[52:55], v[152:155]
  v_exp_f32 v131, v131
  v_mfma_f32_16x16x32_bf16 v[160:163], v[82:85], v[52:55], v[160:163]
  v_cvt_pk_bf16_f32 v122, v128, v129
  v_cvt_pk_bf16_f32 v123, v130, v131
  v_mfma_f32_16x16x32_bf16 v[164:167], v[46:49], v[40:43], v[164:167]
  v_exp_f32 v132, v132
  v_mfma_f32_16x16x32_bf16 v[172:175], v[58:61], v[40:43], v[172:175]
  v_exp_f32 v133, v133
  v_mfma_f32_16x16x32_bf16 v[168:171], v[76:79], v[40:43], v[168:171]
  v_exp_f32 v134, v134
  v_mfma_f32_16x16x32_bf16 v[176:179], v[82:85], v[40:43], v[176:179]
  s_waitcnt lgkmcnt(0)
  v_cvt_pk_bf16_f32 v132, v132, v133
L_pj:
  v_mfma_f32_16x16x32_bf16 v[40:43], a[144:147], a[244:247], 0
  ds_read_b128 v[72:75], v3 offset:256
  ds_read_b128 v[56:59], v3 offset:4352
  v_mfma_f32_16x16x32_bf16 v[40:43], a[160:163], a[248:251], v[40:43]
  v_exp_f32 v135, v135
  v_mfma_f32_16x16x32_bf16 v[40:43], a[176:179], a[252:255], v[40:43]
  ds_read_b128 v[60:63], v3 offset:8448
  ds_read_b128 v[76:79], v3 offset:12544
  v_mfma_f32_16x16x32_bf16 v[40:43], a[192:195], v[180:183], v[40:43]
  v_exp_f32 v140, v140
  v_mfma_f32_16x16x32_bf16 v[40:43], a[208:211], v[64:67], v[40:43]
  ds_read_b128 v[80:83], v3 offset:16640
  ds_read_b128 v[84:87], v3 offset:20736
  v_mfma_f32_16x16x32_bf16 v[40:43], a[224:227], v[68:71], v[40:43]
  v_exp_f32 v141, v141
  v_mfma_f32_16x16x32_bf16 v[44:47], a[228:231], v[68:71], 0
  v_cvt_pk_bf16_f32 v133, v134, v135
  v_cvt_pk_bf16_f32 v134, v140, v141
  v_mfma_f32_16x16x32_bf16 v[44:47], a[212:215], v[64:67], v[44:47]
  v_exp_f32 v142, v142
  v_mfma_f32_16x16x32_bf16 v[44:47], a[196:199], v[180:183], v[44:47]
  v_cvt_pk_bf16_f32 v40, v40, v41
  v_cvt_pk_bf16_f32 v41, v42, v43
  v_mfma_f32_16x16x32_bf16 v[44:47], a[180:183], a[252:255], v[44:47]
  ds_read_b128 v[124:127], v2 offset:512
  ds_read_b128 v[128:131], v2 offset:4608
  v_mfma_f32_16x16x32_bf16 v[44:47], a[164:167], a[248:251], v[44:47]
  v_exp_f32 v143, v143
  v_mfma_f32_16x16x32_bf16 v[44:47], a[148:151], a[244:247], v[44:47]
  s_waitcnt lgkmcnt(2)
  v_cvt_pk_bf16_f32 v135, v142, v143
  v_mfma_f32_16x16x32_bf16 v[48:51], a[144:147], v[72:75], 0
  ds_read_b128 a[244:247], v2 offset:8704
  ds_read_b128 a[248:251], v2 offset:12800
  v_mfma_f32_16x16x32_bf16 v[48:51], a[160:163], v[56:59], v[48:51]
  v_exp_f32 v136, v136
  v_mfma_f32_16x16x32_bf16 v[48:51], a[176:179], v[60:63], v[48:51]
  v_cvt_pk_bf16_f32 v42, v44, v45
  v_cvt_pk_bf16_f32 v43, v46, v47
  v_mfma_f32_16x16x32_bf16 v[48:51], a[192:195], v[76:79], v[48:51]
  buffer_store_dwordx4 v[40:43], v7, s[24:27], s40 offen nt
  v_mfma_f32_16x16x32_bf16 v[48:51], a[208:211], v[80:83], v[48:51]
  ds_read_b128 a[252:255], v2 offset:16896
  ds_read_b128 v[180:183], v2 offset:20992
  v_mfma_f32_16x16x32_bf16 v[48:51], a[224:227], v[84:87], v[48:51]
  v_exp_f32 v137, v137
  v_mfma_f32_16x16x32_bf16 v[52:55], a[228:231], v[84:87], 0
  v_exp_f32 v138, v138
  v_mfma_f32_16x16x32_bf16 v[52:55], a[212:215], v[80:83], v[52:55]
  v_exp_f32 v139, v139
  v_mfma_f32_16x16x32_bf16 v[52:55], a[196:199], v[76:79], v[52:55]
  v_cvt_pk_bf16_f32 v48, v48, v49
  v_cvt_pk_bf16_f32 v49, v50, v51
  v_mfma_f32_16x16x32_bf16 v[52:55], a[180:183], v[60:63], v[52:55]
  v_cvt_pk_bf16_f32 v136, v136, v137
  v_cvt_pk_bf16_f32 v137, v138, v139
  v_mfma_f32_16x16x32_bf16 v[52:55], a[164:167], v[56:59], v[52:55]
  v_exp_f32 v144, v144
  v_mfma_f32_16x16x32_bf16 v[52:55], a[148:151], v[72:75], v[52:55]
  s_waitcnt lgkmcnt(0)
  v_mfma_f32_16x16x32_bf16 v[40:43], a[144:147], v[124:127], 0
  v_exp_f32 v145, v145
  v_mfma_f32_16x16x32_bf16 v[40:43], a[160:163], v[128:131], v[40:43]
  v_exp_f32 v146, v146
  v_mfma_f32_16x16x32_bf16 v[40:43], a[176:179], a[244:247], v[40:43]
  v_cvt_pk_bf16_f32 v50, v52, v53
  v_cvt_pk_bf16_f32 v51, v54, v55
  v_mfma_f32_16x16x32_bf16 v[40:43], a[192:195], a[248:251], v[40:43]
  buffer_store_dwordx4 v[48:51], v7, s[24:27], s41 offen nt
  v_mfma_f32_16x16x32_bf16 v[40:43], a[208:211], a[252:255], v[40:43]
  ds_read_b128 v[72:75], v2 offset:768
  ds_read_b128 v[56:59], v2 offset:4864
  v_mfma_f32_16x16x32_bf16 v[40:43], a[224:227], v[180:183], v[40:43]
  v_exp_f32 v147, v147
  v_mfma_f32_16x16x32_bf16 v[44:47], a[228:231], v[180:183], 0
  ds_read_b128 v[60:63], v2 offset:8960
  ds_read_b128 v[76:79], v2 offset:13056
  v_mfma_f32_16x16x32_bf16 v[44:47], a[212:215], a[252:255], v[44:47]
  v_cvt_pk_bf16_f32 v138, v144, v145
  v_cvt_pk_bf16_f32 v139, v146, v147
  v_mfma_f32_16x16x32_bf16 v[44:47], a[196:199], a[248:251], v[44:47]
  v_cvt_pk_bf16_f32 v40, v40, v41
  v_cvt_pk_bf16_f32 v41, v42, v43
  v_mfma_f32_16x16x32_bf16 v[44:47], a[180:183], a[244:247], v[44:47]
  ds_read_b128 v[80:83], v2 offset:17152
  ds_read_b128 v[84:87], v2 offset:21248
  v_mfma_f32_16x16x32_bf16 v[44:47], a[164:167], v[128:131], v[44:47]
  v_exp_f32 v148, v148
  v_mfma_f32_16x16x32_bf16 v[44:47], a[148:151], v[124:127], v[44:47]
  v_exp_f32 v149, v149
  v_mfma_f32_16x16x32_bf16 v[48:51], a[152:155], v[124:127], 0
  v_mov_b64 v[144:145], 0
  v_cvt_pk_bf16_f32 v148, v148, v149
  v_mfma_f32_16x16x32_bf16 v[48:51], a[168:171], v[128:131], v[48:51]
  v_exp_f32 v150, v150
  v_mfma_f32_16x16x32_bf16 v[48:51], a[184:187], a[244:247], v[48:51]
  v_cvt_pk_bf16_f32 v42, v44, v45
  v_cvt_pk_bf16_f32 v43, v46, v47
  v_mfma_f32_16x16x32_bf16 v[48:51], a[200:203], a[248:251], v[48:51]
  buffer_store_dwordx4 v[40:43], v7, s[24:27], s42 offen nt
  v_mfma_f32_16x16x32_bf16 v[48:51], a[216:219], a[252:255], v[48:51]
  v_exp_f32 v151, v151
  v_mfma_f32_16x16x32_bf16 v[48:51], a[232:235], v[180:183], v[48:51]
  v_exp_f32 v156, v156
  v_mfma_f32_16x16x32_bf16 v[52:55], a[236:239], v[180:183], 0
  v_exp_f32 v157, v157
  v_mfma_f32_16x16x32_bf16 v[52:55], a[220:223], a[252:255], v[52:55]
  v_cvt_pk_bf16_f32 v149, v150, v151
  v_cvt_pk_bf16_f32 v150, v156, v157
  v_mfma_f32_16x16x32_bf16 v[52:55], a[204:207], a[248:251], v[52:55]
  v_cvt_pk_bf16_f32 v48, v48, v49
  v_cvt_pk_bf16_f32 v49, v50, v51
  v_mfma_f32_16x16x32_bf16 v[52:55], a[188:191], a[244:247], v[52:55]
  v_exp_f32 v158, v158
  v_mfma_f32_16x16x32_bf16 v[52:55], a[172:175], v[128:131], v[52:55]
  v_exp_f32 v159, v159
  v_mfma_f32_16x16x32_bf16 v[52:55], a[156:159], v[124:127], v[52:55]
  s_waitcnt lgkmcnt(0)
  v_cvt_pk_bf16_f32 v151, v158, v159
  v_mfma_f32_16x16x32_bf16 v[40:43], a[144:147], v[72:75], 0
  v_exp_f32 v152, v152
  v_mfma_f32_16x16x32_bf16 v[40:43], a[160:163], v[56:59], v[40:43]
  v_exp_f32 v153, v153
  v_mfma_f32_16x16x32_bf16 v[40:43], a[176:179], v[60:63], v[40:43]
  v_cvt_pk_bf16_f32 v50, v52, v53
  v_cvt_pk_bf16_f32 v51, v54, v55
  v_mfma_f32_16x16x32_bf16 v[40:43], a[192:195], v[76:79], v[40:43]
  buffer_store_dwordx4 v[48:51], v8, s[24:27], s42 offen nt
  v_mfma_f32_16x16x32_bf16 v[40:43], a[208:211], v[80:83], v[40:43]
  v_exp_f32 v154, v154
  v_mfma_f32_16x16x32_bf16 v[40:43], a[224:227], v[84:87], v[40:43]
  v_exp_f32 v155, v155
  v_mfma_f32_16x16x32_bf16 v[44:47], a[228:231], v[84:87], 0
  v_cvt_pk_bf16_f32 v152, v152, v153
  v_cvt_pk_bf16_f32 v153, v154, v155
  v_mfma_f32_16x16x32_bf16 v[44:47], a[212:215], v[80:83], v[44:47]
  v_exp_f32 v160, v160
  v_mfma_f32_16x16x32_bf16 v[44:47], a[196:199], v[76:79], v[44:47]
  v_cvt_pk_bf16_f32 v40, v40, v41
  v_cvt_pk_bf16_f32 v41, v42, v43
  v_mfma_f32_16x16x32_bf16 v[44:47], a[180:183], v[60:63], v[44:47]
  v_exp_f32 v161, v161
  v_mfma_f32_16x16x32_bf16 v[44:47], a[164:167], v[56:59], v[44:47]
  v_exp_f32 v162, v162
  v_mfma_f32_16x16x32_bf16 v[44:47], a[148:151], v[72:75], v[44:47]
  v_exp_f32 v163, v163
  v_mfma_f32_16x16x32_bf16 v[48:51], a[152:155], v[72:75], 0
  v_cvt_pk_bf16_f32 v154, v160, v161
  v_cvt_pk_bf16_f32 v155, v162, v163
  v_mfma_f32_16x16x32_bf16 v[48:51], a[168:171], v[56:59], v[48:51]
  v_exp_f32 v164, v164
  v_mfma_f32_16x16x32_bf16 v[48:51], a[184:187], v[60:63], v[48:51]
  v_cvt_pk_bf16_f32 v42, v44, v45
  v_cvt_pk_bf16_f32 v43, v46, v47
  v_mfma_f32_16x16x32_bf16 v[48:51], a[200:203], v[76:79], v[48:51]
  buffer_store_dwordx4 v[40:43], v7, s[24:27], s43 offen nt
  v_mfma_f32_16x16x32_bf16 v[48:51], a[216:219], v[80:83], v[48:51]
  v_exp_f32 v165, v165
  v_mfma_f32_16x16x32_bf16 v[48:51], a[232:235], v[84:87], v[48:51]
  v_exp_f32 v166, v166
  v_mfma_f32_16x16x32_bf16 v[52:55], a[236:239], v[84:87], 0
  v_exp_f32 v167, v167
  v_mfma_f32_16x16x32_bf16 v[52:55], a[220:223], v[80:83], v[52:55]
  v_cvt_pk_bf16_f32 v164, v164, v165
  v_cvt_pk_bf16_f32 v165, v166, v167
  v_mfma_f32_16x16x32_bf16 v[52:55], a[204:207], v[76:79], v[52:55]
  v_cvt_pk_bf16_f32 v48, v48, v49
  v_cvt_pk_bf16_f32 v49, v50, v51
  v_mfma_f32_16x16x32_bf16 v[52:55], a[188:191], v[60:63], v[52:55]
  v_exp_f32 v172, v172
  v_mfma_f32_16x16x32_bf16 v[52:55], a[172:175], v[56:59], v[52:55]
  v_exp_f32 v173, v173
  v_mfma_f32_16x16x32_bf16 v[52:55], a[156:159], v[72:75], v[52:55]
  v_exp_f32 v174, v174
  v_smfmac_f32_16x16x64_bf16 v[144:147], a[240:243], v[116:123], v10
  v_exp_f32 v175, v175
  v_mfma_f32_16x16x32_bf16 v[124:127], v[20:23], v[120:123], 0
  v_cvt_pk_bf16_f32 v166, v172, v173
  v_cvt_pk_bf16_f32 v167, v174, v175
  v_mfma_f32_16x16x32_bf16 v[124:127], v[16:19], v[116:119], v[124:127]
  v_cvt_pk_bf16_f32 v50, v52, v53
  v_cvt_pk_bf16_f32 v51, v54, v55
  v_mfma_f32_16x16x32_bf16 v[128:131], v[24:27], v[116:119], 0
  v_add_f32 v15, v144, v145
  v_mov_b64 v[144:145], 0
  v_mfma_f32_16x16x32_bf16 v[128:131], v[28:31], v[120:123], v[128:131]
  buffer_store_dwordx4 v[48:51], v8, s[24:27], s43 offen nt
  v_mfma_f32_16x16x32_bf16 v[140:143], v[36:39], v[120:123], 0
  v_exp_f32 v168, v168
  v_mfma_f32_16x16x32_bf16 v[140:143], v[32:35], v[116:119], v[140:143]
  v_exp_f32 v169, v169
  v_smfmac_f32_16x16x64_bf16 v[144:147], a[240:243], v[132:139], v10
  v_exp_f32 v170, v170
  v_mfma_f32_16x16x32_bf16 v[116:119], v[20:23], v[136:139], 0
  v_exp_f32 v171, v171
  v_mfma_f32_16x16x32_bf16 v[116:119], v[16:19], v[132:135], v[116:119]
  v_cvt_pk_bf16_f32 v168, v168, v169
  v_cvt_pk_bf16_f32 v169, v170, v171
  v_mfma_f32_16x16x32_bf16 v[120:123], v[24:27], v[132:135], 0
  v_add_f32 v14, v144, v145
  v_mov_b64 v[144:145], 0
  v_mfma_f32_16x16x32_bf16 v[120:123], v[28:31], v[136:139], v[120:123]
  v_exp_f32 v176, v176
  v_mfma_f32_16x16x32_bf16 v[156:159], v[36:39], v[136:139], 0
  v_exp_f32 v177, v177
  v_mfma_f32_16x16x32_bf16 v[156:159], v[32:35], v[132:135], v[156:159]
  v_exp_f32 v178, v178
  v_smfmac_f32_16x16x64_bf16 v[144:147], a[240:243], v[148:155], v10
  v_exp_f32 v179, v179
  v_mfma_f32_16x16x32_bf16 v[132:135], v[20:23], v[152:155], 0
  v_cvt_pk_bf16_f32 v170, v176, v177
  v_cvt_pk_bf16_f32 v171, v178, v179
  v_mfma_f32_16x16x32_bf16 v[132:135], v[16:19], v[148:151], v[132:135]
  v_max3_f32 v9, v14, v15, v9
  v_mfma_f32_16x16x32_bf16 v[136:139], v[24:27], v[148:151], 0
  v_add_f32 v13, v144, v145
  v_mov_b64 v[144:145], 0
  v_mfma_f32_16x16x32_bf16 v[136:139], v[28:31], v[152:155], v[136:139]
  ds_read_b128 a[244:247], v0 offset:0
  ds_read_b128 a[248:251], v1 offset:0
  v_mfma_f32_16x16x32_bf16 v[160:163], v[36:39], v[152:155], 0
  v_rcp_f32 v15, v15
  v_mfma_f32_16x16x32_bf16 v[160:163], v[32:35], v[148:151], v[160:163]
  ds_read_b128 a[252:255], v0 offset:8192
  ds_read_b128 v[180:183], v1 offset:8192
  v_smfmac_f32_16x16x64_bf16 v[144:147], a[240:243], v[164:171], v10
  v_rcp_f32 v14, v14
  v_mfma_f32_16x16x32_bf16 v[148:151], v[20:23], v[168:171], 0
  ds_read_b128 v[64:67], v0 offset:16384
  ds_read_b128 v[68:71], v1 offset:16384
  v_mfma_f32_16x16x32_bf16 v[148:151], v[16:19], v[164:167], v[148:151]
  v_mul_f32 v124, v15, v124
  v_mul_f32 v125, v15, v125
  v_mfma_f32_16x16x32_bf16 v[152:155], v[24:27], v[164:167], 0
  v_add_f32 v12, v144, v145
  v_mul_f32 v126, v15, v126
  v_mfma_f32_16x16x32_bf16 v[152:155], v[28:31], v[168:171], v[152:155]
  v_mul_f32 v127, v15, v127
  v_cvt_pk_bf16_f32 v124, v124, v125
  v_mfma_f32_16x16x32_bf16 v[172:175], v[36:39], v[168:171], 0
  s_waitcnt lgkmcnt(4)
  v_cvt_pk_bf16_f32 v125, v126, v127
  v_mfma_f32_16x16x32_bf16 v[172:175], v[32:35], v[164:167], v[172:175]
  s_cbranch_vccnz L_epi
  v_mfma_f32_16x16x32_bf16 v[76:79], v[184:187], a[244:247], 0
  ds_write_b32 v4, v124 offset:768
  v_mfma_f32_16x16x32_bf16 v[76:79], v[196:199], a[248:251], v[76:79]
  s_waitcnt lgkmcnt(3)
  v_mul_f32 v128, v15, v128
  v_mfma_f32_16x16x32_bf16 v[76:79], v[208:211], a[252:255], v[76:79]
  ds_write_b32 v4, v125 offset:772
  v_mfma_f32_16x16x32_bf16 v[76:79], v[220:223], v[180:183], v[76:79]
  s_waitcnt lgkmcnt(2)
  v_mul_f32 v129, v15, v129
  v_mfma_f32_16x16x32_bf16 v[76:79], v[232:235], v[64:67], v[76:79]
  v_mul_f32 v130, v15, v130
  v_mul_f32 v131, v15, v131
  v_mfma_f32_16x16x32_bf16 v[76:79], v[244:247], v[68:71], v[76:79]
  v_cvt_pk_bf16_f32 v128, v128, v129
  v_cvt_pk_bf16_f32 v129, v130, v131
  v_mfma_f32_16x16x32_bf16 v[80:83], v[248:251], v[68:71], 0
  ds_write_b32 v4, v128 offset:776
  v_mfma_f32_16x16x32_bf16 v[80:83], v[236:239], v[64:67], v[80:83]
  ds_write_b32 v4, v129 offset:780
  v_mfma_f32_16x16x32_bf16 v[80:83], v[224:227], v[180:183], v[80:83]
  v_cvt_pk_bf16_f32 v40, v76, v77
  v_cvt_pk_bf16_f32 v41, v78, v79
  v_mfma_f32_16x16x32_bf16 v[80:83], v[212:215], a[252:255], v[80:83]
  s_add_u32 m0, s33, 0
  v_mul_f32 v140, v15, v140
  v_mfma_f32_16x16x32_bf16 v[80:83], v[200:203], a[248:251], v[80:83]
  buffer_load_dwordx4 v6, s[8:11], s48 offen offset:0 nt lds
  v_mfma_f32_16x16x32_bf16 v[80:83], v[188:191], a[244:247], v[80:83]
  v_mul_f32 v141, v15, v141
  v_mul_f32 v142, v15, v142
  v_mfma_f32_16x16x32_bf16 v[76:79], v[192:195], a[244:247], 0
  v_mul_f32 v143, v15, v143
  v_cvt_pk_bf16_f32 v140, v140, v141
  v_mfma_f32_16x16x32_bf16 v[76:79], v[204:207], a[248:251], v[76:79]
  v_cvt_pk_bf16_f32 v141, v142, v143
  v_max3_f32 v9, v12, v13, v9
  v_mfma_f32_16x16x32_bf16 v[76:79], v[216:219], a[252:255], v[76:79]
  v_cvt_pk_bf16_f32 v42, v80, v81
  v_cvt_pk_bf16_f32 v43, v82, v83
  v_mfma_f32_16x16x32_bf16 v[76:79], v[228:231], v[180:183], v[76:79]
  ds_write_b32 v5, v140 offset:768
  v_mfma_f32_16x16x32_bf16 v[76:79], v[240:243], v[64:67], v[76:79]
  ds_write_b32 v5, v141 offset:772
  v_mfma_f32_16x16x32_bf16 v[76:79], v[252:255], v[68:71], v[76:79]
  v_rcp_f32 v13, v13
  v_mfma_f32_16x16x32_bf16 v[80:83], a[60:63], v[68:71], 0
  s_add_u32 m0, s33, 8064
  v_mul_f32 v116, v14, v116
  v_mfma_f32_16x16x32_bf16 v[80:83], a[48:51], v[64:67], v[80:83]
  buffer_load_dwordx4 v6, s[8:11], s48 offen offset:128 nt lds
  v_mfma_f32_16x16x32_bf16 v[80:83], a[36:39], v[180:183], v[80:83]
  v_cvt_pk_bf16_f32 v44, v76, v77
  v_cvt_pk_bf16_f32 v45, v78, v79
  v_mfma_f32_16x16x32_bf16 v[80:83], a[24:27], a[252:255], v[80:83]
  v_mul_f32 v117, v14, v117
  v_mul_f32 v118, v14, v118
  v_mfma_f32_16x16x32_bf16 v[80:83], a[12:15], a[248:251], v[80:83]
  v_mul_f32 v119, v14, v119
  v_cvt_pk_bf16_f32 v116, v116, v117
  v_mfma_f32_16x16x32_bf16 v[80:83], a[0:3], a[244:247], v[80:83]
  v_cvt_pk_bf16_f32 v117, v118, v119
  v_mul_f32 v120, v14, v120
  v_mfma_f32_16x16x32_bf16 v[76:79], a[4:7], a[244:247], 0
  ds_write_b32 v4, v116 offset:512
  v_mfma_f32_16x16x32_bf16 v[76:79], a[16:19], a[248:251], v[76:79]
  ds_write_b32 v4, v117 offset:516
  v_mfma_f32_16x16x32_bf16 v[76:79], a[28:31], a[252:255], v[76:79]
  v_cvt_pk_bf16_f32 v46, v80, v81
  v_cvt_pk_bf16_f32 v47, v82, v83
  v_mfma_f32_16x16x32_bf16 v[76:79], a[40:43], v[180:183], v[76:79]
  s_add_u32 m0, s33, 16128
  v_mul_f32 v121, v14, v121
  v_mfma_f32_16x16x32_bf16 v[76:79], a[52:55], v[64:67], v[76:79]
  buffer_load_dwordx4 v6, s[8:11], s48 offen offset:256 nt lds
  v_mfma_f32_16x16x32_bf16 v[76:79], a[64:67], v[68:71], v[76:79]
  v_mul_f32 v122, v14, v122
  v_mul_f32 v123, v14, v123
  v_mfma_f32_16x16x32_bf16 v[80:83], a[68:71], v[68:71], 0
  v_cvt_pk_bf16_f32 v120, v120, v121
  v_cvt_pk_bf16_f32 v121, v122, v123
  v_mfma_f32_16x16x32_bf16 v[80:83], a[56:59], v[64:67], v[80:83]
  ds_write_b32 v4, v120 offset:520
  v_mfma_f32_16x16x32_bf16 v[80:83], a[44:47], v[180:183], v[80:83]
  v_cvt_pk_bf16_f32 v48, v76, v77
  v_cvt_pk_bf16_f32 v49, v78, v79
  v_mfma_f32_16x16x32_bf16 v[80:83], a[32:35], a[252:255], v[80:83]
  ds_write_b32 v4, v121 offset:524
  v_mfma_f32_16x16x32_bf16 v[80:83], a[20:23], a[248:251], v[80:83]
  v_mul_f32 v156, v14, v156
  v_mul_f32 v157, v14, v157
  v_mfma_f32_16x16x32_bf16 v[80:83], a[8:11], a[244:247], v[80:83]
  v_mul_f32 v158, v14, v158
  v_mul_f32 v159, v14, v159
  v_mfma_f32_16x16x32_bf16 v[76:79], a[244:247], a[72:75], 0
  s_add_u32 m0, s33, 4096
  v_cvt_pk_bf16_f32 v156, v156, v157
  v_mfma_f32_16x16x32_bf16 v[76:79], a[248:251], a[84:87], v[76:79]
  buffer_load_dwordx4 v6, s[8:11], s49 offen offset:0 nt lds
  v_mfma_f32_16x16x32_bf16 v[76:79], a[252:255], a[96:99], v[76:79]
  v_cvt_pk_bf16_f32 v50, v80, v81
  v_cvt_pk_bf16_f32 v51, v82, v83
  v_mfma_f32_16x16x32_bf16 v[76:79], v[180:183], a[108:111], v[76:79]
  ds_read_b128 v[72:75], v0 offset:2048
  v_cvt_pk_bf16_f32 v157, v158, v159
  v_mfma_f32_16x16x32_bf16 v[76:79], v[64:67], a[120:123], v[76:79]
  ds_read_b128 v[84:87], v1 offset:2048
  v_mfma_f32_16x16x32_bf16 v[76:79], v[68:71], a[132:135], v[76:79]
  ds_read_b128 v[164:167], v0 offset:10240
  v_mfma_f32_16x16x32_bf16 v[80:83], v[68:71], a[136:139], 0
  ds_read_b128 v[168:171], v1 offset:10240
  v_mfma_f32_16x16x32_bf16 v[80:83], v[64:67], a[124:127], v[80:83]
  ds_read_b128 v[176:179], v0 offset:18432
  v_mfma_f32_16x16x32_bf16 v[80:83], v[180:183], a[112:115], v[80:83]
  v_cvt_pk_bf16_f32 v16, v76, v77
  v_cvt_pk_bf16_f32 v17, v78, v79
  v_mfma_f32_16x16x32_bf16 v[80:83], a[252:255], a[100:103], v[80:83]
  ds_read_b128 v[144:147], v1 offset:18432
  s_add_u32 m0, s33, 12160
  v_mfma_f32_16x16x32_bf16 v[80:83], a[248:251], a[88:91], v[80:83]
  buffer_load_dwordx4 v6, s[8:11], s49 offen offset:128 nt lds
  v_mfma_f32_16x16x32_bf16 v[80:83], a[244:247], a[76:79], v[80:83]
  ds_write_b32 v5, v156 offset:512
  v_mfma_f32_16x16x32_bf16 v[76:79], a[244:247], a[80:83], 0
  ds_write_b32 v5, v157 offset:516
  v_mfma_f32_16x16x32_bf16 v[76:79], a[248:251], a[92:95], v[76:79]
  v_rcp_f32 v12, v12
  v_mfma_f32_16x16x32_bf16 v[76:79], a[252:255], a[104:107], v[76:79]
  v_cvt_pk_bf16_f32 v24, v80, v81
  v_cvt_pk_bf16_f32 v25, v82, v83
  v_mfma_f32_16x16x32_bf16 v[76:79], v[180:183], a[116:119], v[76:79]
  v_mul_f32 v132, v13, v132
  v_mul_f32 v133, v13, v133
  v_mfma_f32_16x16x32_bf16 v[76:79], v[64:67], a[128:131], v[76:79]
  v_mul_f32 v134, v13, v134
  v_mul_f32 v135, v13, v135
  v_mfma_f32_16x16x32_bf16 v[76:79], v[68:71], a[140:143], v[76:79]
  s_waitcnt lgkmcnt(2)
  v_cvt_pk_bf16_f32 v132, v132, v133
  v_mfma_f32_16x16x32_bf16 v[80:83], v[184:187], v[72:75], 0
  s_add_u32 m0, s33, 20224
  v_cvt_pk_bf16_f32 v133, v134, v135
  v_mfma_f32_16x16x32_bf16 v[80:83], v[196:199], v[84:87], v[80:83]
  buffer_load_dwordx4 v6, s[8:11], s49 offen offset:256 nt lds
  v_mfma_f32_16x16x32_bf16 v[80:83], v[208:211], v[164:167], v[80:83]
  v_cvt_pk_bf16_f32 v32, v76, v77
  v_cvt_pk_bf16_f32 v33, v78, v79
  v_mfma_f32_16x16x32_bf16 v[80:83], v[220:223], v[168:171], v[80:83]
  s_waitcnt vmcnt(12)
  s_lshl2_add_u32 m0, s3, s47
  v_mfma_f32_16x16x32_bf16 v[80:83], v[232:235], v[176:179], v[80:83]
  ds_write_addtid_b32 v11
  v_mfma_f32_16x16x32_bf16 v[80:83], v[244:247], v[144:147], v[80:83]
  v_mov_b32 v11, 0
  v_mul_f32 v136, v13, v136
  v_mfma_f32_16x16x32_bf16 v[76:79], v[248:251], v[144:147], 0
  s_cmp_eq_u32 s44, s63
  v_mul_f32 v137, v13, v137
  v_mfma_f32_16x16x32_bf16 v[76:79], v[236:239], v[176:179], v[76:79]
  ds_write_b32 v4, v132 offset:256
  v_mfma_f32_16x16x32_bf16 v[76:79], v[224:227], v[168:171], v[76:79]
  v_cvt_pk_bf16_f32 v52, v80, v81
  v_cvt_pk_bf16_f32 v53, v82, v83
  v_mfma_f32_16x16x32_bf16 v[76:79], v[212:215], v[164:167], v[76:79]
  s_cbranch_scc1 L_cl0
L_cb0:
  v_mfma_f32_16x16x32_bf16 v[76:79], v[200:203], v[84:87], v[76:79]
  ds_write_b32 v4, v133 offset:260
  v_mfma_f32_16x16x32_bf16 v[76:79], v[188:191], v[72:75], v[76:79]
  v_mul_f32 v138, v13, v138
  v_mul_f32 v139, v13, v139
  v_mfma_f32_16x16x32_bf16 v[80:83], v[192:195], v[72:75], 0
  v_cvt_pk_bf16_f32 v136, v136, v137
  v_cvt_pk_bf16_f32 v137, v138, v139
  v_mfma_f32_16x16x32_bf16 v[80:83], v[204:207], v[84:87], v[80:83]
  ds_write_b32 v4, v136 offset:264
  v_mfma_f32_16x16x32_bf16 v[80:83], v[216:219], v[164:167], v[80:83]
  v_cvt_pk_bf16_f32 v54, v76, v77
  v_cvt_pk_bf16_f32 v55, v78, v79
  v_mfma_f32_16x16x32_bf16 v[80:83], v[228:231], v[168:171], v[80:83]
  ds_write_b32 v4, v137 offset:268
  v_mfma_f32_16x16x32_bf16 v[80:83], v[240:243], v[176:179], v[80:83]
  v_mul_f32 v160, v13, v160
  v_mul_f32 v161, v13, v161
  v_mfma_f32_16x16x32_bf16 v[80:83], v[252:255], v[144:147], v[80:83]
  v_mul_f32 v162, v13, v162
  v_mul_f32 v163, v13, v163
  v_mfma_f32_16x16x32_bf16 v[76:79], a[60:63], v[144:147], 0
  v_cvt_pk_bf16_f32 v160, v160, v161
  v_cvt_pk_bf16_f32 v161, v162, v163
  v_mfma_f32_16x16x32_bf16 v[76:79], a[48:51], v[176:179], v[76:79]
  ds_write_b32 v5, v160 offset:256
  v_mfma_f32_16x16x32_bf16 v[76:79], a[36:39], v[168:171], v[76:79]
  v_cvt_pk_bf16_f32 v56, v80, v81
  v_cvt_pk_bf16_f32 v57, v82, v83
  v_mfma_f32_16x16x32_bf16 v[76:79], a[24:27], v[164:167], v[76:79]
  ds_write_b32 v5, v161 offset:260
  v_mfma_f32_16x16x32_bf16 v[76:79], a[12:15], v[84:87], v[76:79]
  v_mul_f32 v148, v12, v148
  v_mul_f32 v149, v12, v149
  v_mfma_f32_16x16x32_bf16 v[76:79], a[0:3], v[72:75], v[76:79]
  v_mul_f32 v150, v12, v150
  v_mul_f32 v151, v12, v151
  v_mfma_f32_16x16x32_bf16 v[80:83], a[4:7], v[72:75], 0
  v_cvt_pk_bf16_f32 v148, v148, v149
  v_cvt_pk_bf16_f32 v149, v150, v151
  v_mfma_f32_16x16x32_bf16 v[80:83], a[16:19], v[84:87], v[80:83]
  ds_write_b32 v4, v148 offset:0
  v_mfma_f32_16x16x32_bf16 v[80:83], a[28:31], v[164:167], v[80:83]
  v_cvt_pk_bf16_f32 v58, v76, v77
  v_cvt_pk_bf16_f32 v59, v78, v79
  v_mfma_f32_16x16x32_bf16 v[80:83], a[40:43], v[168:171], v[80:83]
  ds_write_b32 v4, v149 offset:4
  v_mfma_f32_16x16x32_bf16 v[80:83], a[52:55], v[176:179], v[80:83]
  v_mul_f32 v152, v12, v152
  v_mul_f32 v153, v12, v153
  v_mfma_f32_16x16x32_bf16 v[80:83], a[64:67], v[144:147], v[80:83]
  v_mul_f32 v154, v12, v154
  v_mul_f32 v155, v12, v155
  v_mfma_f32_16x16x32_bf16 v[76:79], a[68:71], v[144:147], 0
  v_cvt_pk_bf16_f32 v152, v152, v153
  v_cvt_pk_bf16_f32 v153, v154, v155
  v_mfma_f32_16x16x32_bf16 v[76:79], a[56:59], v[176:179], v[76:79]
  ds_write_b32 v4, v152 offset:8
  v_mfma_f32_16x16x32_bf16 v[76:79], a[44:47], v[168:171], v[76:79]
  v_cvt_pk_bf16_f32 v60, v80, v81
  v_cvt_pk_bf16_f32 v61, v82, v83
  v_mfma_f32_16x16x32_bf16 v[76:79], a[32:35], v[164:167], v[76:79]
  ds_write_b32 v4, v153 offset:12
  v_mfma_f32_16x16x32_bf16 v[76:79], a[20:23], v[84:87], v[76:79]
  v_mul_f32 v172, v12, v172
  v_mul_f32 v173, v12, v173
  v_mfma_f32_16x16x32_bf16 v[76:79], a[8:11], v[72:75], v[76:79]
  v_mul_f32 v174, v12, v174
  v_mul_f32 v175, v12, v175
  v_mfma_f32_16x16x32_bf16 v[80:83], v[72:75], a[72:75], 0
  v_cvt_pk_bf16_f32 v172, v172, v173
  v_cvt_pk_bf16_f32 v173, v174, v175
  v_mfma_f32_16x16x32_bf16 v[80:83], v[84:87], a[84:87], v[80:83]
  ds_write_b32 v5, v172 offset:0
  v_mfma_f32_16x16x32_bf16 v[80:83], v[164:167], a[96:99], v[80:83]
  v_cvt_pk_bf16_f32 v62, v76, v77
  v_cvt_pk_bf16_f32 v63, v78, v79
  v_mfma_f32_16x16x32_bf16 v[80:83], v[168:171], a[108:111], v[80:83]
  ds_read_b128 v[116:119], v0 offset:4096
  v_mfma_f32_16x16x32_bf16 v[80:83], v[176:179], a[120:123], v[80:83]
  ds_read_b128 v[124:127], v1 offset:4096
  v_mfma_f32_16x16x32_bf16 v[80:83], v[144:147], a[132:135], v[80:83]
  ds_read_b128 v[120:123], v0 offset:12288
  v_mfma_f32_16x16x32_bf16 v[76:79], v[144:147], a[136:139], 0
  ds_read_b128 v[128:131], v1 offset:12288
  v_mfma_f32_16x16x32_bf16 v[76:79], v[176:179], a[124:127], v[76:79]
  ds_read_b128 v[132:135], v0 offset:20480
  v_mfma_f32_16x16x32_bf16 v[76:79], v[168:171], a[112:115], v[76:79]
  v_cvt_pk_bf16_f32 v18, v80, v81
  v_cvt_pk_bf16_f32 v19, v82, v83
  v_mfma_f32_16x16x32_bf16 v[76:79], v[164:167], a[100:103], v[76:79]
  ds_read_b128 v[140:143], v1 offset:20480
  v_mfma_f32_16x16x32_bf16 v[76:79], v[84:87], a[88:91], v[76:79]
  ds_write_b32 v5, v173 offset:4
  v_mfma_f32_16x16x32_bf16 v[76:79], v[72:75], a[76:79], v[76:79]
  v_subrev_u32 v3, s7, v3
  v_subrev_u32 v2, s7, v2
  v_mfma_f32_16x16x32_bf16 v[80:83], v[72:75], a[80:83], 0
  v_add_u32 v4, s7, v4
  v_add_u32 v5, s7, v5
  v_mfma_f32_16x16x32_bf16 v[80:83], v[84:87], a[92:95], v[80:83]
  s_sub_u32 s7, 0, s7
  v_max3_f32 v9, v12, v13, v9
  v_mfma_f32_16x16x32_bf16 v[80:83], v[164:167], a[104:107], v[80:83]
  v_cvt_pk_bf16_f32 v26, v76, v77
  v_cvt_pk_bf16_f32 v27, v78, v79
  v_mfma_f32_16x16x32_bf16 v[80:83], v[168:171], a[116:119], v[80:83]
  v_max3_f32 v9, v14, v15, v9
  v_mfma_f32_16x16x32_bf16 v[80:83], v[176:179], a[128:131], v[80:83]
  v_mfma_f32_16x16x32_bf16 v[80:83], v[144:147], a[140:143], v[80:83]
  s_waitcnt lgkmcnt(1)
  v_mfma_f32_16x16x32_bf16 v[148:151], v[184:187], v[116:119], 0
  v_mfma_f32_16x16x32_bf16 v[148:151], v[196:199], v[124:127], v[148:151]
  v_mfma_f32_16x16x32_bf16 v[148:151], v[208:211], v[120:123], v[148:151]
  v_cvt_pk_bf16_f32 v34, v80, v81
  v_cvt_pk_bf16_f32 v35, v82, v83
  v_mfma_f32_16x16x32_bf16 v[148:151], v[220:223], v[128:131], v[148:151]
  v_mfma_f32_16x16x32_bf16 v[148:151], v[232:235], v[132:135], v[148:151]
  v_mfma_f32_16x16x32_bf16 v[148:151], v[244:247], v[140:143], v[148:151]
  v_mfma_f32_16x16x32_bf16 v[156:159], v[248:251], v[140:143], 0
  v_mfma_f32_16x16x32_bf16 v[156:159], v[236:239], v[132:135], v[156:159]
  v_mfma_f32_16x16x32_bf16 v[156:159], v[224:227], v[128:131], v[156:159]
  v_cvt_pk_bf16_f32 v64, v148, v149
  v_cvt_pk_bf16_f32 v65, v150, v151
  v_mfma_f32_16x16x32_bf16 v[156:159], v[212:215], v[120:123], v[156:159]
  v_mfma_f32_16x16x32_bf16 v[156:159], v[200:203], v[124:127], v[156:159]
  v_mfma_f32_16x16x32_bf16 v[156:159], v[188:191], v[116:119], v[156:159]
  v_mfma_f32_16x16x32_bf16 v[148:151], v[192:195], v[116:119], 0
  v_mfma_f32_16x16x32_bf16 v[148:151], v[204:207], v[124:127], v[148:151]
  v_mfma_f32_16x16x32_bf16 v[148:151], v[216:219], v[120:123], v[148:151]
  v_cvt_pk_bf16_f32 v66, v156, v157
  v_cvt_pk_bf16_f32 v67, v158, v159
  v_mfma_f32_16x16x32_bf16 v[148:151], v[228:231], v[128:131], v[148:151]
  s_mov_b32 m0, s47
  s_xor_b32 s47, s47, 1024
  v_mfma_f32_16x16x32_bf16 v[148:151], v[240:243], v[132:135], v[148:151]
  s_add_u32 s40, s50, s52
  s_add_u32 s41, s50, s53
  v_mfma_f32_16x16x32_bf16 v[148:151], v[252:255], v[140:143], v[148:151]
  s_add_u32 s42, s50, s54
  s_add_u32 s43, s50, s55
  v_mfma_f32_16x16x32_bf16 v[156:159], a[60:63], v[140:143], 0
  s_cmp_ge_u32 s6, 94765056
  s_cselect_b64 vcc, -1, 0
  v_mfma_f32_16x16x32_bf16 v[156:159], a[48:51], v[132:135], v[156:159]
  s_mov_b32 s50, s51
  s_mov_b32 s51, s6
  v_mfma_f32_16x16x32_bf16 v[156:159], a[36:39], v[128:131], v[156:159]
  v_cvt_pk_bf16_f32 v68, v148, v149
  v_cvt_pk_bf16_f32 v69, v150, v151
  v_mfma_f32_16x16x32_bf16 v[156:159], a[24:27], v[120:123], v[156:159]
  s_mov_b32 s6, s48
  s_add_u32 s36, s32, s33
  v_mfma_f32_16x16x32_bf16 v[156:159], a[12:15], v[124:127], v[156:159]
  s_mov_b32 s33, s32
  s_sub_u32 s32, s34, s36
  v_mfma_f32_16x16x32_bf16 v[156:159], a[0:3], v[116:119], v[156:159]
  v_mfma_f32_16x16x32_bf16 v[148:151], a[4:7], v[116:119], 0
  v_mfma_f32_16x16x32_bf16 v[148:151], a[16:19], v[124:127], v[148:151]
  v_mfma_f32_16x16x32_bf16 v[148:151], a[28:31], v[120:123], v[148:151]
  v_cvt_pk_bf16_f32 v76, v156, v157
  v_cvt_pk_bf16_f32 v77, v158, v159
  v_mfma_f32_16x16x32_bf16 v[148:151], a[40:43], v[128:131], v[148:151]
  v_mfma_f32_16x16x32_bf16 v[148:151], a[52:55], v[132:135], v[148:151]
  v_mfma_f32_16x16x32_bf16 v[148:151], a[64:67], v[140:143], v[148:151]
  v_mfma_f32_16x16x32_bf16 v[156:159], a[68:71], v[140:143], 0
  v_mfma_f32_16x16x32_bf16 v[156:159], a[56:59], v[132:135], v[156:159]
  v_mfma_f32_16x16x32_bf16 v[156:159], a[44:47], v[128:131], v[156:159]
  v_cvt_pk_bf16_f32 v78, v148, v149
  v_cvt_pk_bf16_f32 v79, v150, v151
  v_mfma_f32_16x16x32_bf16 v[156:159], a[32:35], v[120:123], v[156:159]
  v_mfma_f32_16x16x32_bf16 v[156:159], a[20:23], v[124:127], v[156:159]
  v_mfma_f32_16x16x32_bf16 v[156:159], a[8:11], v[116:119], v[156:159]
  v_mfma_f32_16x16x32_bf16 v[148:151], v[116:119], a[72:75], 0
  v_mfma_f32_16x16x32_bf16 v[148:151], v[124:127], a[84:87], v[148:151]
  v_mfma_f32_16x16x32_bf16 v[148:151], v[120:123], a[96:99], v[148:151]
  v_cvt_pk_bf16_f32 v80, v156, v157
  v_cvt_pk_bf16_f32 v81, v158, v159
  v_mfma_f32_16x16x32_bf16 v[148:151], v[128:131], a[108:111], v[148:151]
  ds_read_b128 v[136:139], v0 offset:6144
  v_mfma_f32_16x16x32_bf16 v[148:151], v[132:135], a[120:123], v[148:151]
  ds_read_b128 v[144:147], v1 offset:6144
  v_mfma_f32_16x16x32_bf16 v[148:151], v[140:143], a[132:135], v[148:151]
  ds_read_b128 v[152:155], v0 offset:14336
  v_mfma_f32_16x16x32_bf16 v[156:159], v[140:143], a[136:139], 0
  ds_read_b128 v[160:163], v1 offset:14336
  v_mfma_f32_16x16x32_bf16 v[156:159], v[132:135], a[124:127], v[156:159]
  ds_read_b128 v[164:167], v0 offset:22528
  v_mfma_f32_16x16x32_bf16 v[156:159], v[128:131], a[112:115], v[156:159]
  v_cvt_pk_bf16_f32 v20, v148, v149
  v_cvt_pk_bf16_f32 v21, v150, v151
  v_mfma_f32_16x16x32_bf16 v[156:159], v[120:123], a[100:103], v[156:159]
  ds_read_b128 v[172:175], v1 offset:22528
  v_mfma_f32_16x16x32_bf16 v[156:159], v[124:127], a[88:91], v[156:159]
  v_mfma_f32_16x16x32_bf16 v[156:159], v[116:119], a[76:79], v[156:159]
  v_mfma_f32_16x16x32_bf16 v[148:151], v[116:119], a[80:83], 0
  v_mfma_f32_16x16x32_bf16 v[148:151], v[124:127], a[92:95], v[148:151]
  v_mfma_f32_16x16x32_bf16 v[148:151], v[120:123], a[104:107], v[148:151]
  v_cvt_pk_bf16_f32 v28, v156, v157
  v_cvt_pk_bf16_f32 v29, v158, v159
  v_mfma_f32_16x16x32_bf16 v[148:151], v[128:131], a[116:119], v[148:151]
  s_cmp_eq_u32 s44, s60
  v_mfma_f32_16x16x32_bf16 v[148:151], v[132:135], a[128:131], v[148:151]
  v_mfma_f32_16x16x32_bf16 v[148:151], v[140:143], a[140:143], v[148:151]
  s_waitcnt lgkmcnt(0)
  v_mfma_f32_16x16x32_bf16 v[168:171], v[184:187], v[136:139], 0
  s_cbranch_scc1 L_cl1
L_cb1:
  v_mfma_f32_16x16x32_bf16 v[168:171], v[196:199], v[144:147], v[168:171]
  v_mfma_f32_16x16x32_bf16 v[168:171], v[208:211], v[152:155], v[168:171]
  v_cvt_pk_bf16_f32 v36, v148, v149
  v_cvt_pk_bf16_f32 v37, v150, v151
  v_mfma_f32_16x16x32_bf16 v[168:171], v[220:223], v[160:163], v[168:171]
  v_mfma_f32_16x16x32_bf16 v[168:171], v[232:235], v[164:167], v[168:171]
  v_mfma_f32_16x16x32_bf16 v[168:171], v[244:247], v[172:175], v[168:171]
  v_mfma_f32_16x16x32_bf16 v[176:179], v[248:251], v[172:175], 0
  v_mfma_f32_16x16x32_bf16 v[176:179], v[236:239], v[164:167], v[176:179]
  v_mfma_f32_16x16x32_bf16 v[176:179], v[224:227], v[160:163], v[176:179]
  v_cvt_pk_bf16_f32 v70, v168, v169
  v_cvt_pk_bf16_f32 v71, v170, v171
  v_mfma_f32_16x16x32_bf16 v[176:179], v[212:215], v[152:155], v[176:179]
  v_mfma_f32_16x16x32_bf16 v[176:179], v[200:203], v[144:147], v[176:179]
  s_barrier
  v_mfma_f32_16x16x32_bf16 v[176:179], v[188:191], v[136:139], v[176:179]
  ds_read_addtid_b32 v116
  v_mad_i32_i16 v0, v10, 1, s32 op_sel:[1,0,0,0]
  v_mfma_f32_16x16x32_bf16 v[168:171], v[192:195], v[136:139], 0
  v_xor_b32 v1, 64, v0
  v_mfma_f32_16x16x32_bf16 v[168:171], v[204:207], v[144:147], v[168:171]
  v_mfma_f32_16x16x32_bf16 v[168:171], v[216:219], v[152:155], v[168:171]
  v_cvt_pk_bf16_f32 v72, v176, v177
  v_cvt_pk_bf16_f32 v73, v178, v179
  v_mfma_f32_16x16x32_bf16 v[168:171], v[228:231], v[160:163], v[168:171]
  v_mfma_f32_16x16x32_bf16 v[168:171], v[240:243], v[164:167], v[168:171]
  v_mfma_f32_16x16x32_bf16 v[168:171], v[252:255], v[172:175], v[168:171]
  s_waitcnt lgkmcnt(0)
  v_readfirstlane_b32 s36, v116
  v_mfma_f32_16x16x32_bf16 v[176:179], a[60:63], v[172:175], 0
  v_mfma_f32_16x16x32_bf16 v[176:179], a[48:51], v[164:167], v[176:179]
  s_add_u32 s36, s36, s44
  s_min_u32 s36, s36, s13
  v_mfma_f32_16x16x32_bf16 v[176:179], a[36:39], v[160:163], v[176:179]
  v_cvt_pk_bf16_f32 v74, v168, v169
  v_cvt_pk_bf16_f32 v75, v170, v171
  v_mfma_f32_16x16x32_bf16 v[176:179], a[24:27], v[152:155], v[176:179]
  s_max_u32 s45, s45, s36
  s_min_u32 s36, s45, s12
  v_mfma_f32_16x16x32_bf16 v[176:179], a[12:15], v[144:147], v[176:179]
  s_cselect_b32 s48, s46, s62
  s_sub_u32 s37, s45, s36
  v_mfma_f32_16x16x32_bf16 v[176:179], a[0:3], v[136:139], v[176:179]
  s_mul_i32 s36, s36, 1572864
  s_add_u32 s48, s48, s36
  v_mfma_f32_16x16x32_bf16 v[168:171], a[4:7], v[136:139], 0
  s_mul_i32 s36, s37, s14
  s_lshr_b32 s36, s36, 8
  v_mfma_f32_16x16x32_bf16 v[168:171], a[16:19], v[144:147], v[168:171]
  s_mul_i32 s36, s36, s15
  s_add_u32 s48, s48, s36
  v_mfma_f32_16x16x32_bf16 v[168:171], a[28:31], v[152:155], v[168:171]
  v_cvt_pk_bf16_f32 v82, v176, v177
  v_cvt_pk_bf16_f32 v83, v178, v179
  v_mfma_f32_16x16x32_bf16 v[168:171], a[40:43], v[160:163], v[168:171]
  s_mulk_i32 s37, 3072
  s_add_u32 s48, s48, s37
  v_mfma_f32_16x16x32_bf16 v[168:171], a[52:55], v[164:167], v[168:171]
  s_add_u32 s49, s48, 786432
  s_bitset1_b64 s[56:57], s45
  v_mfma_f32_16x16x32_bf16 v[168:171], a[64:67], v[172:175], v[168:171]
  s_add_u32 s44, s44, 4
  s_min_u32 s44, s44, s12
  v_mfma_f32_16x16x32_bf16 v[176:179], a[68:71], v[172:175], 0
  s_cmp_ge_u32 s45, s13
  s_cselect_b32 s63, -2, s63
  v_mfma_f32_16x16x32_bf16 v[176:179], a[56:59], v[164:167], v[176:179]
  v_mfma_f32_16x16x32_bf16 v[176:179], a[44:47], v[160:163], v[176:179]
  v_cvt_pk_bf16_f32 v84, v168, v169
  v_cvt_pk_bf16_f32 v85, v170, v171
  v_mfma_f32_16x16x32_bf16 v[176:179], a[32:35], v[152:155], v[176:179]
  v_mfma_f32_16x16x32_bf16 v[176:179], a[20:23], v[144:147], v[176:179]
  v_mfma_f32_16x16x32_bf16 v[176:179], a[8:11], v[136:139], v[176:179]
  v_mfma_f32_16x16x32_bf16 v[168:171], v[136:139], a[72:75], 0
  v_mfma_f32_16x16x32_bf16 v[168:171], v[144:147], a[84:87], v[168:171]
  v_mfma_f32_16x16x32_bf16 v[168:171], v[152:155], a[96:99], v[168:171]
  v_cvt_pk_bf16_f32 v86, v176, v177
  v_cvt_pk_bf16_f32 v87, v178, v179
  v_mfma_f32_16x16x32_bf16 v[168:171], v[160:163], a[108:111], v[168:171]
  v_mfma_f32_16x16x32_bf16 v[168:171], v[164:167], a[120:123], v[168:171]
  v_mfma_f32_16x16x32_bf16 v[168:171], v[172:175], a[132:135], v[168:171]
  v_mfma_f32_16x16x32_bf16 v[176:179], v[172:175], a[136:139], 0
  v_mfma_f32_16x16x32_bf16 v[176:179], v[164:167], a[124:127], v[176:179]
  v_mfma_f32_16x16x32_bf16 v[176:179], v[160:163], a[112:115], v[176:179]
  v_cvt_pk_bf16_f32 v22, v168, v169
  v_cvt_pk_bf16_f32 v23, v170, v171
  v_mfma_f32_16x16x32_bf16 v[176:179], v[152:155], a[100:103], v[176:179]
  ds_read_b128 a[244:247], v3 offset:0
  v_mfma_f32_16x16x32_bf16 v[176:179], v[144:147], a[88:91], v[176:179]
  ds_read_b128 a[248:251], v3 offset:4096
  v_mfma_f32_16x16x32_bf16 v[176:179], v[136:139], a[76:79], v[176:179]
  ds_read_b128 a[252:255], v3 offset:8192
  v_mfma_f32_16x16x32_bf16 v[168:171], v[136:139], a[80:83], 0
  ds_read_b128 v[180:183], v3 offset:12288
  v_mfma_f32_16x16x32_bf16 v[168:171], v[144:147], a[92:95], v[168:171]
  v_mfma_f32_16x16x32_bf16 v[168:171], v[152:155], a[104:107], v[168:171]
  v_cvt_pk_bf16_f32 v30, v176, v177
  v_cvt_pk_bf16_f32 v31, v178, v179
  v_mfma_f32_16x16x32_bf16 v[168:171], v[160:163], a[116:119], v[168:171]
  s_cmp_lg_u32 s31, 0
  v_mfma_f32_16x16x32_bf16 v[168:171], v[164:167], a[128:131], v[168:171]
  v_mfma_f32_16x16x32_bf16 v[168:171], v[172:175], a[140:143], v[168:171]
  s_cbranch_scc0 L_s
  s_branch L_special
L_cl0:
  v_mov_b32 v11, 1
  v_lshrrev_b32 v180, 16, v10
  buffer_atomic_add v11, v180, s[20:23], 0 offen sc0 sc1
  s_branch L_cb0
L_cl1:
  v_mov_b32 v11, 1
  v_lshrrev_b32 v180, 16, v10
  buffer_atomic_add v11, v180, s[20:23], 0 offen sc0 sc1
  s_branch L_cb1
L_epi:
  ds_write_b32 v4, v124 offset:768
  ds_write_b32 v4, v125 offset:772
  v_pk_mul_f32 v[128:129], v[128:129], v[14:15] op_sel:[0,1] op_sel_hi:[1,1]
  v_pk_mul_f32 v[130:131], v[130:131], v[14:15] op_sel:[0,1] op_sel_hi:[1,1]
  v_cvt_pk_bf16_f32 v128, v128, v129
  v_cvt_pk_bf16_f32 v129, v130, v131
  ds_write_b32 v4, v128 offset:776
  ds_write_b32 v4, v129 offset:780
  v_pk_mul_f32 v[140:141], v[140:141], v[14:15] op_sel:[0,1] op_sel_hi:[1,1]
  v_pk_mul_f32 v[142:143], v[142:143], v[14:15] op_sel:[0,1] op_sel_hi:[1,1]
  v_cvt_pk_bf16_f32 v140, v140, v141
  v_cvt_pk_bf16_f32 v141, v142, v143
  ds_write_b32 v5, v140 offset:768
  ds_write_b32 v5, v141 offset:772
  v_pk_mul_f32 v[116:117], v[116:117], v[14:15] op_sel:[0,0] op_sel_hi:[1,0]
  v_pk_mul_f32 v[118:119], v[118:119], v[14:15] op_sel:[0,0] op_sel_hi:[1,0]
  v_cvt_pk_bf16_f32 v116, v116, v117
  v_cvt_pk_bf16_f32 v117, v118, v119
  v_pk_mul_f32 v[120:121], v[120:121], v[14:15] op_sel:[0,0] op_sel_hi:[1,0]
  v_pk_mul_f32 v[122:123], v[122:123], v[14:15] op_sel:[0,0] op_sel_hi:[1,0]
  v_cvt_pk_bf16_f32 v118, v120, v121
  v_cvt_pk_bf16_f32 v119, v122, v123
  ds_write_b128 v4, v[116:119] offset:512
  v_pk_mul_f32 v[156:157], v[156:157], v[14:15] op_sel:[0,0] op_sel_hi:[1,0]
  v_pk_mul_f32 v[158:159], v[158:159], v[14:15] op_sel:[0,0] op_sel_hi:[1,0]
  v_cvt_pk_bf16_f32 v156, v156, v157
  v_cvt_pk_bf16_f32 v157, v158, v159
  ds_write_b64 v5, v[156:157] offset:512
  s_mul_i32 s36, s5, 768
  s_add_u32 s37, s7, s36
  s_sub_u32 s36, s7, s36
  v_subrev_u32 v3, s37, v3
  v_subrev_u32 v2, s36, v2
  v_max3_f32 v9, v12, v13, v9
  v_rcp_f32 v13, v13
  v_rcp_f32 v12, v12
  s_lshl_b32 s36, s5, 1
  s_add_u32 s37, s36, s4
  s_sub_u32 s36, s36, s4
  s_mul_i32 s37, s37, 196608
  s_mul_i32 s36, s36, 196608
  s_sub_u32 s37, s50, s37
  s_add_u32 s36, s50, s36
  s_add_u32 s40, s37, 1179648
  s_waitcnt lgkmcnt(0)
  s_barrier
  ds_read_b128 a[244:247], v3 offset:768
  ds_read_b128 a[248:251], v3 offset:4864
  v_pk_mul_f32 v[132:133], v[132:133], v[12:13] op_sel:[0,1] op_sel_hi:[1,1]
  v_pk_mul_f32 v[134:135], v[134:135], v[12:13] op_sel:[0,1] op_sel_hi:[1,1]
  v_cvt_pk_bf16_f32 v132, v132, v133
  ds_read_b128 a[252:255], v3 offset:8960
  v_cvt_pk_bf16_f32 v133, v134, v135
  v_pk_mul_f32 v[136:137], v[136:137], v[12:13] op_sel:[0,1] op_sel_hi:[1,1]
  v_pk_mul_f32 v[138:139], v[138:139], v[12:13] op_sel:[0,1] op_sel_hi:[1,1]
  ds_read_b128 v[180:183], v3 offset:13056
  v_cvt_pk_bf16_f32 v134, v136, v137
  v_cvt_pk_bf16_f32 v135, v138, v139
  v_pk_mul_f32 v[160:161], v[160:161], v[12:13] op_sel:[0,1] op_sel_hi:[1,1]
  ds_read_b128 v[64:67], v3 offset:17152
  v_pk_mul_f32 v[162:163], v[162:163], v[12:13] op_sel:[0,1] op_sel_hi:[1,1]
  v_cvt_pk_bf16_f32 v160, v160, v161
  v_cvt_pk_bf16_f32 v161, v162, v163
  ds_read_b128 v[68:71], v3 offset:21248
  v_pk_mul_f32 v[148:149], v[148:149], v[12:13] op_sel:[0,0] op_sel_hi:[1,0]
  v_pk_mul_f32 v[150:151], v[150:151], v[12:13] op_sel:[0,0] op_sel_hi:[1,0]
  v_pk_mul_f32 v[152:153], v[152:153], v[12:13] op_sel:[0,0] op_sel_hi:[1,0]
  v_pk_mul_f32 v[154:155], v[154:155], v[12:13] op_sel:[0,0] op_sel_hi:[1,0]
  s_waitcnt lgkmcnt(4)
  v_mfma_f32_16x16x32_bf16 v[40:43], a[144:147], a[244:247], 0
  v_cvt_pk_bf16_f32 v148, v148, v149
  v_cvt_pk_bf16_f32 v149, v150, v151
  v_mfma_f32_16x16x32_bf16 v[40:43], a[160:163], a[248:251], v[40:43]
  s_waitcnt lgkmcnt(2)
  v_cvt_pk_bf16_f32 v150, v152, v153
  v_mfma_f32_16x16x32_bf16 v[40:43], a[176:179], a[252:255], v[40:43]
  v_cvt_pk_bf16_f32 v151, v154, v155
  v_mfma_f32_16x16x32_bf16 v[40:43], a[192:195], v[180:183], v[40:43]
  s_waitcnt lgkmcnt(0)
  v_mfma_f32_16x16x32_bf16 v[40:43], a[208:211], v[64:67], v[40:43]
  ds_write_b128 v4, v[132:135] offset:256
  v_mfma_f32_16x16x32_bf16 v[40:43], a[224:227], v[68:71], v[40:43]
  ds_write_b64 v5, v[160:161] offset:256
  v_mfma_f32_16x16x32_bf16 v[44:47], a[228:231], v[68:71], 0
  ds_write_b128 v4, v[148:151] offset:0
  v_mfma_f32_16x16x32_bf16 v[44:47], a[212:215], v[64:67], v[44:47]
  v_mul_f32 v172, v12, v172
  v_mul_f32 v173, v12, v173
  v_mfma_f32_16x16x32_bf16 v[44:47], a[196:199], v[180:183], v[44:47]
  v_cvt_pk_bf16_f32 v40, v40, v41
  v_cvt_pk_bf16_f32 v41, v42, v43
  v_mfma_f32_16x16x32_bf16 v[44:47], a[180:183], a[252:255], v[44:47]
  v_mul_f32 v174, v12, v174
  v_mul_f32 v175, v12, v175
  v_mfma_f32_16x16x32_bf16 v[44:47], a[164:167], a[248:251], v[44:47]
  v_cvt_pk_bf16_f32 v172, v172, v173
  v_cvt_pk_bf16_f32 v173, v174, v175
  v_mfma_f32_16x16x32_bf16 v[44:47], a[148:151], a[244:247], v[44:47]
  ds_write_b64 v5, v[172:173] offset:0
  v_mfma_f32_16x16x32_bf16 v[48:51], a[152:155], a[244:247], 0
  ds_read_b128 v[72:75], v2 offset:512
  v_mfma_f32_16x16x32_bf16 v[48:51], a[168:171], a[248:251], v[48:51]
  ds_read_b128 v[56:59], v2 offset:4608
  v_mfma_f32_16x16x32_bf16 v[48:51], a[184:187], a[252:255], v[48:51]
  v_cvt_pk_bf16_f32 v42, v44, v45
  v_cvt_pk_bf16_f32 v43, v46, v47
  v_mfma_f32_16x16x32_bf16 v[48:51], a[200:203], v[180:183], v[48:51]
  buffer_store_dwordx4 v[40:43], v7, s[24:27], s40 offen nt
  v_mfma_f32_16x16x32_bf16 v[48:51], a[216:219], v[64:67], v[48:51]
  ds_read_b128 v[60:63], v2 offset:8704
  v_mfma_f32_16x16x32_bf16 v[48:51], a[232:235], v[68:71], v[48:51]
  ds_read_b128 v[76:79], v2 offset:12800
  v_mfma_f32_16x16x32_bf16 v[52:55], a[236:239], v[68:71], 0
  ds_read_b128 v[80:83], v2 offset:16896
  v_mfma_f32_16x16x32_bf16 v[52:55], a[220:223], v[64:67], v[52:55]
  ds_read_b128 v[84:87], v2 offset:20992
  v_mfma_f32_16x16x32_bf16 v[52:55], a[204:207], v[180:183], v[52:55]
  v_cvt_pk_bf16_f32 v48, v48, v49
  v_cvt_pk_bf16_f32 v49, v50, v51
  v_mfma_f32_16x16x32_bf16 v[52:55], a[188:191], a[252:255], v[52:55]
  v_mfma_f32_16x16x32_bf16 v[52:55], a[172:175], a[248:251], v[52:55]
  s_waitcnt lgkmcnt(6)
  s_barrier
  v_mfma_f32_16x16x32_bf16 v[52:55], a[156:159], a[244:247], v[52:55]
  s_waitcnt lgkmcnt(0)
  ds_read_b128 v[124:127], v3 offset:256
  v_mfma_f32_16x16x32_bf16 v[40:43], a[144:147], v[72:75], 0
  ds_read_b128 v[128:131], v3 offset:4352
  s_add_u32 s41, s36, 786432
  v_mfma_f32_16x16x32_bf16 v[40:43], a[160:163], v[56:59], v[40:43]
  ds_read_b128 v[140:143], v3 offset:8448
  v_mfma_f32_16x16x32_bf16 v[40:43], a[176:179], v[60:63], v[40:43]
  v_cvt_pk_bf16_f32 v50, v52, v53
  v_cvt_pk_bf16_f32 v51, v54, v55
  v_mfma_f32_16x16x32_bf16 v[40:43], a[192:195], v[76:79], v[40:43]
  buffer_store_dwordx4 v[48:51], v8, s[24:27], s40 offen nt
  v_mfma_f32_16x16x32_bf16 v[40:43], a[208:211], v[80:83], v[40:43]
  ds_read_b128 v[116:119], v3 offset:12544
  s_add_u32 s42, s37, 393216
  v_mfma_f32_16x16x32_bf16 v[40:43], a[224:227], v[84:87], v[40:43]
  ds_read_b128 v[120:123], v3 offset:16640
  v_mfma_f32_16x16x32_bf16 v[44:47], a[228:231], v[84:87], 0
  ds_read_b128 v[156:159], v3 offset:20736
  s_add_u32 s43, s36, 0
  v_mfma_f32_16x16x32_bf16 v[44:47], a[212:215], v[80:83], v[44:47]
  v_mfma_f32_16x16x32_bf16 v[44:47], a[196:199], v[76:79], v[44:47]
  v_cvt_pk_bf16_f32 v40, v40, v41
  v_cvt_pk_bf16_f32 v41, v42, v43
  v_mfma_f32_16x16x32_bf16 v[44:47], a[180:183], v[60:63], v[44:47]
  v_mfma_f32_16x16x32_bf16 v[44:47], a[164:167], v[56:59], v[44:47]
  v_mfma_f32_16x16x32_bf16 v[44:47], a[148:151], v[72:75], v[44:47]
  s_waitcnt lgkmcnt(0)
  v_mfma_f32_16x16x32_bf16 v[48:51], a[144:147], v[124:127], 0
  v_mfma_f32_16x16x32_bf16 v[48:51], a[160:163], v[128:131], v[48:51]
  v_mfma_f32_16x16x32_bf16 v[48:51], a[176:179], v[140:143], v[48:51]
  v_cvt_pk_bf16_f32 v42, v44, v45
  v_cvt_pk_bf16_f32 v43, v46, v47
  v_mfma_f32_16x16x32_bf16 v[48:51], a[192:195], v[116:119], v[48:51]
  buffer_store_dwordx4 v[40:43], v7, s[24:27], s41 offen nt
  v_mfma_f32_16x16x32_bf16 v[48:51], a[208:211], v[120:123], v[48:51]
  ds_read_b128 v[16:19], v2 offset:0
  v_mfma_f32_16x16x32_bf16 v[48:51], a[224:227], v[156:159], v[48:51]
  ds_read_b128 v[20:23], v2 offset:4096
  v_max3_f32 v9, v12, v13, v9
  v_mfma_f32_16x16x32_bf16 v[52:55], a[228:231], v[156:159], 0
  ds_read_b128 v[24:27], v2 offset:8192
  v_max3_f32 v9, v14, v15, v9
  v_mfma_f32_16x16x32_bf16 v[52:55], a[212:215], v[120:123], v[52:55]
  ds_read_b128 v[28:31], v2 offset:12288
  v_mfma_f32_16x16x32_bf16 v[52:55], a[196:199], v[116:119], v[52:55]
  v_cvt_pk_bf16_f32 v48, v48, v49
  v_cvt_pk_bf16_f32 v49, v50, v51
  v_mfma_f32_16x16x32_bf16 v[52:55], a[180:183], v[140:143], v[52:55]
  ds_read_b128 v[32:35], v2 offset:16384
  s_lshl_b32 s39, s4, 2
  v_mfma_f32_16x16x32_bf16 v[52:55], a[164:167], v[128:131], v[52:55]
  ds_read_b128 v[36:39], v2 offset:20480
  s_add_u32 s39, s39, 28672
  v_mfma_f32_16x16x32_bf16 v[52:55], a[148:151], v[124:127], v[52:55]
  v_mov_b32 v0, s39
  v_mfma_f32_16x16x32_bf16 v[40:43], a[152:155], v[124:127], 0
  s_mov_b64 s[36:37], 0
  v_mfma_f32_16x16x32_bf16 v[40:43], a[168:171], v[128:131], v[40:43]
  v_cmp_nge_f32 vcc, 0x53800000, v9
  v_mfma_f32_16x16x32_bf16 v[40:43], a[184:187], v[140:143], v[40:43]
  v_cvt_pk_bf16_f32 v50, v52, v53
  v_cvt_pk_bf16_f32 v51, v54, v55
  v_mfma_f32_16x16x32_bf16 v[40:43], a[200:203], v[116:119], v[40:43]
  buffer_store_dwordx4 v[48:51], v7, s[24:27], s42 offen nt
  v_mfma_f32_16x16x32_bf16 v[40:43], a[216:219], v[120:123], v[40:43]
  s_or_b64 vcc, vcc, s[36:37]
  s_cselect_b32 s38, 1, 0
  v_mfma_f32_16x16x32_bf16 v[40:43], a[232:235], v[156:159], v[40:43]
  v_mov_b32 v1, s38
  v_mfma_f32_16x16x32_bf16 v[44:47], a[236:239], v[156:159], 0
  ds_write_b32 v0, v1
  v_mfma_f32_16x16x32_bf16 v[44:47], a[220:223], v[120:123], v[44:47]
  v_mov_b32 v1, 28672
  v_mfma_f32_16x16x32_bf16 v[44:47], a[204:207], v[116:119], v[44:47]
  v_cvt_pk_bf16_f32 v40, v40, v41
  v_cvt_pk_bf16_f32 v41, v42, v43
  v_mfma_f32_16x16x32_bf16 v[44:47], a[188:191], v[140:143], v[44:47]
  v_mfma_f32_16x16x32_bf16 v[44:47], a[172:175], v[128:131], v[44:47]
  v_mfma_f32_16x16x32_bf16 v[44:47], a[156:159], v[124:127], v[44:47]
  s_waitcnt lgkmcnt(1)
  v_mfma_f32_16x16x32_bf16 v[48:51], a[144:147], v[16:19], 0
  v_mfma_f32_16x16x32_bf16 v[48:51], a[160:163], v[20:23], v[48:51]
  v_mfma_f32_16x16x32_bf16 v[48:51], a[176:179], v[24:27], v[48:51]
  v_cvt_pk_bf16_f32 v42, v44, v45
  v_cvt_pk_bf16_f32 v43, v46, v47
  v_mfma_f32_16x16x32_bf16 v[48:51], a[192:195], v[28:31], v[48:51]
  buffer_store_dwordx4 v[40:43], v8, s[24:27], s42 offen nt
  v_mfma_f32_16x16x32_bf16 v[48:51], a[208:211], v[32:35], v[48:51]
  v_mfma_f32_16x16x32_bf16 v[48:51], a[224:227], v[36:39], v[48:51]
  v_mfma_f32_16x16x32_bf16 v[52:55], a[228:231], v[36:39], 0
  v_mfma_f32_16x16x32_bf16 v[52:55], a[212:215], v[32:35], v[52:55]
  v_mfma_f32_16x16x32_bf16 v[52:55], a[196:199], v[28:31], v[52:55]
  v_cvt_pk_bf16_f32 v48, v48, v49
  v_cvt_pk_bf16_f32 v49, v50, v51
  v_mfma_f32_16x16x32_bf16 v[52:55], a[180:183], v[24:27], v[52:55]
  v_mfma_f32_16x16x32_bf16 v[52:55], a[164:167], v[20:23], v[52:55]
  v_mfma_f32_16x16x32_bf16 v[52:55], a[148:151], v[16:19], v[52:55]
  s_nop 7
  v_cvt_pk_bf16_f32 v50, v52, v53
  v_cvt_pk_bf16_f32 v51, v54, v55
  buffer_store_dwordx4 v[48:51], v7, s[24:27], s43 offen nt
  s_waitcnt lgkmcnt(0)
  s_barrier
  ds_read_b128 v[116:119], v1
  s_waitcnt lgkmcnt(0)
  v_or3_b32 v116, v116, v117, v118
  v_or_b32 v116, v116, v119
  s_nop 0
  v_readfirstlane_b32 s36, v116
  s_nop 3
  s_andn2_b32 s36, s36, s31
  s_cbranch_scc1 L_redo
  s_endpgm
L_redo:
  s_mov_b64 s[100:101], s[56:57]
  s_mov_b32 s31, 1
  s_waitcnt vmcnt(0) lgkmcnt(0)
  v_mbcnt_lo_u32_b32 v0, -1, 0
  v_mbcnt_hi_u32_b32 v0, -1, v0
  v_add_u32 v0, s3, v0
  s_barrier
  s_branch L_again
L_special0:
  buffer_load_dwordx4 v6, s[8:11], s49 offen offset:256 nt lds
  s_add_u32 s48, s48, 6291456
  s_add_u32 s49, s48, 786432
  s_add_u32 m0, s32, 65536
  ds_read_b64_tr_b16 a[100:101], v13 offset:49152
  buffer_load_dwordx4 v6, s[8:11], s48 offen offset:0 nt lds
  ds_read_b64_tr_b16 a[102:103], v13 offset:49664
  ds_read_b64_tr_b16 a[104:105], v14 offset:49152
  ds_read_b64_tr_b16 a[106:107], v14 offset:49664
  ds_read_b64_tr_b16 a[108:109], v12 offset:61440
  s_add_u32 m0, s32, 73600
  ds_read_b64_tr_b16 a[110:111], v12 offset:61952
  buffer_load_dwordx4 v6, s[8:11], s48 offen offset:128 nt lds
  ds_read_b64_tr_b16 a[112:113], v13 offset:61440
  ds_read_b64_tr_b16 a[114:115], v13 offset:61952
  ds_read_b64_tr_b16 a[116:117], v14 offset:61440
  ds_read_b64_tr_b16 a[118:119], v14 offset:61952
  s_add_u32 m0, s32, 81664
  s_nop 0
  buffer_load_dwordx4 v6, s[8:11], s48 offen offset:256 nt lds
  s_waitcnt lgkmcnt(0)
  s_waitcnt vmcnt(9)
  s_barrier
  ds_read_b64_tr_b16 a[120:121], v15 offset:0
  ds_read_b64_tr_b16 a[122:123], v15 offset:512
  ds_read_b64_tr_b16 a[124:125], v9 offset:0
  ds_read_b64_tr_b16 a[126:127], v9 offset:512
  ds_read_b64_tr_b16 a[128:129], v11 offset:0
  ds_read_b64_tr_b16 a[130:131], v11 offset:512
  ds_read_b64_tr_b16 a[132:133], v15 offset:12288
  ds_read_b64_tr_b16 a[134:135], v15 offset:12800
  ds_read_b64_tr_b16 a[136:137], v9 offset:12288
  ds_read_b64_tr_b16 a[138:139], v9 offset:12800
  ds_read_b64_tr_b16 a[140:141], v11 offset:12288
  ds_read_b64_tr_b16 a[142:143], v11 offset:12800
  v_mfma_f32_16x16x16_bf16 v[124:127], v[62:63], v[74:75], v[124:127]
  v_mfma_f32_16x16x16_bf16 v[120:123], v[80:81], v[74:75], v[120:123]
  v_mfma_f32_16x16x16_bf16 v[128:131], v[86:87], v[74:75], v[128:131]
  v_mfma_f32_16x16x16_bf16 v[132:135], v[50:51], v[68:69], v[160:163]
  v_mfma_f32_16x16x16_bf16 v[140:143], v[62:63], v[68:69], v[180:183]
  v_mfma_f32_16x16x16_bf16 v[136:139], v[80:81], v[68:69], v[100:103]
  v_mfma_f32_16x16x16_bf16 v[144:147], v[86:87], v[68:69], v[96:99]
  v_mfma_f32_16x16x16_bf16 v[148:151], v[50:51], v[56:57], v[104:107]
  v_mfma_f32_16x16x16_bf16 v[156:159], v[62:63], v[56:57], v[100:103]
  v_mfma_f32_16x16x16_bf16 v[152:155], v[80:81], v[56:57], v[152:155]
  v_mfma_f32_16x16x16_bf16 v[160:163], v[86:87], v[56:57], v[168:171]
  v_mfma_f32_16x16x16_bf16 v[164:167], v[50:51], v[44:45], v[100:103]
  v_mfma_f32_16x16x16_bf16 v[172:175], v[62:63], v[44:45], v[96:99]
  v_mfma_f32_16x16x16_bf16 v[168:171], v[80:81], v[44:45], v[168:171]
  v_mfma_f32_16x16x16_bf16 v[176:179], v[86:87], v[44:45], v[176:179]
  v_mfma_f32_16x16x32_bf16 v[132:135], v[46:49], v[64:67], v[132:135]
  v_mfma_f32_16x16x32_bf16 v[140:143], v[58:61], v[64:67], v[140:143]
  v_mfma_f32_16x16x32_bf16 v[136:139], v[76:79], v[64:67], v[136:139]
  v_mfma_f32_16x16x32_bf16 v[144:147], v[82:85], v[64:67], v[144:147]
  v_mfma_f32_16x16x32_bf16 v[148:151], v[46:49], v[52:55], v[148:151]
  v_mfma_f32_16x16x32_bf16 v[156:159], v[58:61], v[52:55], v[156:159]
  v_mfma_f32_16x16x32_bf16 v[152:155], v[76:79], v[52:55], v[152:155]
  v_mfma_f32_16x16x32_bf16 v[160:163], v[82:85], v[52:55], v[160:163]
  v_mfma_f32_16x16x32_bf16 v[164:167], v[46:49], v[40:43], v[164:167]
  v_mfma_f32_16x16x32_bf16 v[172:175], v[58:61], v[40:43], v[172:175]
  v_mfma_f32_16x16x32_bf16 v[168:171], v[76:79], v[40:43], v[168:171]
  v_mfma_f32_16x16x32_bf16 v[176:179], v[82:85], v[40:43], v[176:179]
  s_branch L_sp2
L_special:
  s_ff1_i32_b64 s44, s[100:101]
  s_bitset0_b64 s[100:101], s44
  s_nop 4
  v_cvt_pk_bf16_f32 v38, v168, v169
  v_cvt_pk_bf16_f32 v39, v170, v171
  v_mfma_f32_16x16x32_bf16 v[116:119], v[46:49], v[70:73], v[112:115]
  v_mfma_f32_16x16x32_bf16 v[124:127], v[58:61], v[70:73], v[108:111]
  v_mfma_f32_16x16x32_bf16 v[120:123], v[76:79], v[70:73], v[104:107]
  v_mfma_f32_16x16x32_bf16 v[128:131], v[82:85], v[70:73], v[100:103]
  v_mfma_f32_16x16x16_bf16 v[116:119], v[50:51], v[74:75], v[116:119]
  v_mfma_f32_16x16x16_bf16 v[124:127], v[62:63], v[74:75], v[124:127]
  v_mfma_f32_16x16x16_bf16 v[120:123], v[80:81], v[74:75], v[120:123]
  v_mfma_f32_16x16x16_bf16 v[128:131], v[86:87], v[74:75], v[128:131]
  v_mfma_f32_16x16x16_bf16 v[132:135], v[50:51], v[68:69], v[108:111]
  v_mfma_f32_16x16x16_bf16 v[140:143], v[62:63], v[68:69], v[104:107]
  v_mfma_f32_16x16x16_bf16 v[136:139], v[80:81], v[68:69], v[100:103]
  v_mfma_f32_16x16x16_bf16 v[144:147], v[86:87], v[68:69], v[96:99]
  v_mfma_f32_16x16x16_bf16 v[148:151], v[50:51], v[56:57], v[104:107]
  v_mfma_f32_16x16x16_bf16 v[156:159], v[62:63], v[56:57], v[100:103]
  v_mfma_f32_16x16x16_bf16 v[152:155], v[80:81], v[56:57], v[96:99]
  v_mfma_f32_16x16x16_bf16 v[160:163], v[86:87], v[56:57], v[92:95]
  v_mfma_f32_16x16x16_bf16 v[164:167], v[50:51], v[44:45], v[100:103]
  v_mfma_f32_16x16x16_bf16 v[172:175], v[62:63], v[44:45], v[96:99]
  v_mfma_f32_16x16x16_bf16 v[168:171], v[80:81], v[44:45], v[92:95]
  v_mfma_f32_16x16x16_bf16 v[176:179], v[86:87], v[44:45], v[88:91]
  v_mfma_f32_16x16x32_bf16 v[132:135], v[46:49], v[64:67], v[132:135]
  v_mfma_f32_16x16x32_bf16 v[140:143], v[58:61], v[64:67], v[140:143]
  v_mfma_f32_16x16x32_bf16 v[136:139], v[76:79], v[64:67], v[136:139]
  v_mfma_f32_16x16x32_bf16 v[144:147], v[82:85], v[64:67], v[144:147]
  v_mfma_f32_16x16x32_bf16 v[148:151], v[46:49], v[52:55], v[148:151]
  v_mfma_f32_16x16x32_bf16 v[156:159], v[58:61], v[52:55], v[156:159]
  v_mfma_f32_16x16x32_bf16 v[152:155], v[76:79], v[52:55], v[152:155]
  v_mfma_f32_16x16x32_bf16 v[160:163], v[82:85], v[52:55], v[160:163]
  v_mfma_f32_16x16x32_bf16 v[164:167], v[46:49], v[40:43], v[164:167]
  v_mfma_f32_16x16x32_bf16 v[172:175], v[58:61], v[40:43], v[172:175]
  v_mfma_f32_16x16x32_bf16 v[168:171], v[76:79], v[40:43], v[168:171]
  v_mfma_f32_16x16x32_bf16 v[176:179], v[82:85], v[40:43], v[176:179]
  ds_read_b128 v[64:67], v3 offset:16384
  ds_read_b128 v[68:71], v3 offset:20480
L_sp2:
  s_nop 15
  v_max_f32 v40, v164, v165
  v_max3_f32 v40, v166, v167, v40
  v_max3_f32 v40, v172, v173, v40
  v_max3_f32 v40, v174, v175, v40
  v_max3_f32 v40, v168, v169, v40
  v_max3_f32 v40, v170, v171, v40
  v_max3_f32 v40, v176, v177, v40
  v_max3_f32 v40, v178, v179, v40
  v_mov_b32 v41, v40
  s_nop 1
  v_permlane32_swap_b32 v40, v41
  v_max_f32 v40, v40, v41
  v_mov_b32 v41, v40
  s_nop 1
  v_permlane16_swap_b32 v40, v41
  v_max_f32 v40, v40, v41
  v_sub_f32 v164, v164, v40
  v_sub_f32 v165, v165, v40
  v_sub_f32 v166, v166, v40
  v_sub_f32 v167, v167, v40
  v_sub_f32 v172, v172, v40
  v_sub_f32 v173, v173, v40
  v_sub_f32 v174, v174, v40
  v_sub_f32 v175, v175, v40
  v_sub_f32 v168, v168, v40
  v_sub_f32 v169, v169, v40
  v_sub_f32 v170, v170, v40
  v_sub_f32 v171, v171, v40
  v_sub_f32 v176, v176, v40
  v_sub_f32 v177, v177, v40
  v_sub_f32 v178, v178, v40
  v_sub_f32 v179, v179, v40
  v_max_f32 v40, v148, v149
  v_max3_f32 v40, v150, v151, v40
  v_max3_f32 v40, v156, v157, v40
  v_max3_f32 v40, v158, v159, v40
  v_max3_f32 v40, v152, v153, v40
  v_max3_f32 v40, v154, v155, v40
  v_max3_f32 v40, v160, v161, v40
  v_max3_f32 v40, v162, v163, v40
  v_mov_b32 v41, v40
  s_nop 1
  v_permlane32_swap_b32 v40, v41
  v_max_f32 v40, v40, v41
  v_mov_b32 v41, v40
  s_nop 1
  v_permlane16_swap_b32 v40, v41
  v_max_f32 v40, v40, v41
  v_sub_f32 v148, v148, v40
  v_sub_f32 v149, v149, v40
  v_sub_f32 v150, v150, v40
  v_sub_f32 v151, v151, v40
  v_sub_f32 v156, v156, v40
  v_sub_f32 v157, v157, v40
  v_sub_f32 v158, v158, v40
  v_sub_f32 v159, v159, v40
  v_sub_f32 v152, v152, v40
  v_sub_f32 v153, v153, v40
  v_sub_f32 v154, v154, v40
  v_sub_f32 v155, v155, v40
  v_sub_f32 v160, v160, v40
  v_sub_f32 v161, v161, v40
  v_sub_f32 v162, v162, v40
  v_sub_f32 v163, v163, v40
  v_max_f32 v40, v132, v133
  v_max3_f32 v40, v134, v135, v40
  v_max3_f32 v40, v140, v141, v40
  v_max3_f32 v40, v142, v143, v40
  v_max3_f32 v40, v136, v137, v40
  v_max3_f32 v40, v138, v139, v40
  v_max3_f32 v40, v144, v145, v40
  v_max3_f32 v40, v146, v147, v40
  v_mov_b32 v41, v40
  s_nop 1
  v_permlane32_swap_b32 v40, v41
  v_max_f32 v40, v40, v41
  v_mov_b32 v41, v40
  s_nop 1
  v_permlane16_swap_b32 v40, v41
  v_max_f32 v40, v40, v41
  v_sub_f32 v132, v132, v40
  v_sub_f32 v133, v133, v40
  v_sub_f32 v134, v134, v40
  v_sub_f32 v135, v135, v40
  v_sub_f32 v140, v140, v40
  v_sub_f32 v141, v141, v40
  v_sub_f32 v142, v142, v40
  v_sub_f32 v143, v143, v40
  v_sub_f32 v136, v136, v40
  v_sub_f32 v137, v137, v40
  v_sub_f32 v138, v138, v40
  v_sub_f32 v139, v139, v40
  v_sub_f32 v144, v144, v40
  v_sub_f32 v145, v145, v40
  v_sub_f32 v146, v146, v40
  v_sub_f32 v147, v147, v40
  v_max_f32 v40, v116, v117
  v_max3_f32 v40, v118, v119, v40
  v_max3_f32 v40, v124, v125, v40
  v_max3_f32 v40, v126, v127, v40
  v_max3_f32 v40, v120, v121, v40
  v_max3_f32 v40, v122, v123, v40
  v_max3_f32 v40, v128, v129, v40
  v_max3_f32 v40, v130, v131, v40
  v_mov_b32 v41, v40
  s_nop 1
  v_permlane32_swap_b32 v40, v41
  v_max_f32 v40, v40, v41
  v_mov_b32 v41, v40
  s_nop 1
  v_permlane16_swap_b32 v40, v41
  v_max_f32 v40, v40, v41
  v_sub_f32 v116, v116, v40
  v_sub_f32 v117, v117, v40
  v_sub_f32 v118, v118, v40
  v_sub_f32 v119, v119, v40
  v_sub_f32 v124, v124, v40
  v_sub_f32 v125, v125, v40
  v_sub_f32 v126, v126, v40
  v_sub_f32 v127, v127, v40
  v_sub_f32 v120, v120, v40
  v_sub_f32 v121, v121, v40
  v_sub_f32 v122, v122, v40
  v_sub_f32 v123, v123, v40
  v_sub_f32 v128, v128, v40
  v_sub_f32 v129, v129, v40
  v_sub_f32 v130, v130, v40
  v_sub_f32 v131, v131, v40
  v_exp_f32 v116, v116
  v_exp_f32 v117, v117
  v_exp_f32 v118, v118
  v_exp_f32 v119, v119
  v_cvt_pk_bf16_f32 v116, v116, v117
  v_cvt_pk_bf16_f32 v117, v118, v119
  v_exp_f32 v124, v124
  v_exp_f32 v125, v125
  v_exp_f32 v126, v126
  s_waitcnt lgkmcnt(0)
  s_nop 7
  s_cmp_eq_u32 s35, 1
  s_cbranch_scc1 L_enter
  v_exp_f32 v127, v127
  v_cvt_pk_bf16_f32 v118, v124, v125
  v_cvt_pk_bf16_f32 v119, v126, v127
  v_exp_f32 v120, v120
  v_exp_f32 v121, v121
  v_exp_f32 v122, v122
  v_exp_f32 v123, v123
  v_cvt_pk_bf16_f32 v120, v120, v121
  v_cvt_pk_bf16_f32 v121, v122, v123
  v_exp_f32 v128, v128
  v_exp_f32 v129, v129
  v_exp_f32 v130, v130
  v_exp_f32 v131, v131
  v_cvt_pk_bf16_f32 v122, v128, v129
  v_cvt_pk_bf16_f32 v123, v130, v131
  v_exp_f32 v132, v132
  v_exp_f32 v133, v133
  v_exp_f32 v134, v134
  v_cvt_pk_bf16_f32 v132, v132, v133
  s_nop 7
  s_branch L_pj
L_end:
  s_endpgm
.fill (standalone__window_attn_swin__vision_kernel + 33280 - .) / 4, 4, 0xbf810000
.section .rodata,"a"
.p2align 6
.amdhsa_kernel standalone__window_attn_swin__vision_kernel
  .amdhsa_next_free_vgpr 512
  .amdhsa_next_free_sgpr 102
  .amdhsa_accum_offset 256
  .amdhsa_group_segment_fixed_size 0
  .amdhsa_kernarg_size 72
  .amdhsa_user_sgpr_count 2
  .amdhsa_user_sgpr_kernarg_segment_ptr 1
  .amdhsa_system_sgpr_workgroup_id_x 1
.end_amdhsa_kernel
```

```asm
; @launch grid=(256,1,1) block=(256,1,1) lds=163840
.amdgcn_target "amdgcn-amd-amdhsa--gfx950"
.text
.globl standalone__window_attn_swin__vision_kernel
.p2align 12
.p2align 8
.type standalone__window_attn_swin__vision_kernel,@function
standalone__window_attn_swin__vision_kernel:
  s_mov_b32 s31, 0
  s_mov_b64 s[56:57], 0
L_again:
  s_load_dwordx2 s[8:9], s[0:1], 0
  s_load_dwordx2 s[12:13], s[0:1], 8
  s_cmpk_ge_u32 s2, 256
  s_cbranch_scc1 L_end
  s_getpc_b64 s[42:43]
  s_lshr_b32 s44, s2, 3
  s_lshl_b32 s45, s44, 10
  v_lshl_add_u32 v2, v0, 2, s45
  v_mov_b32 v3, 0
  v_lshl_add_u64 v[2:3], v[2:3], 0, s[42:43]
  global_load_dword v64, v[2:3], off
  v_readfirstlane_b32 s3, v0
  s_load_dwordx2 s[20:21], s[0:1], 24
  s_mov_b32 s11, 0x20000
  s_mov_b32 s15, s11
  s_mov_b32 s14, 223232
  s_mulk_i32 s44, 6912
  v_lshlrev_b32 v26, 5, v0
  s_lshr_b32 s28, s2, 2
  s_or_b32 s28, s28, 1
  s_and_b32 s29, s2, 1
  s_sub_u32 s28, s28, s29
  s_bfe_u32 s29, s2, 0x20001
  s_lshr_b32 s4, s3, 6
  s_lshl_b32 s36, s28, 3
  v_bfe_u32 v21, v0, 3, 3
  v_add3_u32 v25, s36, 4, v21
  v_and_b32 v25, 0x1ff, v25
  v_mul_u32_u24 v25, 0x180, v25
  v_lshrrev_b32 v23, 4, v0
  v_lshrrev_b32 v24, 1, v0
  v_and_b32 v24, 4, v24
  v_bitop3_b32 v24, v24, v23, v0 bitop3:0x96
  v_and_b32 v24, 7, v24
  v_lshl_add_u32 v6, v24, 4, v25
  s_lshl3_add_u32 s36, s29, s4
  s_add_u32 s48, s36, 484
  s_add_u32 s49, s48, 4
  s_and_b32 s49, s49, 0x1ff
  s_mov_b32 s37, 196608
  s_mul_i32 s48, s48, s37
  s_mul_i32 s49, s49, s37
  s_mov_b32 s10, 100663296
  s_waitcnt lgkmcnt(0)
  s_sub_u32 s12, s12, 2048
  s_subb_u32 s13, s13, 0
  buffer_load_dword v65, v26, s[12:15], s44 offen offset:2048
  v_and_b32 v22, 4, v23
  v_and_b32 v24, 2, v21
  v_bitop3_b32 v24, v24, v22, v0 bitop3:0x96
  v_and_b32 v24, 7, v24
  v_mul_u32_u24 v25, 1152, v21
  v_lshl_add_u32 v25, v24, 4, v25
  v_add_u32 v136, 2048, v25
  v_add_u32 v137, 1152, v25
  v_add_u32 v138, 256, v25
  s_mul_i32 s62, s4, 9216
  s_mul_i32 s58, s4, 3072
  s_add_u32 s63, s58, 40960
  s_mov_b32 s22, 1800
  s_mov_b32 s23, s11
  v_lshlrev_b32 v34, 4, v0
  s_lshl_b32 s37, s4, 10
  s_add_u32 m0, s37, 24576
  v_mul_u32_u24 v35, 9, v0
  buffer_load_dwordx4 v34, s[20:23], 0 offen lds
  v_and_b32 v35, -4, v35
  s_load_dwordx2 s[16:17], s[0:1], 16
  s_load_dwordx2 s[24:25], s[0:1], 48
  s_load_dwordx2 s[20:21], s[0:1], 56
  v_and_b32 v16, 63, v0
  v_and_b32 v17, 15, v16
  v_lshrrev_b32 v18, 4, v16
  v_lshrrev_b32 v20, 2, v17
  v_and_b32 v27, 1, v18
  s_add_u32 m0, s63, 0
  s_add_u32 s36, s62, 0
  buffer_load_dwordx4 v136, s[12:15], s36 offen offset:0 lds
  v_lshrrev_b32 v28, 3, v17
  v_lshl_add_u32 v21, v27, 1, v28
  v_mul_u32_u24 v22, 3072, v18
  v_lshl_add_u32 v22, v20, 7, v22
  v_lshl_add_u32 v22, v21, 5, v22
  v_and_b32 v29, 3, v17
  v_lshl_add_u32 v22, v29, 3, v22
  s_mul_i32 s37, s4, 3
  buffer_load_dwordx4 v137, s[12:15], s36 offen offset:1024 lds
  s_and_b32 s38, s37, 3
  s_lshl_b32 s38, s38, 5
  s_lshr_b32 s39, s37, 2
  s_lshl_b32 s39, s39, 10
  s_add_u32 s39, s39, 40960
  v_xor_b32 v23, s38, v22
  v_add_u32 v12, s39, v23
  v_add_u32 v15, 73728, v12
  buffer_load_dwordx4 v138, s[12:15], s36 offen offset:2048 lds
  s_add_u32 s37, s37, 1
  s_and_b32 s38, s37, 3
  s_lshl_b32 s38, s38, 5
  s_lshr_b32 s39, s37, 2
  s_lshl_b32 s39, s39, 10
  s_add_u32 s39, s39, 40960
  s_mov_b64 exec, 0
  s_cmp_eq_u32 s4, 0
  s_cbranch_scc1 L_hop0
  s_cmp_eq_u32 s4, 1
  s_cbranch_scc1 L_hop1
  s_cmp_eq_u32 s4, 2
  s_cbranch_scc1 L_hop2
  s_branch L_hop3
L_hopped:
  s_mov_b64 exec, -1
  v_xor_b32 v23, s38, v22
  s_add_u32 m0, s63, 12288
  s_add_u32 s36, s62, 36864
  buffer_load_dwordx4 v136, s[12:15], s36 offen offset:0 lds
  v_add_u32 v13, s39, v23
  v_add_u32 v9, 73728, v13
  s_add_u32 s37, s37, 1
  s_and_b32 s38, s37, 3
  s_lshl_b32 s38, s38, 5
  s_lshr_b32 s39, s37, 2
  s_lshl_b32 s39, s39, 10
  s_add_u32 s39, s39, 40960
  buffer_load_dwordx4 v137, s[12:15], s36 offen offset:1024 lds
  v_xor_b32 v23, s38, v22
  v_add_u32 v14, s39, v23
  v_add_u32 v11, 73728, v14
  s_mov_b32 s46, 0x3e553b95
  s_mov_b32 s47, s46
  s_mov_b32 s44, 0xffff0000
  v_bfe_u32 v19, v17, 1, 3
  v_and_b32 v21, 1, v17
  buffer_load_dwordx4 v138, s[12:15], s36 offen offset:2048 lds
  v_lshlrev_b32 v21, 2, v21
  v_xor_b32 v19, v19, v21
  v_xor_b32 v21, v18, v19
  v_lshlrev_b32 v21, 4, v21
  v_lshl_add_u32 v0, v17, 7, v21
  s_lshl_b32 s32, s4, 10
  v_subrev_u32 v10, s32, v0
  v_and_b32 v21, 1, v17
  s_add_u32 m0, s63, 24576
  s_add_u32 s36, s62, 73728
  buffer_load_dwordx4 v136, s[12:15], s36 offen offset:0 lds
  v_mul_u32_u24 v21, 0xaaaa, v21
  v_add_u32 v21, 0x4444, v21
  v_lshl_add_u32 v10, v10, 16, v21
  v_xor_b32 v1, 64, v0
  v_lshlrev_b32 v22, 4, v17
  v_lshl_add_u32 v23, v18, 10, v22
  s_and_b32 s5, s4, 1
  s_lshl_b32 s37, s5, 9
  s_add_u32 s38, s37, 114688
  v_add_u32 v3, s38, v23
  s_sub_u32 s38, 114688, s37
  v_add_u32 v2, s38, v23
  s_lshl_b32 s37, s4, 12
  s_add_u32 s37, s37, 90112
  v_add_u32 v4, s37, v23
  s_lshl_b32 s37, s4, 11
  s_add_u32 s37, s37, 106496
  v_lshrrev_b32 v23, 1, v18
  v_lshl_add_u32 v24, v23, 10, v22
  v_lshl_add_u32 v24, v27, 3, v24
  v_add_u32 v5, s37, v24
  s_mov_b32 s7, 24576
  v_sub_u32 v24, v28, v23
  v_mul_i32_i24 v24, 15, v24
  v_and_b32 v26, 7, v17
  v_lshlrev_b32 v25, 2, v27
  v_sub_u32 v30, v26, v25
  v_add3_u32 v24, v24, v30, 19
  s_lshl_b32 s37, s4, 1
  s_and_b32 s37, s37, 0
  s_waitcnt lgkmcnt(0)
  s_mov_b32 s18, 73728
  s_mov_b32 s19, s11
  s_mul_i32 s60, s4, 0x02020000
  s_add_u32 s60, s60, 0x01000c0c
  s_add_u32 s37, s37, 24576
  v_lshl_add_u32 v144, v24, 3, s37
  v_add_u32 v145, 960, v144
  s_lshl_b32 s37, s28, 3
  v_add3_u32 v24, s37, 4, v26
  v_and_b32 v24, 0x1ff, v24
  v_mul_u32_u24 v24, 0x180, v24
  v_mul_u32_u24 v26, 196608, v28
  v_add_u32 v24, v24, v26
  v_lshl_add_u32 v24, v18, 4, v24
  s_lshr_b32 s37, s4, 1
  s_lshl_b32 s38, s37, 6
  s_add_u32 s39, s38, 256
  v_add_u32 v8, s39, v24
  s_lshl_b32 s39, s5, 7
  s_add_u32 s38, s38, s39
  v_add_u32 v7, s38, v24
  v_and_b32 v24, 16, v16
  v_lshlrev_b32 v24, 2, v24
  v_lshlrev_b32 v26, 4, v16
  v_xor_b32 v24, v24, v26
  v_accvgpr_write_b32 a228, v24
  v_add_u32 v30, v25, v20
  v_mul_u32_u24 v31, 3072, v23
  v_lshl_add_u32 v31, v29, 4, v31
  v_mad_u32_u24 v32, v30, 3, s5
  v_lshrrev_b32 v33, 1, v32
  v_xor_b32 v33, s37, v33
  v_and_b32 v33, 1, v33
  v_lshl_add_u32 v32, v32, 1, v33
  buffer_load_dwordx4 v137, s[12:15], s36 offen offset:1024 lds
  v_lshl_add_u32 v32, v32, 6, v31
  v_add_u32 v32, 114688, v32
  v_accvgpr_write_b32 a229, v32
  v_mad_u32_u24 v32, v30, 3, 2
  v_lshrrev_b32 v33, 1, v32
  v_xor_b32 v33, s37, v33
  v_and_b32 v33, 1, v33
  v_lshl_add_u32 v32, v32, 1, v33
  v_lshl_add_u32 v32, v32, 6, v31
  v_add_u32 v32, 114688, v32
  v_accvgpr_write_b32 a230, v32
  v_mul_u32_u24 v31, 3072, v18
  buffer_load_dwordx4 v138, s[12:15], s36 offen offset:2048 lds
  v_lshl_add_u32 v31, v29, 4, v31
  v_mad_u32_u24 v32, v20, 3, s5
  v_lshrrev_b32 v33, 1, v32
  v_xor_b32 v33, s37, v33
  v_and_b32 v33, 1, v33
  v_lshl_add_u32 v32, v32, 1, v33
  v_lshl_add_u32 v32, v32, 6, v31
  v_accvgpr_write_b32 a231, v32
  v_mad_u32_u24 v32, v20, 3, 2
  v_lshrrev_b32 v33, 1, v32
  v_xor_b32 v33, s37, v33
  v_and_b32 v33, 1, v33
  s_add_u32 m0, s63, 36864
  s_add_u32 s36, s62, 110592
  buffer_load_dwordx4 v136, s[12:15], s36 offen offset:0 lds
  v_lshl_add_u32 v32, v32, 1, v33
  v_lshl_add_u32 v32, v32, 6, v31
  v_accvgpr_write_b32 a232, v32
  s_mul_i32 s59, s37, 12288
  s_add_u32 s59, s59, s58
  v_cmp_gt_u32 vcc, 2, v29
  v_mov_b32 v31, 0x3f803f80
  s_mov_b32 s26, 100663296
  s_mov_b32 s27, s11
  v_cndmask_b32 v31, 0, v31, vcc
  v_accvgpr_write_b32 a240, v31
  v_accvgpr_write_b32 a241, v31
  buffer_load_dwordx4 v137, s[12:15], s36 offen offset:1024 lds
  v_accvgpr_write_b32 a242, v31
  v_accvgpr_write_b32 a243, v31
  v_lshrrev_b32 v150, 2, v16
  v_xor_b32 v151, v16, v150
  s_cmp_eq_u32 s28, 63
  s_cselect_b32 s37, 4, 0
  v_and_b32 v151, s37, v151
  v_cmp_eq_u32 vcc, 0, v151
  s_cmp_eq_u32 s29, 3
  s_cselect_b32 s37, 0xc31044fe, 0
  v_mov_b32 v150, s37
  v_mov_b32 v149, 0xc31044fe
  buffer_load_dwordx4 v138, s[12:15], s36 offen offset:2048 lds
  v_cndmask_b32 v151, 0, v150, vcc
  s_waitcnt vmcnt(12)
  s_barrier
  ds_read_b64 v[156:157], v144 offset:24
  v_cndmask_b32 v150, v149, 0, vcc
  ds_read_b64 v[158:159], v144 offset:16
  s_mov_b32 s45, 0x3fb8aa3b
  ds_read_b64 v[152:153], v144 offset:8
  s_lshl_b32 s37, s29, 3
  ds_read_b64 v[154:155], v144 offset:0
  s_lshl_b32 s38, s5, 2
  s_add_u32 m0, s63, 49152
  s_add_u32 s36, s62, 147456
  buffer_load_dwordx4 v136, s[12:15], s36 offen offset:0 lds
  s_xor_b32 s39, s38, 0
  ds_read_b64 v[160:161], v144 offset:264
  s_add_u32 s40, s39, s37
  ds_read_b64 v[162:163], v144 offset:256
  s_add_u32 s40, s40, 484
  ds_read_b64 v[164:165], v144 offset:248
  s_and_b32 s40, s40, 0x1ff
  s_mul_i32 s40, s40, 196608
  ds_read_b64 v[166:167], v144 offset:240
  s_sub_u32 s39, s39, s4
  ds_read_b64 v[172:173], v144 offset:504
  s_mul_i32 s52, s39, 196608
  buffer_load_dwordx4 v137, s[12:15], s36 offen offset:1024 lds
  ds_read_b64 v[174:175], v144 offset:496
  s_xor_b32 s39, s38, 2
  ds_read_b64 v[168:169], v144 offset:488
  s_add_u32 s41, s39, s37
  s_add_u32 s41, s41, 484
  ds_read_b64 v[170:171], v144 offset:480
  s_and_b32 s41, s41, 0x1ff
  ds_read_b64 v[176:177], v144 offset:744
  s_mul_i32 s41, s41, 196608
  ds_read_b64 v[178:179], v144 offset:736
  s_sub_u32 s39, s39, s4
  s_mul_i32 s53, s39, 196608
  buffer_load_dwordx4 v138, s[12:15], s36 offen offset:2048 lds
  ds_read_b64 v[180:181], v144 offset:728
  s_xor_b32 s39, s38, 4
  ds_read_b64 v[182:183], v144 offset:720
  s_add_u32 s42, s39, s37
  ds_read_b64 v[116:117], v144 offset:984
  s_add_u32 s42, s42, 484
  ds_read_b64 v[118:119], v144 offset:976
  s_and_b32 s42, s42, 0x1ff
  s_mul_i32 s42, s42, 196608
  ds_read_b64 v[124:125], v144 offset:968
  s_sub_u32 s39, s39, s4
  ds_read_b64 v[126:127], v144 offset:960
  s_add_u32 m0, s63, 61440
  s_add_u32 s36, s62, 184320
  buffer_load_dwordx4 v136, s[12:15], s36 offen offset:0 lds
  s_mul_i32 s54, s39, 196608
  ds_read_b64 v[120:121], v144 offset:1224
  s_xor_b32 s39, s38, 6
  s_add_u32 s43, s39, s37
  ds_read_b64 v[122:123], v144 offset:1216
  s_add_u32 s43, s43, 484
  ds_read_b64 v[128:129], v144 offset:1208
  s_and_b32 s43, s43, 0x1ff
  ds_read_b64 v[130:131], v144 offset:1200
  s_mul_i32 s43, s43, 196608
  ds_read_b64 v[132:133], v144 offset:1464
  s_sub_u32 s39, s39, s4
  buffer_load_dwordx4 v137, s[12:15], s36 offen offset:1024 lds
  s_mul_i32 s55, s39, 196608
  ds_read_b64 v[134:135], v144 offset:1456
  s_mul_i32 s34, s32, 3
  ds_read_b64 v[140:141], v144 offset:1448
  s_add_u32 s34, s34, 106496
  ds_read_b64 v[142:143], v144 offset:1440
  s_mov_b32 s35, 1
  s_mov_b32 s30, 1
  s_waitcnt vmcnt(11)
  s_barrier
  ds_read_b64_tr_b16 v[184:185], v12 offset:0
  ds_read_b64_tr_b16 v[186:187], v12 offset:512
  buffer_load_dwordx4 v138, s[12:15], s36 offen offset:2048 lds
  ds_read_b64_tr_b16 v[188:189], v13 offset:0
  ds_read_b64_tr_b16 v[190:191], v13 offset:512
  ds_read_b64_tr_b16 v[192:193], v14 offset:0
  ds_read_b64_tr_b16 v[194:195], v14 offset:512
  ds_read_b64_tr_b16 v[196:197], v12 offset:12288
  ds_read_b64_tr_b16 v[198:199], v12 offset:12800
  ds_read_b64_tr_b16 v[200:201], v13 offset:12288
  ds_read_b64_tr_b16 v[202:203], v13 offset:12800
  ds_read_b64_tr_b16 v[204:205], v14 offset:12288
  ds_read_b64_tr_b16 v[206:207], v14 offset:12800
  s_waitcnt lgkmcnt(12)
  v_perm_b32 v88, v157, v156, s60
  s_lshl_b32 m0, s3, 4
  s_nop 0
  buffer_load_dwordx4 v6, s[8:11], s48 offen offset:0 nt lds
  v_perm_b32 v89, v159, v158, s60
  v_perm_b32 v90, v153, v152, s60
  v_perm_b32 v91, v155, v154, s60
  v_perm_b32 v92, v161, v160, s60
  v_perm_b32 v93, v163, v162, s60
  v_perm_b32 v94, v165, v164, s60
  v_perm_b32 v95, v167, v166, s60
  v_perm_b32 v96, v173, v172, s60
  v_perm_b32 v97, v175, v174, s60
  v_perm_b32 v98, v169, v168, s60
  v_perm_b32 v99, v171, v170, s60
  v_perm_b32 v100, v177, v176, s60
  s_addk_i32 m0, 8064
  s_nop 0
  buffer_load_dwordx4 v6, s[8:11], s48 offen offset:128 nt lds
  v_perm_b32 v101, v179, v178, s60
  v_perm_b32 v102, v181, v180, s60
  v_perm_b32 v103, v183, v182, s60
  v_perm_b32 v104, v117, v116, s60
  v_perm_b32 v105, v119, v118, s60
  v_perm_b32 v106, v125, v124, s60
  v_perm_b32 v107, v127, v126, s60
  v_perm_b32 v108, v121, v120, s60
  v_perm_b32 v109, v123, v122, s60
  v_perm_b32 v110, v129, v128, s60
  v_perm_b32 v111, v131, v130, s60
  v_perm_b32 v112, v133, v132, s60
  s_addk_i32 m0, 8064
  s_nop 0
  buffer_load_dwordx4 v6, s[8:11], s48 offen offset:256 nt lds
  v_perm_b32 v113, v135, v134, s60
  v_perm_b32 v114, v141, v140, s60
  v_perm_b32 v115, v143, v142, s60
  s_waitcnt lgkmcnt(10)
  v_lshlrev_b32 v40, 16, v184
  v_and_b32 v41, s44, v184
  v_lshlrev_b32 v42, 16, v185
  v_and_b32 v43, s44, v185
  v_lshlrev_b32 v44, 16, v186
  v_and_b32 v45, s44, v186
  v_lshlrev_b32 v46, 16, v187
  v_and_b32 v47, s44, v187
  s_lshl_b32 m0, s3, 4
  s_addk_i32 m0, 4096
  s_nop 0
  buffer_load_dwordx4 v6, s[8:11], s49 offen offset:0 nt lds
  v_pk_mul_f32 v[40:41], v[40:41], s[46:47]
  v_pk_mul_f32 v[42:43], v[42:43], s[46:47]
  v_pk_mul_f32 v[44:45], v[44:45], s[46:47]
  v_pk_mul_f32 v[46:47], v[46:47], s[46:47]
  v_cvt_pk_bf16_f32 v184, v40, v41
  v_cvt_pk_bf16_f32 v185, v42, v43
  v_cvt_pk_bf16_f32 v186, v44, v45
  s_waitcnt lgkmcnt(0)
  v_cvt_pk_bf16_f32 v187, v46, v47
  v_lshlrev_b32 v48, 16, v188
  v_and_b32 v49, s44, v188
  v_lshlrev_b32 v50, 16, v189
  s_addk_i32 m0, 8064
  s_nop 0
  buffer_load_dwordx4 v6, s[8:11], s49 offen offset:128 nt lds
  v_and_b32 v51, s44, v189
  v_lshlrev_b32 v52, 16, v190
  v_and_b32 v53, s44, v190
  v_lshlrev_b32 v54, 16, v191
  v_and_b32 v55, s44, v191
  v_pk_mul_f32 v[48:49], v[48:49], s[46:47]
  v_pk_mul_f32 v[50:51], v[50:51], s[46:47]
  v_pk_mul_f32 v[52:53], v[52:53], s[46:47]
  v_pk_mul_f32 v[54:55], v[54:55], s[46:47]
  v_cvt_pk_bf16_f32 v188, v48, v49
  v_cvt_pk_bf16_f32 v189, v50, v51
  v_cvt_pk_bf16_f32 v190, v52, v53
  s_addk_i32 m0, 8064
  s_nop 0
  buffer_load_dwordx4 v6, s[8:11], s49 offen offset:256 nt lds
  v_cvt_pk_bf16_f32 v191, v54, v55
  v_lshlrev_b32 v56, 16, v192
  v_and_b32 v57, s44, v192
  v_lshlrev_b32 v58, 16, v193
  v_and_b32 v59, s44, v193
  v_lshlrev_b32 v60, 16, v194
  v_and_b32 v61, s44, v194
  v_lshlrev_b32 v62, 16, v195
  v_and_b32 v63, s44, v195
  v_pk_mul_f32 v[56:57], v[56:57], s[46:47]
  v_pk_mul_f32 v[58:59], v[58:59], s[46:47]
  v_pk_mul_f32 v[60:61], v[60:61], s[46:47]
  s_lshr_b32 s36, s2, 3
  s_mulk_i32 s36, 2304
  buffer_load_dword v66, v35, s[16:19], s36 offen
  v_pk_mul_f32 v[62:63], v[62:63], s[46:47]
  v_cvt_pk_bf16_f32 v192, v56, v57
  v_cvt_pk_bf16_f32 v193, v58, v59
  v_cvt_pk_bf16_f32 v194, v60, v61
  v_cvt_pk_bf16_f32 v195, v62, v63
  v_lshlrev_b32 v40, 16, v196
  v_and_b32 v41, s44, v196
  v_lshlrev_b32 v42, 16, v197
  v_and_b32 v43, s44, v197
  v_lshlrev_b32 v44, 16, v198
  v_and_b32 v45, s44, v198
  v_lshlrev_b32 v46, 16, v199
  v_and_b32 v47, s44, v199
  v_pk_mul_f32 v[40:41], v[40:41], s[46:47]
  v_pk_mul_f32 v[42:43], v[42:43], s[46:47]
  v_pk_mul_f32 v[44:45], v[44:45], s[46:47]
  v_pk_mul_f32 v[46:47], v[46:47], s[46:47]
  v_cvt_pk_bf16_f32 v196, v40, v41
  v_cvt_pk_bf16_f32 v197, v42, v43
  v_cvt_pk_bf16_f32 v198, v44, v45
  v_cvt_pk_bf16_f32 v199, v46, v47
  v_lshlrev_b32 v48, 16, v200
  v_and_b32 v49, s44, v200
  v_lshlrev_b32 v50, 16, v201
  v_and_b32 v51, s44, v201
  v_lshlrev_b32 v52, 16, v202
  v_and_b32 v53, s44, v202
  v_lshlrev_b32 v54, 16, v203
  v_and_b32 v55, s44, v203
  v_pk_mul_f32 v[48:49], v[48:49], s[46:47]
  v_pk_mul_f32 v[50:51], v[50:51], s[46:47]
  v_pk_mul_f32 v[52:53], v[52:53], s[46:47]
  v_pk_mul_f32 v[54:55], v[54:55], s[46:47]
  v_cvt_pk_bf16_f32 v200, v48, v49
  v_cvt_pk_bf16_f32 v201, v50, v51
  v_cvt_pk_bf16_f32 v202, v52, v53
  v_cvt_pk_bf16_f32 v203, v54, v55
  v_lshlrev_b32 v56, 16, v204
  v_and_b32 v57, s44, v204
  v_lshlrev_b32 v58, 16, v205
  v_and_b32 v59, s44, v205
  v_lshlrev_b32 v60, 16, v206
  v_and_b32 v61, s44, v206
  v_lshlrev_b32 v62, 16, v207
  v_and_b32 v63, s44, v207
  v_pk_mul_f32 v[56:57], v[56:57], s[46:47]
  v_pk_mul_f32 v[58:59], v[58:59], s[46:47]
  v_pk_mul_f32 v[60:61], v[60:61], s[46:47]
  v_pk_mul_f32 v[62:63], v[62:63], s[46:47]
  v_cvt_pk_bf16_f32 v204, v56, v57
  v_cvt_pk_bf16_f32 v205, v58, v59
  v_cvt_pk_bf16_f32 v206, v60, v61
  v_cvt_pk_bf16_f32 v207, v62, v63
  s_waitcnt vmcnt(13)
  s_barrier
  ds_read_b64_tr_b16 v[208:209], v12 offset:24576
  ds_read_b64_tr_b16 v[210:211], v12 offset:25088
  ds_read_b64_tr_b16 v[212:213], v13 offset:24576
  ds_read_b64_tr_b16 v[214:215], v13 offset:25088
  ds_read_b64_tr_b16 v[216:217], v14 offset:24576
  ds_read_b64_tr_b16 v[218:219], v14 offset:25088
  ds_read_b64_tr_b16 v[220:221], v12 offset:36864
  ds_read_b64_tr_b16 v[222:223], v12 offset:37376
  ds_read_b64_tr_b16 v[224:225], v13 offset:36864
  ds_read_b64_tr_b16 v[226:227], v13 offset:37376
  ds_read_b64_tr_b16 v[228:229], v14 offset:36864
  ds_read_b64_tr_b16 v[230:231], v14 offset:37376
  s_waitcnt lgkmcnt(10)
  v_lshlrev_b32 v40, 16, v208
  v_and_b32 v41, s44, v208
  v_lshlrev_b32 v42, 16, v209
  v_and_b32 v43, s44, v209
  v_lshlrev_b32 v44, 16, v210
  v_and_b32 v45, s44, v210
  v_lshlrev_b32 v46, 16, v211
  v_and_b32 v47, s44, v211
  v_pk_mul_f32 v[40:41], v[40:41], s[46:47]
  v_pk_mul_f32 v[42:43], v[42:43], s[46:47]
  v_pk_mul_f32 v[44:45], v[44:45], s[46:47]
  v_pk_mul_f32 v[46:47], v[46:47], s[46:47]
  v_cvt_pk_bf16_f32 v208, v40, v41
  v_cvt_pk_bf16_f32 v209, v42, v43
  v_cvt_pk_bf16_f32 v210, v44, v45
L_hop0:
  s_cbranch_execz L_hopped
  s_waitcnt lgkmcnt(0)
  v_cvt_pk_bf16_f32 v211, v46, v47
  v_lshlrev_b32 v48, 16, v212
  v_and_b32 v49, s44, v212
  v_lshlrev_b32 v50, 16, v213
  v_and_b32 v51, s44, v213
  v_lshlrev_b32 v52, 16, v214
  v_and_b32 v53, s44, v214
  v_lshlrev_b32 v54, 16, v215
  v_and_b32 v55, s44, v215
  v_pk_mul_f32 v[48:49], v[48:49], s[46:47]
  v_pk_mul_f32 v[50:51], v[50:51], s[46:47]
  v_pk_mul_f32 v[52:53], v[52:53], s[46:47]
  v_pk_mul_f32 v[54:55], v[54:55], s[46:47]
  v_cvt_pk_bf16_f32 v212, v48, v49
  v_cvt_pk_bf16_f32 v213, v50, v51
  v_cvt_pk_bf16_f32 v214, v52, v53
  v_cvt_pk_bf16_f32 v215, v54, v55
  v_lshlrev_b32 v56, 16, v216
  v_and_b32 v57, s44, v216
  v_lshlrev_b32 v58, 16, v217
  v_and_b32 v59, s44, v217
  v_lshlrev_b32 v60, 16, v218
  v_and_b32 v61, s44, v218
  v_lshlrev_b32 v62, 16, v219
  v_and_b32 v63, s44, v219
  v_pk_mul_f32 v[56:57], v[56:57], s[46:47]
  v_pk_mul_f32 v[58:59], v[58:59], s[46:47]
  v_pk_mul_f32 v[60:61], v[60:61], s[46:47]
  v_pk_mul_f32 v[62:63], v[62:63], s[46:47]
  v_cvt_pk_bf16_f32 v216, v56, v57
  v_cvt_pk_bf16_f32 v217, v58, v59
  v_cvt_pk_bf16_f32 v218, v60, v61
  v_cvt_pk_bf16_f32 v219, v62, v63
  v_lshlrev_b32 v40, 16, v220
  v_and_b32 v41, s44, v220
  v_lshlrev_b32 v42, 16, v221
  v_and_b32 v43, s44, v221
  v_lshlrev_b32 v44, 16, v222
  v_and_b32 v45, s44, v222
  v_lshlrev_b32 v46, 16, v223
  v_and_b32 v47, s44, v223
  v_pk_mul_f32 v[40:41], v[40:41], s[46:47]
  v_pk_mul_f32 v[42:43], v[42:43], s[46:47]
  v_pk_mul_f32 v[44:45], v[44:45], s[46:47]
  v_pk_mul_f32 v[46:47], v[46:47], s[46:47]
  v_cvt_pk_bf16_f32 v220, v40, v41
  v_cvt_pk_bf16_f32 v221, v42, v43
  v_cvt_pk_bf16_f32 v222, v44, v45
  v_cvt_pk_bf16_f32 v223, v46, v47
  v_lshlrev_b32 v48, 16, v224
  v_and_b32 v49, s44, v224
  v_lshlrev_b32 v50, 16, v225
  v_and_b32 v51, s44, v225
  v_lshlrev_b32 v52, 16, v226
  v_and_b32 v53, s44, v226
  v_lshlrev_b32 v54, 16, v227
  v_and_b32 v55, s44, v227
  v_pk_mul_f32 v[48:49], v[48:49], s[46:47]
  v_pk_mul_f32 v[50:51], v[50:51], s[46:47]
  v_pk_mul_f32 v[52:53], v[52:53], s[46:47]
  v_pk_mul_f32 v[54:55], v[54:55], s[46:47]
  v_cvt_pk_bf16_f32 v224, v48, v49
  v_cvt_pk_bf16_f32 v225, v50, v51
  v_cvt_pk_bf16_f32 v226, v52, v53
  v_cvt_pk_bf16_f32 v227, v54, v55
  v_lshlrev_b32 v56, 16, v228
  v_and_b32 v57, s44, v228
  v_lshlrev_b32 v58, 16, v229
  v_and_b32 v59, s44, v229
  v_lshlrev_b32 v60, 16, v230
  v_and_b32 v61, s44, v230
  v_lshlrev_b32 v62, 16, v231
  v_and_b32 v63, s44, v231
  s_add_u32 m0, s63, 73728
  s_add_u32 s36, s62, 384
  buffer_load_dwordx4 v136, s[12:15], s36 offen offset:0 lds
  v_pk_mul_f32 v[56:57], v[56:57], s[46:47]
  v_pk_mul_f32 v[58:59], v[58:59], s[46:47]
  v_pk_mul_f32 v[60:61], v[60:61], s[46:47]
  v_pk_mul_f32 v[62:63], v[62:63], s[46:47]
  v_cvt_pk_bf16_f32 v228, v56, v57
  v_cvt_pk_bf16_f32 v229, v58, v59
  v_cvt_pk_bf16_f32 v230, v60, v61
  v_cvt_pk_bf16_f32 v231, v62, v63
  s_waitcnt vmcnt(8)
  s_barrier
  ds_read_b64_tr_b16 v[232:233], v12 offset:49152
  ds_read_b64_tr_b16 v[234:235], v12 offset:49664
  ds_read_b64_tr_b16 v[236:237], v13 offset:49152
  ds_read_b64_tr_b16 v[238:239], v13 offset:49664
  ds_read_b64_tr_b16 v[240:241], v14 offset:49152
  ds_read_b64_tr_b16 v[242:243], v14 offset:49664
  ds_read_b64_tr_b16 v[244:245], v12 offset:61440
  ds_read_b64_tr_b16 v[246:247], v12 offset:61952
  ds_read_b64_tr_b16 v[248:249], v13 offset:61440
  ds_read_b64_tr_b16 v[250:251], v13 offset:61952
  buffer_load_dwordx4 v137, s[12:15], s36 offen offset:1024 lds
  ds_read_b64_tr_b16 v[252:253], v14 offset:61440
  ds_read_b64_tr_b16 v[254:255], v14 offset:61952
  s_waitcnt lgkmcnt(10)
  v_lshlrev_b32 v40, 16, v232
  v_and_b32 v41, s44, v232
  v_lshlrev_b32 v42, 16, v233
  v_and_b32 v43, s44, v233
  v_lshlrev_b32 v44, 16, v234
  v_and_b32 v45, s44, v234
  v_lshlrev_b32 v46, 16, v235
  v_and_b32 v47, s44, v235
  v_pk_mul_f32 v[40:41], v[40:41], s[46:47]
  v_pk_mul_f32 v[42:43], v[42:43], s[46:47]
  v_pk_mul_f32 v[44:45], v[44:45], s[46:47]
  v_pk_mul_f32 v[46:47], v[46:47], s[46:47]
  v_cvt_pk_bf16_f32 v232, v40, v41
  v_cvt_pk_bf16_f32 v233, v42, v43
  v_cvt_pk_bf16_f32 v234, v44, v45
  s_waitcnt lgkmcnt(0)
  v_cvt_pk_bf16_f32 v235, v46, v47
  buffer_load_dwordx4 v138, s[12:15], s36 offen offset:2048 lds
  v_lshlrev_b32 v48, 16, v236
  v_and_b32 v49, s44, v236
  v_lshlrev_b32 v50, 16, v237
  v_and_b32 v51, s44, v237
  v_lshlrev_b32 v52, 16, v238
  v_and_b32 v53, s44, v238
  v_lshlrev_b32 v54, 16, v239
  v_and_b32 v55, s44, v239
  v_pk_mul_f32 v[48:49], v[48:49], s[46:47]
  v_pk_mul_f32 v[50:51], v[50:51], s[46:47]
  v_pk_mul_f32 v[52:53], v[52:53], s[46:47]
  v_pk_mul_f32 v[54:55], v[54:55], s[46:47]
  v_cvt_pk_bf16_f32 v236, v48, v49
  v_cvt_pk_bf16_f32 v237, v50, v51
  v_cvt_pk_bf16_f32 v238, v52, v53
  v_cvt_pk_bf16_f32 v239, v54, v55
  v_lshlrev_b32 v56, 16, v240
  v_and_b32 v57, s44, v240
  v_lshlrev_b32 v58, 16, v241
  v_and_b32 v59, s44, v241
  s_add_u32 m0, s63, 86016
  s_add_u32 s36, s62, 37248
  buffer_load_dwordx4 v136, s[12:15], s36 offen offset:0 lds
  v_lshlrev_b32 v60, 16, v242
  v_and_b32 v61, s44, v242
  v_lshlrev_b32 v62, 16, v243
  v_and_b32 v63, s44, v243
  v_pk_mul_f32 v[56:57], v[56:57], s[46:47]
  v_pk_mul_f32 v[58:59], v[58:59], s[46:47]
  v_pk_mul_f32 v[60:61], v[60:61], s[46:47]
  v_pk_mul_f32 v[62:63], v[62:63], s[46:47]
  v_cvt_pk_bf16_f32 v240, v56, v57
  v_cvt_pk_bf16_f32 v241, v58, v59
  v_cvt_pk_bf16_f32 v242, v60, v61
  v_cvt_pk_bf16_f32 v243, v62, v63
  v_lshlrev_b32 v40, 16, v244
  v_and_b32 v41, s44, v244
  v_lshlrev_b32 v42, 16, v245
  v_and_b32 v43, s44, v245
  v_lshlrev_b32 v44, 16, v246
  v_and_b32 v45, s44, v246
  v_lshlrev_b32 v46, 16, v247
  v_and_b32 v47, s44, v247
  buffer_load_dwordx4 v137, s[12:15], s36 offen offset:1024 lds
  v_pk_mul_f32 v[40:41], v[40:41], s[46:47]
  v_pk_mul_f32 v[42:43], v[42:43], s[46:47]
  v_pk_mul_f32 v[44:45], v[44:45], s[46:47]
  v_pk_mul_f32 v[46:47], v[46:47], s[46:47]
  v_cvt_pk_bf16_f32 v244, v40, v41
  v_cvt_pk_bf16_f32 v245, v42, v43
  v_cvt_pk_bf16_f32 v246, v44, v45
  v_cvt_pk_bf16_f32 v247, v46, v47
  v_lshlrev_b32 v48, 16, v248
  v_and_b32 v49, s44, v248
  v_lshlrev_b32 v50, 16, v249
  v_and_b32 v51, s44, v249
  v_lshlrev_b32 v52, 16, v250
  v_and_b32 v53, s44, v250
  v_lshlrev_b32 v54, 16, v251
  v_and_b32 v55, s44, v251
  v_pk_mul_f32 v[48:49], v[48:49], s[46:47]
  v_pk_mul_f32 v[50:51], v[50:51], s[46:47]
  v_pk_mul_f32 v[52:53], v[52:53], s[46:47]
  v_pk_mul_f32 v[54:55], v[54:55], s[46:47]
  buffer_load_dwordx4 v138, s[12:15], s36 offen offset:2048 lds
  v_cvt_pk_bf16_f32 v248, v48, v49
  v_cvt_pk_bf16_f32 v249, v50, v51
  v_cvt_pk_bf16_f32 v250, v52, v53
  v_cvt_pk_bf16_f32 v251, v54, v55
  v_lshlrev_b32 v56, 16, v252
  v_and_b32 v57, s44, v252
  v_lshlrev_b32 v58, 16, v253
  v_and_b32 v59, s44, v253
  v_lshlrev_b32 v60, 16, v254
  v_and_b32 v61, s44, v254
  v_lshlrev_b32 v62, 16, v255
  v_and_b32 v63, s44, v255
  v_pk_mul_f32 v[56:57], v[56:57], s[46:47]
  v_pk_mul_f32 v[58:59], v[58:59], s[46:47]
  v_pk_mul_f32 v[60:61], v[60:61], s[46:47]
  v_pk_mul_f32 v[62:63], v[62:63], s[46:47]
  v_cvt_pk_bf16_f32 v252, v56, v57
  v_cvt_pk_bf16_f32 v253, v58, v59
  v_cvt_pk_bf16_f32 v254, v60, v61
  v_cvt_pk_bf16_f32 v255, v62, v63
  s_lshl3_add_u32 s48, s29, s4
  s_add_u32 s48, s48, 4
  s_mul_i32 s48, s48, 196608
  s_add_u32 s49, s48, 786432
  s_add_u32 s50, s48, 100663296
  s_mov_b32 s10, 95158272
  s_waitcnt vmcnt(10)
  s_barrier
  ds_read_b128 a[144:147], v0 offset:0
  ds_read_b128 a[148:151], v1 offset:0
  ds_read_b128 a[152:155], v0 offset:8192
  ds_read_b128 a[156:159], v1 offset:8192
  ds_read_b128 a[160:163], v0 offset:16384
  ds_read_b128 a[164:167], v1 offset:16384
  s_waitcnt lgkmcnt(4)
  v_mfma_f32_16x16x32_bf16 v[164:167], v[184:187], a[144:147], 0
  v_mfma_f32_16x16x32_bf16 v[164:167], v[196:199], a[148:151], v[164:167]
  s_waitcnt lgkmcnt(0)
  v_mfma_f32_16x16x32_bf16 v[164:167], v[208:211], a[152:155], v[164:167]
  s_add_u32 m0, s63, 98304
  s_add_u32 s36, s62, 74112
  v_mfma_f32_16x16x32_bf16 v[164:167], v[220:223], a[156:159], v[164:167]
  buffer_load_dwordx4 v136, s[12:15], s36 offen offset:0 lds
  v_mfma_f32_16x16x32_bf16 v[164:167], v[232:235], a[160:163], v[164:167]
  v_fma_f32 v88, v88, s45, v150
  v_fma_f32 v89, v89, s45, v150
  v_mfma_f32_16x16x32_bf16 v[164:167], v[244:247], a[164:167], v[164:167]
  ds_read_b128 a[168:171], v0 offset:2048
  ds_read_b128 a[172:175], v1 offset:2048
  v_mfma_f32_16x16x32_bf16 v[172:175], v[248:251], a[164:167], 0
  ds_read_b128 a[176:179], v0 offset:10240
  ds_read_b128 a[180:183], v1 offset:10240
  v_mfma_f32_16x16x32_bf16 v[172:175], v[236:239], a[160:163], v[172:175]
  ds_read_b128 a[184:187], v0 offset:18432
  ds_read_b128 a[188:191], v1 offset:18432
  v_mfma_f32_16x16x32_bf16 v[172:175], v[224:227], a[156:159], v[172:175]
  v_cvt_pk_bf16_f32 v40, v164, v165
  v_cvt_pk_bf16_f32 v41, v166, v167
  v_mfma_f32_16x16x32_bf16 v[172:175], v[212:215], a[152:155], v[172:175]
  buffer_load_dwordx4 v137, s[12:15], s36 offen offset:1024 lds
  v_mfma_f32_16x16x32_bf16 v[172:175], v[200:203], a[148:151], v[172:175]
  buffer_load_dwordx4 v138, s[12:15], s36 offen offset:2048 lds
  v_mfma_f32_16x16x32_bf16 v[172:175], v[188:191], a[144:147], v[172:175]
  v_fma_f32 v90, v90, s45, v150
  v_fma_f32 v91, v91, s45, v150
  v_mfma_f32_16x16x32_bf16 v[164:167], v[192:195], a[144:147], 0
  s_add_u32 m0, s63, 110592
  s_add_u32 s36, s62, 110976
  v_mfma_f32_16x16x32_bf16 v[164:167], v[204:207], a[148:151], v[164:167]
  buffer_load_dwordx4 v136, s[12:15], s36 offen offset:0 lds
  v_mfma_f32_16x16x32_bf16 v[164:167], v[216:219], a[152:155], v[164:167]
  v_cvt_pk_bf16_f32 v42, v172, v173
  v_cvt_pk_bf16_f32 v43, v174, v175
  v_mfma_f32_16x16x32_bf16 v[164:167], v[228:231], a[156:159], v[164:167]
  v_fma_f32 v92, v92, s45, v150
  v_fma_f32 v93, v93, s45, v150
  v_mfma_f32_16x16x32_bf16 v[164:167], v[240:243], a[160:163], v[164:167]
  v_fma_f32 v94, v94, s45, v150
  v_fma_f32 v95, v95, s45, v150
  v_mfma_f32_16x16x32_bf16 v[164:167], v[252:255], a[164:167], v[164:167]
  s_waitcnt lgkmcnt(0)
  v_fma_f32 v96, v96, s45, v150
  v_mfma_f32_16x16x32_bf16 v[172:175], v[184:187], a[168:171], 0
  buffer_load_dwordx4 v137, s[12:15], s36 offen offset:1024 lds
  v_mfma_f32_16x16x32_bf16 v[172:175], v[196:199], a[172:175], v[172:175]
  s_waitcnt vmcnt(12)
  s_barrier
  v_mfma_f32_16x16x32_bf16 v[172:175], v[208:211], a[176:179], v[172:175]
  v_cvt_pk_bf16_f32 v44, v164, v165
  v_cvt_pk_bf16_f32 v45, v166, v167
  v_mfma_f32_16x16x32_bf16 v[172:175], v[220:223], a[180:183], v[172:175]
  ds_read_b128 a[192:195], v0 offset:4096
  ds_read_b128 a[196:199], v1 offset:4096
  v_mfma_f32_16x16x32_bf16 v[172:175], v[232:235], a[184:187], v[172:175]
  ds_read_b128 a[200:203], v0 offset:12288
  ds_read_b128 a[204:207], v1 offset:12288
  v_mfma_f32_16x16x32_bf16 v[172:175], v[244:247], a[188:191], v[172:175]
  ds_read_b128 a[208:211], v0 offset:20480
  ds_read_b128 a[212:215], v1 offset:20480
  v_mfma_f32_16x16x32_bf16 v[164:167], v[248:251], a[188:191], 0
  buffer_load_dwordx4 v138, s[12:15], s36 offen offset:2048 lds
  v_mfma_f32_16x16x32_bf16 v[164:167], v[236:239], a[184:187], v[164:167]
  s_add_u32 m0, s63, 0
  s_add_u32 s36, s62, 147840
  v_mfma_f32_16x16x32_bf16 v[164:167], v[224:227], a[180:183], v[164:167]
  v_cvt_pk_bf16_f32 v52, v172, v173
  v_cvt_pk_bf16_f32 v53, v174, v175
  v_mfma_f32_16x16x32_bf16 v[164:167], v[212:215], a[176:179], v[164:167]
  buffer_load_dwordx4 v136, s[12:15], s36 offen offset:0 lds
  v_mfma_f32_16x16x32_bf16 v[164:167], v[200:203], a[172:175], v[164:167]
  v_fma_f32 v97, v97, s45, v150
  v_fma_f32 v98, v98, s45, v150
  v_mfma_f32_16x16x32_bf16 v[164:167], v[188:191], a[168:171], v[164:167]
  v_fma_f32 v99, v99, s45, v150
  v_fma_f32 v100, v100, s45, v150
  v_mfma_f32_16x16x32_bf16 v[172:175], v[192:195], a[168:171], 0
  buffer_load_dwordx4 v137, s[12:15], s36 offen offset:1024 lds
  v_mfma_f32_16x16x32_bf16 v[172:175], v[204:207], a[172:175], v[172:175]
  v_fma_f32 v101, v101, s45, v150
  v_fma_f32 v102, v102, s45, v150
  v_mfma_f32_16x16x32_bf16 v[172:175], v[216:219], a[176:179], v[172:175]
  v_cvt_pk_bf16_f32 v54, v164, v165
  v_cvt_pk_bf16_f32 v55, v166, v167
  v_mfma_f32_16x16x32_bf16 v[172:175], v[228:231], a[180:183], v[172:175]
  v_fma_f32 v103, v103, s45, v150
  v_fma_f32 v104, v104, s45, v150
  v_mfma_f32_16x16x32_bf16 v[172:175], v[240:243], a[184:187], v[172:175]
  buffer_load_dwordx4 v138, s[12:15], s36 offen offset:2048 lds
  v_mfma_f32_16x16x32_bf16 v[172:175], v[252:255], a[188:191], v[172:175]
  s_waitcnt lgkmcnt(0)
  v_fma_f32 v105, v105, s45, v150
  v_mfma_f32_16x16x32_bf16 v[164:167], v[184:187], a[192:195], 0
  v_fma_f32 v106, v106, s45, v150
  v_fma_f32 v107, v107, s45, v150
  v_mfma_f32_16x16x32_bf16 v[164:167], v[196:199], a[196:199], v[164:167]
  v_fma_f32 v108, v108, s45, v150
  v_fma_f32 v109, v109, s45, v150
  v_mfma_f32_16x16x32_bf16 v[164:167], v[208:211], a[200:203], v[164:167]
  v_cvt_pk_bf16_f32 v56, v172, v173
  v_cvt_pk_bf16_f32 v57, v174, v175
  v_mfma_f32_16x16x32_bf16 v[164:167], v[220:223], a[204:207], v[164:167]
  ds_read_b128 a[216:219], v0 offset:6144
  ds_read_b128 a[220:223], v1 offset:6144
  v_mfma_f32_16x16x32_bf16 v[164:167], v[232:235], a[208:211], v[164:167]
  ds_read_b128 a[224:227], v0 offset:14336
  ds_read_b128 a[244:247], v1 offset:14336
  v_mfma_f32_16x16x32_bf16 v[164:167], v[244:247], a[212:215], v[164:167]
  ds_read_b128 a[248:251], v0 offset:22528
  ds_read_b128 a[252:255], v1 offset:22528
  v_mfma_f32_16x16x32_bf16 v[172:175], v[248:251], a[212:215], 0
  s_add_u32 m0, s63, 12288
  s_add_u32 s36, s62, 184704
  v_mfma_f32_16x16x32_bf16 v[172:175], v[236:239], a[208:211], v[172:175]
  buffer_load_dwordx4 v136, s[12:15], s36 offen offset:0 lds
  v_mfma_f32_16x16x32_bf16 v[172:175], v[224:227], a[204:207], v[172:175]
  v_cvt_pk_bf16_f32 v64, v164, v165
  v_cvt_pk_bf16_f32 v65, v166, v167
  v_mfma_f32_16x16x32_bf16 v[172:175], v[212:215], a[200:203], v[172:175]
  s_waitcnt vmcnt(10)
  s_barrier
  v_mfma_f32_16x16x32_bf16 v[172:175], v[200:203], a[196:199], v[172:175]
  buffer_load_dwordx4 v137, s[12:15], s36 offen offset:1024 lds
  v_mfma_f32_16x16x32_bf16 v[172:175], v[188:191], a[192:195], v[172:175]
  buffer_load_dwordx4 v138, s[12:15], s36 offen offset:2048 lds
  v_mfma_f32_16x16x32_bf16 v[164:167], v[192:195], a[192:195], 0
  ds_read_b64_tr_b16 a[0:1], v15 offset:0
  ds_read_b64_tr_b16 a[2:3], v15 offset:512
  v_mfma_f32_16x16x32_bf16 v[164:167], v[204:207], a[196:199], v[164:167]
  s_add_u32 m0, s63, 24576
  s_add_u32 s36, s62, 768
  v_mfma_f32_16x16x32_bf16 v[164:167], v[216:219], a[200:203], v[164:167]
  v_cvt_pk_bf16_f32 v66, v172, v173
  v_cvt_pk_bf16_f32 v67, v174, v175
  v_mfma_f32_16x16x32_bf16 v[164:167], v[228:231], a[204:207], v[164:167]
  buffer_load_dwordx4 v136, s[12:15], s36 offen offset:0 lds
  v_mfma_f32_16x16x32_bf16 v[164:167], v[240:243], a[208:211], v[164:167]
  ds_read_b64_tr_b16 a[4:5], v9 offset:0
  ds_read_b64_tr_b16 a[6:7], v9 offset:512
  v_mfma_f32_16x16x32_bf16 v[164:167], v[252:255], a[212:215], v[164:167]
  s_waitcnt lgkmcnt(4)
  ds_read_b64_tr_b16 a[8:9], v11 offset:0
  v_mfma_f32_16x16x32_bf16 v[172:175], v[184:187], a[216:219], 0
  ds_read_b64_tr_b16 a[10:11], v11 offset:512
  ds_read_b64_tr_b16 a[12:13], v15 offset:12288
  v_mfma_f32_16x16x32_bf16 v[172:175], v[196:199], a[220:223], v[172:175]
  buffer_load_dwordx4 v137, s[12:15], s36 offen offset:1024 lds
  v_mfma_f32_16x16x32_bf16 v[172:175], v[208:211], a[224:227], v[172:175]
  v_cvt_pk_bf16_f32 v68, v164, v165
  v_cvt_pk_bf16_f32 v69, v166, v167
  v_mfma_f32_16x16x32_bf16 v[172:175], v[220:223], a[244:247], v[172:175]
  ds_read_b64_tr_b16 a[14:15], v15 offset:12800
  ds_read_b64_tr_b16 a[16:17], v9 offset:12288
  v_mfma_f32_16x16x32_bf16 v[172:175], v[232:235], a[248:251], v[172:175]
  ds_read_b64_tr_b16 a[18:19], v9 offset:12800
  ds_read_b64_tr_b16 a[20:21], v11 offset:12288
  v_mfma_f32_16x16x32_bf16 v[172:175], v[244:247], a[252:255], v[172:175]
  buffer_load_dwordx4 v138, s[12:15], s36 offen offset:2048 lds
  v_mfma_f32_16x16x32_bf16 v[164:167], v[248:251], a[252:255], 0
  ds_read_b64_tr_b16 a[22:23], v11 offset:12800
  v_fma_f32 v110, v110, s45, v150
  v_mfma_f32_16x16x32_bf16 v[164:167], v[236:239], a[248:251], v[164:167]
  v_fma_f32 v111, v111, s45, v150
  v_fma_f32 v112, v112, s45, v150
  v_mfma_f32_16x16x32_bf16 v[164:167], v[224:227], a[244:247], v[164:167]
  v_cvt_pk_bf16_f32 v70, v172, v173
  v_cvt_pk_bf16_f32 v71, v174, v175
  v_mfma_f32_16x16x32_bf16 v[164:167], v[212:215], a[224:227], v[164:167]
  s_add_u32 m0, s63, 36864
  s_add_u32 s36, s62, 37632
  v_mfma_f32_16x16x32_bf16 v[164:167], v[200:203], a[220:223], v[164:167]
  buffer_load_dwordx4 v136, s[12:15], s36 offen offset:0 lds
  v_mfma_f32_16x16x32_bf16 v[164:167], v[188:191], a[216:219], v[164:167]
  v_fma_f32 v113, v113, s45, v150
  v_fma_f32 v114, v114, s45, v150
  v_mfma_f32_16x16x32_bf16 v[172:175], v[192:195], a[216:219], 0
  v_fma_f32 v115, v115, s45, v150
  v_add_f32 v156, v151, v112
  v_mfma_f32_16x16x32_bf16 v[172:175], v[204:207], a[220:223], v[172:175]
  v_add_f32 v157, v151, v113
  v_add_f32 v158, v151, v114
  v_mfma_f32_16x16x32_bf16 v[172:175], v[216:219], a[224:227], v[172:175]
  v_cvt_pk_bf16_f32 v72, v164, v165
  v_cvt_pk_bf16_f32 v73, v166, v167
  v_mfma_f32_16x16x32_bf16 v[172:175], v[228:231], a[244:247], v[172:175]
  buffer_load_dwordx4 v137, s[12:15], s36 offen offset:1024 lds
  v_mfma_f32_16x16x32_bf16 v[172:175], v[240:243], a[248:251], v[172:175]
  s_waitcnt lgkmcnt(0)
  s_waitcnt vmcnt(11)
  s_barrier
  v_mfma_f32_16x16x32_bf16 v[172:175], v[252:255], a[252:255], v[172:175]
  ds_read_b64_tr_b16 a[24:25], v15 offset:24576
  v_mfma_f32_16x16x32_bf16 v[116:119], a[0:3], a[144:147], 0
  buffer_load_dwordx4 v138, s[12:15], s36 offen offset:2048 lds
  v_mfma_f32_16x16x32_bf16 v[116:119], a[12:15], a[148:151], v[116:119]
  ds_read_b64_tr_b16 a[26:27], v15 offset:25088
  ds_read_b64_tr_b16 a[28:29], v9 offset:24576
  v_mfma_f32_16x16x32_bf16 v[124:127], a[16:19], a[148:151], 0
  v_cvt_pk_bf16_f32 v74, v172, v173
  v_cvt_pk_bf16_f32 v75, v174, v175
  v_mfma_f32_16x16x32_bf16 v[124:127], a[4:7], a[144:147], v[124:127]
  s_add_u32 m0, s63, 49152
  s_add_u32 s36, s62, 74496
  v_mfma_f32_16x16x32_bf16 v[120:123], a[8:11], a[144:147], 0
  buffer_load_dwordx4 v136, s[12:15], s36 offen offset:0 lds
  v_mfma_f32_16x16x32_bf16 v[120:123], a[20:23], a[148:151], v[120:123]
  ds_read_b64_tr_b16 a[30:31], v9 offset:25088
  ds_read_b64_tr_b16 a[32:33], v11 offset:24576
  v_mfma_f32_16x16x32_bf16 v[128:131], a[0:3], a[168:171], 0
  ds_read_b64_tr_b16 a[34:35], v11 offset:25088
  ds_read_b64_tr_b16 a[36:37], v15 offset:36864
  v_mfma_f32_16x16x32_bf16 v[128:131], a[12:15], a[172:175], v[128:131]
  ds_read_b64_tr_b16 a[38:39], v15 offset:37376
  ds_read_b64_tr_b16 a[40:41], v9 offset:36864
  v_mfma_f32_16x16x32_bf16 v[132:135], a[16:19], a[172:175], 0
  buffer_load_dwordx4 v137, s[12:15], s36 offen offset:1024 lds
  v_mfma_f32_16x16x32_bf16 v[132:135], a[4:7], a[168:171], v[132:135]
  ds_read_b64_tr_b16 a[42:43], v9 offset:37376
  ds_read_b64_tr_b16 a[44:45], v11 offset:36864
  v_mfma_f32_16x16x32_bf16 v[140:143], a[8:11], a[168:171], 0
  ds_read_b64_tr_b16 a[46:47], v11 offset:37376
  v_add_f32 v159, v151, v115
  v_mfma_f32_16x16x32_bf16 v[140:143], a[20:23], a[172:175], v[140:143]
  v_add_f32 v160, v151, v108
  v_add_f32 v161, v151, v109
  v_mfma_f32_16x16x32_bf16 v[16:19], a[0:3], a[192:195], 0
  v_add_f32 v162, v151, v110
  v_add_f32 v163, v151, v111
  v_mfma_f32_16x16x32_bf16 v[16:19], a[12:15], a[196:199], v[16:19]
  buffer_load_dwordx4 v138, s[12:15], s36 offen offset:2048 lds
  v_mfma_f32_16x16x32_bf16 v[20:23], a[16:19], a[196:199], 0
  v_add_f32 v180, v151, v104
  v_add_f32 v181, v151, v105
  v_mfma_f32_16x16x32_bf16 v[20:23], a[4:7], a[192:195], v[20:23]
  v_add_f32 v182, v151, v106
  v_add_f32 v183, v151, v107
  v_mfma_f32_16x16x32_bf16 v[24:27], a[8:11], a[192:195], 0
  s_add_u32 m0, s63, 61440
  s_add_u32 s36, s62, 111360
  v_mfma_f32_16x16x32_bf16 v[24:27], a[20:23], a[196:199], v[24:27]
  buffer_load_dwordx4 v136, s[12:15], s36 offen offset:0 lds
  v_mfma_f32_16x16x32_bf16 v[28:31], a[0:3], a[216:219], 0
  v_add_f32 v152, v151, v96
  v_add_f32 v153, v151, v97
  v_mfma_f32_16x16x32_bf16 v[28:31], a[12:15], a[220:223], v[28:31]
  v_add_f32 v154, v151, v98
  v_add_f32 v155, v151, v99
  v_mfma_f32_16x16x32_bf16 v[32:35], a[16:19], a[220:223], 0
  v_add_f32 v168, v151, v92
  v_add_f32 v169, v151, v93
  v_mfma_f32_16x16x32_bf16 v[32:35], a[4:7], a[216:219], v[32:35]
  buffer_load_dwordx4 v137, s[12:15], s36 offen offset:1024 lds
  v_mfma_f32_16x16x32_bf16 v[36:39], a[8:11], a[216:219], 0
  v_add_f32 v170, v151, v94
  v_add_f32 v171, v151, v95
  v_mfma_f32_16x16x32_bf16 v[36:39], a[20:23], a[220:223], v[36:39]
  s_waitcnt lgkmcnt(0)
  v_add_f32 v176, v151, v88
  v_mfma_f32_16x16x32_bf16 v[116:119], a[24:27], a[152:155], v[116:119]
  s_waitcnt vmcnt(11)
  s_barrier
  v_mfma_f32_16x16x32_bf16 v[116:119], a[36:39], a[156:159], v[116:119]
  buffer_load_dwordx4 v138, s[12:15], s36 offen offset:2048 lds
  v_mfma_f32_16x16x32_bf16 v[124:127], a[40:43], a[156:159], v[124:127]
  ds_read_b64_tr_b16 a[48:49], v12 offset:0
  ds_read_b64_tr_b16 a[50:51], v12 offset:512
  v_mfma_f32_16x16x32_bf16 v[124:127], a[28:31], a[152:155], v[124:127]
  ds_read_b64_tr_b16 a[52:53], v13 offset:0
  ds_read_b64_tr_b16 a[54:55], v13 offset:512
  v_mfma_f32_16x16x32_bf16 v[120:123], a[32:35], a[152:155], v[120:123]
  s_add_u32 m0, s63, 73728
  s_add_u32 s36, s62, 148224
  v_mfma_f32_16x16x32_bf16 v[120:123], a[44:47], a[156:159], v[120:123]
  buffer_load_dwordx4 v136, s[12:15], s36 offen offset:0 lds
  v_mfma_f32_16x16x32_bf16 v[128:131], a[24:27], a[176:179], v[128:131]
  ds_read_b64_tr_b16 a[56:57], v14 offset:0
  ds_read_b64_tr_b16 a[58:59], v14 offset:512
  v_mfma_f32_16x16x32_bf16 v[128:131], a[36:39], a[180:183], v[128:131]
  ds_read_b64_tr_b16 a[60:61], v12 offset:12288
  ds_read_b64_tr_b16 a[62:63], v12 offset:12800
  v_mfma_f32_16x16x32_bf16 v[132:135], a[40:43], a[180:183], v[132:135]
  ds_read_b64_tr_b16 a[64:65], v13 offset:12288
  ds_read_b64_tr_b16 a[66:67], v13 offset:12800
  v_mfma_f32_16x16x32_bf16 v[132:135], a[28:31], a[176:179], v[132:135]
  ds_read_b64_tr_b16 a[68:69], v14 offset:12288
  ds_read_b64_tr_b16 a[70:71], v14 offset:12800
  v_mfma_f32_16x16x32_bf16 v[140:143], a[32:35], a[176:179], v[140:143]
  buffer_load_dwordx4 v137, s[12:15], s36 offen offset:1024 lds
  v_mfma_f32_16x16x32_bf16 v[140:143], a[44:47], a[180:183], v[140:143]
  v_add_f32 v177, v151, v89
  v_add_f32 v178, v151, v90
  v_mfma_f32_16x16x32_bf16 v[16:19], a[24:27], a[200:203], v[16:19]
  v_add_f32 v179, v151, v91
  s_and_b32 s38, s28, -2
  v_mfma_f32_16x16x32_bf16 v[16:19], a[36:39], a[204:207], v[16:19]
  s_min_u32 s38, s38, 60
  s_lshl_b32 s37, s38, 1
  v_mfma_f32_16x16x32_bf16 v[20:23], a[40:43], a[204:207], v[20:23]
  buffer_load_dwordx4 v138, s[12:15], s36 offen offset:2048 lds
  v_mfma_f32_16x16x32_bf16 v[20:23], a[28:31], a[200:203], v[20:23]
  s_mov_b32 s22, 4
  s_add_u32 s46, s4, 68
  v_mfma_f32_16x16x32_bf16 v[24:27], a[32:35], a[200:203], v[24:27]
  s_mul_i32 s46, s46, 196608
  s_mov_b32 s47, 24576
  v_mfma_f32_16x16x32_bf16 v[24:27], a[44:47], a[204:207], v[24:27]
  s_add_u32 m0, s63, 86016
  s_add_u32 s36, s62, 185088
  v_mfma_f32_16x16x32_bf16 v[28:31], a[24:27], a[224:227], v[28:31]
  buffer_load_dwordx4 v136, s[12:15], s36 offen offset:0 lds
  v_mfma_f32_16x16x32_bf16 v[28:31], a[36:39], a[244:247], v[28:31]
  v_mfma_f32_16x16x32_bf16 v[32:35], a[40:43], a[244:247], v[32:35]
  s_waitcnt lgkmcnt(0)
  s_waitcnt vmcnt(10)
  s_barrier
  v_mfma_f32_16x16x32_bf16 v[32:35], a[28:31], a[224:227], v[32:35]
  ds_read_b64_tr_b16 a[72:73], v12 offset:24576
  ds_read_b64_tr_b16 a[74:75], v12 offset:25088
  v_mfma_f32_16x16x32_bf16 v[36:39], a[32:35], a[224:227], v[36:39]
  buffer_load_dwordx4 v137, s[12:15], s36 offen offset:1024 lds
  v_mfma_f32_16x16x32_bf16 v[36:39], a[44:47], a[244:247], v[36:39]
  ds_read_b64_tr_b16 a[76:77], v13 offset:24576
  v_mfma_f32_16x16x32_bf16 v[116:119], a[48:51], a[160:163], v[116:119]
  ds_read_b64_tr_b16 a[78:79], v13 offset:25088
  ds_read_b64_tr_b16 a[80:81], v14 offset:24576
  v_mfma_f32_16x16x32_bf16 v[116:119], a[60:63], a[164:167], v[116:119]
  ds_read_b64_tr_b16 a[82:83], v14 offset:25088
  ds_read_b64_tr_b16 a[84:85], v12 offset:36864
  v_mfma_f32_16x16x32_bf16 v[124:127], a[64:67], a[164:167], v[124:127]
  buffer_load_dwordx4 v138, s[12:15], s36 offen offset:2048 lds
  v_mfma_f32_16x16x32_bf16 v[124:127], a[52:55], a[160:163], v[124:127]
  ds_read_b64_tr_b16 a[86:87], v12 offset:37376
  ds_read_b64_tr_b16 a[88:89], v13 offset:36864
  v_mfma_f32_16x16x32_bf16 v[120:123], a[56:59], a[160:163], v[120:123]
  v_cvt_pk_bf16_f32 v46, v116, v117
  v_cvt_pk_bf16_f32 v47, v118, v119
  v_mfma_f32_16x16x32_bf16 v[120:123], a[68:71], a[164:167], v[120:123]
  s_add_u32 m0, s32, 40960
  ds_read_b64_tr_b16 a[90:91], v13 offset:37376
  v_mfma_f32_16x16x32_bf16 v[128:131], a[48:51], a[184:187], v[128:131]
  v_cvt_pk_bf16_f32 v48, v124, v125
  v_cvt_pk_bf16_f32 v49, v126, v127
  v_mfma_f32_16x16x32_bf16 v[128:131], a[60:63], a[188:191], v[128:131]
  buffer_load_dwordx4 v6, s[8:11], s48 offen offset:0 nt lds
  v_mfma_f32_16x16x32_bf16 v[132:135], a[64:67], a[188:191], v[132:135]
  v_cvt_pk_bf16_f32 v50, v120, v121
  v_cvt_pk_bf16_f32 v51, v122, v123
  v_mfma_f32_16x16x32_bf16 v[132:135], a[52:55], a[184:187], v[132:135]
  s_add_u32 m0, s32, 49024
  ds_read_b64_tr_b16 a[92:93], v14 offset:36864
  v_mfma_f32_16x16x32_bf16 v[140:143], a[56:59], a[184:187], v[140:143]
  v_cvt_pk_bf16_f32 v58, v128, v129
  v_cvt_pk_bf16_f32 v59, v130, v131
  v_mfma_f32_16x16x32_bf16 v[140:143], a[68:71], a[188:191], v[140:143]
  buffer_load_dwordx4 v6, s[8:11], s48 offen offset:128 nt lds
  v_mfma_f32_16x16x32_bf16 v[16:19], a[48:51], a[208:211], v[16:19]
  v_cvt_pk_bf16_f32 v60, v132, v133
  v_cvt_pk_bf16_f32 v61, v134, v135
  v_mfma_f32_16x16x32_bf16 v[16:19], a[60:63], a[212:215], v[16:19]
  s_add_u32 m0, s32, 57088
  ds_read_b64_tr_b16 a[94:95], v14 offset:37376
L_hop1:
  s_cbranch_execz L_hopped
  v_mfma_f32_16x16x32_bf16 v[20:23], a[64:67], a[212:215], v[20:23]
  v_cvt_pk_bf16_f32 v62, v140, v141
  v_cvt_pk_bf16_f32 v63, v142, v143
  v_mfma_f32_16x16x32_bf16 v[20:23], a[52:55], a[208:211], v[20:23]
  buffer_load_dwordx4 v6, s[8:11], s48 offen offset:256 nt lds
  v_mfma_f32_16x16x32_bf16 v[24:27], a[56:59], a[208:211], v[24:27]
  v_cvt_pk_bf16_f32 v76, v16, v17
  v_cvt_pk_bf16_f32 v77, v18, v19
  v_mfma_f32_16x16x32_bf16 v[24:27], a[68:71], a[212:215], v[24:27]
  s_add_u32 m0, s32, 45056
  v_mfma_f32_16x16x32_bf16 v[28:31], a[48:51], a[248:251], v[28:31]
  v_cvt_pk_bf16_f32 v78, v20, v21
  v_cvt_pk_bf16_f32 v79, v22, v23
  v_mfma_f32_16x16x32_bf16 v[28:31], a[60:63], a[252:255], v[28:31]
  s_waitcnt lgkmcnt(0)
  s_waitcnt vmcnt(9)
  s_barrier
  v_mfma_f32_16x16x32_bf16 v[32:35], a[64:67], a[252:255], v[32:35]
  v_cvt_pk_bf16_f32 v80, v24, v25
  v_cvt_pk_bf16_f32 v81, v26, v27
  v_mfma_f32_16x16x32_bf16 v[32:35], a[52:55], a[248:251], v[32:35]
  buffer_load_dwordx4 v6, s[8:11], s49 offen offset:0 nt lds
  v_mfma_f32_16x16x32_bf16 v[36:39], a[56:59], a[248:251], v[36:39]
  v_cvt_pk_bf16_f32 v82, v28, v29
  v_cvt_pk_bf16_f32 v83, v30, v31
  v_mfma_f32_16x16x32_bf16 v[36:39], a[68:71], a[252:255], v[36:39]
  s_add_u32 m0, s32, 53120
  ds_read_b64_tr_b16 a[96:97], v12 offset:49152
  v_mfma_f32_16x16x32_bf16 v[116:119], v[46:49], v[70:73], v[156:159]
  v_cvt_pk_bf16_f32 v84, v32, v33
  v_cvt_pk_bf16_f32 v85, v34, v35
  v_mfma_f32_16x16x32_bf16 v[124:127], v[58:61], v[70:73], v[160:163]
  buffer_load_dwordx4 v6, s[8:11], s49 offen offset:128 nt lds
  v_mfma_f32_16x16x32_bf16 v[120:123], v[76:79], v[70:73], v[104:107]
  v_cvt_pk_bf16_f32 v86, v36, v37
  v_cvt_pk_bf16_f32 v87, v38, v39
  v_mfma_f32_16x16x32_bf16 v[128:131], v[82:85], v[70:73], v[100:103]
  s_add_u32 m0, s32, 61184
  ds_read_b64_tr_b16 a[98:99], v12 offset:49664
  v_mfma_f32_16x16x16_bf16 v[116:119], v[50:51], v[74:75], v[116:119]
  s_cmp_lg_u32 s31, 0
  s_cbranch_scc1 L_special0
  v_mfma_f32_16x16x16_bf16 v[124:127], v[62:63], v[74:75], v[124:127]
  buffer_load_dwordx4 v6, s[8:11], s49 offen offset:256 nt lds
  v_mfma_f32_16x16x16_bf16 v[120:123], v[80:81], v[74:75], v[120:123]
  s_add_u32 s48, s48, 6291456
  s_add_u32 s49, s48, 786432
  v_mfma_f32_16x16x16_bf16 v[128:131], v[86:87], v[74:75], v[128:131]
  s_add_u32 m0, s32, 65536
  ds_read_b64_tr_b16 a[100:101], v13 offset:49152
  v_mfma_f32_16x16x16_bf16 v[132:135], v[50:51], v[68:69], v[160:163]
  buffer_load_dwordx4 v6, s[8:11], s48 offen offset:0 nt lds
  v_mfma_f32_16x16x16_bf16 v[140:143], v[62:63], v[68:69], v[180:183]
  ds_read_b64_tr_b16 a[102:103], v13 offset:49664
  ds_read_b64_tr_b16 a[104:105], v14 offset:49152
  v_mfma_f32_16x16x16_bf16 v[136:139], v[80:81], v[68:69], v[100:103]
  ds_read_b64_tr_b16 a[106:107], v14 offset:49664
  ds_read_b64_tr_b16 a[108:109], v12 offset:61440
  v_mfma_f32_16x16x16_bf16 v[144:147], v[86:87], v[68:69], v[96:99]
  s_add_u32 m0, s32, 73600
  ds_read_b64_tr_b16 a[110:111], v12 offset:61952
  v_mfma_f32_16x16x16_bf16 v[148:151], v[50:51], v[56:57], v[104:107]
  buffer_load_dwordx4 v6, s[8:11], s48 offen offset:128 nt lds
  v_mfma_f32_16x16x16_bf16 v[156:159], v[62:63], v[56:57], v[100:103]
  ds_read_b64_tr_b16 a[112:113], v13 offset:61440
  ds_read_b64_tr_b16 a[114:115], v13 offset:61952
  v_mfma_f32_16x16x16_bf16 v[152:155], v[80:81], v[56:57], v[152:155]
  ds_read_b64_tr_b16 a[116:117], v14 offset:61440
  ds_read_b64_tr_b16 a[118:119], v14 offset:61952
  v_mfma_f32_16x16x16_bf16 v[160:163], v[86:87], v[56:57], v[168:171]
  s_add_u32 m0, s32, 81664
  v_mfma_f32_16x16x16_bf16 v[164:167], v[50:51], v[44:45], v[100:103]
  buffer_load_dwordx4 v6, s[8:11], s48 offen offset:256 nt lds
  v_mfma_f32_16x16x16_bf16 v[172:175], v[62:63], v[44:45], v[96:99]
  v_exp_f32 v116, v116
  v_mfma_f32_16x16x16_bf16 v[168:171], v[80:81], v[44:45], v[168:171]
  v_exp_f32 v117, v117
  v_mfma_f32_16x16x16_bf16 v[176:179], v[86:87], v[44:45], v[176:179]
  v_exp_f32 v118, v118
  v_mfma_f32_16x16x32_bf16 v[132:135], v[46:49], v[64:67], v[132:135]
  s_waitcnt lgkmcnt(0)
  s_waitcnt vmcnt(9)
  s_barrier
  v_mfma_f32_16x16x32_bf16 v[140:143], v[58:61], v[64:67], v[140:143]
  ds_read_b64_tr_b16 a[120:121], v15 offset:0
  ds_read_b64_tr_b16 a[122:123], v15 offset:512
  v_mfma_f32_16x16x32_bf16 v[136:139], v[76:79], v[64:67], v[136:139]
  ds_read_b64_tr_b16 a[124:125], v9 offset:0
  ds_read_b64_tr_b16 a[126:127], v9 offset:512
  v_mfma_f32_16x16x32_bf16 v[144:147], v[82:85], v[64:67], v[144:147]
  ds_read_b64_tr_b16 a[128:129], v11 offset:0
  ds_read_b64_tr_b16 a[130:131], v11 offset:512
  v_mfma_f32_16x16x32_bf16 v[148:151], v[46:49], v[52:55], v[148:151]
  ds_read_b64_tr_b16 a[132:133], v15 offset:12288
  ds_read_b64_tr_b16 a[134:135], v15 offset:12800
  v_mfma_f32_16x16x32_bf16 v[156:159], v[58:61], v[52:55], v[156:159]
  ds_read_b64_tr_b16 a[136:137], v9 offset:12288
  ds_read_b64_tr_b16 a[138:139], v9 offset:12800
  v_mfma_f32_16x16x32_bf16 v[152:155], v[76:79], v[52:55], v[152:155]
  ds_read_b64_tr_b16 a[140:141], v11 offset:12288
  ds_read_b64_tr_b16 a[142:143], v11 offset:12800
  v_mfma_f32_16x16x32_bf16 v[160:163], v[82:85], v[52:55], v[160:163]
  v_exp_f32 v119, v119
  v_mfma_f32_16x16x32_bf16 v[164:167], v[46:49], v[40:43], v[164:167]
  v_cvt_pk_bf16_f32 v116, v116, v117
  v_cvt_pk_bf16_f32 v117, v118, v119
  v_mfma_f32_16x16x32_bf16 v[172:175], v[58:61], v[40:43], v[172:175]
  v_exp_f32 v124, v124
  v_mfma_f32_16x16x32_bf16 v[168:171], v[76:79], v[40:43], v[168:171]
  v_exp_f32 v125, v125
  v_mfma_f32_16x16x32_bf16 v[176:179], v[82:85], v[40:43], v[176:179]
  v_exp_f32 v126, v126
L_enter:
  v_mfma_f32_16x16x32_bf16 v[40:43], a[144:147], a[72:75], 0
  v_exp_f32 v127, v127
  v_mfma_f32_16x16x32_bf16 v[40:43], a[148:151], a[84:87], v[40:43]
  v_cvt_pk_bf16_f32 v118, v124, v125
  v_cvt_pk_bf16_f32 v119, v126, v127
  v_mfma_f32_16x16x32_bf16 v[40:43], a[152:155], a[96:99], v[40:43]
  v_exp_f32 v120, v120
  v_mfma_f32_16x16x32_bf16 v[40:43], a[156:159], a[108:111], v[40:43]
  s_waitcnt lgkmcnt(0)
  v_mfma_f32_16x16x32_bf16 v[40:43], a[160:163], a[120:123], v[40:43]
  v_exp_f32 v121, v121
  v_mfma_f32_16x16x32_bf16 v[40:43], a[164:167], a[132:135], v[40:43]
  v_exp_f32 v122, v122
  v_mfma_f32_16x16x32_bf16 v[44:47], a[164:167], a[136:139], 0
  v_exp_f32 v123, v123
  v_mfma_f32_16x16x32_bf16 v[44:47], a[160:163], a[124:127], v[44:47]
  v_cvt_pk_bf16_f32 v120, v120, v121
  v_cvt_pk_bf16_f32 v121, v122, v123
  v_mfma_f32_16x16x32_bf16 v[44:47], a[156:159], a[112:115], v[44:47]
  v_cvt_pk_bf16_f32 v16, v40, v41
  v_cvt_pk_bf16_f32 v17, v42, v43
  v_mfma_f32_16x16x32_bf16 v[44:47], a[152:155], a[100:103], v[44:47]
  v_exp_f32 v128, v128
  v_mfma_f32_16x16x32_bf16 v[44:47], a[148:151], a[88:91], v[44:47]
  v_exp_f32 v129, v129
  v_mfma_f32_16x16x32_bf16 v[44:47], a[144:147], a[76:79], v[44:47]
  v_exp_f32 v130, v130
  v_mfma_f32_16x16x32_bf16 v[40:43], a[144:147], a[80:83], 0
  v_exp_f32 v131, v131
  v_mfma_f32_16x16x32_bf16 v[40:43], a[148:151], a[92:95], v[40:43]
  v_cvt_pk_bf16_f32 v122, v128, v129
  v_cvt_pk_bf16_f32 v123, v130, v131
  v_mfma_f32_16x16x32_bf16 v[40:43], a[152:155], a[104:107], v[40:43]
  v_cvt_pk_bf16_f32 v24, v44, v45
  v_cvt_pk_bf16_f32 v25, v46, v47
  v_mfma_f32_16x16x32_bf16 v[40:43], a[156:159], a[116:119], v[40:43]
  v_exp_f32 v132, v132
  v_mfma_f32_16x16x32_bf16 v[40:43], a[160:163], a[128:131], v[40:43]
  v_exp_f32 v133, v133
  v_mfma_f32_16x16x32_bf16 v[40:43], a[164:167], a[140:143], v[40:43]
  v_exp_f32 v134, v134
  v_mfma_f32_16x16x32_bf16 v[44:47], a[168:171], a[72:75], 0
  v_cvt_pk_bf16_f32 v132, v132, v133
  v_mfma_f32_16x16x32_bf16 v[44:47], a[172:175], a[84:87], v[44:47]
  v_exp_f32 v135, v135
  v_mfma_f32_16x16x32_bf16 v[44:47], a[176:179], a[96:99], v[44:47]
  v_cvt_pk_bf16_f32 v32, v40, v41
  v_cvt_pk_bf16_f32 v33, v42, v43
  v_mfma_f32_16x16x32_bf16 v[44:47], a[180:183], a[108:111], v[44:47]
  v_exp_f32 v140, v140
  v_mfma_f32_16x16x32_bf16 v[44:47], a[184:187], a[120:123], v[44:47]
  v_exp_f32 v141, v141
  v_mfma_f32_16x16x32_bf16 v[44:47], a[188:191], a[132:135], v[44:47]
  v_cvt_pk_bf16_f32 v133, v134, v135
  v_cvt_pk_bf16_f32 v134, v140, v141
  v_mfma_f32_16x16x32_bf16 v[40:43], a[188:191], a[136:139], 0
  v_exp_f32 v142, v142
  v_mfma_f32_16x16x32_bf16 v[40:43], a[184:187], a[124:127], v[40:43]
  v_exp_f32 v143, v143
  v_mfma_f32_16x16x32_bf16 v[40:43], a[180:183], a[112:115], v[40:43]
  v_cvt_pk_bf16_f32 v18, v44, v45
  v_cvt_pk_bf16_f32 v19, v46, v47
  v_mfma_f32_16x16x32_bf16 v[40:43], a[176:179], a[100:103], v[40:43]
  v_cvt_pk_bf16_f32 v135, v142, v143
  v_mfma_f32_16x16x32_bf16 v[40:43], a[172:175], a[88:91], v[40:43]
  v_exp_f32 v136, v136
  v_mfma_f32_16x16x32_bf16 v[40:43], a[168:171], a[76:79], v[40:43]
  v_exp_f32 v137, v137
  v_mfma_f32_16x16x32_bf16 v[44:47], a[168:171], a[80:83], 0
  v_exp_f32 v138, v138
  v_mfma_f32_16x16x32_bf16 v[44:47], a[172:175], a[92:95], v[44:47]
  v_exp_f32 v139, v139
  v_mfma_f32_16x16x32_bf16 v[44:47], a[176:179], a[104:107], v[44:47]
  v_cvt_pk_bf16_f32 v26, v40, v41
  v_cvt_pk_bf16_f32 v27, v42, v43
  v_mfma_f32_16x16x32_bf16 v[44:47], a[180:183], a[116:119], v[44:47]
  v_cvt_pk_bf16_f32 v136, v136, v137
  v_cvt_pk_bf16_f32 v137, v138, v139
  v_mfma_f32_16x16x32_bf16 v[44:47], a[184:187], a[128:131], v[44:47]
  v_exp_f32 v144, v144
  v_mfma_f32_16x16x32_bf16 v[44:47], a[188:191], a[140:143], v[44:47]
  v_exp_f32 v145, v145
  v_mfma_f32_16x16x32_bf16 v[40:43], a[192:195], a[72:75], 0
  v_exp_f32 v146, v146
  v_mfma_f32_16x16x32_bf16 v[40:43], a[196:199], a[84:87], v[40:43]
  v_exp_f32 v147, v147
  v_mfma_f32_16x16x32_bf16 v[40:43], a[200:203], a[96:99], v[40:43]
  v_cvt_pk_bf16_f32 v34, v44, v45
  v_cvt_pk_bf16_f32 v35, v46, v47
  v_mfma_f32_16x16x32_bf16 v[40:43], a[204:207], a[108:111], v[40:43]
  v_cvt_pk_bf16_f32 v138, v144, v145
  v_cvt_pk_bf16_f32 v139, v146, v147
  v_mfma_f32_16x16x32_bf16 v[40:43], a[208:211], a[120:123], v[40:43]
  v_exp_f32 v148, v148
  v_mfma_f32_16x16x32_bf16 v[40:43], a[212:215], a[132:135], v[40:43]
  v_exp_f32 v149, v149
  v_mfma_f32_16x16x32_bf16 v[44:47], a[212:215], a[136:139], 0
  v_mov_b64 v[144:145], 0
  v_cvt_pk_bf16_f32 v148, v148, v149
  v_mfma_f32_16x16x32_bf16 v[44:47], a[208:211], a[124:127], v[44:47]
  v_exp_f32 v150, v150
  v_mfma_f32_16x16x32_bf16 v[44:47], a[204:207], a[112:115], v[44:47]
  v_cvt_pk_bf16_f32 v20, v40, v41
  v_cvt_pk_bf16_f32 v21, v42, v43
  v_mfma_f32_16x16x32_bf16 v[44:47], a[200:203], a[100:103], v[44:47]
  v_exp_f32 v151, v151
  v_mfma_f32_16x16x32_bf16 v[44:47], a[196:199], a[88:91], v[44:47]
  v_exp_f32 v156, v156
  v_mfma_f32_16x16x32_bf16 v[44:47], a[192:195], a[76:79], v[44:47]
  v_exp_f32 v157, v157
  v_mfma_f32_16x16x32_bf16 v[40:43], a[192:195], a[80:83], 0
  v_cvt_pk_bf16_f32 v149, v150, v151
  v_cvt_pk_bf16_f32 v150, v156, v157
  v_mfma_f32_16x16x32_bf16 v[40:43], a[196:199], a[92:95], v[40:43]
  v_exp_f32 v158, v158
  v_mfma_f32_16x16x32_bf16 v[40:43], a[200:203], a[104:107], v[40:43]
  v_cvt_pk_bf16_f32 v28, v44, v45
  v_cvt_pk_bf16_f32 v29, v46, v47
  v_mfma_f32_16x16x32_bf16 v[40:43], a[204:207], a[116:119], v[40:43]
  v_exp_f32 v159, v159
  v_mfma_f32_16x16x32_bf16 v[40:43], a[208:211], a[128:131], v[40:43]
  v_cvt_pk_bf16_f32 v151, v158, v159
  v_mfma_f32_16x16x32_bf16 v[40:43], a[212:215], a[140:143], v[40:43]
  v_exp_f32 v152, v152
  v_mfma_f32_16x16x32_bf16 v[44:47], a[216:219], a[72:75], 0
  v_exp_f32 v153, v153
  v_mfma_f32_16x16x32_bf16 v[44:47], a[220:223], a[84:87], v[44:47]
  v_exp_f32 v154, v154
  v_mfma_f32_16x16x32_bf16 v[44:47], a[224:227], a[96:99], v[44:47]
  v_cvt_pk_bf16_f32 v36, v40, v41
  v_cvt_pk_bf16_f32 v37, v42, v43
  v_mfma_f32_16x16x32_bf16 v[44:47], a[244:247], a[108:111], v[44:47]
  v_exp_f32 v155, v155
  v_mfma_f32_16x16x32_bf16 v[44:47], a[248:251], a[120:123], v[44:47]
  v_cvt_pk_bf16_f32 v152, v152, v153
  v_cvt_pk_bf16_f32 v153, v154, v155
  v_mfma_f32_16x16x32_bf16 v[44:47], a[252:255], a[132:135], v[44:47]
  v_exp_f32 v160, v160
  v_mfma_f32_16x16x32_bf16 v[40:43], a[252:255], a[136:139], 0
  v_exp_f32 v161, v161
  v_mfma_f32_16x16x32_bf16 v[40:43], a[248:251], a[124:127], v[40:43]
  v_exp_f32 v162, v162
  v_mfma_f32_16x16x32_bf16 v[40:43], a[244:247], a[112:115], v[40:43]
  v_cvt_pk_bf16_f32 v22, v44, v45
  v_cvt_pk_bf16_f32 v23, v46, v47
  v_mfma_f32_16x16x32_bf16 v[40:43], a[224:227], a[100:103], v[40:43]
  v_exp_f32 v163, v163
  v_mfma_f32_16x16x32_bf16 v[40:43], a[220:223], a[88:91], v[40:43]
  v_cvt_pk_bf16_f32 v154, v160, v161
  v_cvt_pk_bf16_f32 v155, v162, v163
  v_mfma_f32_16x16x32_bf16 v[40:43], a[216:219], a[76:79], v[40:43]
  v_exp_f32 v164, v164
  v_mfma_f32_16x16x32_bf16 v[44:47], a[216:219], a[80:83], 0
  v_exp_f32 v165, v165
  v_mfma_f32_16x16x32_bf16 v[44:47], a[220:223], a[92:95], v[44:47]
  v_exp_f32 v166, v166
  v_mfma_f32_16x16x32_bf16 v[44:47], a[224:227], a[104:107], v[44:47]
  v_cvt_pk_bf16_f32 v30, v40, v41
  v_cvt_pk_bf16_f32 v31, v42, v43
  v_mfma_f32_16x16x32_bf16 v[44:47], a[244:247], a[116:119], v[44:47]
  v_exp_f32 v167, v167
  v_mfma_f32_16x16x32_bf16 v[44:47], a[248:251], a[128:131], v[44:47]
  v_cvt_pk_bf16_f32 v164, v164, v165
  v_cvt_pk_bf16_f32 v165, v166, v167
  v_mfma_f32_16x16x32_bf16 v[44:47], a[252:255], a[140:143], v[44:47]
  v_exp_f32 v172, v172
  s_add_u32 s32, s32, 40960
  v_mad_i32_i16 v0, v10, 1, s32 op_sel:[1,0,0,0]
  v_xor_b32 v1, 64, v0
  s_add_u32 s20, s20, s37
  s_addc_u32 s21, s21, 0
  v_exp_f32 v173, v173
  v_exp_f32 v174, v174
  v_smfmac_f32_16x16x64_bf16 v[144:147], a[240:243], v[116:123], v10
  v_exp_f32 v175, v175
  v_mfma_f32_16x16x32_bf16 v[124:127], v[20:23], v[120:123], 0
  v_cvt_pk_bf16_f32 v166, v172, v173
  v_cvt_pk_bf16_f32 v167, v174, v175
  v_mfma_f32_16x16x32_bf16 v[124:127], v[16:19], v[116:119], v[124:127]
  v_cvt_pk_bf16_f32 v38, v44, v45
  v_cvt_pk_bf16_f32 v39, v46, v47
  v_mfma_f32_16x16x32_bf16 v[128:131], v[24:27], v[116:119], 0
  v_add_f32 v15, v144, v145
  v_mov_b64 v[144:145], 0
  v_mfma_f32_16x16x32_bf16 v[128:131], v[28:31], v[120:123], v[128:131]
  v_exp_f32 v168, v168
  v_mfma_f32_16x16x32_bf16 v[140:143], v[36:39], v[120:123], 0
  v_exp_f32 v169, v169
  v_mfma_f32_16x16x32_bf16 v[140:143], v[32:35], v[116:119], v[140:143]
  v_exp_f32 v170, v170
  v_smfmac_f32_16x16x64_bf16 v[144:147], a[240:243], v[132:139], v10
  v_exp_f32 v171, v171
  v_mfma_f32_16x16x32_bf16 v[116:119], v[20:23], v[136:139], 0
  v_cvt_pk_bf16_f32 v168, v168, v169
  v_cvt_pk_bf16_f32 v169, v170, v171
  v_mfma_f32_16x16x32_bf16 v[116:119], v[16:19], v[132:135], v[116:119]
  v_exp_f32 v176, v176
  v_mfma_f32_16x16x32_bf16 v[120:123], v[24:27], v[132:135], 0
  v_add_f32 v14, v144, v145
  v_mov_b64 v[144:145], 0
  v_mfma_f32_16x16x32_bf16 v[120:123], v[28:31], v[136:139], v[120:123]
  v_exp_f32 v177, v177
  v_mfma_f32_16x16x32_bf16 v[156:159], v[36:39], v[136:139], 0
  v_exp_f32 v178, v178
  v_mfma_f32_16x16x32_bf16 v[156:159], v[32:35], v[132:135], v[156:159]
  v_exp_f32 v179, v179
  v_smfmac_f32_16x16x64_bf16 v[144:147], a[240:243], v[148:155], v10
  v_cvt_pk_bf16_f32 v170, v176, v177
  v_cvt_pk_bf16_f32 v171, v178, v179
  v_mfma_f32_16x16x32_bf16 v[132:135], v[20:23], v[152:155], 0
  s_add_u32 m0, s32, 28672
  v_max_f32 v9, v14, v15
  v_mfma_f32_16x16x32_bf16 v[132:135], v[16:19], v[148:151], v[132:135]
  s_waitcnt vmcnt(6)
  s_barrier
  v_mfma_f32_16x16x32_bf16 v[136:139], v[24:27], v[148:151], 0
  v_add_f32 v13, v144, v145
  v_mov_b64 v[144:145], 0
  v_mfma_f32_16x16x32_bf16 v[136:139], v[28:31], v[152:155], v[136:139]
  ds_read_b128 a[244:247], v0 offset:0
  ds_read_b128 a[248:251], v1 offset:0
  v_mfma_f32_16x16x32_bf16 v[160:163], v[36:39], v[152:155], 0
  buffer_load_dwordx4 v6, s[8:11], s49 offen offset:0 nt lds
  v_mfma_f32_16x16x32_bf16 v[160:163], v[32:35], v[148:151], v[160:163]
  ds_read_b128 a[252:255], v0 offset:8192
  ds_read_b128 v[180:183], v1 offset:8192
  v_smfmac_f32_16x16x64_bf16 v[144:147], a[240:243], v[164:171], v10
  s_add_u32 m0, s32, 36736
  v_mfma_f32_16x16x32_bf16 v[148:151], v[20:23], v[168:171], 0
  ds_read_b128 v[64:67], v0 offset:16384
  ds_read_b128 v[68:71], v1 offset:16384
  v_mfma_f32_16x16x32_bf16 v[148:151], v[16:19], v[164:167], v[148:151]
  buffer_load_dwordx4 v6, s[8:11], s49 offen offset:128 nt lds
  v_mfma_f32_16x16x32_bf16 v[152:155], v[24:27], v[164:167], 0
  v_add_f32 v12, v144, v145
  s_add_u32 m0, s32, 44800
  v_mfma_f32_16x16x32_bf16 v[152:155], v[28:31], v[168:171], v[152:155]
  buffer_load_dwordx4 v6, s[8:11], s49 offen offset:256 nt lds
  v_mfma_f32_16x16x32_bf16 v[172:175], v[36:39], v[168:171], 0
  v_rcp_f32 v15, v15
  v_mfma_f32_16x16x32_bf16 v[172:175], v[32:35], v[164:167], v[172:175]
  s_waitcnt lgkmcnt(4)
  v_mfma_f32_16x16x32_bf16 v[76:79], a[244:247], a[80:83], 0
  v_rcp_f32 v14, v14
  v_mfma_f32_16x16x32_bf16 v[76:79], a[248:251], a[92:95], v[76:79]
  s_waitcnt lgkmcnt(2)
  v_mul_f32 v124, v15, v124
  v_mfma_f32_16x16x32_bf16 v[76:79], a[252:255], a[104:107], v[76:79]
  v_mul_f32 v125, v15, v125
  v_mul_f32 v126, v15, v126
  v_mfma_f32_16x16x32_bf16 v[76:79], v[180:183], a[116:119], v[76:79]
  s_waitcnt lgkmcnt(0)
  v_mul_f32 v127, v15, v127
  v_mfma_f32_16x16x32_bf16 v[76:79], v[64:67], a[128:131], v[76:79]
  v_cvt_pk_bf16_f32 v124, v124, v125
  v_cvt_pk_bf16_f32 v125, v126, v127
  v_mfma_f32_16x16x32_bf16 v[76:79], v[68:71], a[140:143], v[76:79]
  v_mul_f32 v128, v15, v128
  v_mul_f32 v129, v15, v129
  v_mfma_f32_16x16x32_bf16 v[80:83], v[68:71], a[136:139], 0
  v_mul_f32 v130, v15, v130
  v_mul_f32 v131, v15, v131
  v_mfma_f32_16x16x32_bf16 v[80:83], v[64:67], a[124:127], v[80:83]
  v_cvt_pk_bf16_f32 v126, v128, v129
  v_cvt_pk_bf16_f32 v127, v130, v131
  v_mfma_f32_16x16x32_bf16 v[80:83], v[180:183], a[112:115], v[80:83]
  v_cvt_pk_bf16_f32 v32, v76, v77
  v_cvt_pk_bf16_f32 v33, v78, v79
  v_mfma_f32_16x16x32_bf16 v[80:83], a[252:255], a[100:103], v[80:83]
  ds_write_b128 v4, v[124:127] offset:768
  v_mfma_f32_16x16x32_bf16 v[80:83], a[248:251], a[88:91], v[80:83]
  v_mul_f32 v140, v15, v140
  v_mul_f32 v141, v15, v141
  v_mfma_f32_16x16x32_bf16 v[80:83], a[244:247], a[76:79], v[80:83]
  v_mul_f32 v142, v15, v142
  v_mul_f32 v143, v15, v143
  v_mfma_f32_16x16x32_bf16 v[76:79], a[244:247], a[72:75], 0
  v_cvt_pk_bf16_f32 v140, v140, v141
  v_cvt_pk_bf16_f32 v141, v142, v143
  v_mfma_f32_16x16x32_bf16 v[76:79], a[248:251], a[84:87], v[76:79]
  ds_write_b64 v5, v[140:141] offset:768
  v_mfma_f32_16x16x32_bf16 v[76:79], a[252:255], a[96:99], v[76:79]
  v_cvt_pk_bf16_f32 v24, v80, v81
  v_cvt_pk_bf16_f32 v25, v82, v83
  v_mfma_f32_16x16x32_bf16 v[76:79], v[180:183], a[108:111], v[76:79]
  v_max3_f32 v9, v12, v13, v9
  v_mfma_f32_16x16x32_bf16 v[76:79], v[64:67], a[120:123], v[76:79]
  v_rcp_f32 v13, v13
  v_mfma_f32_16x16x32_bf16 v[76:79], v[68:71], a[132:135], v[76:79]
  v_mul_f32 v116, v14, v116
  v_mul_f32 v117, v14, v117
  v_mfma_f32_16x16x32_bf16 v[80:83], a[68:71], v[68:71], 0
  v_mul_f32 v118, v14, v118
  v_mul_f32 v119, v14, v119
  v_mfma_f32_16x16x32_bf16 v[80:83], a[56:59], v[64:67], v[80:83]
  v_cvt_pk_bf16_f32 v116, v116, v117
  v_cvt_pk_bf16_f32 v117, v118, v119
  v_mfma_f32_16x16x32_bf16 v[80:83], a[44:47], v[180:183], v[80:83]
  v_cvt_pk_bf16_f32 v16, v76, v77
  v_cvt_pk_bf16_f32 v17, v78, v79
  v_mfma_f32_16x16x32_bf16 v[80:83], a[32:35], a[252:255], v[80:83]
  v_mul_f32 v120, v14, v120
  v_mul_f32 v121, v14, v121
  v_mfma_f32_16x16x32_bf16 v[80:83], a[20:23], a[248:251], v[80:83]
  v_mul_f32 v122, v14, v122
  v_mul_f32 v123, v14, v123
  v_mfma_f32_16x16x32_bf16 v[80:83], a[8:11], a[244:247], v[80:83]
  v_cvt_pk_bf16_f32 v118, v120, v121
  v_cvt_pk_bf16_f32 v119, v122, v123
  v_mfma_f32_16x16x32_bf16 v[76:79], a[4:7], a[244:247], 0
  ds_write_b128 v4, v[116:119] offset:512
  v_mfma_f32_16x16x32_bf16 v[76:79], a[16:19], a[248:251], v[76:79]
  v_mul_f32 v156, v14, v156
  v_mul_f32 v157, v14, v157
  v_mfma_f32_16x16x32_bf16 v[76:79], a[28:31], a[252:255], v[76:79]
  v_cvt_pk_bf16_f32 v50, v80, v81
  v_cvt_pk_bf16_f32 v51, v82, v83
  v_mfma_f32_16x16x32_bf16 v[76:79], a[40:43], v[180:183], v[76:79]
  v_mul_f32 v158, v14, v158
  v_mul_f32 v159, v14, v159
  v_mfma_f32_16x16x32_bf16 v[76:79], a[52:55], v[64:67], v[76:79]
  v_cvt_pk_bf16_f32 v156, v156, v157
  v_cvt_pk_bf16_f32 v157, v158, v159
  v_mfma_f32_16x16x32_bf16 v[76:79], a[64:67], v[68:71], v[76:79]
  ds_write_b64 v5, v[156:157] offset:512
  v_mfma_f32_16x16x32_bf16 v[80:83], a[60:63], v[68:71], 0
  v_rcp_f32 v12, v12
  v_mfma_f32_16x16x32_bf16 v[80:83], a[48:51], v[64:67], v[80:83]
  v_mul_f32 v132, v13, v132
  v_mul_f32 v133, v13, v133
  v_mfma_f32_16x16x32_bf16 v[80:83], a[36:39], v[180:183], v[80:83]
  v_cvt_pk_bf16_f32 v48, v76, v77
  v_cvt_pk_bf16_f32 v49, v78, v79
  v_mfma_f32_16x16x32_bf16 v[80:83], a[24:27], a[252:255], v[80:83]
  v_mul_f32 v134, v13, v134
  v_mul_f32 v135, v13, v135
  v_mfma_f32_16x16x32_bf16 v[80:83], a[12:15], a[248:251], v[80:83]
  v_cvt_pk_bf16_f32 v132, v132, v133
  v_cvt_pk_bf16_f32 v133, v134, v135
  v_mfma_f32_16x16x32_bf16 v[80:83], a[0:3], a[244:247], v[80:83]
  v_mul_f32 v136, v13, v136
  v_mul_f32 v137, v13, v137
  v_mfma_f32_16x16x32_bf16 v[76:79], v[192:195], a[244:247], 0
  v_mul_f32 v138, v13, v138
  v_mul_f32 v139, v13, v139
  v_mfma_f32_16x16x32_bf16 v[76:79], v[204:207], a[248:251], v[76:79]
  v_cvt_pk_bf16_f32 v134, v136, v137
  v_cvt_pk_bf16_f32 v135, v138, v139
  v_mfma_f32_16x16x32_bf16 v[76:79], v[216:219], a[252:255], v[76:79]
  v_cvt_pk_bf16_f32 v46, v80, v81
  v_cvt_pk_bf16_f32 v47, v82, v83
  v_mfma_f32_16x16x32_bf16 v[76:79], v[228:231], v[180:183], v[76:79]
  ds_read_b128 v[72:75], v0 offset:2048
  v_mul_f32 v160, v13, v160
  v_mfma_f32_16x16x32_bf16 v[76:79], v[240:243], v[64:67], v[76:79]
  ds_read_b128 v[84:87], v1 offset:2048
  v_mul_f32 v161, v13, v161
  v_mfma_f32_16x16x32_bf16 v[76:79], v[252:255], v[68:71], v[76:79]
  ds_read_b128 v[164:167], v0 offset:10240
  v_mul_f32 v162, v13, v162
  v_mfma_f32_16x16x32_bf16 v[80:83], v[248:251], v[68:71], 0
  ds_read_b128 v[168:171], v1 offset:10240
  v_mul_f32 v163, v13, v163
  v_mfma_f32_16x16x32_bf16 v[80:83], v[236:239], v[64:67], v[80:83]
  ds_read_b128 v[176:179], v0 offset:18432
  v_cvt_pk_bf16_f32 v160, v160, v161
  v_mfma_f32_16x16x32_bf16 v[80:83], v[224:227], v[180:183], v[80:83]
  v_cvt_pk_bf16_f32 v44, v76, v77
  v_cvt_pk_bf16_f32 v45, v78, v79
  v_mfma_f32_16x16x32_bf16 v[80:83], v[212:215], a[252:255], v[80:83]
  ds_read_b128 v[144:147], v1 offset:18432
  v_cvt_pk_bf16_f32 v161, v162, v163
  v_mfma_f32_16x16x32_bf16 v[80:83], v[200:203], a[248:251], v[80:83]
  ds_write_b128 v4, v[132:135] offset:256
  v_mfma_f32_16x16x32_bf16 v[80:83], v[188:191], a[244:247], v[80:83]
  ds_write_b64 v5, v[160:161] offset:256
  v_mfma_f32_16x16x32_bf16 v[76:79], v[184:187], a[244:247], 0
  v_mul_f32 v148, v12, v148
  v_mul_f32 v149, v12, v149
  v_mfma_f32_16x16x32_bf16 v[76:79], v[196:199], a[248:251], v[76:79]
  v_mul_f32 v150, v12, v150
  v_mul_f32 v151, v12, v151
  v_mfma_f32_16x16x32_bf16 v[76:79], v[208:211], a[252:255], v[76:79]
  v_cvt_pk_bf16_f32 v42, v80, v81
  v_cvt_pk_bf16_f32 v43, v82, v83
  v_mfma_f32_16x16x32_bf16 v[76:79], v[220:223], v[180:183], v[76:79]
  v_cvt_pk_bf16_f32 v148, v148, v149
  v_cvt_pk_bf16_f32 v149, v150, v151
  v_mfma_f32_16x16x32_bf16 v[76:79], v[232:235], v[64:67], v[76:79]
  v_mul_f32 v152, v12, v152
  v_mul_f32 v153, v12, v153
  v_mfma_f32_16x16x32_bf16 v[76:79], v[244:247], v[68:71], v[76:79]
  s_waitcnt lgkmcnt(2)
  v_mul_f32 v154, v12, v154
  v_mfma_f32_16x16x32_bf16 v[80:83], v[244:247], v[144:147], 0
  v_mul_f32 v155, v12, v155
  v_cvt_pk_bf16_f32 v150, v152, v153
  v_mfma_f32_16x16x32_bf16 v[80:83], v[232:235], v[176:179], v[80:83]
  v_cvt_pk_bf16_f32 v151, v154, v155
  v_mul_f32 v172, v12, v172
  v_mfma_f32_16x16x32_bf16 v[80:83], v[220:223], v[168:171], v[80:83]
  v_cvt_pk_bf16_f32 v40, v76, v77
  v_cvt_pk_bf16_f32 v41, v78, v79
  v_mfma_f32_16x16x32_bf16 v[80:83], v[208:211], v[164:167], v[80:83]
  ds_write_b128 v4, v[148:151] offset:0
  v_mfma_f32_16x16x32_bf16 v[80:83], v[196:199], v[84:87], v[80:83]
  v_mul_f32 v173, v12, v173
  v_mul_f32 v174, v12, v174
  v_mfma_f32_16x16x32_bf16 v[80:83], v[184:187], v[72:75], v[80:83]
  v_mul_f32 v175, v12, v175
  v_cvt_pk_bf16_f32 v172, v172, v173
  v_mfma_f32_16x16x32_bf16 v[76:79], v[188:191], v[72:75], 0
  v_cvt_pk_bf16_f32 v173, v174, v175
  v_mfma_f32_16x16x32_bf16 v[76:79], v[200:203], v[84:87], v[76:79]
  ds_write_b64 v5, v[172:173] offset:0
  v_mfma_f32_16x16x32_bf16 v[76:79], v[212:215], v[164:167], v[76:79]
  v_cvt_pk_bf16_f32 v52, v80, v81
  v_cvt_pk_bf16_f32 v53, v82, v83
  v_mfma_f32_16x16x32_bf16 v[76:79], v[224:227], v[168:171], v[76:79]
  v_subrev_u32 v3, s7, v3
  v_subrev_u32 v2, s7, v2
  v_mfma_f32_16x16x32_bf16 v[76:79], v[236:239], v[176:179], v[76:79]
  v_add_u32 v4, s7, v4
  v_add_u32 v5, s7, v5
  v_mfma_f32_16x16x32_bf16 v[76:79], v[248:251], v[144:147], v[76:79]
  s_sub_u32 s7, 0, s7
  v_max3_f32 v9, v12, v13, v9
  v_mfma_f32_16x16x32_bf16 v[80:83], v[252:255], v[144:147], 0
  v_max3_f32 v9, v14, v15, v9
  v_accvgpr_read_b32 v180, a228
  v_mfma_f32_16x16x32_bf16 v[80:83], v[240:243], v[176:179], v[80:83]
  s_add_u32 m0, s58, 114688
  s_add_u32 s36, s58, 0
  v_mfma_f32_16x16x32_bf16 v[80:83], v[228:231], v[168:171], v[80:83]
  v_cvt_pk_bf16_f32 v54, v76, v77
  v_cvt_pk_bf16_f32 v55, v78, v79
  v_mfma_f32_16x16x32_bf16 v[80:83], v[216:219], v[164:167], v[80:83]
  buffer_load_dwordx4 v180, s[16:19], s36 offen offset:0 lds
  v_mfma_f32_16x16x32_bf16 v[80:83], v[204:207], v[84:87], v[80:83]
  s_add_u32 s37, s28, 4
  s_lshr_b32 s37, s37, 6
  v_mfma_f32_16x16x32_bf16 v[80:83], v[192:195], v[72:75], v[80:83]
  buffer_load_dwordx4 v180, s[16:19], s36 offen offset:1024 lds
  v_mfma_f32_16x16x32_bf16 v[76:79], a[0:3], v[72:75], 0
  s_add_u32 s39, s28, 1
  s_lshr_b32 s39, s39, 6
  v_mfma_f32_16x16x32_bf16 v[76:79], a[12:15], v[84:87], v[76:79]
  s_sub_u32 s62, s38, s28
  s_mulk_i32 s62, 3072
  v_mfma_f32_16x16x32_bf16 v[76:79], a[24:27], v[164:167], v[76:79]
  v_cvt_pk_bf16_f32 v56, v80, v81
  v_cvt_pk_bf16_f32 v57, v82, v83
  v_mfma_f32_16x16x32_bf16 v[76:79], a[36:39], v[168:171], v[76:79]
  buffer_load_dwordx4 v180, s[16:19], s36 offen offset:2048 lds
  v_mfma_f32_16x16x32_bf16 v[76:79], a[48:51], v[176:179], v[76:79]
  s_add_u32 s62, s62, s46
  s_mul_i32 s14, s37, -42
  v_mfma_f32_16x16x32_bf16 v[76:79], a[60:63], v[144:147], v[76:79]
  s_add_u32 m0, s58, 126976
  s_add_u32 s36, s58, 18432
  v_mfma_f32_16x16x32_bf16 v[80:83], a[64:67], v[144:147], 0
  buffer_load_dwordx4 v180, s[16:19], s36 offen offset:0 lds
  v_mfma_f32_16x16x32_bf16 v[80:83], a[52:55], v[176:179], v[80:83]
  s_addk_i32 s14, 128
  s_mul_i32 s15, s37, -3072
  v_mfma_f32_16x16x32_bf16 v[80:83], a[40:43], v[168:171], v[80:83]
  v_cvt_pk_bf16_f32 v58, v76, v77
  v_cvt_pk_bf16_f32 v59, v78, v79
  v_mfma_f32_16x16x32_bf16 v[80:83], a[28:31], v[164:167], v[80:83]
  s_add_u32 s15, s15, 1566720
  s_lshl3_add_u32 s12, s39, 48
  v_mfma_f32_16x16x32_bf16 v[80:83], a[16:19], v[84:87], v[80:83]
  buffer_load_dwordx4 v180, s[16:19], s36 offen offset:1024 lds
  v_mfma_f32_16x16x32_bf16 v[80:83], a[4:7], v[72:75], v[80:83]
  s_lshl2_add_u32 s13, s37, 104
  s_sub_u32 s13, s13, s12
  v_mfma_f32_16x16x32_bf16 v[76:79], a[8:11], v[72:75], 0
  s_or_b32 s39, s39, s31
  s_or_b32 s39, s39, s4
  v_mfma_f32_16x16x32_bf16 v[76:79], a[20:23], v[84:87], v[76:79]
L_hop2:
  s_cbranch_execz L_hopped
  buffer_load_dwordx4 v180, s[16:19], s36 offen offset:2048 lds
  v_mfma_f32_16x16x32_bf16 v[76:79], a[32:35], v[164:167], v[76:79]
  v_cvt_pk_bf16_f32 v60, v80, v81
  v_cvt_pk_bf16_f32 v61, v82, v83
  v_mfma_f32_16x16x32_bf16 v[76:79], a[44:47], v[168:171], v[76:79]
  s_lshl_b32 s39, s39, 8
  s_add_u32 s63, s12, s39
  v_mfma_f32_16x16x32_bf16 v[76:79], a[56:59], v[176:179], v[76:79]
  s_add_u32 m0, s58, 139264
  s_add_u32 s36, s58, 36864
  v_mfma_f32_16x16x32_bf16 v[76:79], a[68:71], v[144:147], v[76:79]
  buffer_load_dwordx4 v180, s[16:19], s36 offen offset:0 lds
  v_mfma_f32_16x16x32_bf16 v[80:83], v[144:147], a[132:135], 0
  s_waitcnt vmcnt(13)
  s_barrier
  v_mfma_f32_16x16x32_bf16 v[80:83], v[176:179], a[120:123], v[80:83]
  s_add_u32 s60, s63, s29
  s_sub_u32 s60, s60, 4
  v_mfma_f32_16x16x32_bf16 v[80:83], v[168:171], a[108:111], v[80:83]
  v_cvt_pk_bf16_f32 v62, v76, v77
  v_cvt_pk_bf16_f32 v63, v78, v79
  v_mfma_f32_16x16x32_bf16 v[80:83], v[164:167], a[96:99], v[80:83]
  ds_read_b128 v[116:119], v0 offset:4096
  ds_read_b128 v[124:127], v1 offset:4096
  v_mfma_f32_16x16x32_bf16 v[80:83], v[84:87], a[84:87], v[80:83]
  buffer_load_dwordx4 v180, s[16:19], s36 offen offset:1024 lds
  v_mfma_f32_16x16x32_bf16 v[80:83], v[72:75], a[72:75], v[80:83]
  ds_read_b128 v[120:123], v0 offset:12288
  ds_read_b128 v[128:131], v1 offset:12288
  v_mfma_f32_16x16x32_bf16 v[76:79], v[72:75], a[76:79], 0
  buffer_load_dwordx4 v180, s[16:19], s36 offen offset:2048 lds
  v_mfma_f32_16x16x32_bf16 v[76:79], v[84:87], a[88:91], v[76:79]
  ds_read_b128 v[132:135], v0 offset:20480
  ds_read_b128 v[140:143], v1 offset:20480
  v_mfma_f32_16x16x32_bf16 v[76:79], v[164:167], a[100:103], v[76:79]
  v_cvt_pk_bf16_f32 v18, v80, v81
  v_cvt_pk_bf16_f32 v19, v82, v83
  v_mfma_f32_16x16x32_bf16 v[76:79], v[168:171], a[112:115], v[76:79]
  s_add_u32 m0, s58, 151552
  s_add_u32 s36, s58, 55296
  v_mfma_f32_16x16x32_bf16 v[76:79], v[176:179], a[124:127], v[76:79]
  buffer_load_dwordx4 v180, s[16:19], s36 offen offset:0 lds
  v_mfma_f32_16x16x32_bf16 v[76:79], v[144:147], a[136:139], v[76:79]
  v_mfma_f32_16x16x32_bf16 v[80:83], v[144:147], a[140:143], 0
  v_mfma_f32_16x16x32_bf16 v[80:83], v[176:179], a[128:131], v[80:83]
  buffer_load_dwordx4 v180, s[16:19], s36 offen offset:1024 lds
  v_mfma_f32_16x16x32_bf16 v[80:83], v[168:171], a[116:119], v[80:83]
  v_cvt_pk_bf16_f32 v26, v76, v77
  v_cvt_pk_bf16_f32 v27, v78, v79
  v_mfma_f32_16x16x32_bf16 v[80:83], v[164:167], a[104:107], v[80:83]
  v_mfma_f32_16x16x32_bf16 v[80:83], v[84:87], a[92:95], v[80:83]
  buffer_load_dwordx4 v180, s[16:19], s36 offen offset:2048 lds
  v_mfma_f32_16x16x32_bf16 v[80:83], v[72:75], a[80:83], v[80:83]
  s_waitcnt lgkmcnt(0)
  v_mfma_f32_16x16x32_bf16 v[148:151], v[116:119], a[80:83], 0
  v_mfma_f32_16x16x32_bf16 v[148:151], v[124:127], a[92:95], v[148:151]
  s_add_u32 m0, s58, 0
  s_add_u32 s36, s59, 12288
  v_mfma_f32_16x16x32_bf16 v[148:151], v[120:123], a[104:107], v[148:151]
  v_cvt_pk_bf16_f32 v34, v80, v81
  v_cvt_pk_bf16_f32 v35, v82, v83
  v_mfma_f32_16x16x32_bf16 v[148:151], v[128:131], a[116:119], v[148:151]
  buffer_load_dwordx4 v180, s[16:19], s36 offen offset:0 lds
  v_mfma_f32_16x16x32_bf16 v[148:151], v[132:135], a[128:131], v[148:151]
  v_mfma_f32_16x16x32_bf16 v[148:151], v[140:143], a[140:143], v[148:151]
  buffer_load_dwordx4 v180, s[16:19], s36 offen offset:1024 lds
  v_mfma_f32_16x16x32_bf16 v[156:159], v[140:143], a[136:139], 0
  ds_read_b128 v[136:139], v0 offset:6144
  ds_read_b128 v[144:147], v1 offset:6144
  v_mfma_f32_16x16x32_bf16 v[156:159], v[132:135], a[124:127], v[156:159]
  v_mfma_f32_16x16x32_bf16 v[156:159], v[128:131], a[112:115], v[156:159]
  v_cvt_pk_bf16_f32 v36, v148, v149
  v_cvt_pk_bf16_f32 v37, v150, v151
  v_mfma_f32_16x16x32_bf16 v[156:159], v[120:123], a[100:103], v[156:159]
  ds_read_b128 v[152:155], v0 offset:14336
  ds_read_b128 v[160:163], v1 offset:14336
  v_mfma_f32_16x16x32_bf16 v[156:159], v[124:127], a[88:91], v[156:159]
  buffer_load_dwordx4 v180, s[16:19], s36 offen offset:2048 lds
  v_mfma_f32_16x16x32_bf16 v[156:159], v[116:119], a[76:79], v[156:159]
  ds_read_b128 v[164:167], v0 offset:22528
  ds_read_b128 v[172:175], v1 offset:22528
  v_mfma_f32_16x16x32_bf16 v[148:151], v[116:119], a[72:75], 0
  s_add_u32 m0, s58, 12288
  s_add_u32 s36, s59, 49152
  v_mfma_f32_16x16x32_bf16 v[148:151], v[124:127], a[84:87], v[148:151]
  buffer_load_dwordx4 v180, s[16:19], s36 offen offset:0 lds
  v_mfma_f32_16x16x32_bf16 v[148:151], v[120:123], a[96:99], v[148:151]
  v_cvt_pk_bf16_f32 v28, v156, v157
  v_cvt_pk_bf16_f32 v29, v158, v159
  v_mfma_f32_16x16x32_bf16 v[148:151], v[128:131], a[108:111], v[148:151]
  v_mfma_f32_16x16x32_bf16 v[148:151], v[132:135], a[120:123], v[148:151]
  buffer_load_dwordx4 v180, s[16:19], s36 offen offset:1024 lds
  v_mfma_f32_16x16x32_bf16 v[148:151], v[140:143], a[132:135], v[148:151]
  v_mfma_f32_16x16x32_bf16 v[156:159], a[68:71], v[140:143], 0
  v_mfma_f32_16x16x32_bf16 v[156:159], a[56:59], v[132:135], v[156:159]
  v_mfma_f32_16x16x32_bf16 v[156:159], a[44:47], v[128:131], v[156:159]
  v_cvt_pk_bf16_f32 v20, v148, v149
  v_cvt_pk_bf16_f32 v21, v150, v151
  v_mfma_f32_16x16x32_bf16 v[156:159], a[32:35], v[120:123], v[156:159]
  buffer_load_dwordx4 v180, s[16:19], s36 offen offset:2048 lds
  v_mfma_f32_16x16x32_bf16 v[156:159], a[20:23], v[124:127], v[156:159]
  v_accvgpr_read_b32 v180, a229
  v_accvgpr_read_b32 v181, a230
  v_mfma_f32_16x16x32_bf16 v[156:159], a[8:11], v[116:119], v[156:159]
  v_accvgpr_read_b32 v182, a231
  v_accvgpr_read_b32 v183, a232
  v_mfma_f32_16x16x32_bf16 v[148:151], a[4:7], v[116:119], 0
  s_add_u32 s48, s48, 6291456
  s_add_u32 s49, s48, 786432
  v_mfma_f32_16x16x32_bf16 v[148:151], a[16:19], v[124:127], v[148:151]
  s_sub_u32 s33, s32, 40960
  s_add_u32 s32, s33, 65536
  v_mfma_f32_16x16x32_bf16 v[148:151], a[28:31], v[120:123], v[148:151]
  v_cvt_pk_bf16_f32 v80, v156, v157
  v_cvt_pk_bf16_f32 v81, v158, v159
  v_mfma_f32_16x16x32_bf16 v[148:151], a[40:43], v[128:131], v[148:151]
  s_mov_b32 s35, 2
  s_mov_b64 vcc, 0
  v_mfma_f32_16x16x32_bf16 v[148:151], a[52:55], v[132:135], v[148:151]
  s_sub_u32 s50, s48, 12582912
  s_sub_u32 s51, s48, 6291456
  v_mfma_f32_16x16x32_bf16 v[148:151], a[64:67], v[140:143], v[148:151]
  s_sub_u32 s6, s48, 0
  s_add_u32 s44, s29, 8
  v_mfma_f32_16x16x32_bf16 v[156:159], a[60:63], v[140:143], 0
  s_mov_b32 s45, 0
  v_mov_b32 v11, 0
  v_mfma_f32_16x16x32_bf16 v[156:159], a[48:51], v[132:135], v[156:159]
  v_mad_i32_i16 v0, v10, 1, s32 op_sel:[1,0,0,0]
  v_xor_b32 v1, 64, v0
  v_mfma_f32_16x16x32_bf16 v[156:159], a[36:39], v[128:131], v[156:159]
  v_cvt_pk_bf16_f32 v78, v148, v149
  v_cvt_pk_bf16_f32 v79, v150, v151
  v_mfma_f32_16x16x32_bf16 v[156:159], a[24:27], v[120:123], v[156:159]
  s_waitcnt lgkmcnt(0)
  s_waitcnt vmcnt(9)
  s_barrier
  v_mfma_f32_16x16x32_bf16 v[156:159], a[12:15], v[124:127], v[156:159]
  s_add_u32 m0, s33, 40960
  ds_read_b64_tr_b16 a[144:145], v180 offset:0
  v_mfma_f32_16x16x32_bf16 v[156:159], a[0:3], v[116:119], v[156:159]
  buffer_load_dwordx4 v6, s[8:11], s48 offen offset:0 nt lds
  v_mfma_f32_16x16x32_bf16 v[148:151], v[192:195], v[116:119], 0
  ds_read_b64_tr_b16 a[146:147], v180 offset:6144
  ds_read_b64_tr_b16 a[148:149], v180 offset:8
  v_mfma_f32_16x16x32_bf16 v[148:151], v[204:207], v[124:127], v[148:151]
  ds_read_b64_tr_b16 a[150:151], v180 offset:6152
  v_mfma_f32_16x16x32_bf16 v[148:151], v[216:219], v[120:123], v[148:151]
  v_cvt_pk_bf16_f32 v76, v156, v157
  v_cvt_pk_bf16_f32 v77, v158, v159
  v_mfma_f32_16x16x32_bf16 v[148:151], v[228:231], v[128:131], v[148:151]
  s_add_u32 m0, s33, 49024
  ds_read_b64_tr_b16 a[152:153], v181 offset:0
  v_mfma_f32_16x16x32_bf16 v[148:151], v[240:243], v[132:135], v[148:151]
  buffer_load_dwordx4 v6, s[8:11], s48 offen offset:128 nt lds
  v_mfma_f32_16x16x32_bf16 v[148:151], v[252:255], v[140:143], v[148:151]
  ds_read_b64_tr_b16 a[154:155], v181 offset:6144
  ds_read_b64_tr_b16 a[156:157], v181 offset:8
  v_mfma_f32_16x16x32_bf16 v[156:159], v[248:251], v[140:143], 0
  ds_read_b64_tr_b16 a[158:159], v181 offset:6152
  v_mfma_f32_16x16x32_bf16 v[156:159], v[236:239], v[132:135], v[156:159]
  s_add_u32 m0, s33, 57088
  ds_read_b64_tr_b16 a[160:161], v180 offset:12288
  v_mfma_f32_16x16x32_bf16 v[156:159], v[224:227], v[128:131], v[156:159]
  v_cvt_pk_bf16_f32 v68, v148, v149
  v_cvt_pk_bf16_f32 v69, v150, v151
  v_mfma_f32_16x16x32_bf16 v[156:159], v[212:215], v[120:123], v[156:159]
  buffer_load_dwordx4 v6, s[8:11], s48 offen offset:256 nt lds
  v_mfma_f32_16x16x32_bf16 v[156:159], v[200:203], v[124:127], v[156:159]
  ds_read_b64_tr_b16 a[162:163], v180 offset:18432
  ds_read_b64_tr_b16 a[164:165], v180 offset:12296
  v_mfma_f32_16x16x32_bf16 v[156:159], v[188:191], v[116:119], v[156:159]
  ds_read_b64_tr_b16 a[166:167], v180 offset:18440
  v_mfma_f32_16x16x32_bf16 v[148:151], v[184:187], v[116:119], 0
  ds_read_b64_tr_b16 a[168:169], v181 offset:12288
  ds_read_b64_tr_b16 a[170:171], v181 offset:18432
  v_mfma_f32_16x16x32_bf16 v[148:151], v[196:199], v[124:127], v[148:151]
  s_add_u32 m0, s33, 45056
  ds_read_b64_tr_b16 a[172:173], v181 offset:12296
  v_mfma_f32_16x16x32_bf16 v[148:151], v[208:211], v[120:123], v[148:151]
  v_cvt_pk_bf16_f32 v66, v156, v157
  v_cvt_pk_bf16_f32 v67, v158, v159
  v_mfma_f32_16x16x32_bf16 v[148:151], v[220:223], v[128:131], v[148:151]
  buffer_load_dwordx4 v6, s[8:11], s49 offen offset:0 nt lds
  v_mfma_f32_16x16x32_bf16 v[148:151], v[232:235], v[132:135], v[148:151]
  ds_read_b64_tr_b16 a[174:175], v181 offset:18440
  v_mfma_f32_16x16x32_bf16 v[148:151], v[244:247], v[140:143], v[148:151]
  ds_read_b64_tr_b16 a[176:177], v180 offset:24576
  v_mfma_f32_16x16x32_bf16 v[168:171], v[244:247], v[172:175], 0
  s_add_u32 m0, s33, 53120
  ds_read_b64_tr_b16 a[178:179], v180 offset:30720
  v_mfma_f32_16x16x32_bf16 v[168:171], v[232:235], v[164:167], v[168:171]
  s_waitcnt vmcnt(4)
  s_barrier
  v_mfma_f32_16x16x32_bf16 v[168:171], v[220:223], v[160:163], v[168:171]
  v_cvt_pk_bf16_f32 v64, v148, v149
  v_cvt_pk_bf16_f32 v65, v150, v151
  v_mfma_f32_16x16x32_bf16 v[168:171], v[208:211], v[152:155], v[168:171]
  buffer_load_dwordx4 v6, s[8:11], s49 offen offset:128 nt lds
  v_mfma_f32_16x16x32_bf16 v[168:171], v[196:199], v[144:147], v[168:171]
  ds_read_b64_tr_b16 a[180:181], v180 offset:24584
  ds_read_b64_tr_b16 a[182:183], v180 offset:30728
  v_mfma_f32_16x16x32_bf16 v[168:171], v[184:187], v[136:139], v[168:171]
  s_add_u32 m0, s33, 61184
  ds_read_b64_tr_b16 a[184:185], v181 offset:24576
  v_mfma_f32_16x16x32_bf16 v[176:179], v[188:191], v[136:139], 0
  buffer_load_dwordx4 v6, s[8:11], s49 offen offset:256 nt lds
  v_mfma_f32_16x16x32_bf16 v[176:179], v[200:203], v[144:147], v[176:179]
  ds_read_b64_tr_b16 a[186:187], v181 offset:30720
  s_add_u32 s48, s48, 6291456
  v_mfma_f32_16x16x32_bf16 v[176:179], v[212:215], v[152:155], v[176:179]
  v_cvt_pk_bf16_f32 v70, v168, v169
  v_cvt_pk_bf16_f32 v71, v170, v171
  v_mfma_f32_16x16x32_bf16 v[176:179], v[224:227], v[160:163], v[176:179]
  ds_read_b64_tr_b16 a[188:189], v181 offset:24584
  ds_read_b64_tr_b16 a[190:191], v181 offset:30728
  v_mfma_f32_16x16x32_bf16 v[176:179], v[236:239], v[164:167], v[176:179]
  ds_read_b64_tr_b16 a[192:193], v180 offset:36864
  s_add_u32 s49, s48, 786432
  v_mfma_f32_16x16x32_bf16 v[176:179], v[248:251], v[172:175], v[176:179]
  ds_read_b64_tr_b16 a[194:195], v180 offset:43008
  ds_read_b64_tr_b16 a[196:197], v180 offset:36872
  v_mfma_f32_16x16x32_bf16 v[168:171], v[252:255], v[172:175], 0
  ds_read_b64_tr_b16 a[198:199], v180 offset:43016
  v_mfma_f32_16x16x32_bf16 v[168:171], v[240:243], v[164:167], v[168:171]
  ds_read_b64_tr_b16 a[200:201], v181 offset:36864
  v_mfma_f32_16x16x32_bf16 v[168:171], v[228:231], v[160:163], v[168:171]
  v_cvt_pk_bf16_f32 v72, v176, v177
  v_cvt_pk_bf16_f32 v73, v178, v179
  v_mfma_f32_16x16x32_bf16 v[168:171], v[216:219], v[152:155], v[168:171]
  ds_read_b64_tr_b16 a[202:203], v181 offset:43008
  v_mfma_f32_16x16x32_bf16 v[168:171], v[204:207], v[144:147], v[168:171]
  ds_read_b64_tr_b16 a[204:205], v181 offset:36872
  v_mfma_f32_16x16x32_bf16 v[168:171], v[192:195], v[136:139], v[168:171]
  ds_read_b64_tr_b16 a[206:207], v181 offset:43016
  v_mfma_f32_16x16x32_bf16 v[176:179], a[0:3], v[136:139], 0
  ds_read_b64_tr_b16 a[208:209], v182 offset:0
  v_mfma_f32_16x16x32_bf16 v[176:179], a[12:15], v[144:147], v[176:179]
  ds_read_b64_tr_b16 a[210:211], v182 offset:1536
  v_mfma_f32_16x16x32_bf16 v[176:179], a[24:27], v[152:155], v[176:179]
  v_cvt_pk_bf16_f32 v74, v168, v169
  v_cvt_pk_bf16_f32 v75, v170, v171
  v_mfma_f32_16x16x32_bf16 v[176:179], a[36:39], v[160:163], v[176:179]
  ds_read_b64_tr_b16 a[212:213], v182 offset:8
  v_mfma_f32_16x16x32_bf16 v[176:179], a[48:51], v[164:167], v[176:179]
  ds_read_b64_tr_b16 a[214:215], v182 offset:1544
  v_mfma_f32_16x16x32_bf16 v[176:179], a[60:63], v[172:175], v[176:179]
  ds_read_b64_tr_b16 a[216:217], v183 offset:0
  v_mfma_f32_16x16x32_bf16 v[168:171], a[64:67], v[172:175], 0
  ds_read_b64_tr_b16 a[218:219], v183 offset:1536
  v_mfma_f32_16x16x32_bf16 v[168:171], a[52:55], v[164:167], v[168:171]
  ds_read_b64_tr_b16 a[220:221], v183 offset:8
  v_mfma_f32_16x16x32_bf16 v[168:171], a[40:43], v[160:163], v[168:171]
  v_cvt_pk_bf16_f32 v82, v176, v177
  v_cvt_pk_bf16_f32 v83, v178, v179
  v_mfma_f32_16x16x32_bf16 v[168:171], a[28:31], v[152:155], v[168:171]
  ds_read_b64_tr_b16 a[222:223], v183 offset:1544
  v_mfma_f32_16x16x32_bf16 v[168:171], a[16:19], v[144:147], v[168:171]
  ds_read_b64_tr_b16 a[224:225], v182 offset:12288
  v_mfma_f32_16x16x32_bf16 v[168:171], a[4:7], v[136:139], v[168:171]
  ds_read_b64_tr_b16 a[226:227], v182 offset:13824
  v_mfma_f32_16x16x32_bf16 v[176:179], a[8:11], v[136:139], 0
  ds_read_b64_tr_b16 a[228:229], v182 offset:12296
  v_mfma_f32_16x16x32_bf16 v[176:179], a[20:23], v[144:147], v[176:179]
  ds_read_b64_tr_b16 a[230:231], v182 offset:13832
  v_mfma_f32_16x16x32_bf16 v[176:179], a[32:35], v[152:155], v[176:179]
  v_cvt_pk_bf16_f32 v84, v168, v169
  v_cvt_pk_bf16_f32 v85, v170, v171
  v_mfma_f32_16x16x32_bf16 v[176:179], a[44:47], v[160:163], v[176:179]
  ds_read_b64_tr_b16 a[232:233], v183 offset:12288
  v_mfma_f32_16x16x32_bf16 v[176:179], a[56:59], v[164:167], v[176:179]
  ds_read_b64_tr_b16 a[234:235], v183 offset:13824
  v_mfma_f32_16x16x32_bf16 v[176:179], a[68:71], v[172:175], v[176:179]
  ds_read_b64_tr_b16 a[236:237], v183 offset:12296
  v_mfma_f32_16x16x32_bf16 v[168:171], v[172:175], a[132:135], 0
  ds_read_b64_tr_b16 a[238:239], v183 offset:13832
  v_mfma_f32_16x16x32_bf16 v[168:171], v[164:167], a[120:123], v[168:171]
  v_mfma_f32_16x16x32_bf16 v[168:171], v[160:163], a[108:111], v[168:171]
  v_cvt_pk_bf16_f32 v86, v176, v177
  v_cvt_pk_bf16_f32 v87, v178, v179
  v_mfma_f32_16x16x32_bf16 v[168:171], v[152:155], a[96:99], v[168:171]
  v_mfma_f32_16x16x32_bf16 v[168:171], v[144:147], a[84:87], v[168:171]
  v_mfma_f32_16x16x32_bf16 v[168:171], v[136:139], a[72:75], v[168:171]
  v_mfma_f32_16x16x32_bf16 v[176:179], v[136:139], a[76:79], 0
  s_waitcnt lgkmcnt(0)
  s_waitcnt vmcnt(24)
  s_barrier
  v_mfma_f32_16x16x32_bf16 v[176:179], v[144:147], a[88:91], v[176:179]
  v_mfma_f32_16x16x32_bf16 v[176:179], v[152:155], a[100:103], v[176:179]
  v_cvt_pk_bf16_f32 v22, v168, v169
  v_cvt_pk_bf16_f32 v23, v170, v171
  v_mfma_f32_16x16x32_bf16 v[176:179], v[160:163], a[112:115], v[176:179]
  ds_read_b128 a[244:247], v3 offset:0
  v_mfma_f32_16x16x32_bf16 v[176:179], v[164:167], a[124:127], v[176:179]
  ds_read_b128 a[248:251], v3 offset:4096
  v_mfma_f32_16x16x32_bf16 v[176:179], v[172:175], a[136:139], v[176:179]
  ds_read_b128 a[252:255], v3 offset:8192
  v_mfma_f32_16x16x32_bf16 v[168:171], v[172:175], a[140:143], 0
  ds_read_b128 v[180:183], v3 offset:12288
  v_mfma_f32_16x16x32_bf16 v[168:171], v[164:167], a[128:131], v[168:171]
  v_mfma_f32_16x16x32_bf16 v[168:171], v[160:163], a[116:119], v[168:171]
  v_cvt_pk_bf16_f32 v30, v176, v177
  v_cvt_pk_bf16_f32 v31, v178, v179
  v_mfma_f32_16x16x32_bf16 v[168:171], v[152:155], a[104:107], v[168:171]
  s_cmp_lg_u32 s31, 0
  v_mfma_f32_16x16x32_bf16 v[168:171], v[144:147], a[92:95], v[168:171]
  v_mfma_f32_16x16x32_bf16 v[168:171], v[136:139], a[80:83], v[168:171]
  s_cbranch_scc0 L_s
  s_branch L_special
.fill (0x4000 - 768 + standalone__window_attn_swin__vision_kernel - .) / 4, 4, 0xbf810000
L_hop3:
  s_branch L_hopped
  s_nop 0
L_s:
  v_mfma_f32_16x16x32_bf16 v[116:119], v[46:49], v[70:73], v[112:115]
  v_mfma_f32_16x16x32_bf16 v[124:127], v[58:61], v[70:73], v[108:111]
  v_mfma_f32_16x16x32_bf16 v[120:123], v[76:79], v[70:73], v[104:107]
  v_cvt_pk_bf16_f32 v38, v168, v169
  v_cvt_pk_bf16_f32 v39, v170, v171
  v_mfma_f32_16x16x32_bf16 v[128:131], v[82:85], v[70:73], v[100:103]
  v_mfma_f32_16x16x16_bf16 v[116:119], v[50:51], v[74:75], v[116:119]
  v_mfma_f32_16x16x16_bf16 v[124:127], v[62:63], v[74:75], v[124:127]
  v_mfma_f32_16x16x16_bf16 v[120:123], v[80:81], v[74:75], v[120:123]
  v_mfma_f32_16x16x16_bf16 v[128:131], v[86:87], v[74:75], v[128:131]
  v_exp_f32 v116, v116
  v_mfma_f32_16x16x16_bf16 v[144:147], v[86:87], v[68:69], v[96:99]
  v_exp_f32 v117, v117
  v_mfma_f32_16x16x16_bf16 v[136:139], v[80:81], v[68:69], v[100:103]
  v_exp_f32 v118, v118
  v_mfma_f32_16x16x16_bf16 v[140:143], v[62:63], v[68:69], v[104:107]
  v_exp_f32 v119, v119
  v_mfma_f32_16x16x16_bf16 v[132:135], v[50:51], v[68:69], v[108:111]
  v_cvt_pk_bf16_f32 v116, v116, v117
  v_cvt_pk_bf16_f32 v117, v118, v119
  v_mfma_f32_16x16x16_bf16 v[148:151], v[50:51], v[56:57], v[104:107]
  v_exp_f32 v124, v124
  v_mfma_f32_16x16x16_bf16 v[156:159], v[62:63], v[56:57], v[100:103]
  v_exp_f32 v125, v125
  v_mfma_f32_16x16x16_bf16 v[152:155], v[80:81], v[56:57], v[96:99]
  v_exp_f32 v126, v126
  v_mfma_f32_16x16x16_bf16 v[160:163], v[86:87], v[56:57], v[92:95]
  v_exp_f32 v127, v127
  v_mfma_f32_16x16x16_bf16 v[176:179], v[86:87], v[44:45], v[88:91]
  v_cvt_pk_bf16_f32 v118, v124, v125
  v_cvt_pk_bf16_f32 v119, v126, v127
  v_mfma_f32_16x16x16_bf16 v[168:171], v[80:81], v[44:45], v[92:95]
  v_exp_f32 v120, v120
  v_mfma_f32_16x16x16_bf16 v[172:175], v[62:63], v[44:45], v[96:99]
  v_exp_f32 v121, v121
  v_mfma_f32_16x16x16_bf16 v[164:167], v[50:51], v[44:45], v[100:103]
  v_exp_f32 v122, v122
  v_mfma_f32_16x16x32_bf16 v[132:135], v[46:49], v[64:67], v[132:135]
  v_exp_f32 v123, v123
  v_mfma_f32_16x16x32_bf16 v[140:143], v[58:61], v[64:67], v[140:143]
  v_cvt_pk_bf16_f32 v120, v120, v121
  v_cvt_pk_bf16_f32 v121, v122, v123
  v_mfma_f32_16x16x32_bf16 v[136:139], v[76:79], v[64:67], v[136:139]
  v_exp_f32 v128, v128
  v_mfma_f32_16x16x32_bf16 v[144:147], v[82:85], v[64:67], v[144:147]
  ds_read_b128 v[64:67], v3 offset:16384
  ds_read_b128 v[68:71], v3 offset:20480
  v_mfma_f32_16x16x32_bf16 v[160:163], v[82:85], v[52:55], v[160:163]
  v_exp_f32 v129, v129
  v_mfma_f32_16x16x32_bf16 v[152:155], v[76:79], v[52:55], v[152:155]
  v_exp_f32 v130, v130
  v_mfma_f32_16x16x32_bf16 v[156:159], v[58:61], v[52:55], v[156:159]
  v_exp_f32 v131, v131
  v_mfma_f32_16x16x32_bf16 v[148:151], v[46:49], v[52:55], v[148:151]
  v_cvt_pk_bf16_f32 v122, v128, v129
  v_cvt_pk_bf16_f32 v123, v130, v131
  v_mfma_f32_16x16x32_bf16 v[164:167], v[46:49], v[40:43], v[164:167]
  v_exp_f32 v132, v132
  v_mfma_f32_16x16x32_bf16 v[172:175], v[58:61], v[40:43], v[172:175]
  v_exp_f32 v133, v133
  v_mfma_f32_16x16x32_bf16 v[168:171], v[76:79], v[40:43], v[168:171]
  v_exp_f32 v134, v134
  v_mfma_f32_16x16x32_bf16 v[176:179], v[82:85], v[40:43], v[176:179]
  s_waitcnt lgkmcnt(0)
  v_cvt_pk_bf16_f32 v132, v132, v133
L_pj:
  v_mfma_f32_16x16x32_bf16 v[40:43], a[144:147], a[244:247], 0
  ds_read_b128 v[72:75], v3 offset:256
  ds_read_b128 v[56:59], v3 offset:4352
  v_mfma_f32_16x16x32_bf16 v[40:43], a[160:163], a[248:251], v[40:43]
  v_exp_f32 v135, v135
  v_mfma_f32_16x16x32_bf16 v[40:43], a[176:179], a[252:255], v[40:43]
  ds_read_b128 v[60:63], v3 offset:8448
  ds_read_b128 v[76:79], v3 offset:12544
  v_mfma_f32_16x16x32_bf16 v[40:43], a[192:195], v[180:183], v[40:43]
  v_exp_f32 v140, v140
  v_mfma_f32_16x16x32_bf16 v[40:43], a[208:211], v[64:67], v[40:43]
  ds_read_b128 v[80:83], v3 offset:16640
  ds_read_b128 v[84:87], v3 offset:20736
  v_mfma_f32_16x16x32_bf16 v[40:43], a[224:227], v[68:71], v[40:43]
  v_exp_f32 v141, v141
  v_mfma_f32_16x16x32_bf16 v[44:47], a[228:231], v[68:71], 0
  v_cvt_pk_bf16_f32 v133, v134, v135
  v_cvt_pk_bf16_f32 v134, v140, v141
  v_mfma_f32_16x16x32_bf16 v[44:47], a[212:215], v[64:67], v[44:47]
  v_exp_f32 v142, v142
  v_mfma_f32_16x16x32_bf16 v[44:47], a[196:199], v[180:183], v[44:47]
  v_cvt_pk_bf16_f32 v40, v40, v41
  v_cvt_pk_bf16_f32 v41, v42, v43
  v_mfma_f32_16x16x32_bf16 v[44:47], a[180:183], a[252:255], v[44:47]
  ds_read_b128 v[124:127], v2 offset:512
  ds_read_b128 v[128:131], v2 offset:4608
  v_mfma_f32_16x16x32_bf16 v[44:47], a[164:167], a[248:251], v[44:47]
  v_exp_f32 v143, v143
  v_mfma_f32_16x16x32_bf16 v[44:47], a[148:151], a[244:247], v[44:47]
  s_waitcnt lgkmcnt(2)
  v_cvt_pk_bf16_f32 v135, v142, v143
  v_mfma_f32_16x16x32_bf16 v[48:51], a[144:147], v[72:75], 0
  ds_read_b128 a[244:247], v2 offset:8704
  ds_read_b128 a[248:251], v2 offset:12800
  v_mfma_f32_16x16x32_bf16 v[48:51], a[160:163], v[56:59], v[48:51]
  v_exp_f32 v136, v136
  v_mfma_f32_16x16x32_bf16 v[48:51], a[176:179], v[60:63], v[48:51]
  v_cvt_pk_bf16_f32 v42, v44, v45
  v_cvt_pk_bf16_f32 v43, v46, v47
  v_mfma_f32_16x16x32_bf16 v[48:51], a[192:195], v[76:79], v[48:51]
  buffer_store_dwordx4 v[40:43], v7, s[24:27], s40 offen nt
  v_mfma_f32_16x16x32_bf16 v[48:51], a[208:211], v[80:83], v[48:51]
  ds_read_b128 a[252:255], v2 offset:16896
  ds_read_b128 v[180:183], v2 offset:20992
  v_mfma_f32_16x16x32_bf16 v[48:51], a[224:227], v[84:87], v[48:51]
  v_exp_f32 v137, v137
  v_mfma_f32_16x16x32_bf16 v[52:55], a[228:231], v[84:87], 0
  v_exp_f32 v138, v138
  v_mfma_f32_16x16x32_bf16 v[52:55], a[212:215], v[80:83], v[52:55]
  v_exp_f32 v139, v139
  v_mfma_f32_16x16x32_bf16 v[52:55], a[196:199], v[76:79], v[52:55]
  v_cvt_pk_bf16_f32 v48, v48, v49
  v_cvt_pk_bf16_f32 v49, v50, v51
  v_mfma_f32_16x16x32_bf16 v[52:55], a[180:183], v[60:63], v[52:55]
  v_cvt_pk_bf16_f32 v136, v136, v137
  v_cvt_pk_bf16_f32 v137, v138, v139
  v_mfma_f32_16x16x32_bf16 v[52:55], a[164:167], v[56:59], v[52:55]
  v_exp_f32 v144, v144
  v_mfma_f32_16x16x32_bf16 v[52:55], a[148:151], v[72:75], v[52:55]
  s_waitcnt lgkmcnt(0)
  v_mfma_f32_16x16x32_bf16 v[40:43], a[144:147], v[124:127], 0
  v_exp_f32 v145, v145
  v_mfma_f32_16x16x32_bf16 v[40:43], a[160:163], v[128:131], v[40:43]
  v_exp_f32 v146, v146
  v_mfma_f32_16x16x32_bf16 v[40:43], a[176:179], a[244:247], v[40:43]
  v_cvt_pk_bf16_f32 v50, v52, v53
  v_cvt_pk_bf16_f32 v51, v54, v55
  v_mfma_f32_16x16x32_bf16 v[40:43], a[192:195], a[248:251], v[40:43]
  buffer_store_dwordx4 v[48:51], v7, s[24:27], s41 offen nt
  v_mfma_f32_16x16x32_bf16 v[40:43], a[208:211], a[252:255], v[40:43]
  ds_read_b128 v[72:75], v2 offset:768
  ds_read_b128 v[56:59], v2 offset:4864
  v_mfma_f32_16x16x32_bf16 v[40:43], a[224:227], v[180:183], v[40:43]
  v_exp_f32 v147, v147
  v_mfma_f32_16x16x32_bf16 v[44:47], a[228:231], v[180:183], 0
  ds_read_b128 v[60:63], v2 offset:8960
  ds_read_b128 v[76:79], v2 offset:13056
  v_mfma_f32_16x16x32_bf16 v[44:47], a[212:215], a[252:255], v[44:47]
  v_cvt_pk_bf16_f32 v138, v144, v145
  v_cvt_pk_bf16_f32 v139, v146, v147
  v_mfma_f32_16x16x32_bf16 v[44:47], a[196:199], a[248:251], v[44:47]
  v_cvt_pk_bf16_f32 v40, v40, v41
  v_cvt_pk_bf16_f32 v41, v42, v43
  v_mfma_f32_16x16x32_bf16 v[44:47], a[180:183], a[244:247], v[44:47]
  ds_read_b128 v[80:83], v2 offset:17152
  ds_read_b128 v[84:87], v2 offset:21248
  v_mfma_f32_16x16x32_bf16 v[44:47], a[164:167], v[128:131], v[44:47]
  v_exp_f32 v148, v148
  v_mfma_f32_16x16x32_bf16 v[44:47], a[148:151], v[124:127], v[44:47]
  v_exp_f32 v149, v149
  v_mfma_f32_16x16x32_bf16 v[48:51], a[152:155], v[124:127], 0
  v_mov_b64 v[144:145], 0
  v_cvt_pk_bf16_f32 v148, v148, v149
  v_mfma_f32_16x16x32_bf16 v[48:51], a[168:171], v[128:131], v[48:51]
  v_exp_f32 v150, v150
  v_mfma_f32_16x16x32_bf16 v[48:51], a[184:187], a[244:247], v[48:51]
  v_cvt_pk_bf16_f32 v42, v44, v45
  v_cvt_pk_bf16_f32 v43, v46, v47
  v_mfma_f32_16x16x32_bf16 v[48:51], a[200:203], a[248:251], v[48:51]
  buffer_store_dwordx4 v[40:43], v7, s[24:27], s42 offen nt
  v_mfma_f32_16x16x32_bf16 v[48:51], a[216:219], a[252:255], v[48:51]
  v_exp_f32 v151, v151
  v_mfma_f32_16x16x32_bf16 v[48:51], a[232:235], v[180:183], v[48:51]
  v_exp_f32 v156, v156
  v_mfma_f32_16x16x32_bf16 v[52:55], a[236:239], v[180:183], 0
  v_exp_f32 v157, v157
  v_mfma_f32_16x16x32_bf16 v[52:55], a[220:223], a[252:255], v[52:55]
  v_cvt_pk_bf16_f32 v149, v150, v151
  v_cvt_pk_bf16_f32 v150, v156, v157
  v_mfma_f32_16x16x32_bf16 v[52:55], a[204:207], a[248:251], v[52:55]
  v_cvt_pk_bf16_f32 v48, v48, v49
  v_cvt_pk_bf16_f32 v49, v50, v51
  v_mfma_f32_16x16x32_bf16 v[52:55], a[188:191], a[244:247], v[52:55]
  v_exp_f32 v158, v158
  v_mfma_f32_16x16x32_bf16 v[52:55], a[172:175], v[128:131], v[52:55]
  v_exp_f32 v159, v159
  v_mfma_f32_16x16x32_bf16 v[52:55], a[156:159], v[124:127], v[52:55]
  s_waitcnt lgkmcnt(0)
  v_cvt_pk_bf16_f32 v151, v158, v159
  v_mfma_f32_16x16x32_bf16 v[40:43], a[144:147], v[72:75], 0
  v_exp_f32 v152, v152
  v_mfma_f32_16x16x32_bf16 v[40:43], a[160:163], v[56:59], v[40:43]
  v_exp_f32 v153, v153
  v_mfma_f32_16x16x32_bf16 v[40:43], a[176:179], v[60:63], v[40:43]
  v_cvt_pk_bf16_f32 v50, v52, v53
  v_cvt_pk_bf16_f32 v51, v54, v55
  v_mfma_f32_16x16x32_bf16 v[40:43], a[192:195], v[76:79], v[40:43]
  buffer_store_dwordx4 v[48:51], v8, s[24:27], s42 offen nt
  v_mfma_f32_16x16x32_bf16 v[40:43], a[208:211], v[80:83], v[40:43]
  v_exp_f32 v154, v154
  v_mfma_f32_16x16x32_bf16 v[40:43], a[224:227], v[84:87], v[40:43]
  v_exp_f32 v155, v155
  v_mfma_f32_16x16x32_bf16 v[44:47], a[228:231], v[84:87], 0
  v_cvt_pk_bf16_f32 v152, v152, v153
  v_cvt_pk_bf16_f32 v153, v154, v155
  v_mfma_f32_16x16x32_bf16 v[44:47], a[212:215], v[80:83], v[44:47]
  v_exp_f32 v160, v160
  v_mfma_f32_16x16x32_bf16 v[44:47], a[196:199], v[76:79], v[44:47]
  v_cvt_pk_bf16_f32 v40, v40, v41
  v_cvt_pk_bf16_f32 v41, v42, v43
  v_mfma_f32_16x16x32_bf16 v[44:47], a[180:183], v[60:63], v[44:47]
  v_exp_f32 v161, v161
  v_mfma_f32_16x16x32_bf16 v[44:47], a[164:167], v[56:59], v[44:47]
  v_exp_f32 v162, v162
  v_mfma_f32_16x16x32_bf16 v[44:47], a[148:151], v[72:75], v[44:47]
  v_exp_f32 v163, v163
  v_mfma_f32_16x16x32_bf16 v[48:51], a[152:155], v[72:75], 0
  v_cvt_pk_bf16_f32 v154, v160, v161
  v_cvt_pk_bf16_f32 v155, v162, v163
  v_mfma_f32_16x16x32_bf16 v[48:51], a[168:171], v[56:59], v[48:51]
  v_exp_f32 v164, v164
  v_mfma_f32_16x16x32_bf16 v[48:51], a[184:187], v[60:63], v[48:51]
  v_cvt_pk_bf16_f32 v42, v44, v45
  v_cvt_pk_bf16_f32 v43, v46, v47
  v_mfma_f32_16x16x32_bf16 v[48:51], a[200:203], v[76:79], v[48:51]
  buffer_store_dwordx4 v[40:43], v7, s[24:27], s43 offen nt
  v_mfma_f32_16x16x32_bf16 v[48:51], a[216:219], v[80:83], v[48:51]
  v_exp_f32 v165, v165
  v_mfma_f32_16x16x32_bf16 v[48:51], a[232:235], v[84:87], v[48:51]
  v_exp_f32 v166, v166
  v_mfma_f32_16x16x32_bf16 v[52:55], a[236:239], v[84:87], 0
  v_exp_f32 v167, v167
  v_mfma_f32_16x16x32_bf16 v[52:55], a[220:223], v[80:83], v[52:55]
  v_cvt_pk_bf16_f32 v164, v164, v165
  v_cvt_pk_bf16_f32 v165, v166, v167
  v_mfma_f32_16x16x32_bf16 v[52:55], a[204:207], v[76:79], v[52:55]
  v_cvt_pk_bf16_f32 v48, v48, v49
  v_cvt_pk_bf16_f32 v49, v50, v51
  v_mfma_f32_16x16x32_bf16 v[52:55], a[188:191], v[60:63], v[52:55]
  v_exp_f32 v172, v172
  v_mfma_f32_16x16x32_bf16 v[52:55], a[172:175], v[56:59], v[52:55]
  v_exp_f32 v173, v173
  v_mfma_f32_16x16x32_bf16 v[52:55], a[156:159], v[72:75], v[52:55]
  v_exp_f32 v174, v174
  v_smfmac_f32_16x16x64_bf16 v[144:147], a[240:243], v[116:123], v10
  v_exp_f32 v175, v175
  v_mfma_f32_16x16x32_bf16 v[124:127], v[20:23], v[120:123], 0
  v_cvt_pk_bf16_f32 v166, v172, v173
  v_cvt_pk_bf16_f32 v167, v174, v175
  v_mfma_f32_16x16x32_bf16 v[124:127], v[16:19], v[116:119], v[124:127]
  v_cvt_pk_bf16_f32 v50, v52, v53
  v_cvt_pk_bf16_f32 v51, v54, v55
  v_mfma_f32_16x16x32_bf16 v[128:131], v[24:27], v[116:119], 0
  v_add_f32 v15, v144, v145
  v_mov_b64 v[144:145], 0
  v_mfma_f32_16x16x32_bf16 v[128:131], v[28:31], v[120:123], v[128:131]
  buffer_store_dwordx4 v[48:51], v8, s[24:27], s43 offen nt
  v_mfma_f32_16x16x32_bf16 v[140:143], v[36:39], v[120:123], 0
  v_exp_f32 v168, v168
  v_mfma_f32_16x16x32_bf16 v[140:143], v[32:35], v[116:119], v[140:143]
  v_exp_f32 v169, v169
  v_smfmac_f32_16x16x64_bf16 v[144:147], a[240:243], v[132:139], v10
  v_exp_f32 v170, v170
  v_mfma_f32_16x16x32_bf16 v[116:119], v[20:23], v[136:139], 0
  v_exp_f32 v171, v171
  v_mfma_f32_16x16x32_bf16 v[116:119], v[16:19], v[132:135], v[116:119]
  v_cvt_pk_bf16_f32 v168, v168, v169
  v_cvt_pk_bf16_f32 v169, v170, v171
  v_mfma_f32_16x16x32_bf16 v[120:123], v[24:27], v[132:135], 0
  v_add_f32 v14, v144, v145
  v_mov_b64 v[144:145], 0
  v_mfma_f32_16x16x32_bf16 v[120:123], v[28:31], v[136:139], v[120:123]
  v_exp_f32 v176, v176
  v_mfma_f32_16x16x32_bf16 v[156:159], v[36:39], v[136:139], 0
  v_exp_f32 v177, v177
  v_mfma_f32_16x16x32_bf16 v[156:159], v[32:35], v[132:135], v[156:159]
  v_exp_f32 v178, v178
  v_smfmac_f32_16x16x64_bf16 v[144:147], a[240:243], v[148:155], v10
  v_exp_f32 v179, v179
  v_mfma_f32_16x16x32_bf16 v[132:135], v[20:23], v[152:155], 0
  v_cvt_pk_bf16_f32 v170, v176, v177
  v_cvt_pk_bf16_f32 v171, v178, v179
  v_mfma_f32_16x16x32_bf16 v[132:135], v[16:19], v[148:151], v[132:135]
  v_max3_f32 v9, v14, v15, v9
  v_mfma_f32_16x16x32_bf16 v[136:139], v[24:27], v[148:151], 0
  v_add_f32 v13, v144, v145
  v_mov_b64 v[144:145], 0
  v_mfma_f32_16x16x32_bf16 v[136:139], v[28:31], v[152:155], v[136:139]
  ds_read_b128 a[244:247], v0 offset:0
  ds_read_b128 a[248:251], v1 offset:0
  v_mfma_f32_16x16x32_bf16 v[160:163], v[36:39], v[152:155], 0
  v_rcp_f32 v15, v15
  v_mfma_f32_16x16x32_bf16 v[160:163], v[32:35], v[148:151], v[160:163]
  ds_read_b128 a[252:255], v0 offset:8192
  ds_read_b128 v[180:183], v1 offset:8192
  v_smfmac_f32_16x16x64_bf16 v[144:147], a[240:243], v[164:171], v10
  v_rcp_f32 v14, v14
  v_mfma_f32_16x16x32_bf16 v[148:151], v[20:23], v[168:171], 0
  ds_read_b128 v[64:67], v0 offset:16384
  ds_read_b128 v[68:71], v1 offset:16384
  v_mfma_f32_16x16x32_bf16 v[148:151], v[16:19], v[164:167], v[148:151]
  v_mul_f32 v124, v15, v124
  v_mul_f32 v125, v15, v125
  v_mfma_f32_16x16x32_bf16 v[152:155], v[24:27], v[164:167], 0
  v_add_f32 v12, v144, v145
  v_mul_f32 v126, v15, v126
  v_mfma_f32_16x16x32_bf16 v[152:155], v[28:31], v[168:171], v[152:155]
  v_mul_f32 v127, v15, v127
  v_cvt_pk_bf16_f32 v124, v124, v125
  v_mfma_f32_16x16x32_bf16 v[172:175], v[36:39], v[168:171], 0
  s_waitcnt lgkmcnt(4)
  v_cvt_pk_bf16_f32 v125, v126, v127
  v_mfma_f32_16x16x32_bf16 v[172:175], v[32:35], v[164:167], v[172:175]
  s_cbranch_vccnz L_epi
  v_mfma_f32_16x16x32_bf16 v[76:79], a[244:247], a[80:83], 0
  ds_write_b32 v4, v124 offset:768
  v_mfma_f32_16x16x32_bf16 v[76:79], a[248:251], a[92:95], v[76:79]
  s_waitcnt lgkmcnt(3)
  v_mul_f32 v128, v15, v128
  v_mfma_f32_16x16x32_bf16 v[76:79], a[252:255], a[104:107], v[76:79]
  ds_write_b32 v4, v125 offset:772
  v_mfma_f32_16x16x32_bf16 v[76:79], v[180:183], a[116:119], v[76:79]
  s_waitcnt lgkmcnt(2)
  v_mul_f32 v129, v15, v129
  v_mfma_f32_16x16x32_bf16 v[76:79], v[64:67], a[128:131], v[76:79]
  v_mul_f32 v130, v15, v130
  v_mul_f32 v131, v15, v131
  v_mfma_f32_16x16x32_bf16 v[76:79], v[68:71], a[140:143], v[76:79]
  v_cvt_pk_bf16_f32 v128, v128, v129
  v_cvt_pk_bf16_f32 v129, v130, v131
  v_mfma_f32_16x16x32_bf16 v[80:83], v[68:71], a[136:139], 0
  ds_write_b32 v4, v128 offset:776
  v_mfma_f32_16x16x32_bf16 v[80:83], v[64:67], a[124:127], v[80:83]
  ds_write_b32 v4, v129 offset:780
  v_mfma_f32_16x16x32_bf16 v[80:83], v[180:183], a[112:115], v[80:83]
  v_cvt_pk_bf16_f32 v32, v76, v77
  v_cvt_pk_bf16_f32 v33, v78, v79
  v_mfma_f32_16x16x32_bf16 v[80:83], a[252:255], a[100:103], v[80:83]
  s_add_u32 m0, s33, 0
  v_mul_f32 v140, v15, v140
  v_mfma_f32_16x16x32_bf16 v[80:83], a[248:251], a[88:91], v[80:83]
  buffer_load_dwordx4 v6, s[8:11], s48 offen offset:0 nt lds
  v_mfma_f32_16x16x32_bf16 v[80:83], a[244:247], a[76:79], v[80:83]
  v_mul_f32 v141, v15, v141
  v_mul_f32 v142, v15, v142
  v_mfma_f32_16x16x32_bf16 v[76:79], a[244:247], a[72:75], 0
  v_mul_f32 v143, v15, v143
  v_cvt_pk_bf16_f32 v140, v140, v141
  v_mfma_f32_16x16x32_bf16 v[76:79], a[248:251], a[84:87], v[76:79]
  v_cvt_pk_bf16_f32 v141, v142, v143
  v_max3_f32 v9, v12, v13, v9
  v_mfma_f32_16x16x32_bf16 v[76:79], a[252:255], a[96:99], v[76:79]
  v_cvt_pk_bf16_f32 v24, v80, v81
  v_cvt_pk_bf16_f32 v25, v82, v83
  v_mfma_f32_16x16x32_bf16 v[76:79], v[180:183], a[108:111], v[76:79]
  ds_write_b32 v5, v140 offset:768
  v_mfma_f32_16x16x32_bf16 v[76:79], v[64:67], a[120:123], v[76:79]
  ds_write_b32 v5, v141 offset:772
  v_mfma_f32_16x16x32_bf16 v[76:79], v[68:71], a[132:135], v[76:79]
  v_rcp_f32 v13, v13
  v_mfma_f32_16x16x32_bf16 v[80:83], a[68:71], v[68:71], 0
  s_add_u32 m0, s33, 8064
  v_mul_f32 v116, v14, v116
  v_mfma_f32_16x16x32_bf16 v[80:83], a[56:59], v[64:67], v[80:83]
  buffer_load_dwordx4 v6, s[8:11], s48 offen offset:128 nt lds
  v_mfma_f32_16x16x32_bf16 v[80:83], a[44:47], v[180:183], v[80:83]
  v_cvt_pk_bf16_f32 v16, v76, v77
  v_cvt_pk_bf16_f32 v17, v78, v79
  v_mfma_f32_16x16x32_bf16 v[80:83], a[32:35], a[252:255], v[80:83]
  v_mul_f32 v117, v14, v117
  v_mul_f32 v118, v14, v118
  v_mfma_f32_16x16x32_bf16 v[80:83], a[20:23], a[248:251], v[80:83]
  v_mul_f32 v119, v14, v119
  v_cvt_pk_bf16_f32 v116, v116, v117
  v_mfma_f32_16x16x32_bf16 v[80:83], a[8:11], a[244:247], v[80:83]
  v_cvt_pk_bf16_f32 v117, v118, v119
  v_mul_f32 v120, v14, v120
  v_mfma_f32_16x16x32_bf16 v[76:79], a[4:7], a[244:247], 0
  ds_write_b32 v4, v116 offset:512
  v_mfma_f32_16x16x32_bf16 v[76:79], a[16:19], a[248:251], v[76:79]
  ds_write_b32 v4, v117 offset:516
  v_mfma_f32_16x16x32_bf16 v[76:79], a[28:31], a[252:255], v[76:79]
  v_cvt_pk_bf16_f32 v50, v80, v81
  v_cvt_pk_bf16_f32 v51, v82, v83
  v_mfma_f32_16x16x32_bf16 v[76:79], a[40:43], v[180:183], v[76:79]
  s_add_u32 m0, s33, 16128
  v_mul_f32 v121, v14, v121
  v_mfma_f32_16x16x32_bf16 v[76:79], a[52:55], v[64:67], v[76:79]
  buffer_load_dwordx4 v6, s[8:11], s48 offen offset:256 nt lds
  v_mfma_f32_16x16x32_bf16 v[76:79], a[64:67], v[68:71], v[76:79]
  v_mul_f32 v122, v14, v122
  v_mul_f32 v123, v14, v123
  v_mfma_f32_16x16x32_bf16 v[80:83], a[60:63], v[68:71], 0
  v_cvt_pk_bf16_f32 v120, v120, v121
  v_cvt_pk_bf16_f32 v121, v122, v123
  v_mfma_f32_16x16x32_bf16 v[80:83], a[48:51], v[64:67], v[80:83]
  ds_write_b32 v4, v120 offset:520
  v_mfma_f32_16x16x32_bf16 v[80:83], a[36:39], v[180:183], v[80:83]
  v_cvt_pk_bf16_f32 v48, v76, v77
  v_cvt_pk_bf16_f32 v49, v78, v79
  v_mfma_f32_16x16x32_bf16 v[80:83], a[24:27], a[252:255], v[80:83]
  ds_write_b32 v4, v121 offset:524
  v_mfma_f32_16x16x32_bf16 v[80:83], a[12:15], a[248:251], v[80:83]
  v_mul_f32 v156, v14, v156
  v_mul_f32 v157, v14, v157
  v_mfma_f32_16x16x32_bf16 v[80:83], a[0:3], a[244:247], v[80:83]
  v_mul_f32 v158, v14, v158
  v_mul_f32 v159, v14, v159
  v_mfma_f32_16x16x32_bf16 v[76:79], v[192:195], a[244:247], 0
  s_add_u32 m0, s33, 4096
  v_cvt_pk_bf16_f32 v156, v156, v157
  v_mfma_f32_16x16x32_bf16 v[76:79], v[204:207], a[248:251], v[76:79]
  buffer_load_dwordx4 v6, s[8:11], s49 offen offset:0 nt lds
  v_mfma_f32_16x16x32_bf16 v[76:79], v[216:219], a[252:255], v[76:79]
  v_cvt_pk_bf16_f32 v46, v80, v81
  v_cvt_pk_bf16_f32 v47, v82, v83
  v_mfma_f32_16x16x32_bf16 v[76:79], v[228:231], v[180:183], v[76:79]
  ds_read_b128 v[72:75], v0 offset:2048
  v_cvt_pk_bf16_f32 v157, v158, v159
  v_mfma_f32_16x16x32_bf16 v[76:79], v[240:243], v[64:67], v[76:79]
  ds_read_b128 v[84:87], v1 offset:2048
  v_mfma_f32_16x16x32_bf16 v[76:79], v[252:255], v[68:71], v[76:79]
  ds_read_b128 v[164:167], v0 offset:10240
  v_mfma_f32_16x16x32_bf16 v[80:83], v[248:251], v[68:71], 0
  ds_read_b128 v[168:171], v1 offset:10240
  v_mfma_f32_16x16x32_bf16 v[80:83], v[236:239], v[64:67], v[80:83]
  ds_read_b128 v[176:179], v0 offset:18432
  v_mfma_f32_16x16x32_bf16 v[80:83], v[224:227], v[180:183], v[80:83]
  v_cvt_pk_bf16_f32 v44, v76, v77
  v_cvt_pk_bf16_f32 v45, v78, v79
  v_mfma_f32_16x16x32_bf16 v[80:83], v[212:215], a[252:255], v[80:83]
  ds_read_b128 v[144:147], v1 offset:18432
  s_add_u32 m0, s33, 12160
  v_mfma_f32_16x16x32_bf16 v[80:83], v[200:203], a[248:251], v[80:83]
  buffer_load_dwordx4 v6, s[8:11], s49 offen offset:128 nt lds
  v_mfma_f32_16x16x32_bf16 v[80:83], v[188:191], a[244:247], v[80:83]
  ds_write_b32 v5, v156 offset:512
  v_mfma_f32_16x16x32_bf16 v[76:79], v[184:187], a[244:247], 0
  ds_write_b32 v5, v157 offset:516
  v_mfma_f32_16x16x32_bf16 v[76:79], v[196:199], a[248:251], v[76:79]
  v_rcp_f32 v12, v12
  v_mfma_f32_16x16x32_bf16 v[76:79], v[208:211], a[252:255], v[76:79]
  v_cvt_pk_bf16_f32 v42, v80, v81
  v_cvt_pk_bf16_f32 v43, v82, v83
  v_mfma_f32_16x16x32_bf16 v[76:79], v[220:223], v[180:183], v[76:79]
  v_mul_f32 v132, v13, v132
  v_mul_f32 v133, v13, v133
  v_mfma_f32_16x16x32_bf16 v[76:79], v[232:235], v[64:67], v[76:79]
  v_mul_f32 v134, v13, v134
  v_mul_f32 v135, v13, v135
  v_mfma_f32_16x16x32_bf16 v[76:79], v[244:247], v[68:71], v[76:79]
  s_waitcnt lgkmcnt(2)
  v_cvt_pk_bf16_f32 v132, v132, v133
  v_mfma_f32_16x16x32_bf16 v[80:83], v[244:247], v[144:147], 0
  s_add_u32 m0, s33, 20224
  v_cvt_pk_bf16_f32 v133, v134, v135
  v_mfma_f32_16x16x32_bf16 v[80:83], v[232:235], v[176:179], v[80:83]
  buffer_load_dwordx4 v6, s[8:11], s49 offen offset:256 nt lds
  v_mfma_f32_16x16x32_bf16 v[80:83], v[220:223], v[168:171], v[80:83]
  v_cvt_pk_bf16_f32 v40, v76, v77
  v_cvt_pk_bf16_f32 v41, v78, v79
  v_mfma_f32_16x16x32_bf16 v[80:83], v[208:211], v[164:167], v[80:83]
  s_waitcnt vmcnt(12)
  s_lshl2_add_u32 m0, s3, s47
  v_mfma_f32_16x16x32_bf16 v[80:83], v[196:199], v[84:87], v[80:83]
  ds_write_addtid_b32 v11
  v_mfma_f32_16x16x32_bf16 v[80:83], v[184:187], v[72:75], v[80:83]
  v_mov_b32 v11, 0
  v_mul_f32 v136, v13, v136
  v_mfma_f32_16x16x32_bf16 v[76:79], v[188:191], v[72:75], 0
  s_cmp_eq_u32 s44, s63
  v_mul_f32 v137, v13, v137
  v_mfma_f32_16x16x32_bf16 v[76:79], v[200:203], v[84:87], v[76:79]
  ds_write_b32 v4, v132 offset:256
  v_mfma_f32_16x16x32_bf16 v[76:79], v[212:215], v[164:167], v[76:79]
  v_cvt_pk_bf16_f32 v52, v80, v81
  v_cvt_pk_bf16_f32 v53, v82, v83
  v_mfma_f32_16x16x32_bf16 v[76:79], v[224:227], v[168:171], v[76:79]
  s_cbranch_scc1 L_cl0
L_cb0:
  v_mfma_f32_16x16x32_bf16 v[76:79], v[236:239], v[176:179], v[76:79]
  ds_write_b32 v4, v133 offset:260
  v_mfma_f32_16x16x32_bf16 v[76:79], v[248:251], v[144:147], v[76:79]
  v_mul_f32 v138, v13, v138
  v_mul_f32 v139, v13, v139
  v_mfma_f32_16x16x32_bf16 v[80:83], v[252:255], v[144:147], 0
  v_cvt_pk_bf16_f32 v136, v136, v137
  v_cvt_pk_bf16_f32 v137, v138, v139
  v_mfma_f32_16x16x32_bf16 v[80:83], v[240:243], v[176:179], v[80:83]
  ds_write_b32 v4, v136 offset:264
  v_mfma_f32_16x16x32_bf16 v[80:83], v[228:231], v[168:171], v[80:83]
  v_cvt_pk_bf16_f32 v54, v76, v77
  v_cvt_pk_bf16_f32 v55, v78, v79
  v_mfma_f32_16x16x32_bf16 v[80:83], v[216:219], v[164:167], v[80:83]
  ds_write_b32 v4, v137 offset:268
  v_mfma_f32_16x16x32_bf16 v[80:83], v[204:207], v[84:87], v[80:83]
  v_mul_f32 v160, v13, v160
  v_mul_f32 v161, v13, v161
  v_mfma_f32_16x16x32_bf16 v[80:83], v[192:195], v[72:75], v[80:83]
  v_mul_f32 v162, v13, v162
  v_mul_f32 v163, v13, v163
  v_mfma_f32_16x16x32_bf16 v[76:79], a[0:3], v[72:75], 0
  v_cvt_pk_bf16_f32 v160, v160, v161
  v_cvt_pk_bf16_f32 v161, v162, v163
  v_mfma_f32_16x16x32_bf16 v[76:79], a[12:15], v[84:87], v[76:79]
  ds_write_b32 v5, v160 offset:256
  v_mfma_f32_16x16x32_bf16 v[76:79], a[24:27], v[164:167], v[76:79]
  v_cvt_pk_bf16_f32 v56, v80, v81
  v_cvt_pk_bf16_f32 v57, v82, v83
  v_mfma_f32_16x16x32_bf16 v[76:79], a[36:39], v[168:171], v[76:79]
  ds_write_b32 v5, v161 offset:260
  v_mfma_f32_16x16x32_bf16 v[76:79], a[48:51], v[176:179], v[76:79]
  v_mul_f32 v148, v12, v148
  v_mul_f32 v149, v12, v149
  v_mfma_f32_16x16x32_bf16 v[76:79], a[60:63], v[144:147], v[76:79]
  v_mul_f32 v150, v12, v150
  v_mul_f32 v151, v12, v151
  v_mfma_f32_16x16x32_bf16 v[80:83], a[64:67], v[144:147], 0
  v_cvt_pk_bf16_f32 v148, v148, v149
  v_cvt_pk_bf16_f32 v149, v150, v151
  v_mfma_f32_16x16x32_bf16 v[80:83], a[52:55], v[176:179], v[80:83]
  ds_write_b32 v4, v148 offset:0
  v_mfma_f32_16x16x32_bf16 v[80:83], a[40:43], v[168:171], v[80:83]
  v_cvt_pk_bf16_f32 v58, v76, v77
  v_cvt_pk_bf16_f32 v59, v78, v79
  v_mfma_f32_16x16x32_bf16 v[80:83], a[28:31], v[164:167], v[80:83]
  ds_write_b32 v4, v149 offset:4
  v_mfma_f32_16x16x32_bf16 v[80:83], a[16:19], v[84:87], v[80:83]
  v_mul_f32 v152, v12, v152
  v_mul_f32 v153, v12, v153
  v_mfma_f32_16x16x32_bf16 v[80:83], a[4:7], v[72:75], v[80:83]
  v_mul_f32 v154, v12, v154
  v_mul_f32 v155, v12, v155
  v_mfma_f32_16x16x32_bf16 v[76:79], a[8:11], v[72:75], 0
  v_cvt_pk_bf16_f32 v152, v152, v153
  v_cvt_pk_bf16_f32 v153, v154, v155
  v_mfma_f32_16x16x32_bf16 v[76:79], a[20:23], v[84:87], v[76:79]
  ds_write_b32 v4, v152 offset:8
  v_mfma_f32_16x16x32_bf16 v[76:79], a[32:35], v[164:167], v[76:79]
  v_cvt_pk_bf16_f32 v60, v80, v81
  v_cvt_pk_bf16_f32 v61, v82, v83
  v_mfma_f32_16x16x32_bf16 v[76:79], a[44:47], v[168:171], v[76:79]
  ds_write_b32 v4, v153 offset:12
  v_mfma_f32_16x16x32_bf16 v[76:79], a[56:59], v[176:179], v[76:79]
  v_mul_f32 v172, v12, v172
  v_mul_f32 v173, v12, v173
  v_mfma_f32_16x16x32_bf16 v[76:79], a[68:71], v[144:147], v[76:79]
  v_mul_f32 v174, v12, v174
  v_mul_f32 v175, v12, v175
  v_mfma_f32_16x16x32_bf16 v[80:83], v[144:147], a[132:135], 0
  v_cvt_pk_bf16_f32 v172, v172, v173
  v_cvt_pk_bf16_f32 v173, v174, v175
  v_mfma_f32_16x16x32_bf16 v[80:83], v[176:179], a[120:123], v[80:83]
  ds_write_b32 v5, v172 offset:0
  v_mfma_f32_16x16x32_bf16 v[80:83], v[168:171], a[108:111], v[80:83]
  v_cvt_pk_bf16_f32 v62, v76, v77
  v_cvt_pk_bf16_f32 v63, v78, v79
  v_mfma_f32_16x16x32_bf16 v[80:83], v[164:167], a[96:99], v[80:83]
  ds_read_b128 v[116:119], v0 offset:4096
  v_mfma_f32_16x16x32_bf16 v[80:83], v[84:87], a[84:87], v[80:83]
  ds_read_b128 v[124:127], v1 offset:4096
  v_mfma_f32_16x16x32_bf16 v[80:83], v[72:75], a[72:75], v[80:83]
  ds_read_b128 v[120:123], v0 offset:12288
  v_mfma_f32_16x16x32_bf16 v[76:79], v[72:75], a[76:79], 0
  ds_read_b128 v[128:131], v1 offset:12288
  v_mfma_f32_16x16x32_bf16 v[76:79], v[84:87], a[88:91], v[76:79]
  ds_read_b128 v[132:135], v0 offset:20480
  v_mfma_f32_16x16x32_bf16 v[76:79], v[164:167], a[100:103], v[76:79]
  v_cvt_pk_bf16_f32 v18, v80, v81
  v_cvt_pk_bf16_f32 v19, v82, v83
  v_mfma_f32_16x16x32_bf16 v[76:79], v[168:171], a[112:115], v[76:79]
  ds_read_b128 v[140:143], v1 offset:20480
  v_mfma_f32_16x16x32_bf16 v[76:79], v[176:179], a[124:127], v[76:79]
  ds_write_b32 v5, v173 offset:4
  v_mfma_f32_16x16x32_bf16 v[76:79], v[144:147], a[136:139], v[76:79]
  v_subrev_u32 v3, s7, v3
  v_subrev_u32 v2, s7, v2
  v_mfma_f32_16x16x32_bf16 v[80:83], v[144:147], a[140:143], 0
  v_add_u32 v4, s7, v4
  v_add_u32 v5, s7, v5
  v_mfma_f32_16x16x32_bf16 v[80:83], v[176:179], a[128:131], v[80:83]
  s_sub_u32 s7, 0, s7
  v_max3_f32 v9, v12, v13, v9
  v_mfma_f32_16x16x32_bf16 v[80:83], v[168:171], a[116:119], v[80:83]
  v_cvt_pk_bf16_f32 v26, v76, v77
  v_cvt_pk_bf16_f32 v27, v78, v79
  v_mfma_f32_16x16x32_bf16 v[80:83], v[164:167], a[104:107], v[80:83]
  v_max3_f32 v9, v14, v15, v9
  v_mfma_f32_16x16x32_bf16 v[80:83], v[84:87], a[92:95], v[80:83]
  v_mfma_f32_16x16x32_bf16 v[80:83], v[72:75], a[80:83], v[80:83]
  s_waitcnt lgkmcnt(1)
  v_mfma_f32_16x16x32_bf16 v[148:151], v[116:119], a[80:83], 0
  v_mfma_f32_16x16x32_bf16 v[148:151], v[124:127], a[92:95], v[148:151]
  v_mfma_f32_16x16x32_bf16 v[148:151], v[120:123], a[104:107], v[148:151]
  v_cvt_pk_bf16_f32 v34, v80, v81
  v_cvt_pk_bf16_f32 v35, v82, v83
  v_mfma_f32_16x16x32_bf16 v[148:151], v[128:131], a[116:119], v[148:151]
  v_mfma_f32_16x16x32_bf16 v[148:151], v[132:135], a[128:131], v[148:151]
  v_mfma_f32_16x16x32_bf16 v[148:151], v[140:143], a[140:143], v[148:151]
  v_mfma_f32_16x16x32_bf16 v[156:159], v[140:143], a[136:139], 0
  v_mfma_f32_16x16x32_bf16 v[156:159], v[132:135], a[124:127], v[156:159]
  v_mfma_f32_16x16x32_bf16 v[156:159], v[128:131], a[112:115], v[156:159]
  v_cvt_pk_bf16_f32 v36, v148, v149
  v_cvt_pk_bf16_f32 v37, v150, v151
  v_mfma_f32_16x16x32_bf16 v[156:159], v[120:123], a[100:103], v[156:159]
  v_mfma_f32_16x16x32_bf16 v[156:159], v[124:127], a[88:91], v[156:159]
  v_mfma_f32_16x16x32_bf16 v[156:159], v[116:119], a[76:79], v[156:159]
  v_mfma_f32_16x16x32_bf16 v[148:151], v[116:119], a[72:75], 0
  v_mfma_f32_16x16x32_bf16 v[148:151], v[124:127], a[84:87], v[148:151]
  v_mfma_f32_16x16x32_bf16 v[148:151], v[120:123], a[96:99], v[148:151]
  v_cvt_pk_bf16_f32 v28, v156, v157
  v_cvt_pk_bf16_f32 v29, v158, v159
  v_mfma_f32_16x16x32_bf16 v[148:151], v[128:131], a[108:111], v[148:151]
  s_mov_b32 m0, s47
  s_xor_b32 s47, s47, 1024
  v_mfma_f32_16x16x32_bf16 v[148:151], v[132:135], a[120:123], v[148:151]
  s_add_u32 s40, s50, s52
  s_add_u32 s41, s50, s53
  v_mfma_f32_16x16x32_bf16 v[148:151], v[140:143], a[132:135], v[148:151]
  s_add_u32 s42, s50, s54
  s_add_u32 s43, s50, s55
  v_mfma_f32_16x16x32_bf16 v[156:159], a[68:71], v[140:143], 0
  s_cmp_ge_u32 s6, 94765056
  s_cselect_b64 vcc, -1, 0
  v_mfma_f32_16x16x32_bf16 v[156:159], a[56:59], v[132:135], v[156:159]
  s_mov_b32 s50, s51
  s_mov_b32 s51, s6
  v_mfma_f32_16x16x32_bf16 v[156:159], a[44:47], v[128:131], v[156:159]
  v_cvt_pk_bf16_f32 v20, v148, v149
  v_cvt_pk_bf16_f32 v21, v150, v151
  v_mfma_f32_16x16x32_bf16 v[156:159], a[32:35], v[120:123], v[156:159]
  s_mov_b32 s6, s48
  s_add_u32 s36, s32, s33
  v_mfma_f32_16x16x32_bf16 v[156:159], a[20:23], v[124:127], v[156:159]
  s_mov_b32 s33, s32
  s_sub_u32 s32, s34, s36
  v_mfma_f32_16x16x32_bf16 v[156:159], a[8:11], v[116:119], v[156:159]
  v_mfma_f32_16x16x32_bf16 v[148:151], a[4:7], v[116:119], 0
  v_mfma_f32_16x16x32_bf16 v[148:151], a[16:19], v[124:127], v[148:151]
  v_mfma_f32_16x16x32_bf16 v[148:151], a[28:31], v[120:123], v[148:151]
  v_cvt_pk_bf16_f32 v80, v156, v157
  v_cvt_pk_bf16_f32 v81, v158, v159
  v_mfma_f32_16x16x32_bf16 v[148:151], a[40:43], v[128:131], v[148:151]
  v_mfma_f32_16x16x32_bf16 v[148:151], a[52:55], v[132:135], v[148:151]
  v_mfma_f32_16x16x32_bf16 v[148:151], a[64:67], v[140:143], v[148:151]
  v_mfma_f32_16x16x32_bf16 v[156:159], a[60:63], v[140:143], 0
  v_mfma_f32_16x16x32_bf16 v[156:159], a[48:51], v[132:135], v[156:159]
  v_mfma_f32_16x16x32_bf16 v[156:159], a[36:39], v[128:131], v[156:159]
  v_cvt_pk_bf16_f32 v78, v148, v149
  v_cvt_pk_bf16_f32 v79, v150, v151
  v_mfma_f32_16x16x32_bf16 v[156:159], a[24:27], v[120:123], v[156:159]
  v_mfma_f32_16x16x32_bf16 v[156:159], a[12:15], v[124:127], v[156:159]
  v_mfma_f32_16x16x32_bf16 v[156:159], a[0:3], v[116:119], v[156:159]
  v_mfma_f32_16x16x32_bf16 v[148:151], v[192:195], v[116:119], 0
  v_mfma_f32_16x16x32_bf16 v[148:151], v[204:207], v[124:127], v[148:151]
  v_mfma_f32_16x16x32_bf16 v[148:151], v[216:219], v[120:123], v[148:151]
  v_cvt_pk_bf16_f32 v76, v156, v157
  v_cvt_pk_bf16_f32 v77, v158, v159
  v_mfma_f32_16x16x32_bf16 v[148:151], v[228:231], v[128:131], v[148:151]
  ds_read_b128 v[136:139], v0 offset:6144
  v_mfma_f32_16x16x32_bf16 v[148:151], v[240:243], v[132:135], v[148:151]
  ds_read_b128 v[144:147], v1 offset:6144
  v_mfma_f32_16x16x32_bf16 v[148:151], v[252:255], v[140:143], v[148:151]
  ds_read_b128 v[152:155], v0 offset:14336
  v_mfma_f32_16x16x32_bf16 v[156:159], v[248:251], v[140:143], 0
  ds_read_b128 v[160:163], v1 offset:14336
  v_mfma_f32_16x16x32_bf16 v[156:159], v[236:239], v[132:135], v[156:159]
  ds_read_b128 v[164:167], v0 offset:22528
  v_mfma_f32_16x16x32_bf16 v[156:159], v[224:227], v[128:131], v[156:159]
  v_cvt_pk_bf16_f32 v68, v148, v149
  v_cvt_pk_bf16_f32 v69, v150, v151
  v_mfma_f32_16x16x32_bf16 v[156:159], v[212:215], v[120:123], v[156:159]
  ds_read_b128 v[172:175], v1 offset:22528
  v_mfma_f32_16x16x32_bf16 v[156:159], v[200:203], v[124:127], v[156:159]
  v_mfma_f32_16x16x32_bf16 v[156:159], v[188:191], v[116:119], v[156:159]
  v_mfma_f32_16x16x32_bf16 v[148:151], v[184:187], v[116:119], 0
  v_mfma_f32_16x16x32_bf16 v[148:151], v[196:199], v[124:127], v[148:151]
  v_mfma_f32_16x16x32_bf16 v[148:151], v[208:211], v[120:123], v[148:151]
  v_cvt_pk_bf16_f32 v66, v156, v157
  v_cvt_pk_bf16_f32 v67, v158, v159
  v_mfma_f32_16x16x32_bf16 v[148:151], v[220:223], v[128:131], v[148:151]
  s_cmp_eq_u32 s44, s60
  v_mfma_f32_16x16x32_bf16 v[148:151], v[232:235], v[132:135], v[148:151]
  v_mfma_f32_16x16x32_bf16 v[148:151], v[244:247], v[140:143], v[148:151]
  s_waitcnt lgkmcnt(0)
  v_mfma_f32_16x16x32_bf16 v[168:171], v[244:247], v[172:175], 0
  s_cbranch_scc1 L_cl1
L_cb1:
  v_mfma_f32_16x16x32_bf16 v[168:171], v[232:235], v[164:167], v[168:171]
  v_mfma_f32_16x16x32_bf16 v[168:171], v[220:223], v[160:163], v[168:171]
  v_cvt_pk_bf16_f32 v64, v148, v149
  v_cvt_pk_bf16_f32 v65, v150, v151
  v_mfma_f32_16x16x32_bf16 v[168:171], v[208:211], v[152:155], v[168:171]
  v_mfma_f32_16x16x32_bf16 v[168:171], v[196:199], v[144:147], v[168:171]
  v_mfma_f32_16x16x32_bf16 v[168:171], v[184:187], v[136:139], v[168:171]
  v_mfma_f32_16x16x32_bf16 v[176:179], v[188:191], v[136:139], 0
  v_mfma_f32_16x16x32_bf16 v[176:179], v[200:203], v[144:147], v[176:179]
  v_mfma_f32_16x16x32_bf16 v[176:179], v[212:215], v[152:155], v[176:179]
  v_cvt_pk_bf16_f32 v70, v168, v169
  v_cvt_pk_bf16_f32 v71, v170, v171
  v_mfma_f32_16x16x32_bf16 v[176:179], v[224:227], v[160:163], v[176:179]
  v_mfma_f32_16x16x32_bf16 v[176:179], v[236:239], v[164:167], v[176:179]
  s_barrier
  v_mfma_f32_16x16x32_bf16 v[176:179], v[248:251], v[172:175], v[176:179]
  ds_read_addtid_b32 v116
  v_mad_i32_i16 v0, v10, 1, s32 op_sel:[1,0,0,0]
  v_mfma_f32_16x16x32_bf16 v[168:171], v[252:255], v[172:175], 0
  v_xor_b32 v1, 64, v0
  v_mfma_f32_16x16x32_bf16 v[168:171], v[240:243], v[164:167], v[168:171]
  v_mfma_f32_16x16x32_bf16 v[168:171], v[228:231], v[160:163], v[168:171]
  v_cvt_pk_bf16_f32 v72, v176, v177
  v_cvt_pk_bf16_f32 v73, v178, v179
  v_mfma_f32_16x16x32_bf16 v[168:171], v[216:219], v[152:155], v[168:171]
  v_mfma_f32_16x16x32_bf16 v[168:171], v[204:207], v[144:147], v[168:171]
  v_mfma_f32_16x16x32_bf16 v[168:171], v[192:195], v[136:139], v[168:171]
  s_waitcnt lgkmcnt(0)
  v_readfirstlane_b32 s36, v116
  v_mfma_f32_16x16x32_bf16 v[176:179], a[0:3], v[136:139], 0
  v_mfma_f32_16x16x32_bf16 v[176:179], a[12:15], v[144:147], v[176:179]
  s_add_u32 s36, s36, s44
  s_min_u32 s36, s36, s13
  v_mfma_f32_16x16x32_bf16 v[176:179], a[24:27], v[152:155], v[176:179]
  v_cvt_pk_bf16_f32 v74, v168, v169
  v_cvt_pk_bf16_f32 v75, v170, v171
  v_mfma_f32_16x16x32_bf16 v[176:179], a[36:39], v[160:163], v[176:179]
  s_max_u32 s45, s45, s36
  s_min_u32 s36, s45, s12
  v_mfma_f32_16x16x32_bf16 v[176:179], a[48:51], v[164:167], v[176:179]
  s_cselect_b32 s48, s46, s62
  s_sub_u32 s37, s45, s36
  v_mfma_f32_16x16x32_bf16 v[176:179], a[60:63], v[172:175], v[176:179]
  s_mul_i32 s36, s36, 1572864
  s_add_u32 s48, s48, s36
  v_mfma_f32_16x16x32_bf16 v[168:171], a[64:67], v[172:175], 0
  s_mul_i32 s36, s37, s14
  s_lshr_b32 s36, s36, 8
  v_mfma_f32_16x16x32_bf16 v[168:171], a[52:55], v[164:167], v[168:171]
  s_mul_i32 s36, s36, s15
  s_add_u32 s48, s48, s36
  v_mfma_f32_16x16x32_bf16 v[168:171], a[40:43], v[160:163], v[168:171]
  v_cvt_pk_bf16_f32 v82, v176, v177
  v_cvt_pk_bf16_f32 v83, v178, v179
  v_mfma_f32_16x16x32_bf16 v[168:171], a[28:31], v[152:155], v[168:171]
  s_mulk_i32 s37, 3072
  s_add_u32 s48, s48, s37
  v_mfma_f32_16x16x32_bf16 v[168:171], a[16:19], v[144:147], v[168:171]
  s_add_u32 s49, s48, 786432
  s_bitset1_b64 s[56:57], s45
  v_mfma_f32_16x16x32_bf16 v[168:171], a[4:7], v[136:139], v[168:171]
  s_add_u32 s44, s44, 4
  s_min_u32 s44, s44, s12
  v_mfma_f32_16x16x32_bf16 v[176:179], a[8:11], v[136:139], 0
  s_cmp_ge_u32 s45, s13
  s_cselect_b32 s63, -2, s63
  v_mfma_f32_16x16x32_bf16 v[176:179], a[20:23], v[144:147], v[176:179]
  v_mfma_f32_16x16x32_bf16 v[176:179], a[32:35], v[152:155], v[176:179]
  v_cvt_pk_bf16_f32 v84, v168, v169
  v_cvt_pk_bf16_f32 v85, v170, v171
  v_mfma_f32_16x16x32_bf16 v[176:179], a[44:47], v[160:163], v[176:179]
  v_mfma_f32_16x16x32_bf16 v[176:179], a[56:59], v[164:167], v[176:179]
  v_mfma_f32_16x16x32_bf16 v[176:179], a[68:71], v[172:175], v[176:179]
  v_mfma_f32_16x16x32_bf16 v[168:171], v[172:175], a[132:135], 0
  v_mfma_f32_16x16x32_bf16 v[168:171], v[164:167], a[120:123], v[168:171]
  v_mfma_f32_16x16x32_bf16 v[168:171], v[160:163], a[108:111], v[168:171]
  v_cvt_pk_bf16_f32 v86, v176, v177
  v_cvt_pk_bf16_f32 v87, v178, v179
  v_mfma_f32_16x16x32_bf16 v[168:171], v[152:155], a[96:99], v[168:171]
  v_mfma_f32_16x16x32_bf16 v[168:171], v[144:147], a[84:87], v[168:171]
  v_mfma_f32_16x16x32_bf16 v[168:171], v[136:139], a[72:75], v[168:171]
  v_mfma_f32_16x16x32_bf16 v[176:179], v[136:139], a[76:79], 0
  v_mfma_f32_16x16x32_bf16 v[176:179], v[144:147], a[88:91], v[176:179]
  v_mfma_f32_16x16x32_bf16 v[176:179], v[152:155], a[100:103], v[176:179]
  v_cvt_pk_bf16_f32 v22, v168, v169
  v_cvt_pk_bf16_f32 v23, v170, v171
  v_mfma_f32_16x16x32_bf16 v[176:179], v[160:163], a[112:115], v[176:179]
  ds_read_b128 a[244:247], v3 offset:0
  v_mfma_f32_16x16x32_bf16 v[176:179], v[164:167], a[124:127], v[176:179]
  ds_read_b128 a[248:251], v3 offset:4096
  v_mfma_f32_16x16x32_bf16 v[176:179], v[172:175], a[136:139], v[176:179]
  ds_read_b128 a[252:255], v3 offset:8192
  v_mfma_f32_16x16x32_bf16 v[168:171], v[172:175], a[140:143], 0
  ds_read_b128 v[180:183], v3 offset:12288
  v_mfma_f32_16x16x32_bf16 v[168:171], v[164:167], a[128:131], v[168:171]
  v_mfma_f32_16x16x32_bf16 v[168:171], v[160:163], a[116:119], v[168:171]
  v_cvt_pk_bf16_f32 v30, v176, v177
  v_cvt_pk_bf16_f32 v31, v178, v179
  v_mfma_f32_16x16x32_bf16 v[168:171], v[152:155], a[104:107], v[168:171]
  s_cmp_lg_u32 s31, 0
  v_mfma_f32_16x16x32_bf16 v[168:171], v[144:147], a[92:95], v[168:171]
  v_mfma_f32_16x16x32_bf16 v[168:171], v[136:139], a[80:83], v[168:171]
  s_cbranch_scc0 L_s
  s_branch L_special
L_cl0:
  v_mov_b32 v11, 1
  v_lshrrev_b32 v180, 16, v10
  buffer_atomic_add v11, v180, s[20:23], 0 offen sc0 sc1
  s_branch L_cb0
L_cl1:
  v_mov_b32 v11, 1
  v_lshrrev_b32 v180, 16, v10
  buffer_atomic_add v11, v180, s[20:23], 0 offen sc0 sc1
  s_branch L_cb1
L_epi:
  ds_write_b32 v4, v124 offset:768
  ds_write_b32 v4, v125 offset:772
  v_pk_mul_f32 v[128:129], v[128:129], v[14:15] op_sel:[0,1] op_sel_hi:[1,1]
  v_pk_mul_f32 v[130:131], v[130:131], v[14:15] op_sel:[0,1] op_sel_hi:[1,1]
  v_cvt_pk_bf16_f32 v128, v128, v129
  v_cvt_pk_bf16_f32 v129, v130, v131
  ds_write_b32 v4, v128 offset:776
  ds_write_b32 v4, v129 offset:780
  v_pk_mul_f32 v[140:141], v[140:141], v[14:15] op_sel:[0,1] op_sel_hi:[1,1]
  v_pk_mul_f32 v[142:143], v[142:143], v[14:15] op_sel:[0,1] op_sel_hi:[1,1]
  v_cvt_pk_bf16_f32 v140, v140, v141
  v_cvt_pk_bf16_f32 v141, v142, v143
  ds_write_b32 v5, v140 offset:768
  ds_write_b32 v5, v141 offset:772
  v_pk_mul_f32 v[116:117], v[116:117], v[14:15] op_sel:[0,0] op_sel_hi:[1,0]
  v_pk_mul_f32 v[118:119], v[118:119], v[14:15] op_sel:[0,0] op_sel_hi:[1,0]
  v_cvt_pk_bf16_f32 v116, v116, v117
  v_cvt_pk_bf16_f32 v117, v118, v119
  v_pk_mul_f32 v[120:121], v[120:121], v[14:15] op_sel:[0,0] op_sel_hi:[1,0]
  v_pk_mul_f32 v[122:123], v[122:123], v[14:15] op_sel:[0,0] op_sel_hi:[1,0]
  v_cvt_pk_bf16_f32 v118, v120, v121
  v_cvt_pk_bf16_f32 v119, v122, v123
  ds_write_b128 v4, v[116:119] offset:512
  v_pk_mul_f32 v[156:157], v[156:157], v[14:15] op_sel:[0,0] op_sel_hi:[1,0]
  v_pk_mul_f32 v[158:159], v[158:159], v[14:15] op_sel:[0,0] op_sel_hi:[1,0]
  v_cvt_pk_bf16_f32 v156, v156, v157
  v_cvt_pk_bf16_f32 v157, v158, v159
  ds_write_b64 v5, v[156:157] offset:512
  s_mul_i32 s36, s5, 768
  s_add_u32 s37, s7, s36
  s_sub_u32 s36, s7, s36
  v_subrev_u32 v3, s37, v3
  v_subrev_u32 v2, s36, v2
  v_max3_f32 v9, v12, v13, v9
  v_rcp_f32 v13, v13
  v_rcp_f32 v12, v12
  s_lshl_b32 s36, s5, 1
  s_add_u32 s37, s36, s4
  s_sub_u32 s36, s36, s4
  s_mul_i32 s37, s37, 196608
  s_mul_i32 s36, s36, 196608
  s_sub_u32 s37, s50, s37
  s_add_u32 s36, s50, s36
  s_add_u32 s40, s37, 1179648
  s_waitcnt lgkmcnt(0)
  s_barrier
  ds_read_b128 a[244:247], v3 offset:768
  ds_read_b128 a[248:251], v3 offset:4864
  v_pk_mul_f32 v[132:133], v[132:133], v[12:13] op_sel:[0,1] op_sel_hi:[1,1]
  v_pk_mul_f32 v[134:135], v[134:135], v[12:13] op_sel:[0,1] op_sel_hi:[1,1]
  v_cvt_pk_bf16_f32 v132, v132, v133
  ds_read_b128 a[252:255], v3 offset:8960
  v_cvt_pk_bf16_f32 v133, v134, v135
  v_pk_mul_f32 v[136:137], v[136:137], v[12:13] op_sel:[0,1] op_sel_hi:[1,1]
  v_pk_mul_f32 v[138:139], v[138:139], v[12:13] op_sel:[0,1] op_sel_hi:[1,1]
  ds_read_b128 v[180:183], v3 offset:13056
  v_cvt_pk_bf16_f32 v134, v136, v137
  v_cvt_pk_bf16_f32 v135, v138, v139
  v_pk_mul_f32 v[160:161], v[160:161], v[12:13] op_sel:[0,1] op_sel_hi:[1,1]
  ds_read_b128 v[64:67], v3 offset:17152
  v_pk_mul_f32 v[162:163], v[162:163], v[12:13] op_sel:[0,1] op_sel_hi:[1,1]
  v_cvt_pk_bf16_f32 v160, v160, v161
  v_cvt_pk_bf16_f32 v161, v162, v163
  ds_read_b128 v[68:71], v3 offset:21248
  v_pk_mul_f32 v[148:149], v[148:149], v[12:13] op_sel:[0,0] op_sel_hi:[1,0]
  v_pk_mul_f32 v[150:151], v[150:151], v[12:13] op_sel:[0,0] op_sel_hi:[1,0]
  v_pk_mul_f32 v[152:153], v[152:153], v[12:13] op_sel:[0,0] op_sel_hi:[1,0]
  v_pk_mul_f32 v[154:155], v[154:155], v[12:13] op_sel:[0,0] op_sel_hi:[1,0]
  s_waitcnt lgkmcnt(4)
  v_mfma_f32_16x16x32_bf16 v[40:43], a[144:147], a[244:247], 0
  v_cvt_pk_bf16_f32 v148, v148, v149
  v_cvt_pk_bf16_f32 v149, v150, v151
  v_mfma_f32_16x16x32_bf16 v[40:43], a[160:163], a[248:251], v[40:43]
  s_waitcnt lgkmcnt(2)
  v_cvt_pk_bf16_f32 v150, v152, v153
  v_mfma_f32_16x16x32_bf16 v[40:43], a[176:179], a[252:255], v[40:43]
  v_cvt_pk_bf16_f32 v151, v154, v155
  v_mfma_f32_16x16x32_bf16 v[40:43], a[192:195], v[180:183], v[40:43]
  s_waitcnt lgkmcnt(0)
  v_mfma_f32_16x16x32_bf16 v[40:43], a[208:211], v[64:67], v[40:43]
  ds_write_b128 v4, v[132:135] offset:256
  v_mfma_f32_16x16x32_bf16 v[40:43], a[224:227], v[68:71], v[40:43]
  ds_write_b64 v5, v[160:161] offset:256
  v_mfma_f32_16x16x32_bf16 v[44:47], a[228:231], v[68:71], 0
  ds_write_b128 v4, v[148:151] offset:0
  v_mfma_f32_16x16x32_bf16 v[44:47], a[212:215], v[64:67], v[44:47]
  v_mul_f32 v172, v12, v172
  v_mul_f32 v173, v12, v173
  v_mfma_f32_16x16x32_bf16 v[44:47], a[196:199], v[180:183], v[44:47]
  v_cvt_pk_bf16_f32 v40, v40, v41
  v_cvt_pk_bf16_f32 v41, v42, v43
  v_mfma_f32_16x16x32_bf16 v[44:47], a[180:183], a[252:255], v[44:47]
  v_mul_f32 v174, v12, v174
  v_mul_f32 v175, v12, v175
  v_mfma_f32_16x16x32_bf16 v[44:47], a[164:167], a[248:251], v[44:47]
  v_cvt_pk_bf16_f32 v172, v172, v173
  v_cvt_pk_bf16_f32 v173, v174, v175
  v_mfma_f32_16x16x32_bf16 v[44:47], a[148:151], a[244:247], v[44:47]
  ds_write_b64 v5, v[172:173] offset:0
  v_mfma_f32_16x16x32_bf16 v[48:51], a[152:155], a[244:247], 0
  ds_read_b128 v[72:75], v2 offset:512
  v_mfma_f32_16x16x32_bf16 v[48:51], a[168:171], a[248:251], v[48:51]
  ds_read_b128 v[56:59], v2 offset:4608
  v_mfma_f32_16x16x32_bf16 v[48:51], a[184:187], a[252:255], v[48:51]
  v_cvt_pk_bf16_f32 v42, v44, v45
  v_cvt_pk_bf16_f32 v43, v46, v47
  v_mfma_f32_16x16x32_bf16 v[48:51], a[200:203], v[180:183], v[48:51]
  buffer_store_dwordx4 v[40:43], v7, s[24:27], s40 offen nt
  v_mfma_f32_16x16x32_bf16 v[48:51], a[216:219], v[64:67], v[48:51]
  ds_read_b128 v[60:63], v2 offset:8704
  v_mfma_f32_16x16x32_bf16 v[48:51], a[232:235], v[68:71], v[48:51]
  ds_read_b128 v[76:79], v2 offset:12800
  v_mfma_f32_16x16x32_bf16 v[52:55], a[236:239], v[68:71], 0
  ds_read_b128 v[80:83], v2 offset:16896
  v_mfma_f32_16x16x32_bf16 v[52:55], a[220:223], v[64:67], v[52:55]
  ds_read_b128 v[84:87], v2 offset:20992
  v_mfma_f32_16x16x32_bf16 v[52:55], a[204:207], v[180:183], v[52:55]
  v_cvt_pk_bf16_f32 v48, v48, v49
  v_cvt_pk_bf16_f32 v49, v50, v51
  v_mfma_f32_16x16x32_bf16 v[52:55], a[188:191], a[252:255], v[52:55]
  v_mfma_f32_16x16x32_bf16 v[52:55], a[172:175], a[248:251], v[52:55]
  s_waitcnt lgkmcnt(6)
  s_barrier
  v_mfma_f32_16x16x32_bf16 v[52:55], a[156:159], a[244:247], v[52:55]
  s_waitcnt lgkmcnt(0)
  ds_read_b128 v[124:127], v3 offset:256
  v_mfma_f32_16x16x32_bf16 v[40:43], a[144:147], v[72:75], 0
  ds_read_b128 v[128:131], v3 offset:4352
  s_add_u32 s41, s36, 786432
  v_mfma_f32_16x16x32_bf16 v[40:43], a[160:163], v[56:59], v[40:43]
  ds_read_b128 v[140:143], v3 offset:8448
  v_mfma_f32_16x16x32_bf16 v[40:43], a[176:179], v[60:63], v[40:43]
  v_cvt_pk_bf16_f32 v50, v52, v53
  v_cvt_pk_bf16_f32 v51, v54, v55
  v_mfma_f32_16x16x32_bf16 v[40:43], a[192:195], v[76:79], v[40:43]
  buffer_store_dwordx4 v[48:51], v8, s[24:27], s40 offen nt
  v_mfma_f32_16x16x32_bf16 v[40:43], a[208:211], v[80:83], v[40:43]
  ds_read_b128 v[116:119], v3 offset:12544
  s_add_u32 s42, s37, 393216
  v_mfma_f32_16x16x32_bf16 v[40:43], a[224:227], v[84:87], v[40:43]
  ds_read_b128 v[120:123], v3 offset:16640
  v_mfma_f32_16x16x32_bf16 v[44:47], a[228:231], v[84:87], 0
  ds_read_b128 v[156:159], v3 offset:20736
  s_add_u32 s43, s36, 0
  v_mfma_f32_16x16x32_bf16 v[44:47], a[212:215], v[80:83], v[44:47]
  v_mfma_f32_16x16x32_bf16 v[44:47], a[196:199], v[76:79], v[44:47]
  v_cvt_pk_bf16_f32 v40, v40, v41
  v_cvt_pk_bf16_f32 v41, v42, v43
  v_mfma_f32_16x16x32_bf16 v[44:47], a[180:183], v[60:63], v[44:47]
  v_mfma_f32_16x16x32_bf16 v[44:47], a[164:167], v[56:59], v[44:47]
  v_mfma_f32_16x16x32_bf16 v[44:47], a[148:151], v[72:75], v[44:47]
  s_waitcnt lgkmcnt(0)
  v_mfma_f32_16x16x32_bf16 v[48:51], a[144:147], v[124:127], 0
  v_mfma_f32_16x16x32_bf16 v[48:51], a[160:163], v[128:131], v[48:51]
  v_mfma_f32_16x16x32_bf16 v[48:51], a[176:179], v[140:143], v[48:51]
  v_cvt_pk_bf16_f32 v42, v44, v45
  v_cvt_pk_bf16_f32 v43, v46, v47
  v_mfma_f32_16x16x32_bf16 v[48:51], a[192:195], v[116:119], v[48:51]
  buffer_store_dwordx4 v[40:43], v7, s[24:27], s41 offen nt
  v_mfma_f32_16x16x32_bf16 v[48:51], a[208:211], v[120:123], v[48:51]
  ds_read_b128 v[16:19], v2 offset:0
  v_mfma_f32_16x16x32_bf16 v[48:51], a[224:227], v[156:159], v[48:51]
  ds_read_b128 v[20:23], v2 offset:4096
  v_max3_f32 v9, v12, v13, v9
  v_mfma_f32_16x16x32_bf16 v[52:55], a[228:231], v[156:159], 0
  ds_read_b128 v[24:27], v2 offset:8192
  v_max3_f32 v9, v14, v15, v9
  v_mfma_f32_16x16x32_bf16 v[52:55], a[212:215], v[120:123], v[52:55]
  ds_read_b128 v[28:31], v2 offset:12288
  v_mfma_f32_16x16x32_bf16 v[52:55], a[196:199], v[116:119], v[52:55]
  v_cvt_pk_bf16_f32 v48, v48, v49
  v_cvt_pk_bf16_f32 v49, v50, v51
  v_mfma_f32_16x16x32_bf16 v[52:55], a[180:183], v[140:143], v[52:55]
  ds_read_b128 v[32:35], v2 offset:16384
  s_lshl_b32 s39, s4, 2
  v_mfma_f32_16x16x32_bf16 v[52:55], a[164:167], v[128:131], v[52:55]
  ds_read_b128 v[36:39], v2 offset:20480
  s_add_u32 s39, s39, 28672
  v_mfma_f32_16x16x32_bf16 v[52:55], a[148:151], v[124:127], v[52:55]
  v_mov_b32 v0, s39
  v_mfma_f32_16x16x32_bf16 v[40:43], a[152:155], v[124:127], 0
  s_mov_b64 s[36:37], 0
  v_mfma_f32_16x16x32_bf16 v[40:43], a[168:171], v[128:131], v[40:43]
  v_cmp_nge_f32 vcc, 0x53800000, v9
  v_mfma_f32_16x16x32_bf16 v[40:43], a[184:187], v[140:143], v[40:43]
  v_cvt_pk_bf16_f32 v50, v52, v53
  v_cvt_pk_bf16_f32 v51, v54, v55
  v_mfma_f32_16x16x32_bf16 v[40:43], a[200:203], v[116:119], v[40:43]
  buffer_store_dwordx4 v[48:51], v7, s[24:27], s42 offen nt
  v_mfma_f32_16x16x32_bf16 v[40:43], a[216:219], v[120:123], v[40:43]
  s_or_b64 vcc, vcc, s[36:37]
  s_cselect_b32 s38, 1, 0
  v_mfma_f32_16x16x32_bf16 v[40:43], a[232:235], v[156:159], v[40:43]
  v_mov_b32 v1, s38
  v_mfma_f32_16x16x32_bf16 v[44:47], a[236:239], v[156:159], 0
  ds_write_b32 v0, v1
  v_mfma_f32_16x16x32_bf16 v[44:47], a[220:223], v[120:123], v[44:47]
  v_mov_b32 v1, 28672
  v_mfma_f32_16x16x32_bf16 v[44:47], a[204:207], v[116:119], v[44:47]
  v_cvt_pk_bf16_f32 v40, v40, v41
  v_cvt_pk_bf16_f32 v41, v42, v43
  v_mfma_f32_16x16x32_bf16 v[44:47], a[188:191], v[140:143], v[44:47]
  v_mfma_f32_16x16x32_bf16 v[44:47], a[172:175], v[128:131], v[44:47]
  v_mfma_f32_16x16x32_bf16 v[44:47], a[156:159], v[124:127], v[44:47]
  s_waitcnt lgkmcnt(1)
  v_mfma_f32_16x16x32_bf16 v[48:51], a[144:147], v[16:19], 0
  v_mfma_f32_16x16x32_bf16 v[48:51], a[160:163], v[20:23], v[48:51]
  v_mfma_f32_16x16x32_bf16 v[48:51], a[176:179], v[24:27], v[48:51]
  v_cvt_pk_bf16_f32 v42, v44, v45
  v_cvt_pk_bf16_f32 v43, v46, v47
  v_mfma_f32_16x16x32_bf16 v[48:51], a[192:195], v[28:31], v[48:51]
  buffer_store_dwordx4 v[40:43], v8, s[24:27], s42 offen nt
  v_mfma_f32_16x16x32_bf16 v[48:51], a[208:211], v[32:35], v[48:51]
  v_mfma_f32_16x16x32_bf16 v[48:51], a[224:227], v[36:39], v[48:51]
  v_mfma_f32_16x16x32_bf16 v[52:55], a[228:231], v[36:39], 0
  v_mfma_f32_16x16x32_bf16 v[52:55], a[212:215], v[32:35], v[52:55]
  v_mfma_f32_16x16x32_bf16 v[52:55], a[196:199], v[28:31], v[52:55]
  v_cvt_pk_bf16_f32 v48, v48, v49
  v_cvt_pk_bf16_f32 v49, v50, v51
  v_mfma_f32_16x16x32_bf16 v[52:55], a[180:183], v[24:27], v[52:55]
  v_mfma_f32_16x16x32_bf16 v[52:55], a[164:167], v[20:23], v[52:55]
  v_mfma_f32_16x16x32_bf16 v[52:55], a[148:151], v[16:19], v[52:55]
  s_nop 7
  v_cvt_pk_bf16_f32 v50, v52, v53
  v_cvt_pk_bf16_f32 v51, v54, v55
  buffer_store_dwordx4 v[48:51], v7, s[24:27], s43 offen nt
  s_waitcnt lgkmcnt(0)
  s_barrier
  ds_read_b128 v[116:119], v1
  s_waitcnt lgkmcnt(0)
  v_or3_b32 v116, v116, v117, v118
  v_or_b32 v116, v116, v119
  s_nop 0
  v_readfirstlane_b32 s36, v116
  s_nop 3
  s_andn2_b32 s36, s36, s31
  s_cbranch_scc1 L_redo
  s_endpgm
L_redo:
  s_mov_b64 s[100:101], s[56:57]
  s_mov_b32 s31, 1
  s_waitcnt vmcnt(0) lgkmcnt(0)
  v_mbcnt_lo_u32_b32 v0, -1, 0
  v_mbcnt_hi_u32_b32 v0, -1, v0
  v_add_u32 v0, s3, v0
  s_barrier
  s_branch L_again
L_special0:
  buffer_load_dwordx4 v6, s[8:11], s49 offen offset:256 nt lds
  s_add_u32 s48, s48, 6291456
  s_add_u32 s49, s48, 786432
  s_add_u32 m0, s32, 65536
  ds_read_b64_tr_b16 a[100:101], v13 offset:49152
  buffer_load_dwordx4 v6, s[8:11], s48 offen offset:0 nt lds
  ds_read_b64_tr_b16 a[102:103], v13 offset:49664
  ds_read_b64_tr_b16 a[104:105], v14 offset:49152
  ds_read_b64_tr_b16 a[106:107], v14 offset:49664
  ds_read_b64_tr_b16 a[108:109], v12 offset:61440
  s_add_u32 m0, s32, 73600
  ds_read_b64_tr_b16 a[110:111], v12 offset:61952
  buffer_load_dwordx4 v6, s[8:11], s48 offen offset:128 nt lds
  ds_read_b64_tr_b16 a[112:113], v13 offset:61440
  ds_read_b64_tr_b16 a[114:115], v13 offset:61952
  ds_read_b64_tr_b16 a[116:117], v14 offset:61440
  ds_read_b64_tr_b16 a[118:119], v14 offset:61952
  s_add_u32 m0, s32, 81664
  s_nop 0
  buffer_load_dwordx4 v6, s[8:11], s48 offen offset:256 nt lds
  s_waitcnt lgkmcnt(0)
  s_waitcnt vmcnt(9)
  s_barrier
  ds_read_b64_tr_b16 a[120:121], v15 offset:0
  ds_read_b64_tr_b16 a[122:123], v15 offset:512
  ds_read_b64_tr_b16 a[124:125], v9 offset:0
  ds_read_b64_tr_b16 a[126:127], v9 offset:512
  ds_read_b64_tr_b16 a[128:129], v11 offset:0
  ds_read_b64_tr_b16 a[130:131], v11 offset:512
  ds_read_b64_tr_b16 a[132:133], v15 offset:12288
  ds_read_b64_tr_b16 a[134:135], v15 offset:12800
  ds_read_b64_tr_b16 a[136:137], v9 offset:12288
  ds_read_b64_tr_b16 a[138:139], v9 offset:12800
  ds_read_b64_tr_b16 a[140:141], v11 offset:12288
  ds_read_b64_tr_b16 a[142:143], v11 offset:12800
  v_mfma_f32_16x16x16_bf16 v[124:127], v[62:63], v[74:75], v[124:127]
  v_mfma_f32_16x16x16_bf16 v[120:123], v[80:81], v[74:75], v[120:123]
  v_mfma_f32_16x16x16_bf16 v[128:131], v[86:87], v[74:75], v[128:131]
  v_mfma_f32_16x16x16_bf16 v[132:135], v[50:51], v[68:69], v[160:163]
  v_mfma_f32_16x16x16_bf16 v[140:143], v[62:63], v[68:69], v[180:183]
  v_mfma_f32_16x16x16_bf16 v[136:139], v[80:81], v[68:69], v[100:103]
  v_mfma_f32_16x16x16_bf16 v[144:147], v[86:87], v[68:69], v[96:99]
  v_mfma_f32_16x16x16_bf16 v[148:151], v[50:51], v[56:57], v[104:107]
  v_mfma_f32_16x16x16_bf16 v[156:159], v[62:63], v[56:57], v[100:103]
  v_mfma_f32_16x16x16_bf16 v[152:155], v[80:81], v[56:57], v[152:155]
  v_mfma_f32_16x16x16_bf16 v[160:163], v[86:87], v[56:57], v[168:171]
  v_mfma_f32_16x16x16_bf16 v[164:167], v[50:51], v[44:45], v[100:103]
  v_mfma_f32_16x16x16_bf16 v[172:175], v[62:63], v[44:45], v[96:99]
  v_mfma_f32_16x16x16_bf16 v[168:171], v[80:81], v[44:45], v[168:171]
  v_mfma_f32_16x16x16_bf16 v[176:179], v[86:87], v[44:45], v[176:179]
  v_mfma_f32_16x16x32_bf16 v[132:135], v[46:49], v[64:67], v[132:135]
  v_mfma_f32_16x16x32_bf16 v[140:143], v[58:61], v[64:67], v[140:143]
  v_mfma_f32_16x16x32_bf16 v[136:139], v[76:79], v[64:67], v[136:139]
  v_mfma_f32_16x16x32_bf16 v[144:147], v[82:85], v[64:67], v[144:147]
  v_mfma_f32_16x16x32_bf16 v[148:151], v[46:49], v[52:55], v[148:151]
  v_mfma_f32_16x16x32_bf16 v[156:159], v[58:61], v[52:55], v[156:159]
  v_mfma_f32_16x16x32_bf16 v[152:155], v[76:79], v[52:55], v[152:155]
  v_mfma_f32_16x16x32_bf16 v[160:163], v[82:85], v[52:55], v[160:163]
  v_mfma_f32_16x16x32_bf16 v[164:167], v[46:49], v[40:43], v[164:167]
  v_mfma_f32_16x16x32_bf16 v[172:175], v[58:61], v[40:43], v[172:175]
  v_mfma_f32_16x16x32_bf16 v[168:171], v[76:79], v[40:43], v[168:171]
  v_mfma_f32_16x16x32_bf16 v[176:179], v[82:85], v[40:43], v[176:179]
  s_branch L_sp2
L_special:
  s_ff1_i32_b64 s44, s[100:101]
  s_bitset0_b64 s[100:101], s44
  s_nop 4
  v_cvt_pk_bf16_f32 v38, v168, v169
  v_cvt_pk_bf16_f32 v39, v170, v171
  v_mfma_f32_16x16x32_bf16 v[116:119], v[46:49], v[70:73], v[112:115]
  v_mfma_f32_16x16x32_bf16 v[124:127], v[58:61], v[70:73], v[108:111]
  v_mfma_f32_16x16x32_bf16 v[120:123], v[76:79], v[70:73], v[104:107]
  v_mfma_f32_16x16x32_bf16 v[128:131], v[82:85], v[70:73], v[100:103]
  v_mfma_f32_16x16x16_bf16 v[116:119], v[50:51], v[74:75], v[116:119]
  v_mfma_f32_16x16x16_bf16 v[124:127], v[62:63], v[74:75], v[124:127]
  v_mfma_f32_16x16x16_bf16 v[120:123], v[80:81], v[74:75], v[120:123]
  v_mfma_f32_16x16x16_bf16 v[128:131], v[86:87], v[74:75], v[128:131]
  v_mfma_f32_16x16x16_bf16 v[144:147], v[86:87], v[68:69], v[96:99]
  v_mfma_f32_16x16x16_bf16 v[136:139], v[80:81], v[68:69], v[100:103]
  v_mfma_f32_16x16x16_bf16 v[140:143], v[62:63], v[68:69], v[104:107]
  v_mfma_f32_16x16x16_bf16 v[132:135], v[50:51], v[68:69], v[108:111]
  v_mfma_f32_16x16x16_bf16 v[148:151], v[50:51], v[56:57], v[104:107]
  v_mfma_f32_16x16x16_bf16 v[156:159], v[62:63], v[56:57], v[100:103]
  v_mfma_f32_16x16x16_bf16 v[152:155], v[80:81], v[56:57], v[96:99]
  v_mfma_f32_16x16x16_bf16 v[160:163], v[86:87], v[56:57], v[92:95]
  v_mfma_f32_16x16x16_bf16 v[176:179], v[86:87], v[44:45], v[88:91]
  v_mfma_f32_16x16x16_bf16 v[168:171], v[80:81], v[44:45], v[92:95]
  v_mfma_f32_16x16x16_bf16 v[172:175], v[62:63], v[44:45], v[96:99]
  v_mfma_f32_16x16x16_bf16 v[164:167], v[50:51], v[44:45], v[100:103]
  v_mfma_f32_16x16x32_bf16 v[132:135], v[46:49], v[64:67], v[132:135]
  v_mfma_f32_16x16x32_bf16 v[140:143], v[58:61], v[64:67], v[140:143]
  v_mfma_f32_16x16x32_bf16 v[136:139], v[76:79], v[64:67], v[136:139]
  v_mfma_f32_16x16x32_bf16 v[144:147], v[82:85], v[64:67], v[144:147]
  v_mfma_f32_16x16x32_bf16 v[160:163], v[82:85], v[52:55], v[160:163]
  v_mfma_f32_16x16x32_bf16 v[152:155], v[76:79], v[52:55], v[152:155]
  v_mfma_f32_16x16x32_bf16 v[156:159], v[58:61], v[52:55], v[156:159]
  v_mfma_f32_16x16x32_bf16 v[148:151], v[46:49], v[52:55], v[148:151]
  v_mfma_f32_16x16x32_bf16 v[164:167], v[46:49], v[40:43], v[164:167]
  v_mfma_f32_16x16x32_bf16 v[172:175], v[58:61], v[40:43], v[172:175]
  v_mfma_f32_16x16x32_bf16 v[168:171], v[76:79], v[40:43], v[168:171]
  v_mfma_f32_16x16x32_bf16 v[176:179], v[82:85], v[40:43], v[176:179]
  ds_read_b128 v[64:67], v3 offset:16384
  ds_read_b128 v[68:71], v3 offset:20480
L_sp2:
  s_nop 15
  v_max_f32 v40, v164, v165
  v_max3_f32 v40, v166, v167, v40
  v_max3_f32 v40, v172, v173, v40
  v_max3_f32 v40, v174, v175, v40
  v_max3_f32 v40, v168, v169, v40
  v_max3_f32 v40, v170, v171, v40
  v_max3_f32 v40, v176, v177, v40
  v_max3_f32 v40, v178, v179, v40
  v_mov_b32 v41, v40
  s_nop 1
  v_permlane32_swap_b32 v40, v41
  v_max_f32 v40, v40, v41
  v_mov_b32 v41, v40
  s_nop 1
  v_permlane16_swap_b32 v40, v41
  v_max_f32 v40, v40, v41
  v_sub_f32 v164, v164, v40
  v_sub_f32 v165, v165, v40
  v_sub_f32 v166, v166, v40
  v_sub_f32 v167, v167, v40
  v_sub_f32 v172, v172, v40
  v_sub_f32 v173, v173, v40
  v_sub_f32 v174, v174, v40
  v_sub_f32 v175, v175, v40
  v_sub_f32 v168, v168, v40
  v_sub_f32 v169, v169, v40
  v_sub_f32 v170, v170, v40
  v_sub_f32 v171, v171, v40
  v_sub_f32 v176, v176, v40
  v_sub_f32 v177, v177, v40
  v_sub_f32 v178, v178, v40
  v_sub_f32 v179, v179, v40
  v_max_f32 v40, v148, v149
  v_max3_f32 v40, v150, v151, v40
  v_max3_f32 v40, v156, v157, v40
  v_max3_f32 v40, v158, v159, v40
  v_max3_f32 v40, v152, v153, v40
  v_max3_f32 v40, v154, v155, v40
  v_max3_f32 v40, v160, v161, v40
  v_max3_f32 v40, v162, v163, v40
  v_mov_b32 v41, v40
  s_nop 1
  v_permlane32_swap_b32 v40, v41
  v_max_f32 v40, v40, v41
  v_mov_b32 v41, v40
  s_nop 1
  v_permlane16_swap_b32 v40, v41
  v_max_f32 v40, v40, v41
  v_sub_f32 v148, v148, v40
  v_sub_f32 v149, v149, v40
  v_sub_f32 v150, v150, v40
  v_sub_f32 v151, v151, v40
  v_sub_f32 v156, v156, v40
  v_sub_f32 v157, v157, v40
  v_sub_f32 v158, v158, v40
  v_sub_f32 v159, v159, v40
  v_sub_f32 v152, v152, v40
  v_sub_f32 v153, v153, v40
  v_sub_f32 v154, v154, v40
  v_sub_f32 v155, v155, v40
  v_sub_f32 v160, v160, v40
  v_sub_f32 v161, v161, v40
  v_sub_f32 v162, v162, v40
  v_sub_f32 v163, v163, v40
  v_max_f32 v40, v132, v133
  v_max3_f32 v40, v134, v135, v40
  v_max3_f32 v40, v140, v141, v40
  v_max3_f32 v40, v142, v143, v40
  v_max3_f32 v40, v136, v137, v40
  v_max3_f32 v40, v138, v139, v40
  v_max3_f32 v40, v144, v145, v40
  v_max3_f32 v40, v146, v147, v40
  v_mov_b32 v41, v40
  s_nop 1
  v_permlane32_swap_b32 v40, v41
  v_max_f32 v40, v40, v41
  v_mov_b32 v41, v40
  s_nop 1
  v_permlane16_swap_b32 v40, v41
  v_max_f32 v40, v40, v41
  v_sub_f32 v132, v132, v40
  v_sub_f32 v133, v133, v40
  v_sub_f32 v134, v134, v40
  v_sub_f32 v135, v135, v40
  v_sub_f32 v140, v140, v40
  v_sub_f32 v141, v141, v40
  v_sub_f32 v142, v142, v40
  v_sub_f32 v143, v143, v40
  v_sub_f32 v136, v136, v40
  v_sub_f32 v137, v137, v40
  v_sub_f32 v138, v138, v40
  v_sub_f32 v139, v139, v40
  v_sub_f32 v144, v144, v40
  v_sub_f32 v145, v145, v40
  v_sub_f32 v146, v146, v40
  v_sub_f32 v147, v147, v40
  v_max_f32 v40, v116, v117
  v_max3_f32 v40, v118, v119, v40
  v_max3_f32 v40, v124, v125, v40
  v_max3_f32 v40, v126, v127, v40
  v_max3_f32 v40, v120, v121, v40
  v_max3_f32 v40, v122, v123, v40
  v_max3_f32 v40, v128, v129, v40
  v_max3_f32 v40, v130, v131, v40
  v_mov_b32 v41, v40
  s_nop 1
  v_permlane32_swap_b32 v40, v41
  v_max_f32 v40, v40, v41
  v_mov_b32 v41, v40
  s_nop 1
  v_permlane16_swap_b32 v40, v41
  v_max_f32 v40, v40, v41
  v_sub_f32 v116, v116, v40
  v_sub_f32 v117, v117, v40
  v_sub_f32 v118, v118, v40
  v_sub_f32 v119, v119, v40
  v_sub_f32 v124, v124, v40
  v_sub_f32 v125, v125, v40
  v_sub_f32 v126, v126, v40
  v_sub_f32 v127, v127, v40
  v_sub_f32 v120, v120, v40
  v_sub_f32 v121, v121, v40
  v_sub_f32 v122, v122, v40
  v_sub_f32 v123, v123, v40
  v_sub_f32 v128, v128, v40
  v_sub_f32 v129, v129, v40
  v_sub_f32 v130, v130, v40
  v_sub_f32 v131, v131, v40
  v_exp_f32 v116, v116
  v_exp_f32 v117, v117
  v_exp_f32 v118, v118
  v_exp_f32 v119, v119
  v_cvt_pk_bf16_f32 v116, v116, v117
  v_cvt_pk_bf16_f32 v117, v118, v119
  v_exp_f32 v124, v124
  v_exp_f32 v125, v125
  v_exp_f32 v126, v126
  s_waitcnt lgkmcnt(0)
  s_nop 7
  s_cmp_eq_u32 s35, 1
  s_cbranch_scc1 L_enter
  v_exp_f32 v127, v127
  v_cvt_pk_bf16_f32 v118, v124, v125
  v_cvt_pk_bf16_f32 v119, v126, v127
  v_exp_f32 v120, v120
  v_exp_f32 v121, v121
  v_exp_f32 v122, v122
  v_exp_f32 v123, v123
  v_cvt_pk_bf16_f32 v120, v120, v121
  v_cvt_pk_bf16_f32 v121, v122, v123
  v_exp_f32 v128, v128
  v_exp_f32 v129, v129
  v_exp_f32 v130, v130
  v_exp_f32 v131, v131
  v_cvt_pk_bf16_f32 v122, v128, v129
  v_cvt_pk_bf16_f32 v123, v130, v131
  v_exp_f32 v132, v132
  v_exp_f32 v133, v133
  v_exp_f32 v134, v134
  v_cvt_pk_bf16_f32 v132, v132, v133
  s_nop 7
  s_branch L_pj
L_end:
  s_endpgm
.fill (standalone__window_attn_swin__vision_kernel + 33280 - .) / 4, 4, 0xbf810000
.section .rodata,"a"
.p2align 6
.amdhsa_kernel standalone__window_attn_swin__vision_kernel
  .amdhsa_next_free_vgpr 512
  .amdhsa_next_free_sgpr 102
  .amdhsa_accum_offset 256
  .amdhsa_group_segment_fixed_size 0
  .amdhsa_kernarg_size 72
  .amdhsa_user_sgpr_count 2
  .amdhsa_user_sgpr_kernarg_segment_ptr 1
  .amdhsa_system_sgpr_workgroup_id_x 1
.end_amdhsa_kernel
```
